```python
import torch

def _softmax(x, axis=-1):
    return torch.softmax(x, dim=axis)
def _gelu(x):
    return torch.nn.functional.gelu(x, approximate="tanh")
def _silu(x):
    return torch.nn.functional.silu(x)
def _sigmoid(x):
    return torch.sigmoid(x)
def _layernorm(x, axis=-1, eps=1e-5):
    m = x.mean(dim=axis, keepdim=True)
    v = x.var(dim=axis, keepdim=True, unbiased=False)
    return (x - m) / torch.sqrt(v + eps)
def _scatter_add(tgt, idx, src, axis=0):
    return tgt.clone().index_add_(axis, idx, src)
def _segment_sum(src, seg, n):
    out = torch.zeros((n,) + src.shape[1:], dtype=src.dtype)
    return out.index_add_(0, seg, src)
def _pad(x, pw):
    flat = tuple(v for pair in reversed(pw) for v in pair)
    return torch.nn.functional.pad(x, flat)

kernel_name = 'interleave_layers__sliding_block_cached__glu_gated_swiglu__decode'

def setup_inputs():

    _w = (lambda a: (lambda t: t.to(torch.bfloat16) if t.is_floating_point() else t)(torch.as_tensor(a)))
    def _A_setup():
        B, Sq, D = 1, 1, 640
        Hq, Hkv, Sk, Dh = 32, 32, 32768, 192
        assert Hq % Hkv == 0, (Hq, Hkv)
        return {
            "x": _w((lambda *s: torch.randn(*s, dtype=torch.bfloat16) * 0.05)(B, Sq, D)),
            "k_cache": _w((lambda *s: torch.randn(*s, dtype=torch.bfloat16) * 0.8)(B, Hkv, Sk, Dh)),
            "v_cache": _w((lambda *s: torch.randn(*s, dtype=torch.bfloat16) * 1.6)(B, Hkv, Sk, Dh)),
            "wq": _w((lambda *s: torch.randn(*s, dtype=torch.bfloat16) * 0.8)(D, Hq * Dh) * (D ** -0.5)),
            "wo": _w((lambda *s: torch.randn(*s, dtype=torch.bfloat16) * 1.6)(Hq * Dh, D) * ((Hq * Dh) ** -0.5)),
        }
    _A_in = _A_setup()

    def _B_setup():
        B, S, D, F = 1, 1, 640, 1536
        return {
            "x": _w((lambda *s: torch.randn(*s, dtype=torch.bfloat16) * 0.05)(B, S, D)),
            "w1": _w((lambda *s: torch.randn(*s, dtype=torch.bfloat16) * 0.4)(D, F) * (2.0 / D) ** 0.5),
            "w3": _w((lambda *s: torch.randn(*s, dtype=torch.bfloat16) * 0.4)(D, F) * (2.0 / D) ** 0.5),
            "w2": _w((lambda *s: torch.randn(*s, dtype=torch.bfloat16) * 0.4)(F, D) * (2.0 / F) ** 0.5),
        }
    _B_in = _B_setup()

    return {
        "A_x": _A_in["x"],
        "A_k_cache": _A_in["k_cache"],
        "A_v_cache": _A_in["v_cache"],
        "A_wq": _A_in["wq"],
        "A_wo": _A_in["wo"],
        "B_x": _B_in["x"],
        "B_w1": _B_in["w1"],
        "B_w3": _B_in["w3"],
        "B_w2": _B_in["w2"],
    }

def reference(A_x, A_k_cache, A_v_cache, A_wq, A_wo, B_x, B_w1, B_w3, B_w2):
    def _A_ref(x, k_cache, v_cache, wq, wo):
        B, Sq, D = x.shape
        Hq, Dh = 32, 192
        Hkv, Sk = k_cache.shape[1], k_cache.shape[2]
        W = min(4096, max(256, Sk // 4))
        rep = Hq // Hkv
        q = (lambda x, *d: x.permute(*d))((x @ wq).reshape(B, Sq, Hq, Dh), 0, 2, 1, 3)
        k = (lambda x, n, axis: torch.repeat_interleave(x, n, dim=axis))(k_cache[:, :, Sk - W:, :], rep, axis=1)
        v = (lambda x, n, axis: torch.repeat_interleave(x, n, dim=axis))(v_cache[:, :, Sk - W:, :], rep, axis=1)
        scores = torch.einsum("bhqd,bhkd->bhqk", q, k) * (Dh ** -0.5)
        p = _softmax(scores, axis=-1)
        o = torch.einsum("bhqk,bhkd->bhqd", p, v)
        return (lambda x, *d: x.permute(*d))(o, 0, 2, 1, 3).reshape(B, Sq, Hq * Dh) @ wo

    def _B_ref(x, w1, w3, w2):
        gate = torch.einsum("bsd,df->bsf", x, w1)
        up = torch.einsum("bsd,df->bsf", x, w3)
        h = _silu(gate) * up
        out = torch.einsum("bsf,fd->bsd", h, w2)
        return out

    x = A_x
    x = x + _A_ref(_layernorm(x, axis=-1), A_k_cache, A_v_cache, A_wq, A_wo)
    x = x + _B_ref(_layernorm(x, axis=-1), B_w1, B_w3, B_w2)
    x = x + _A_ref(_layernorm(x, axis=-1), A_k_cache, A_v_cache, A_wq, A_wo)
    x = x + _B_ref(_layernorm(x, axis=-1), B_w1, B_w3, B_w2)
    return x
```

```asm
; @launch grid=(256,1,1) block=(256,1,1) lds=104960
.amdgcn_target "amdgcn-amd-amdhsa--gfx950"
.text
.globl interleave_layers__sliding_block_cached__glu_gated_swiglu__decode_kernel
.p2align 8
.type interleave_layers__sliding_block_cached__glu_gated_swiglu__decode_kernel,@function
interleave_layers__sliding_block_cached__glu_gated_swiglu__decode_kernel:
    s_cmp_ge_u32 s2, 256
    s_cbranch_scc1 DONE
    s_load_dwordx16 s[64:79], s[0:1], 0
    s_load_dwordx8 s[80:87], s[0:1], 64
    v_and_b32 v1, 63, v0
    v_lshrrev_b32 v13, 6, v0
    s_and_b32 s45, s2, 7
    v_readfirstlane_b32 s44, v13
    s_lshr_b32 s46, s2, 3
    s_lshr_b32 s47, s46, 3
    s_lshl_b32 s52, s45, 2
    s_add_u32 s47, s47, s52
    s_and_b32 s48, s46, 7
    v_lshrrev_b32 v19, 4, v1
    v_and_b32 v20, 3, v1
    v_bfe_u32 v21, v1, 2, 2
    v_mul_u32_u24 v16, 384, v21
    v_lshl_add_u32 v16, v20, 4, v16
    v_lshrrev_b32 v22, 5, v1
    v_mul_u32_u24 v17, 1536, v22
    v_add_u32 v17, v17, v16
    v_and_b32 v22, 1, v19
    v_lshl_add_u32 v17, v22, 6, v17
    v_add_u32 v17, 256, v17
    v_lshl_add_u32 v16, v19, 6, v16
    s_mul_i32 s55, s47, 12582912
    s_mul_i32 s52, s48, 196608
    s_add_u32 s55, s55, s52
    s_mul_i32 s52, s44, 3072
    s_add_u32 s55, s55, s52
    s_add_u32 s55, s55, 11010048
    s_waitcnt lgkmcnt(0)
    s_mov_b32 s8, s66
    s_and_b32 s9, s67, 0xffff
    s_mov_b32 s10, 402653184
    s_mov_b32 s11, 0x20000
    s_add_u32 s54, s55, 0
    buffer_load_dwordx4 a[0:3], v16, s[8:11], s54 offen nt
    buffer_load_dwordx4 a[4:7], v16, s[8:11], s54 offen offset:1536 nt
    buffer_load_dwordx4 a[8:11], v17, s[8:11], s54 offen nt
    s_add_u32 s54, s55, 12288
    buffer_load_dwordx4 a[12:15], v16, s[8:11], s54 offen nt
    buffer_load_dwordx4 a[16:19], v16, s[8:11], s54 offen offset:1536 nt
    buffer_load_dwordx4 a[20:23], v17, s[8:11], s54 offen nt
    s_add_u32 s54, s55, 24576
    buffer_load_dwordx4 a[24:27], v16, s[8:11], s54 offen nt
    buffer_load_dwordx4 a[28:31], v16, s[8:11], s54 offen offset:1536 nt
    buffer_load_dwordx4 a[32:35], v17, s[8:11], s54 offen nt
    s_add_u32 s54, s55, 36864
    buffer_load_dwordx4 a[36:39], v16, s[8:11], s54 offen nt
    buffer_load_dwordx4 a[40:43], v16, s[8:11], s54 offen offset:1536 nt
    buffer_load_dwordx4 a[44:47], v17, s[8:11], s54 offen nt
    s_mov_b32 s12, s68
    s_and_b32 s13, s69, 0xffff
    s_mov_b32 s14, 402653184
    s_mov_b32 s15, 0x20000
    s_mov_b32 s16, s86
    s_and_b32 s17, s87, 0xffff
    s_mov_b32 s18, 1610612736
    s_mov_b32 s19, 0x20000
    s_mov_b32 s20, s70
    s_and_b32 s21, s71, 0xffff
    s_mov_b32 s22, 7864320
    s_mov_b32 s23, 0x20000
    s_mov_b32 s32, s64
    s_and_b32 s33, s65, 0xffff
    s_mov_b32 s34, 1280
    s_mov_b32 s35, 0x20000
    s_mov_b32 s36, s82
    s_and_b32 s37, s83, 0xffff
    s_mov_b32 s38, 1280
    s_mov_b32 s39, 0x20000
    s_mov_b32 s40, s84
    s_and_b32 s41, s85, 0xffff
    s_mov_b32 s42, 256
    s_mov_b32 s43, 0x20000
    s_cmp_ge_u32 s46, 10
    s_cselect_b32 s56, 1, 0
    s_cmp_ge_u32 s46, 20
    s_cselect_b32 s52, 2, s56
    s_mul_i32 s52, s52, 10
    s_sub_u32 s57, s46, s52
    s_min_u32 s4, s46, 29
    s_cmp_ge_u32 s4, 15
    s_cselect_b32 s58, 1, 0
    s_mul_i32 s52, s58, 15
    s_sub_u32 s52, s4, s52
    s_mul_i32 s59, s52, 52
    s_lshr_b32 s59, s59, 8
    s_mul_i32 s53, s59, 5
    s_sub_u32 s3, s52, s53
    s_cmp_ge_u32 s46, 20
    s_cselect_b32 s24, s80, s72
    s_cselect_b32 s25, s81, s73
    s_mov_b32 s26, 7864320
    s_cselect_b32 s26, 1966080, s26
    s_and_b32 s25, s25, 0xffff
    s_mov_b32 s27, 0x20000
    s_cmp_eq_u32 s58, 1
    s_cselect_b32 s28, s78, s76
    s_cselect_b32 s29, s79, s77
    s_and_b32 s29, s29, 0xffff
    s_mov_b32 s30, 1966080
    s_mov_b32 s31, 0x20000
    s_cmp_ge_u32 s46, 20
    s_cselect_b32 s52, 0, s56
    s_or_b32 s52, s52, s45
    s_cmp_eq_u32 s52, 0
    s_cselect_b32 s62, 1.0, 0
    s_mov_b32 s49, 0
    s_mov_b32 s50, 0
    s_mov_b32 s6, 1
    v_and_b32 v23, 31, v1
    s_lshl_b32 s52, s44, 5
    v_add_u32 v23, s52, v23
    v_min_u32 v23, 79, v23
    s_mul_i32 s52, s48, 160
    v_lshlrev_b32 v23, 1, v23
    v_mov_b32 v30, 0
    buffer_load_short_d16_hi v30, v23, s[32:35], s52 offen
    v_add_u32 v24, 0, v1
    v_mul_u32_u24 v25, 171, v24
    v_lshrrev_b32 v25, 12, v25
    v_mul_u32_u24 v26, 24, v25
    v_sub_u32 v26, v24, v26
    v_mul_u32_u24 v25, 12288, v25
    v_lshl_add_u32 v27, v26, 4, v25
    v_add_u32 v24, 64, v1
    v_mul_u32_u24 v25, 171, v24
    v_lshrrev_b32 v25, 12, v25
    v_mul_u32_u24 v26, 24, v25
    v_sub_u32 v26, v24, v26
    v_mul_u32_u24 v25, 12288, v25
    v_lshl_add_u32 v28, v26, 4, v25
    v_add_u32 v24, 128, v1
    v_mul_u32_u24 v25, 171, v24
    v_lshrrev_b32 v25, 12, v25
    v_mul_u32_u24 v26, 24, v25
    v_sub_u32 v26, v24, v26
    v_mul_u32_u24 v25, 12288, v25
    v_lshl_add_u32 v29, v26, 4, v25
    s_mul_i32 s52, s48, 983040
    s_mul_i32 s53, s47, 384
    s_add_u32 s52, s52, s53
    s_mul_i32 s53, s44, 98304
    s_add_u32 s52, s52, s53
    s_mul_i32 s53, s44, 3072
    s_add_u32 m0, s53, 65536
    s_add_u32 s54, s52, 0
    buffer_load_dwordx4 v27, s[20:23], s54 offen nt lds
    s_add_u32 m0, s53, 66560
    s_nop 0
    buffer_load_dwordx4 v28, s[20:23], s54 offen nt lds
    s_add_u32 m0, s53, 67584
    s_nop 0
    buffer_load_dwordx4 v29, s[20:23], s54 offen nt lds
    s_add_u32 m0, s53, 77824
    s_add_u32 s54, s52, 393216
    buffer_load_dwordx4 v27, s[20:23], s54 offen nt lds
    s_add_u32 m0, s53, 78848
    s_nop 0
    buffer_load_dwordx4 v28, s[20:23], s54 offen nt lds
    s_add_u32 m0, s53, 79872
    s_nop 0
    buffer_load_dwordx4 v29, s[20:23], s54 offen nt lds
    s_cmp_ge_u32 s44, 2
    s_cbranch_scc1 WQD
    s_add_u32 m0, s53, 90112
    s_add_u32 s54, s52, 786432
    buffer_load_dwordx4 v27, s[20:23], s54 offen nt lds
    s_add_u32 m0, s53, 91136
    s_nop 0
    buffer_load_dwordx4 v28, s[20:23], s54 offen nt lds
    s_add_u32 m0, s53, 92160
    s_nop 0
    buffer_load_dwordx4 v29, s[20:23], s54 offen nt lds
WQD:
    v_mov_b32 v32, -1
    v_mov_b32 v33, -1
    s_mov_b32 s5, 1048576
    s_mul_i32 s52, s47, 12288
    s_mul_i32 s53, s44, 3072
    s_add_u32 s52, s52, s53
    s_lshl_b32 s53, s48, 7
    s_add_u32 s52, s52, s53
    v_lshl_add_u32 v24, v1, 3, s52
    s_lshl_b32 s52, s47, 7
    s_lshl_b32 s53, s48, 3
    s_add_u32 s52, s52, s53
    s_add_u32 s52, s52, 393216
    v_mov_b32 v25, s52
    s_lshl_b32 s52, s47, 3
    s_add_u32 s52, s52, s48
    s_mul_i32 s52, s52, 384
    s_mul_i32 s53, s44, 96
    s_add_u32 s52, s52, s53
    s_add_u32 s52, s52, 479232
    v_lshl_add_u32 v26, v1, 2, s52
    s_lshl_b32 s52, s47, 7
    s_lshl_b32 s53, s48, 2
    s_add_u32 s52, s52, s53
    s_add_u32 s52, s52, 577536
    v_writelane_b32 v26, s52, 24
    v_and_b32 v31, 31, v1
    s_lshl_b32 s52, s44, 5
    v_add_u32 v31, s52, v31
    s_mul_i32 s52, s47, 2560
    s_mul_i32 s53, s48, 320
    s_add_u32 s52, s52, s53
    s_add_u32 s52, s52, 397312
    v_lshl_add_u32 v31, v31, 2, s52
    v_and_b32 v34, 31, v1
    s_lshl_b32 s52, s44, 5
    v_add_u32 v34, s52, v34
    s_mov_b64 exec, 0xffff
    buffer_store_dwordx2 v[32:33], v24, s[16:19], 0 offen offset:0 sc1
    buffer_store_dwordx2 v[32:33], v24, s[16:19], 0 offen offset:1024 sc1
    buffer_store_dwordx2 v[32:33], v24, s[16:19], 0 offen offset:2048 sc1
    buffer_store_dwordx2 v[32:33], v24, s[16:19], s5 offen offset:0 sc1
    buffer_store_dwordx2 v[32:33], v24, s[16:19], s5 offen offset:1024 sc1
    buffer_store_dwordx2 v[32:33], v24, s[16:19], s5 offen offset:2048 sc1
    s_mov_b64 exec, 0x1ffffff
    buffer_store_dword v32, v26, s[16:19], 0 offen offset:0 sc1
    buffer_store_dword v32, v26, s[16:19], s5 offen offset:0 sc1
    s_mov_b64 exec, 1
    buffer_store_dwordx2 v[32:33], v25, s[16:19], 0 offen offset:0 sc1
    buffer_store_dwordx2 v[32:33], v25, s[16:19], s5 offen offset:0 sc1
    s_mov_b64 exec, -1
    v_cmp_gt_u32 vcc, 80, v34
    s_and_b32 vcc_hi, vcc_hi, 0
    s_mov_b64 exec, vcc
    s_cbranch_execz NOXR
    buffer_store_dword v32, v31, s[16:19], 0 offen offset:0 sc1
    buffer_store_dword v32, v31, s[16:19], s5 offen offset:0 sc1
NOXR:
    s_mov_b64 exec, -1
    s_cmp_ge_u32 s46, 30
    s_cbranch_scc1 CLRD
    s_mul_i32 s52, s45, 12
    s_lshl_b32 s53, s59, 2
    s_add_u32 s52, s52, s53
    s_add_u32 s52, s52, s44
    s_mul_i32 s52, s52, 10
    s_mul_i32 s53, s58, 5
    s_add_u32 s52, s52, s53
    s_add_u32 s52, s52, s3
    s_lshl_b32 s52, s52, 7
    s_add_u32 s52, s52, 663552
    v_lshl_add_u32 v24, v1, 3, s52
    s_lshl_b32 s52, s45, 5
    s_add_u32 s52, s52, s4
    s_lshl_b32 s52, s52, 3
    s_add_u32 s52, s52, 786432
    v_mov_b32 v25, s52
    v_and_b32 v26, 31, v1
    s_lshl_b32 s52, s44, 5
    v_add_u32 v26, s52, v26
    s_lshl_b32 s52, s45, 5
    s_add_u32 s52, s52, s4
    s_lshl_b32 s52, s52, 9
    s_add_u32 s52, s52, 790528
    v_lshl_add_u32 v26, v26, 2, s52
    s_cmp_ge_u32 s46, 20
    s_cbranch_scc1 CLRY2
    s_lshl_b32 s52, s57, 2
    s_add_u32 s52, s52, s44
    s_lshl_b32 s52, s52, 4
    s_lshl_b32 s53, s45, 1
    s_add_u32 s52, s52, s53
    s_add_u32 s52, s52, s56
    s_lshl_b32 s52, s52, 7
    s_add_u32 s52, s52, 581632
    v_lshl_add_u32 v31, v1, 2, s52
    s_branch CLRY
CLRY2:
    s_lshl_b32 s52, s57, 2
    s_add_u32 s52, s52, s44
    s_lshl_b32 s52, s52, 3
    s_add_u32 s52, s52, s45
    s_lshl_b32 s52, s52, 7
    s_add_u32 s52, s52, 921600
    v_lshl_add_u32 v31, v1, 2, s52
CLRY:
    s_mov_b64 exec, 0xffff
    buffer_store_dwordx2 v[32:33], v24, s[16:19], 0 offen offset:0 sc1
    buffer_store_dwordx2 v[32:33], v24, s[16:19], s5 offen offset:0 sc1
    buffer_store_dword v32, v31, s[16:19], 0 offen offset:0 sc1
    buffer_store_dword v32, v31, s[16:19], s5 offen offset:0 sc1
    s_mov_b64 exec, 1
    buffer_store_dwordx2 v[32:33], v25, s[16:19], 0 offen offset:0 sc1
    buffer_store_dwordx2 v[32:33], v25, s[16:19], s5 offen offset:0 sc1
    s_mov_b32 exec_lo, -1
    buffer_store_dword v32, v26, s[16:19], 0 offen offset:0 sc1
    buffer_store_dword v32, v26, s[16:19], s5 offen offset:0 sc1
    s_mov_b64 exec, -1
CLRD:
    v_and_b32 v24, 15, v1
    v_cmp_eq_u32 vcc, 1, v24
    v_mov_b32 v25, 96256
    v_mov_b32 v26, 97280
    v_cndmask_b32 v2, v25, v26, vcc
    v_lshl_add_u32 v2, v19, 4, v2
    v_lshlrev_b32 v24, 6, v19
    v_lshl_add_u32 v24, v20, 4, v24
    v_add_u32 v24, 98304, v24
    v_and_b32 v25, 1, v19
    v_lshlrev_b32 v25, 6, v25
    v_lshl_add_u32 v25, v20, 4, v25
    v_add_u32 v25, 98560, v25
    v_mov_b32 v26, 98688
    v_and_b32 v27, 2, v19
    v_cmp_eq_u32 vcc, 0, v21
    s_nop 1
    v_cndmask_b32 v3, v26, v24, vcc
    v_cmp_eq_u32 vcc, 2, v21
    s_nop 1
    v_cndmask_b32 v4, v26, v24, vcc
    v_cmp_eq_u32 vcc, 1, v21
    s_nop 1
    v_cndmask_b32 v6, v26, v24, vcc
    v_cmp_eq_u32 vcc, 3, v21
    s_nop 1
    v_cndmask_b32 v7, v26, v24, vcc
    v_cmp_eq_u32 vcc, v27, v21
    v_add_u32 v27, 1, v27
    s_nop 0
    v_cndmask_b32 v5, v26, v25, vcc
    v_cmp_eq_u32 vcc, v27, v21
    s_nop 1
    v_cndmask_b32 v8, v26, v25, vcc
    v_and_b32 v24, 1, v1
    v_lshlrev_b32 v24, 4, v24
    v_mov_b32 v25, 0xffff
    v_lshlrev_b32 v25, v24, v25
    v_bfe_u32 v24, v1, 1, 2
    v_cmp_eq_u32 vcc, 0, v24
    s_nop 1
    v_cndmask_b32 v9, 0, v25, vcc
    v_cmp_eq_u32 vcc, 1, v24
    s_nop 1
    v_cndmask_b32 v10, 0, v25, vcc
    v_cmp_eq_u32 vcc, 2, v24
    s_nop 1
    v_cndmask_b32 v11, 0, v25, vcc
    v_cmp_eq_u32 vcc, 3, v24
    s_nop 1
    v_cndmask_b32 v12, 0, v25, vcc
    v_cmp_gt_u32 vcc, 40, v0
    v_cmp_le_u32 s[60:61], 64, v0
    s_or_b64 vcc, vcc, s[60:61]
    v_mov_b32 v25, 0x3f803f80
    s_nop 0
    v_cndmask_b32 v25, 0, v25, vcc
    v_lshlrev_b32 v24, 2, v0
    v_add_u32 v24, 97280, v24
    ds_write_b32 v24, v25
    v_mov_b32 v24, 98688
    v_mov_b64 v[26:27], 0
    ds_write_b64 v24, v[26:27]
    ds_write_b64 v24, v[26:27] offset:8
    s_getreg_b32 s52, hwreg(HW_REG_XCC_ID)
    s_and_b32 s52, s52, 15
    s_mul_i32 s53, s52, s52
    s_lshl_b32 s52, s52, 8
    s_lshl_b32 s53, s53, 18
    s_add_u32 s5, s52, s53
    s_add_u32 s5, s5, 1
    s_add_u32 s54, s55, 49152
    buffer_load_dwordx4 a[48:51], v16, s[8:11], s54 offen nt
    buffer_load_dwordx4 a[52:55], v16, s[8:11], s54 offen offset:1536 nt
    buffer_load_dwordx4 a[56:59], v17, s[8:11], s54 offen nt
    s_add_u32 s54, s55, 61440
    buffer_load_dwordx4 a[60:63], v16, s[8:11], s54 offen nt
    buffer_load_dwordx4 a[64:67], v16, s[8:11], s54 offen offset:1536 nt
    buffer_load_dwordx4 a[68:71], v17, s[8:11], s54 offen nt
    s_add_u32 s54, s55, 73728
    buffer_load_dwordx4 a[72:75], v16, s[8:11], s54 offen nt
    buffer_load_dwordx4 a[76:79], v16, s[8:11], s54 offen offset:1536 nt
    buffer_load_dwordx4 a[80:83], v17, s[8:11], s54 offen nt
    s_add_u32 s54, s55, 86016
    buffer_load_dwordx4 a[84:87], v16, s[8:11], s54 offen nt
    buffer_load_dwordx4 a[88:91], v16, s[8:11], s54 offen offset:1536 nt
    buffer_load_dwordx4 a[92:95], v17, s[8:11], s54 offen nt
    s_add_u32 s54, s55, 98304
    buffer_load_dwordx4 a[96:99], v16, s[8:11], s54 offen nt
    buffer_load_dwordx4 a[100:103], v16, s[8:11], s54 offen offset:1536 nt
    buffer_load_dwordx4 a[104:107], v17, s[8:11], s54 offen nt
    s_add_u32 s54, s55, 110592
    buffer_load_dwordx4 a[108:111], v16, s[8:11], s54 offen nt
    buffer_load_dwordx4 a[112:115], v16, s[8:11], s54 offen offset:1536 nt
    buffer_load_dwordx4 a[116:119], v17, s[8:11], s54 offen nt
    v_mov_b32 v80, v16
    v_mov_b32 v81, v17
    s_waitcnt vmcnt(18)
    s_barrier
    s_cmp_lg_u32 s44, 3
    s_cbranch_scc1 NOAT
    v_mov_b32 v24, s5
    s_lshl_b32 s52, s45, 2
    v_mov_b32 v25, 0
    s_mov_b64 exec, 1
    buffer_atomic_add v24, v25, s[40:43], s52 offen sc1
    s_mov_b64 exec, -1
NOAT:
    v_and_b32 v16, 15, v1
    v_lshrrev_b32 v17, 4, v1
    v_lshrrev_b32 v18, 2, v16
    v_and_b32 v16, 3, v16
    v_lshlrev_b32 v16, 3, v16
    s_mul_i32 s52, s44, 96
    s_add_u32 s52, s52, 65536
    v_add_u32 v16, s52, v16
    v_mul_u32_u24 v18, 384, v18
    v_add_u32 v16, v16, v18
    v_and_b32 v18, 1, v17
    v_mul_u32_u24 v17, 3072, v17
    v_mul_u32_u24 v18, 3072, v18
    v_add_u32 v17, v17, v16
    v_add_u32 v18, v18, v16
    ds_read_b64_tr_b16 v[44:45], v17 offset:0
    ds_read_b64_tr_b16 v[46:47], v17 offset:1536
    ds_read_b64_tr_b16 v[48:49], v17 offset:12288
    ds_read_b64_tr_b16 v[50:51], v17 offset:13824
    ds_read_b64_tr_b16 v[52:53], v18 offset:24576
    ds_read_b64_tr_b16 v[54:55], v18 offset:26112
    ds_read_b64_tr_b16 v[56:57], v17 offset:32
    ds_read_b64_tr_b16 v[58:59], v17 offset:1568
    ds_read_b64_tr_b16 v[60:61], v17 offset:12320
    ds_read_b64_tr_b16 v[62:63], v17 offset:13856
    ds_read_b64_tr_b16 v[64:65], v18 offset:24608
    ds_read_b64_tr_b16 v[66:67], v18 offset:26144
    ds_read_b64_tr_b16 v[68:69], v17 offset:64
    ds_read_b64_tr_b16 v[70:71], v17 offset:1600
    ds_read_b64_tr_b16 v[72:73], v17 offset:12352
    ds_read_b64_tr_b16 v[74:75], v17 offset:13888
    ds_read_b64_tr_b16 v[76:77], v18 offset:24640
    ds_read_b64_tr_b16 v[78:79], v18 offset:26176
    s_mul_i32 s52, s47, 12288
    s_mul_i32 s53, s44, 3072
    s_add_u32 s52, s52, s53
    s_lshl_b32 s53, s48, 7
    s_add_u32 s52, s52, s53
    v_lshl_add_u32 v14, v1, 3, s52
    s_lshl_b32 s52, s47, 7
    s_lshl_b32 s53, s48, 3
    s_add_u32 s52, s52, s53
    s_add_u32 s52, s52, 393216
    v_mov_b32 v15, s52
    v_and_b32 v28, 31, v1
    s_lshl_b32 s52, s44, 5
    v_add_u32 v28, s52, v28
    s_mul_i32 s52, s47, 2560
    s_mul_i32 s53, s48, 320
    s_add_u32 s52, s52, s53
    s_add_u32 s52, s52, 397312
    v_lshl_add_u32 v28, v28, 2, s52
    v_and_b32 v29, 31, v1
    s_lshl_b32 s52, s44, 5
    v_add_u32 v29, s52, v29
    s_branch QMID
LOOP:
    v_and_b32 v16, 15, v1
    v_lshrrev_b32 v17, 4, v1
    v_lshrrev_b32 v18, 2, v16
    v_and_b32 v16, 3, v16
    v_lshlrev_b32 v16, 3, v16
    s_mul_i32 s52, s44, 96
    s_add_u32 s52, s52, 65536
    v_add_u32 v16, s52, v16
    v_mul_u32_u24 v18, 384, v18
    v_add_u32 v16, v16, v18
    v_and_b32 v18, 1, v17
    v_mul_u32_u24 v17, 3072, v17
    v_mul_u32_u24 v18, 3072, v18
    v_add_u32 v17, v17, v16
    v_add_u32 v18, v18, v16
    ds_read_b64_tr_b16 v[44:45], v17 offset:0
    ds_read_b64_tr_b16 v[46:47], v17 offset:1536
    ds_read_b64_tr_b16 v[48:49], v17 offset:12288
    ds_read_b64_tr_b16 v[50:51], v17 offset:13824
    ds_read_b64_tr_b16 v[52:53], v18 offset:24576
    ds_read_b64_tr_b16 v[54:55], v18 offset:26112
    ds_read_b64_tr_b16 v[56:57], v17 offset:32
    ds_read_b64_tr_b16 v[58:59], v17 offset:1568
    ds_read_b64_tr_b16 v[60:61], v17 offset:12320
    ds_read_b64_tr_b16 v[62:63], v17 offset:13856
    ds_read_b64_tr_b16 v[64:65], v18 offset:24608
    ds_read_b64_tr_b16 v[66:67], v18 offset:26144
    ds_read_b64_tr_b16 v[68:69], v17 offset:64
    ds_read_b64_tr_b16 v[70:71], v17 offset:1600
    ds_read_b64_tr_b16 v[72:73], v17 offset:12352
    ds_read_b64_tr_b16 v[74:75], v17 offset:13888
    ds_read_b64_tr_b16 v[76:77], v18 offset:24640
    ds_read_b64_tr_b16 v[78:79], v18 offset:26176
    s_mul_i32 s52, s47, 12288
    s_mul_i32 s53, s44, 3072
    s_add_u32 s52, s52, s53
    s_lshl_b32 s53, s48, 7
    s_add_u32 s52, s52, s53
    v_lshl_add_u32 v14, v1, 3, s52
    s_lshl_b32 s52, s47, 7
    s_lshl_b32 s53, s48, 3
    s_add_u32 s52, s52, s53
    s_add_u32 s52, s52, 393216
    v_mov_b32 v15, s52
    v_and_b32 v28, 31, v1
    s_lshl_b32 s52, s44, 5
    v_add_u32 v28, s52, v28
    s_mul_i32 s52, s47, 2560
    s_mul_i32 s53, s48, 320
    s_add_u32 s52, s52, s53
    s_add_u32 s52, s52, 397312
    v_lshl_add_u32 v28, v28, 2, s52
    v_and_b32 v29, 31, v1
    s_lshl_b32 s52, s44, 5
    v_add_u32 v29, s52, v29
    s_cmp_eq_u32 s44, 3
    s_cbranch_scc1 Y2OK
    v_min_u32 v20, 79, v29
    s_mul_i32 s52, s48, 80
    v_add_u32 v20, s52, v20
    v_lshrrev_b32 v21, 4, v20
    v_and_b32 v20, 15, v20
    v_lshlrev_b32 v21, 10, v21
    v_lshl_add_u32 v21, v20, 2, v21
    v_lshrrev_b32 v20, 5, v1
    v_lshl_add_u32 v21, v20, 9, v21
    v_add_u32 v21, 921600, v21
    s_mov_b32 s51, 0
Y2P:
    buffer_load_dword v22, v21, s[16:19], s49 offen offset:0 sc1
    buffer_load_dword v23, v21, s[16:19], s49 offen offset:128 sc1
    buffer_load_dword v24, v21, s[16:19], s49 offen offset:256 sc1
    buffer_load_dword v25, v21, s[16:19], s49 offen offset:384 sc1
    s_waitcnt vmcnt(0)
    v_add_f32 v22, v22, v23
    v_add_f32 v24, v24, v25
    v_add_f32 v30, v22, v24
    v_mov_b32 v31, v30
    s_nop 1
    v_permlane32_swap_b32 v30, v31
    v_add_f32 v30, v30, v31
    v_cmp_u_f32 vcc, v30, v30
    s_cbranch_vccz Y2OK
    s_add_u32 s51, s51, 1
    s_sleep 1
    s_cmp_lt_u32 s51, 0x8000
    s_cbranch_scc1 Y2P
Y2OK:
    s_cmp_lg_u32 s49, 0
    s_cbranch_scc1 FINAL
    s_mov_b32 s49, 1048576
QMID:
    s_cmp_eq_u32 s44, 3
    s_cbranch_scc1 QX
    v_cvt_pk_bf16_f32 v30, v30, v30
    v_cmp_gt_u32 vcc, 80, v29
    v_lshlrev_b32 v20, 1, v29
    v_add_u32 v20, 96256, v20
    v_cndmask_b32 v30, 0, v30, vcc
    ds_write_b16 v20, v30
    v_and_b32 v30, 0xffff0000, v30
    s_and_b32 vcc_hi, vcc_hi, 0
    s_mov_b64 exec, vcc
    s_cmp_eq_u32 s50, 0
    s_cbranch_scc1 SLOW0
    buffer_store_dword v30, v28, s[16:19], s49 offen
PUBD0:
    s_mov_b64 exec, -1
QX:
    s_waitcnt lgkmcnt(0)
    s_barrier
    ds_read_b128 v[32:35], v2 offset:0
    ds_read_b128 v[36:39], v2 offset:64
    ds_read_b128 v[40:43], v2 offset:128
    s_waitcnt lgkmcnt(0)
    v_mfma_f32_16x16x32_bf16 v[16:19], v[32:35], v[44:47], 0
    v_mfma_f32_16x16x32_bf16 v[16:19], v[36:39], v[48:51], v[16:19]
    v_mfma_f32_16x16x32_bf16 v[16:19], v[40:43], v[52:55], v[16:19]
    v_mfma_f32_16x16x32_bf16 v[20:23], v[32:35], v[56:59], 0
    v_mfma_f32_16x16x32_bf16 v[20:23], v[36:39], v[60:63], v[20:23]
    v_mfma_f32_16x16x32_bf16 v[20:23], v[40:43], v[64:67], v[20:23]
    v_mfma_f32_16x16x32_bf16 v[24:27], v[32:35], v[68:71], 0
    v_mfma_f32_16x16x32_bf16 v[24:27], v[36:39], v[72:75], v[24:27]
    v_mfma_f32_16x16x32_bf16 v[24:27], v[40:43], v[76:79], v[24:27]
    v_mfma_f32_16x16x32_bf16 v[28:31], v[32:35], v[32:35], 0
    v_mfma_f32_16x16x32_bf16 v[28:31], v[36:39], v[36:39], v[28:31]
    v_mfma_f32_16x16x32_bf16 v[28:31], v[40:43], v[40:43], v[28:31]
    s_mov_b64 exec, 0xffff
    s_nop 2
    s_cmp_eq_u32 s50, 0
    s_cbranch_scc1 SLOW1
    buffer_store_dwordx2 v[16:17], v14, s[16:19], s49 offen offset:0
    buffer_store_dwordx2 v[20:21], v14, s[16:19], s49 offen offset:1024
    buffer_store_dwordx2 v[24:25], v14, s[16:19], s49 offen offset:2048
PUBD1:
    s_cmp_lg_u32 s44, 3
    s_cbranch_scc1 NOQS
    s_mov_b64 exec, 1
    s_nop 4
    s_cmp_eq_u32 s50, 0
    s_cbranch_scc1 SLOW2
    buffer_store_dwordx2 v[28:29], v15, s[16:19], s49 offen
PUBD2:
NOQS:
    s_mov_b64 exec, -1
    s_cmp_eq_u32 s6, 0
    s_cbranch_scc1 ENTRY
    v_mov_b32 v16, v80
    v_mov_b32 v17, v81
    s_add_u32 s54, s55, 122880
    buffer_load_dwordx4 a[120:123], v16, s[8:11], s54 offen nt
    buffer_load_dwordx4 a[124:127], v16, s[8:11], s54 offen offset:1536 nt
    buffer_load_dwordx4 a[128:131], v17, s[8:11], s54 offen nt
    s_add_u32 s54, s55, 135168
    buffer_load_dwordx4 a[132:135], v16, s[8:11], s54 offen nt
    buffer_load_dwordx4 a[136:139], v16, s[8:11], s54 offen offset:1536 nt
    buffer_load_dwordx4 a[140:143], v17, s[8:11], s54 offen nt
    s_add_u32 s54, s55, 147456
    buffer_load_dwordx4 a[144:147], v16, s[8:11], s54 offen nt
    buffer_load_dwordx4 a[148:151], v16, s[8:11], s54 offen offset:1536 nt
    buffer_load_dwordx4 a[152:155], v17, s[8:11], s54 offen nt
    s_add_u32 s54, s55, 159744
    buffer_load_dwordx4 a[156:159], v16, s[8:11], s54 offen nt
    buffer_load_dwordx4 a[160:163], v16, s[8:11], s54 offen offset:1536 nt
    buffer_load_dwordx4 a[164:167], v17, s[8:11], s54 offen nt
    s_add_u32 s54, s55, 172032
    buffer_load_dwordx4 a[168:171], v16, s[8:11], s54 offen nt
    buffer_load_dwordx4 a[172:175], v16, s[8:11], s54 offen offset:1536 nt
    buffer_load_dwordx4 a[176:179], v17, s[8:11], s54 offen nt
    s_add_u32 s54, s55, 184320
    buffer_load_dwordx4 a[180:183], v16, s[8:11], s54 offen nt
    buffer_load_dwordx4 a[184:187], v16, s[8:11], s54 offen offset:1536 nt
    buffer_load_dwordx4 a[188:191], v17, s[8:11], s54 offen nt
    v_lshrrev_b32 v24, 3, v1
    v_and_b32 v25, 7, v1
    v_mul_u32_u24 v26, 1280, v24
    v_lshl_add_u32 v26, v25, 4, v26
    s_cmp_ge_u32 s46, 30
    s_cbranch_scc1 WOD
    s_mul_i32 s52, s45, 768
    s_mul_i32 s53, s56, 384
    s_add_u32 s52, s52, s53
    s_mul_i32 s53, s45, 192
    s_cmp_ge_u32 s46, 20
    s_cselect_b32 s52, s53, s52
    s_lshl_b32 s53, s44, 3
    s_add_u32 s52, s52, s53
    s_mul_i32 s52, s52, 1280
    s_lshl_b32 s53, s57, 7
    s_add_u32 s52, s52, s53
    s_lshl_b32 s53, s44, 10
    s_add_u32 m0, s53, 0
    s_add_u32 s54, s52, 0
    buffer_load_dwordx4 v26, s[24:27], s54 offen nt lds
    s_add_u32 m0, s53, 4096
    s_add_u32 s54, s52, 40960
    buffer_load_dwordx4 v26, s[24:27], s54 offen nt lds
    s_add_u32 m0, s53, 8192
    s_add_u32 s54, s52, 81920
    buffer_load_dwordx4 v26, s[24:27], s54 offen nt lds
    s_add_u32 m0, s53, 12288
    s_add_u32 s54, s52, 122880
    buffer_load_dwordx4 v26, s[24:27], s54 offen nt lds
    s_add_u32 m0, s53, 16384
    s_add_u32 s54, s52, 163840
    buffer_load_dwordx4 v26, s[24:27], s54 offen nt lds
    s_add_u32 m0, s53, 20480
    s_add_u32 s54, s52, 204800
    buffer_load_dwordx4 v26, s[24:27], s54 offen nt lds
    s_cmp_ge_u32 s46, 20
    s_cbranch_scc1 WOD
    s_add_u32 m0, s53, 24576
    s_add_u32 s54, s52, 245760
    buffer_load_dwordx4 v26, s[24:27], s54 offen nt lds
    s_add_u32 m0, s53, 28672
    s_add_u32 s54, s52, 286720
    buffer_load_dwordx4 v26, s[24:27], s54 offen nt lds
    s_add_u32 m0, s53, 32768
    s_add_u32 s54, s52, 327680
    buffer_load_dwordx4 v26, s[24:27], s54 offen nt lds
    s_add_u32 m0, s53, 36864
    s_add_u32 s54, s52, 368640
    buffer_load_dwordx4 v26, s[24:27], s54 offen nt lds
    s_add_u32 m0, s53, 40960
    s_add_u32 s54, s52, 409600
    buffer_load_dwordx4 v26, s[24:27], s54 offen nt lds
    s_add_u32 m0, s53, 45056
    s_add_u32 s54, s52, 450560
    buffer_load_dwordx4 v26, s[24:27], s54 offen nt lds
WOD:
    v_lshrrev_b32 v40, 4, v1
    v_bfe_u32 v41, v1, 3, 1
    v_lshl_add_u32 v40, v41, 2, v40
    v_mul_u32_u24 v40, 384, v40
    v_and_b32 v41, 7, v1
    v_lshl_add_u32 v40, v41, 4, v40
    v_lshlrev_b32 v41, 2, v41
    buffer_load_dword v42, v41, s[40:43], 0 offen sc1
    s_add_u32 s54, s55, 0
    buffer_load_dwordx4 a[192:195], v40, s[12:15], s54 offen offset:0 nt
    buffer_load_dwordx4 a[196:199], v40, s[12:15], s54 offen offset:128 nt
    buffer_load_dwordx4 a[200:203], v40, s[12:15], s54 offen offset:256 nt
    s_add_u32 s54, s55, 12288
    buffer_load_dwordx4 a[204:207], v40, s[12:15], s54 offen offset:0 nt
    buffer_load_dwordx4 a[208:211], v40, s[12:15], s54 offen offset:128 nt
    buffer_load_dwordx4 a[212:215], v40, s[12:15], s54 offen offset:256 nt
    s_add_u32 s54, s55, 24576
    buffer_load_dwordx4 a[216:219], v40, s[12:15], s54 offen offset:0 nt
    buffer_load_dwordx4 a[220:223], v40, s[12:15], s54 offen offset:128 nt
    buffer_load_dwordx4 a[224:227], v40, s[12:15], s54 offen offset:256 nt
    s_add_u32 s54, s55, 36864
    buffer_load_dwordx4 a[228:231], v40, s[12:15], s54 offen offset:0 nt
    buffer_load_dwordx4 a[232:235], v40, s[12:15], s54 offen offset:128 nt
    buffer_load_dwordx4 a[236:239], v40, s[12:15], s54 offen offset:256 nt
    s_add_u32 s54, s55, 49152
    buffer_load_dwordx4 a[240:243], v40, s[12:15], s54 offen offset:0 nt
    buffer_load_dwordx4 a[244:247], v40, s[12:15], s54 offen offset:128 nt
    buffer_load_dwordx4 a[248:251], v40, s[12:15], s54 offen offset:256 nt
    s_add_u32 s54, s55, 61440
    buffer_load_dwordx4 a[252:255], v40, s[12:15], s54 offen offset:0 nt
    buffer_load_dwordx4 v[128:131], v40, s[12:15], s54 offen offset:128 nt
    buffer_load_dwordx4 v[132:135], v40, s[12:15], s54 offen offset:256 nt
    s_add_u32 s54, s55, 73728
    buffer_load_dwordx4 v[136:139], v40, s[12:15], s54 offen offset:0 nt
    buffer_load_dwordx4 v[140:143], v40, s[12:15], s54 offen offset:128 nt
    buffer_load_dwordx4 v[144:147], v40, s[12:15], s54 offen offset:256 nt
    s_add_u32 s54, s55, 86016
    buffer_load_dwordx4 v[148:151], v40, s[12:15], s54 offen offset:0 nt
    buffer_load_dwordx4 v[152:155], v40, s[12:15], s54 offen offset:128 nt
    buffer_load_dwordx4 v[156:159], v40, s[12:15], s54 offen offset:256 nt
    s_waitcnt vmcnt(24)
    s_mov_b32 s51, 0
HSP:
    v_and_b32 v43, 0xff, v42
    v_cmp_ne_u32 vcc, 32, v43
    s_cbranch_vccz HSOK
    buffer_load_dword v42, v41, s[40:43], 0 offen sc1
    s_waitcnt vmcnt(0)
    s_add_u32 s51, s51, 1
    s_cmp_lt_u32 s51, 0x8000
    s_cbranch_scc1 HSP
HSOK:
    v_readlane_b32 s52, v42, s45
    s_lshl_b32 s53, s5, 5
    s_cmp_eq_u32 s52, s53
    s_cselect_b32 s50, 1, 0
    v_lshrrev_b32 v42, 3, v1
    v_mul_u32_u24 v42, 3072, v42
    v_lshl_add_u32 v42, v41, 2, v42
ENTRY:
    s_mov_b32 s51, 0
    v_lshrrev_b32 v14, 4, v0
    v_and_b32 v15, 15, v0
    v_lshlrev_b32 v14, 10, v14
    v_lshl_add_u32 v14, v15, 3, v14
    s_mul_i32 s52, s47, 12288
    v_add_u32 v14, s52, v14
    v_and_b32 v15, 7, v1
    s_lshl_b32 s52, s47, 7
    s_add_u32 s52, s52, 393216
    v_lshl_add_u32 v15, v15, 3, s52
ENP:
    s_cmp_eq_u32 s44, 3
    s_cbranch_scc1 ENL
    buffer_load_dwordx2 v[16:17], v14, s[16:19], s49 offen offset:0 sc1
    buffer_load_dwordx2 v[18:19], v14, s[16:19], s49 offen offset:128 sc1
    buffer_load_dwordx2 v[20:21], v14, s[16:19], s49 offen offset:256 sc1
    buffer_load_dwordx2 v[22:23], v14, s[16:19], s49 offen offset:384 sc1
    buffer_load_dwordx2 v[24:25], v14, s[16:19], s49 offen offset:512 sc1
    buffer_load_dwordx2 v[26:27], v14, s[16:19], s49 offen offset:640 sc1
    buffer_load_dwordx2 v[28:29], v14, s[16:19], s49 offen offset:768 sc1
    buffer_load_dwordx2 v[30:31], v14, s[16:19], s49 offen offset:896 sc1
    buffer_load_dwordx2 v[32:33], v15, s[16:19], s49 offen sc1
ENL:
    s_cmp_lg_u32 s6, 0
    s_cbranch_scc1 REST
    s_waitcnt vmcnt(0)
RESTD:
    s_cmp_eq_u32 s44, 3
    s_cbranch_scc1 ENOK2
    v_add_f32_dpp v32, v32, v32 quad_perm:[1,0,3,2] row_mask:0xf bank_mask:0xf
    v_add_f32_dpp v33, v33, v33 quad_perm:[1,0,3,2] row_mask:0xf bank_mask:0xf
    v_pk_add_f32 v[16:17], v[16:17], v[18:19]
    v_pk_add_f32 v[20:21], v[20:21], v[22:23]
    v_add_f32_dpp v32, v32, v32 quad_perm:[2,3,0,1] row_mask:0xf bank_mask:0xf
    v_add_f32_dpp v33, v33, v33 quad_perm:[2,3,0,1] row_mask:0xf bank_mask:0xf
    v_pk_add_f32 v[24:25], v[24:25], v[26:27]
    v_pk_add_f32 v[28:29], v[28:29], v[30:31]
    v_add_f32_dpp v32, v32, v32 row_half_mirror row_mask:0xf bank_mask:0xf
    v_add_f32_dpp v33, v33, v33 row_half_mirror row_mask:0xf bank_mask:0xf
    v_pk_add_f32 v[16:17], v[16:17], v[20:21]
    v_pk_add_f32 v[24:25], v[24:25], v[28:29]
    v_mul_f32 v33, 0x3acccccd, v33
    v_mov_b32 v13, 0x3727c5ac
    v_fmac_f32 v13, 0x3acccccd, v32
    v_fma_f32 v32, -v33, v33, v13
    v_rsq_f32 v32, v32
    v_pk_add_f32 v[16:17], v[16:17], v[24:25]
    v_mul_f32 v32, 0x3dd53b94, v32
    v_fma_f32 v16, -v33, v17, v16
    v_mul_f32 v16, v16, v32
    v_cmp_u_f32 vcc, v16, v16
    s_cbranch_vccz ENOK
    s_add_u32 s51, s51, 1
    s_sleep 1
    s_cmp_lt_u32 s51, 0x8000
    s_cbranch_scc1 ENP
ENOK:
    v_cvt_pk_bf16_f32 v16, v16, v16
    v_lshlrev_b32 v17, 1, v0
    v_add_u32 v17, 98304, v17
    ds_write_b16 v17, v16
ENOK2:
    s_waitcnt lgkmcnt(0)
    s_barrier
    ds_read_b128 v[16:19], v3
    ds_read_b128 v[20:23], v4
    ds_read_b128 v[24:27], v5
    ds_read_b128 v[28:31], v6
    ds_read_b128 v[32:35], v7
    ds_read_b128 v[36:39], v8
    s_lshl_b32 s52, s47, 3
    s_add_u32 s52, s52, s48
    s_mul_i32 s52, s52, 384
    s_mul_i32 s53, s44, 96
    s_add_u32 s52, s52, s53
    s_add_u32 s52, s52, 479232
    v_lshl_add_u32 v14, v1, 2, s52
    s_lshl_b32 s52, s47, 7
    s_lshl_b32 s53, s48, 2
    s_add_u32 s52, s52, s53
    s_add_u32 s52, s52, 577536
    v_writelane_b32 v14, s52, 24
    v_and_b32 v15, 7, v1
    v_lshlrev_b32 v15, 5, v15
    v_bfe_u32 v61, v1, 4, 1
    v_lshl_add_u32 v15, v61, 4, v15
    v_lshrrev_b32 v61, 5, v1
    v_mul_u32_u24 v61, 768, v61
    v_add_u32 v15, v15, v61
    s_mul_i32 s52, s44, 1536
    s_add_u32 s52, s52, 98816
    v_add_u32 v15, s52, v15
    s_mul_i32 s52, s44, 192
    s_add_u32 s52, s52, 98816
    v_min_u32 v60, 23, v1
    v_lshl_add_u32 v60, v60, 3, s52
    s_waitcnt lgkmcnt(0)
    s_cmp_lg_u32 s49, 0
    s_cbranch_scc1 NOBO
    v_and_b32 v61, 3, v1
    v_lshlrev_b32 v61, 3, v61
    v_bfe_u32 v13, v1, 2, 2
    v_lshl_add_u32 v61, v13, 7, v61
    v_lshrrev_b32 v13, 4, v1
    v_lshl_add_u32 v61, v13, 10, v61
    s_lshl_b32 s52, s44, 5
    v_add_u32 v61, s52, v61
    ds_read_b64_tr_b16 v[80:81], v61 offset:0
    ds_read_b64_tr_b16 v[82:83], v61 offset:512
    ds_read_b64_tr_b16 v[84:85], v61 offset:4096
    ds_read_b64_tr_b16 v[86:87], v61 offset:4608
    ds_read_b64_tr_b16 v[88:89], v61 offset:8192
    ds_read_b64_tr_b16 v[90:91], v61 offset:8704
    ds_read_b64_tr_b16 v[92:93], v61 offset:12288
    ds_read_b64_tr_b16 v[94:95], v61 offset:12800
    ds_read_b64_tr_b16 v[96:97], v61 offset:16384
    ds_read_b64_tr_b16 v[98:99], v61 offset:16896
    ds_read_b64_tr_b16 v[100:101], v61 offset:20480
    ds_read_b64_tr_b16 v[102:103], v61 offset:20992
    ds_read_b64_tr_b16 v[104:105], v61 offset:24576
    ds_read_b64_tr_b16 v[106:107], v61 offset:25088
    ds_read_b64_tr_b16 v[108:109], v61 offset:28672
    ds_read_b64_tr_b16 v[110:111], v61 offset:29184
    ds_read_b64_tr_b16 v[112:113], v61 offset:32768
    ds_read_b64_tr_b16 v[114:115], v61 offset:33280
    ds_read_b64_tr_b16 v[116:117], v61 offset:36864
    ds_read_b64_tr_b16 v[118:119], v61 offset:37376
    ds_read_b64_tr_b16 v[120:121], v61 offset:40960
    ds_read_b64_tr_b16 v[122:123], v61 offset:41472
    ds_read_b64_tr_b16 v[124:125], v61 offset:45056
    ds_read_b64_tr_b16 v[126:127], v61 offset:45568
NOBO:
    v_mfma_f32_16x16x32_bf16 v[40:43], a[0:3], v[16:19], 0
    v_mfma_f32_16x16x32_bf16 v[40:43], a[4:7], v[20:23], v[40:43]
    v_mfma_f32_16x16x32_bf16 v[40:43], a[8:11], v[24:27], v[40:43]
    v_mfma_f32_16x16x32_bf16 v[40:43], a[12:15], v[28:31], v[40:43]
    v_mfma_f32_16x16x32_bf16 v[40:43], a[16:19], v[32:35], v[40:43]
    v_mfma_f32_16x16x32_bf16 v[40:43], a[20:23], v[36:39], v[40:43]
    v_mfma_f32_16x16x32_bf16 v[44:47], a[24:27], v[16:19], 0
    v_mfma_f32_16x16x32_bf16 v[44:47], a[28:31], v[20:23], v[44:47]
    v_mfma_f32_16x16x32_bf16 v[44:47], a[32:35], v[24:27], v[44:47]
    v_mfma_f32_16x16x32_bf16 v[44:47], a[36:39], v[28:31], v[44:47]
    v_mfma_f32_16x16x32_bf16 v[44:47], a[40:43], v[32:35], v[44:47]
    v_mfma_f32_16x16x32_bf16 v[44:47], a[44:47], v[36:39], v[44:47]
    v_mfma_f32_16x16x32_bf16 v[48:51], a[48:51], v[16:19], 0
    v_mfma_f32_16x16x32_bf16 v[48:51], a[52:55], v[20:23], v[48:51]
    v_mov_b32_dpp v52, v40 quad_perm:[0,0,0,0] row_mask:0xf bank_mask:0xf
    v_mfma_f32_16x16x32_bf16 v[48:51], a[56:59], v[24:27], v[48:51]
    v_add_f32_dpp v52, v41, v52 quad_perm:[1,1,1,1] row_mask:0xf bank_mask:0xf
    v_mfma_f32_16x16x32_bf16 v[48:51], a[60:63], v[28:31], v[48:51]
    v_add_f32_dpp v52, v42, v52 quad_perm:[2,2,2,2] row_mask:0xf bank_mask:0xf
    v_mfma_f32_16x16x32_bf16 v[48:51], a[64:67], v[32:35], v[48:51]
    v_add_f32_dpp v52, v43, v52 quad_perm:[3,3,3,3] row_mask:0xf bank_mask:0xf
    v_mfma_f32_16x16x32_bf16 v[48:51], a[68:71], v[36:39], v[48:51]
    v_mov_b32 v62, v52
    v_mfma_f32_16x16x32_bf16 v[40:43], a[72:75], v[16:19], 0
    v_mfma_f32_16x16x32_bf16 v[40:43], a[76:79], v[20:23], v[40:43]
    v_mov_b32_dpp v53, v44 quad_perm:[0,0,0,0] row_mask:0xf bank_mask:0xf
    v_mfma_f32_16x16x32_bf16 v[40:43], a[80:83], v[24:27], v[40:43]
    v_add_f32_dpp v53, v45, v53 quad_perm:[1,1,1,1] row_mask:0xf bank_mask:0xf
    v_mfma_f32_16x16x32_bf16 v[40:43], a[84:87], v[28:31], v[40:43]
    v_add_f32_dpp v53, v46, v53 quad_perm:[2,2,2,2] row_mask:0xf bank_mask:0xf
    v_mfma_f32_16x16x32_bf16 v[40:43], a[88:91], v[32:35], v[40:43]
    v_add_f32_dpp v53, v47, v53 quad_perm:[3,3,3,3] row_mask:0xf bank_mask:0xf
    v_mfma_f32_16x16x32_bf16 v[40:43], a[92:95], v[36:39], v[40:43]
    v_max_f32 v62, v62, v53
    v_mfma_f32_16x16x32_bf16 v[44:47], a[96:99], v[16:19], 0
    v_mfma_f32_16x16x32_bf16 v[44:47], a[100:103], v[20:23], v[44:47]
    v_mov_b32_dpp v54, v48 quad_perm:[0,0,0,0] row_mask:0xf bank_mask:0xf
    v_mfma_f32_16x16x32_bf16 v[44:47], a[104:107], v[24:27], v[44:47]
    v_add_f32_dpp v54, v49, v54 quad_perm:[1,1,1,1] row_mask:0xf bank_mask:0xf
    v_mfma_f32_16x16x32_bf16 v[44:47], a[108:111], v[28:31], v[44:47]
    v_add_f32_dpp v54, v50, v54 quad_perm:[2,2,2,2] row_mask:0xf bank_mask:0xf
    v_mfma_f32_16x16x32_bf16 v[44:47], a[112:115], v[32:35], v[44:47]
    v_add_f32_dpp v54, v51, v54 quad_perm:[3,3,3,3] row_mask:0xf bank_mask:0xf
    v_mfma_f32_16x16x32_bf16 v[44:47], a[116:119], v[36:39], v[44:47]
    v_max_f32 v62, v62, v54
    v_mfma_f32_16x16x32_bf16 v[48:51], a[120:123], v[16:19], 0
    v_mfma_f32_16x16x32_bf16 v[48:51], a[124:127], v[20:23], v[48:51]
    v_mov_b32_dpp v55, v40 quad_perm:[0,0,0,0] row_mask:0xf bank_mask:0xf
    v_mfma_f32_16x16x32_bf16 v[48:51], a[128:131], v[24:27], v[48:51]
    v_add_f32_dpp v55, v41, v55 quad_perm:[1,1,1,1] row_mask:0xf bank_mask:0xf
    v_mfma_f32_16x16x32_bf16 v[48:51], a[132:135], v[28:31], v[48:51]
    v_add_f32_dpp v55, v42, v55 quad_perm:[2,2,2,2] row_mask:0xf bank_mask:0xf
    v_mfma_f32_16x16x32_bf16 v[48:51], a[136:139], v[32:35], v[48:51]
    v_add_f32_dpp v55, v43, v55 quad_perm:[3,3,3,3] row_mask:0xf bank_mask:0xf
    v_mfma_f32_16x16x32_bf16 v[48:51], a[140:143], v[36:39], v[48:51]
    v_max_f32 v62, v62, v55
    v_mfma_f32_16x16x32_bf16 v[40:43], a[144:147], v[16:19], 0
    v_mfma_f32_16x16x32_bf16 v[40:43], a[148:151], v[20:23], v[40:43]
    v_mov_b32_dpp v56, v44 quad_perm:[0,0,0,0] row_mask:0xf bank_mask:0xf
    v_mfma_f32_16x16x32_bf16 v[40:43], a[152:155], v[24:27], v[40:43]
    v_add_f32_dpp v56, v45, v56 quad_perm:[1,1,1,1] row_mask:0xf bank_mask:0xf
    v_mfma_f32_16x16x32_bf16 v[40:43], a[156:159], v[28:31], v[40:43]
    v_add_f32_dpp v56, v46, v56 quad_perm:[2,2,2,2] row_mask:0xf bank_mask:0xf
    v_mfma_f32_16x16x32_bf16 v[40:43], a[160:163], v[32:35], v[40:43]
    v_add_f32_dpp v56, v47, v56 quad_perm:[3,3,3,3] row_mask:0xf bank_mask:0xf
    v_mfma_f32_16x16x32_bf16 v[40:43], a[164:167], v[36:39], v[40:43]
    v_max_f32 v62, v62, v56
    v_mfma_f32_16x16x32_bf16 v[44:47], a[168:171], v[16:19], 0
    v_mfma_f32_16x16x32_bf16 v[44:47], a[172:175], v[20:23], v[44:47]
    v_mov_b32_dpp v57, v48 quad_perm:[0,0,0,0] row_mask:0xf bank_mask:0xf
    v_mfma_f32_16x16x32_bf16 v[44:47], a[176:179], v[24:27], v[44:47]
    v_add_f32_dpp v57, v49, v57 quad_perm:[1,1,1,1] row_mask:0xf bank_mask:0xf
    v_mfma_f32_16x16x32_bf16 v[44:47], a[180:183], v[28:31], v[44:47]
    v_add_f32_dpp v57, v50, v57 quad_perm:[2,2,2,2] row_mask:0xf bank_mask:0xf
    v_mfma_f32_16x16x32_bf16 v[44:47], a[184:187], v[32:35], v[44:47]
    v_add_f32_dpp v57, v51, v57 quad_perm:[3,3,3,3] row_mask:0xf bank_mask:0xf
    v_mfma_f32_16x16x32_bf16 v[44:47], a[188:191], v[36:39], v[44:47]
    v_max_f32 v62, v62, v57
    v_mov_b32_dpp v58, v40 quad_perm:[0,0,0,0] row_mask:0xf bank_mask:0xf
    v_add_f32_dpp v58, v41, v58 quad_perm:[1,1,1,1] row_mask:0xf bank_mask:0xf
    v_add_f32_dpp v58, v42, v58 quad_perm:[2,2,2,2] row_mask:0xf bank_mask:0xf
    v_add_f32_dpp v58, v43, v58 quad_perm:[3,3,3,3] row_mask:0xf bank_mask:0xf
    v_max_f32 v62, v62, v58
    s_nop 2
    v_mov_b32_dpp v59, v44 quad_perm:[0,0,0,0] row_mask:0xf bank_mask:0xf
    v_add_f32_dpp v59, v45, v59 quad_perm:[1,1,1,1] row_mask:0xf bank_mask:0xf
    v_add_f32_dpp v59, v46, v59 quad_perm:[2,2,2,2] row_mask:0xf bank_mask:0xf
    v_add_f32_dpp v59, v47, v59 quad_perm:[3,3,3,3] row_mask:0xf bank_mask:0xf
    v_max_f32 v62, v62, v59
    s_nop 1
    v_max_f32_dpp v62, v62, v62 row_ror:4 row_mask:0xf bank_mask:0xf
    s_nop 1
    v_max_f32_dpp v62, v62, v62 row_ror:8 row_mask:0xf bank_mask:0xf
    v_mov_b32 v63, v62
    s_nop 1
    v_permlane16_swap_b32 v62, v63
    v_max_f32 v62, v62, v63
    v_mov_b32 v63, v62
    s_nop 1
    v_permlane32_swap_b32 v62, v63
    v_max_f32 v62, v62, v63
    v_sub_f32 v52, v52, v62
    v_exp_f32 v52, v52
    s_nop 0
    v_cvt_pk_bf16_f32 v44, v52, v52
    v_and_b32 v16, v44, v9
    v_and_b32 v17, v44, v10
    v_and_b32_dpp v18, v44, v11 row_shr:4 row_mask:0xf bank_mask:0xf bound_ctrl:0
    v_and_b32_dpp v19, v44, v12 row_shr:4 row_mask:0xf bank_mask:0xf bound_ctrl:0
    v_and_b32_dpp v20, v44, v9 row_shl:4 row_mask:0xf bank_mask:0xf bound_ctrl:0
    v_and_b32_dpp v21, v44, v10 row_shl:4 row_mask:0xf bank_mask:0xf bound_ctrl:0
    v_and_b32 v22, v44, v11
    v_and_b32 v23, v44, v12
    v_mov_b32 v63, v52
    s_waitcnt vmcnt(46)
    v_mfma_f32_16x16x32_bf16 v[32:35], v[16:19], a[192:195], 0
    v_sub_f32 v53, v53, v62
    v_exp_f32 v53, v53
    v_mfma_f32_16x16x32_bf16 v[36:39], v[16:19], a[196:199], 0
    v_cvt_pk_bf16_f32 v44, v53, v53
    v_and_b32 v24, v44, v9
    v_mfma_f32_16x16x32_bf16 v[40:43], v[16:19], a[200:203], 0
    v_and_b32 v25, v44, v10
    v_and_b32_dpp v26, v44, v11 row_shr:4 row_mask:0xf bank_mask:0xf bound_ctrl:0
    v_mfma_f32_16x16x32_bf16 v[32:35], v[20:23], a[204:207], v[32:35]
    v_and_b32_dpp v27, v44, v12 row_shr:4 row_mask:0xf bank_mask:0xf bound_ctrl:0
    v_and_b32_dpp v28, v44, v9 row_shl:4 row_mask:0xf bank_mask:0xf bound_ctrl:0
    v_mfma_f32_16x16x32_bf16 v[36:39], v[20:23], a[208:211], v[36:39]
    v_and_b32_dpp v29, v44, v10 row_shl:4 row_mask:0xf bank_mask:0xf bound_ctrl:0
    v_and_b32 v30, v44, v11
    v_mfma_f32_16x16x32_bf16 v[40:43], v[20:23], a[212:215], v[40:43]
    v_and_b32 v31, v44, v12
    v_add_f32 v63, v63, v53
    s_waitcnt vmcnt(40)
    v_mfma_f32_16x16x32_bf16 v[32:35], v[24:27], a[216:219], v[32:35]
    v_sub_f32 v54, v54, v62
    v_exp_f32 v54, v54
    v_mfma_f32_16x16x32_bf16 v[36:39], v[24:27], a[220:223], v[36:39]
    v_cvt_pk_bf16_f32 v44, v54, v54
    v_and_b32 v16, v44, v9
    v_mfma_f32_16x16x32_bf16 v[40:43], v[24:27], a[224:227], v[40:43]
    v_and_b32 v17, v44, v10
    v_and_b32_dpp v18, v44, v11 row_shr:4 row_mask:0xf bank_mask:0xf bound_ctrl:0
    v_mfma_f32_16x16x32_bf16 v[32:35], v[28:31], a[228:231], v[32:35]
    v_and_b32_dpp v19, v44, v12 row_shr:4 row_mask:0xf bank_mask:0xf bound_ctrl:0
    v_and_b32_dpp v20, v44, v9 row_shl:4 row_mask:0xf bank_mask:0xf bound_ctrl:0
    v_mfma_f32_16x16x32_bf16 v[36:39], v[28:31], a[232:235], v[36:39]
    v_and_b32_dpp v21, v44, v10 row_shl:4 row_mask:0xf bank_mask:0xf bound_ctrl:0
    v_and_b32 v22, v44, v11
    v_mfma_f32_16x16x32_bf16 v[40:43], v[28:31], a[236:239], v[40:43]
    v_and_b32 v23, v44, v12
    v_add_f32 v63, v63, v54
    s_waitcnt vmcnt(34)
    v_mfma_f32_16x16x32_bf16 v[32:35], v[16:19], a[240:243], v[32:35]
    v_sub_f32 v55, v55, v62
    v_exp_f32 v55, v55
    v_mfma_f32_16x16x32_bf16 v[36:39], v[16:19], a[244:247], v[36:39]
    v_cvt_pk_bf16_f32 v44, v55, v55
    v_and_b32 v24, v44, v9
    v_mfma_f32_16x16x32_bf16 v[40:43], v[16:19], a[248:251], v[40:43]
    v_and_b32 v25, v44, v10
    v_and_b32_dpp v26, v44, v11 row_shr:4 row_mask:0xf bank_mask:0xf bound_ctrl:0
    v_mfma_f32_16x16x32_bf16 v[32:35], v[20:23], a[252:255], v[32:35]
    v_and_b32_dpp v27, v44, v12 row_shr:4 row_mask:0xf bank_mask:0xf bound_ctrl:0
    v_and_b32_dpp v28, v44, v9 row_shl:4 row_mask:0xf bank_mask:0xf bound_ctrl:0
    v_mfma_f32_16x16x32_bf16 v[36:39], v[20:23], v[128:131], v[36:39]
    v_and_b32_dpp v29, v44, v10 row_shl:4 row_mask:0xf bank_mask:0xf bound_ctrl:0
    v_and_b32 v30, v44, v11
    v_mfma_f32_16x16x32_bf16 v[40:43], v[20:23], v[132:135], v[40:43]
    v_and_b32 v31, v44, v12
    v_add_f32 v63, v63, v55
    s_waitcnt vmcnt(28)
    v_mfma_f32_16x16x32_bf16 v[32:35], v[24:27], v[136:139], v[32:35]
    v_sub_f32 v56, v56, v62
    v_exp_f32 v56, v56
    v_mfma_f32_16x16x32_bf16 v[36:39], v[24:27], v[140:143], v[36:39]
    v_cvt_pk_bf16_f32 v44, v56, v56
    v_and_b32 v16, v44, v9
    v_mfma_f32_16x16x32_bf16 v[40:43], v[24:27], v[144:147], v[40:43]
    v_and_b32 v17, v44, v10
    v_and_b32_dpp v18, v44, v11 row_shr:4 row_mask:0xf bank_mask:0xf bound_ctrl:0
    v_mfma_f32_16x16x32_bf16 v[32:35], v[28:31], v[148:151], v[32:35]
    v_and_b32_dpp v19, v44, v12 row_shr:4 row_mask:0xf bank_mask:0xf bound_ctrl:0
    v_and_b32_dpp v20, v44, v9 row_shl:4 row_mask:0xf bank_mask:0xf bound_ctrl:0
    v_mfma_f32_16x16x32_bf16 v[36:39], v[28:31], v[152:155], v[36:39]
    v_and_b32_dpp v21, v44, v10 row_shl:4 row_mask:0xf bank_mask:0xf bound_ctrl:0
    v_and_b32 v22, v44, v11
    v_mfma_f32_16x16x32_bf16 v[40:43], v[28:31], v[156:159], v[40:43]
    v_and_b32 v23, v44, v12
    v_add_f32 v63, v63, v56
    s_waitcnt vmcnt(22)
    v_mfma_f32_16x16x32_bf16 v[32:35], v[16:19], v[160:163], v[32:35]
    v_sub_f32 v57, v57, v62
    v_exp_f32 v57, v57
    v_mfma_f32_16x16x32_bf16 v[36:39], v[16:19], v[164:167], v[36:39]
    v_cvt_pk_bf16_f32 v44, v57, v57
    v_and_b32 v24, v44, v9
    v_mfma_f32_16x16x32_bf16 v[40:43], v[16:19], v[168:171], v[40:43]
    v_and_b32 v25, v44, v10
    v_and_b32_dpp v26, v44, v11 row_shr:4 row_mask:0xf bank_mask:0xf bound_ctrl:0
    v_mfma_f32_16x16x32_bf16 v[32:35], v[20:23], v[172:175], v[32:35]
    v_and_b32_dpp v27, v44, v12 row_shr:4 row_mask:0xf bank_mask:0xf bound_ctrl:0
    v_and_b32_dpp v28, v44, v9 row_shl:4 row_mask:0xf bank_mask:0xf bound_ctrl:0
    v_mfma_f32_16x16x32_bf16 v[36:39], v[20:23], v[176:179], v[36:39]
    v_and_b32_dpp v29, v44, v10 row_shl:4 row_mask:0xf bank_mask:0xf bound_ctrl:0
    v_and_b32 v30, v44, v11
    v_mfma_f32_16x16x32_bf16 v[40:43], v[20:23], v[180:183], v[40:43]
    v_and_b32 v31, v44, v12
    v_add_f32 v63, v63, v57
    s_waitcnt vmcnt(16)
    v_mfma_f32_16x16x32_bf16 v[32:35], v[24:27], v[184:187], v[32:35]
    v_sub_f32 v58, v58, v62
    v_exp_f32 v58, v58
    v_mfma_f32_16x16x32_bf16 v[36:39], v[24:27], v[188:191], v[36:39]
    v_cvt_pk_bf16_f32 v44, v58, v58
    v_and_b32 v16, v44, v9
    v_mfma_f32_16x16x32_bf16 v[40:43], v[24:27], v[192:195], v[40:43]
    v_and_b32 v17, v44, v10
    v_and_b32_dpp v18, v44, v11 row_shr:4 row_mask:0xf bank_mask:0xf bound_ctrl:0
    v_mfma_f32_16x16x32_bf16 v[32:35], v[28:31], v[196:199], v[32:35]
    v_and_b32_dpp v19, v44, v12 row_shr:4 row_mask:0xf bank_mask:0xf bound_ctrl:0
    v_and_b32_dpp v20, v44, v9 row_shl:4 row_mask:0xf bank_mask:0xf bound_ctrl:0
    v_mfma_f32_16x16x32_bf16 v[36:39], v[28:31], v[200:203], v[36:39]
    v_and_b32_dpp v21, v44, v10 row_shl:4 row_mask:0xf bank_mask:0xf bound_ctrl:0
    v_and_b32 v22, v44, v11
    v_mfma_f32_16x16x32_bf16 v[40:43], v[28:31], v[204:207], v[40:43]
    v_and_b32 v23, v44, v12
    v_add_f32 v63, v63, v58
    s_waitcnt vmcnt(10)
    v_mfma_f32_16x16x32_bf16 v[32:35], v[16:19], v[208:211], v[32:35]
    v_sub_f32 v59, v59, v62
    v_exp_f32 v59, v59
    v_mfma_f32_16x16x32_bf16 v[36:39], v[16:19], v[212:215], v[36:39]
    v_cvt_pk_bf16_f32 v44, v59, v59
    v_and_b32 v24, v44, v9
    v_mfma_f32_16x16x32_bf16 v[40:43], v[16:19], v[216:219], v[40:43]
    v_and_b32 v25, v44, v10
    v_and_b32_dpp v26, v44, v11 row_shr:4 row_mask:0xf bank_mask:0xf bound_ctrl:0
    v_mfma_f32_16x16x32_bf16 v[32:35], v[20:23], v[220:223], v[32:35]
    v_and_b32_dpp v27, v44, v12 row_shr:4 row_mask:0xf bank_mask:0xf bound_ctrl:0
    v_and_b32_dpp v28, v44, v9 row_shl:4 row_mask:0xf bank_mask:0xf bound_ctrl:0
    v_mfma_f32_16x16x32_bf16 v[36:39], v[20:23], v[224:227], v[36:39]
    v_and_b32_dpp v29, v44, v10 row_shl:4 row_mask:0xf bank_mask:0xf bound_ctrl:0
    v_and_b32 v30, v44, v11
    v_mfma_f32_16x16x32_bf16 v[40:43], v[20:23], v[228:231], v[40:43]
    v_and_b32 v31, v44, v12
    v_add_f32 v63, v63, v59
    s_waitcnt vmcnt(4)
    v_mfma_f32_16x16x32_bf16 v[32:35], v[24:27], v[232:235], v[32:35]
    s_nop 0
    v_add_f32_dpp v63, v63, v63 row_ror:4 row_mask:0xf bank_mask:0xf
    v_mfma_f32_16x16x32_bf16 v[36:39], v[24:27], v[236:239], v[36:39]
    s_nop 0
    s_nop 0
    v_mfma_f32_16x16x32_bf16 v[40:43], v[24:27], v[240:243], v[40:43]
    v_add_f32_dpp v63, v63, v63 row_ror:8 row_mask:0xf bank_mask:0xf
    v_mov_b32 v44, v63
    v_mfma_f32_16x16x32_bf16 v[32:35], v[28:31], v[244:247], v[32:35]
    s_nop 0
    v_permlane16_swap_b32 v63, v44
    v_mfma_f32_16x16x32_bf16 v[36:39], v[28:31], v[248:251], v[36:39]
    v_add_f32 v63, v63, v44
    v_mov_b32 v44, v63
    v_mfma_f32_16x16x32_bf16 v[40:43], v[28:31], v[252:255], v[40:43]
    s_nop 0
    v_permlane32_swap_b32 v63, v44
    v_add_f32 v63, v63, v44
    s_lshl_b32 s52, s44, 3
    s_add_u32 s52, s52, 98752
    v_mov_b32 v61, s52
    ds_write_b64 v61, v[62:63]
    s_mov_b32 exec_lo, 0x00ff00ff
    s_mov_b32 exec_hi, 0xff00ff00
    s_nop 1
    ds_write_b128 v15, v[32:35] offset:0
    ds_write_b128 v15, v[36:39] offset:256
    ds_write_b128 v15, v[40:43] offset:512
    s_mov_b64 exec, -1
    v_mov_b32 v61, 98752
    s_waitcnt lgkmcnt(0)
    s_barrier
    ds_read_b128 v[16:19], v61
    ds_read_b128 v[20:23], v61 offset:16
    ds_read_b64 v[24:25], v60 offset:0
    ds_read_b64 v[26:27], v60 offset:768
    ds_read_b64 v[28:29], v60 offset:1536
    ds_read_b64 v[30:31], v60 offset:2304
    ds_read_b64 v[32:33], v60 offset:3072
    ds_read_b64 v[34:35], v60 offset:3840
    ds_read_b64 v[36:37], v60 offset:4608
    ds_read_b64 v[38:39], v60 offset:5376
    s_waitcnt lgkmcnt(8)
    v_max_f32 v40, v16, v18
    v_max3_f32 v40, v40, v20, v22
    v_sub_f32 v16, v16, v40
    v_sub_f32 v18, v18, v40
    v_sub_f32 v20, v20, v40
    v_sub_f32 v22, v22, v40
    v_exp_f32 v16, v16
    v_exp_f32 v18, v18
    v_exp_f32 v20, v20
    v_exp_f32 v22, v22
    v_mul_f32 v41, v16, v17
    v_fmac_f32 v41, v18, v19
    v_fmac_f32 v41, v20, v21
    v_fmac_f32 v41, v22, v23
    v_rcp_f32 v42, v41
    v_log_f32 v43, v41
    s_waitcnt lgkmcnt(0)
    v_pk_add_f32 v[24:25], v[24:25], v[26:27]
    v_pk_add_f32 v[28:29], v[28:29], v[30:31]
    v_pk_add_f32 v[32:33], v[32:33], v[34:35]
    v_pk_add_f32 v[36:37], v[36:37], v[38:39]
    v_pk_mul_f32 v[24:25], v[24:25], v[16:17] op_sel_hi:[1,0]
    v_pk_fma_f32 v[24:25], v[28:29], v[18:19], v[24:25] op_sel_hi:[1,0,1]
    v_pk_fma_f32 v[24:25], v[32:33], v[20:21], v[24:25] op_sel_hi:[1,0,1]
    v_pk_fma_f32 v[24:25], v[36:37], v[22:23], v[24:25] op_sel_hi:[1,0,1]
    v_pk_mul_f32 v[24:25], v[24:25], v[42:43] op_sel_hi:[1,0]
    v_add_f32 v43, v43, v40
    v_cmp_eq_u32 vcc, 24, v1
    v_cvt_pk_bf16_f32 v24, v24, v25
    s_mov_b64 exec, 0x1ffffff
    v_cndmask_b32 v24, v24, v43, vcc
    s_cmp_eq_u32 s50, 0
    s_cbranch_scc1 SLOW3
    buffer_store_dword v24, v14, s[16:19], s49 offen
PUBD3:
    s_mov_b64 exec, -1
    s_cmp_ge_u32 s46, 20
    s_cbranch_scc1 WOX
    v_and_b32 v56, 15, v1
    v_lshrrev_b32 v57, 4, v1
    v_mul_u32_u24 v58, 384, v56
    v_lshl_add_u32 v58, v57, 4, v58
    s_lshl_b32 s52, s45, 1
    s_add_u32 s52, s52, s56
    s_mul_i32 s53, s52, 6144
    s_add_u32 s53, s53, 479232
    v_add_u32 v58, s53, v58
    s_lshl_b32 s53, s52, 8
    s_add_u32 s53, s53, 577536
    v_lshrrev_b32 v59, 1, v57
    v_lshl_add_u32 v59, v59, 7, s53
    v_and_b32 v60, 1, v57
    v_lshl_add_u32 v59, v60, 4, v59
    v_xor_b32 v60, 16, v59
    s_mul_i32 s53, s52, 5120
    s_lshl_b32 s54, s57, 8
    s_add_u32 s53, s53, s54
    s_lshl_b32 s54, s44, 6
    s_add_u32 s53, s53, s54
    s_add_u32 s53, s53, 397312
    v_lshl_add_u32 v61, v56, 2, s53
    s_lshl_b32 s52, s57, 2
    s_add_u32 s52, s52, s44
    s_lshl_b32 s52, s52, 4
    s_lshl_b32 s53, s45, 1
    s_add_u32 s52, s52, s53
    s_add_u32 s52, s52, s56
    s_lshl_b32 s52, s52, 7
    s_add_u32 s52, s52, 581632
    v_lshl_add_u32 v14, v1, 2, s52
    v_cmp_gt_u32 s[60:61], 32, v1
    s_mov_b32 s51, 0
WOP:
    buffer_load_dwordx4 v[40:43], v59, s[16:19], s49 offen sc1
    buffer_load_dwordx4 v[44:47], v60, s[16:19], s49 offen sc1
    buffer_load_dwordx4 v[16:19], v58, s[16:19], s49 offen offset:0 sc1
    buffer_load_dwordx4 v[20:23], v58, s[16:19], s49 offen offset:64 sc1
    buffer_load_dwordx4 v[24:27], v58, s[16:19], s49 offen offset:128 sc1
    buffer_load_dwordx4 v[28:31], v58, s[16:19], s49 offen offset:192 sc1
    buffer_load_dwordx4 v[32:35], v58, s[16:19], s49 offen offset:256 sc1
    buffer_load_dwordx4 v[36:39], v58, s[16:19], s49 offen offset:320 sc1
    buffer_load_dword v62, v61, s[16:19], s49 offen sc1
    s_waitcnt vmcnt(0)
    v_mfma_f32_16x16x32_bf16 v[48:51], v[16:19], v[80:83], 0
    v_max3_f32 v63, v40, v41, v42
    v_max3_f32 v63, v63, v43, v44
    v_mfma_f32_16x16x32_bf16 v[52:55], v[16:19], v[104:107], 0
    v_max3_f32 v63, v63, v45, v46
    v_max_f32 v63, v63, v47
    v_mfma_f32_16x16x32_bf16 v[48:51], v[20:23], v[84:87], v[48:51]
    v_sub_f32 v40, v40, v63
    v_sub_f32 v41, v41, v63
    v_mfma_f32_16x16x32_bf16 v[52:55], v[20:23], v[108:111], v[52:55]
    v_sub_f32 v42, v42, v63
    v_sub_f32 v43, v43, v63
    v_mfma_f32_16x16x32_bf16 v[48:51], v[24:27], v[88:91], v[48:51]
    v_sub_f32 v44, v44, v63
    v_sub_f32 v45, v45, v63
    v_mfma_f32_16x16x32_bf16 v[52:55], v[24:27], v[112:115], v[52:55]
    v_sub_f32 v46, v46, v63
    v_sub_f32 v47, v47, v63
    v_mfma_f32_16x16x32_bf16 v[48:51], v[28:31], v[92:95], v[48:51]
    v_exp_f32 v40, v40
    v_exp_f32 v41, v41
    v_mfma_f32_16x16x32_bf16 v[52:55], v[28:31], v[116:119], v[52:55]
    v_exp_f32 v42, v42
    v_exp_f32 v43, v43
    v_mfma_f32_16x16x32_bf16 v[48:51], v[32:35], v[96:99], v[48:51]
    v_exp_f32 v44, v44
    v_exp_f32 v45, v45
    v_mfma_f32_16x16x32_bf16 v[52:55], v[32:35], v[120:123], v[52:55]
    v_exp_f32 v46, v46
    v_exp_f32 v47, v47
    v_mfma_f32_16x16x32_bf16 v[48:51], v[36:39], v[100:103], v[48:51]
    v_add_f32 v63, v40, v41
    v_add_f32 v44, v44, v45
    v_mfma_f32_16x16x32_bf16 v[52:55], v[36:39], v[124:127], v[52:55]
    v_add_f32 v46, v46, v47
    v_add_f32 v45, v42, v43
    v_add_f32 v44, v44, v46
    v_add_f32 v63, v63, v45
    v_add_f32 v63, v63, v44
    v_rcp_f32 v63, v63
    s_nop 3
    v_cndmask_b32 v48, v52, v48, s[60:61]
    v_cndmask_b32 v49, v53, v49, s[60:61]
    v_cndmask_b32 v50, v54, v50, s[60:61]
    v_cndmask_b32 v51, v55, v51, s[60:61]
    v_mul_f32 v48, v48, v40
    v_fmac_f32 v48, v49, v41
    v_fmac_f32 v48, v50, v42
    v_fmac_f32 v48, v51, v43
    v_mul_f32 v48, v48, v63
    v_mov_b32 v49, v48
    s_nop 1
    v_permlane16_swap_b32 v48, v49
    v_add_f32 v48, v48, v49
    v_mov_b32 v49, v48
    s_nop 1
    v_permlane32_swap_b32 v48, v49
    v_add_f32 v48, v48, v49
    v_fmac_f32 v48, s62, v62
    v_cmp_u_f32 vcc, v48, v48
    s_cbranch_vccz WOOK
    s_add_u32 s51, s51, 1
    s_sleep 1
    s_cmp_lt_u32 s51, 0x8000
    s_cbranch_scc1 WOP
WOOK:
    s_mov_b64 exec, 0xffff
    buffer_store_dword v48, v14, s[16:19], s49 offen sc1
    s_mov_b64 exec, -1
WOX:
    s_cmp_ge_u32 s46, 30
    s_cbranch_scc1 STX
    s_cmp_lg_u32 s49, 0
    s_cbranch_scc1 NOW13
    s_waitcnt vmcnt(1)
    s_barrier
NOW13:
    v_and_b32 v61, 3, v1
    v_lshlrev_b32 v61, 3, v61
    v_bfe_u32 v13, v1, 2, 2
    v_lshl_add_u32 v61, v13, 7, v61
    v_lshrrev_b32 v13, 4, v1
    v_lshl_add_u32 v61, v13, 10, v61
    s_lshl_b32 s52, s44, 5
    v_add_u32 v61, s52, v61
    ds_read_b64_tr_b16 v[64:65], v61 offset:49152
    ds_read_b64_tr_b16 v[66:67], v61 offset:49664
    ds_read_b64_tr_b16 v[68:69], v61 offset:53248
    ds_read_b64_tr_b16 v[70:71], v61 offset:53760
    ds_read_b64_tr_b16 v[72:73], v61 offset:57344
    ds_read_b64_tr_b16 v[74:75], v61 offset:57856
    ds_read_b64_tr_b16 v[76:77], v61 offset:61440
    ds_read_b64_tr_b16 v[78:79], v61 offset:61952
    s_mul_i32 s52, s45, 12
    s_lshl_b32 s53, s59, 2
    s_add_u32 s52, s52, s53
    s_add_u32 s52, s52, s44
    s_mul_i32 s52, s52, 10
    s_mul_i32 s53, s58, 5
    s_add_u32 s52, s52, s53
    s_add_u32 s52, s52, s3
    s_lshl_b32 s52, s52, 7
    s_add_u32 s52, s52, 663552
    v_lshl_add_u32 v14, v1, 3, s52
    s_lshl_b32 s52, s45, 5
    s_add_u32 s52, s52, s4
    s_lshl_b32 s52, s52, 3
    s_add_u32 s52, s52, 786432
    v_mov_b32 v15, s52
    v_and_b32 v56, 31, v1
    s_lshl_b32 s52, s44, 5
    v_add_u32 v56, s52, v56
    s_lshl_b32 s52, s45, 5
    s_add_u32 s52, s52, s4
    s_lshl_b32 s52, s52, 9
    s_add_u32 s52, s52, 790528
    v_lshl_add_u32 v56, v56, 2, s52
    v_and_b32 v57, 31, v1
    s_lshl_b32 s52, s44, 5
    v_add_u32 v57, s52, v57
    v_lshlrev_b32 v57, 1, v57
    v_add_u32 v57, 96512, v57
    v_bfe_u32 v58, v1, 4, 1
    v_lshlrev_b32 v58, 11, v58
    v_lshrrev_b32 v59, 5, v1
    v_lshl_add_u32 v58, v59, 10, v58
    v_and_b32 v59, 15, v1
    v_lshl_add_u32 v58, v59, 2, v58
    s_lshl_b32 s52, s3, 14
    s_lshl_b32 s53, s44, 12
    s_add_u32 s52, s52, s53
    s_add_u32 s52, s52, 581632
    v_add_u32 v58, s52, v58
    s_mov_b32 s51, 0
F1P:
    buffer_load_dword v16, v58, s[16:19], s49 offen offset:0 sc1
    buffer_load_dword v17, v58, s[16:19], s49 offen offset:128 sc1
    buffer_load_dword v18, v58, s[16:19], s49 offen offset:256 sc1
    buffer_load_dword v19, v58, s[16:19], s49 offen offset:384 sc1
    buffer_load_dword v20, v58, s[16:19], s49 offen offset:512 sc1
    buffer_load_dword v21, v58, s[16:19], s49 offen offset:640 sc1
    buffer_load_dword v22, v58, s[16:19], s49 offen offset:768 sc1
    buffer_load_dword v23, v58, s[16:19], s49 offen offset:896 sc1
    s_waitcnt vmcnt(0)
    v_pk_add_f32 v[16:17], v[16:17], v[18:19]
    v_pk_add_f32 v[20:21], v[20:21], v[22:23]
    v_pk_add_f32 v[16:17], v[16:17], v[20:21]
    v_add_f32 v16, v16, v17
    v_mov_b32 v17, v16
    s_nop 1
    v_permlane32_swap_b32 v16, v17
    v_add_f32 v16, v16, v17
    v_cmp_u_f32 vcc, v16, v16
    s_cbranch_vccz F1OK
    s_add_u32 s51, s51, 1
    s_sleep 1
    s_cmp_lt_u32 s51, 0x8000
    s_cbranch_scc1 F1P
F1OK:
    v_cvt_pk_bf16_f32 v16, v16, v16
    ds_write_b16 v57, v16
    v_and_b32 v16, 0xffff0000, v16
    s_mov_b32 exec_hi, 0
    s_cmp_eq_u32 s50, 0
    s_cbranch_scc1 SLOW4
    buffer_store_dword v16, v56, s[16:19], s49 offen
PUBD4:
    s_mov_b64 exec, -1
    s_waitcnt lgkmcnt(0)
    s_barrier
    ds_read_b128 v[20:23], v2 offset:256
    ds_read_b128 v[24:27], v2 offset:320
    ds_read_b128 v[28:31], v2 offset:384
    ds_read_b128 v[32:35], v2 offset:448
    s_waitcnt lgkmcnt(0)
    v_mfma_f32_16x16x32_bf16 v[40:43], v[20:23], v[64:67], 0
    v_mfma_f32_16x16x32_bf16 v[40:43], v[24:27], v[68:71], v[40:43]
    v_mfma_f32_16x16x32_bf16 v[40:43], v[28:31], v[72:75], v[40:43]
    v_mfma_f32_16x16x32_bf16 v[40:43], v[32:35], v[76:79], v[40:43]
    s_cmp_lg_u32 s44, 3
    s_cbranch_scc1 NOGS0
    v_mfma_f32_16x16x32_bf16 v[44:47], v[20:23], v[20:23], 0
    v_mfma_f32_16x16x32_bf16 v[44:47], v[24:27], v[24:27], v[44:47]
    v_mfma_f32_16x16x32_bf16 v[44:47], v[28:31], v[28:31], v[44:47]
    v_mfma_f32_16x16x32_bf16 v[44:47], v[32:35], v[32:35], v[44:47]
NOGS0:
    s_mov_b64 exec, 0xffff
    s_nop 3
    s_cmp_eq_u32 s50, 0
    s_cbranch_scc1 SLOW5
    buffer_store_dwordx2 v[40:41], v14, s[16:19], s49 offen
PUBD5:
    s_cmp_lg_u32 s44, 3
    s_cbranch_scc1 NOGS
    s_mov_b64 exec, 1
    s_cmp_eq_u32 s50, 0
    s_cbranch_scc1 SLOW6
    buffer_store_dwordx2 v[44:45], v15, s[16:19], s49 offen
PUBD6:
NOGS:
    s_mov_b64 exec, -1
    s_cmp_lt_u32 s46, 20
    s_cbranch_scc1 STX
    s_lshl_b32 s52, s57, 2
    s_add_u32 s52, s52, s44
    s_lshl_b32 s52, s52, 3
    s_add_u32 s52, s52, s45
    s_lshl_b32 s52, s52, 7
    s_add_u32 s52, s52, 921600
    v_lshl_add_u32 v14, v1, 2, s52
    v_lshrrev_b32 v56, 4, v0
    v_min_u32 v56, 11, v56
    v_mul_u32_u24 v56, 1280, v56
    v_and_b32 v57, 15, v0
    v_lshl_add_u32 v56, v57, 3, v56
    s_mul_i32 s52, s45, 15360
    s_add_u32 s52, s52, 663552
    v_add_u32 v56, s52, v56
    v_and_b32 v58, 7, v1
    v_cmp_gt_u32 vcc, 5, v58
    v_min_u32 v58, 4, v58
    s_lshl_b32 s52, s45, 8
    s_add_u32 s52, s52, 786432
    v_lshl_add_u32 v58, v58, 3, s52
    v_cndmask_b32 v60, 0, 1.0, vcc
    s_lshl_b32 s52, s45, 14
    s_lshl_b32 s53, s57, 8
    s_add_u32 s52, s52, s53
    s_lshl_b32 s53, s44, 6
    s_add_u32 s52, s52, s53
    s_add_u32 s52, s52, 790528
    v_lshl_add_u32 v59, v57, 2, s52
    v_lshlrev_b32 v57, 1, v0
    v_add_u32 v57, 96768, v57
    s_mov_b32 s51, 0
W2P:
    buffer_load_dwordx2 v[36:37], v58, s[16:19], s49 offen sc1
    buffer_load_dwordx2 v[16:17], v56, s[16:19], s49 offen offset:0 sc1
    buffer_load_dwordx2 v[18:19], v56, s[16:19], s49 offen offset:128 sc1
    buffer_load_dwordx2 v[20:21], v56, s[16:19], s49 offen offset:256 sc1
    buffer_load_dwordx2 v[22:23], v56, s[16:19], s49 offen offset:384 sc1
    buffer_load_dwordx2 v[24:25], v56, s[16:19], s49 offen offset:512 sc1
    buffer_load_dwordx2 v[26:27], v56, s[16:19], s49 offen offset:640 sc1
    buffer_load_dwordx2 v[28:29], v56, s[16:19], s49 offen offset:768 sc1
    buffer_load_dwordx2 v[30:31], v56, s[16:19], s49 offen offset:896 sc1
    buffer_load_dwordx2 v[32:33], v56, s[16:19], s49 offen offset:1024 sc1
    buffer_load_dwordx2 v[34:35], v56, s[16:19], s49 offen offset:1152 sc1
    buffer_load_dword v62, v59, s[16:19], s49 offen sc1
    s_waitcnt vmcnt(0)
    v_pk_mul_f32 v[36:37], v[36:37], v[60:61] op_sel_hi:[1,0]
    v_pk_add_f32 v[16:17], v[16:17], v[18:19]
    v_pk_add_f32 v[26:27], v[26:27], v[28:29]
    v_add_f32_dpp v36, v36, v36 quad_perm:[1,0,3,2] row_mask:0xf bank_mask:0xf
    v_add_f32_dpp v37, v37, v37 quad_perm:[1,0,3,2] row_mask:0xf bank_mask:0xf
    v_pk_add_f32 v[20:21], v[20:21], v[22:23]
    v_pk_add_f32 v[30:31], v[30:31], v[32:33]
    v_add_f32_dpp v36, v36, v36 quad_perm:[2,3,0,1] row_mask:0xf bank_mask:0xf
    v_add_f32_dpp v37, v37, v37 quad_perm:[2,3,0,1] row_mask:0xf bank_mask:0xf
    v_pk_add_f32 v[16:17], v[16:17], v[24:25]
    v_pk_add_f32 v[26:27], v[26:27], v[34:35]
    v_add_f32_dpp v36, v36, v36 row_half_mirror row_mask:0xf bank_mask:0xf
    v_add_f32_dpp v37, v37, v37 row_half_mirror row_mask:0xf bank_mask:0xf
    v_pk_add_f32 v[16:17], v[16:17], v[20:21]
    v_pk_add_f32 v[26:27], v[26:27], v[30:31]
    v_mul_f32 v37, 0x3acccccd, v37
    v_mov_b32 v13, 0x3727c5ac
    v_fmac_f32 v13, 0x3acccccd, v36
    v_fma_f32 v36, -v37, v37, v13
    v_rsq_f32 v36, v36
    v_fma_f32 v16, -v37, v17, v16
    v_fma_f32 v26, -v37, v27, v26
    v_mul_f32 v16, v16, v36
    v_mul_f32 v26, v26, v36
    v_mul_f32 v17, 0xbfb8aa3b, v16
    v_exp_f32 v17, v17
    v_mul_f32 v16, v16, v26
    v_add_f32 v17, 1.0, v17
    v_rcp_f32 v17, v17
    s_nop 0
    v_mul_f32 v16, v16, v17
    v_cmp_u_f32 vcc, v16, v62
    s_cbranch_vccz W2OK
    s_add_u32 s51, s51, 1
    s_sleep 1
    s_cmp_lt_u32 s51, 0x8000
    s_cbranch_scc1 W2P
W2OK:
    v_cvt_pk_bf16_f32 v16, v16, v16
    ds_write_b16 v57, v16
    s_waitcnt lgkmcnt(0)
    s_barrier
    ds_read_b128 v[16:19], v2 offset:512
    ds_read_b128 v[20:23], v2 offset:576
    ds_read_b128 v[24:27], v2 offset:640
    ds_read_b128 v[28:31], v2 offset:704
    ds_read_b128 v[32:35], v2 offset:768
    ds_read_b128 v[36:39], v2 offset:832
    s_waitcnt lgkmcnt(0)
    v_mfma_f32_16x16x32_bf16 v[40:43], v[16:19], v[80:83], 0
    v_mfma_f32_16x16x32_bf16 v[40:43], v[20:23], v[84:87], v[40:43]
    v_mfma_f32_16x16x32_bf16 v[40:43], v[24:27], v[88:91], v[40:43]
    v_mfma_f32_16x16x32_bf16 v[40:43], v[28:31], v[92:95], v[40:43]
    v_mfma_f32_16x16x32_bf16 v[40:43], v[32:35], v[96:99], v[40:43]
    v_mfma_f32_16x16x32_bf16 v[40:43], v[36:39], v[100:103], v[40:43]
    s_mov_b64 exec, 0xffff
    s_nop 6
    v_fmac_f32 v40, s62, v62
    buffer_store_dword v40, v14, s[16:19], s49 offen sc1
    s_mov_b64 exec, -1
STX:
    s_cmp_eq_u32 s49, 0
    s_cbranch_scc1 LOOP
    s_and_b32 s52, s2, 0xc7
    s_cmp_eq_u32 s52, 0
    s_cbranch_scc1 LOOP
    s_endpgm
FINAL:
    s_cmp_eq_u32 s44, 3
    s_cbranch_scc1 FINX
    v_cvt_pk_bf16_f32 v30, v30, v30
    v_cmp_gt_u32 vcc, 80, v29
    v_lshlrev_b32 v20, 1, v29
    s_mul_i32 s52, s48, 160
    s_and_b32 vcc_hi, vcc_hi, 0
    s_mov_b64 exec, vcc
    buffer_store_short v30, v20, s[36:39], s52 offen
    s_mov_b64 exec, -1
FINX:
DONE:
    s_endpgm
SLOW0:
    buffer_store_dword v30, v28, s[16:19], s49 offen sc1
    s_branch PUBD0
SLOW1:
    buffer_store_dwordx2 v[16:17], v14, s[16:19], s49 offen offset:0 sc1
    buffer_store_dwordx2 v[20:21], v14, s[16:19], s49 offen offset:1024 sc1
    buffer_store_dwordx2 v[24:25], v14, s[16:19], s49 offen offset:2048 sc1
    s_branch PUBD1
SLOW2:
    buffer_store_dwordx2 v[28:29], v15, s[16:19], s49 offen sc1
    s_branch PUBD2
REST:
    s_add_u32 s54, s55, 98304
    buffer_load_dwordx4 v[160:163], v40, s[12:15], s54 offen offset:0 nt
    buffer_load_dwordx4 v[164:167], v40, s[12:15], s54 offen offset:128 nt
    buffer_load_dwordx4 v[168:171], v40, s[12:15], s54 offen offset:256 nt
    s_add_u32 s54, s55, 110592
    buffer_load_dwordx4 v[172:175], v40, s[12:15], s54 offen offset:0 nt
    buffer_load_dwordx4 v[176:179], v40, s[12:15], s54 offen offset:128 nt
    buffer_load_dwordx4 v[180:183], v40, s[12:15], s54 offen offset:256 nt
    s_add_u32 s54, s55, 122880
    buffer_load_dwordx4 v[184:187], v40, s[12:15], s54 offen offset:0 nt
    buffer_load_dwordx4 v[188:191], v40, s[12:15], s54 offen offset:128 nt
    buffer_load_dwordx4 v[192:195], v40, s[12:15], s54 offen offset:256 nt
    s_add_u32 s54, s55, 135168
    buffer_load_dwordx4 v[196:199], v40, s[12:15], s54 offen offset:0 nt
    buffer_load_dwordx4 v[200:203], v40, s[12:15], s54 offen offset:128 nt
    buffer_load_dwordx4 v[204:207], v40, s[12:15], s54 offen offset:256 nt
    s_add_u32 s54, s55, 147456
    buffer_load_dwordx4 v[208:211], v40, s[12:15], s54 offen offset:0 nt
    buffer_load_dwordx4 v[212:215], v40, s[12:15], s54 offen offset:128 nt
    buffer_load_dwordx4 v[216:219], v40, s[12:15], s54 offen offset:256 nt
    s_add_u32 s54, s55, 159744
    buffer_load_dwordx4 v[220:223], v40, s[12:15], s54 offen offset:0 nt
    buffer_load_dwordx4 v[224:227], v40, s[12:15], s54 offen offset:128 nt
    buffer_load_dwordx4 v[228:231], v40, s[12:15], s54 offen offset:256 nt
    s_add_u32 s54, s55, 172032
    buffer_load_dwordx4 v[232:235], v40, s[12:15], s54 offen offset:0 nt
    buffer_load_dwordx4 v[236:239], v40, s[12:15], s54 offen offset:128 nt
    buffer_load_dwordx4 v[240:243], v40, s[12:15], s54 offen offset:256 nt
    s_add_u32 s54, s55, 184320
    buffer_load_dwordx4 v[244:247], v40, s[12:15], s54 offen offset:0 nt
    buffer_load_dwordx4 v[248:251], v40, s[12:15], s54 offen offset:128 nt
    buffer_load_dwordx4 v[252:255], v40, s[12:15], s54 offen offset:256 nt
    s_lshl_b32 s52, s3, 7
    s_lshl_b32 s53, s44, 3
    s_add_u32 s52, s52, s53
    s_mul_i32 s52, s52, 3072
    s_mul_i32 s53, s45, 384
    s_add_u32 s52, s52, s53
    s_lshl_b32 s53, s59, 7
    s_add_u32 s52, s52, s53
    s_lshl_b32 s53, s44, 10
    s_add_u32 m0, s53, 49152
    s_add_u32 s54, s52, 0
    buffer_load_dwordx4 v42, s[28:31], s54 offen nt lds
    s_add_u32 m0, s53, 53248
    s_add_u32 s54, s52, 98304
    buffer_load_dwordx4 v42, s[28:31], s54 offen nt lds
    s_add_u32 m0, s53, 57344
    s_add_u32 s54, s52, 196608
    buffer_load_dwordx4 v42, s[28:31], s54 offen nt lds
    s_add_u32 m0, s53, 61440
    s_add_u32 s54, s52, 294912
    buffer_load_dwordx4 v42, s[28:31], s54 offen nt lds
    s_mov_b32 s6, 0
    s_waitcnt vmcnt(28)
    s_branch RESTD
SLOW3:
    buffer_store_dword v24, v14, s[16:19], s49 offen sc1
    s_branch PUBD3
SLOW4:
    buffer_store_dword v16, v56, s[16:19], s49 offen sc1
    s_branch PUBD4
SLOW5:
    buffer_store_dwordx2 v[40:41], v14, s[16:19], s49 offen sc1
    s_branch PUBD5
SLOW6:
    buffer_store_dwordx2 v[44:45], v15, s[16:19], s49 offen sc1
    s_branch PUBD6
.section .rodata,"a"
.p2align 6
.amdhsa_kernel interleave_layers__sliding_block_cached__glu_gated_swiglu__decode_kernel
  .amdhsa_next_free_vgpr 512
  .amdhsa_next_free_sgpr 102
  .amdhsa_accum_offset 256
  .amdhsa_group_segment_fixed_size 0
  .amdhsa_kernarg_size 96
  .amdhsa_user_sgpr_count 2
  .amdhsa_user_sgpr_kernarg_segment_ptr 1
  .amdhsa_system_sgpr_workgroup_id_x 1
.end_amdhsa_kernel
```

```asm
; @launch grid=(256,1,1) block=(256,1,1) lds=108032
.amdgcn_target "amdgcn-amd-amdhsa--gfx950"
.text
.globl interleave_layers__sliding_block_cached__glu_gated_swiglu__decode_kernel
.p2align 8
.type interleave_layers__sliding_block_cached__glu_gated_swiglu__decode_kernel,@function
interleave_layers__sliding_block_cached__glu_gated_swiglu__decode_kernel:
    s_cmp_ge_u32 s2, 256
    s_cbranch_scc1 DONE
    s_load_dwordx16 s[64:79], s[0:1], 0
    s_load_dwordx8 s[80:87], s[0:1], 64
    s_memrealtime s[98:99]
    s_getpc_b64 s[60:61]
PCREF:
    v_lshlrev_b32 v14, 7, v0
    v_cmp_gt_u32 vcc, CODEEND-PCREF, v14
    v_mov_b32 v15, s61
    s_and_saveexec_b64 s[88:89], vcc
    s_cbranch_execz NOPF
    v_add_co_u32 v14, vcc, s60, v14
    s_nop 1
    v_addc_co_u32 v15, vcc, 0, v15, vcc
    global_load_dword v79, v[14:15], off
NOPF:
    s_mov_b64 exec, s[88:89]
    v_and_b32 v1, 63, v0
    v_lshrrev_b32 v13, 6, v0
    s_and_b32 s45, s2, 7
    v_readfirstlane_b32 s44, v13
    s_lshr_b32 s46, s2, 3
    s_lshr_b32 s7, s46, 3
    s_lshl_b32 s52, s45, 2
    s_add_u32 s47, s7, s52
    s_and_b32 s48, s46, 7
    v_lshrrev_b32 v19, 4, v1
    v_and_b32 v20, 3, v1
    v_bfe_u32 v21, v1, 2, 2
    v_mul_u32_u24 v80, 384, v21
    v_lshl_add_u32 v80, v20, 4, v80
    v_lshrrev_b32 v22, 5, v1
    v_mul_u32_u24 v81, 1536, v22
    v_add_u32 v81, v81, v80
    v_and_b32 v22, 1, v19
    v_lshl_add_u32 v81, v22, 6, v81
    v_add_u32 v81, 256, v81
    v_lshl_add_u32 v80, v19, 6, v80
    s_mul_i32 s55, s47, 12582912
    s_mul_i32 s54, s48, 196608
    s_add_u32 s55, s55, s54
    s_mul_i32 s54, s44, 3072
    s_add_u32 s55, s55, s54
    s_add_u32 s55, s55, 11010048
    s_waitcnt lgkmcnt(0)
    s_mov_b32 s8, s66
    s_and_b32 s9, s67, 0xffff
    s_mov_b32 s10, 402653184
    s_mov_b32 s11, 0x20000
    s_mov_b32 s6, 1
    s_mov_b32 s100, 0
    s_cmp_eq_u32 s44, 3
    s_cbranch_scc1 SETUP
KPART1:
    s_add_u32 s54, s55, 0
    buffer_load_dwordx4 a[0:3], v80, s[8:11], s54 offen nt
    buffer_load_dwordx4 a[4:7], v80, s[8:11], s54 offen offset:1536 nt
    buffer_load_dwordx4 a[8:11], v81, s[8:11], s54 offen nt
    s_add_u32 s54, s55, 12288
    buffer_load_dwordx4 a[12:15], v80, s[8:11], s54 offen nt
    buffer_load_dwordx4 a[16:19], v80, s[8:11], s54 offen offset:1536 nt
    buffer_load_dwordx4 a[20:23], v81, s[8:11], s54 offen nt
    s_add_u32 s54, s55, 24576
    buffer_load_dwordx4 a[24:27], v80, s[8:11], s54 offen nt
    buffer_load_dwordx4 a[28:31], v80, s[8:11], s54 offen offset:1536 nt
    buffer_load_dwordx4 a[32:35], v81, s[8:11], s54 offen nt
    s_cmp_eq_u32 s100, 1
    s_cbranch_scc1 Q0G
SETUP:
    s_mov_b32 s16, s86
    s_and_b32 s17, s87, 0xffff
    s_mov_b32 s18, 1610612736
    s_mov_b32 s19, 0x20000
    s_mov_b32 s12, s68
    s_and_b32 s13, s69, 0xffff
    s_mov_b32 s14, 402653184
    s_mov_b32 s15, 0x20000
    s_mov_b32 s20, s70
    s_and_b32 s21, s71, 0xffff
    s_mov_b32 s22, 7864320
    s_mov_b32 s23, 0x20000
    s_mov_b32 s32, s64
    s_and_b32 s33, s65, 0xffff
    s_mov_b32 s34, 1280
    s_mov_b32 s35, 0x20000
    s_mov_b32 s36, s82
    s_and_b32 s37, s83, 0xffff
    s_mov_b32 s38, 1280
    s_mov_b32 s39, 0x20000
    s_mov_b32 s40, s84
    s_and_b32 s41, s85, 0xffff
    s_mov_b32 s42, 256
    s_mov_b32 s43, 0x20000
    v_mov_b32 v87, 1879048192
    v_mov_b32 v88, 1879048192
    s_cmp_lg_u32 s44, 3
    s_cbranch_scc1 SETUP2
    v_mov_b32 v32, -1
    v_mov_b32 v33, -1
    v_mov_b32 v34, -1
    v_mov_b32 v35, -1
    s_cmp_lg_u32 s2, 0
    s_cbranch_scc1 NONW
    s_or_b32 s98, s98, 0x10
    s_and_b32 s101, s98, 0xfffffff0
    v_mov_b32 v24, s101
    v_mov_b32 v25, 0
    s_mov_b64 exec, 1
    buffer_store_dword v24, v25, s[40:43], 0 offen sc1
    s_mov_b64 exec, -1
NONW:
    v_lshlrev_b32 v24, 4, v1
    v_lshlrev_b32 v27, 2, v1
    s_mul_i32 s52, s2, 1280
    buffer_store_dwordx4 v[32:35], v24, s[16:19], s52 offen sc1
    buffer_store_dword v32, v27, s[16:19], s52 offen offset:1024 sc1
    v_mov_b32 v26, 1879048192
    v_mov_b32 v88, v24
    v_cmp_gt_u32 vcc, 40, v1
    v_lshlrev_b32 v27, 2, v1
    buffer_load_dwordx4 v[44:47], v24, s[32:35], 0 offen
    buffer_load_dword v48, v27, s[32:35], 0 offen offset:1024
    v_cndmask_b32 v28, v26, v27, vcc
    s_mul_i32 s52, s48, 160
    buffer_load_dword v86, v28, s[32:35], s52 offen
    s_mul_i32 s52, s48, 320
    s_add_u32 s52, s52, 81920
    s_and_b32 s53, s2, 0xc7
    s_cmp_eq_u32 s53, 0
    s_cselect_b32 s52, s52, 1879048192
    v_lshl_add_u32 v87, v1, 3, s52
    v_cndmask_b32 v87, v26, v87, vcc
    v_add_u32 v24, 0, v1
    v_mul_u32_u24 v36, 171, v24
    v_lshrrev_b32 v36, 12, v36
    v_mul_u32_u24 v37, 24, v36
    v_sub_u32 v37, v24, v37
    v_mul_u32_u24 v36, 12288, v36
    v_lshl_add_u32 v38, v37, 4, v36
    v_add_u32 v24, 64, v1
    v_mul_u32_u24 v36, 171, v24
    v_lshrrev_b32 v36, 12, v36
    v_mul_u32_u24 v37, 24, v36
    v_sub_u32 v37, v24, v37
    v_mul_u32_u24 v36, 12288, v36
    v_lshl_add_u32 v39, v37, 4, v36
    v_add_u32 v24, 128, v1
    v_mul_u32_u24 v36, 171, v24
    v_lshrrev_b32 v36, 12, v36
    v_mul_u32_u24 v37, 24, v36
    v_sub_u32 v37, v24, v37
    v_mul_u32_u24 v36, 12288, v36
    v_lshl_add_u32 v40, v37, 4, v36
    s_mul_i32 s52, s48, 983040
    s_mul_i32 s54, s47, 384
    s_add_u32 s52, s52, s54
    s_mov_b32 s53, 65536
WQL:
    s_add_u32 m0, s53, 0
    s_nop 0
    buffer_load_dwordx4 v38, s[20:23], s52 offen nt lds
    s_add_u32 m0, s53, 1024
    s_nop 0
    buffer_load_dwordx4 v39, s[20:23], s52 offen nt lds
    s_add_u32 m0, s53, 2048
    s_nop 0
    buffer_load_dwordx4 v40, s[20:23], s52 offen nt lds
    s_add_u32 s52, s52, 98304
    s_add_u32 s53, s53, 3072
    s_cmp_lt_u32 s53, 96256
    s_cbranch_scc1 WQL
    v_mov_b32 v37, 0
    buffer_load_dword v89, v37, s[40:43], 0 offen sc1
    s_barrier
    s_waitcnt vmcnt(31)
    v_mov_b32 v36, 0x3f803f80
    v_mov_b32 v37, v36
    v_cndmask_b32 v36, 0, v36, vcc
    v_add_u32 v27, 96256, v27
    ds_write_b32 v27, v36 offset:1024
    ds_write_b32 v27, v37 offset:1280
    ds_write_b32 v27, v86
    v_mov_b32 v24, 98688
    v_mov_b64 v[36:37], 0
    ds_write_b64 v24, v[36:37]
    ds_write_b64 v24, v[36:37] offset:8
    v_mov_b32 v38, 0x3f803f80
    v_dot2_f32_bf16 v36, v44, v44, v36
    v_dot2_f32_bf16 v37, v44, v38, v37
    v_dot2_f32_bf16 v36, v45, v45, v36
    v_dot2_f32_bf16 v37, v45, v38, v37
    v_dot2_f32_bf16 v36, v46, v46, v36
    v_dot2_f32_bf16 v37, v46, v38, v37
    v_dot2_f32_bf16 v36, v47, v47, v36
    v_dot2_f32_bf16 v37, v47, v38, v37
    v_dot2_f32_bf16 v36, v48, v48, v36
    v_dot2_f32_bf16 v37, v48, v38, v37
    s_nop 2
    v_add_f32_dpp v36, v36, v36 quad_perm:[1,0,3,2] row_mask:0xf bank_mask:0xf
    v_add_f32_dpp v37, v37, v37 quad_perm:[1,0,3,2] row_mask:0xf bank_mask:0xf
    s_nop 0
    v_add_f32_dpp v36, v36, v36 quad_perm:[2,3,0,1] row_mask:0xf bank_mask:0xf
    v_add_f32_dpp v37, v37, v37 quad_perm:[2,3,0,1] row_mask:0xf bank_mask:0xf
    s_nop 0
    v_add_f32_dpp v36, v36, v36 row_half_mirror row_mask:0xf bank_mask:0xf
    v_add_f32_dpp v37, v37, v37 row_half_mirror row_mask:0xf bank_mask:0xf
    s_nop 0
    v_add_f32_dpp v36, v36, v36 row_mirror row_mask:0xf bank_mask:0xf
    v_add_f32_dpp v37, v37, v37 row_mirror row_mask:0xf bank_mask:0xf
    s_nop 0
    v_mov_b32 v39, v36
    s_nop 1
    v_permlane16_swap_b32 v36, v39
    v_add_f32 v36, v36, v39
    v_mov_b32 v39, v37
    s_nop 1
    v_permlane16_swap_b32 v37, v39
    v_add_f32 v37, v37, v39
    v_mov_b32 v39, v36
    s_nop 1
    v_permlane32_swap_b32 v36, v39
    v_add_f32 v36, v36, v39
    v_mov_b32 v39, v37
    s_nop 1
    v_permlane32_swap_b32 v37, v39
    v_add_f32 v37, v37, v39
    v_mov_b32 v39, 0x3727c5ac
    v_mul_f32 v37, 0x3acccccd, v37
    v_fmamk_f32 v36, v36, 0x3acccccd, v39
    v_fma_f32 v36, -v37, v37, v36
    v_rsq_f32 v36, v36
    v_mov_b32 v84, v37
    v_mul_f32 v85, 0x3dd53b94, v36
SETUP2:
    s_cmp_ge_u32 s46, 10
    s_cselect_b32 s56, 1, 0
    s_cmp_ge_u32 s46, 20
    s_cselect_b32 s52, 2, s56
    s_mul_i32 s52, s52, 10
    s_sub_u32 s57, s46, s52
    s_min_u32 s4, s46, 29
    s_cmp_ge_u32 s4, 15
    s_cselect_b32 s58, 1, 0
    s_mul_i32 s52, s58, 15
    s_sub_u32 s52, s4, s52
    s_mul_i32 s59, s52, 52
    s_lshr_b32 s59, s59, 8
    s_mul_i32 s53, s59, 5
    s_sub_u32 s3, s52, s53
    s_cmp_ge_u32 s46, 20
    s_cselect_b32 s24, s80, s72
    s_cselect_b32 s25, s81, s73
    s_mov_b32 s26, 7864320
    s_cselect_b32 s26, 1966080, s26
    s_and_b32 s25, s25, 0xffff
    s_mov_b32 s27, 0x20000
    s_cmp_eq_u32 s58, 1
    s_cselect_b32 s28, s78, s76
    s_cselect_b32 s29, s79, s77
    s_and_b32 s29, s29, 0xffff
    s_mov_b32 s30, 1966080
    s_mov_b32 s31, 0x20000
    s_mov_b32 s49, 0
    s_mul_i32 s63, s45, 69888
    s_add_u32 s63, s63, 414720
    s_mul_i32 s62, s45, 28160
    s_add_u32 s62, s62, 87040
    s_mov_b32 s50, 0
    v_and_b32 v24, 15, v1
    v_cmp_eq_u32 vcc, 1, v24
    v_mov_b32 v25, 96256
    v_mov_b32 v26, 97280
    v_cndmask_b32 v2, v25, v26, vcc
    v_lshl_add_u32 v2, v19, 4, v2
    v_lshlrev_b32 v24, 6, v19
    v_lshl_add_u32 v24, v20, 4, v24
    v_add_u32 v24, 98304, v24
    v_and_b32 v25, 1, v19
    v_lshlrev_b32 v25, 6, v25
    v_lshl_add_u32 v25, v20, 4, v25
    v_add_u32 v25, 98560, v25
    v_mov_b32 v26, 98688
    v_and_b32 v27, 2, v19
    v_cmp_eq_u32 vcc, 0, v21
    s_nop 1
    v_cndmask_b32 v3, v26, v24, vcc
    v_cmp_eq_u32 vcc, 2, v21
    s_nop 1
    v_cndmask_b32 v4, v26, v24, vcc
    v_cmp_eq_u32 vcc, 1, v21
    s_nop 1
    v_cndmask_b32 v6, v26, v24, vcc
    v_cmp_eq_u32 vcc, 3, v21
    s_nop 1
    v_cndmask_b32 v7, v26, v24, vcc
    v_cmp_eq_u32 vcc, v27, v21
    v_add_u32 v27, 1, v27
    s_nop 0
    v_cndmask_b32 v5, v26, v25, vcc
    v_cmp_eq_u32 vcc, v27, v21
    s_nop 1
    v_cndmask_b32 v8, v26, v25, vcc
    v_and_b32 v24, 1, v1
    v_lshlrev_b32 v24, 4, v24
    v_mov_b32 v25, 0xffff
    v_lshlrev_b32 v25, v24, v25
    v_bfe_u32 v24, v1, 1, 2
    v_cmp_eq_u32 vcc, 0, v24
    s_nop 1
    v_cndmask_b32 v9, 0, v25, vcc
    v_cmp_eq_u32 vcc, 1, v24
    s_nop 1
    v_cndmask_b32 v10, 0, v25, vcc
    v_cmp_eq_u32 vcc, 2, v24
    s_nop 1
    v_cndmask_b32 v11, 0, v25, vcc
    v_cmp_eq_u32 vcc, 3, v24
    s_nop 1
    v_cndmask_b32 v12, 0, v25, vcc
    v_bfe_u32 v24, v1, 3, 1
    v_lshl_add_u32 v82, v24, 2, v19
    v_mul_u32_u24 v82, 384, v82
    v_and_b32 v24, 7, v1
    v_lshl_add_u32 v82, v24, 4, v82
    s_cmp_lg_u32 s44, 3
    s_cbranch_scc1 KBAR
    s_mov_b32 s51, 0
    v_mov_b32 v37, 0
NOP:
    s_waitcnt vmcnt(0)
    v_readfirstlane_b32 s5, v89
    s_cmp_lg_u32 s5, 0
    s_cbranch_scc1 NOOK
    buffer_load_dword v89, v37, s[40:43], 0 offen sc1
    s_add_u32 s51, s51, 1
    s_sleep 4
    s_cmp_lt_u32 s51, 0x8000
    s_cbranch_scc1 NOP
NOOK:
    s_getreg_b32 s52, hwreg(HW_REG_XCC_ID)
    s_and_b32 s52, s52, 15
    s_or_b32 s5, s5, s52
    v_mov_b32 v36, s5
    s_lshl_b32 s52, s45, 7
    s_lshl_b32 s54, s46, 2
    s_add_u32 s52, s52, s54
    s_add_u32 s52, s52, 1376256
    s_mov_b64 exec, 1
    buffer_store_dword v36, v37, s[16:19], s52 offen sc1
    s_mov_b64 exec, -1
    s_mov_b32 s44, 0
    s_branch LOOP
KBAR:
    s_barrier
KPART2:
    s_add_u32 s54, s55, 36864
    buffer_load_dwordx4 a[36:39], v80, s[8:11], s54 offen nt
    buffer_load_dwordx4 a[40:43], v80, s[8:11], s54 offen offset:1536 nt
    buffer_load_dwordx4 a[44:47], v81, s[8:11], s54 offen nt
    s_add_u32 s54, s55, 49152
    buffer_load_dwordx4 a[48:51], v80, s[8:11], s54 offen nt
    buffer_load_dwordx4 a[52:55], v80, s[8:11], s54 offen offset:1536 nt
    buffer_load_dwordx4 a[56:59], v81, s[8:11], s54 offen nt
    s_add_u32 s54, s55, 61440
    buffer_load_dwordx4 a[60:63], v80, s[8:11], s54 offen nt
    buffer_load_dwordx4 a[64:67], v80, s[8:11], s54 offen offset:1536 nt
    buffer_load_dwordx4 a[68:71], v81, s[8:11], s54 offen nt
    s_add_u32 s54, s55, 73728
    buffer_load_dwordx4 a[72:75], v80, s[8:11], s54 offen nt
    buffer_load_dwordx4 a[76:79], v80, s[8:11], s54 offen offset:1536 nt
    buffer_load_dwordx4 a[80:83], v81, s[8:11], s54 offen nt
    s_add_u32 s54, s55, 86016
    buffer_load_dwordx4 a[84:87], v80, s[8:11], s54 offen nt
    buffer_load_dwordx4 a[88:91], v80, s[8:11], s54 offen offset:1536 nt
    buffer_load_dwordx4 a[92:95], v81, s[8:11], s54 offen nt
    s_add_u32 s54, s55, 98304
    buffer_load_dwordx4 a[96:99], v80, s[8:11], s54 offen nt
    buffer_load_dwordx4 a[100:103], v80, s[8:11], s54 offen offset:1536 nt
    buffer_load_dwordx4 a[104:107], v81, s[8:11], s54 offen nt
    s_add_u32 s54, s55, 110592
    buffer_load_dwordx4 a[108:111], v80, s[8:11], s54 offen nt
    buffer_load_dwordx4 a[112:115], v80, s[8:11], s54 offen offset:1536 nt
    buffer_load_dwordx4 a[116:119], v81, s[8:11], s54 offen nt
    s_add_u32 s54, s55, 122880
    buffer_load_dwordx4 a[120:123], v80, s[8:11], s54 offen nt
    buffer_load_dwordx4 a[124:127], v80, s[8:11], s54 offen offset:1536 nt
    buffer_load_dwordx4 a[128:131], v81, s[8:11], s54 offen nt
    s_add_u32 s54, s55, 135168
    buffer_load_dwordx4 a[132:135], v80, s[8:11], s54 offen nt
    buffer_load_dwordx4 a[136:139], v80, s[8:11], s54 offen offset:1536 nt
    buffer_load_dwordx4 a[140:143], v81, s[8:11], s54 offen nt
    s_add_u32 s54, s55, 147456
    buffer_load_dwordx4 a[144:147], v80, s[8:11], s54 offen nt
    buffer_load_dwordx4 a[148:151], v80, s[8:11], s54 offen offset:1536 nt
    buffer_load_dwordx4 a[152:155], v81, s[8:11], s54 offen nt
    s_add_u32 s54, s55, 159744
    buffer_load_dwordx4 a[156:159], v80, s[8:11], s54 offen nt
    buffer_load_dwordx4 a[160:163], v80, s[8:11], s54 offen offset:1536 nt
    buffer_load_dwordx4 a[164:167], v81, s[8:11], s54 offen nt
    s_add_u32 s54, s55, 172032
    buffer_load_dwordx4 a[168:171], v80, s[8:11], s54 offen nt
    buffer_load_dwordx4 a[172:175], v80, s[8:11], s54 offen offset:1536 nt
    buffer_load_dwordx4 a[176:179], v81, s[8:11], s54 offen nt
    s_add_u32 s54, s55, 184320
    buffer_load_dwordx4 a[180:183], v80, s[8:11], s54 offen nt
    buffer_load_dwordx4 a[184:187], v80, s[8:11], s54 offen offset:1536 nt
    buffer_load_dwordx4 a[188:191], v81, s[8:11], s54 offen nt
    s_add_u32 s54, s55, 0
    buffer_load_dwordx4 a[192:195], v82, s[12:15], s54 offen offset:0 nt
    buffer_load_dwordx4 a[196:199], v82, s[12:15], s54 offen offset:128 nt
    buffer_load_dwordx4 a[200:203], v82, s[12:15], s54 offen offset:256 nt
    s_add_u32 s54, s55, 12288
    buffer_load_dwordx4 a[204:207], v82, s[12:15], s54 offen offset:0 nt
    buffer_load_dwordx4 a[208:211], v82, s[12:15], s54 offen offset:128 nt
    buffer_load_dwordx4 a[212:215], v82, s[12:15], s54 offen offset:256 nt
    s_add_u32 s54, s55, 24576
    buffer_load_dwordx4 a[216:219], v82, s[12:15], s54 offen offset:0 nt
    buffer_load_dwordx4 a[220:223], v82, s[12:15], s54 offen offset:128 nt
    buffer_load_dwordx4 a[224:227], v82, s[12:15], s54 offen offset:256 nt
    s_add_u32 s54, s55, 36864
    buffer_load_dwordx4 a[228:231], v82, s[12:15], s54 offen offset:0 nt
    buffer_load_dwordx4 a[232:235], v82, s[12:15], s54 offen offset:128 nt
    buffer_load_dwordx4 a[236:239], v82, s[12:15], s54 offen offset:256 nt
    s_add_u32 s54, s55, 49152
    buffer_load_dwordx4 a[240:243], v82, s[12:15], s54 offen offset:0 nt
    buffer_load_dwordx4 a[244:247], v82, s[12:15], s54 offen offset:128 nt
    buffer_load_dwordx4 a[248:251], v82, s[12:15], s54 offen offset:256 nt
    s_add_u32 s54, s55, 61440
    buffer_load_dwordx4 a[252:255], v82, s[12:15], s54 offen offset:0 nt
    buffer_load_dwordx4 v[128:131], v82, s[12:15], s54 offen offset:128 nt
    buffer_load_dwordx4 v[132:135], v82, s[12:15], s54 offen offset:256 nt
    s_add_u32 s54, s55, 73728
    buffer_load_dwordx4 v[136:139], v82, s[12:15], s54 offen offset:0 nt
    buffer_load_dwordx4 v[140:143], v82, s[12:15], s54 offen offset:128 nt
    buffer_load_dwordx4 v[144:147], v82, s[12:15], s54 offen offset:256 nt
    s_cmp_eq_u32 s44, 3
    s_cbranch_scc1 HSHK
VPART2:
    s_add_u32 s54, s55, 86016
    buffer_load_dwordx4 v[148:151], v82, s[12:15], s54 offen offset:0 nt
    buffer_load_dwordx4 v[152:155], v82, s[12:15], s54 offen offset:128 nt
    buffer_load_dwordx4 v[156:159], v82, s[12:15], s54 offen offset:256 nt
    s_add_u32 s54, s55, 98304
    buffer_load_dwordx4 v[160:163], v82, s[12:15], s54 offen offset:0 nt
    buffer_load_dwordx4 v[164:167], v82, s[12:15], s54 offen offset:128 nt
    buffer_load_dwordx4 v[168:171], v82, s[12:15], s54 offen offset:256 nt
    s_add_u32 s54, s55, 110592
    buffer_load_dwordx4 v[172:175], v82, s[12:15], s54 offen offset:0 nt
    buffer_load_dwordx4 v[176:179], v82, s[12:15], s54 offen offset:128 nt
    buffer_load_dwordx4 v[180:183], v82, s[12:15], s54 offen offset:256 nt
    s_add_u32 s54, s55, 122880
    buffer_load_dwordx4 v[184:187], v82, s[12:15], s54 offen offset:0 nt
    buffer_load_dwordx4 v[188:191], v82, s[12:15], s54 offen offset:128 nt
    buffer_load_dwordx4 v[192:195], v82, s[12:15], s54 offen offset:256 nt
    s_add_u32 s54, s55, 135168
    buffer_load_dwordx4 v[196:199], v82, s[12:15], s54 offen offset:0 nt
    buffer_load_dwordx4 v[200:203], v82, s[12:15], s54 offen offset:128 nt
    buffer_load_dwordx4 v[204:207], v82, s[12:15], s54 offen offset:256 nt
    s_add_u32 s54, s55, 147456
    buffer_load_dwordx4 v[208:211], v82, s[12:15], s54 offen offset:0 nt
    buffer_load_dwordx4 v[212:215], v82, s[12:15], s54 offen offset:128 nt
    buffer_load_dwordx4 v[216:219], v82, s[12:15], s54 offen offset:256 nt
    s_add_u32 s54, s55, 159744
    buffer_load_dwordx4 v[220:223], v82, s[12:15], s54 offen offset:0 nt
    buffer_load_dwordx4 v[224:227], v82, s[12:15], s54 offen offset:128 nt
    buffer_load_dwordx4 v[228:231], v82, s[12:15], s54 offen offset:256 nt
    s_add_u32 s54, s55, 172032
    buffer_load_dwordx4 v[232:235], v82, s[12:15], s54 offen offset:0 nt
    buffer_load_dwordx4 v[236:239], v82, s[12:15], s54 offen offset:128 nt
    buffer_load_dwordx4 v[240:243], v82, s[12:15], s54 offen offset:256 nt
    s_add_u32 s54, s55, 184320
    buffer_load_dwordx4 v[244:247], v82, s[12:15], s54 offen offset:0 nt
    buffer_load_dwordx4 v[248:251], v82, s[12:15], s54 offen offset:128 nt
    buffer_load_dwordx4 v[252:255], v82, s[12:15], s54 offen offset:256 nt
    s_cmp_eq_u32 s44, 3
    s_cbranch_scc1 QK0
    s_branch ENTRY
LOOP:
    v_and_b32 v16, 15, v1
    v_lshrrev_b32 v17, 4, v1
    v_lshrrev_b32 v18, 2, v16
    v_and_b32 v16, 3, v16
    v_lshlrev_b32 v16, 3, v16
    s_mul_i32 s52, s44, 96
    s_add_u32 s52, s52, 65536
    v_add_u32 v16, s52, v16
    v_mul_u32_u24 v18, 384, v18
    v_add_u32 v16, v16, v18
    v_and_b32 v18, 1, v17
    v_mul_u32_u24 v17, 3072, v17
    v_mul_u32_u24 v18, 3072, v18
    v_add_u32 v17, v17, v16
    v_add_u32 v18, v18, v16
    ds_read_b64_tr_b16 v[44:45], v17 offset:0
    ds_read_b64_tr_b16 v[46:47], v17 offset:1536
    ds_read_b64_tr_b16 v[48:49], v17 offset:12288
    ds_read_b64_tr_b16 v[50:51], v17 offset:13824
    ds_read_b64_tr_b16 v[52:53], v18 offset:24576
    ds_read_b64_tr_b16 v[54:55], v18 offset:26112
    ds_read_b64_tr_b16 v[56:57], v17 offset:32
    ds_read_b64_tr_b16 v[58:59], v17 offset:1568
    ds_read_b64_tr_b16 v[60:61], v17 offset:12320
    ds_read_b64_tr_b16 v[62:63], v17 offset:13856
    ds_read_b64_tr_b16 v[64:65], v18 offset:24608
    ds_read_b64_tr_b16 v[66:67], v18 offset:26144
    ds_read_b64_tr_b16 v[68:69], v17 offset:64
    ds_read_b64_tr_b16 v[70:71], v17 offset:1600
    ds_read_b64_tr_b16 v[72:73], v17 offset:12352
    ds_read_b64_tr_b16 v[74:75], v17 offset:13888
    ds_read_b64_tr_b16 v[76:77], v18 offset:24640
    ds_read_b64_tr_b16 v[78:79], v18 offset:26176
    s_mul_i32 s52, s7, 12288
    s_mul_i32 s54, s44, 3072
    s_add_u32 s52, s52, s54
    s_lshl_b32 s54, s48, 7
    s_add_u32 s52, s52, s54
    s_add_u32 s52, s52, 20480
    v_lshl_add_u32 v14, v1, 3, s52
    s_lshl_b32 s52, s7, 6
    s_lshl_b32 s54, s48, 3
    s_add_u32 s52, s52, s54
    s_add_u32 s52, s52, 69632
    v_mov_b32 v15, s52
    v_and_b32 v29, 31, v1
    v_lshl_add_u32 v29, s44, 5, v29
    s_mul_i32 s52, s48, 320
    s_add_u32 s52, s52, 81920
    s_and_b32 s53, s2, 0xc7
    s_cmp_eq_u32 s53, 0
    s_cselect_b32 s52, s52, 1879048192
    v_lshl_add_u32 v28, v29, 2, s52
    v_lshlrev_b32 v19, 1, v29
    v_add_u32 v19, 96256, v19
    v_cmp_gt_u32 vcc, 80, v29
    s_mov_b64 s[60:61], vcc
    s_cmp_lg_u32 s6, 0
    s_cbranch_scc1 QA0
    s_cmp_lt_u32 s46, 30
    s_cbranch_scc1 NOGSW
    v_mov_b32 v20, 20224
    s_mov_b32 s51, 0
GSW:
    buffer_load_dword v21, v20, s[16:19], s62 offen sc1
    s_waitcnt vmcnt(0)
    v_cmp_u_f32 vcc, v21, v21
    s_cbranch_vccz NOGSW
    s_add_u32 s51, s51, 1
    s_sleep 2
    s_cmp_lt_u32 s51, 0x8000
    s_cbranch_scc1 GSW
NOGSW:
    v_min_u32 v13, 18, v1
    v_lshlrev_b32 v13, 7, v13
    s_mul_i32 s52, s45, 69888
    s_mul_i32 s54, s46, 2432
    s_add_u32 s52, s52, s54
    s_add_u32 s52, s52, 409600
    buffer_load_dword v13, v13, s[16:19], s52 offen sc1
    s_cmp_eq_u32 s44, 3
    s_cbranch_scc1 Y2OK
    v_min_u32 v20, 79, v29
    s_mul_i32 s52, s48, 80
    v_add_u32 v20, s52, v20
    v_lshrrev_b32 v26, 4, v20
    v_and_b32 v20, 15, v20
    v_lshlrev_b32 v26, 10, v26
    v_lshl_add_u32 v26, v20, 2, v26
    v_lshrrev_b32 v20, 5, v1
    v_lshl_add_u32 v26, v20, 9, v26
    v_add_u32 v26, 40960, v26
    s_mov_b32 s51, 0
    s_sub_u32 s52, s46, 20
    s_cmp_lt_u32 s52, 10
    s_cbranch_scc1 GYB
    s_sleep 18
GYB:
    s_sleep 4
Y2P:
    buffer_load_dword v22, v26, s[16:19], s49 offen offset:0 sc1
    buffer_load_dword v23, v26, s[16:19], s49 offen offset:128 sc1
    buffer_load_dword v24, v26, s[16:19], s49 offen offset:256 sc1
    buffer_load_dword v25, v26, s[16:19], s49 offen offset:384 sc1
    s_waitcnt vmcnt(0)
    v_pk_add_f32 v[22:23], v[22:23], v[24:25]
    v_add_f32 v30, v22, v23
    v_mov_b32 v31, v30
    s_nop 1
    v_permlane32_swap_b32 v30, v31
    v_add_f32 v30, v30, v31
    v_cmp_u_f32 vcc, v30, v30
    s_cbranch_vccz Y2OK
    s_add_u32 s51, s51, 1
    s_sleep 1
    s_cmp_lt_u32 s51, 0x8000
    s_cbranch_scc1 Y2P
Y2OK:
    s_cmp_lg_u32 s49, 0
    s_cbranch_scc1 FINAL
    s_mov_b32 s49, 327680
    s_mov_b32 s62, s63
    s_cmp_eq_u32 s44, 3
    s_cbranch_scc1 QX
    v_cvt_pk_bf16_f32 v30, v30, v30
    v_cndmask_b32 v30, 0, v30, s[60:61]
    ds_write_b16 v19, v30
    v_and_b32 v30, 0xffff0000, v30
    s_mov_b32 exec_lo, s60
    s_mov_b32 exec_hi, 0
    s_cmp_eq_u32 s50, 0
    s_cbranch_scc1 SLOW0
    buffer_store_dword v30, v28, s[16:19], s49 offen
PUBD0:
    s_mov_b64 exec, -1
QX:
    s_waitcnt lgkmcnt(0)
    s_barrier
QA0:
    ds_read_b128 v[32:35], v2 offset:0
    ds_read_b128 v[36:39], v2 offset:64
    ds_read_b128 v[40:43], v2 offset:128
    s_waitcnt lgkmcnt(2)
    v_mfma_f32_16x16x32_bf16 v[28:31], v[32:35], v[32:35], 0
    v_mfma_f32_16x16x32_bf16 v[16:19], v[32:35], v[44:47], 0
    v_mfma_f32_16x16x32_bf16 v[20:23], v[32:35], v[56:59], 0
    v_mfma_f32_16x16x32_bf16 v[24:27], v[32:35], v[68:71], 0
    s_waitcnt lgkmcnt(1)
    v_mfma_f32_16x16x32_bf16 v[28:31], v[36:39], v[36:39], v[28:31]
    v_mfma_f32_16x16x32_bf16 v[16:19], v[36:39], v[48:51], v[16:19]
    v_mfma_f32_16x16x32_bf16 v[20:23], v[36:39], v[60:63], v[20:23]
    v_mfma_f32_16x16x32_bf16 v[24:27], v[36:39], v[72:75], v[24:27]
    s_waitcnt lgkmcnt(0)
    v_mfma_f32_16x16x32_bf16 v[16:19], v[40:43], v[52:55], v[16:19]
    v_mfma_f32_16x16x32_bf16 v[20:23], v[40:43], v[64:67], v[20:23]
    v_mfma_f32_16x16x32_bf16 v[24:27], v[40:43], v[76:79], v[24:27]
    v_mfma_f32_16x16x32_bf16 v[28:31], v[40:43], v[40:43], v[28:31]
    s_mov_b64 exec, 0xffff
    s_cmp_lg_u32 s6, 0
    s_cbranch_scc1 HOOKA
    s_cmp_eq_u32 s50, 0
    s_cbranch_scc1 SLOW1
    buffer_store_dwordx2 v[16:17], v14, s[16:19], s62 offen offset:0
    buffer_store_dwordx2 v[20:21], v14, s[16:19], s62 offen offset:1024
    buffer_store_dwordx2 v[24:25], v14, s[16:19], s62 offen offset:2048
    s_mov_b64 exec, 1
    buffer_store_dwordx2 v[28:29], v15, s[16:19], s62 offen
PUBD1:
    s_mov_b64 exec, -1
ENTRY:
    s_mov_b32 s51, 0
    v_lshrrev_b32 v66, 4, v0
    v_and_b32 v67, 15, v0
    v_lshlrev_b32 v66, 10, v66
    v_lshl_add_u32 v66, v67, 3, v66
    s_mul_i32 s52, s7, 12288
    s_add_u32 s52, s52, 20480
    v_add_u32 v66, s52, v66
    v_and_b32 v67, 7, v1
    s_lshl_b32 s52, s7, 6
    s_add_u32 s52, s52, 69632
    v_lshl_add_u32 v67, v67, 3, s52
    v_lshlrev_b32 v68, 1, v0
    v_add_u32 v68, 98304, v68
    v_mov_b32 v69, 0x3727c5ac
    s_cmp_eq_u32 s49, 0
    s_cselect_b32 s53, 3, s44
    s_cmp_eq_u32 s53, 3
    s_cbranch_scc1 EN0
    s_nop 15
    s_nop 7
    buffer_load_dwordx2 v[62:63], v67, s[16:19], s62 offen sc1
    buffer_load_dwordx2 v[44:45], v66, s[16:19], s62 offen offset:0 sc1
    buffer_load_dwordx2 v[46:47], v66, s[16:19], s62 offen offset:128 sc1
    buffer_load_dwordx2 v[48:49], v66, s[16:19], s62 offen offset:256 sc1
    buffer_load_dwordx2 v[50:51], v66, s[16:19], s62 offen offset:384 sc1
    buffer_load_dwordx2 v[52:53], v66, s[16:19], s62 offen offset:512 sc1
    buffer_load_dwordx2 v[54:55], v66, s[16:19], s62 offen offset:640 sc1
    buffer_load_dwordx2 v[56:57], v66, s[16:19], s62 offen offset:768 sc1
    buffer_load_dwordx2 v[58:59], v66, s[16:19], s62 offen offset:896 sc1
EN0:
    v_lshrrev_b32 v14, 2, v1
    v_lshlrev_b32 v14, 7, v14
    v_and_b32 v15, 3, v1
    v_lshl_add_u32 v14, v15, 2, v14
    s_mul_i32 s52, s7, 3072
    s_mul_i32 s54, s44, 768
    s_add_u32 s52, s52, s54
    s_lshl_b32 s54, s48, 4
    s_add_u32 s52, s52, s54
    v_add_u32 v14, s52, v14
    s_lshl_b32 s52, s7, 5
    s_lshl_b32 s54, s48, 2
    s_add_u32 s52, s52, s54
    s_add_u32 s52, s52, 19968
    v_writelane_b32 v14, s52, 24
    v_and_b32 v15, 7, v1
    v_lshlrev_b32 v15, 5, v15
    v_bfe_u32 v61, v1, 4, 1
    v_lshl_add_u32 v15, v61, 4, v15
    v_lshrrev_b32 v61, 5, v1
    v_mul_u32_u24 v61, 768, v61
    v_add_u32 v15, v15, v61
    s_mul_i32 s52, s44, 1536
    s_add_u32 s52, s52, 98816
    v_add_u32 v15, s52, v15
    s_mul_i32 s52, s44, 192
    s_add_u32 s52, s52, 98816
    v_min_u32 v60, 23, v1
    v_lshl_add_u32 v60, v60, 3, s52
    s_lshl_b32 s52, s44, 3
    s_add_u32 s52, s52, 98752
    v_mov_b32 v61, s52
    v_mov_b32 v70, 98752
    s_cmp_eq_u32 s53, 3
    s_cbranch_scc1 ENOK2
    s_nop 15
ENP:
    buffer_load_dwordx2 v[62:63], v67, s[16:19], s62 offen sc1
    buffer_load_dwordx2 v[44:45], v66, s[16:19], s62 offen offset:0 sc1
    buffer_load_dwordx2 v[46:47], v66, s[16:19], s62 offen offset:128 sc1
    buffer_load_dwordx2 v[48:49], v66, s[16:19], s62 offen offset:256 sc1
    buffer_load_dwordx2 v[50:51], v66, s[16:19], s62 offen offset:384 sc1
    buffer_load_dwordx2 v[52:53], v66, s[16:19], s62 offen offset:512 sc1
    buffer_load_dwordx2 v[54:55], v66, s[16:19], s62 offen offset:640 sc1
    buffer_load_dwordx2 v[56:57], v66, s[16:19], s62 offen offset:768 sc1
    buffer_load_dwordx2 v[58:59], v66, s[16:19], s62 offen offset:896 sc1
    s_waitcnt vmcnt(9)
    v_add_f32_dpp v32, v62, v62 quad_perm:[1,0,3,2] row_mask:0xf bank_mask:0xf
    v_add_f32_dpp v33, v63, v63 quad_perm:[1,0,3,2] row_mask:0xf bank_mask:0xf
    v_pk_add_f32 v[16:17], v[44:45], v[46:47]
    v_pk_add_f32 v[20:21], v[48:49], v[50:51]
    v_add_f32_dpp v32, v32, v32 quad_perm:[2,3,0,1] row_mask:0xf bank_mask:0xf
    v_add_f32_dpp v33, v33, v33 quad_perm:[2,3,0,1] row_mask:0xf bank_mask:0xf
    v_pk_add_f32 v[24:25], v[52:53], v[54:55]
    v_pk_add_f32 v[28:29], v[56:57], v[58:59]
    v_add_f32_dpp v32, v32, v32 row_half_mirror row_mask:0xf bank_mask:0xf
    v_add_f32_dpp v33, v33, v33 row_half_mirror row_mask:0xf bank_mask:0xf
    v_pk_add_f32 v[16:17], v[16:17], v[20:21]
    v_pk_add_f32 v[24:25], v[24:25], v[28:29]
    v_mul_f32 v33, 0x3acccccd, v33
    v_fmamk_f32 v32, v32, 0x3acccccd, v69
    v_fma_f32 v32, -v33, v33, v32
    v_rsq_f32 v32, v32
    v_pk_add_f32 v[16:17], v[16:17], v[24:25]
    v_mul_f32 v32, 0x3dd53b94, v32
    v_fma_f32 v16, -v33, v17, v16
    v_mul_f32 v16, v16, v32
    v_cmp_u_f32 vcc, v16, v16
    s_cbranch_vccz ENOK
    s_add_u32 s51, s51, 1
    s_cmp_lt_u32 s51, 0x8000
    s_cbranch_scc1 ENP
ENOK:
    v_cvt_pk_bf16_f32 v16, v16, v16
    ds_write_b16 v68, v16
ENOK2:
    s_waitcnt lgkmcnt(0)
    s_barrier
    ds_read_b128 v[16:19], v3
    ds_read_b128 v[20:23], v4
    ds_read_b128 v[24:27], v5
    ds_read_b128 v[28:31], v6
    ds_read_b128 v[32:35], v7
    ds_read_b128 v[36:39], v8
    s_cmp_eq_u32 s49, 0
    s_cbranch_scc1 HOOKF
    s_waitcnt vmcnt(0)
QK:
    s_waitcnt lgkmcnt(5)
    v_mfma_f32_16x16x32_bf16 v[40:43], a[0:3], v[16:19], 0
    s_waitcnt lgkmcnt(4)
    v_mfma_f32_16x16x32_bf16 v[40:43], a[4:7], v[20:23], v[40:43]
    s_waitcnt lgkmcnt(3)
    v_mfma_f32_16x16x32_bf16 v[40:43], a[8:11], v[24:27], v[40:43]
    s_waitcnt lgkmcnt(2)
    v_mfma_f32_16x16x32_bf16 v[40:43], a[12:15], v[28:31], v[40:43]
    s_waitcnt lgkmcnt(1)
    v_mfma_f32_16x16x32_bf16 v[40:43], a[16:19], v[32:35], v[40:43]
    s_waitcnt lgkmcnt(0)
    v_mfma_f32_16x16x32_bf16 v[40:43], a[20:23], v[36:39], v[40:43]
    v_mfma_f32_16x16x32_bf16 v[44:47], a[24:27], v[16:19], 0
    v_mfma_f32_16x16x32_bf16 v[44:47], a[28:31], v[20:23], v[44:47]
    v_mfma_f32_16x16x32_bf16 v[44:47], a[32:35], v[24:27], v[44:47]
    v_mfma_f32_16x16x32_bf16 v[44:47], a[36:39], v[28:31], v[44:47]
    v_mfma_f32_16x16x32_bf16 v[44:47], a[40:43], v[32:35], v[44:47]
    v_mfma_f32_16x16x32_bf16 v[44:47], a[44:47], v[36:39], v[44:47]
    v_mfma_f32_16x16x32_bf16 v[48:51], a[48:51], v[16:19], 0
    v_mfma_f32_16x16x32_bf16 v[48:51], a[52:55], v[20:23], v[48:51]
    v_mov_b32_dpp v52, v40 quad_perm:[0,0,0,0] row_mask:0xf bank_mask:0xf
    v_mfma_f32_16x16x32_bf16 v[48:51], a[56:59], v[24:27], v[48:51]
    v_add_f32_dpp v52, v41, v52 quad_perm:[1,1,1,1] row_mask:0xf bank_mask:0xf
    v_mfma_f32_16x16x32_bf16 v[48:51], a[60:63], v[28:31], v[48:51]
    v_add_f32_dpp v52, v42, v52 quad_perm:[2,2,2,2] row_mask:0xf bank_mask:0xf
    v_mfma_f32_16x16x32_bf16 v[48:51], a[64:67], v[32:35], v[48:51]
    v_add_f32_dpp v52, v43, v52 quad_perm:[3,3,3,3] row_mask:0xf bank_mask:0xf
    v_mfma_f32_16x16x32_bf16 v[48:51], a[68:71], v[36:39], v[48:51]
    v_mov_b32 v62, v52
    v_mfma_f32_16x16x32_bf16 v[40:43], a[72:75], v[16:19], 0
    v_mfma_f32_16x16x32_bf16 v[40:43], a[76:79], v[20:23], v[40:43]
    v_mov_b32_dpp v53, v44 quad_perm:[0,0,0,0] row_mask:0xf bank_mask:0xf
    v_mfma_f32_16x16x32_bf16 v[40:43], a[80:83], v[24:27], v[40:43]
    v_add_f32_dpp v53, v45, v53 quad_perm:[1,1,1,1] row_mask:0xf bank_mask:0xf
    v_mfma_f32_16x16x32_bf16 v[40:43], a[84:87], v[28:31], v[40:43]
    v_add_f32_dpp v53, v46, v53 quad_perm:[2,2,2,2] row_mask:0xf bank_mask:0xf
    v_mfma_f32_16x16x32_bf16 v[40:43], a[88:91], v[32:35], v[40:43]
    v_add_f32_dpp v53, v47, v53 quad_perm:[3,3,3,3] row_mask:0xf bank_mask:0xf
    v_mfma_f32_16x16x32_bf16 v[40:43], a[92:95], v[36:39], v[40:43]
    v_max_f32 v62, v62, v53
    v_mfma_f32_16x16x32_bf16 v[44:47], a[96:99], v[16:19], 0
    v_mfma_f32_16x16x32_bf16 v[44:47], a[100:103], v[20:23], v[44:47]
    v_mov_b32_dpp v54, v48 quad_perm:[0,0,0,0] row_mask:0xf bank_mask:0xf
    v_mfma_f32_16x16x32_bf16 v[44:47], a[104:107], v[24:27], v[44:47]
    v_add_f32_dpp v54, v49, v54 quad_perm:[1,1,1,1] row_mask:0xf bank_mask:0xf
    v_mfma_f32_16x16x32_bf16 v[44:47], a[108:111], v[28:31], v[44:47]
    v_add_f32_dpp v54, v50, v54 quad_perm:[2,2,2,2] row_mask:0xf bank_mask:0xf
    v_mfma_f32_16x16x32_bf16 v[44:47], a[112:115], v[32:35], v[44:47]
    v_add_f32_dpp v54, v51, v54 quad_perm:[3,3,3,3] row_mask:0xf bank_mask:0xf
    v_mfma_f32_16x16x32_bf16 v[44:47], a[116:119], v[36:39], v[44:47]
    v_max_f32 v62, v62, v54
    v_mfma_f32_16x16x32_bf16 v[48:51], a[120:123], v[16:19], 0
    v_mfma_f32_16x16x32_bf16 v[48:51], a[124:127], v[20:23], v[48:51]
    v_mov_b32_dpp v55, v40 quad_perm:[0,0,0,0] row_mask:0xf bank_mask:0xf
    v_mfma_f32_16x16x32_bf16 v[48:51], a[128:131], v[24:27], v[48:51]
    v_add_f32_dpp v55, v41, v55 quad_perm:[1,1,1,1] row_mask:0xf bank_mask:0xf
    v_mfma_f32_16x16x32_bf16 v[48:51], a[132:135], v[28:31], v[48:51]
    v_add_f32_dpp v55, v42, v55 quad_perm:[2,2,2,2] row_mask:0xf bank_mask:0xf
    v_mfma_f32_16x16x32_bf16 v[48:51], a[136:139], v[32:35], v[48:51]
    v_add_f32_dpp v55, v43, v55 quad_perm:[3,3,3,3] row_mask:0xf bank_mask:0xf
    v_mfma_f32_16x16x32_bf16 v[48:51], a[140:143], v[36:39], v[48:51]
    v_max_f32 v62, v62, v55
    v_mfma_f32_16x16x32_bf16 v[40:43], a[144:147], v[16:19], 0
    v_mfma_f32_16x16x32_bf16 v[40:43], a[148:151], v[20:23], v[40:43]
    v_mov_b32_dpp v56, v44 quad_perm:[0,0,0,0] row_mask:0xf bank_mask:0xf
    v_mfma_f32_16x16x32_bf16 v[40:43], a[152:155], v[24:27], v[40:43]
    v_add_f32_dpp v56, v45, v56 quad_perm:[1,1,1,1] row_mask:0xf bank_mask:0xf
    v_mfma_f32_16x16x32_bf16 v[40:43], a[156:159], v[28:31], v[40:43]
    v_add_f32_dpp v56, v46, v56 quad_perm:[2,2,2,2] row_mask:0xf bank_mask:0xf
    v_mfma_f32_16x16x32_bf16 v[40:43], a[160:163], v[32:35], v[40:43]
    v_add_f32_dpp v56, v47, v56 quad_perm:[3,3,3,3] row_mask:0xf bank_mask:0xf
    v_mfma_f32_16x16x32_bf16 v[40:43], a[164:167], v[36:39], v[40:43]
    v_max_f32 v62, v62, v56
    v_mfma_f32_16x16x32_bf16 v[44:47], a[168:171], v[16:19], 0
    v_mfma_f32_16x16x32_bf16 v[44:47], a[172:175], v[20:23], v[44:47]
    v_mov_b32_dpp v57, v48 quad_perm:[0,0,0,0] row_mask:0xf bank_mask:0xf
    v_mfma_f32_16x16x32_bf16 v[44:47], a[176:179], v[24:27], v[44:47]
    v_add_f32_dpp v57, v49, v57 quad_perm:[1,1,1,1] row_mask:0xf bank_mask:0xf
    v_mfma_f32_16x16x32_bf16 v[44:47], a[180:183], v[28:31], v[44:47]
    v_add_f32_dpp v57, v50, v57 quad_perm:[2,2,2,2] row_mask:0xf bank_mask:0xf
    v_mfma_f32_16x16x32_bf16 v[44:47], a[184:187], v[32:35], v[44:47]
    v_add_f32_dpp v57, v51, v57 quad_perm:[3,3,3,3] row_mask:0xf bank_mask:0xf
    v_mfma_f32_16x16x32_bf16 v[44:47], a[188:191], v[36:39], v[44:47]
    v_max_f32 v62, v62, v57
    v_mov_b32_dpp v58, v40 quad_perm:[0,0,0,0] row_mask:0xf bank_mask:0xf
    v_add_f32_dpp v58, v41, v58 quad_perm:[1,1,1,1] row_mask:0xf bank_mask:0xf
    v_add_f32_dpp v58, v42, v58 quad_perm:[2,2,2,2] row_mask:0xf bank_mask:0xf
    v_add_f32_dpp v58, v43, v58 quad_perm:[3,3,3,3] row_mask:0xf bank_mask:0xf
    v_max_f32 v62, v62, v58
    s_nop 2
    v_mov_b32_dpp v59, v44 quad_perm:[0,0,0,0] row_mask:0xf bank_mask:0xf
    v_add_f32_dpp v59, v45, v59 quad_perm:[1,1,1,1] row_mask:0xf bank_mask:0xf
    v_add_f32_dpp v59, v46, v59 quad_perm:[2,2,2,2] row_mask:0xf bank_mask:0xf
    v_add_f32_dpp v59, v47, v59 quad_perm:[3,3,3,3] row_mask:0xf bank_mask:0xf
    v_max_f32 v62, v62, v59
    s_nop 1
    v_max_f32_dpp v62, v62, v62 row_ror:4 row_mask:0xf bank_mask:0xf
    s_nop 1
    v_max_f32_dpp v62, v62, v62 row_ror:8 row_mask:0xf bank_mask:0xf
    v_mov_b32 v63, v62
    s_nop 1
    v_permlane16_swap_b32 v62, v63
    v_max_f32 v62, v62, v63
    v_mov_b32 v63, v62
    s_nop 1
    v_permlane32_swap_b32 v62, v63
    v_max_f32 v62, v62, v63
    v_sub_f32 v52, v52, v62
    v_exp_f32 v52, v52
    s_nop 0
    v_cvt_pk_bf16_f32 v44, v52, v52
    v_and_b32 v16, v44, v9
    v_and_b32 v17, v44, v10
    v_and_b32_dpp v18, v44, v11 row_shr:4 row_mask:0xf bank_mask:0xf bound_ctrl:0
    v_and_b32_dpp v19, v44, v12 row_shr:4 row_mask:0xf bank_mask:0xf bound_ctrl:0
    v_and_b32_dpp v20, v44, v9 row_shl:4 row_mask:0xf bank_mask:0xf bound_ctrl:0
    v_and_b32_dpp v21, v44, v10 row_shl:4 row_mask:0xf bank_mask:0xf bound_ctrl:0
    v_and_b32 v22, v44, v11
    v_and_b32 v23, v44, v12
    v_mov_b32 v63, v52
    s_waitcnt vmcnt(42)
    v_mfma_f32_16x16x32_bf16 v[32:35], v[16:19], a[192:195], 0
    v_sub_f32 v53, v53, v62
    v_exp_f32 v53, v53
    v_mfma_f32_16x16x32_bf16 v[36:39], v[16:19], a[196:199], 0
    v_cvt_pk_bf16_f32 v44, v53, v53
    v_and_b32 v24, v44, v9
    v_mfma_f32_16x16x32_bf16 v[40:43], v[16:19], a[200:203], 0
    v_and_b32 v25, v44, v10
    v_and_b32_dpp v26, v44, v11 row_shr:4 row_mask:0xf bank_mask:0xf bound_ctrl:0
    v_mfma_f32_16x16x32_bf16 v[32:35], v[20:23], a[204:207], v[32:35]
    v_and_b32_dpp v27, v44, v12 row_shr:4 row_mask:0xf bank_mask:0xf bound_ctrl:0
    v_and_b32_dpp v28, v44, v9 row_shl:4 row_mask:0xf bank_mask:0xf bound_ctrl:0
    v_mfma_f32_16x16x32_bf16 v[36:39], v[20:23], a[208:211], v[36:39]
    v_and_b32_dpp v29, v44, v10 row_shl:4 row_mask:0xf bank_mask:0xf bound_ctrl:0
    v_and_b32 v30, v44, v11
    v_mfma_f32_16x16x32_bf16 v[40:43], v[20:23], a[212:215], v[40:43]
    v_and_b32 v31, v44, v12
    v_add_f32 v63, v63, v53
    s_waitcnt vmcnt(36)
    v_mfma_f32_16x16x32_bf16 v[32:35], v[24:27], a[216:219], v[32:35]
    v_sub_f32 v54, v54, v62
    v_exp_f32 v54, v54
    v_mfma_f32_16x16x32_bf16 v[36:39], v[24:27], a[220:223], v[36:39]
    v_cvt_pk_bf16_f32 v44, v54, v54
    v_and_b32 v16, v44, v9
    v_mfma_f32_16x16x32_bf16 v[40:43], v[24:27], a[224:227], v[40:43]
    v_and_b32 v17, v44, v10
    v_and_b32_dpp v18, v44, v11 row_shr:4 row_mask:0xf bank_mask:0xf bound_ctrl:0
    v_mfma_f32_16x16x32_bf16 v[32:35], v[28:31], a[228:231], v[32:35]
    v_and_b32_dpp v19, v44, v12 row_shr:4 row_mask:0xf bank_mask:0xf bound_ctrl:0
    v_and_b32_dpp v20, v44, v9 row_shl:4 row_mask:0xf bank_mask:0xf bound_ctrl:0
    v_mfma_f32_16x16x32_bf16 v[36:39], v[28:31], a[232:235], v[36:39]
    v_and_b32_dpp v21, v44, v10 row_shl:4 row_mask:0xf bank_mask:0xf bound_ctrl:0
    v_and_b32 v22, v44, v11
    v_mfma_f32_16x16x32_bf16 v[40:43], v[28:31], a[236:239], v[40:43]
    v_and_b32 v23, v44, v12
    v_add_f32 v63, v63, v54
    s_waitcnt vmcnt(30)
    v_mfma_f32_16x16x32_bf16 v[32:35], v[16:19], a[240:243], v[32:35]
    v_sub_f32 v55, v55, v62
    v_exp_f32 v55, v55
    v_mfma_f32_16x16x32_bf16 v[36:39], v[16:19], a[244:247], v[36:39]
    v_cvt_pk_bf16_f32 v44, v55, v55
    v_and_b32 v24, v44, v9
    v_mfma_f32_16x16x32_bf16 v[40:43], v[16:19], a[248:251], v[40:43]
    v_and_b32 v25, v44, v10
    v_and_b32_dpp v26, v44, v11 row_shr:4 row_mask:0xf bank_mask:0xf bound_ctrl:0
    v_mfma_f32_16x16x32_bf16 v[32:35], v[20:23], a[252:255], v[32:35]
    v_and_b32_dpp v27, v44, v12 row_shr:4 row_mask:0xf bank_mask:0xf bound_ctrl:0
    v_and_b32_dpp v28, v44, v9 row_shl:4 row_mask:0xf bank_mask:0xf bound_ctrl:0
    v_mfma_f32_16x16x32_bf16 v[36:39], v[20:23], v[128:131], v[36:39]
    v_and_b32_dpp v29, v44, v10 row_shl:4 row_mask:0xf bank_mask:0xf bound_ctrl:0
    v_and_b32 v30, v44, v11
    v_mfma_f32_16x16x32_bf16 v[40:43], v[20:23], v[132:135], v[40:43]
    v_and_b32 v31, v44, v12
    v_add_f32 v63, v63, v55
    s_waitcnt vmcnt(24)
    v_mfma_f32_16x16x32_bf16 v[32:35], v[24:27], v[136:139], v[32:35]
    v_sub_f32 v56, v56, v62
    v_exp_f32 v56, v56
    v_mfma_f32_16x16x32_bf16 v[36:39], v[24:27], v[140:143], v[36:39]
    v_cvt_pk_bf16_f32 v44, v56, v56
    v_and_b32 v16, v44, v9
    v_mfma_f32_16x16x32_bf16 v[40:43], v[24:27], v[144:147], v[40:43]
    v_and_b32 v17, v44, v10
    v_and_b32_dpp v18, v44, v11 row_shr:4 row_mask:0xf bank_mask:0xf bound_ctrl:0
    v_mfma_f32_16x16x32_bf16 v[32:35], v[28:31], v[148:151], v[32:35]
    v_and_b32_dpp v19, v44, v12 row_shr:4 row_mask:0xf bank_mask:0xf bound_ctrl:0
    v_and_b32_dpp v20, v44, v9 row_shl:4 row_mask:0xf bank_mask:0xf bound_ctrl:0
    v_mfma_f32_16x16x32_bf16 v[36:39], v[28:31], v[152:155], v[36:39]
    v_and_b32_dpp v21, v44, v10 row_shl:4 row_mask:0xf bank_mask:0xf bound_ctrl:0
    v_and_b32 v22, v44, v11
    v_mfma_f32_16x16x32_bf16 v[40:43], v[28:31], v[156:159], v[40:43]
    v_and_b32 v23, v44, v12
    v_add_f32 v63, v63, v56
    s_waitcnt vmcnt(18)
    v_mfma_f32_16x16x32_bf16 v[32:35], v[16:19], v[160:163], v[32:35]
    v_sub_f32 v57, v57, v62
    v_exp_f32 v57, v57
    v_mfma_f32_16x16x32_bf16 v[36:39], v[16:19], v[164:167], v[36:39]
    v_cvt_pk_bf16_f32 v44, v57, v57
    v_and_b32 v24, v44, v9
    v_mfma_f32_16x16x32_bf16 v[40:43], v[16:19], v[168:171], v[40:43]
    v_and_b32 v25, v44, v10
    v_and_b32_dpp v26, v44, v11 row_shr:4 row_mask:0xf bank_mask:0xf bound_ctrl:0
    v_mfma_f32_16x16x32_bf16 v[32:35], v[20:23], v[172:175], v[32:35]
    v_and_b32_dpp v27, v44, v12 row_shr:4 row_mask:0xf bank_mask:0xf bound_ctrl:0
    v_and_b32_dpp v28, v44, v9 row_shl:4 row_mask:0xf bank_mask:0xf bound_ctrl:0
    v_mfma_f32_16x16x32_bf16 v[36:39], v[20:23], v[176:179], v[36:39]
    v_and_b32_dpp v29, v44, v10 row_shl:4 row_mask:0xf bank_mask:0xf bound_ctrl:0
    v_and_b32 v30, v44, v11
    v_mfma_f32_16x16x32_bf16 v[40:43], v[20:23], v[180:183], v[40:43]
    v_and_b32 v31, v44, v12
    v_add_f32 v63, v63, v57
    s_waitcnt vmcnt(12)
    v_mfma_f32_16x16x32_bf16 v[32:35], v[24:27], v[184:187], v[32:35]
    v_sub_f32 v58, v58, v62
    v_exp_f32 v58, v58
    v_mfma_f32_16x16x32_bf16 v[36:39], v[24:27], v[188:191], v[36:39]
    v_cvt_pk_bf16_f32 v44, v58, v58
    v_and_b32 v16, v44, v9
    v_mfma_f32_16x16x32_bf16 v[40:43], v[24:27], v[192:195], v[40:43]
    v_and_b32 v17, v44, v10
    v_and_b32_dpp v18, v44, v11 row_shr:4 row_mask:0xf bank_mask:0xf bound_ctrl:0
    v_mfma_f32_16x16x32_bf16 v[32:35], v[28:31], v[196:199], v[32:35]
    v_and_b32_dpp v19, v44, v12 row_shr:4 row_mask:0xf bank_mask:0xf bound_ctrl:0
    v_and_b32_dpp v20, v44, v9 row_shl:4 row_mask:0xf bank_mask:0xf bound_ctrl:0
    v_mfma_f32_16x16x32_bf16 v[36:39], v[28:31], v[200:203], v[36:39]
    v_and_b32_dpp v21, v44, v10 row_shl:4 row_mask:0xf bank_mask:0xf bound_ctrl:0
    v_and_b32 v22, v44, v11
    v_mfma_f32_16x16x32_bf16 v[40:43], v[28:31], v[204:207], v[40:43]
    v_and_b32 v23, v44, v12
    v_add_f32 v63, v63, v58
    s_waitcnt vmcnt(6)
    v_mfma_f32_16x16x32_bf16 v[32:35], v[16:19], v[208:211], v[32:35]
    v_sub_f32 v59, v59, v62
    v_exp_f32 v59, v59
    v_mfma_f32_16x16x32_bf16 v[36:39], v[16:19], v[212:215], v[36:39]
    v_cvt_pk_bf16_f32 v44, v59, v59
    v_and_b32 v24, v44, v9
    v_mfma_f32_16x16x32_bf16 v[40:43], v[16:19], v[216:219], v[40:43]
    v_and_b32 v25, v44, v10
    v_and_b32_dpp v26, v44, v11 row_shr:4 row_mask:0xf bank_mask:0xf bound_ctrl:0
    v_mfma_f32_16x16x32_bf16 v[32:35], v[20:23], v[220:223], v[32:35]
    v_and_b32_dpp v27, v44, v12 row_shr:4 row_mask:0xf bank_mask:0xf bound_ctrl:0
    v_and_b32_dpp v28, v44, v9 row_shl:4 row_mask:0xf bank_mask:0xf bound_ctrl:0
    v_mfma_f32_16x16x32_bf16 v[36:39], v[20:23], v[224:227], v[36:39]
    v_and_b32_dpp v29, v44, v10 row_shl:4 row_mask:0xf bank_mask:0xf bound_ctrl:0
    v_and_b32 v30, v44, v11
    v_mfma_f32_16x16x32_bf16 v[40:43], v[20:23], v[228:231], v[40:43]
    v_and_b32 v31, v44, v12
    v_add_f32 v63, v63, v59
    s_waitcnt vmcnt(0)
    v_mfma_f32_16x16x32_bf16 v[32:35], v[24:27], v[232:235], v[32:35]
    s_nop 0
    v_add_f32_dpp v63, v63, v63 row_ror:4 row_mask:0xf bank_mask:0xf
    v_mfma_f32_16x16x32_bf16 v[36:39], v[24:27], v[236:239], v[36:39]
    s_nop 0
    s_nop 0
    v_mfma_f32_16x16x32_bf16 v[40:43], v[24:27], v[240:243], v[40:43]
    v_add_f32_dpp v63, v63, v63 row_ror:8 row_mask:0xf bank_mask:0xf
    v_mov_b32 v44, v63
    v_mfma_f32_16x16x32_bf16 v[32:35], v[28:31], v[244:247], v[32:35]
    s_nop 0
    v_permlane16_swap_b32 v63, v44
    v_mfma_f32_16x16x32_bf16 v[36:39], v[28:31], v[248:251], v[36:39]
    v_add_f32 v63, v63, v44
    v_mov_b32 v44, v63
    v_mfma_f32_16x16x32_bf16 v[40:43], v[28:31], v[252:255], v[40:43]
    s_nop 0
    v_permlane32_swap_b32 v63, v44
    v_add_f32 v63, v63, v44
    ds_write_b64 v61, v[62:63]
    s_mov_b32 exec_lo, 0x00ff00ff
    s_mov_b32 exec_hi, 0xff00ff00
    ds_write_b128 v15, v[32:35] offset:0
    ds_write_b128 v15, v[36:39] offset:256
    ds_write_b128 v15, v[40:43] offset:512
    s_mov_b64 exec, -1
    v_cmp_eq_u32 s[60:61], 24, v1
    s_cmp_eq_u32 s49, 0
    s_cbranch_scc1 HOOKC
EXB:
    s_waitcnt lgkmcnt(0)
    s_barrier
    ds_read_b128 v[16:19], v70
    ds_read_b128 v[20:23], v70 offset:16
    ds_read_b64 v[24:25], v60 offset:0
    ds_read_b64 v[26:27], v60 offset:768
    ds_read_b64 v[28:29], v60 offset:1536
    ds_read_b64 v[30:31], v60 offset:2304
    ds_read_b64 v[32:33], v60 offset:3072
    ds_read_b64 v[34:35], v60 offset:3840
    ds_read_b64 v[36:37], v60 offset:4608
    ds_read_b64 v[38:39], v60 offset:5376
    s_waitcnt lgkmcnt(8)
    v_max_f32 v40, v16, v18
    v_max3_f32 v40, v40, v20, v22
    v_sub_f32 v16, v16, v40
    v_sub_f32 v18, v18, v40
    v_sub_f32 v20, v20, v40
    v_sub_f32 v22, v22, v40
    v_exp_f32 v16, v16
    v_exp_f32 v18, v18
    v_exp_f32 v20, v20
    v_exp_f32 v22, v22
    v_mul_f32 v41, v16, v17
    v_fmac_f32 v41, v18, v19
    v_fmac_f32 v41, v20, v21
    v_fmac_f32 v41, v22, v23
    v_rcp_f32 v42, v41
    v_log_f32 v43, v41
    s_waitcnt lgkmcnt(0)
    v_pk_add_f32 v[24:25], v[24:25], v[26:27]
    v_pk_add_f32 v[28:29], v[28:29], v[30:31]
    v_pk_add_f32 v[32:33], v[32:33], v[34:35]
    v_pk_add_f32 v[36:37], v[36:37], v[38:39]
    v_pk_mul_f32 v[24:25], v[24:25], v[16:17] op_sel_hi:[1,0]
    v_pk_fma_f32 v[24:25], v[28:29], v[18:19], v[24:25] op_sel_hi:[1,0,1]
    v_pk_fma_f32 v[24:25], v[32:33], v[20:21], v[24:25] op_sel_hi:[1,0,1]
    v_pk_fma_f32 v[24:25], v[36:37], v[22:23], v[24:25] op_sel_hi:[1,0,1]
    v_pk_mul_f32 v[24:25], v[24:25], v[42:43] op_sel_hi:[1,0]
    v_add_f32 v43, v43, v40
    v_cvt_pk_bf16_f32 v24, v24, v25
    s_mov_b64 exec, 0x1ffffff
    v_cndmask_b32 v24, v24, v43, s[60:61]
    s_cmp_eq_u32 s50, 0
    s_cbranch_scc1 SLOW2
    buffer_store_dword v24, v14, s[16:19], s62 offen
PUBD2:
    s_mov_b64 exec, -1
    s_cmp_ge_u32 s46, 20
    s_cbranch_scc1 HOOKG3
    v_and_b32 v30, 7, v1
    v_lshrrev_b32 v31, 4, v1
    v_lshlrev_b32 v58, 4, v30
    v_lshl_add_u32 v58, v31, 7, v58
    s_mul_i32 s52, s56, 6144
    s_mul_i32 s54, s44, 1536
    s_add_u32 s52, s52, s54
    v_add_u32 v58, s52, v58
    s_lshr_b32 s53, s44, 1
    s_lshl_b32 s52, s56, 6
    s_lshl_b32 s54, s53, 5
    s_add_u32 s52, s52, s54
    s_add_u32 s52, s52, 19968
    v_lshl_add_u32 v59, v31, 2, v30
    v_and_b32 v59, 7, v59
    v_lshl_add_u32 v59, v59, 2, s52
    s_lshl_b32 s52, s57, 8
    s_add_u32 s52, s52, 81920
    s_or_b32 s53, s45, s56
    s_cmp_eq_u32 s53, 0
    s_cselect_b32 s52, s52, 1879048192
    v_lshl_add_u32 v61, v1, 2, s52
    v_mov_b64 v[44:45], 0
    v_mov_b64 v[46:47], 0
    v_mov_b64 v[48:49], 0
    v_mov_b64 v[50:51], 0
    v_mov_b64 v[52:53], 0
    v_mov_b64 v[54:55], 0
    s_mov_b32 s60, 0x00ff00ff
    s_mov_b32 s61, 0x00ff00ff
    s_mov_b32 s51, 0
    s_cmp_eq_u32 s49, 0
    s_cbranch_scc1 HOOKG
    s_nop 7
WO0:
    buffer_load_dword v57, v61, s[16:19], s49 offen sc1
    buffer_load_dword v56, v59, s[16:19], s62 offen sc1
    s_mov_b64 exec, s[60:61]
    buffer_load_dwordx4 v[44:47], v58, s[16:19], s62 offen offset:0 sc1
    buffer_load_dwordx4 v[48:51], v58, s[16:19], s62 offen offset:512 sc1
    buffer_load_dwordx4 v[52:55], v58, s[16:19], s62 offen offset:1024 sc1
    s_mov_b64 exec, -1
    s_cmp_eq_u32 s49, 0
    s_cbranch_scc1 HOOKG2
    s_nop 15
    s_nop 15
WO1:
    v_lshrrev_b32 v14, 5, v1
    v_lshlrev_b32 v14, 11, v14
    v_and_b32 v15, 31, v1
    v_lshl_add_u32 v14, v15, 2, v14
    s_lshl_b32 s52, s57, 12
    s_lshl_b32 s54, s45, 8
    s_add_u32 s52, s52, s54
    s_lshl_b32 s54, s56, 7
    s_add_u32 s52, s52, s54
    v_add_u32 v14, s52, v14
    s_lshl_b32 s52, s44, 9
    s_add_u32 s52, s52, 104960
    v_lshl_add_u32 v15, v15, 4, s52
    v_and_b32 v64, 15, v1
    v_lshlrev_b32 v64, 4, v64
    v_lshl_add_u32 v64, v31, 2, v64
    v_add_u32 v64, 104960, v64
WOP:
    buffer_load_dword v57, v61, s[16:19], s49 offen sc1
    buffer_load_dword v56, v59, s[16:19], s62 offen sc1
    s_mov_b64 exec, s[60:61]
    buffer_load_dwordx4 v[44:47], v58, s[16:19], s62 offen offset:0 sc1
    buffer_load_dwordx4 v[48:51], v58, s[16:19], s62 offen offset:512 sc1
    buffer_load_dwordx4 v[52:55], v58, s[16:19], s62 offen offset:1024 sc1
    s_mov_b64 exec, -1
    s_waitcnt vmcnt(5) lgkmcnt(0)
    v_max3_u32 v63, v44, v48, v52
    v_mov_b32 v32, v56
    v_max_u32 v63, v63, v32
    v_cmp_eq_u32 vcc, -1, v63
    s_cbranch_vccnz WOAG
    v_mfma_f32_16x16x32_bf16 v[16:19], v[44:47], v[80:83], 0
    v_max_f32_dpp v33, v32, v32 quad_perm:[1,0,3,2] row_mask:0xf bank_mask:0xf
    s_nop 0
    v_mfma_f32_16x16x32_bf16 v[16:19], v[48:51], v[96:99], v[16:19]
    v_max_f32_dpp v33, v33, v33 quad_perm:[2,3,0,1] row_mask:0xf bank_mask:0xf
    s_nop 0
    v_mfma_f32_16x16x32_bf16 v[16:19], v[52:55], v[112:115], v[16:19]
    v_max_f32_dpp v33, v33, v33 row_half_mirror row_mask:0xf bank_mask:0xf
    v_sub_f32 v34, v32, v33
    v_mfma_f32_16x16x32_bf16 v[20:23], v[44:47], v[84:87], 0
    v_exp_f32 v34, v34
    s_nop 0
    v_mfma_f32_16x16x32_bf16 v[20:23], v[48:51], v[100:103], v[20:23]
    v_add_f32_dpp v33, v34, v34 quad_perm:[1,0,3,2] row_mask:0xf bank_mask:0xf
    s_nop 0
    v_mfma_f32_16x16x32_bf16 v[20:23], v[52:55], v[116:119], v[20:23]
    v_add_f32_dpp v33, v33, v33 quad_perm:[2,3,0,1] row_mask:0xf bank_mask:0xf
    s_nop 0
    v_mfma_f32_16x16x32_bf16 v[24:27], v[44:47], v[88:91], 0
    v_add_f32_dpp v33, v33, v33 row_half_mirror row_mask:0xf bank_mask:0xf
    v_rcp_f32 v33, v33
    v_mfma_f32_16x16x32_bf16 v[24:27], v[48:51], v[104:107], v[24:27]
    v_mul_f32 v34, v34, v33
    s_nop 0
    v_mfma_f32_16x16x32_bf16 v[24:27], v[52:55], v[120:123], v[24:27]
    v_mul_f32_dpp v36, v34, v16 row_newbcast:0 row_mask:0xf bank_mask:0xf
    v_fmac_f32_dpp v36, v34, v17 row_newbcast:1 row_mask:0xf bank_mask:0xf
    v_mfma_f32_16x16x32_bf16 v[28:31], v[44:47], v[92:95], 0
    v_fmac_f32_dpp v36, v34, v18 row_newbcast:2 row_mask:0xf bank_mask:0xf
    v_fmac_f32_dpp v36, v34, v19 row_newbcast:3 row_mask:0xf bank_mask:0xf
    v_mfma_f32_16x16x32_bf16 v[28:31], v[48:51], v[108:111], v[28:31]
    v_mul_f32_dpp v37, v34, v20 row_newbcast:0 row_mask:0xf bank_mask:0xf
    v_fmac_f32_dpp v37, v34, v21 row_newbcast:1 row_mask:0xf bank_mask:0xf
    v_mfma_f32_16x16x32_bf16 v[28:31], v[52:55], v[124:127], v[28:31]
    v_fmac_f32_dpp v37, v34, v22 row_newbcast:2 row_mask:0xf bank_mask:0xf
    v_fmac_f32_dpp v37, v34, v23 row_newbcast:3 row_mask:0xf bank_mask:0xf
    v_cmp_u_f32 vcc, v36, v57
    v_mul_f32_dpp v38, v34, v24 row_newbcast:0 row_mask:0xf bank_mask:0xf
    v_fmac_f32_dpp v38, v34, v25 row_newbcast:1 row_mask:0xf bank_mask:0xf
    v_fmac_f32_dpp v38, v34, v26 row_newbcast:2 row_mask:0xf bank_mask:0xf
    v_fmac_f32_dpp v38, v34, v27 row_newbcast:3 row_mask:0xf bank_mask:0xf
    s_mov_b32 exec_hi, 0
    v_mul_f32_dpp v39, v34, v28 row_newbcast:0 row_mask:0xf bank_mask:0xf
    v_fmac_f32_dpp v39, v34, v29 row_newbcast:1 row_mask:0xf bank_mask:0xf
    v_fmac_f32_dpp v39, v34, v30 row_newbcast:2 row_mask:0xf bank_mask:0xf
    v_fmac_f32_dpp v39, v34, v31 row_newbcast:3 row_mask:0xf bank_mask:0xf
    s_cbranch_vccz WOOK
    s_mov_b64 exec, -1
WOAG:
    s_add_u32 s51, s51, 1
    s_cmp_lt_u32 s51, 0x8000
    s_cbranch_scc1 WOP
    s_mov_b32 exec_hi, 0
WOOK:
    ds_write_b128 v15, v[36:39]
    s_mov_b64 exec, -1
    s_cmp_lg_u32 s44, 3
    s_waitcnt vmcnt(0) lgkmcnt(0)
    s_barrier
    s_cbranch_scc1 WOX
    ds_read2st64_b32 v[16:17], v64 offset0:0 offset1:1
    ds_read2st64_b32 v[18:19], v64 offset0:2 offset1:3
    ds_read2st64_b32 v[20:21], v64 offset0:4 offset1:5
    ds_read2st64_b32 v[22:23], v64 offset0:6 offset1:7
    s_waitcnt lgkmcnt(2)
    v_pk_add_f32 v[16:17], v[16:17], v[18:19]
    v_add_f32 v16, v16, v57
    s_waitcnt lgkmcnt(0)
    v_pk_add_f32 v[20:21], v[20:21], v[22:23]
    v_pk_add_f32 v[16:17], v[16:17], v[20:21]
    v_add_f32 v16, v16, v17
    buffer_store_dword v16, v14, s[16:19], s49 offen sc1
WOX:
    s_cmp_ge_u32 s46, 30
    s_cbranch_scc1 STX
    v_and_b32 v61, 3, v1
    v_lshlrev_b32 v61, 3, v61
    v_bfe_u32 v60, v1, 2, 2
    v_lshl_add_u32 v61, v60, 7, v61
    v_lshrrev_b32 v60, 4, v1
    v_lshl_add_u32 v61, v60, 10, v61
    v_bfe_u32 v60, v1, 3, 2
    v_lshl_add_u32 v61, v60, 5, v61
    s_lshl_b32 s52, s44, 5
    v_xor_b32 v61, s52, v61
    ds_read_b64_tr_b16 v[64:65], v61 offset:49152
    ds_read_b64_tr_b16 v[66:67], v61 offset:49664
    ds_read_b64_tr_b16 v[68:69], v61 offset:53248
    ds_read_b64_tr_b16 v[70:71], v61 offset:53760
    ds_read_b64_tr_b16 v[72:73], v61 offset:57344
    ds_read_b64_tr_b16 v[74:75], v61 offset:57856
    ds_read_b64_tr_b16 v[76:77], v61 offset:61440
    ds_read_b64_tr_b16 v[78:79], v61 offset:61952
    s_mul_i32 s52, s59, 2560
    s_mul_i32 s54, s44, 640
    s_add_u32 s52, s52, s54
    s_mul_i32 s54, s58, 320
    s_add_u32 s52, s52, s54
    s_lshl_b32 s54, s3, 6
    s_add_u32 s52, s52, s54
    v_lshl_add_u32 v14, v1, 2, s52
    s_lshl_b32 s52, s4, 3
    s_add_u32 s52, s52, 20224
    v_mov_b32 v15, s52
    v_and_b32 v57, 31, v1
    v_lshl_add_u32 v57, s44, 5, v57
    s_lshl_b32 s52, s4, 9
    s_add_u32 s52, s52, 84480
    s_cmp_lt_u32 s4, 5
    s_cselect_b32 s52, s52, 1879048192
    s_cmp_eq_u32 s45, 0
    s_cselect_b32 s52, s52, 1879048192
    v_lshl_add_u32 v56, v57, 2, s52
    v_lshlrev_b32 v57, 1, v57
    v_add_u32 v57, 96512, v57
    v_lshrrev_b32 v58, 5, v1
    v_lshlrev_b32 v58, 10, v58
    v_and_b32 v59, 31, v1
    v_lshl_add_u32 v58, v59, 2, v58
    s_lshl_b32 s52, s3, 13
    s_lshl_b32 s54, s44, 11
    s_add_u32 s52, s52, s54
    v_add_u32 v58, s52, v58
    v_lshrrev_b32 v52, 4, v0
    v_min_u32 v52, 11, v52
    v_mul_u32_u24 v52, 640, v52
    v_and_b32 v53, 15, v0
    v_lshl_add_u32 v52, v53, 2, v52
    s_cmp_eq_u32 s49, 0
    s_cbranch_scc1 HOOKD
    s_cmp_lt_u32 s46, 20
    s_cbranch_scc1 GFB
    s_sleep 20
GFB:
    s_sleep 9
F1S:
    v_add_u32 v14, 12288, v14
    v_add_u32 v52, 12288, v52
    s_mov_b32 s51, 0
F1P:
    buffer_load_dword v16, v58, s[16:19], s49 offen offset:0 sc1
    buffer_load_dword v17, v58, s[16:19], s49 offen offset:128 sc1
    buffer_load_dword v18, v58, s[16:19], s49 offen offset:256 sc1
    buffer_load_dword v19, v58, s[16:19], s49 offen offset:384 sc1
    buffer_load_dword v20, v58, s[16:19], s49 offen offset:512 sc1
    buffer_load_dword v21, v58, s[16:19], s49 offen offset:640 sc1
    buffer_load_dword v22, v58, s[16:19], s49 offen offset:768 sc1
    buffer_load_dword v23, v58, s[16:19], s49 offen offset:896 sc1
    s_waitcnt vmcnt(0)
    v_pk_add_f32 v[16:17], v[16:17], v[18:19]
    v_pk_add_f32 v[20:21], v[20:21], v[22:23]
    v_pk_add_f32 v[16:17], v[16:17], v[20:21]
    v_add_f32 v16, v16, v17
    v_mov_b32 v17, v16
    s_nop 1
    v_permlane32_swap_b32 v16, v17
    v_add_f32 v16, v16, v17
    v_cmp_u_f32 vcc, v16, v16
    s_cbranch_vccz F1OK
    s_add_u32 s51, s51, 1
    s_sleep 1
    s_cmp_lt_u32 s51, 0x8000
    s_cbranch_scc1 F1P
F1OK:
    v_cvt_pk_bf16_f32 v16, v16, v16
    ds_write_b16 v57, v16
    v_and_b32 v16, 0xffff0000, v16
    s_mov_b32 exec_hi, 0
    s_cmp_eq_u32 s50, 0
    s_cbranch_scc1 SLOW4
    buffer_store_dword v16, v56, s[16:19], s49 offen
PUBD4:
    s_mov_b64 exec, -1
    s_waitcnt lgkmcnt(0)
    s_barrier
    ds_read_b128 v[20:23], v2 offset:256
    ds_read_b128 v[24:27], v2 offset:320
    ds_read_b128 v[28:31], v2 offset:384
    ds_read_b128 v[32:35], v2 offset:448
    s_waitcnt lgkmcnt(3)
    v_mfma_f32_16x16x32_bf16 v[40:43], v[20:23], v[64:67], 0
    v_mfma_f32_16x16x32_bf16 v[44:47], v[20:23], v[20:23], 0
    s_waitcnt lgkmcnt(2)
    v_mfma_f32_16x16x32_bf16 v[40:43], v[24:27], v[68:71], v[40:43]
    v_mfma_f32_16x16x32_bf16 v[44:47], v[24:27], v[24:27], v[44:47]
    s_waitcnt lgkmcnt(1)
    v_mfma_f32_16x16x32_bf16 v[40:43], v[28:31], v[72:75], v[40:43]
    v_mfma_f32_16x16x32_bf16 v[44:47], v[28:31], v[28:31], v[44:47]
    s_waitcnt lgkmcnt(0)
    v_mfma_f32_16x16x32_bf16 v[40:43], v[32:35], v[76:79], v[40:43]
    v_mfma_f32_16x16x32_bf16 v[44:47], v[32:35], v[32:35], v[44:47]
    s_mov_b64 exec, 0xffff
    s_nop 3
    s_cmp_eq_u32 s50, 0
    s_cbranch_scc1 SLOW5
    buffer_store_dword v40, v14, s[16:19], s62 offen
    s_mov_b64 exec, 1
    buffer_store_dwordx2 v[44:45], v15, s[16:19], s62 offen
PUBD5:
    s_mov_b64 exec, -1
    s_cmp_lt_u32 s46, 20
    s_cbranch_scc1 STX
    v_and_b32 v58, 7, v1
    v_cmp_gt_u32 vcc, 5, v58
    v_lshlrev_b32 v58, 3, v58
    v_add_u32 v58, 20224, v58
    v_mov_b32 v59, 1879048192
    v_cndmask_b32 v58, v59, v58, vcc
    s_lshl_b32 s52, s57, 8
    s_lshl_b32 s54, s44, 6
    s_add_u32 s52, s52, s54
    s_add_u32 s52, s52, 84480
    s_cmp_eq_u32 s45, 0
    s_cselect_b32 s52, s52, 1879048192
    v_lshl_add_u32 v59, v53, 2, s52
    s_cmp_eq_u32 s44, 3
    s_cselect_b32 s53, 1879048192, s62
    s_nop 15
    s_nop 7
    buffer_load_dword v76, v59, s[16:19], s49 offen sc1
    buffer_load_dwordx2 v[74:75], v58, s[16:19], s62 offen sc1
    buffer_load_dword v64, v52, s[16:19], s53 offen offset:0 sc1
    buffer_load_dword v65, v52, s[16:19], s53 offen offset:320 sc1
    buffer_load_dword v66, v52, s[16:19], s53 offen offset:64 sc1
    buffer_load_dword v67, v52, s[16:19], s53 offen offset:384 sc1
    buffer_load_dword v68, v52, s[16:19], s53 offen offset:128 sc1
    buffer_load_dword v69, v52, s[16:19], s53 offen offset:448 sc1
    buffer_load_dword v70, v52, s[16:19], s53 offen offset:192 sc1
    buffer_load_dword v71, v52, s[16:19], s53 offen offset:512 sc1
    buffer_load_dword v72, v52, s[16:19], s53 offen offset:256 sc1
    buffer_load_dword v73, v52, s[16:19], s53 offen offset:576 sc1
    s_lshl_b32 s52, s57, 12
    s_lshl_b32 s54, s44, 10
    s_add_u32 s52, s52, s54
    s_lshl_b32 s54, s45, 7
    s_add_u32 s52, s52, s54
    s_add_u32 s52, s52, 40960
    v_lshl_add_u32 v14, v1, 2, s52
    v_lshlrev_b32 v57, 1, v0
    v_add_u32 v57, 96768, v57
    v_mov_b32 v60, 0x3727c5ac
    s_mov_b32 s51, 0
    s_nop 15
    s_nop 15
    s_nop 7
W2P:
    buffer_load_dword v76, v59, s[16:19], s49 offen sc1
    buffer_load_dwordx2 v[74:75], v58, s[16:19], s62 offen sc1
    buffer_load_dword v64, v52, s[16:19], s53 offen offset:0 sc1
    buffer_load_dword v65, v52, s[16:19], s53 offen offset:320 sc1
    buffer_load_dword v66, v52, s[16:19], s53 offen offset:64 sc1
    buffer_load_dword v67, v52, s[16:19], s53 offen offset:384 sc1
    buffer_load_dword v68, v52, s[16:19], s53 offen offset:128 sc1
    buffer_load_dword v69, v52, s[16:19], s53 offen offset:448 sc1
    buffer_load_dword v70, v52, s[16:19], s53 offen offset:192 sc1
    buffer_load_dword v71, v52, s[16:19], s53 offen offset:512 sc1
    buffer_load_dword v72, v52, s[16:19], s53 offen offset:256 sc1
    buffer_load_dword v73, v52, s[16:19], s53 offen offset:576 sc1
    s_waitcnt vmcnt(12)
    v_add_f32_dpp v36, v74, v74 quad_perm:[1,0,3,2] row_mask:0xf bank_mask:0xf
    v_add_f32_dpp v37, v75, v75 quad_perm:[1,0,3,2] row_mask:0xf bank_mask:0xf
    v_pk_add_f32 v[16:17], v[64:65], v[66:67]
    v_add_f32_dpp v36, v36, v36 quad_perm:[2,3,0,1] row_mask:0xf bank_mask:0xf
    v_add_f32_dpp v37, v37, v37 quad_perm:[2,3,0,1] row_mask:0xf bank_mask:0xf
    v_pk_add_f32 v[20:21], v[68:69], v[70:71]
    v_add_f32_dpp v36, v36, v36 row_half_mirror row_mask:0xf bank_mask:0xf
    v_add_f32_dpp v37, v37, v37 row_half_mirror row_mask:0xf bank_mask:0xf
    v_pk_add_f32 v[16:17], v[16:17], v[72:73]
    v_mul_f32 v37, 0x3acccccd, v37
    v_fmamk_f32 v36, v36, 0x3acccccd, v60
    v_fma_f32 v36, -v37, v37, v36
    v_rsq_f32 v36, v36
    v_pk_add_f32 v[16:17], v[16:17], v[20:21]
    v_pk_fma_f32 v[16:17], v[36:37], v[126:127], v[16:17] op_sel:[1,0,0] op_sel_hi:[1,1,1] neg_lo:[1,0,0] neg_hi:[1,0,0]
    v_pk_mul_f32 v[16:17], v[16:17], v[36:37] op_sel_hi:[1,0]
    v_mul_f32 v18, 0xbfb8aa3b, v16
    v_exp_f32 v18, v18
    v_mul_f32 v16, v16, v17
    v_add_f32 v18, 1.0, v18
    v_rcp_f32 v18, v18
    v_cmp_u_f32 vcc, v16, v76
    v_mul_f32 v16, v16, v18
    s_cbranch_vccz W2OK
    s_add_u32 s51, s51, 1
    s_cmp_lt_u32 s51, 0x8000
    s_cbranch_scc1 W2P
W2OK:
    v_cvt_pk_bf16_f32 v16, v16, v16
    ds_write_b16 v57, v16
    s_waitcnt lgkmcnt(0)
    s_barrier
    ds_read_b128 v[16:19], v2 offset:512
    ds_read_b128 v[20:23], v2 offset:576
    ds_read_b128 v[24:27], v2 offset:640
    ds_read_b128 v[28:31], v2 offset:704
    ds_read_b128 v[32:35], v2 offset:768
    ds_read_b128 v[36:39], v2 offset:832
    s_waitcnt lgkmcnt(5)
    v_mfma_f32_16x16x32_bf16 v[40:43], v[16:19], v[80:83], 0
    s_waitcnt lgkmcnt(4)
    v_mfma_f32_16x16x32_bf16 v[40:43], v[20:23], v[84:87], v[40:43]
    s_waitcnt lgkmcnt(3)
    v_mfma_f32_16x16x32_bf16 v[40:43], v[24:27], v[88:91], v[40:43]
    s_waitcnt lgkmcnt(2)
    v_mfma_f32_16x16x32_bf16 v[40:43], v[28:31], v[92:95], v[40:43]
    s_waitcnt lgkmcnt(1)
    v_mfma_f32_16x16x32_bf16 v[40:43], v[32:35], v[96:99], v[40:43]
    s_waitcnt lgkmcnt(0)
    v_mfma_f32_16x16x32_bf16 v[40:43], v[36:39], v[100:103], v[40:43]
    s_mov_b64 exec, 0xffff
    s_waitcnt vmcnt(0)
    s_nop 5
    v_add_f32 v40, v40, v76
    buffer_store_dword v40, v14, s[16:19], s49 offen sc1
    s_mov_b64 exec, -1
STX:
    s_cmp_lg_u32 s49, 0
    s_cbranch_scc1 LAST
    s_branch LOOP
LAST:
    s_and_b32 s52, s2, 0xc7
    s_cmp_eq_u32 s52, 0
    s_cbranch_scc1 LOOP
    s_endpgm
FINAL:
    s_cmp_eq_u32 s44, 3
    s_cbranch_scc1 FINX
    v_cvt_pk_bf16_f32 v30, v30, v30
    v_lshlrev_b32 v20, 1, v29
    s_mul_i32 s52, s48, 160
    s_mov_b32 exec_lo, s60
    s_mov_b32 exec_hi, 0
    buffer_store_short v30, v20, s[36:39], s52 offen
    s_mov_b64 exec, -1
FINX:
DONE:
    s_endpgm
HOOKA:
    s_nop 3
    s_mul_i32 s52, s44, 192
    s_add_u32 s52, s52, 98816
    v_lshl_add_u32 v14, v1, 2, s52
    v_fma_f32 v16, -v84, v17, v16
    v_mul_f32 v16, v16, v85
    ds_write_b32 v14, v16 offset:0
    v_fma_f32 v20, -v84, v21, v20
    v_mul_f32 v20, v20, v85
    ds_write_b32 v14, v20 offset:64
    v_fma_f32 v24, -v84, v25, v24
    v_mul_f32 v24, v24, v85
    ds_write_b32 v14, v24 offset:128
    s_mov_b64 exec, -1
    s_add_u32 s44, s44, 1
    s_cmp_lt_u32 s44, 4
    s_cbranch_scc1 LOOP
    s_mov_b32 s44, 3
    s_mov_b32 s100, 1
    v_lshlrev_b32 v14, 2, v1
    v_add_u32 v14, 98816, v14
    ds_read2st64_b32 v[16:17], v14 offset0:0 offset1:1
    ds_read_b32 v18, v14 offset:512
    s_lshl_b32 s52, s47, 13
    s_lshl_b32 s54, s48, 10
    s_add_u32 s52, s52, s54
    s_add_u32 s52, s52, 1114112
    s_waitcnt lgkmcnt(0)
    v_bitop3_b32 v19, v16, v17, v18 bitop3:0x96
    v_xor_b32 v19, v19, v89
    buffer_store_dwordx4 v[16:19], v88, s[16:19], s52 offen sc1
    s_branch KPART1
Q0G:
    v_lshlrev_b32 v15, 1, v1
    v_add_u32 v15, 98304, v15
    s_lshl_b32 s52, s47, 13
    s_add_u32 s52, s52, 1114112
    s_add_u32 s53, s52, 4096
    s_mov_b32 s51, 0
Q0P:
    buffer_load_dwordx4 v[16:19], v88, s[16:19], s52 offen offset:0 sc1
    buffer_load_dwordx4 v[20:23], v88, s[16:19], s52 offen offset:1024 sc1
    buffer_load_dwordx4 v[24:27], v88, s[16:19], s52 offen offset:2048 sc1
    buffer_load_dwordx4 v[28:31], v88, s[16:19], s52 offen offset:3072 sc1
    buffer_load_dwordx4 v[32:35], v88, s[16:19], s53 offen offset:0 sc1
    buffer_load_dwordx4 v[36:39], v88, s[16:19], s53 offen offset:1024 sc1
    buffer_load_dwordx4 v[40:43], v88, s[16:19], s53 offen offset:2048 sc1
    buffer_load_dwordx4 v[44:47], v88, s[16:19], s53 offen offset:3072 sc1
    v_mov_b32 v48, 0
    s_waitcnt vmcnt(0)
    v_bitop3_b32 v49, v16, v17, v18 bitop3:0x96
    v_bitop3_b32 v49, v49, v19, v89 bitop3:0x96
    v_or_b32 v48, v48, v49
    v_bitop3_b32 v49, v20, v21, v22 bitop3:0x96
    v_bitop3_b32 v49, v49, v23, v89 bitop3:0x96
    v_or_b32 v48, v48, v49
    v_bitop3_b32 v49, v24, v25, v26 bitop3:0x96
    v_bitop3_b32 v49, v49, v27, v89 bitop3:0x96
    v_or_b32 v48, v48, v49
    v_bitop3_b32 v49, v28, v29, v30 bitop3:0x96
    v_bitop3_b32 v49, v49, v31, v89 bitop3:0x96
    v_or_b32 v48, v48, v49
    v_bitop3_b32 v49, v32, v33, v34 bitop3:0x96
    v_bitop3_b32 v49, v49, v35, v89 bitop3:0x96
    v_or_b32 v48, v48, v49
    v_bitop3_b32 v49, v36, v37, v38 bitop3:0x96
    v_bitop3_b32 v49, v49, v39, v89 bitop3:0x96
    v_or_b32 v48, v48, v49
    v_bitop3_b32 v49, v40, v41, v42 bitop3:0x96
    v_bitop3_b32 v49, v49, v43, v89 bitop3:0x96
    v_or_b32 v48, v48, v49
    v_bitop3_b32 v49, v44, v45, v46 bitop3:0x96
    v_bitop3_b32 v49, v49, v47, v89 bitop3:0x96
    v_or_b32 v48, v48, v49
    v_cmp_ne_u32 vcc, 0, v48
    s_cbranch_vccz Q0OK
    s_add_u32 s51, s51, 1
    s_sleep 4
    s_cmp_lt_u32 s51, 0x8000
    s_cbranch_scc1 Q0P
Q0OK:
    v_pk_add_f32 v[16:17], v[16:17], v[20:21]
    v_add_f32 v18, v18, v22
    v_pk_add_f32 v[16:17], v[16:17], v[24:25]
    v_add_f32 v18, v18, v26
    v_pk_add_f32 v[16:17], v[16:17], v[28:29]
    v_add_f32 v18, v18, v30
    v_pk_add_f32 v[16:17], v[16:17], v[32:33]
    v_add_f32 v18, v18, v34
    v_pk_add_f32 v[16:17], v[16:17], v[36:37]
    v_add_f32 v18, v18, v38
    v_pk_add_f32 v[16:17], v[16:17], v[40:41]
    v_add_f32 v18, v18, v42
    v_pk_add_f32 v[16:17], v[16:17], v[44:45]
    v_add_f32 v18, v18, v46
    v_cvt_pk_bf16_f32 v16, v16, v17
    v_cvt_pk_bf16_f32 v18, v18, v18
    ds_write_b16 v15, v16
    ds_write_b16_d16_hi v15, v16 offset:128
    ds_write_b16 v15, v18 offset:256
    s_mov_b32 s52, 1376256
    buffer_load_dwordx4 v[24:27], v88, s[16:19], s52 offen sc1
    s_branch KPART2
HSHK:
    s_waitcnt vmcnt(60)
    s_mov_b32 s51, 0
HSP:
    v_xor_b32 v20, s5, v24
    v_xor_b32 v21, s5, v25
    v_xor_b32 v22, s5, v26
    v_xor_b32 v23, s5, v27
    v_or3_b32 v20, v20, v21, v22
    v_or_b32 v20, v20, v23
    v_cmp_lt_u32 vcc, 15, v20
    s_cbranch_vccz HSOK
    s_mov_b32 s52, 1376256
    buffer_load_dwordx4 v[24:27], v88, s[16:19], s52 offen sc1
    s_waitcnt vmcnt(0)
    s_add_u32 s51, s51, 1
    s_sleep 8
    s_cmp_lt_u32 s51, 0x8000
    s_cbranch_scc1 HSP
HSOK:
    v_cmp_ne_u32 vcc, 0, v20
    s_lshl_b32 s52, s45, 3
    s_lshr_b64 s[60:61], vcc, s52
    s_and_b32 s52, s60, 0xff
    s_cselect_b32 s50, 0, 1
    v_mov_b32 v38, 98784
    v_mov_b32 v39, s50
    ds_write_b32 v38, v39
    v_and_b32 v21, 0xffff0000, v86
    v_lshlrev_b32 v20, 16, v86
    buffer_store_dwordx2 v[20:21], v87, s[16:19], 0 offen sc1
    v_min_u32 v83, 8, v1
    v_lshlrev_b32 v83, 7, v83
    s_mul_i32 s52, s45, 28160
    s_mul_i32 s54, s46, 1152
    s_add_u32 s52, s52, s54
    s_add_u32 s52, s52, 81920
    buffer_load_dword v83, v83, s[16:19], s52 offen sc1
    s_branch ENTRY
HOOKF:
    v_mov_b32 v40, 98784
    ds_read_b32 v40, v40
    s_mov_b32 s6, 0
    s_waitcnt lgkmcnt(0)
    v_readfirstlane_b32 s50, v40
    s_cmp_eq_u32 s44, 3
    s_cbranch_scc1 VPART2
QK0:
    s_waitcnt vmcnt(48)
    s_branch QK
HOOKC:
    s_cmp_eq_u32 s44, 3
    s_cbranch_scc1 EXB
    s_cmp_ge_u32 s46, 30
    s_cbranch_scc1 EXB
    v_lshrrev_b32 v46, 3, v1
    v_and_b32 v45, 7, v1
    v_and_b32 v47, 2, v46
    v_xor_b32 v45, v45, v47
    s_and_b32 s52, s44, 1
    s_lshl_b32 s52, s52, 2
    v_xor_b32 v45, s52, v45
    v_mul_u32_u24 v48, 3072, v46
    v_lshl_add_u32 v48, v45, 4, v48
    v_mul_u32_u24 v47, 1280, v46
    v_lshl_add_u32 v47, v45, 4, v47
    s_mul_i32 s52, s45, 768
    s_mul_i32 s54, s56, 384
    s_add_u32 s52, s52, s54
    s_mul_i32 s53, s45, 192
    s_cmp_ge_u32 s46, 20
    s_cselect_b32 s52, s53, s52
    s_mov_b32 s51, 49152
    s_cselect_b32 s51, 24576, s51
    s_mul_i32 s52, s52, 1280
    s_mul_i32 s54, s44, 10240
    s_add_u32 s52, s52, s54
    s_lshl_b32 s54, s57, 7
    s_add_u32 s52, s52, s54
    s_lshl_b32 s53, s44, 10
WOL:
    s_mov_b32 m0, s53
    s_add_u32 s53, s53, 3072
    buffer_load_dwordx4 v47, s[24:27], s52 offen nt lds
    v_xor_b32 v47, 64, v47
    s_add_u32 s52, s52, 30720
    s_cmp_lt_u32 s53, s51
    s_cbranch_scc1 WOL
    s_mul_i32 s52, s3, 393216
    s_mul_i32 s54, s44, 24576
    s_add_u32 s52, s52, s54
    s_mul_i32 s54, s45, 384
    s_add_u32 s52, s52, s54
    s_lshl_b32 s54, s59, 7
    s_add_u32 s52, s52, s54
    s_lshl_b32 s53, s44, 10
    s_add_u32 s53, s53, 49152
W13L:
    s_mov_b32 m0, s53
    s_add_u32 s53, s53, 3072
    buffer_load_dwordx4 v48, s[28:31], s52 offen nt lds
    v_xor_b32 v48, 64, v48
    s_add_u32 s52, s52, 73728
    s_cmp_lt_u32 s53, 65536
    s_cbranch_scc1 W13L
    s_branch EXB
HOOKG:
    v_and_b32 v71, 3, v1
    v_lshlrev_b32 v71, 3, v71
    v_bfe_u32 v72, v1, 2, 2
    v_lshl_add_u32 v71, v72, 7, v71
    v_lshrrev_b32 v72, 4, v1
    v_lshl_add_u32 v71, v72, 10, v71
    v_bfe_u32 v72, v1, 3, 2
    v_lshl_add_u32 v71, v72, 5, v71
    s_mul_i32 s52, s44, 12288
    v_add_u32 v71, s52, v71
    v_xor_b32 v72, 32, v71
    v_xor_b32 v73, 64, v71
    v_xor_b32 v74, 96, v71
    s_waitcnt vmcnt(1)
    s_barrier
    s_branch WO0
HOOKG2:
    ds_read_b64_tr_b16 v[80:81], v71 offset:0
    ds_read_b64_tr_b16 v[82:83], v71 offset:512
    ds_read_b64_tr_b16 v[96:97], v71 offset:4096
    ds_read_b64_tr_b16 v[98:99], v71 offset:4608
    ds_read_b64_tr_b16 v[112:113], v71 offset:8192
    ds_read_b64_tr_b16 v[114:115], v71 offset:8704
    ds_read_b64_tr_b16 v[84:85], v72 offset:0
    ds_read_b64_tr_b16 v[86:87], v72 offset:512
    ds_read_b64_tr_b16 v[100:101], v72 offset:4096
    ds_read_b64_tr_b16 v[102:103], v72 offset:4608
    ds_read_b64_tr_b16 v[116:117], v72 offset:8192
    ds_read_b64_tr_b16 v[118:119], v72 offset:8704
    ds_read_b64_tr_b16 v[88:89], v73 offset:0
    ds_read_b64_tr_b16 v[90:91], v73 offset:512
    ds_read_b64_tr_b16 v[104:105], v73 offset:4096
    ds_read_b64_tr_b16 v[106:107], v73 offset:4608
    ds_read_b64_tr_b16 v[120:121], v73 offset:8192
    ds_read_b64_tr_b16 v[122:123], v73 offset:8704
    ds_read_b64_tr_b16 v[92:93], v74 offset:0
    ds_read_b64_tr_b16 v[94:95], v74 offset:512
    ds_read_b64_tr_b16 v[108:109], v74 offset:4096
    ds_read_b64_tr_b16 v[110:111], v74 offset:4608
    ds_read_b64_tr_b16 v[124:125], v74 offset:8192
    ds_read_b64_tr_b16 v[126:127], v74 offset:8704
    s_branch WO1
HOOKG3:
    s_cmp_lg_u32 s49, 0
    s_cbranch_scc1 WOX
    v_and_b32 v71, 3, v1
    v_lshlrev_b32 v71, 3, v71
    v_bfe_u32 v72, v1, 2, 2
    v_lshl_add_u32 v71, v72, 7, v71
    v_lshrrev_b32 v72, 4, v1
    v_lshl_add_u32 v71, v72, 10, v71
    v_bfe_u32 v72, v1, 3, 2
    v_lshl_add_u32 v71, v72, 5, v71
    s_lshl_b32 s52, s44, 5
    v_xor_b32 v71, s52, v71
    s_waitcnt vmcnt(1)
    s_barrier
    ds_read_b64_tr_b16 v[80:81], v71 offset:0
    ds_read_b64_tr_b16 v[82:83], v71 offset:512
    ds_read_b64_tr_b16 v[84:85], v71 offset:4096
    ds_read_b64_tr_b16 v[86:87], v71 offset:4608
    ds_read_b64_tr_b16 v[88:89], v71 offset:8192
    ds_read_b64_tr_b16 v[90:91], v71 offset:8704
    ds_read_b64_tr_b16 v[92:93], v71 offset:12288
    ds_read_b64_tr_b16 v[94:95], v71 offset:12800
    ds_read_b64_tr_b16 v[96:97], v71 offset:16384
    ds_read_b64_tr_b16 v[98:99], v71 offset:16896
    ds_read_b64_tr_b16 v[100:101], v71 offset:20480
    ds_read_b64_tr_b16 v[102:103], v71 offset:20992
    s_branch WOX
HOOKD:
    v_mov_b32 v44, -1
    v_mov_b32 v45, -1
    v_mov_b32 v46, -1
    v_mul_u32_u24 v47, 12, v1
    s_mul_i32 s52, s2, 3072
    s_mul_i32 s54, s44, 768
    s_add_u32 s52, s52, s54
    s_add_u32 s52, s52, 327680
    buffer_store_dwordx3 v[44:46], v47, s[16:19], s52 offen sc1
    ds_read_b128 v[20:23], v2 offset:256
    ds_read_b128 v[24:27], v2 offset:320
    ds_read_b128 v[28:31], v2 offset:384
    ds_read_b128 v[32:35], v2 offset:448
    s_waitcnt lgkmcnt(0)
    v_mfma_f32_16x16x32_bf16 v[40:43], v[20:23], v[64:67], 0
    v_mfma_f32_16x16x32_bf16 v[40:43], v[24:27], v[68:71], v[40:43]
    v_mfma_f32_16x16x32_bf16 v[40:43], v[28:31], v[72:75], v[40:43]
    v_mfma_f32_16x16x32_bf16 v[40:43], v[32:35], v[76:79], v[40:43]
    s_add_u32 s53, s62, 20480
    s_mov_b64 exec, 0xffff
    s_nop 5
    s_cmp_eq_u32 s50, 0
    s_cbranch_scc1 SLOW3
    buffer_store_dword v41, v14, s[16:19], s53 offen
PUBD3:
    s_mov_b64 exec, -1
    s_cmp_lt_u32 s46, 20
    s_cbranch_scc1 F1S
    s_mov_b32 s51, 0
GCP:
    buffer_load_dword v16, v52, s[16:19], s53 offen offset:0 sc1
    buffer_load_dword v17, v52, s[16:19], s53 offen offset:64 sc1
    buffer_load_dword v18, v52, s[16:19], s53 offen offset:128 sc1
    buffer_load_dword v19, v52, s[16:19], s53 offen offset:192 sc1
    buffer_load_dword v20, v52, s[16:19], s53 offen offset:256 sc1
    buffer_load_dword v21, v52, s[16:19], s53 offen offset:320 sc1
    buffer_load_dword v22, v52, s[16:19], s53 offen offset:384 sc1
    buffer_load_dword v23, v52, s[16:19], s53 offen offset:448 sc1
    buffer_load_dword v24, v52, s[16:19], s53 offen offset:512 sc1
    buffer_load_dword v25, v52, s[16:19], s53 offen offset:576 sc1
    s_waitcnt vmcnt(0)
    v_add_f32 v16, v16, v17
    v_add_f32 v18, v18, v19
    v_add_f32 v16, v16, v20
    v_add_f32 v126, v16, v18
    v_add_f32 v21, v21, v22
    v_add_f32 v23, v23, v24
    v_add_f32 v21, v21, v25
    v_add_f32 v127, v21, v23
    v_cmp_u_f32 vcc, v126, v127
    s_cbranch_vccz GCOK
    s_add_u32 s51, s51, 1
    s_sleep 1
    s_cmp_lt_u32 s51, 0x8000
    s_cbranch_scc1 GCP
GCOK:
    s_branch F1S
SLOW0:
    buffer_store_dword v30, v28, s[16:19], s49 offen sc1
    s_branch PUBD0
SLOW1:
    buffer_store_dwordx2 v[16:17], v14, s[16:19], s62 offen offset:0 sc1
    buffer_store_dwordx2 v[20:21], v14, s[16:19], s62 offen offset:1024 sc1
    buffer_store_dwordx2 v[24:25], v14, s[16:19], s62 offen offset:2048 sc1
    s_mov_b64 exec, 1
    buffer_store_dwordx2 v[28:29], v15, s[16:19], s62 offen sc1
    s_branch PUBD1
SLOW2:
    buffer_store_dword v24, v14, s[16:19], s62 offen sc1
    s_branch PUBD2
SLOW3:
    buffer_store_dword v41, v14, s[16:19], s53 offen sc1
    s_branch PUBD3
SLOW4:
    buffer_store_dword v16, v56, s[16:19], s49 offen sc1
    s_branch PUBD4
SLOW5:
    buffer_store_dword v40, v14, s[16:19], s62 offen sc1
    s_mov_b64 exec, 1
    buffer_store_dwordx2 v[44:45], v15, s[16:19], s62 offen sc1
    s_branch PUBD5
CODEEND:
    s_endpgm
.section .rodata,"a"
.p2align 6
.amdhsa_kernel interleave_layers__sliding_block_cached__glu_gated_swiglu__decode_kernel
  .amdhsa_next_free_vgpr 512
  .amdhsa_next_free_sgpr 102
  .amdhsa_accum_offset 256
  .amdhsa_group_segment_fixed_size 0
  .amdhsa_kernarg_size 96
  .amdhsa_user_sgpr_count 2
  .amdhsa_user_sgpr_kernarg_segment_ptr 1
  .amdhsa_system_sgpr_workgroup_id_x 1
.end_amdhsa_kernel
```

```asm
; @launch grid=(256,1,1) block=(256,1,1) lds=108288
.amdgcn_target "amdgcn-amd-amdhsa--gfx950"
.text
.globl interleave_layers__sliding_block_cached__glu_gated_swiglu__decode_kernel
.p2align 8
.type interleave_layers__sliding_block_cached__glu_gated_swiglu__decode_kernel,@function
interleave_layers__sliding_block_cached__glu_gated_swiglu__decode_kernel:
    s_cmp_ge_u32 s2, 256
    s_cbranch_scc1 DONE
    s_load_dwordx16 s[64:79], s[0:1], 0
    s_load_dwordx8 s[80:87], s[0:1], 64
    s_memrealtime s[98:99]
    s_getpc_b64 s[60:61]
PCREF:
    v_lshlrev_b32 v14, 7, v0
    v_cmp_gt_u32 vcc, CODEEND-PCREF, v14
    v_mov_b32 v15, s61
    s_and_saveexec_b64 s[88:89], vcc
    s_cbranch_execz NOPF
    v_add_co_u32 v14, vcc, s60, v14
    s_nop 1
    v_addc_co_u32 v15, vcc, 0, v15, vcc
    global_load_dword v79, v[14:15], off
NOPF:
    s_mov_b64 exec, s[88:89]
    v_and_b32 v1, 63, v0
    v_lshrrev_b32 v13, 6, v0
    s_and_b32 s45, s2, 7
    v_readfirstlane_b32 s44, v13
    s_lshr_b32 s46, s2, 3
    s_lshr_b32 s7, s46, 3
    s_lshl_b32 s52, s45, 2
    s_add_u32 s47, s7, s52
    s_and_b32 s48, s46, 7
    v_lshrrev_b32 v19, 4, v1
    v_bfe_u32 v21, v1, 1, 3
    v_and_b32 v20, 1, v1
    v_mul_u32_u24 v80, 384, v21
    v_lshl_add_u32 v80, v20, 4, v80
    v_lshl_add_u32 v80, v19, 5, v80
    s_mul_i32 s52, s48, 3
    s_lshl_b32 s54, s44, 0
    s_add_u32 s52, s52, s54
    s_add_u32 s53, s48, 384
    s_cmp_eq_u32 s44, 3
    s_cselect_b32 s52, s53, s52
    s_cselect_b32 s97, 8, 24
    s_mulk_i32 s97, 3072
    s_mul_i32 s55, s47, 12582912
    s_mul_i32 s54, s52, 3072
    s_add_u32 s55, s55, s54
    s_add_u32 s55, s55, 11010048
    s_mov_b32 s96, s55
    s_waitcnt lgkmcnt(0)
    s_mov_b32 s8, s66
    s_and_b32 s9, s67, 0xffff
    s_mov_b32 s10, 402653184
    s_mov_b32 s11, 0x20000
    s_mov_b32 s6, 1
    s_mov_b32 s100, 0
    s_cmp_eq_u32 s44, 3
    s_cbranch_scc1 SETUP
KPART1:
    buffer_load_dwordx4 a[0:3], v80, s[8:11], s96 offen offset:0 nt
    buffer_load_dwordx4 a[8:11], v80, s[8:11], s96 offen offset:128 nt
    buffer_load_dwordx4 a[16:19], v80, s[8:11], s96 offen offset:256 nt
    s_add_u32 s96, s96, s97
    buffer_load_dwordx4 a[4:7], v80, s[8:11], s96 offen offset:0 nt
    buffer_load_dwordx4 a[12:15], v80, s[8:11], s96 offen offset:128 nt
    buffer_load_dwordx4 a[20:23], v80, s[8:11], s96 offen offset:256 nt
    s_add_u32 s96, s96, s97
    buffer_load_dwordx4 a[24:27], v80, s[8:11], s96 offen offset:0 nt
    buffer_load_dwordx4 a[32:35], v80, s[8:11], s96 offen offset:128 nt
    buffer_load_dwordx4 a[40:43], v80, s[8:11], s96 offen offset:256 nt
    s_add_u32 s96, s96, s97
    s_cmp_eq_u32 s100, 1
    s_cbranch_scc1 Q0G
SETUP:
    s_mov_b32 s16, s86
    s_and_b32 s17, s87, 0xffff
    s_mov_b32 s18, 1610612736
    s_mov_b32 s19, 0x20000
    s_mov_b32 s12, s68
    s_and_b32 s13, s69, 0xffff
    s_mov_b32 s14, 402653184
    s_mov_b32 s15, 0x20000
    s_mov_b32 s20, s70
    s_and_b32 s21, s71, 0xffff
    s_mov_b32 s22, 7864320
    s_mov_b32 s23, 0x20000
    s_mov_b32 s32, s64
    s_and_b32 s33, s65, 0xffff
    s_mov_b32 s34, 1280
    s_mov_b32 s35, 0x20000
    s_mov_b32 s36, s82
    s_and_b32 s37, s83, 0xffff
    s_mov_b32 s38, 1280
    s_mov_b32 s39, 0x20000
    s_mov_b32 s40, s84
    s_and_b32 s41, s85, 0xffff
    s_mov_b32 s42, 256
    s_mov_b32 s43, 0x20000
    v_mov_b32 v87, 1879048192
    v_mov_b32 v88, 1879048192
    s_cmp_lg_u32 s44, 3
    s_cbranch_scc1 SETUP2
    v_mov_b32 v32, -1
    v_mov_b32 v33, -1
    v_mov_b32 v34, -1
    v_mov_b32 v35, -1
    s_cmp_lg_u32 s2, 0
    s_cbranch_scc1 NONW
    s_or_b32 s98, s98, 0x10
    s_and_b32 s101, s98, 0xfffffff0
    v_mov_b32 v24, s101
    v_mov_b32 v25, 0
    s_mov_b64 exec, 1
    buffer_store_dword v24, v25, s[40:43], 0 offen sc1
    s_mov_b64 exec, -1
NONW:
    v_lshlrev_b32 v24, 4, v1
    v_lshlrev_b32 v27, 2, v1
    s_mul_i32 s52, s2, 1280
    buffer_store_dwordx4 v[32:35], v24, s[16:19], s52 offen sc1
    buffer_store_dword v32, v27, s[16:19], s52 offen offset:1024 sc1
    v_mov_b32 v26, 1879048192
    v_mov_b32 v88, v24
    v_cmp_gt_u32 vcc, 40, v1
    v_lshlrev_b32 v27, 2, v1
    buffer_load_dwordx4 v[44:47], v24, s[32:35], 0 offen
    buffer_load_dword v48, v27, s[32:35], 0 offen offset:1024
    v_cndmask_b32 v28, v26, v27, vcc
    s_mul_i32 s52, s48, 160
    buffer_load_dword v86, v28, s[32:35], s52 offen
    s_mul_i32 s52, s48, 320
    s_add_u32 s52, s52, 81920
    s_and_b32 s53, s2, 0xc7
    s_cmp_eq_u32 s53, 0
    s_cselect_b32 s52, s52, 1879048192
    v_lshl_add_u32 v87, v1, 3, s52
    v_cndmask_b32 v87, v26, v87, vcc
    v_add_u32 v24, 0, v1
    v_mul_u32_u24 v36, 171, v24
    v_lshrrev_b32 v36, 12, v36
    v_mul_u32_u24 v37, 24, v36
    v_sub_u32 v37, v24, v37
    v_and_b32 v24, 2, v36
    v_xor_b32 v37, v37, v24
    v_mul_u32_u24 v36, 12288, v36
    v_lshl_add_u32 v38, v37, 4, v36
    v_add_u32 v24, 64, v1
    v_mul_u32_u24 v36, 171, v24
    v_lshrrev_b32 v36, 12, v36
    v_mul_u32_u24 v37, 24, v36
    v_sub_u32 v37, v24, v37
    v_and_b32 v24, 2, v36
    v_xor_b32 v37, v37, v24
    v_mul_u32_u24 v36, 12288, v36
    v_lshl_add_u32 v39, v37, 4, v36
    v_add_u32 v24, 128, v1
    v_mul_u32_u24 v36, 171, v24
    v_lshrrev_b32 v36, 12, v36
    v_mul_u32_u24 v37, 24, v36
    v_sub_u32 v37, v24, v37
    v_and_b32 v24, 2, v36
    v_xor_b32 v37, v37, v24
    v_mul_u32_u24 v36, 12288, v36
    v_lshl_add_u32 v40, v37, 4, v36
    s_mul_i32 s52, s48, 983040
    s_mul_i32 s54, s47, 384
    s_add_u32 s52, s52, s54
    s_mov_b32 s53, 65536
WQL:
    s_add_u32 m0, s53, 0
    s_nop 0
    buffer_load_dwordx4 v38, s[20:23], s52 offen nt lds
    v_xor_b32 v38, 64, v38
    s_add_u32 m0, s53, 1024
    s_nop 0
    buffer_load_dwordx4 v39, s[20:23], s52 offen nt lds
    v_xor_b32 v39, 64, v39
    s_add_u32 m0, s53, 2048
    s_nop 0
    buffer_load_dwordx4 v40, s[20:23], s52 offen nt lds
    v_xor_b32 v40, 64, v40
    s_add_u32 s52, s52, 98304
    s_add_u32 s53, s53, 3072
    s_cmp_lt_u32 s53, 96256
    s_cbranch_scc1 WQL
    v_mov_b32 v37, 0
    buffer_load_dword v89, v37, s[40:43], 0 offen sc1
    s_barrier
    s_waitcnt vmcnt(31)
    v_mov_b32 v36, 0x3f803f80
    v_mov_b32 v37, v36
    v_cndmask_b32 v36, 0, v36, vcc
    v_add_u32 v27, 96256, v27
    ds_write_b32 v27, v36 offset:1024
    ds_write_b32 v27, v37 offset:1280
    ds_write_b32 v27, v86
    v_mov_b64 v[36:37], 0
    ds_write_b32 v27, v36 offset:10752
    ds_write_b32 v27, v36 offset:11008
    v_mov_b32 v38, 0x3f803f80
    v_dot2_f32_bf16 v36, v44, v44, v36
    v_dot2_f32_bf16 v37, v44, v38, v37
    v_dot2_f32_bf16 v36, v45, v45, v36
    v_dot2_f32_bf16 v37, v45, v38, v37
    v_dot2_f32_bf16 v36, v46, v46, v36
    v_dot2_f32_bf16 v37, v46, v38, v37
    v_dot2_f32_bf16 v36, v47, v47, v36
    v_dot2_f32_bf16 v37, v47, v38, v37
    v_dot2_f32_bf16 v36, v48, v48, v36
    v_dot2_f32_bf16 v37, v48, v38, v37
    s_nop 2
    v_add_f32_dpp v36, v36, v36 quad_perm:[1,0,3,2] row_mask:0xf bank_mask:0xf
    v_add_f32_dpp v37, v37, v37 quad_perm:[1,0,3,2] row_mask:0xf bank_mask:0xf
    s_nop 0
    v_add_f32_dpp v36, v36, v36 quad_perm:[2,3,0,1] row_mask:0xf bank_mask:0xf
    v_add_f32_dpp v37, v37, v37 quad_perm:[2,3,0,1] row_mask:0xf bank_mask:0xf
    s_nop 0
    v_add_f32_dpp v36, v36, v36 row_half_mirror row_mask:0xf bank_mask:0xf
    v_add_f32_dpp v37, v37, v37 row_half_mirror row_mask:0xf bank_mask:0xf
    s_nop 0
    v_add_f32_dpp v36, v36, v36 row_mirror row_mask:0xf bank_mask:0xf
    v_add_f32_dpp v37, v37, v37 row_mirror row_mask:0xf bank_mask:0xf
    s_nop 0
    v_mov_b32 v39, v36
    s_nop 1
    v_permlane16_swap_b32 v36, v39
    v_add_f32 v36, v36, v39
    v_mov_b32 v39, v37
    s_nop 1
    v_permlane16_swap_b32 v37, v39
    v_add_f32 v37, v37, v39
    v_mov_b32 v39, v36
    s_nop 1
    v_permlane32_swap_b32 v36, v39
    v_add_f32 v36, v36, v39
    v_mov_b32 v39, v37
    s_nop 1
    v_permlane32_swap_b32 v37, v39
    v_add_f32 v37, v37, v39
    v_mov_b32 v39, 0x3727c5ac
    v_mul_f32 v37, 0x3acccccd, v37
    v_fmamk_f32 v36, v36, 0x3acccccd, v39
    v_fma_f32 v36, -v37, v37, v36
    v_rsq_f32 v36, v36
    v_mov_b32 v84, v37
    v_mul_f32 v85, 0x3dd53b94, v36
SETUP2:
    s_cmp_ge_u32 s46, 10
    s_cselect_b32 s56, 1, 0
    s_cmp_ge_u32 s46, 20
    s_cselect_b32 s52, 2, s56
    s_mul_i32 s52, s52, 10
    s_sub_u32 s57, s46, s52
    s_min_u32 s4, s46, 29
    s_cmp_ge_u32 s4, 15
    s_cselect_b32 s58, 1, 0
    s_mul_i32 s52, s58, 15
    s_sub_u32 s52, s4, s52
    s_mul_i32 s59, s52, 52
    s_lshr_b32 s59, s59, 8
    s_mul_i32 s53, s59, 5
    s_sub_u32 s3, s52, s53
    s_cmp_ge_u32 s46, 20
    s_cselect_b32 s24, s80, s72
    s_cselect_b32 s25, s81, s73
    s_mov_b32 s26, 7864320
    s_cselect_b32 s26, 1966080, s26
    s_and_b32 s25, s25, 0xffff
    s_mov_b32 s27, 0x20000
    s_cmp_eq_u32 s58, 1
    s_cselect_b32 s28, s78, s76
    s_cselect_b32 s29, s79, s77
    s_and_b32 s29, s29, 0xffff
    s_mov_b32 s30, 1966080
    s_mov_b32 s31, 0x20000
    s_mov_b32 s49, 0
    s_mul_i32 s63, s45, 45312
    s_add_u32 s63, s63, 414720
    s_mul_i32 s62, s45, 28160
    s_add_u32 s62, s62, 87040
    s_mov_b32 s50, 0
    v_and_b32 v24, 15, v1
    v_cmp_eq_u32 vcc, 1, v24
    v_mov_b32 v25, 96256
    v_mov_b32 v26, 97280
    v_cndmask_b32 v2, v25, v26, vcc
    v_lshl_add_u32 v2, v19, 4, v2
    v_and_b32 v24, 3, v1
    v_lshlrev_b32 v24, 4, v24
    v_and_b32 v25, 1, v19
    v_lshl_add_u32 v24, v25, 6, v24
    v_add_u32 v24, 98304, v24
    v_bfe_u32 v25, v1, 2, 2
    v_lshrrev_b32 v27, 5, v1
    v_sub_u32 v25, v25, v27
    v_mov_b32 v26, 107008
    v_cmp_eq_u32 vcc, 0, v25
    s_nop 1
    v_cndmask_b32 v3, v26, v24, vcc
    v_cmp_eq_u32 vcc, 2, v25
    s_nop 1
    v_cndmask_b32 v4, v26, v24, vcc
    v_and_b32 v24, 3, v1
    v_cmp_eq_u32 vcc, 3, v24
    v_mov_b32 v25, 0xffff
    v_mov_b32 v26, 0xffff0000
    v_cndmask_b32 v25, v25, v26, vcc
    v_cndmask_b32 v24, v24, 0, vcc
    v_or_b32 v24, 12, v24
    v_mul_u32_u24 v24, 0x1111, v24
    v_mul_u32_u24 v26, 0xaaaa, v20
    v_add_u32 v26, 0x4444, v26
    v_lshl_add_u32 v7, v24, 16, v26
    v_and_b32 v24, 4, v1
    v_cmp_eq_u32 vcc, 0, v24
    s_nop 1
    v_cndmask_b32 v5, 0, v25, vcc
    v_cndmask_b32 v6, v25, 0, vcc
    v_mul_u32_u24 v82, s97, v27
    v_bfe_u32 v24, v1, 3, 1
    v_mul_u32_u24 v24, 1536, v24
    v_add_u32 v82, v82, v24
    v_and_b32 v24, 1, v19
    v_mul_u32_u24 v24, 768, v24
    v_add_u32 v82, v82, v24
    v_and_b32 v24, 7, v1
    v_lshl_add_u32 v82, v24, 4, v82
    s_mul_i32 s52, s7, 6144
    s_add_u32 s52, s52, 20480
    v_lshl_add_u32 v8, v0, 4, s52
    s_lshl_b32 s52, s7, 6
    s_add_u32 s52, s52, 45056
    v_lshl_add_u32 v9, v24, 3, s52
    v_and_b32 v10, 0xe1, v0
    v_lshlrev_b32 v10, 1, v10
    v_bfe_u32 v24, v0, 4, 1
    v_lshl_add_u32 v10, v24, 3, v10
    v_bfe_u32 v24, v0, 3, 1
    v_lshl_add_u32 v10, v24, 5, v10
    v_bfe_u32 v24, v0, 2, 1
    v_lshl_add_u32 v10, v24, 2, v10
    v_bfe_u32 v24, v0, 1, 1
    v_lshl_add_u32 v10, v24, 4, v10
    v_add_u32 v10, 98304, v10
    v_mov_b32 v11, 0x3727c5ac
    v_mov_b32 v12, 98752
    s_cmp_lg_u32 s44, 3
    s_cbranch_scc1 KBAR
    s_mov_b32 s51, 0
    v_mov_b32 v37, 0
NOP:
    s_waitcnt vmcnt(0)
    v_readfirstlane_b32 s5, v89
    s_cmp_lg_u32 s5, 0
    s_cbranch_scc1 NOOK
    buffer_load_dword v89, v37, s[40:43], 0 offen sc1
    s_add_u32 s51, s51, 1
    s_sleep 4
    s_cmp_lt_u32 s51, 0x8000
    s_cbranch_scc1 NOP
NOOK:
    s_getreg_b32 s52, hwreg(HW_REG_XCC_ID)
    s_and_b32 s52, s52, 15
    s_or_b32 s5, s5, s52
    v_mov_b32 v36, s5
    s_lshl_b32 s52, s45, 7
    s_lshl_b32 s54, s46, 2
    s_add_u32 s52, s52, s54
    s_add_u32 s52, s52, 1376256
    s_mov_b64 exec, 1
    buffer_store_dword v36, v37, s[16:19], s52 offen sc1
    s_mov_b64 exec, -1
    s_mov_b32 s44, 0
    s_branch LOOP
KBAR:
    s_barrier
KPART2:
    buffer_load_dwordx4 a[28:31], v80, s[8:11], s96 offen offset:0 nt
    buffer_load_dwordx4 a[36:39], v80, s[8:11], s96 offen offset:128 nt
    buffer_load_dwordx4 a[44:47], v80, s[8:11], s96 offen offset:256 nt
    s_add_u32 s96, s96, s97
    buffer_load_dwordx4 a[48:51], v80, s[8:11], s96 offen offset:0 nt
    buffer_load_dwordx4 a[56:59], v80, s[8:11], s96 offen offset:128 nt
    buffer_load_dwordx4 a[64:67], v80, s[8:11], s96 offen offset:256 nt
    s_add_u32 s96, s96, s97
    buffer_load_dwordx4 a[52:55], v80, s[8:11], s96 offen offset:0 nt
    buffer_load_dwordx4 a[60:63], v80, s[8:11], s96 offen offset:128 nt
    buffer_load_dwordx4 a[68:71], v80, s[8:11], s96 offen offset:256 nt
    s_add_u32 s96, s96, s97
    buffer_load_dwordx4 a[72:75], v80, s[8:11], s96 offen offset:0 nt
    buffer_load_dwordx4 a[80:83], v80, s[8:11], s96 offen offset:128 nt
    buffer_load_dwordx4 a[88:91], v80, s[8:11], s96 offen offset:256 nt
    s_add_u32 s96, s96, s97
    buffer_load_dwordx4 a[76:79], v80, s[8:11], s96 offen offset:0 nt
    buffer_load_dwordx4 a[84:87], v80, s[8:11], s96 offen offset:128 nt
    buffer_load_dwordx4 a[92:95], v80, s[8:11], s96 offen offset:256 nt
    s_add_u32 s96, s96, s97
    buffer_load_dwordx4 a[96:99], v80, s[8:11], s96 offen offset:0 nt
    buffer_load_dwordx4 a[104:107], v80, s[8:11], s96 offen offset:128 nt
    buffer_load_dwordx4 a[112:115], v80, s[8:11], s96 offen offset:256 nt
    s_add_u32 s96, s96, s97
    buffer_load_dwordx4 a[100:103], v80, s[8:11], s96 offen offset:0 nt
    buffer_load_dwordx4 a[108:111], v80, s[8:11], s96 offen offset:128 nt
    buffer_load_dwordx4 a[116:119], v80, s[8:11], s96 offen offset:256 nt
    s_add_u32 s96, s96, s97
    buffer_load_dwordx4 a[120:123], v80, s[8:11], s96 offen offset:0 nt
    buffer_load_dwordx4 a[128:131], v80, s[8:11], s96 offen offset:128 nt
    buffer_load_dwordx4 a[136:139], v80, s[8:11], s96 offen offset:256 nt
    s_add_u32 s96, s96, s97
    buffer_load_dwordx4 a[124:127], v80, s[8:11], s96 offen offset:0 nt
    buffer_load_dwordx4 a[132:135], v80, s[8:11], s96 offen offset:128 nt
    buffer_load_dwordx4 a[140:143], v80, s[8:11], s96 offen offset:256 nt
    s_add_u32 s96, s96, s97
    buffer_load_dwordx4 a[144:147], v80, s[8:11], s96 offen offset:0 nt
    buffer_load_dwordx4 a[152:155], v80, s[8:11], s96 offen offset:128 nt
    buffer_load_dwordx4 a[160:163], v80, s[8:11], s96 offen offset:256 nt
    s_add_u32 s96, s96, s97
    buffer_load_dwordx4 a[148:151], v80, s[8:11], s96 offen offset:0 nt
    buffer_load_dwordx4 a[156:159], v80, s[8:11], s96 offen offset:128 nt
    buffer_load_dwordx4 a[164:167], v80, s[8:11], s96 offen offset:256 nt
    s_add_u32 s96, s96, s97
    buffer_load_dwordx4 a[168:171], v80, s[8:11], s96 offen offset:0 nt
    buffer_load_dwordx4 a[176:179], v80, s[8:11], s96 offen offset:128 nt
    buffer_load_dwordx4 a[184:187], v80, s[8:11], s96 offen offset:256 nt
    s_add_u32 s96, s96, s97
    buffer_load_dwordx4 a[172:175], v80, s[8:11], s96 offen offset:0 nt
    buffer_load_dwordx4 a[180:183], v80, s[8:11], s96 offen offset:128 nt
    buffer_load_dwordx4 a[188:191], v80, s[8:11], s96 offen offset:256 nt
    s_lshl_b32 s97, s97, 1
    buffer_load_dwordx4 a[192:195], v82, s[12:15], s55 offen offset:0 nt
    buffer_load_dwordx4 a[200:203], v82, s[12:15], s55 offen offset:128 nt
    buffer_load_dwordx4 a[208:211], v82, s[12:15], s55 offen offset:256 nt
    buffer_load_dwordx4 a[216:219], v82, s[12:15], s55 offen offset:384 nt
    buffer_load_dwordx4 a[224:227], v82, s[12:15], s55 offen offset:512 nt
    buffer_load_dwordx4 a[232:235], v82, s[12:15], s55 offen offset:640 nt
    s_add_u32 s55, s55, s97
    buffer_load_dwordx4 a[196:199], v82, s[12:15], s55 offen offset:0 nt
    buffer_load_dwordx4 a[204:207], v82, s[12:15], s55 offen offset:128 nt
    buffer_load_dwordx4 a[212:215], v82, s[12:15], s55 offen offset:256 nt
    buffer_load_dwordx4 a[220:223], v82, s[12:15], s55 offen offset:384 nt
    buffer_load_dwordx4 a[228:231], v82, s[12:15], s55 offen offset:512 nt
    buffer_load_dwordx4 a[236:239], v82, s[12:15], s55 offen offset:640 nt
    s_add_u32 s55, s55, s97
    buffer_load_dwordx4 a[240:243], v82, s[12:15], s55 offen offset:0 nt
    buffer_load_dwordx4 a[248:251], v82, s[12:15], s55 offen offset:128 nt
    buffer_load_dwordx4 v[128:131], v82, s[12:15], s55 offen offset:256 nt
    buffer_load_dwordx4 v[136:139], v82, s[12:15], s55 offen offset:384 nt
    buffer_load_dwordx4 v[144:147], v82, s[12:15], s55 offen offset:512 nt
    buffer_load_dwordx4 v[152:155], v82, s[12:15], s55 offen offset:640 nt
    s_add_u32 s55, s55, s97
    buffer_load_dwordx4 a[244:247], v82, s[12:15], s55 offen offset:0 nt
    buffer_load_dwordx4 a[252:255], v82, s[12:15], s55 offen offset:128 nt
    buffer_load_dwordx4 v[132:135], v82, s[12:15], s55 offen offset:256 nt
    buffer_load_dwordx4 v[140:143], v82, s[12:15], s55 offen offset:384 nt
    buffer_load_dwordx4 v[148:151], v82, s[12:15], s55 offen offset:512 nt
    buffer_load_dwordx4 v[156:159], v82, s[12:15], s55 offen offset:640 nt
    s_add_u32 s55, s55, s97
    s_cmp_eq_u32 s44, 3
    s_cbranch_scc1 HSHK
VPART2:
    buffer_load_dwordx4 v[160:163], v82, s[12:15], s55 offen offset:0 nt
    buffer_load_dwordx4 v[168:171], v82, s[12:15], s55 offen offset:128 nt
    buffer_load_dwordx4 v[176:179], v82, s[12:15], s55 offen offset:256 nt
    buffer_load_dwordx4 v[184:187], v82, s[12:15], s55 offen offset:384 nt
    buffer_load_dwordx4 v[192:195], v82, s[12:15], s55 offen offset:512 nt
    buffer_load_dwordx4 v[200:203], v82, s[12:15], s55 offen offset:640 nt
    s_add_u32 s55, s55, s97
    buffer_load_dwordx4 v[164:167], v82, s[12:15], s55 offen offset:0 nt
    buffer_load_dwordx4 v[172:175], v82, s[12:15], s55 offen offset:128 nt
    buffer_load_dwordx4 v[180:183], v82, s[12:15], s55 offen offset:256 nt
    buffer_load_dwordx4 v[188:191], v82, s[12:15], s55 offen offset:384 nt
    buffer_load_dwordx4 v[196:199], v82, s[12:15], s55 offen offset:512 nt
    buffer_load_dwordx4 v[204:207], v82, s[12:15], s55 offen offset:640 nt
    s_add_u32 s55, s55, s97
    buffer_load_dwordx4 v[208:211], v82, s[12:15], s55 offen offset:0 nt
    buffer_load_dwordx4 v[216:219], v82, s[12:15], s55 offen offset:128 nt
    buffer_load_dwordx4 v[224:227], v82, s[12:15], s55 offen offset:256 nt
    buffer_load_dwordx4 v[232:235], v82, s[12:15], s55 offen offset:384 nt
    buffer_load_dwordx4 v[240:243], v82, s[12:15], s55 offen offset:512 nt
    buffer_load_dwordx4 v[248:251], v82, s[12:15], s55 offen offset:640 nt
    s_add_u32 s55, s55, s97
    buffer_load_dwordx4 v[212:215], v82, s[12:15], s55 offen offset:0 nt
    buffer_load_dwordx4 v[220:223], v82, s[12:15], s55 offen offset:128 nt
    buffer_load_dwordx4 v[228:231], v82, s[12:15], s55 offen offset:256 nt
    buffer_load_dwordx4 v[236:239], v82, s[12:15], s55 offen offset:384 nt
    buffer_load_dwordx4 v[244:247], v82, s[12:15], s55 offen offset:512 nt
    buffer_load_dwordx4 v[252:255], v82, s[12:15], s55 offen offset:640 nt
    s_cmp_eq_u32 s44, 3
    s_cbranch_scc1 QK0
    s_branch ENTRY
LOOP:
    v_and_b32 v16, 3, v1
    v_lshrrev_b32 v17, 4, v1
    v_bfe_u32 v18, v1, 2, 2
    v_lshlrev_b32 v16, 3, v16
    v_mul_u32_u24 v18, 384, v18
    v_add_u32 v16, v16, v18
    v_bfe_u32 v18, v1, 3, 2
    v_xor_b32 v18, s44, v18
    v_lshl_add_u32 v16, v18, 5, v16
    v_add_u32 v16, 65536, v16
    v_and_b32 v18, 1, v17
    v_mul_u32_u24 v17, 3072, v17
    v_mul_u32_u24 v18, 3072, v18
    v_add_u32 v17, v17, v16
    v_add_u32 v18, v18, v16
    ds_read_b64_tr_b16 v[44:45], v17 offset:0
    ds_read_b64_tr_b16 v[46:47], v17 offset:1536
    ds_read_b64_tr_b16 v[56:57], v17 offset:128
    ds_read_b64_tr_b16 v[58:59], v17 offset:1664
    ds_read_b64_tr_b16 v[68:69], v17 offset:256
    ds_read_b64_tr_b16 v[70:71], v17 offset:1792
    ds_read_b64_tr_b16 v[48:49], v17 offset:12288
    ds_read_b64_tr_b16 v[50:51], v17 offset:13824
    ds_read_b64_tr_b16 v[60:61], v17 offset:12416
    ds_read_b64_tr_b16 v[62:63], v17 offset:13952
    ds_read_b64_tr_b16 v[72:73], v17 offset:12544
    ds_read_b64_tr_b16 v[74:75], v17 offset:14080
    ds_read_b64_tr_b16 v[52:53], v18 offset:24576
    ds_read_b64_tr_b16 v[54:55], v18 offset:26112
    ds_read_b64_tr_b16 v[64:65], v18 offset:24704
    ds_read_b64_tr_b16 v[66:67], v18 offset:26240
    ds_read_b64_tr_b16 v[76:77], v18 offset:24832
    ds_read_b64_tr_b16 v[78:79], v18 offset:26368
    s_cmp_lg_u32 s6, 0
    s_cbranch_scc1 QA0
    v_and_b32 v29, 31, v1
    v_lshl_add_u32 v29, s44, 5, v29
    s_cmp_eq_u32 s44, 3
    s_cbranch_scc1 Y2N
    v_min_u32 v20, 79, v29
    s_mul_i32 s52, s48, 80
    v_add_u32 v20, s52, v20
    v_lshrrev_b32 v26, 4, v20
    v_and_b32 v20, 15, v20
    v_lshlrev_b32 v26, 10, v26
    v_lshl_add_u32 v26, v20, 2, v26
    v_lshrrev_b32 v20, 5, v1
    v_lshl_add_u32 v26, v20, 9, v26
    v_add_u32 v26, 40960, v26
    s_sub_u32 s52, s46, 20
    s_cmp_ge_u32 s52, 10
    s_cbranch_scc1 HOOKL
    s_sleep 8
GYB:
    buffer_load_dword v22, v26, s[16:19], s49 offen offset:0 sc1
    buffer_load_dword v23, v26, s[16:19], s49 offen offset:128 sc1
    buffer_load_dword v24, v26, s[16:19], s49 offen offset:256 sc1
    buffer_load_dword v25, v26, s[16:19], s49 offen offset:384 sc1
Y2N:
    s_lshr_b32 s53, s48, 2
    s_mul_i32 s52, s7, 6144
    s_lshl_b32 s54, s44, 8
    s_add_u32 s52, s52, s54
    s_mul_i32 s54, s53, 3056
    s_add_u32 s52, s52, s54
    s_lshl_b32 s54, s48, 2
    s_add_u32 s52, s52, s54
    s_add_u32 s52, s52, 20480
    v_lshl_add_u32 v14, v1, 4, s52
    s_lshl_b32 s52, s7, 6
    s_lshl_b32 s54, s48, 3
    s_add_u32 s52, s52, s54
    s_add_u32 s52, s52, 45056
    v_mov_b32 v15, s52
    s_mul_i32 s52, s48, 320
    s_add_u32 s52, s52, 81920
    s_and_b32 s53, s2, 0xc7
    s_cmp_eq_u32 s53, 0
    s_cselect_b32 s52, s52, 1879048192
    v_lshl_add_u32 v28, v29, 2, s52
    v_lshlrev_b32 v19, 1, v29
    v_add_u32 v19, 96256, v19
    v_cmp_gt_u32 vcc, 80, v29
    s_mov_b64 s[60:61], vcc
    s_mov_b32 s51, 0
    s_cmp_eq_u32 s44, 3
    s_cbranch_scc1 Y2OK
    s_branch Y2W
Y2P:
    buffer_load_dword v22, v26, s[16:19], s49 offen offset:0 sc1
    buffer_load_dword v23, v26, s[16:19], s49 offen offset:128 sc1
    buffer_load_dword v24, v26, s[16:19], s49 offen offset:256 sc1
    buffer_load_dword v25, v26, s[16:19], s49 offen offset:384 sc1
Y2W:
    s_waitcnt vmcnt(0)
    v_pk_add_f32 v[22:23], v[22:23], v[24:25]
    v_add_f32 v30, v22, v23
    v_mov_b32 v31, v30
    s_nop 1
    v_permlane32_swap_b32 v30, v31
    v_add_f32 v30, v30, v31
    v_cmp_u_f32 vcc, v30, v30
    s_cbranch_vccz Y2OK
    s_add_u32 s51, s51, 1
    s_sleep 1
    s_cmp_lt_u32 s51, 0x8000
    s_cbranch_scc1 Y2P
Y2OK:
    s_cmp_lg_u32 s49, 0
    s_cbranch_scc1 FINAL
    s_mov_b32 s49, 327680
    s_mov_b32 s62, s63
    s_cmp_eq_u32 s44, 3
    s_cbranch_scc1 QX
    v_cvt_pk_bf16_f32 v30, v30, v30
    v_cndmask_b32 v30, 0, v30, s[60:61]
    ds_write_b16 v19, v30
    v_and_b32 v30, 0xffff0000, v30
    s_mov_b32 exec_lo, s60
    s_mov_b32 exec_hi, 0
    s_cmp_eq_u32 s50, 0
    s_cbranch_scc1 SLOW0
    buffer_store_dword v30, v28, s[16:19], s49 offen
PUBD0:
    s_mov_b64 exec, -1
QX:
    s_waitcnt lgkmcnt(0)
    s_barrier
QA0:
    ds_read_b128 v[32:35], v2 offset:0
    ds_read_b128 v[36:39], v2 offset:64
    ds_read_b128 v[40:43], v2 offset:128
    s_waitcnt lgkmcnt(2)
    v_mfma_f32_16x16x32_bf16 v[28:31], v[32:35], v[32:35], 0
    v_mfma_f32_16x16x32_bf16 v[16:19], v[32:35], v[44:47], 0
    v_mfma_f32_16x16x32_bf16 v[20:23], v[32:35], v[56:59], 0
    v_mfma_f32_16x16x32_bf16 v[24:27], v[32:35], v[68:71], 0
    s_waitcnt lgkmcnt(1)
    v_mfma_f32_16x16x32_bf16 v[28:31], v[36:39], v[36:39], v[28:31]
    v_mfma_f32_16x16x32_bf16 v[16:19], v[36:39], v[48:51], v[16:19]
    v_mfma_f32_16x16x32_bf16 v[20:23], v[36:39], v[60:63], v[20:23]
    v_mfma_f32_16x16x32_bf16 v[24:27], v[36:39], v[72:75], v[24:27]
    s_waitcnt lgkmcnt(0)
    v_mfma_f32_16x16x32_bf16 v[16:19], v[40:43], v[52:55], v[16:19]
    v_mfma_f32_16x16x32_bf16 v[20:23], v[40:43], v[64:67], v[20:23]
    v_mfma_f32_16x16x32_bf16 v[24:27], v[40:43], v[76:79], v[24:27]
    v_mfma_f32_16x16x32_bf16 v[28:31], v[40:43], v[40:43], v[28:31]
    s_mov_b64 exec, 0xffff
    s_cmp_lg_u32 s6, 0
    s_cbranch_scc1 HOOKA
    s_cmp_eq_u32 s50, 0
    s_cbranch_scc1 SLOW1
    buffer_store_dword v16, v14, s[16:19], s62 offen offset:0
    buffer_store_dword v20, v14, s[16:19], s62 offen offset:1024
    buffer_store_dword v24, v14, s[16:19], s62 offen offset:2048
    s_mov_b64 exec, 1
    buffer_store_dwordx2 v[28:29], v15, s[16:19], s62 offen
PUBD1:
    s_mov_b64 exec, -1
ENTRY:
    s_mov_b32 s51, 0
    v_mov_b64 v[64:65], 0
    v_mov_b64 v[66:67], 0
    v_mov_b64 v[68:69], 0
    v_mov_b64 v[70:71], 0
    v_mov_b64 v[72:73], 0
    v_mov_b64 v[74:75], 0
    v_mov_b64 v[76:77], 0
    v_mov_b64 v[78:79], 0
    s_cmp_eq_u32 s49, 0
    s_cselect_b32 s53, 3, s44
    s_cmp_eq_u32 s53, 3
    s_cbranch_scc1 EN0
    s_nop 15
    buffer_load_dwordx2 v[62:63], v9, s[16:19], s62 offen sc1
    buffer_load_dwordx4 v[44:47], v8, s[16:19], s62 offen offset:0 sc1
    buffer_load_dwordx4 v[48:51], v8, s[16:19], s62 offen offset:3072 sc1
EN0:
    v_lshrrev_b32 v14, 2, v1
    v_lshlrev_b32 v14, 7, v14
    v_and_b32 v15, 3, v1
    v_lshl_add_u32 v14, v15, 2, v14
    s_mul_i32 s52, s7, 3072
    s_mul_i32 s54, s44, 768
    s_add_u32 s52, s52, s54
    s_lshl_b32 s54, s48, 4
    s_add_u32 s52, s52, s54
    v_add_u32 v14, s52, v14
    s_lshl_b32 s52, s7, 5
    s_lshl_b32 s54, s48, 2
    s_add_u32 s52, s52, s54
    s_add_u32 s52, s52, 19968
    v_writelane_b32 v14, s52, 24
    v_and_b32 v15, 7, v1
    v_lshlrev_b32 v15, 5, v15
    v_bfe_u32 v61, v1, 4, 1
    v_lshl_add_u32 v15, v61, 4, v15
    v_lshrrev_b32 v61, 5, v1
    v_mul_u32_u24 v61, 768, v61
    v_add_u32 v15, v15, v61
    s_mul_i32 s52, s44, 1536
    s_add_u32 s52, s52, 98816
    v_add_u32 v15, s52, v15
    s_mul_i32 s52, s44, 192
    s_add_u32 s52, s52, 98816
    v_min_u32 v60, 23, v1
    v_lshl_add_u32 v60, v60, 3, s52
    s_lshl_b32 s52, s44, 3
    s_add_u32 s52, s52, 98752
    v_mov_b32 v61, s52
    s_cmp_eq_u32 s53, 3
    s_cbranch_scc1 ENOK2
    s_nop 7
ENP:
    buffer_load_dwordx2 v[62:63], v9, s[16:19], s62 offen sc1
    buffer_load_dwordx4 v[44:47], v8, s[16:19], s62 offen offset:0 sc1
    buffer_load_dwordx4 v[48:51], v8, s[16:19], s62 offen offset:3072 sc1
    s_waitcnt vmcnt(3)
    v_add_f32_dpp v32, v62, v62 quad_perm:[1,0,3,2] row_mask:0xf bank_mask:0xf
    v_add_f32_dpp v33, v63, v63 quad_perm:[1,0,3,2] row_mask:0xf bank_mask:0xf
    v_pk_add_f32 v[16:17], v[44:45], v[46:47]
    v_add_f32_dpp v32, v32, v32 quad_perm:[2,3,0,1] row_mask:0xf bank_mask:0xf
    v_add_f32_dpp v33, v33, v33 quad_perm:[2,3,0,1] row_mask:0xf bank_mask:0xf
    v_pk_add_f32 v[20:21], v[48:49], v[50:51]
    v_add_f32_dpp v32, v32, v32 row_half_mirror row_mask:0xf bank_mask:0xf
    v_add_f32_dpp v33, v33, v33 row_half_mirror row_mask:0xf bank_mask:0xf
    v_pk_add_f32 v[16:17], v[16:17], v[20:21]
    v_mul_f32 v33, 0x3acccccd, v33
    v_fmamk_f32 v32, v32, 0x3acccccd, v11
    v_fma_f32 v32, -v33, v33, v32
    v_rsq_f32 v32, v32
    v_add_f32 v16, v16, v17
    v_mul_f32 v32, 0x3dd53b94, v32
    v_fma_f32 v16, -v33, v13, v16
    v_mul_f32 v16, v16, v32
    v_cmp_u_f32 vcc, v16, v16
    s_cbranch_vccz ENOK
    s_add_u32 s51, s51, 1
    s_cmp_lt_u32 s51, 0x8000
    s_cbranch_scc1 ENP
ENOK:
    v_cvt_pk_bf16_f32 v16, v16, v16
    ds_write_b16 v10, v16
ENOK2:
    s_waitcnt lgkmcnt(0)
    s_barrier
    ds_read_b128 v[16:19], v3 offset:0
    ds_read_b128 v[20:23], v3 offset:128
    ds_read_b128 v[24:27], v3 offset:256
    ds_read_b128 v[28:31], v4 offset:0
    ds_read_b128 v[32:35], v4 offset:128
    ds_read_b128 v[36:39], v4 offset:256
    s_cmp_eq_u32 s49, 0
    s_cbranch_scc1 HOOKF
    s_waitcnt vmcnt(0)
QK:
    v_mov_b64 v[40:41], 0
    v_mov_b64 v[42:43], 0
    v_mov_b64 v[44:45], 0
    v_mov_b64 v[46:47], 0
    v_mov_b64 v[48:49], 0
    v_mov_b64 v[50:51], 0
    s_waitcnt lgkmcnt(5)
    v_smfmac_f32_16x16x64_bf16 v[64:67], v[16:19], a[0:7], v7
    s_waitcnt lgkmcnt(4)
    v_smfmac_f32_16x16x64_bf16 v[64:67], v[20:23], a[8:15], v7
    s_waitcnt lgkmcnt(3)
    v_smfmac_f32_16x16x64_bf16 v[64:67], v[24:27], a[16:23], v7
    s_waitcnt lgkmcnt(2)
    v_smfmac_f32_16x16x64_bf16 v[64:67], v[28:31], a[24:31], v7
    s_waitcnt lgkmcnt(1)
    v_smfmac_f32_16x16x64_bf16 v[64:67], v[32:35], a[32:39], v7
    s_waitcnt lgkmcnt(0)
    v_smfmac_f32_16x16x64_bf16 v[64:67], v[36:39], a[40:47], v7
    v_smfmac_f32_16x16x64_bf16 v[68:71], v[16:19], a[48:55], v7
    v_smfmac_f32_16x16x64_bf16 v[68:71], v[20:23], a[56:63], v7
    v_smfmac_f32_16x16x64_bf16 v[68:71], v[24:27], a[64:71], v7
    v_smfmac_f32_16x16x64_bf16 v[68:71], v[28:31], a[72:79], v7
    v_smfmac_f32_16x16x64_bf16 v[68:71], v[32:35], a[80:87], v7
    v_smfmac_f32_16x16x64_bf16 v[68:71], v[36:39], a[88:95], v7
    v_smfmac_f32_16x16x64_bf16 v[72:75], v[16:19], a[96:103], v7
    v_smfmac_f32_16x16x64_bf16 v[72:75], v[20:23], a[104:111], v7
    v_smfmac_f32_16x16x64_bf16 v[72:75], v[24:27], a[112:119], v7
    v_mov_b32_dpp v52, v64 quad_perm:[0,0,2,2] row_mask:0xf bank_mask:0xf
    v_smfmac_f32_16x16x64_bf16 v[72:75], v[28:31], a[120:127], v7
    v_add_f32_dpp v52, v65, v52 quad_perm:[0,0,2,2] row_mask:0xf bank_mask:0xf
    v_smfmac_f32_16x16x64_bf16 v[72:75], v[32:35], a[128:135], v7
    v_add_f32_dpp v52, v66, v52 quad_perm:[1,1,3,3] row_mask:0xf bank_mask:0xf
    v_smfmac_f32_16x16x64_bf16 v[72:75], v[36:39], a[136:143], v7
    v_add_f32_dpp v52, v67, v52 quad_perm:[1,1,3,3] row_mask:0xf bank_mask:0xf
    v_smfmac_f32_16x16x64_bf16 v[76:79], v[16:19], a[144:151], v7
    v_smfmac_f32_16x16x64_bf16 v[76:79], v[20:23], a[152:159], v7
    v_smfmac_f32_16x16x64_bf16 v[76:79], v[24:27], a[160:167], v7
    v_mov_b32_dpp v53, v68 quad_perm:[0,0,2,2] row_mask:0xf bank_mask:0xf
    v_smfmac_f32_16x16x64_bf16 v[76:79], v[28:31], a[168:175], v7
    v_add_f32_dpp v53, v69, v53 quad_perm:[0,0,2,2] row_mask:0xf bank_mask:0xf
    v_smfmac_f32_16x16x64_bf16 v[76:79], v[32:35], a[176:183], v7
    v_add_f32_dpp v53, v70, v53 quad_perm:[1,1,3,3] row_mask:0xf bank_mask:0xf
    v_smfmac_f32_16x16x64_bf16 v[76:79], v[36:39], a[184:191], v7
    v_add_f32_dpp v53, v71, v53 quad_perm:[1,1,3,3] row_mask:0xf bank_mask:0xf
    v_mov_b32_dpp v54, v72 quad_perm:[0,0,2,2] row_mask:0xf bank_mask:0xf
    v_add_f32_dpp v54, v73, v54 quad_perm:[0,0,2,2] row_mask:0xf bank_mask:0xf
    v_add_f32_dpp v54, v74, v54 quad_perm:[1,1,3,3] row_mask:0xf bank_mask:0xf
    v_add_f32_dpp v54, v75, v54 quad_perm:[1,1,3,3] row_mask:0xf bank_mask:0xf
    v_max3_f32 v62, v52, v53, v54
    s_nop 1
    v_mov_b32_dpp v55, v76 quad_perm:[0,0,2,2] row_mask:0xf bank_mask:0xf
    v_add_f32_dpp v55, v77, v55 quad_perm:[0,0,2,2] row_mask:0xf bank_mask:0xf
    v_add_f32_dpp v55, v78, v55 quad_perm:[1,1,3,3] row_mask:0xf bank_mask:0xf
    v_add_f32_dpp v55, v79, v55 quad_perm:[1,1,3,3] row_mask:0xf bank_mask:0xf
    v_max_f32 v62, v62, v55
    s_nop 1
    v_max_f32_dpp v62, v62, v62 quad_perm:[2,3,0,1] row_mask:0xf bank_mask:0xf
    s_nop 1
    v_max_f32_dpp v62, v62, v62 row_ror:4 row_mask:0xf bank_mask:0xf
    s_nop 1
    v_max_f32_dpp v62, v62, v62 row_ror:8 row_mask:0xf bank_mask:0xf
    v_mov_b32 v63, v62
    s_nop 1
    v_permlane16_swap_b32 v62, v63
    v_max_f32 v62, v62, v63
    v_mov_b32 v63, v62
    s_nop 1
    v_permlane32_swap_b32 v62, v63
    v_max_f32 v62, v62, v63
    v_sub_f32 v52, v52, v62
    v_exp_f32 v52, v52
    s_nop 0
    v_cvt_pk_bf16_f32 v56, v52, v52
    v_mov_b32 v63, v52
    s_nop 0
    v_and_b32_dpp v16, v56, v5 quad_perm:[0,0,0,0] row_mask:0xf bank_mask:0xf
    v_and_b32_dpp v19, v56, v6 quad_perm:[0,0,0,0] row_mask:0xf bank_mask:0xf
    s_nop 0
    v_mov_b32_dpp v17, v16 row_shr:4 row_mask:0xf bank_mask:0xf bound_ctrl:0
    v_mov_b32_dpp v18, v19 row_shl:4 row_mask:0xf bank_mask:0xf bound_ctrl:0
    s_nop 0
    s_waitcnt vmcnt(36)
    v_smfmac_f32_16x16x64_bf16 v[40:43], v[16:19], a[192:199], v7 abid:1
    v_and_b32_dpp v20, v56, v5 quad_perm:[2,2,2,2] row_mask:0xf bank_mask:0xf
    v_and_b32_dpp v23, v56, v6 quad_perm:[2,2,2,2] row_mask:0xf bank_mask:0xf
    v_smfmac_f32_16x16x64_bf16 v[44:47], v[16:19], a[200:207], v7 abid:1
    v_mov_b32_dpp v21, v20 row_shr:4 row_mask:0xf bank_mask:0xf bound_ctrl:0
    v_mov_b32_dpp v22, v23 row_shl:4 row_mask:0xf bank_mask:0xf bound_ctrl:0
    v_sub_f32 v53, v53, v62
    v_exp_f32 v53, v53
    v_smfmac_f32_16x16x64_bf16 v[48:51], v[16:19], a[208:215], v7 abid:1
    v_cvt_pk_bf16_f32 v57, v53, v53
    v_add_f32 v63, v63, v53
    v_smfmac_f32_16x16x64_bf16 v[40:43], v[20:23], a[216:223], v7 abid:1
    v_and_b32_dpp v16, v57, v5 quad_perm:[0,0,0,0] row_mask:0xf bank_mask:0xf
    v_and_b32_dpp v19, v57, v6 quad_perm:[0,0,0,0] row_mask:0xf bank_mask:0xf
    v_smfmac_f32_16x16x64_bf16 v[44:47], v[20:23], a[224:231], v7 abid:1
    v_mov_b32_dpp v17, v16 row_shr:4 row_mask:0xf bank_mask:0xf bound_ctrl:0
    v_mov_b32_dpp v18, v19 row_shl:4 row_mask:0xf bank_mask:0xf bound_ctrl:0
    v_smfmac_f32_16x16x64_bf16 v[48:51], v[20:23], a[232:239], v7 abid:1
    s_waitcnt vmcnt(24)
    v_smfmac_f32_16x16x64_bf16 v[40:43], v[16:19], a[240:247], v7 abid:1
    v_and_b32_dpp v20, v57, v5 quad_perm:[2,2,2,2] row_mask:0xf bank_mask:0xf
    v_and_b32_dpp v23, v57, v6 quad_perm:[2,2,2,2] row_mask:0xf bank_mask:0xf
    v_smfmac_f32_16x16x64_bf16 v[44:47], v[16:19], a[248:255], v7 abid:1
    v_mov_b32_dpp v21, v20 row_shr:4 row_mask:0xf bank_mask:0xf bound_ctrl:0
    v_mov_b32_dpp v22, v23 row_shl:4 row_mask:0xf bank_mask:0xf bound_ctrl:0
    v_sub_f32 v54, v54, v62
    v_exp_f32 v54, v54
    v_smfmac_f32_16x16x64_bf16 v[48:51], v[16:19], v[128:135], v7 abid:1
    v_cvt_pk_bf16_f32 v56, v54, v54
    v_add_f32 v63, v63, v54
    v_smfmac_f32_16x16x64_bf16 v[40:43], v[20:23], v[136:143], v7 abid:1
    v_and_b32_dpp v16, v56, v5 quad_perm:[0,0,0,0] row_mask:0xf bank_mask:0xf
    v_and_b32_dpp v19, v56, v6 quad_perm:[0,0,0,0] row_mask:0xf bank_mask:0xf
    v_smfmac_f32_16x16x64_bf16 v[44:47], v[20:23], v[144:151], v7 abid:1
    v_mov_b32_dpp v17, v16 row_shr:4 row_mask:0xf bank_mask:0xf bound_ctrl:0
    v_mov_b32_dpp v18, v19 row_shl:4 row_mask:0xf bank_mask:0xf bound_ctrl:0
    v_smfmac_f32_16x16x64_bf16 v[48:51], v[20:23], v[152:159], v7 abid:1
    s_waitcnt vmcnt(12)
    v_smfmac_f32_16x16x64_bf16 v[40:43], v[16:19], v[160:167], v7 abid:1
    v_and_b32_dpp v20, v56, v5 quad_perm:[2,2,2,2] row_mask:0xf bank_mask:0xf
    v_and_b32_dpp v23, v56, v6 quad_perm:[2,2,2,2] row_mask:0xf bank_mask:0xf
    v_smfmac_f32_16x16x64_bf16 v[44:47], v[16:19], v[168:175], v7 abid:1
    v_mov_b32_dpp v21, v20 row_shr:4 row_mask:0xf bank_mask:0xf bound_ctrl:0
    v_mov_b32_dpp v22, v23 row_shl:4 row_mask:0xf bank_mask:0xf bound_ctrl:0
    v_sub_f32 v55, v55, v62
    v_exp_f32 v55, v55
    v_smfmac_f32_16x16x64_bf16 v[48:51], v[16:19], v[176:183], v7 abid:1
    v_cvt_pk_bf16_f32 v57, v55, v55
    v_add_f32 v63, v63, v55
    v_smfmac_f32_16x16x64_bf16 v[40:43], v[20:23], v[184:191], v7 abid:1
    v_and_b32_dpp v16, v57, v5 quad_perm:[0,0,0,0] row_mask:0xf bank_mask:0xf
    v_and_b32_dpp v19, v57, v6 quad_perm:[0,0,0,0] row_mask:0xf bank_mask:0xf
    v_smfmac_f32_16x16x64_bf16 v[44:47], v[20:23], v[192:199], v7 abid:1
    v_mov_b32_dpp v17, v16 row_shr:4 row_mask:0xf bank_mask:0xf bound_ctrl:0
    v_mov_b32_dpp v18, v19 row_shl:4 row_mask:0xf bank_mask:0xf bound_ctrl:0
    v_smfmac_f32_16x16x64_bf16 v[48:51], v[20:23], v[200:207], v7 abid:1
    s_waitcnt vmcnt(0)
    v_smfmac_f32_16x16x64_bf16 v[40:43], v[16:19], v[208:215], v7 abid:1
    v_add_f32_dpp v63, v63, v63 quad_perm:[2,3,0,1] row_mask:0xf bank_mask:0xf
    v_and_b32_dpp v20, v57, v5 quad_perm:[2,2,2,2] row_mask:0xf bank_mask:0xf
    v_and_b32_dpp v23, v57, v6 quad_perm:[2,2,2,2] row_mask:0xf bank_mask:0xf
    v_add_f32_dpp v63, v63, v63 row_ror:4 row_mask:0xf bank_mask:0xf
    v_smfmac_f32_16x16x64_bf16 v[44:47], v[16:19], v[216:223], v7 abid:1
    v_mov_b32_dpp v21, v20 row_shr:4 row_mask:0xf bank_mask:0xf bound_ctrl:0
    v_mov_b32_dpp v22, v23 row_shl:4 row_mask:0xf bank_mask:0xf bound_ctrl:0
    v_add_f32_dpp v63, v63, v63 row_ror:8 row_mask:0xf bank_mask:0xf
    v_mov_b32 v58, v63
    v_smfmac_f32_16x16x64_bf16 v[48:51], v[16:19], v[224:231], v7 abid:1
    s_nop 0
    v_permlane16_swap_b32 v63, v58
    v_smfmac_f32_16x16x64_bf16 v[40:43], v[20:23], v[232:239], v7 abid:1
    v_add_f32 v63, v63, v58
    v_mov_b32 v58, v63
    v_smfmac_f32_16x16x64_bf16 v[44:47], v[20:23], v[240:247], v7 abid:1
    v_smfmac_f32_16x16x64_bf16 v[48:51], v[20:23], v[248:255], v7 abid:1
    v_permlane32_swap_b32 v63, v58
    v_add_f32 v63, v63, v58
    ds_write_b64 v61, v[62:63]
    s_mov_b32 exec_lo, 0x00ff00ff
    s_mov_b32 exec_hi, 0xff00ff00
    s_nop 0
    ds_write_b128 v15, v[40:43] offset:0
    ds_write_b128 v15, v[44:47] offset:256
    ds_write_b128 v15, v[48:51] offset:512
    s_mov_b64 exec, -1
    v_cmp_eq_u32 s[60:61], 24, v1
    s_cmp_eq_u32 s49, 0
    s_cbranch_scc1 HOOKC
EXB:
    s_waitcnt lgkmcnt(0)
    s_barrier
    ds_read_b128 v[16:19], v12
    ds_read_b128 v[20:23], v12 offset:16
    ds_read_b64 v[24:25], v60 offset:0
    ds_read_b64 v[26:27], v60 offset:768
    ds_read_b64 v[28:29], v60 offset:1536
    ds_read_b64 v[30:31], v60 offset:2304
    ds_read_b64 v[32:33], v60 offset:3072
    ds_read_b64 v[34:35], v60 offset:3840
    ds_read_b64 v[36:37], v60 offset:4608
    ds_read_b64 v[38:39], v60 offset:5376
    s_waitcnt lgkmcnt(8)
    v_max_f32 v40, v16, v18
    v_max3_f32 v40, v40, v20, v22
    v_sub_f32 v16, v16, v40
    v_sub_f32 v18, v18, v40
    v_sub_f32 v20, v20, v40
    v_sub_f32 v22, v22, v40
    v_exp_f32 v16, v16
    v_exp_f32 v18, v18
    v_exp_f32 v20, v20
    v_exp_f32 v22, v22
    v_mul_f32 v41, v16, v17
    v_fmac_f32 v41, v18, v19
    v_fmac_f32 v41, v20, v21
    v_fmac_f32 v41, v22, v23
    v_rcp_f32 v42, v41
    v_log_f32 v43, v41
    s_waitcnt lgkmcnt(0)
    v_pk_add_f32 v[24:25], v[24:25], v[26:27]
    v_pk_add_f32 v[28:29], v[28:29], v[30:31]
    v_pk_add_f32 v[32:33], v[32:33], v[34:35]
    v_pk_add_f32 v[36:37], v[36:37], v[38:39]
    v_pk_mul_f32 v[24:25], v[24:25], v[16:17] op_sel_hi:[1,0]
    v_pk_fma_f32 v[24:25], v[28:29], v[18:19], v[24:25] op_sel_hi:[1,0,1]
    v_pk_fma_f32 v[24:25], v[32:33], v[20:21], v[24:25] op_sel_hi:[1,0,1]
    v_pk_fma_f32 v[24:25], v[36:37], v[22:23], v[24:25] op_sel_hi:[1,0,1]
    v_pk_mul_f32 v[24:25], v[24:25], v[42:43] op_sel_hi:[1,0]
    v_add_f32 v43, v43, v40
    v_cvt_pk_bf16_f32 v24, v24, v25
    s_mov_b64 exec, 0x1ffffff
    v_cndmask_b32 v24, v24, v43, s[60:61]
    s_cmp_eq_u32 s50, 0
    s_cbranch_scc1 SLOW2
    buffer_store_dword v24, v14, s[16:19], s62 offen
PUBD2:
    s_mov_b64 exec, -1
    s_cmp_ge_u32 s46, 20
    s_cbranch_scc1 HOOKG3
    v_and_b32 v30, 7, v1
    v_lshrrev_b32 v31, 4, v1
    v_lshlrev_b32 v58, 4, v30
    v_lshl_add_u32 v58, v31, 7, v58
    s_mul_i32 s52, s56, 6144
    s_mul_i32 s54, s44, 1536
    s_add_u32 s52, s52, s54
    v_add_u32 v58, s52, v58
    s_lshr_b32 s53, s44, 1
    s_lshl_b32 s52, s56, 6
    s_lshl_b32 s54, s53, 5
    s_add_u32 s52, s52, s54
    s_add_u32 s52, s52, 19968
    v_lshl_add_u32 v59, v31, 2, v30
    v_and_b32 v59, 7, v59
    v_lshl_add_u32 v59, v59, 2, s52
    s_lshl_b32 s52, s57, 8
    s_add_u32 s52, s52, 81920
    s_or_b32 s53, s45, s56
    s_cmp_eq_u32 s53, 0
    s_cselect_b32 s52, s52, 1879048192
    v_lshl_add_u32 v61, v1, 2, s52
    v_mov_b64 v[44:45], 0
    v_mov_b64 v[46:47], 0
    v_mov_b64 v[48:49], 0
    v_mov_b64 v[50:51], 0
    v_mov_b64 v[52:53], 0
    v_mov_b64 v[54:55], 0
    s_mov_b32 s60, 0x00ff00ff
    s_mov_b32 s61, 0x00ff00ff
    s_mov_b32 s51, 0
    s_cmp_eq_u32 s49, 0
    s_cbranch_scc1 HOOKG
WO0:
    buffer_load_dword v57, v61, s[16:19], s49 offen sc1
    buffer_load_dword v56, v59, s[16:19], s62 offen sc1
    s_mov_b64 exec, s[60:61]
    buffer_load_dwordx4 v[44:47], v58, s[16:19], s62 offen offset:0 sc1
    buffer_load_dwordx4 v[48:51], v58, s[16:19], s62 offen offset:512 sc1
    buffer_load_dwordx4 v[52:55], v58, s[16:19], s62 offen offset:1024 sc1
    s_mov_b64 exec, -1
    s_cmp_eq_u32 s49, 0
    s_cbranch_scc1 HOOKG2
    s_nop 15
    s_nop 7
WO1:
    v_lshrrev_b32 v14, 5, v1
    v_lshlrev_b32 v14, 11, v14
    v_and_b32 v15, 31, v1
    v_lshl_add_u32 v14, v15, 2, v14
    s_lshl_b32 s52, s57, 12
    s_lshl_b32 s54, s45, 8
    s_add_u32 s52, s52, s54
    s_lshl_b32 s54, s56, 7
    s_add_u32 s52, s52, s54
    v_add_u32 v14, s52, v14
    s_lshl_b32 s52, s44, 9
    s_add_u32 s52, s52, 104960
    v_lshl_add_u32 v15, v15, 4, s52
    v_and_b32 v64, 15, v1
    v_lshlrev_b32 v64, 4, v64
    v_lshl_add_u32 v64, v31, 2, v64
    v_add_u32 v64, 104960, v64
WOP:
    buffer_load_dword v57, v61, s[16:19], s49 offen sc1
    buffer_load_dword v56, v59, s[16:19], s62 offen sc1
    s_mov_b64 exec, s[60:61]
    buffer_load_dwordx4 v[44:47], v58, s[16:19], s62 offen offset:0 sc1
    buffer_load_dwordx4 v[48:51], v58, s[16:19], s62 offen offset:512 sc1
    buffer_load_dwordx4 v[52:55], v58, s[16:19], s62 offen offset:1024 sc1
    s_mov_b64 exec, -1
    s_waitcnt vmcnt(5) lgkmcnt(0)
    v_max3_u32 v63, v44, v48, v52
    v_mov_b32 v32, v56
    v_max_u32 v63, v63, v32
    v_cmp_eq_u32 vcc, -1, v63
    s_cbranch_vccnz WOAG
    v_mfma_f32_16x16x32_bf16 v[16:19], v[44:47], v[80:83], 0
    v_max_f32_dpp v33, v32, v32 quad_perm:[1,0,3,2] row_mask:0xf bank_mask:0xf
    s_nop 0
    v_mfma_f32_16x16x32_bf16 v[16:19], v[48:51], v[96:99], v[16:19]
    v_max_f32_dpp v33, v33, v33 quad_perm:[2,3,0,1] row_mask:0xf bank_mask:0xf
    s_nop 0
    v_mfma_f32_16x16x32_bf16 v[16:19], v[52:55], v[112:115], v[16:19]
    v_max_f32_dpp v33, v33, v33 row_half_mirror row_mask:0xf bank_mask:0xf
    v_sub_f32 v34, v32, v33
    v_mfma_f32_16x16x32_bf16 v[20:23], v[44:47], v[84:87], 0
    v_exp_f32 v34, v34
    s_nop 0
    v_mfma_f32_16x16x32_bf16 v[20:23], v[48:51], v[100:103], v[20:23]
    v_add_f32_dpp v33, v34, v34 quad_perm:[1,0,3,2] row_mask:0xf bank_mask:0xf
    s_nop 0
    v_mfma_f32_16x16x32_bf16 v[20:23], v[52:55], v[116:119], v[20:23]
    v_add_f32_dpp v33, v33, v33 quad_perm:[2,3,0,1] row_mask:0xf bank_mask:0xf
    s_nop 0
    v_mfma_f32_16x16x32_bf16 v[24:27], v[44:47], v[88:91], 0
    v_add_f32_dpp v33, v33, v33 row_half_mirror row_mask:0xf bank_mask:0xf
    v_rcp_f32 v33, v33
    v_mfma_f32_16x16x32_bf16 v[24:27], v[48:51], v[104:107], v[24:27]
    v_mul_f32 v34, v34, v33
    s_nop 0
    v_mfma_f32_16x16x32_bf16 v[24:27], v[52:55], v[120:123], v[24:27]
    v_mul_f32_dpp v36, v34, v16 row_newbcast:0 row_mask:0xf bank_mask:0xf
    v_fmac_f32_dpp v36, v34, v17 row_newbcast:1 row_mask:0xf bank_mask:0xf
    v_mfma_f32_16x16x32_bf16 v[28:31], v[44:47], v[92:95], 0
    v_fmac_f32_dpp v36, v34, v18 row_newbcast:2 row_mask:0xf bank_mask:0xf
    v_fmac_f32_dpp v36, v34, v19 row_newbcast:3 row_mask:0xf bank_mask:0xf
    v_mfma_f32_16x16x32_bf16 v[28:31], v[48:51], v[108:111], v[28:31]
    v_mul_f32_dpp v37, v34, v20 row_newbcast:0 row_mask:0xf bank_mask:0xf
    v_fmac_f32_dpp v37, v34, v21 row_newbcast:1 row_mask:0xf bank_mask:0xf
    v_mfma_f32_16x16x32_bf16 v[28:31], v[52:55], v[124:127], v[28:31]
    v_fmac_f32_dpp v37, v34, v22 row_newbcast:2 row_mask:0xf bank_mask:0xf
    v_fmac_f32_dpp v37, v34, v23 row_newbcast:3 row_mask:0xf bank_mask:0xf
    v_cmp_u_f32 vcc, v36, v57
    v_mul_f32_dpp v38, v34, v24 row_newbcast:0 row_mask:0xf bank_mask:0xf
    v_fmac_f32_dpp v38, v34, v25 row_newbcast:1 row_mask:0xf bank_mask:0xf
    v_fmac_f32_dpp v38, v34, v26 row_newbcast:2 row_mask:0xf bank_mask:0xf
    v_fmac_f32_dpp v38, v34, v27 row_newbcast:3 row_mask:0xf bank_mask:0xf
    s_mov_b32 exec_hi, 0
    v_mul_f32_dpp v39, v34, v28 row_newbcast:0 row_mask:0xf bank_mask:0xf
    v_fmac_f32_dpp v39, v34, v29 row_newbcast:1 row_mask:0xf bank_mask:0xf
    v_fmac_f32_dpp v39, v34, v30 row_newbcast:2 row_mask:0xf bank_mask:0xf
    v_fmac_f32_dpp v39, v34, v31 row_newbcast:3 row_mask:0xf bank_mask:0xf
    s_cbranch_vccz WOOK
    s_mov_b64 exec, -1
WOAG:
    s_add_u32 s51, s51, 1
    s_cmp_lt_u32 s51, 0x8000
    s_cbranch_scc1 WOP
    s_mov_b32 exec_hi, 0
WOOK:
    ds_write_b128 v15, v[36:39]
    s_mov_b64 exec, -1
    s_cmp_lg_u32 s44, 3
    s_waitcnt vmcnt(0) lgkmcnt(0)
    s_barrier
    s_cbranch_scc1 WOX
    ds_read2st64_b32 v[16:17], v64 offset0:0 offset1:1
    ds_read2st64_b32 v[18:19], v64 offset0:2 offset1:3
    ds_read2st64_b32 v[20:21], v64 offset0:4 offset1:5
    ds_read2st64_b32 v[22:23], v64 offset0:6 offset1:7
    s_waitcnt lgkmcnt(2)
    v_pk_add_f32 v[16:17], v[16:17], v[18:19]
    v_add_f32 v16, v16, v57
    s_waitcnt lgkmcnt(0)
    v_pk_add_f32 v[20:21], v[20:21], v[22:23]
    v_pk_add_f32 v[16:17], v[16:17], v[20:21]
    v_add_f32 v16, v16, v17
    buffer_store_dword v16, v14, s[16:19], s49 offen sc1
WOX:
    s_cmp_ge_u32 s46, 30
    s_cbranch_scc1 STX
    v_and_b32 v61, 3, v1
    v_lshlrev_b32 v61, 3, v61
    v_bfe_u32 v60, v1, 2, 2
    v_lshl_add_u32 v61, v60, 7, v61
    v_lshrrev_b32 v60, 4, v1
    v_lshl_add_u32 v61, v60, 10, v61
    v_bfe_u32 v60, v1, 3, 2
    v_lshl_add_u32 v61, v60, 5, v61
    s_lshl_b32 s52, s44, 5
    v_xor_b32 v61, s52, v61
    ds_read_b64_tr_b16 v[64:65], v61 offset:49152
    ds_read_b64_tr_b16 v[66:67], v61 offset:49664
    ds_read_b64_tr_b16 v[68:69], v61 offset:53248
    ds_read_b64_tr_b16 v[70:71], v61 offset:53760
    ds_read_b64_tr_b16 v[72:73], v61 offset:57344
    ds_read_b64_tr_b16 v[74:75], v61 offset:57856
    ds_read_b64_tr_b16 v[76:77], v61 offset:61440
    ds_read_b64_tr_b16 v[78:79], v61 offset:61952
    s_lshl_b32 s52, s59, 6
    s_lshl_b32 s54, s44, 4
    s_add_u32 s52, s52, s54
    v_add_u32 v14, s52, v1
    s_mul_i32 s52, s58, 3072
    s_lshl_b32 s54, s3, 2
    s_add_u32 s52, s52, s54
    s_lshl_b32 s53, s58, 2
    s_add_u32 s53, s53, 6144
    s_cmp_eq_u32 s3, 4
    s_cselect_b32 s52, s53, s52
    s_cselect_b32 s53, 3, 4
    v_lshlrev_b32 v14, s53, v14
    v_add_u32 v14, s52, v14
    s_lshl_b32 s52, s4, 3
    s_add_u32 s52, s52, 20224
    v_mov_b32 v15, s52
    v_and_b32 v57, 31, v1
    v_lshl_add_u32 v57, s44, 5, v57
    s_lshl_b32 s52, s4, 9
    s_add_u32 s52, s52, 84480
    s_cmp_lt_u32 s4, 5
    s_cselect_b32 s52, s52, 1879048192
    s_cmp_eq_u32 s45, 0
    s_cselect_b32 s52, s52, 1879048192
    v_lshl_add_u32 v56, v57, 2, s52
    v_lshlrev_b32 v57, 1, v57
    v_add_u32 v57, 96512, v57
    v_lshrrev_b32 v58, 5, v1
    v_lshlrev_b32 v58, 10, v58
    v_and_b32 v59, 31, v1
    v_lshl_add_u32 v58, v59, 2, v58
    s_lshl_b32 s52, s3, 13
    s_lshl_b32 s54, s44, 11
    s_add_u32 s52, s52, s54
    v_add_u32 v58, s52, v58
    v_min_u32 v54, 191, v0
    v_lshlrev_b32 v52, 4, v54
    v_lshlrev_b32 v54, 3, v54
    v_add_u32 v54, 6144, v54
    v_and_b32 v53, 15, v0
    s_mov_b32 s100, 0
    s_cmp_eq_u32 s49, 0
    s_cbranch_scc1 HOOKD
    s_cmp_lt_u32 s46, 20
    s_cbranch_scc1 GFB
    s_sleep 18
GFB:
    s_sleep 8
F1S:
    v_add_u32 v14, 12288, v14
    v_add_u32 v52, 12288, v52
    v_add_u32 v54, 12288, v54
    s_mov_b32 s51, 0
F1P:
    buffer_load_dword v16, v58, s[16:19], s49 offen offset:0 sc1
    buffer_load_dword v17, v58, s[16:19], s49 offen offset:128 sc1
    buffer_load_dword v18, v58, s[16:19], s49 offen offset:256 sc1
    buffer_load_dword v19, v58, s[16:19], s49 offen offset:384 sc1
    buffer_load_dword v20, v58, s[16:19], s49 offen offset:512 sc1
    buffer_load_dword v21, v58, s[16:19], s49 offen offset:640 sc1
    buffer_load_dword v22, v58, s[16:19], s49 offen offset:768 sc1
    buffer_load_dword v23, v58, s[16:19], s49 offen offset:896 sc1
    s_cmp_eq_u32 s100, 3
    s_cbranch_scc1 HOOKH
F1W:
    s_waitcnt vmcnt(0)
    v_pk_add_f32 v[16:17], v[16:17], v[18:19]
    v_pk_add_f32 v[20:21], v[20:21], v[22:23]
    v_pk_add_f32 v[16:17], v[16:17], v[20:21]
    v_add_f32 v16, v16, v17
    v_mov_b32 v17, v16
    s_nop 1
    v_permlane32_swap_b32 v16, v17
    v_add_f32 v16, v16, v17
    v_cmp_u_f32 vcc, v16, v16
    s_cbranch_vccz F1OK
    s_add_u32 s51, s51, 1
    s_sleep 1
    s_cmp_lt_u32 s51, 0x8000
    s_cbranch_scc1 F1P
F1OK:
    v_cvt_pk_bf16_f32 v16, v16, v16
    ds_write_b16 v57, v16
    v_and_b32 v16, 0xffff0000, v16
    s_mov_b32 exec_hi, 0
    s_cmp_eq_u32 s50, 0
    s_cbranch_scc1 SLOW7
    buffer_store_dword v16, v56, s[16:19], s49 offen
PUBD7:
    s_mov_b64 exec, -1
    s_waitcnt lgkmcnt(0)
    s_barrier
    ds_read_b128 v[20:23], v2 offset:256
    ds_read_b128 v[24:27], v2 offset:320
    ds_read_b128 v[28:31], v2 offset:384
    ds_read_b128 v[32:35], v2 offset:448
    s_waitcnt lgkmcnt(3)
    v_mfma_f32_16x16x32_bf16 v[40:43], v[20:23], v[64:67], 0
    v_mfma_f32_16x16x32_bf16 v[44:47], v[20:23], v[20:23], 0
    s_waitcnt lgkmcnt(2)
    v_mfma_f32_16x16x32_bf16 v[40:43], v[24:27], v[68:71], v[40:43]
    v_mfma_f32_16x16x32_bf16 v[44:47], v[24:27], v[24:27], v[44:47]
    s_waitcnt lgkmcnt(1)
    v_mfma_f32_16x16x32_bf16 v[40:43], v[28:31], v[72:75], v[40:43]
    v_mfma_f32_16x16x32_bf16 v[44:47], v[28:31], v[28:31], v[44:47]
    s_waitcnt lgkmcnt(0)
    v_mfma_f32_16x16x32_bf16 v[40:43], v[32:35], v[76:79], v[40:43]
    v_mfma_f32_16x16x32_bf16 v[44:47], v[32:35], v[32:35], v[44:47]
    s_mov_b64 exec, 0xffff
    s_nop 3
    s_cmp_eq_u32 s50, 0
    s_cbranch_scc1 SLOW8
    buffer_store_dword v40, v14, s[16:19], s62 offen
    s_mov_b64 exec, 1
    buffer_store_dwordx2 v[44:45], v15, s[16:19], s62 offen
PUBD8:
    s_mov_b64 exec, -1
    s_cmp_lt_u32 s46, 20
    s_cbranch_scc1 STX
    v_and_b32 v58, 7, v1
    v_cmp_gt_u32 vcc, 5, v58
    v_lshlrev_b32 v58, 3, v58
    v_add_u32 v58, 20224, v58
    v_mov_b32 v59, 1879048192
    v_cndmask_b32 v58, v59, v58, vcc
    s_lshl_b32 s52, s57, 8
    s_lshl_b32 s54, s44, 6
    s_add_u32 s52, s52, s54
    s_add_u32 s52, s52, 84480
    s_cmp_eq_u32 s45, 0
    s_cselect_b32 s52, s52, 1879048192
    v_lshl_add_u32 v59, v53, 2, s52
    s_cmp_eq_u32 s44, 3
    s_cselect_b32 s53, 1879048192, s62
    s_mov_b32 s51, 0
    s_cmp_eq_u32 s49, 0
    s_cbranch_scc1 HOOKI
    s_nop 3
W20:
    s_nop 11
    buffer_load_dword v76, v59, s[16:19], s49 offen sc1
    buffer_load_dwordx2 v[74:75], v58, s[16:19], s62 offen sc1
    buffer_load_dwordx4 v[64:67], v52, s[16:19], s53 offen offset:0 sc1
    buffer_load_dwordx4 v[68:71], v52, s[16:19], s53 offen offset:3072 sc1
    buffer_load_dwordx2 v[72:73], v54, s[16:19], s53 offen sc1
    s_lshl_b32 s52, s57, 12
    s_lshl_b32 s54, s44, 10
    s_add_u32 s52, s52, s54
    s_lshl_b32 s54, s45, 7
    s_add_u32 s52, s52, s54
    s_add_u32 s52, s52, 40960
    v_lshl_add_u32 v14, v1, 2, s52
    v_lshlrev_b32 v57, 1, v0
    v_add_u32 v57, 96768, v57
    s_mov_b32 s51, 0
    s_nop 15
    s_nop 13
W2P:
    buffer_load_dword v76, v59, s[16:19], s49 offen sc1
    buffer_load_dwordx2 v[74:75], v58, s[16:19], s62 offen sc1
    buffer_load_dwordx4 v[64:67], v52, s[16:19], s53 offen offset:0 sc1
    buffer_load_dwordx4 v[68:71], v52, s[16:19], s53 offen offset:3072 sc1
    buffer_load_dwordx2 v[72:73], v54, s[16:19], s53 offen sc1
    s_waitcnt vmcnt(5)
    v_add_f32_dpp v36, v74, v74 quad_perm:[1,0,3,2] row_mask:0xf bank_mask:0xf
    v_add_f32_dpp v37, v75, v75 quad_perm:[1,0,3,2] row_mask:0xf bank_mask:0xf
    v_pk_add_f32 v[18:19], v[64:65], v[66:67]
    v_add_f32_dpp v36, v36, v36 quad_perm:[2,3,0,1] row_mask:0xf bank_mask:0xf
    v_add_f32_dpp v37, v37, v37 quad_perm:[2,3,0,1] row_mask:0xf bank_mask:0xf
    v_pk_add_f32 v[20:21], v[68:69], v[70:71]
    v_add_f32_dpp v36, v36, v36 row_half_mirror row_mask:0xf bank_mask:0xf
    v_add_f32_dpp v37, v37, v37 row_half_mirror row_mask:0xf bank_mask:0xf
    v_add_f32 v16, v18, v19
    v_add_f32 v17, v20, v21
    v_mul_f32 v37, 0x3acccccd, v37
    v_fmamk_f32 v36, v36, 0x3acccccd, v11
    v_fma_f32 v36, -v37, v37, v36
    v_rsq_f32 v36, v36
    v_pk_add_f32 v[16:17], v[16:17], v[72:73]
    v_pk_fma_f32 v[16:17], v[36:37], v[126:127], v[16:17] op_sel:[1,0,0] op_sel_hi:[1,1,1] neg_lo:[1,0,0] neg_hi:[1,0,0]
    v_pk_mul_f32 v[16:17], v[16:17], v[36:37] op_sel_hi:[1,0]
    v_mul_f32 v18, 0xbfb8aa3b, v16
    v_exp_f32 v18, v18
    v_mul_f32 v16, v16, v17
    v_add_f32 v18, 1.0, v18
    v_rcp_f32 v18, v18
    v_cmp_u_f32 vcc, v16, v76
    v_mul_f32 v16, v16, v18
    s_cbranch_vccz W2OK
    s_add_u32 s51, s51, 1
    s_cmp_lt_u32 s51, 0x8000
    s_cbranch_scc1 W2P
W2OK:
    v_cvt_pk_bf16_f32 v16, v16, v16
    ds_write_b16 v57, v16
    s_waitcnt lgkmcnt(0)
    s_barrier
    ds_read_b128 v[16:19], v2 offset:512
    ds_read_b128 v[20:23], v2 offset:576
    ds_read_b128 v[24:27], v2 offset:640
    ds_read_b128 v[28:31], v2 offset:704
    ds_read_b128 v[32:35], v2 offset:768
    ds_read_b128 v[36:39], v2 offset:832
    s_waitcnt lgkmcnt(5)
    v_mfma_f32_16x16x32_bf16 v[40:43], v[16:19], v[80:83], 0
    s_waitcnt lgkmcnt(4)
    v_mfma_f32_16x16x32_bf16 v[40:43], v[20:23], v[84:87], v[40:43]
    s_waitcnt lgkmcnt(3)
    v_mfma_f32_16x16x32_bf16 v[40:43], v[24:27], v[88:91], v[40:43]
    s_waitcnt lgkmcnt(2)
    v_mfma_f32_16x16x32_bf16 v[40:43], v[28:31], v[92:95], v[40:43]
    s_waitcnt lgkmcnt(1)
    v_mfma_f32_16x16x32_bf16 v[40:43], v[32:35], v[96:99], v[40:43]
    s_waitcnt lgkmcnt(0)
    v_mfma_f32_16x16x32_bf16 v[40:43], v[36:39], v[100:103], v[40:43]
    s_mov_b64 exec, 0xffff
    s_waitcnt vmcnt(0)
    s_nop 5
    v_add_f32 v40, v40, v76
    buffer_store_dword v40, v14, s[16:19], s49 offen sc1
    s_mov_b64 exec, -1
STX:
    s_cmp_lg_u32 s49, 0
    s_cbranch_scc1 LAST
    s_branch LOOP
LAST:
    s_and_b32 s52, s2, 0xc7
    s_cmp_eq_u32 s52, 0
    s_cbranch_scc1 LOOP
    s_endpgm
FINAL:
    s_cmp_eq_u32 s44, 3
    s_cbranch_scc1 FINX
    v_cvt_pk_bf16_f32 v30, v30, v30
    v_lshlrev_b32 v20, 1, v29
    s_mul_i32 s52, s48, 160
    s_mov_b32 exec_lo, s60
    s_mov_b32 exec_hi, 0
    buffer_store_short v30, v20, s[36:39], s52 offen
    s_mov_b64 exec, -1
FINX:
DONE:
    s_endpgm
HOOKL:
    s_cmp_lg_u32 s49, 0
    s_cbranch_scc1 HL2
    s_cmp_lt_u32 s46, 30
    s_cbranch_scc1 NOGSW
    v_mov_b32 v20, 20224
    s_mov_b32 s51, 0
GSW:
    buffer_load_dword v21, v20, s[16:19], s62 offen sc1
    s_waitcnt vmcnt(0)
    v_cmp_u_f32 vcc, v21, v21
    s_cbranch_vccz NOGSW
    s_add_u32 s51, s51, 1
    s_sleep 2
    s_cmp_lt_u32 s51, 0x8000
    s_cbranch_scc1 GSW
NOGSW:
    s_cmp_ge_u32 s46, 30
    s_cselect_b32 s53, 10, 0
    s_sub_u32 s53, s46, s53
    v_min_u32 v27, 17, v1
    v_lshlrev_b32 v27, 7, v27
    s_mul_i32 s52, s45, 45312
    s_mul_i32 s54, s53, 2304
    s_add_u32 s52, s52, s54
    s_add_u32 s52, s52, 409600
    buffer_load_dword v27, v27, s[16:19], s52 offen sc1
    v_lshlrev_b32 v24, 3, v0
    s_mul_i32 s52, s47, 12288
    s_add_u32 s52, s52, 1441792
    s_mov_b32 s51, 0
QCPA:
    s_add_u32 s53, s52, 0
    buffer_load_dwordx2 v[32:33], v24, s[16:19], s53 offen offset:0 sc1
    buffer_load_dwordx2 v[34:35], v24, s[16:19], s53 offen offset:1536 sc1
    s_add_u32 s53, s52, 3072
    buffer_load_dwordx2 v[36:37], v24, s[16:19], s53 offen offset:0 sc1
    buffer_load_dwordx2 v[38:39], v24, s[16:19], s53 offen offset:1536 sc1
    s_add_u32 s53, s52, 6144
    buffer_load_dwordx2 v[40:41], v24, s[16:19], s53 offen offset:0 sc1
    buffer_load_dwordx2 v[42:43], v24, s[16:19], s53 offen offset:1536 sc1
    s_add_u32 s53, s52, 9216
    buffer_load_dwordx2 v[20:21], v24, s[16:19], s53 offen offset:0 sc1
    buffer_load_dwordx2 v[22:23], v24, s[16:19], s53 offen offset:1536 sc1
    s_cmp_lg_u32 s51, 0
    s_cbranch_scc1 QCWA
    s_sleep 26
QCWA:
    s_waitcnt vmcnt(0)
    v_bitop3_b32 v33, v32, v33, s101 bitop3:0x96
    v_bitop3_b32 v35, v34, v35, s101 bitop3:0x96
    v_bitop3_b32 v37, v36, v37, s101 bitop3:0x96
    v_bitop3_b32 v39, v38, v39, s101 bitop3:0x96
    v_bitop3_b32 v41, v40, v41, s101 bitop3:0x96
    v_bitop3_b32 v43, v42, v43, s101 bitop3:0x96
    v_bitop3_b32 v21, v20, v21, s101 bitop3:0x96
    v_bitop3_b32 v23, v22, v23, s101 bitop3:0x96
    v_add_f32 v13, v32, v34
    v_add_f32 v13, v13, v36
    v_add_f32 v13, v13, v38
    v_add_f32 v13, v13, v40
    v_add_f32 v13, v13, v42
    v_add_f32 v13, v13, v20
    v_add_f32 v13, v13, v22
    v_or_b32 v33, v33, v35
    v_or_b32 v33, v33, v37
    v_or_b32 v33, v33, v39
    v_or_b32 v33, v33, v41
    v_or_b32 v33, v33, v43
    v_or_b32 v33, v33, v21
    v_or_b32 v33, v33, v23
    v_cmp_ne_u32 vcc, 0, v33
    s_cbranch_vccz QCOKA
    s_add_u32 s51, s51, 1
    s_sleep 2
    s_cmp_lt_u32 s51, 0x8000
    s_cbranch_scc1 QCPA
QCOKA:
    s_branch GYB
HL2:
    s_sleep 21
    s_branch GYB
HOOKA:
    s_nop 3
    s_lshl_b32 s52, s44, 6
    s_add_u32 s52, s52, 98816
    v_lshl_add_u32 v14, v1, 2, s52
    ds_write_b32 v14, v17 offset:8704
    v_fma_f32 v16, -v84, v17, v16
    v_mul_f32 v16, v16, v85
    ds_write_b32 v14, v16 offset:0
    ds_write_b32 v14, v21 offset:8960
    v_fma_f32 v20, -v84, v21, v20
    v_mul_f32 v20, v20, v85
    ds_write_b32 v14, v20 offset:256
    ds_write_b32 v14, v25 offset:9216
    v_fma_f32 v24, -v84, v25, v24
    v_mul_f32 v24, v24, v85
    ds_write_b32 v14, v24 offset:512
    s_mov_b64 exec, -1
    s_add_u32 s44, s44, 1
    s_cmp_lt_u32 s44, 4
    s_cbranch_scc1 LOOP
    s_mov_b32 s44, 3
    s_mov_b32 s100, 1
    v_lshlrev_b32 v14, 2, v1
    v_add_u32 v14, 98816, v14
    ds_read2st64_b32 v[16:17], v14 offset0:0 offset1:1
    ds_read_b32 v18, v14 offset:512
    s_lshl_b32 s52, s47, 13
    s_lshl_b32 s54, s48, 10
    s_add_u32 s52, s52, s54
    s_add_u32 s52, s52, 1114112
    s_waitcnt lgkmcnt(0)
    v_bitop3_b32 v19, v16, v17, v18 bitop3:0x96
    v_xor_b32 v19, v19, v89
    buffer_store_dwordx4 v[16:19], v88, s[16:19], s52 offen sc1
    s_branch KPART1
Q0G:
    v_and_b32 v15, 0xe1, v1
    v_lshlrev_b32 v15, 1, v15
    v_bfe_u32 v14, v1, 4, 1
    v_lshl_add_u32 v15, v14, 3, v15
    v_bfe_u32 v14, v1, 3, 1
    v_lshl_add_u32 v15, v14, 5, v15
    v_bfe_u32 v14, v1, 2, 1
    v_lshl_add_u32 v15, v14, 2, v15
    v_bfe_u32 v14, v1, 1, 1
    v_lshl_add_u32 v15, v14, 4, v15
    v_add_u32 v15, 98304, v15
    s_lshl_b32 s52, s47, 13
    s_add_u32 s52, s52, 1114112
    s_add_u32 s53, s52, 4096
    s_mov_b32 s51, 0
Q0P:
    buffer_load_dwordx4 v[16:19], v88, s[16:19], s52 offen offset:0 sc1
    buffer_load_dwordx4 v[20:23], v88, s[16:19], s52 offen offset:1024 sc1
    buffer_load_dwordx4 v[24:27], v88, s[16:19], s52 offen offset:2048 sc1
    buffer_load_dwordx4 v[28:31], v88, s[16:19], s52 offen offset:3072 sc1
    buffer_load_dwordx4 v[32:35], v88, s[16:19], s53 offen offset:0 sc1
    buffer_load_dwordx4 v[36:39], v88, s[16:19], s53 offen offset:1024 sc1
    buffer_load_dwordx4 v[40:43], v88, s[16:19], s53 offen offset:2048 sc1
    buffer_load_dwordx4 v[44:47], v88, s[16:19], s53 offen offset:3072 sc1
    v_mov_b32 v48, 0
    s_waitcnt vmcnt(0)
    v_bitop3_b32 v49, v16, v17, v18 bitop3:0x96
    v_bitop3_b32 v49, v49, v19, v89 bitop3:0x96
    v_or_b32 v48, v48, v49
    v_bitop3_b32 v49, v20, v21, v22 bitop3:0x96
    v_bitop3_b32 v49, v49, v23, v89 bitop3:0x96
    v_or_b32 v48, v48, v49
    v_bitop3_b32 v49, v24, v25, v26 bitop3:0x96
    v_bitop3_b32 v49, v49, v27, v89 bitop3:0x96
    v_or_b32 v48, v48, v49
    v_bitop3_b32 v49, v28, v29, v30 bitop3:0x96
    v_bitop3_b32 v49, v49, v31, v89 bitop3:0x96
    v_or_b32 v48, v48, v49
    v_bitop3_b32 v49, v32, v33, v34 bitop3:0x96
    v_bitop3_b32 v49, v49, v35, v89 bitop3:0x96
    v_or_b32 v48, v48, v49
    v_bitop3_b32 v49, v36, v37, v38 bitop3:0x96
    v_bitop3_b32 v49, v49, v39, v89 bitop3:0x96
    v_or_b32 v48, v48, v49
    v_bitop3_b32 v49, v40, v41, v42 bitop3:0x96
    v_bitop3_b32 v49, v49, v43, v89 bitop3:0x96
    v_or_b32 v48, v48, v49
    v_bitop3_b32 v49, v44, v45, v46 bitop3:0x96
    v_bitop3_b32 v49, v49, v47, v89 bitop3:0x96
    v_or_b32 v48, v48, v49
    v_cmp_ne_u32 vcc, 0, v48
    s_cbranch_vccz Q0OK
    s_add_u32 s51, s51, 1
    s_sleep 4
    s_cmp_lt_u32 s51, 0x8000
    s_cbranch_scc1 Q0P
Q0OK:
    v_pk_add_f32 v[16:17], v[16:17], v[20:21]
    v_add_f32 v18, v18, v22
    v_pk_add_f32 v[16:17], v[16:17], v[24:25]
    v_add_f32 v18, v18, v26
    v_pk_add_f32 v[16:17], v[16:17], v[28:29]
    v_add_f32 v18, v18, v30
    v_pk_add_f32 v[16:17], v[16:17], v[32:33]
    v_add_f32 v18, v18, v34
    v_pk_add_f32 v[16:17], v[16:17], v[36:37]
    v_add_f32 v18, v18, v38
    v_pk_add_f32 v[16:17], v[16:17], v[40:41]
    v_add_f32 v18, v18, v42
    v_pk_add_f32 v[16:17], v[16:17], v[44:45]
    v_add_f32 v18, v18, v46
    v_cvt_pk_bf16_f32 v16, v16, v17
    v_cvt_pk_bf16_f32 v18, v18, v18
    ds_write_b16 v15, v16
    ds_write_b16_d16_hi v15, v16 offset:128
    ds_write_b16 v15, v18 offset:256
    s_mov_b32 s52, 1376256
    buffer_load_dwordx4 v[24:27], v88, s[16:19], s52 offen sc1
    s_branch KPART2
HSHK:
    s_waitcnt vmcnt(63)
    s_mov_b32 s51, 0
HSP:
    v_xor_b32 v20, s5, v24
    v_xor_b32 v21, s5, v25
    v_xor_b32 v22, s5, v26
    v_xor_b32 v23, s5, v27
    v_or3_b32 v20, v20, v21, v22
    v_or_b32 v20, v20, v23
    v_cmp_lt_u32 vcc, 15, v20
    s_cbranch_vccz HSOK
    s_mov_b32 s52, 1376256
    buffer_load_dwordx4 v[24:27], v88, s[16:19], s52 offen sc1
    s_waitcnt vmcnt(0)
    s_add_u32 s51, s51, 1
    s_sleep 8
    s_cmp_lt_u32 s51, 0x8000
    s_cbranch_scc1 HSP
HSOK:
    v_cmp_ne_u32 vcc, 0, v20
    s_lshl_b32 s52, s45, 3
    s_lshr_b64 s[60:61], vcc, s52
    s_and_b32 s52, s60, 0xff
    s_cselect_b32 s50, 0, 1
    v_mov_b32 v38, 98784
    v_or_b32 v39, s50, v89
    ds_write_b32 v38, v39
    v_and_b32 v21, 0xffff0000, v86
    v_lshlrev_b32 v20, 16, v86
    buffer_store_dwordx2 v[20:21], v87, s[16:19], 0 offen sc1
    v_min_u32 v83, 8, v1
    v_lshlrev_b32 v83, 7, v83
    s_mul_i32 s52, s45, 28160
    s_mul_i32 s54, s46, 1152
    s_add_u32 s52, s52, s54
    s_add_u32 s52, s52, 81920
    buffer_load_dword v83, v83, s[16:19], s52 offen sc1
    s_branch ENTRY
HOOKF:
    v_mov_b32 v40, 98784
    ds_read_b32 v40, v40
    s_mov_b32 s6, 0
    s_waitcnt lgkmcnt(0)
    v_readfirstlane_b32 s101, v40
    s_and_b32 s50, s101, 1
    s_and_b32 s101, s101, 0xfffffff0
    s_cmp_eq_u32 s44, 3
    s_cbranch_scc1 VPART2
QK0:
    s_waitcnt vmcnt(48)
    s_branch QK
HOOKC:
    s_cmp_eq_u32 s44, 3
    s_cbranch_scc1 EXB
    s_cmp_ge_u32 s46, 30
    s_cbranch_scc1 EXB
    v_lshrrev_b32 v54, 3, v1
    v_and_b32 v53, 7, v1
    v_and_b32 v55, 2, v54
    v_xor_b32 v53, v53, v55
    s_and_b32 s52, s44, 1
    s_lshl_b32 s52, s52, 2
    v_xor_b32 v53, s52, v53
    v_mul_u32_u24 v56, 3072, v54
    v_lshl_add_u32 v56, v53, 4, v56
    v_mul_u32_u24 v55, 1280, v54
    v_lshl_add_u32 v55, v53, 4, v55
    s_mul_i32 s52, s45, 768
    s_mul_i32 s54, s56, 384
    s_add_u32 s52, s52, s54
    s_mul_i32 s53, s45, 192
    s_cmp_ge_u32 s46, 20
    s_cselect_b32 s52, s53, s52
    s_mov_b32 s51, 49152
    s_cselect_b32 s51, 24576, s51
    s_mul_i32 s52, s52, 1280
    s_mul_i32 s54, s44, 10240
    s_add_u32 s52, s52, s54
    s_lshl_b32 s54, s57, 7
    s_add_u32 s52, s52, s54
    s_lshl_b32 s53, s44, 10
WOL:
    s_mov_b32 m0, s53
    s_add_u32 s53, s53, 3072
    buffer_load_dwordx4 v55, s[24:27], s52 offen nt lds
    v_xor_b32 v55, 64, v55
    s_add_u32 s52, s52, 30720
    s_cmp_lt_u32 s53, s51
    s_cbranch_scc1 WOL
    s_mul_i32 s52, s3, 393216
    s_mul_i32 s54, s44, 24576
    s_add_u32 s52, s52, s54
    s_mul_i32 s54, s45, 384
    s_add_u32 s52, s52, s54
    s_lshl_b32 s54, s59, 7
    s_add_u32 s52, s52, s54
    s_lshl_b32 s53, s44, 10
    s_add_u32 s53, s53, 49152
W13L:
    s_mov_b32 m0, s53
    s_add_u32 s53, s53, 3072
    buffer_load_dwordx4 v56, s[28:31], s52 offen nt lds
    v_xor_b32 v56, 64, v56
    s_add_u32 s52, s52, 73728
    s_cmp_lt_u32 s53, 65536
    s_cbranch_scc1 W13L
    s_branch EXB
HOOKG:
    v_and_b32 v71, 3, v1
    v_lshlrev_b32 v71, 3, v71
    v_bfe_u32 v72, v1, 2, 2
    v_lshl_add_u32 v71, v72, 7, v71
    v_lshrrev_b32 v72, 4, v1
    v_lshl_add_u32 v71, v72, 10, v71
    v_bfe_u32 v72, v1, 3, 2
    v_lshl_add_u32 v71, v72, 5, v71
    s_mul_i32 s52, s44, 12288
    v_add_u32 v71, s52, v71
    v_xor_b32 v72, 32, v71
    v_xor_b32 v73, 64, v71
    v_xor_b32 v74, 96, v71
    s_cmp_lg_u32 s44, 3
    s_cbranch_scc1 QCNA
    v_lshlrev_b32 v75, 2, v1
    v_add_u32 v76, 107520, v75
    v_lshlrev_b32 v75, 1, v75
    ds_read_b32 v64, v76 offset:0
    ds_read_b32 v66, v76 offset:256
    ds_read_b32 v68, v76 offset:512
    s_mul_i32 s52, s47, 12288
    s_mul_i32 s54, s48, 1536
    s_add_u32 s52, s52, s54
    s_add_u32 s52, s52, 1441792
    s_waitcnt lgkmcnt(0)
    v_xor_b32 v65, s101, v64
    v_xor_b32 v67, s101, v66
    v_xor_b32 v69, s101, v68
    s_cmp_eq_u32 s50, 0
    s_cbranch_scc1 SLOW3
    buffer_store_dwordx2 v[64:65], v75, s[16:19], s52 offen offset:0
    buffer_store_dwordx2 v[66:67], v75, s[16:19], s52 offen offset:512
    buffer_store_dwordx2 v[68:69], v75, s[16:19], s52 offen offset:1024
PUBD3:
    s_branch QCMA
QCNA:
    s_waitcnt vmcnt(1)
QCMA:
    s_barrier
    s_branch WO0
HOOKG2:
    ds_read_b64_tr_b16 v[80:81], v71 offset:0
    ds_read_b64_tr_b16 v[82:83], v71 offset:512
    ds_read_b64_tr_b16 v[96:97], v71 offset:4096
    ds_read_b64_tr_b16 v[98:99], v71 offset:4608
    ds_read_b64_tr_b16 v[112:113], v71 offset:8192
    ds_read_b64_tr_b16 v[114:115], v71 offset:8704
    ds_read_b64_tr_b16 v[84:85], v72 offset:0
    ds_read_b64_tr_b16 v[86:87], v72 offset:512
    ds_read_b64_tr_b16 v[100:101], v72 offset:4096
    ds_read_b64_tr_b16 v[102:103], v72 offset:4608
    ds_read_b64_tr_b16 v[116:117], v72 offset:8192
    ds_read_b64_tr_b16 v[118:119], v72 offset:8704
    ds_read_b64_tr_b16 v[88:89], v73 offset:0
    ds_read_b64_tr_b16 v[90:91], v73 offset:512
    ds_read_b64_tr_b16 v[104:105], v73 offset:4096
    ds_read_b64_tr_b16 v[106:107], v73 offset:4608
    ds_read_b64_tr_b16 v[120:121], v73 offset:8192
    ds_read_b64_tr_b16 v[122:123], v73 offset:8704
    ds_read_b64_tr_b16 v[92:93], v74 offset:0
    ds_read_b64_tr_b16 v[94:95], v74 offset:512
    ds_read_b64_tr_b16 v[108:109], v74 offset:4096
    ds_read_b64_tr_b16 v[110:111], v74 offset:4608
    ds_read_b64_tr_b16 v[124:125], v74 offset:8192
    ds_read_b64_tr_b16 v[126:127], v74 offset:8704
    s_branch WO1
HOOKG3:
    s_cmp_lg_u32 s49, 0
    s_cbranch_scc1 WOX
    v_and_b32 v71, 3, v1
    v_lshlrev_b32 v71, 3, v71
    v_bfe_u32 v72, v1, 2, 2
    v_lshl_add_u32 v71, v72, 7, v71
    v_lshrrev_b32 v72, 4, v1
    v_lshl_add_u32 v71, v72, 10, v71
    v_bfe_u32 v72, v1, 3, 2
    v_lshl_add_u32 v71, v72, 5, v71
    s_lshl_b32 s52, s44, 5
    v_xor_b32 v71, s52, v71
    s_cmp_lg_u32 s44, 3
    s_cbranch_scc1 QCNB
    v_lshlrev_b32 v75, 2, v1
    v_add_u32 v76, 107520, v75
    v_lshlrev_b32 v75, 1, v75
    ds_read_b32 v64, v76 offset:0
    ds_read_b32 v66, v76 offset:256
    ds_read_b32 v68, v76 offset:512
    s_mul_i32 s52, s47, 12288
    s_mul_i32 s54, s48, 1536
    s_add_u32 s52, s52, s54
    s_add_u32 s52, s52, 1441792
    s_waitcnt lgkmcnt(0)
    v_xor_b32 v65, s101, v64
    v_xor_b32 v67, s101, v66
    v_xor_b32 v69, s101, v68
    s_cmp_eq_u32 s50, 0
    s_cbranch_scc1 SLOW4
    buffer_store_dwordx2 v[64:65], v75, s[16:19], s52 offen offset:0
    buffer_store_dwordx2 v[66:67], v75, s[16:19], s52 offen offset:512
    buffer_store_dwordx2 v[68:69], v75, s[16:19], s52 offen offset:1024
PUBD4:
    s_branch QCMB
QCNB:
    s_waitcnt vmcnt(1)
QCMB:
    s_barrier
    ds_read_b64_tr_b16 v[80:81], v71 offset:0
    ds_read_b64_tr_b16 v[82:83], v71 offset:512
    ds_read_b64_tr_b16 v[84:85], v71 offset:4096
    ds_read_b64_tr_b16 v[86:87], v71 offset:4608
    ds_read_b64_tr_b16 v[88:89], v71 offset:8192
    ds_read_b64_tr_b16 v[90:91], v71 offset:8704
    ds_read_b64_tr_b16 v[92:93], v71 offset:12288
    ds_read_b64_tr_b16 v[94:95], v71 offset:12800
    ds_read_b64_tr_b16 v[96:97], v71 offset:16384
    ds_read_b64_tr_b16 v[98:99], v71 offset:16896
    ds_read_b64_tr_b16 v[100:101], v71 offset:20480
    ds_read_b64_tr_b16 v[102:103], v71 offset:20992
    s_branch WOX
HOOKD:
    v_mov_b64 v[44:45], -1
    v_lshlrev_b32 v47, 3, v1
    s_mul_i32 s52, s46, 1536
    s_mul_i32 s54, s44, 384
    s_add_u32 s52, s52, s54
    v_add_u32 v46, s52, v47
    v_cmp_gt_u32 vcc, 45312, v46
    s_lshl_b32 s52, s2, 9
    s_lshl_b32 s54, s44, 7
    s_add_u32 s52, s52, s54
    v_add_u32 v47, s52, v47
    s_and_b32 exec_lo, vcc_lo, -1
    s_and_b32 exec_hi, vcc_hi, 0xffff
    s_cbranch_execz HD1
    s_cmp_eq_u32 s50, 0
    s_cbranch_scc1 SLOW5
    buffer_store_dwordx2 v[44:45], v46, s[16:19], s63 offen
PUBD5:
HD1:
    s_mov_b64 exec, -1
    v_cmp_gt_u32 vcc, 87040, v47
    s_mov_b32 s52, 327680
    s_and_b32 exec_lo, vcc_lo, 0xffff
    s_mov_b32 exec_hi, 0
    s_cbranch_execz HD2
    buffer_store_dwordx2 v[44:45], v47, s[16:19], s52 offen sc1
HD2:
    s_mov_b64 exec, -1
    ds_read_b128 v[20:23], v2 offset:256
    ds_read_b128 v[24:27], v2 offset:320
    ds_read_b128 v[28:31], v2 offset:384
    ds_read_b128 v[32:35], v2 offset:448
    s_waitcnt lgkmcnt(0)
    v_mfma_f32_16x16x32_bf16 v[40:43], v[20:23], v[64:67], 0
    v_mfma_f32_16x16x32_bf16 v[40:43], v[24:27], v[68:71], v[40:43]
    v_mfma_f32_16x16x32_bf16 v[40:43], v[28:31], v[72:75], v[40:43]
    v_mfma_f32_16x16x32_bf16 v[40:43], v[32:35], v[76:79], v[40:43]
    s_add_u32 s53, s62, 20480
    s_mov_b64 exec, 0xffff
    s_nop 5
    s_cmp_eq_u32 s50, 0
    s_cbranch_scc1 SLOW6
    buffer_store_dword v41, v14, s[16:19], s53 offen
PUBD6:
    s_mov_b64 exec, -1
    s_cmp_lt_u32 s46, 20
    s_cbranch_scc1 F1S
    s_mov_b32 s100, 3
    s_cmp_eq_u32 s44, 3
    s_cbranch_scc1 F1S
    v_lshlrev_b32 v32, 3, v0
    s_mul_i32 s52, s47, 12288
    s_add_u32 s52, s52, 1441792
    s_mov_b32 s51, 0
QCPB:
    s_add_u32 s53, s52, 0
    buffer_load_dwordx2 v[16:17], v32, s[16:19], s53 offen offset:0 sc1
    buffer_load_dwordx2 v[18:19], v32, s[16:19], s53 offen offset:1536 sc1
    s_add_u32 s53, s52, 3072
    buffer_load_dwordx2 v[20:21], v32, s[16:19], s53 offen offset:0 sc1
    buffer_load_dwordx2 v[22:23], v32, s[16:19], s53 offen offset:1536 sc1
    s_add_u32 s53, s52, 6144
    buffer_load_dwordx2 v[24:25], v32, s[16:19], s53 offen offset:0 sc1
    buffer_load_dwordx2 v[26:27], v32, s[16:19], s53 offen offset:1536 sc1
    s_add_u32 s53, s52, 9216
    buffer_load_dwordx2 v[28:29], v32, s[16:19], s53 offen offset:0 sc1
    buffer_load_dwordx2 v[30:31], v32, s[16:19], s53 offen offset:1536 sc1
    s_waitcnt vmcnt(0)
    v_bitop3_b32 v17, v16, v17, s101 bitop3:0x96
    v_bitop3_b32 v19, v18, v19, s101 bitop3:0x96
    v_bitop3_b32 v21, v20, v21, s101 bitop3:0x96
    v_bitop3_b32 v23, v22, v23, s101 bitop3:0x96
    v_bitop3_b32 v25, v24, v25, s101 bitop3:0x96
    v_bitop3_b32 v27, v26, v27, s101 bitop3:0x96
    v_bitop3_b32 v29, v28, v29, s101 bitop3:0x96
    v_bitop3_b32 v31, v30, v31, s101 bitop3:0x96
    v_add_f32 v13, v16, v18
    v_add_f32 v13, v13, v20
    v_add_f32 v13, v13, v22
    v_add_f32 v13, v13, v24
    v_add_f32 v13, v13, v26
    v_add_f32 v13, v13, v28
    v_add_f32 v13, v13, v30
    v_or_b32 v17, v17, v19
    v_or_b32 v17, v17, v21
    v_or_b32 v17, v17, v23
    v_or_b32 v17, v17, v25
    v_or_b32 v17, v17, v27
    v_or_b32 v17, v17, v29
    v_or_b32 v17, v17, v31
    v_cmp_ne_u32 vcc, 0, v17
    s_cbranch_vccz QCOKB
    s_add_u32 s51, s51, 1
    s_sleep 2
    s_cmp_lt_u32 s51, 0x8000
    s_cbranch_scc1 QCPB
QCOKB:
    s_branch F1S
HOOKH:
    s_add_u32 s52, s62, 8192
    buffer_load_dwordx4 v[104:107], v52, s[16:19], s52 offen offset:0 sc1
    buffer_load_dwordx4 v[108:111], v52, s[16:19], s52 offen offset:3072 sc1
    buffer_load_dwordx2 v[112:113], v54, s[16:19], s52 offen sc1
    s_branch F1W
GCP:
    s_add_u32 s52, s62, 8192
    buffer_load_dwordx4 v[104:107], v52, s[16:19], s52 offen offset:0 sc1
    buffer_load_dwordx4 v[108:111], v52, s[16:19], s52 offen offset:3072 sc1
    buffer_load_dwordx2 v[112:113], v54, s[16:19], s52 offen sc1
    s_waitcnt vmcnt(0)
HOOKI:
    v_pk_add_f32 v[104:105], v[104:105], v[106:107]
    v_pk_add_f32 v[108:109], v[108:109], v[110:111]
    v_add_f32 v126, v104, v105
    v_add_f32 v127, v108, v109
    v_pk_add_f32 v[126:127], v[126:127], v[112:113]
    v_cmp_u_f32 vcc, v126, v127
    s_cbranch_vccz GCOK
    s_add_u32 s51, s51, 1
    s_cmp_lt_u32 s51, 0x8000
    s_cbranch_scc1 GCP
GCOK:
    s_branch W20
SLOW0:
    buffer_store_dword v30, v28, s[16:19], s49 offen sc1
    s_branch PUBD0
SLOW1:
    buffer_store_dword v16, v14, s[16:19], s62 offen offset:0 sc1
    buffer_store_dword v20, v14, s[16:19], s62 offen offset:1024 sc1
    buffer_store_dword v24, v14, s[16:19], s62 offen offset:2048 sc1
    s_mov_b64 exec, 1
    buffer_store_dwordx2 v[28:29], v15, s[16:19], s62 offen sc1
    s_branch PUBD1
SLOW2:
    buffer_store_dword v24, v14, s[16:19], s62 offen sc1
    s_branch PUBD2
SLOW3:
    buffer_store_dwordx2 v[64:65], v75, s[16:19], s52 offen offset:0 sc1
    buffer_store_dwordx2 v[66:67], v75, s[16:19], s52 offen offset:512 sc1
    buffer_store_dwordx2 v[68:69], v75, s[16:19], s52 offen offset:1024 sc1
    s_branch PUBD3
SLOW4:
    buffer_store_dwordx2 v[64:65], v75, s[16:19], s52 offen offset:0 sc1
    buffer_store_dwordx2 v[66:67], v75, s[16:19], s52 offen offset:512 sc1
    buffer_store_dwordx2 v[68:69], v75, s[16:19], s52 offen offset:1024 sc1
    s_branch PUBD4
SLOW5:
    buffer_store_dwordx2 v[44:45], v46, s[16:19], s63 offen sc1
    s_branch PUBD5
SLOW6:
    buffer_store_dword v41, v14, s[16:19], s53 offen sc1
    s_branch PUBD6
SLOW7:
    buffer_store_dword v16, v56, s[16:19], s49 offen sc1
    s_branch PUBD7
SLOW8:
    buffer_store_dword v40, v14, s[16:19], s62 offen sc1
    s_mov_b64 exec, 1
    buffer_store_dwordx2 v[44:45], v15, s[16:19], s62 offen sc1
    s_branch PUBD8
CODEEND:
    s_endpgm
.section .rodata,"a"
.p2align 6
.amdhsa_kernel interleave_layers__sliding_block_cached__glu_gated_swiglu__decode_kernel
  .amdhsa_next_free_vgpr 512
  .amdhsa_next_free_sgpr 102
  .amdhsa_accum_offset 256
  .amdhsa_group_segment_fixed_size 0
  .amdhsa_kernarg_size 96
  .amdhsa_user_sgpr_count 2
  .amdhsa_user_sgpr_kernarg_segment_ptr 1
  .amdhsa_system_sgpr_workgroup_id_x 1
.end_amdhsa_kernel
```

```asm
; @launch grid=(256,1,1) block=(256,1,1) lds=108288
.amdgcn_target "amdgcn-amd-amdhsa--gfx950"
.text
.globl interleave_layers__sliding_block_cached__glu_gated_swiglu__decode_kernel
.p2align 8
.type interleave_layers__sliding_block_cached__glu_gated_swiglu__decode_kernel,@function
interleave_layers__sliding_block_cached__glu_gated_swiglu__decode_kernel:
    s_cmp_ge_u32 s2, 256
    s_cbranch_scc1 DONE
    s_load_dwordx16 s[64:79], s[0:1], 0
    s_load_dwordx8 s[80:87], s[0:1], 64
    s_memrealtime s[98:99]
    s_getpc_b64 s[60:61]
PCREF:
    v_lshlrev_b32 v14, 7, v0
    v_cmp_gt_u32 vcc, CODEEND-PCREF, v14
    v_mov_b32 v15, s61
    s_and_saveexec_b64 s[88:89], vcc
    s_cbranch_execz NOPF
    v_add_co_u32 v14, vcc, s60, v14
    s_nop 1
    v_addc_co_u32 v15, vcc, 0, v15, vcc
    global_load_dword v79, v[14:15], off
NOPF:
    s_mov_b64 exec, s[88:89]
    v_and_b32 v1, 63, v0
    v_lshrrev_b32 v13, 6, v0
    s_and_b32 s45, s2, 7
    v_readfirstlane_b32 s44, v13
    s_lshr_b32 s46, s2, 3
    s_lshr_b32 s7, s46, 3
    s_lshl_b32 s52, s45, 2
    s_add_u32 s47, s7, s52
    s_and_b32 s48, s46, 7
    v_lshrrev_b32 v19, 4, v1
    v_bfe_u32 v21, v1, 1, 3
    v_and_b32 v20, 1, v1
    v_mul_u32_u24 v80, 384, v21
    v_lshl_add_u32 v80, v20, 4, v80
    v_lshl_add_u32 v80, v19, 5, v80
    s_mul_i32 s52, s48, 3
    s_lshl_b32 s54, s44, 0
    s_add_u32 s52, s52, s54
    s_add_u32 s53, s48, 384
    s_cmp_eq_u32 s44, 3
    s_cselect_b32 s52, s53, s52
    s_cselect_b32 s97, 8, 24
    s_mulk_i32 s97, 3072
    s_mul_i32 s55, s47, 12582912
    s_mul_i32 s54, s52, 3072
    s_add_u32 s55, s55, s54
    s_add_u32 s55, s55, 11010048
    s_mov_b32 s96, s55
    s_waitcnt lgkmcnt(0)
    s_mov_b32 s8, s66
    s_and_b32 s9, s67, 0xffff
    s_mov_b32 s10, 402653184
    s_mov_b32 s11, 0x20000
    s_mov_b32 s6, 1
    s_mov_b32 s100, 0
    s_cmp_eq_u32 s44, 3
    s_cbranch_scc1 SETUP
    buffer_load_dwordx4 a[0:3], v80, s[8:11], s96 offen offset:0 nt
    buffer_load_dwordx4 a[8:11], v80, s[8:11], s96 offen offset:128 nt
    buffer_load_dwordx4 a[16:19], v80, s[8:11], s96 offen offset:256 nt
    s_add_u32 s96, s96, s97
    buffer_load_dwordx4 a[4:7], v80, s[8:11], s96 offen offset:0 nt
    buffer_load_dwordx4 a[12:15], v80, s[8:11], s96 offen offset:128 nt
    buffer_load_dwordx4 a[20:23], v80, s[8:11], s96 offen offset:256 nt
    s_add_u32 s96, s96, s97
    buffer_load_dwordx4 a[24:27], v80, s[8:11], s96 offen offset:0 nt
    buffer_load_dwordx4 a[32:35], v80, s[8:11], s96 offen offset:128 nt
    buffer_load_dwordx4 a[40:43], v80, s[8:11], s96 offen offset:256 nt
    s_add_u32 s96, s96, s97
SETUP:
    s_mov_b32 s16, s86
    s_and_b32 s17, s87, 0xffff
    s_mov_b32 s18, 1610612736
    s_mov_b32 s19, 0x20000
    s_mov_b32 s12, s68
    s_and_b32 s13, s69, 0xffff
    s_mov_b32 s14, 402653184
    s_mov_b32 s15, 0x20000
    s_mov_b32 s20, s70
    s_and_b32 s21, s71, 0xffff
    s_mov_b32 s22, 7864320
    s_mov_b32 s23, 0x20000
    s_mov_b32 s32, s64
    s_and_b32 s33, s65, 0xffff
    s_mov_b32 s34, 1280
    s_mov_b32 s35, 0x20000
    s_mov_b32 s36, s82
    s_and_b32 s37, s83, 0xffff
    s_mov_b32 s38, 1280
    s_mov_b32 s39, 0x20000
    s_mov_b32 s40, s84
    s_and_b32 s41, s85, 0xffff
    s_mov_b32 s42, 256
    s_mov_b32 s43, 0x20000
    v_mov_b32 v87, 1879048192
    v_mov_b32 v88, 1879048192
    s_cmp_lg_u32 s44, 3
    s_cbranch_scc1 SETUP2
    v_mov_b32 v32, -1
    v_mov_b32 v33, -1
    v_mov_b32 v34, -1
    v_mov_b32 v35, -1
    s_cmp_lg_u32 s2, 0
    s_cbranch_scc1 NONW
    s_or_b32 s98, s98, 0x10
    s_and_b32 s101, s98, 0xfffffff0
    v_mov_b32 v24, s101
    v_mov_b32 v25, 0
    s_mov_b64 exec, 1
    buffer_store_dword v24, v25, s[40:43], 0 offen sc1
    s_mov_b64 exec, -1
NONW:
    v_lshlrev_b32 v24, 4, v1
    v_lshlrev_b32 v27, 2, v1
    s_mul_i32 s52, s2, 1280
    buffer_store_dwordx4 v[32:35], v24, s[16:19], s52 offen sc1
    buffer_store_dword v32, v27, s[16:19], s52 offen offset:1024 sc1
    v_mov_b32 v26, 1879048192
    v_mov_b32 v88, v24
    v_cmp_gt_u32 vcc, 40, v1
    v_lshlrev_b32 v27, 2, v1
    buffer_load_dwordx4 v[44:47], v24, s[32:35], 0 offen
    buffer_load_dword v48, v27, s[32:35], 0 offen offset:1024
    v_cndmask_b32 v28, v26, v27, vcc
    s_mul_i32 s52, s48, 160
    buffer_load_dword v86, v28, s[32:35], s52 offen
    s_mul_i32 s52, s48, 320
    s_add_u32 s52, s52, 81920
    s_and_b32 s53, s2, 0xc7
    s_cmp_eq_u32 s53, 0
    s_cselect_b32 s52, s52, 1879048192
    v_lshl_add_u32 v87, v1, 3, s52
    v_cndmask_b32 v87, v26, v87, vcc
    v_add_u32 v24, 0, v1
    v_mul_u32_u24 v36, 171, v24
    v_lshrrev_b32 v36, 12, v36
    v_mul_u32_u24 v37, 24, v36
    v_sub_u32 v37, v24, v37
    v_and_b32 v24, 2, v36
    v_xor_b32 v37, v37, v24
    v_mul_u32_u24 v36, 12288, v36
    v_lshl_add_u32 v38, v37, 4, v36
    v_add_u32 v24, 64, v1
    v_mul_u32_u24 v36, 171, v24
    v_lshrrev_b32 v36, 12, v36
    v_mul_u32_u24 v37, 24, v36
    v_sub_u32 v37, v24, v37
    v_and_b32 v24, 2, v36
    v_xor_b32 v37, v37, v24
    v_mul_u32_u24 v36, 12288, v36
    v_lshl_add_u32 v39, v37, 4, v36
    v_add_u32 v24, 128, v1
    v_mul_u32_u24 v36, 171, v24
    v_lshrrev_b32 v36, 12, v36
    v_mul_u32_u24 v37, 24, v36
    v_sub_u32 v37, v24, v37
    v_and_b32 v24, 2, v36
    v_xor_b32 v37, v37, v24
    v_mul_u32_u24 v36, 12288, v36
    v_lshl_add_u32 v40, v37, 4, v36
    s_mul_i32 s52, s48, 983040
    s_mul_i32 s54, s47, 384
    s_add_u32 s52, s52, s54
    s_mov_b32 s53, 65536
WQL:
    s_add_u32 m0, s53, 0
    s_nop 0
    buffer_load_dwordx4 v38, s[20:23], s52 offen nt lds
    v_xor_b32 v38, 64, v38
    s_add_u32 m0, s53, 1024
    s_nop 0
    buffer_load_dwordx4 v39, s[20:23], s52 offen nt lds
    v_xor_b32 v39, 64, v39
    s_add_u32 m0, s53, 2048
    s_nop 0
    buffer_load_dwordx4 v40, s[20:23], s52 offen nt lds
    v_xor_b32 v40, 64, v40
    s_add_u32 s52, s52, 98304
    s_add_u32 s53, s53, 3072
    s_cmp_lt_u32 s53, 96256
    s_cbranch_scc1 WQL
    v_mov_b32 v37, 0
    buffer_load_dword v89, v37, s[40:43], 0 offen sc1
    s_barrier
    s_waitcnt vmcnt(31)
    v_mov_b32 v36, 0x3f803f80
    v_mov_b32 v37, v36
    v_cndmask_b32 v36, 0, v36, vcc
    v_add_u32 v27, 96256, v27
    ds_write_b32 v27, v36 offset:1024
    ds_write_b32 v27, v37 offset:1280
    ds_write_b32 v27, v86
    v_mov_b64 v[36:37], 0
    ds_write_b32 v27, v36 offset:10752
    ds_write_b32 v27, v36 offset:11008
    v_mov_b32 v38, 0x3f803f80
    v_dot2_f32_bf16 v36, v44, v44, v36
    v_dot2_f32_bf16 v37, v44, v38, v37
    v_dot2_f32_bf16 v36, v45, v45, v36
    v_dot2_f32_bf16 v37, v45, v38, v37
    v_dot2_f32_bf16 v36, v46, v46, v36
    v_dot2_f32_bf16 v37, v46, v38, v37
    v_dot2_f32_bf16 v36, v47, v47, v36
    v_dot2_f32_bf16 v37, v47, v38, v37
    v_dot2_f32_bf16 v36, v48, v48, v36
    v_dot2_f32_bf16 v37, v48, v38, v37
    s_nop 2
    v_add_f32_dpp v36, v36, v36 quad_perm:[1,0,3,2] row_mask:0xf bank_mask:0xf
    v_add_f32_dpp v37, v37, v37 quad_perm:[1,0,3,2] row_mask:0xf bank_mask:0xf
    s_nop 0
    v_add_f32_dpp v36, v36, v36 quad_perm:[2,3,0,1] row_mask:0xf bank_mask:0xf
    v_add_f32_dpp v37, v37, v37 quad_perm:[2,3,0,1] row_mask:0xf bank_mask:0xf
    s_nop 0
    v_add_f32_dpp v36, v36, v36 row_half_mirror row_mask:0xf bank_mask:0xf
    v_add_f32_dpp v37, v37, v37 row_half_mirror row_mask:0xf bank_mask:0xf
    s_nop 0
    v_add_f32_dpp v36, v36, v36 row_mirror row_mask:0xf bank_mask:0xf
    v_add_f32_dpp v37, v37, v37 row_mirror row_mask:0xf bank_mask:0xf
    s_nop 0
    v_mov_b32 v39, v36
    s_nop 1
    v_permlane16_swap_b32 v36, v39
    v_add_f32 v36, v36, v39
    v_mov_b32 v39, v37
    s_nop 1
    v_permlane16_swap_b32 v37, v39
    v_add_f32 v37, v37, v39
    v_mov_b32 v39, v36
    s_nop 1
    v_permlane32_swap_b32 v36, v39
    v_add_f32 v36, v36, v39
    v_mov_b32 v39, v37
    s_nop 1
    v_permlane32_swap_b32 v37, v39
    v_add_f32 v37, v37, v39
    v_mov_b32 v39, 0x3727c5ac
    v_mul_f32 v37, 0x3acccccd, v37
    v_fmamk_f32 v36, v36, 0x3acccccd, v39
    v_fma_f32 v36, -v37, v37, v36
    v_rsq_f32 v36, v36
    v_mov_b32 v84, v37
    v_mul_f32 v85, 0x3dd53b94, v36
SETUP2:
    s_mov_b32 s32, s72
    s_and_b32 s33, s73, 0xffff
    s_mov_b32 s34, 7864320
    s_mov_b32 s35, 0x20000
    s_cmp_ge_u32 s46, 10
    s_cselect_b32 s56, 1, 0
    s_cmp_ge_u32 s46, 20
    s_cselect_b32 s52, 2, s56
    s_mul_i32 s52, s52, 10
    s_sub_u32 s57, s46, s52
    s_min_u32 s4, s46, 29
    s_cmp_ge_u32 s4, 15
    s_cselect_b32 s58, 1, 0
    s_mul_i32 s52, s58, 15
    s_sub_u32 s52, s4, s52
    s_mul_i32 s59, s52, 52
    s_lshr_b32 s59, s59, 8
    s_mul_i32 s53, s59, 5
    s_sub_u32 s3, s52, s53
    s_cmp_ge_u32 s46, 20
    s_cselect_b32 s24, s80, s72
    s_cselect_b32 s25, s81, s73
    s_mov_b32 s26, 7864320
    s_cselect_b32 s26, 1966080, s26
    s_and_b32 s25, s25, 0xffff
    s_mov_b32 s27, 0x20000
    s_cmp_eq_u32 s58, 1
    s_cselect_b32 s28, s78, s76
    s_cselect_b32 s29, s79, s77
    s_and_b32 s29, s29, 0xffff
    s_mov_b32 s30, 1966080
    s_mov_b32 s31, 0x20000
    s_mov_b32 s49, 0
    s_mul_i32 s63, s45, 45312
    s_add_u32 s63, s63, 414720
    s_mul_i32 s62, s45, 28160
    s_add_u32 s62, s62, 87040
    s_mov_b32 s50, 0
    v_and_b32 v24, 15, v1
    v_cmp_eq_u32 vcc, 1, v24
    v_mov_b32 v25, 96256
    v_mov_b32 v26, 97280
    v_cndmask_b32 v2, v25, v26, vcc
    v_lshl_add_u32 v2, v19, 4, v2
    v_and_b32 v24, 3, v1
    v_lshlrev_b32 v24, 4, v24
    v_and_b32 v25, 1, v19
    v_lshl_add_u32 v24, v25, 6, v24
    v_add_u32 v24, 98304, v24
    v_bfe_u32 v25, v1, 2, 2
    v_lshrrev_b32 v27, 5, v1
    v_sub_u32 v25, v25, v27
    v_mov_b32 v26, 107008
    v_cmp_eq_u32 vcc, 0, v25
    s_nop 1
    v_cndmask_b32 v3, v26, v24, vcc
    v_cmp_eq_u32 vcc, 2, v25
    s_nop 1
    v_cndmask_b32 v4, v26, v24, vcc
    v_and_b32 v24, 3, v1
    v_cmp_eq_u32 vcc, 3, v24
    v_mov_b32 v25, 0xffff
    v_mov_b32 v26, 0xffff0000
    v_cndmask_b32 v25, v25, v26, vcc
    v_cndmask_b32 v24, v24, 0, vcc
    v_or_b32 v24, 12, v24
    v_mul_u32_u24 v24, 0x1111, v24
    v_mul_u32_u24 v26, 0xaaaa, v20
    v_add_u32 v26, 0x4444, v26
    v_lshl_add_u32 v7, v24, 16, v26
    v_and_b32 v24, 4, v1
    v_cmp_eq_u32 vcc, 0, v24
    s_nop 1
    v_cndmask_b32 v5, 0, v25, vcc
    v_cndmask_b32 v6, v25, 0, vcc
    v_mul_u32_u24 v82, s97, v27
    v_bfe_u32 v24, v1, 3, 1
    v_mul_u32_u24 v24, 1536, v24
    v_add_u32 v82, v82, v24
    v_and_b32 v24, 1, v19
    v_mul_u32_u24 v24, 768, v24
    v_add_u32 v82, v82, v24
    v_and_b32 v24, 7, v1
    v_lshl_add_u32 v82, v24, 4, v82
    s_mul_i32 s52, s7, 6144
    s_add_u32 s52, s52, 20480
    v_lshl_add_u32 v8, v0, 4, s52
    s_lshl_b32 s52, s7, 6
    s_add_u32 s52, s52, 45056
    v_lshl_add_u32 v9, v24, 3, s52
    v_and_b32 v10, 0xe1, v0
    v_lshlrev_b32 v10, 1, v10
    v_bfe_u32 v24, v0, 4, 1
    v_lshl_add_u32 v10, v24, 3, v10
    v_bfe_u32 v24, v0, 3, 1
    v_lshl_add_u32 v10, v24, 5, v10
    v_bfe_u32 v24, v0, 2, 1
    v_lshl_add_u32 v10, v24, 2, v10
    v_bfe_u32 v24, v0, 1, 1
    v_lshl_add_u32 v10, v24, 4, v10
    v_add_u32 v10, 98304, v10
    v_mov_b32 v11, 0x3727c5ac
    v_mov_b32 v12, 98752
    s_cmp_lg_u32 s44, 3
    s_cbranch_scc1 KBAR
    s_mov_b32 s51, 0
    v_mov_b32 v37, 0
NOP:
    s_waitcnt vmcnt(0)
    v_readfirstlane_b32 s5, v89
    s_cmp_lg_u32 s5, 0
    s_cbranch_scc1 NOOK
    buffer_load_dword v89, v37, s[40:43], 0 offen sc1
    s_add_u32 s51, s51, 1
    s_sleep 4
    s_cmp_lt_u32 s51, 0x8000
    s_cbranch_scc1 NOP
NOOK:
    s_getreg_b32 s52, hwreg(HW_REG_XCC_ID)
    s_and_b32 s52, s52, 15
    s_or_b32 s5, s5, s52
    v_mov_b32 v36, s5
    s_lshl_b32 s52, s45, 7
    s_lshl_b32 s54, s46, 2
    s_add_u32 s52, s52, s54
    s_add_u32 s52, s52, 1376256
    s_mov_b64 exec, 1
    buffer_store_dword v36, v37, s[16:19], s52 offen sc1
    s_mov_b64 exec, -1
    s_mov_b32 s44, 0
    s_branch LOOP
KBAR:
    s_barrier
    s_waitcnt vmcnt(8)
    buffer_load_dwordx4 a[28:31], v80, s[8:11], s96 offen offset:0 nt
    s_waitcnt vmcnt(8)
    buffer_load_dwordx4 a[36:39], v80, s[8:11], s96 offen offset:128 nt
    s_waitcnt vmcnt(8)
    buffer_load_dwordx4 a[44:47], v80, s[8:11], s96 offen offset:256 nt
    s_add_u32 s96, s96, s97
    s_waitcnt vmcnt(8)
    buffer_load_dwordx4 a[48:51], v80, s[8:11], s96 offen offset:0 nt
    s_waitcnt vmcnt(8)
    buffer_load_dwordx4 a[56:59], v80, s[8:11], s96 offen offset:128 nt
    s_waitcnt vmcnt(8)
    buffer_load_dwordx4 a[64:67], v80, s[8:11], s96 offen offset:256 nt
    s_add_u32 s96, s96, s97
    s_waitcnt vmcnt(8)
    buffer_load_dwordx4 a[52:55], v80, s[8:11], s96 offen offset:0 nt
    s_waitcnt vmcnt(8)
    buffer_load_dwordx4 a[60:63], v80, s[8:11], s96 offen offset:128 nt
    s_waitcnt vmcnt(8)
    buffer_load_dwordx4 a[68:71], v80, s[8:11], s96 offen offset:256 nt
    s_add_u32 s96, s96, s97
    s_waitcnt vmcnt(8)
    buffer_load_dwordx4 a[72:75], v80, s[8:11], s96 offen offset:0 nt
    s_waitcnt vmcnt(8)
    buffer_load_dwordx4 a[80:83], v80, s[8:11], s96 offen offset:128 nt
    s_waitcnt vmcnt(8)
    buffer_load_dwordx4 a[88:91], v80, s[8:11], s96 offen offset:256 nt
    s_add_u32 s96, s96, s97
    s_waitcnt vmcnt(8)
    buffer_load_dwordx4 a[76:79], v80, s[8:11], s96 offen offset:0 nt
    s_waitcnt vmcnt(8)
    buffer_load_dwordx4 a[84:87], v80, s[8:11], s96 offen offset:128 nt
    s_waitcnt vmcnt(8)
    buffer_load_dwordx4 a[92:95], v80, s[8:11], s96 offen offset:256 nt
    s_add_u32 s96, s96, s97
    s_waitcnt vmcnt(8)
    buffer_load_dwordx4 a[96:99], v80, s[8:11], s96 offen offset:0 nt
    s_waitcnt vmcnt(8)
    buffer_load_dwordx4 a[104:107], v80, s[8:11], s96 offen offset:128 nt
    s_waitcnt vmcnt(8)
    buffer_load_dwordx4 a[112:115], v80, s[8:11], s96 offen offset:256 nt
    s_add_u32 s96, s96, s97
    s_waitcnt vmcnt(8)
    buffer_load_dwordx4 a[100:103], v80, s[8:11], s96 offen offset:0 nt
    s_waitcnt vmcnt(8)
    buffer_load_dwordx4 a[108:111], v80, s[8:11], s96 offen offset:128 nt
    s_waitcnt vmcnt(8)
    buffer_load_dwordx4 a[116:119], v80, s[8:11], s96 offen offset:256 nt
    s_add_u32 s96, s96, s97
    s_waitcnt vmcnt(8)
    buffer_load_dwordx4 a[120:123], v80, s[8:11], s96 offen offset:0 nt
    s_waitcnt vmcnt(8)
    buffer_load_dwordx4 a[128:131], v80, s[8:11], s96 offen offset:128 nt
    s_waitcnt vmcnt(8)
    buffer_load_dwordx4 a[136:139], v80, s[8:11], s96 offen offset:256 nt
    s_add_u32 s96, s96, s97
    s_waitcnt vmcnt(8)
    buffer_load_dwordx4 a[124:127], v80, s[8:11], s96 offen offset:0 nt
    s_waitcnt vmcnt(8)
    buffer_load_dwordx4 a[132:135], v80, s[8:11], s96 offen offset:128 nt
    s_waitcnt vmcnt(8)
    buffer_load_dwordx4 a[140:143], v80, s[8:11], s96 offen offset:256 nt
    s_add_u32 s96, s96, s97
    s_waitcnt vmcnt(8)
    buffer_load_dwordx4 a[144:147], v80, s[8:11], s96 offen offset:0 nt
    s_waitcnt vmcnt(8)
    buffer_load_dwordx4 a[152:155], v80, s[8:11], s96 offen offset:128 nt
    s_waitcnt vmcnt(8)
    buffer_load_dwordx4 a[160:163], v80, s[8:11], s96 offen offset:256 nt
    s_add_u32 s96, s96, s97
    s_waitcnt vmcnt(8)
    buffer_load_dwordx4 a[148:151], v80, s[8:11], s96 offen offset:0 nt
    s_waitcnt vmcnt(8)
    buffer_load_dwordx4 a[156:159], v80, s[8:11], s96 offen offset:128 nt
    s_waitcnt vmcnt(8)
    buffer_load_dwordx4 a[164:167], v80, s[8:11], s96 offen offset:256 nt
    s_add_u32 s96, s96, s97
    s_waitcnt vmcnt(8)
    buffer_load_dwordx4 a[168:171], v80, s[8:11], s96 offen offset:0 nt
    s_waitcnt vmcnt(8)
    buffer_load_dwordx4 a[176:179], v80, s[8:11], s96 offen offset:128 nt
    s_waitcnt vmcnt(8)
    buffer_load_dwordx4 a[184:187], v80, s[8:11], s96 offen offset:256 nt
    s_add_u32 s96, s96, s97
    s_waitcnt vmcnt(8)
    buffer_load_dwordx4 a[172:175], v80, s[8:11], s96 offen offset:0 nt
    s_waitcnt vmcnt(8)
    buffer_load_dwordx4 a[180:183], v80, s[8:11], s96 offen offset:128 nt
    s_waitcnt vmcnt(8)
    buffer_load_dwordx4 a[188:191], v80, s[8:11], s96 offen offset:256 nt
    s_lshl_b32 s97, s97, 1
    s_waitcnt vmcnt(8)
    buffer_load_dwordx4 a[192:195], v82, s[12:15], s55 offen offset:0 nt
    s_waitcnt vmcnt(8)
    buffer_load_dwordx4 a[200:203], v82, s[12:15], s55 offen offset:128 nt
    s_waitcnt vmcnt(8)
    buffer_load_dwordx4 a[208:211], v82, s[12:15], s55 offen offset:256 nt
    s_waitcnt vmcnt(8)
    buffer_load_dwordx4 a[216:219], v82, s[12:15], s55 offen offset:384 nt
    s_waitcnt vmcnt(8)
    buffer_load_dwordx4 a[224:227], v82, s[12:15], s55 offen offset:512 nt
    s_waitcnt vmcnt(8)
    buffer_load_dwordx4 a[232:235], v82, s[12:15], s55 offen offset:640 nt
    s_add_u32 s55, s55, s97
    s_waitcnt vmcnt(8)
    buffer_load_dwordx4 a[196:199], v82, s[12:15], s55 offen offset:0 nt
    s_waitcnt vmcnt(8)
    buffer_load_dwordx4 a[204:207], v82, s[12:15], s55 offen offset:128 nt
    s_waitcnt vmcnt(8)
    buffer_load_dwordx4 a[212:215], v82, s[12:15], s55 offen offset:256 nt
    s_waitcnt vmcnt(8)
    buffer_load_dwordx4 a[220:223], v82, s[12:15], s55 offen offset:384 nt
    s_waitcnt vmcnt(8)
    buffer_load_dwordx4 a[228:231], v82, s[12:15], s55 offen offset:512 nt
    s_waitcnt vmcnt(8)
    buffer_load_dwordx4 a[236:239], v82, s[12:15], s55 offen offset:640 nt
    s_add_u32 s55, s55, s97
    s_waitcnt vmcnt(8)
    buffer_load_dwordx4 a[240:243], v82, s[12:15], s55 offen offset:0 nt
    s_waitcnt vmcnt(8)
    buffer_load_dwordx4 a[248:251], v82, s[12:15], s55 offen offset:128 nt
    s_waitcnt vmcnt(8)
    buffer_load_dwordx4 v[128:131], v82, s[12:15], s55 offen offset:256 nt
    s_waitcnt vmcnt(8)
    buffer_load_dwordx4 v[136:139], v82, s[12:15], s55 offen offset:384 nt
    s_waitcnt vmcnt(8)
    buffer_load_dwordx4 v[144:147], v82, s[12:15], s55 offen offset:512 nt
    s_waitcnt vmcnt(8)
    buffer_load_dwordx4 v[152:155], v82, s[12:15], s55 offen offset:640 nt
    s_add_u32 s55, s55, s97
    s_waitcnt vmcnt(8)
    buffer_load_dwordx4 a[244:247], v82, s[12:15], s55 offen offset:0 nt
    s_waitcnt vmcnt(8)
    buffer_load_dwordx4 a[252:255], v82, s[12:15], s55 offen offset:128 nt
    s_waitcnt vmcnt(8)
    buffer_load_dwordx4 v[132:135], v82, s[12:15], s55 offen offset:256 nt
    s_waitcnt vmcnt(8)
    buffer_load_dwordx4 v[140:143], v82, s[12:15], s55 offen offset:384 nt
    s_waitcnt vmcnt(8)
    buffer_load_dwordx4 v[148:151], v82, s[12:15], s55 offen offset:512 nt
    s_waitcnt vmcnt(8)
    buffer_load_dwordx4 v[156:159], v82, s[12:15], s55 offen offset:640 nt
    s_add_u32 s55, s55, s97
    s_waitcnt vmcnt(8)
    buffer_load_dwordx4 v[160:163], v82, s[12:15], s55 offen offset:0 nt
    s_waitcnt vmcnt(8)
    buffer_load_dwordx4 v[168:171], v82, s[12:15], s55 offen offset:128 nt
    s_waitcnt vmcnt(8)
    buffer_load_dwordx4 v[176:179], v82, s[12:15], s55 offen offset:256 nt
    s_waitcnt vmcnt(8)
    buffer_load_dwordx4 v[184:187], v82, s[12:15], s55 offen offset:384 nt
    s_waitcnt vmcnt(8)
    buffer_load_dwordx4 v[192:195], v82, s[12:15], s55 offen offset:512 nt
    s_waitcnt vmcnt(8)
    buffer_load_dwordx4 v[200:203], v82, s[12:15], s55 offen offset:640 nt
    s_add_u32 s55, s55, s97
    s_waitcnt vmcnt(8)
    buffer_load_dwordx4 v[164:167], v82, s[12:15], s55 offen offset:0 nt
    s_waitcnt vmcnt(8)
    buffer_load_dwordx4 v[172:175], v82, s[12:15], s55 offen offset:128 nt
    s_waitcnt vmcnt(8)
    buffer_load_dwordx4 v[180:183], v82, s[12:15], s55 offen offset:256 nt
    s_waitcnt vmcnt(8)
    buffer_load_dwordx4 v[188:191], v82, s[12:15], s55 offen offset:384 nt
    s_waitcnt vmcnt(8)
    buffer_load_dwordx4 v[196:199], v82, s[12:15], s55 offen offset:512 nt
    s_waitcnt vmcnt(8)
    buffer_load_dwordx4 v[204:207], v82, s[12:15], s55 offen offset:640 nt
    s_add_u32 s55, s55, s97
    s_waitcnt vmcnt(8)
    buffer_load_dwordx4 v[208:211], v82, s[12:15], s55 offen offset:0 nt
    s_waitcnt vmcnt(8)
    buffer_load_dwordx4 v[216:219], v82, s[12:15], s55 offen offset:128 nt
    s_waitcnt vmcnt(8)
    buffer_load_dwordx4 v[224:227], v82, s[12:15], s55 offen offset:256 nt
    s_waitcnt vmcnt(8)
    buffer_load_dwordx4 v[232:235], v82, s[12:15], s55 offen offset:384 nt
    s_waitcnt vmcnt(8)
    buffer_load_dwordx4 v[240:243], v82, s[12:15], s55 offen offset:512 nt
    s_waitcnt vmcnt(8)
    buffer_load_dwordx4 v[248:251], v82, s[12:15], s55 offen offset:640 nt
    s_add_u32 s55, s55, s97
    s_waitcnt vmcnt(8)
    buffer_load_dwordx4 v[212:215], v82, s[12:15], s55 offen offset:0 nt
    s_waitcnt vmcnt(8)
    buffer_load_dwordx4 v[220:223], v82, s[12:15], s55 offen offset:128 nt
    s_waitcnt vmcnt(8)
    buffer_load_dwordx4 v[228:231], v82, s[12:15], s55 offen offset:256 nt
    s_barrier
    s_waitcnt vmcnt(8)
    buffer_load_dwordx4 v[236:239], v82, s[12:15], s55 offen offset:384 nt
    s_waitcnt vmcnt(8)
    buffer_load_dwordx4 v[244:247], v82, s[12:15], s55 offen offset:512 nt
    s_waitcnt vmcnt(8)
    buffer_load_dwordx4 v[252:255], v82, s[12:15], s55 offen offset:640 nt
    s_branch ENTRY
LOOP:
    v_and_b32 v16, 3, v1
    v_lshrrev_b32 v17, 4, v1
    v_bfe_u32 v18, v1, 2, 2
    v_lshlrev_b32 v16, 3, v16
    v_mul_u32_u24 v18, 384, v18
    v_add_u32 v16, v16, v18
    v_bfe_u32 v18, v1, 3, 2
    v_xor_b32 v18, s44, v18
    v_lshl_add_u32 v16, v18, 5, v16
    v_add_u32 v16, 65536, v16
    v_and_b32 v18, 1, v17
    v_mul_u32_u24 v17, 3072, v17
    v_mul_u32_u24 v18, 3072, v18
    v_add_u32 v17, v17, v16
    v_add_u32 v18, v18, v16
    ds_read_b64_tr_b16 v[44:45], v17 offset:0
    ds_read_b64_tr_b16 v[46:47], v17 offset:1536
    ds_read_b64_tr_b16 v[56:57], v17 offset:128
    ds_read_b64_tr_b16 v[58:59], v17 offset:1664
    ds_read_b64_tr_b16 v[68:69], v17 offset:256
    ds_read_b64_tr_b16 v[70:71], v17 offset:1792
    ds_read_b64_tr_b16 v[48:49], v17 offset:12288
    ds_read_b64_tr_b16 v[50:51], v17 offset:13824
    ds_read_b64_tr_b16 v[60:61], v17 offset:12416
    ds_read_b64_tr_b16 v[62:63], v17 offset:13952
    ds_read_b64_tr_b16 v[72:73], v17 offset:12544
    ds_read_b64_tr_b16 v[74:75], v17 offset:14080
    ds_read_b64_tr_b16 v[52:53], v18 offset:24576
    ds_read_b64_tr_b16 v[54:55], v18 offset:26112
    ds_read_b64_tr_b16 v[64:65], v18 offset:24704
    ds_read_b64_tr_b16 v[66:67], v18 offset:26240
    ds_read_b64_tr_b16 v[76:77], v18 offset:24832
    ds_read_b64_tr_b16 v[78:79], v18 offset:26368
    s_cmp_lg_u32 s6, 0
    s_cbranch_scc1 QA0
    v_and_b32 v29, 31, v1
    v_lshl_add_u32 v29, s44, 5, v29
    s_cmp_eq_u32 s44, 3
    s_cbranch_scc1 Y2N
    v_min_u32 v20, 79, v29
    s_mul_i32 s52, s48, 80
    v_add_u32 v20, s52, v20
    v_lshrrev_b32 v26, 4, v20
    v_and_b32 v20, 15, v20
    v_lshlrev_b32 v26, 10, v26
    v_lshl_add_u32 v26, v20, 2, v26
    v_lshrrev_b32 v20, 5, v1
    v_lshl_add_u32 v26, v20, 9, v26
    v_add_u32 v26, 40960, v26
    s_sub_u32 s52, s46, 20
    s_cmp_ge_u32 s52, 10
    s_cbranch_scc1 HOOKL
    s_sleep 8
GYB:
    buffer_load_dword v22, v26, s[16:19], s49 offen offset:0 sc1
    buffer_load_dword v23, v26, s[16:19], s49 offen offset:128 sc1
    buffer_load_dword v24, v26, s[16:19], s49 offen offset:256 sc1
    buffer_load_dword v25, v26, s[16:19], s49 offen offset:384 sc1
Y2N:
    s_lshr_b32 s53, s48, 2
    s_mul_i32 s52, s7, 6144
    s_lshl_b32 s54, s44, 8
    s_add_u32 s52, s52, s54
    s_mul_i32 s54, s53, 3056
    s_add_u32 s52, s52, s54
    s_lshl_b32 s54, s48, 2
    s_add_u32 s52, s52, s54
    s_add_u32 s52, s52, 20480
    v_lshl_add_u32 v14, v1, 4, s52
    s_lshl_b32 s52, s7, 6
    s_lshl_b32 s54, s48, 3
    s_add_u32 s52, s52, s54
    s_add_u32 s52, s52, 45056
    v_mov_b32 v15, s52
    s_mul_i32 s52, s48, 320
    s_add_u32 s52, s52, 81920
    s_and_b32 s53, s2, 0xc7
    s_cmp_eq_u32 s53, 0
    s_cselect_b32 s52, s52, 1879048192
    v_lshl_add_u32 v28, v29, 2, s52
    v_lshlrev_b32 v19, 1, v29
    v_add_u32 v19, 96256, v19
    v_cmp_gt_u32 vcc, 80, v29
    s_mov_b64 s[60:61], vcc
    s_mov_b32 s51, 0
    s_cmp_eq_u32 s44, 3
    s_cbranch_scc1 Y2OK
    s_branch Y2W
Y2P:
    buffer_load_dword v22, v26, s[16:19], s49 offen offset:0 sc1
    buffer_load_dword v23, v26, s[16:19], s49 offen offset:128 sc1
    buffer_load_dword v24, v26, s[16:19], s49 offen offset:256 sc1
    buffer_load_dword v25, v26, s[16:19], s49 offen offset:384 sc1
Y2W:
    s_waitcnt vmcnt(0)
    v_pk_add_f32 v[22:23], v[22:23], v[24:25]
    v_add_f32 v30, v22, v23
    v_mov_b32 v31, v30
    s_nop 1
    v_permlane32_swap_b32 v30, v31
    v_add_f32 v30, v30, v31
    v_cmp_u_f32 vcc, v30, v30
    s_cbranch_vccz Y2OK
    s_add_u32 s51, s51, 1
    s_sleep 1
    s_cmp_lt_u32 s51, 0x8000
    s_cbranch_scc1 Y2P
Y2OK:
    s_cmp_lg_u32 s49, 0
    s_cbranch_scc1 FINAL
    s_mov_b32 s49, 327680
    s_mov_b32 s62, s63
    s_cmp_eq_u32 s44, 3
    s_cbranch_scc1 QX
    v_cvt_pk_bf16_f32 v30, v30, v30
    v_cndmask_b32 v30, 0, v30, s[60:61]
    ds_write_b16 v19, v30
    v_and_b32 v30, 0xffff0000, v30
    s_mov_b32 exec_lo, s60
    s_mov_b32 exec_hi, 0
    s_cmp_eq_u32 s50, 0
    s_cbranch_scc1 SLOW0
    buffer_store_dword v30, v28, s[16:19], s49 offen
PUBD0:
    s_mov_b64 exec, -1
QX:
    s_waitcnt lgkmcnt(0)
    s_barrier
QA0:
    ds_read_b128 v[32:35], v2 offset:0
    ds_read_b128 v[36:39], v2 offset:64
    ds_read_b128 v[40:43], v2 offset:128
    s_waitcnt lgkmcnt(2)
    v_mfma_f32_16x16x32_bf16 v[28:31], v[32:35], v[32:35], 0
    v_mfma_f32_16x16x32_bf16 v[16:19], v[32:35], v[44:47], 0
    v_mfma_f32_16x16x32_bf16 v[20:23], v[32:35], v[56:59], 0
    v_mfma_f32_16x16x32_bf16 v[24:27], v[32:35], v[68:71], 0
    s_waitcnt lgkmcnt(1)
    v_mfma_f32_16x16x32_bf16 v[28:31], v[36:39], v[36:39], v[28:31]
    v_mfma_f32_16x16x32_bf16 v[16:19], v[36:39], v[48:51], v[16:19]
    v_mfma_f32_16x16x32_bf16 v[20:23], v[36:39], v[60:63], v[20:23]
    v_mfma_f32_16x16x32_bf16 v[24:27], v[36:39], v[72:75], v[24:27]
    s_waitcnt lgkmcnt(0)
    v_mfma_f32_16x16x32_bf16 v[16:19], v[40:43], v[52:55], v[16:19]
    v_mfma_f32_16x16x32_bf16 v[20:23], v[40:43], v[64:67], v[20:23]
    v_mfma_f32_16x16x32_bf16 v[24:27], v[40:43], v[76:79], v[24:27]
    v_mfma_f32_16x16x32_bf16 v[28:31], v[40:43], v[40:43], v[28:31]
    s_mov_b64 exec, 0xffff
    s_cmp_lg_u32 s6, 0
    s_cbranch_scc1 HOOKA
    s_cmp_eq_u32 s50, 0
    s_cbranch_scc1 SLOW1
    buffer_store_dword v16, v14, s[16:19], s62 offen offset:0
    buffer_store_dword v20, v14, s[16:19], s62 offen offset:1024
    buffer_store_dword v24, v14, s[16:19], s62 offen offset:2048
    s_mov_b64 exec, 1
    buffer_store_dwordx2 v[28:29], v15, s[16:19], s62 offen
PUBD1:
    s_mov_b64 exec, -1
ENTRY:
    s_mov_b32 s51, 0
    v_mov_b64 v[64:65], 0
    v_mov_b64 v[66:67], 0
    v_mov_b64 v[68:69], 0
    v_mov_b64 v[70:71], 0
    v_mov_b64 v[72:73], 0
    v_mov_b64 v[74:75], 0
    v_mov_b64 v[76:77], 0
    v_mov_b64 v[78:79], 0
    s_cmp_eq_u32 s49, 0
    s_cselect_b32 s53, 3, s44
    s_cmp_eq_u32 s53, 3
    s_cbranch_scc1 EN0
    s_nop 15
    buffer_load_dwordx2 v[62:63], v9, s[16:19], s62 offen sc1
    buffer_load_dwordx4 v[44:47], v8, s[16:19], s62 offen offset:0 sc1
    buffer_load_dwordx4 v[48:51], v8, s[16:19], s62 offen offset:3072 sc1
EN0:
    v_lshrrev_b32 v14, 2, v1
    v_lshlrev_b32 v14, 7, v14
    v_and_b32 v15, 3, v1
    v_lshl_add_u32 v14, v15, 2, v14
    s_mul_i32 s52, s7, 3072
    s_mul_i32 s54, s44, 768
    s_add_u32 s52, s52, s54
    s_lshl_b32 s54, s48, 4
    s_add_u32 s52, s52, s54
    v_add_u32 v14, s52, v14
    s_lshl_b32 s52, s7, 5
    s_lshl_b32 s54, s48, 2
    s_add_u32 s52, s52, s54
    s_add_u32 s52, s52, 19968
    v_writelane_b32 v14, s52, 24
    v_and_b32 v15, 7, v1
    v_lshlrev_b32 v15, 5, v15
    v_bfe_u32 v61, v1, 4, 1
    v_lshl_add_u32 v15, v61, 4, v15
    v_lshrrev_b32 v61, 5, v1
    v_mul_u32_u24 v61, 768, v61
    v_add_u32 v15, v15, v61
    s_mul_i32 s52, s44, 1536
    s_add_u32 s52, s52, 98816
    v_add_u32 v15, s52, v15
    s_mul_i32 s52, s44, 192
    s_add_u32 s52, s52, 98816
    v_min_u32 v60, 23, v1
    v_lshl_add_u32 v60, v60, 3, s52
    s_lshl_b32 s52, s44, 3
    s_add_u32 s52, s52, 98752
    v_mov_b32 v61, s52
    s_cmp_eq_u32 s49, 0
    s_cbranch_scc1 HOOKE
    s_cmp_eq_u32 s53, 3
    s_cbranch_scc1 ENOK2
    s_nop 5
ENP:
    buffer_load_dwordx2 v[62:63], v9, s[16:19], s62 offen sc1
    buffer_load_dwordx4 v[44:47], v8, s[16:19], s62 offen offset:0 sc1
    buffer_load_dwordx4 v[48:51], v8, s[16:19], s62 offen offset:3072 sc1
    s_waitcnt vmcnt(3)
    v_add_f32_dpp v32, v62, v62 quad_perm:[1,0,3,2] row_mask:0xf bank_mask:0xf
    v_add_f32_dpp v33, v63, v63 quad_perm:[1,0,3,2] row_mask:0xf bank_mask:0xf
    v_pk_add_f32 v[16:17], v[44:45], v[46:47]
    v_add_f32_dpp v32, v32, v32 quad_perm:[2,3,0,1] row_mask:0xf bank_mask:0xf
    v_add_f32_dpp v33, v33, v33 quad_perm:[2,3,0,1] row_mask:0xf bank_mask:0xf
    v_pk_add_f32 v[20:21], v[48:49], v[50:51]
    v_add_f32_dpp v32, v32, v32 row_half_mirror row_mask:0xf bank_mask:0xf
    v_add_f32_dpp v33, v33, v33 row_half_mirror row_mask:0xf bank_mask:0xf
    v_pk_add_f32 v[16:17], v[16:17], v[20:21]
    v_mul_f32 v33, 0x3acccccd, v33
    v_fmamk_f32 v32, v32, 0x3acccccd, v11
    v_fma_f32 v32, -v33, v33, v32
    v_rsq_f32 v32, v32
    v_add_f32 v16, v16, v17
    v_mul_f32 v32, 0x3dd53b94, v32
    v_fma_f32 v16, -v33, v13, v16
    v_mul_f32 v16, v16, v32
    v_cmp_u_f32 vcc, v16, v16
    s_cbranch_vccz ENOK
    s_add_u32 s51, s51, 1
    s_cmp_lt_u32 s51, 0x8000
    s_cbranch_scc1 ENP
ENOK:
    v_cvt_pk_bf16_f32 v16, v16, v16
    ds_write_b16 v10, v16
ENOK2:
    s_waitcnt lgkmcnt(0)
    s_barrier
QFRAG:
    ds_read_b128 v[16:19], v3 offset:0
    ds_read_b128 v[20:23], v3 offset:128
    ds_read_b128 v[24:27], v3 offset:256
    ds_read_b128 v[28:31], v4 offset:0
    ds_read_b128 v[32:35], v4 offset:128
    ds_read_b128 v[36:39], v4 offset:256
    s_cmp_eq_u32 s49, 0
    s_cbranch_scc1 HOOKF
    s_waitcnt vmcnt(0)
QK:
    v_mov_b64 v[40:41], 0
    v_mov_b64 v[42:43], 0
    v_mov_b64 v[44:45], 0
    v_mov_b64 v[46:47], 0
    v_mov_b64 v[48:49], 0
    v_mov_b64 v[50:51], 0
    s_waitcnt lgkmcnt(5)
    v_smfmac_f32_16x16x64_bf16 v[64:67], v[16:19], a[0:7], v7
    s_waitcnt lgkmcnt(4)
    v_smfmac_f32_16x16x64_bf16 v[64:67], v[20:23], a[8:15], v7
    s_waitcnt lgkmcnt(3)
    v_smfmac_f32_16x16x64_bf16 v[64:67], v[24:27], a[16:23], v7
    s_waitcnt lgkmcnt(2)
    v_smfmac_f32_16x16x64_bf16 v[64:67], v[28:31], a[24:31], v7
    s_waitcnt lgkmcnt(1)
    v_smfmac_f32_16x16x64_bf16 v[64:67], v[32:35], a[32:39], v7
    s_waitcnt lgkmcnt(0)
    v_smfmac_f32_16x16x64_bf16 v[64:67], v[36:39], a[40:47], v7
    v_smfmac_f32_16x16x64_bf16 v[68:71], v[16:19], a[48:55], v7
    v_smfmac_f32_16x16x64_bf16 v[68:71], v[20:23], a[56:63], v7
    v_smfmac_f32_16x16x64_bf16 v[68:71], v[24:27], a[64:71], v7
    v_smfmac_f32_16x16x64_bf16 v[68:71], v[28:31], a[72:79], v7
    v_smfmac_f32_16x16x64_bf16 v[68:71], v[32:35], a[80:87], v7
    v_smfmac_f32_16x16x64_bf16 v[68:71], v[36:39], a[88:95], v7
    v_smfmac_f32_16x16x64_bf16 v[72:75], v[16:19], a[96:103], v7
    v_smfmac_f32_16x16x64_bf16 v[72:75], v[20:23], a[104:111], v7
    v_smfmac_f32_16x16x64_bf16 v[72:75], v[24:27], a[112:119], v7
    v_mov_b32_dpp v52, v64 quad_perm:[0,0,2,2] row_mask:0xf bank_mask:0xf
    v_smfmac_f32_16x16x64_bf16 v[72:75], v[28:31], a[120:127], v7
    v_add_f32_dpp v52, v65, v52 quad_perm:[0,0,2,2] row_mask:0xf bank_mask:0xf
    v_smfmac_f32_16x16x64_bf16 v[72:75], v[32:35], a[128:135], v7
    v_add_f32_dpp v52, v66, v52 quad_perm:[1,1,3,3] row_mask:0xf bank_mask:0xf
    v_smfmac_f32_16x16x64_bf16 v[72:75], v[36:39], a[136:143], v7
    v_add_f32_dpp v52, v67, v52 quad_perm:[1,1,3,3] row_mask:0xf bank_mask:0xf
    v_smfmac_f32_16x16x64_bf16 v[76:79], v[16:19], a[144:151], v7
    v_smfmac_f32_16x16x64_bf16 v[76:79], v[20:23], a[152:159], v7
    v_smfmac_f32_16x16x64_bf16 v[76:79], v[24:27], a[160:167], v7
    v_mov_b32_dpp v53, v68 quad_perm:[0,0,2,2] row_mask:0xf bank_mask:0xf
    v_smfmac_f32_16x16x64_bf16 v[76:79], v[28:31], a[168:175], v7
    v_add_f32_dpp v53, v69, v53 quad_perm:[0,0,2,2] row_mask:0xf bank_mask:0xf
    v_smfmac_f32_16x16x64_bf16 v[76:79], v[32:35], a[176:183], v7
    v_add_f32_dpp v53, v70, v53 quad_perm:[1,1,3,3] row_mask:0xf bank_mask:0xf
    v_smfmac_f32_16x16x64_bf16 v[76:79], v[36:39], a[184:191], v7
    v_add_f32_dpp v53, v71, v53 quad_perm:[1,1,3,3] row_mask:0xf bank_mask:0xf
    v_mov_b32_dpp v54, v72 quad_perm:[0,0,2,2] row_mask:0xf bank_mask:0xf
    v_add_f32_dpp v54, v73, v54 quad_perm:[0,0,2,2] row_mask:0xf bank_mask:0xf
    v_add_f32_dpp v54, v74, v54 quad_perm:[1,1,3,3] row_mask:0xf bank_mask:0xf
    v_add_f32_dpp v54, v75, v54 quad_perm:[1,1,3,3] row_mask:0xf bank_mask:0xf
    v_max3_f32 v62, v52, v53, v54
    s_nop 1
    v_mov_b32_dpp v55, v76 quad_perm:[0,0,2,2] row_mask:0xf bank_mask:0xf
    v_add_f32_dpp v55, v77, v55 quad_perm:[0,0,2,2] row_mask:0xf bank_mask:0xf
    v_add_f32_dpp v55, v78, v55 quad_perm:[1,1,3,3] row_mask:0xf bank_mask:0xf
    v_add_f32_dpp v55, v79, v55 quad_perm:[1,1,3,3] row_mask:0xf bank_mask:0xf
    v_max_f32 v62, v62, v55
    s_nop 1
    v_max_f32_dpp v62, v62, v62 quad_perm:[2,3,0,1] row_mask:0xf bank_mask:0xf
    s_nop 1
    v_max_f32_dpp v62, v62, v62 row_ror:4 row_mask:0xf bank_mask:0xf
    s_nop 1
    v_max_f32_dpp v62, v62, v62 row_ror:8 row_mask:0xf bank_mask:0xf
    v_mov_b32 v63, v62
    s_nop 1
    v_permlane16_swap_b32 v62, v63
    v_max_f32 v62, v62, v63
    v_mov_b32 v63, v62
    s_nop 1
    v_permlane32_swap_b32 v62, v63
    v_max_f32 v62, v62, v63
    v_sub_f32 v52, v52, v62
    v_exp_f32 v52, v52
    s_nop 0
    v_cvt_pk_bf16_f32 v56, v52, v52
    v_mov_b32 v63, v52
    s_nop 0
    v_and_b32_dpp v16, v56, v5 quad_perm:[0,0,0,0] row_mask:0xf bank_mask:0xf
    v_and_b32_dpp v19, v56, v6 quad_perm:[0,0,0,0] row_mask:0xf bank_mask:0xf
    s_nop 0
    v_mov_b32_dpp v17, v16 row_shr:4 row_mask:0xf bank_mask:0xf bound_ctrl:0
    v_mov_b32_dpp v18, v19 row_shl:4 row_mask:0xf bank_mask:0xf bound_ctrl:0
    s_nop 0
    s_waitcnt vmcnt(36)
    v_smfmac_f32_16x16x64_bf16 v[40:43], v[16:19], a[192:199], v7 abid:1
    v_and_b32_dpp v20, v56, v5 quad_perm:[2,2,2,2] row_mask:0xf bank_mask:0xf
    v_and_b32_dpp v23, v56, v6 quad_perm:[2,2,2,2] row_mask:0xf bank_mask:0xf
    v_smfmac_f32_16x16x64_bf16 v[44:47], v[16:19], a[200:207], v7 abid:1
    v_mov_b32_dpp v21, v20 row_shr:4 row_mask:0xf bank_mask:0xf bound_ctrl:0
    v_mov_b32_dpp v22, v23 row_shl:4 row_mask:0xf bank_mask:0xf bound_ctrl:0
    v_sub_f32 v53, v53, v62
    v_exp_f32 v53, v53
    v_smfmac_f32_16x16x64_bf16 v[48:51], v[16:19], a[208:215], v7 abid:1
    v_cvt_pk_bf16_f32 v57, v53, v53
    v_add_f32 v63, v63, v53
    v_smfmac_f32_16x16x64_bf16 v[40:43], v[20:23], a[216:223], v7 abid:1
    v_and_b32_dpp v16, v57, v5 quad_perm:[0,0,0,0] row_mask:0xf bank_mask:0xf
    v_and_b32_dpp v19, v57, v6 quad_perm:[0,0,0,0] row_mask:0xf bank_mask:0xf
    v_smfmac_f32_16x16x64_bf16 v[44:47], v[20:23], a[224:231], v7 abid:1
    v_mov_b32_dpp v17, v16 row_shr:4 row_mask:0xf bank_mask:0xf bound_ctrl:0
    v_mov_b32_dpp v18, v19 row_shl:4 row_mask:0xf bank_mask:0xf bound_ctrl:0
    v_smfmac_f32_16x16x64_bf16 v[48:51], v[20:23], a[232:239], v7 abid:1
    s_waitcnt vmcnt(24)
    v_smfmac_f32_16x16x64_bf16 v[40:43], v[16:19], a[240:247], v7 abid:1
    v_and_b32_dpp v20, v57, v5 quad_perm:[2,2,2,2] row_mask:0xf bank_mask:0xf
    v_and_b32_dpp v23, v57, v6 quad_perm:[2,2,2,2] row_mask:0xf bank_mask:0xf
    v_smfmac_f32_16x16x64_bf16 v[44:47], v[16:19], a[248:255], v7 abid:1
    v_mov_b32_dpp v21, v20 row_shr:4 row_mask:0xf bank_mask:0xf bound_ctrl:0
    v_mov_b32_dpp v22, v23 row_shl:4 row_mask:0xf bank_mask:0xf bound_ctrl:0
    v_sub_f32 v54, v54, v62
    v_exp_f32 v54, v54
    v_smfmac_f32_16x16x64_bf16 v[48:51], v[16:19], v[128:135], v7 abid:1
    v_cvt_pk_bf16_f32 v56, v54, v54
    v_add_f32 v63, v63, v54
    v_smfmac_f32_16x16x64_bf16 v[40:43], v[20:23], v[136:143], v7 abid:1
    v_and_b32_dpp v16, v56, v5 quad_perm:[0,0,0,0] row_mask:0xf bank_mask:0xf
    v_and_b32_dpp v19, v56, v6 quad_perm:[0,0,0,0] row_mask:0xf bank_mask:0xf
    v_smfmac_f32_16x16x64_bf16 v[44:47], v[20:23], v[144:151], v7 abid:1
    v_mov_b32_dpp v17, v16 row_shr:4 row_mask:0xf bank_mask:0xf bound_ctrl:0
    v_mov_b32_dpp v18, v19 row_shl:4 row_mask:0xf bank_mask:0xf bound_ctrl:0
    v_smfmac_f32_16x16x64_bf16 v[48:51], v[20:23], v[152:159], v7 abid:1
    s_waitcnt vmcnt(12)
    v_smfmac_f32_16x16x64_bf16 v[40:43], v[16:19], v[160:167], v7 abid:1
    v_and_b32_dpp v20, v56, v5 quad_perm:[2,2,2,2] row_mask:0xf bank_mask:0xf
    v_and_b32_dpp v23, v56, v6 quad_perm:[2,2,2,2] row_mask:0xf bank_mask:0xf
    v_smfmac_f32_16x16x64_bf16 v[44:47], v[16:19], v[168:175], v7 abid:1
    v_mov_b32_dpp v21, v20 row_shr:4 row_mask:0xf bank_mask:0xf bound_ctrl:0
    v_mov_b32_dpp v22, v23 row_shl:4 row_mask:0xf bank_mask:0xf bound_ctrl:0
    v_sub_f32 v55, v55, v62
    v_exp_f32 v55, v55
    v_smfmac_f32_16x16x64_bf16 v[48:51], v[16:19], v[176:183], v7 abid:1
    v_cvt_pk_bf16_f32 v57, v55, v55
    v_add_f32 v63, v63, v55
    v_smfmac_f32_16x16x64_bf16 v[40:43], v[20:23], v[184:191], v7 abid:1
    v_and_b32_dpp v16, v57, v5 quad_perm:[0,0,0,0] row_mask:0xf bank_mask:0xf
    v_and_b32_dpp v19, v57, v6 quad_perm:[0,0,0,0] row_mask:0xf bank_mask:0xf
    v_smfmac_f32_16x16x64_bf16 v[44:47], v[20:23], v[192:199], v7 abid:1
    v_mov_b32_dpp v17, v16 row_shr:4 row_mask:0xf bank_mask:0xf bound_ctrl:0
    v_mov_b32_dpp v18, v19 row_shl:4 row_mask:0xf bank_mask:0xf bound_ctrl:0
    v_smfmac_f32_16x16x64_bf16 v[48:51], v[20:23], v[200:207], v7 abid:1
    s_waitcnt vmcnt(0)
    v_smfmac_f32_16x16x64_bf16 v[40:43], v[16:19], v[208:215], v7 abid:1
    v_add_f32_dpp v63, v63, v63 quad_perm:[2,3,0,1] row_mask:0xf bank_mask:0xf
    v_and_b32_dpp v20, v57, v5 quad_perm:[2,2,2,2] row_mask:0xf bank_mask:0xf
    v_and_b32_dpp v23, v57, v6 quad_perm:[2,2,2,2] row_mask:0xf bank_mask:0xf
    v_add_f32_dpp v63, v63, v63 row_ror:4 row_mask:0xf bank_mask:0xf
    v_smfmac_f32_16x16x64_bf16 v[44:47], v[16:19], v[216:223], v7 abid:1
    v_mov_b32_dpp v21, v20 row_shr:4 row_mask:0xf bank_mask:0xf bound_ctrl:0
    v_mov_b32_dpp v22, v23 row_shl:4 row_mask:0xf bank_mask:0xf bound_ctrl:0
    v_add_f32_dpp v63, v63, v63 row_ror:8 row_mask:0xf bank_mask:0xf
    v_mov_b32 v58, v63
    v_smfmac_f32_16x16x64_bf16 v[48:51], v[16:19], v[224:231], v7 abid:1
    s_nop 0
    v_permlane16_swap_b32 v63, v58
    v_smfmac_f32_16x16x64_bf16 v[40:43], v[20:23], v[232:239], v7 abid:1
    v_add_f32 v63, v63, v58
    v_mov_b32 v58, v63
    v_smfmac_f32_16x16x64_bf16 v[44:47], v[20:23], v[240:247], v7 abid:1
    v_smfmac_f32_16x16x64_bf16 v[48:51], v[20:23], v[248:255], v7 abid:1
    v_permlane32_swap_b32 v63, v58
    v_add_f32 v63, v63, v58
    ds_write_b64 v61, v[62:63]
    s_mov_b32 exec_lo, 0x00ff00ff
    s_mov_b32 exec_hi, 0xff00ff00
    s_nop 0
    ds_write_b128 v15, v[40:43] offset:0
    ds_write_b128 v15, v[44:47] offset:256
    ds_write_b128 v15, v[48:51] offset:512
    s_mov_b64 exec, -1
    v_cmp_eq_u32 s[60:61], 24, v1
    s_cmp_eq_u32 s49, 0
    s_cbranch_scc1 HOOKC
EXB:
    s_waitcnt lgkmcnt(0)
    s_barrier
    ds_read_b128 v[16:19], v12
    ds_read_b128 v[20:23], v12 offset:16
    ds_read_b64 v[24:25], v60 offset:0
    ds_read_b64 v[26:27], v60 offset:768
    ds_read_b64 v[28:29], v60 offset:1536
    ds_read_b64 v[30:31], v60 offset:2304
    ds_read_b64 v[32:33], v60 offset:3072
    ds_read_b64 v[34:35], v60 offset:3840
    ds_read_b64 v[36:37], v60 offset:4608
    ds_read_b64 v[38:39], v60 offset:5376
    s_waitcnt lgkmcnt(8)
    v_max_f32 v40, v16, v18
    v_max3_f32 v40, v40, v20, v22
    v_sub_f32 v16, v16, v40
    v_sub_f32 v18, v18, v40
    v_sub_f32 v20, v20, v40
    v_sub_f32 v22, v22, v40
    v_exp_f32 v16, v16
    v_exp_f32 v18, v18
    v_exp_f32 v20, v20
    v_exp_f32 v22, v22
    v_mul_f32 v41, v16, v17
    v_fmac_f32 v41, v18, v19
    v_fmac_f32 v41, v20, v21
    v_fmac_f32 v41, v22, v23
    v_rcp_f32 v42, v41
    v_log_f32 v43, v41
    s_waitcnt lgkmcnt(0)
    v_pk_add_f32 v[24:25], v[24:25], v[26:27]
    v_pk_add_f32 v[28:29], v[28:29], v[30:31]
    v_pk_add_f32 v[32:33], v[32:33], v[34:35]
    v_pk_add_f32 v[36:37], v[36:37], v[38:39]
    v_pk_mul_f32 v[24:25], v[24:25], v[16:17] op_sel_hi:[1,0]
    v_pk_fma_f32 v[24:25], v[28:29], v[18:19], v[24:25] op_sel_hi:[1,0,1]
    v_pk_fma_f32 v[24:25], v[32:33], v[20:21], v[24:25] op_sel_hi:[1,0,1]
    v_pk_fma_f32 v[24:25], v[36:37], v[22:23], v[24:25] op_sel_hi:[1,0,1]
    v_pk_mul_f32 v[24:25], v[24:25], v[42:43] op_sel_hi:[1,0]
    v_add_f32 v43, v43, v40
    v_cvt_pk_bf16_f32 v24, v24, v25
    s_mov_b64 exec, 0x1ffffff
    v_cndmask_b32 v24, v24, v43, s[60:61]
    s_cmp_eq_u32 s50, 0
    s_cbranch_scc1 SLOW2
    buffer_store_dword v24, v14, s[16:19], s62 offen
PUBD2:
    s_mov_b64 exec, -1
    s_cmp_ge_u32 s46, 20
    s_cbranch_scc1 HOOKG3
    v_and_b32 v30, 7, v1
    v_lshrrev_b32 v31, 4, v1
    v_lshlrev_b32 v58, 4, v30
    v_lshl_add_u32 v58, v31, 7, v58
    s_mul_i32 s52, s56, 6144
    s_mul_i32 s54, s44, 1536
    s_add_u32 s52, s52, s54
    v_add_u32 v58, s52, v58
    s_lshr_b32 s53, s44, 1
    s_lshl_b32 s52, s56, 6
    s_lshl_b32 s54, s53, 5
    s_add_u32 s52, s52, s54
    s_add_u32 s52, s52, 19968
    v_lshl_add_u32 v59, v31, 2, v30
    v_and_b32 v59, 7, v59
    v_lshl_add_u32 v59, v59, 2, s52
    s_lshl_b32 s52, s57, 8
    s_add_u32 s52, s52, 81920
    s_or_b32 s53, s45, s56
    s_cmp_eq_u32 s53, 0
    s_cselect_b32 s52, s52, 1879048192
    v_lshl_add_u32 v61, v1, 2, s52
    v_mov_b64 v[44:45], 0
    v_mov_b64 v[46:47], 0
    v_mov_b64 v[48:49], 0
    v_mov_b64 v[50:51], 0
    v_mov_b64 v[52:53], 0
    v_mov_b64 v[54:55], 0
    s_mov_b32 s60, 0x00ff00ff
    s_mov_b32 s61, 0x00ff00ff
    s_mov_b32 s51, 0
    s_cmp_eq_u32 s49, 0
    s_cbranch_scc1 HOOKG
WO0:
    buffer_load_dword v57, v61, s[16:19], s49 offen sc1
    buffer_load_dword v56, v59, s[16:19], s62 offen sc1
    s_mov_b64 exec, s[60:61]
    buffer_load_dwordx4 v[44:47], v58, s[16:19], s62 offen offset:0 sc1
    buffer_load_dwordx4 v[48:51], v58, s[16:19], s62 offen offset:512 sc1
    buffer_load_dwordx4 v[52:55], v58, s[16:19], s62 offen offset:1024 sc1
    s_mov_b64 exec, -1
    s_cmp_eq_u32 s49, 0
    s_cbranch_scc1 HOOKG2
    s_nop 15
    s_nop 7
    v_lshrrev_b32 v14, 5, v1
    v_lshlrev_b32 v14, 11, v14
    v_and_b32 v15, 31, v1
    v_lshl_add_u32 v14, v15, 2, v14
    s_lshl_b32 s52, s57, 12
    s_lshl_b32 s54, s45, 8
    s_add_u32 s52, s52, s54
    s_lshl_b32 s54, s56, 7
    s_add_u32 s52, s52, s54
    v_add_u32 v14, s52, v14
    s_lshl_b32 s52, s44, 9
    s_add_u32 s52, s52, 104960
    v_lshl_add_u32 v15, v15, 4, s52
    v_and_b32 v64, 15, v1
    v_lshlrev_b32 v64, 4, v64
    v_lshl_add_u32 v64, v31, 2, v64
    v_add_u32 v64, 104960, v64
WOP:
    buffer_load_dword v57, v61, s[16:19], s49 offen sc1
    buffer_load_dword v56, v59, s[16:19], s62 offen sc1
    s_mov_b64 exec, s[60:61]
    buffer_load_dwordx4 v[44:47], v58, s[16:19], s62 offen offset:0 sc1
    buffer_load_dwordx4 v[48:51], v58, s[16:19], s62 offen offset:512 sc1
    buffer_load_dwordx4 v[52:55], v58, s[16:19], s62 offen offset:1024 sc1
    s_mov_b64 exec, -1
    s_waitcnt vmcnt(5)
WOC:
    v_max3_u32 v63, v44, v48, v52
    v_mov_b32 v32, v56
    v_max_u32 v63, v63, v32
    v_cmp_eq_u32 vcc, -1, v63
    s_cbranch_vccnz WOAG
    v_mfma_f32_16x16x32_bf16 v[16:19], v[44:47], v[80:83], 0
    v_max_f32_dpp v33, v32, v32 quad_perm:[1,0,3,2] row_mask:0xf bank_mask:0xf
    s_nop 0
    v_mfma_f32_16x16x32_bf16 v[16:19], v[48:51], v[96:99], v[16:19]
    v_max_f32_dpp v33, v33, v33 quad_perm:[2,3,0,1] row_mask:0xf bank_mask:0xf
    s_nop 0
    v_mfma_f32_16x16x32_bf16 v[16:19], v[52:55], v[112:115], v[16:19]
    v_max_f32_dpp v33, v33, v33 row_half_mirror row_mask:0xf bank_mask:0xf
    v_sub_f32 v34, v32, v33
    v_mfma_f32_16x16x32_bf16 v[20:23], v[44:47], v[84:87], 0
    v_exp_f32 v34, v34
    s_nop 0
    v_mfma_f32_16x16x32_bf16 v[20:23], v[48:51], v[100:103], v[20:23]
    v_add_f32_dpp v33, v34, v34 quad_perm:[1,0,3,2] row_mask:0xf bank_mask:0xf
    s_nop 0
    v_mfma_f32_16x16x32_bf16 v[20:23], v[52:55], v[116:119], v[20:23]
    v_add_f32_dpp v33, v33, v33 quad_perm:[2,3,0,1] row_mask:0xf bank_mask:0xf
    s_nop 0
    v_mfma_f32_16x16x32_bf16 v[24:27], v[44:47], v[88:91], 0
    v_add_f32_dpp v33, v33, v33 row_half_mirror row_mask:0xf bank_mask:0xf
    v_rcp_f32 v33, v33
    v_mfma_f32_16x16x32_bf16 v[24:27], v[48:51], v[104:107], v[24:27]
    v_mul_f32 v34, v34, v33
    s_nop 0
    v_mfma_f32_16x16x32_bf16 v[24:27], v[52:55], v[120:123], v[24:27]
    v_mul_f32_dpp v36, v34, v16 row_newbcast:0 row_mask:0xf bank_mask:0xf
    v_fmac_f32_dpp v36, v34, v17 row_newbcast:1 row_mask:0xf bank_mask:0xf
    v_mfma_f32_16x16x32_bf16 v[28:31], v[44:47], v[92:95], 0
    v_fmac_f32_dpp v36, v34, v18 row_newbcast:2 row_mask:0xf bank_mask:0xf
    v_fmac_f32_dpp v36, v34, v19 row_newbcast:3 row_mask:0xf bank_mask:0xf
    v_mfma_f32_16x16x32_bf16 v[28:31], v[48:51], v[108:111], v[28:31]
    v_mul_f32_dpp v37, v34, v20 row_newbcast:0 row_mask:0xf bank_mask:0xf
    v_fmac_f32_dpp v37, v34, v21 row_newbcast:1 row_mask:0xf bank_mask:0xf
    v_mfma_f32_16x16x32_bf16 v[28:31], v[52:55], v[124:127], v[28:31]
    v_fmac_f32_dpp v37, v34, v22 row_newbcast:2 row_mask:0xf bank_mask:0xf
    v_fmac_f32_dpp v37, v34, v23 row_newbcast:3 row_mask:0xf bank_mask:0xf
    v_cmp_u_f32 vcc, v36, v57
    v_mul_f32_dpp v38, v34, v24 row_newbcast:0 row_mask:0xf bank_mask:0xf
    v_fmac_f32_dpp v38, v34, v25 row_newbcast:1 row_mask:0xf bank_mask:0xf
    v_fmac_f32_dpp v38, v34, v26 row_newbcast:2 row_mask:0xf bank_mask:0xf
    v_fmac_f32_dpp v38, v34, v27 row_newbcast:3 row_mask:0xf bank_mask:0xf
    s_mov_b32 exec_hi, 0
    v_mul_f32_dpp v39, v34, v28 row_newbcast:0 row_mask:0xf bank_mask:0xf
    v_fmac_f32_dpp v39, v34, v29 row_newbcast:1 row_mask:0xf bank_mask:0xf
    v_fmac_f32_dpp v39, v34, v30 row_newbcast:2 row_mask:0xf bank_mask:0xf
    v_fmac_f32_dpp v39, v34, v31 row_newbcast:3 row_mask:0xf bank_mask:0xf
    s_cbranch_vccz WOOK
    s_mov_b64 exec, -1
WOAG:
    s_add_u32 s51, s51, 1
    s_cmp_lt_u32 s51, 0x8000
    s_cbranch_scc1 WOP
    s_mov_b32 exec_hi, 0
WOOK:
    ds_write_b128 v15, v[36:39]
    s_mov_b64 exec, -1
    s_cmp_lg_u32 s44, 3
    s_waitcnt lgkmcnt(0)
    s_barrier
    s_cbranch_scc1 WOX
    ds_read2st64_b32 v[16:17], v64 offset0:0 offset1:1
    ds_read2st64_b32 v[18:19], v64 offset0:2 offset1:3
    ds_read2st64_b32 v[20:21], v64 offset0:4 offset1:5
    ds_read2st64_b32 v[22:23], v64 offset0:6 offset1:7
    s_waitcnt lgkmcnt(2)
    v_pk_add_f32 v[16:17], v[16:17], v[18:19]
    v_add_f32 v16, v16, v57
    s_waitcnt lgkmcnt(0)
    v_pk_add_f32 v[20:21], v[20:21], v[22:23]
    v_pk_add_f32 v[16:17], v[16:17], v[20:21]
    v_add_f32 v16, v16, v17
    buffer_store_dword v16, v14, s[16:19], s49 offen sc1
WOX:
    s_cmp_ge_u32 s46, 30
    s_cbranch_scc1 STX
    v_and_b32 v61, 3, v1
    v_lshlrev_b32 v61, 3, v61
    v_bfe_u32 v60, v1, 2, 2
    v_lshl_add_u32 v61, v60, 7, v61
    v_lshrrev_b32 v60, 4, v1
    v_lshl_add_u32 v61, v60, 10, v61
    v_bfe_u32 v60, v1, 3, 2
    v_lshl_add_u32 v61, v60, 5, v61
    s_lshl_b32 s52, s44, 5
    v_xor_b32 v61, s52, v61
    s_cmp_eq_u32 s44, 3
    s_cbranch_scc1 F1W3
    s_waitcnt vmcnt(0)
F1W3:
    s_waitcnt vmcnt(1)
    s_cmp_eq_u32 s49, 0
    s_cbranch_scc1 HOOKJ
    ds_read_b64_tr_b16 v[64:65], v61 offset:49152
    ds_read_b64_tr_b16 v[66:67], v61 offset:49664
    ds_read_b64_tr_b16 v[68:69], v61 offset:53248
    ds_read_b64_tr_b16 v[70:71], v61 offset:53760
    ds_read_b64_tr_b16 v[72:73], v61 offset:57344
    ds_read_b64_tr_b16 v[74:75], v61 offset:57856
    ds_read_b64_tr_b16 v[76:77], v61 offset:61440
    ds_read_b64_tr_b16 v[78:79], v61 offset:61952
F1NB:
    s_lshl_b32 s52, s59, 6
    s_lshl_b32 s54, s44, 4
    s_add_u32 s52, s52, s54
    v_add_u32 v14, s52, v1
    s_mul_i32 s52, s58, 3072
    s_lshl_b32 s54, s3, 2
    s_add_u32 s52, s52, s54
    s_lshl_b32 s53, s58, 2
    s_add_u32 s53, s53, 6144
    s_cmp_eq_u32 s3, 4
    s_cselect_b32 s52, s53, s52
    s_cselect_b32 s53, 3, 4
    v_lshlrev_b32 v14, s53, v14
    v_add_u32 v14, s52, v14
    s_lshl_b32 s52, s4, 3
    s_add_u32 s52, s52, 20224
    v_mov_b32 v15, s52
    v_and_b32 v57, 31, v1
    v_lshl_add_u32 v57, s44, 5, v57
    s_lshl_b32 s52, s4, 9
    s_add_u32 s52, s52, 84480
    s_cmp_lt_u32 s4, 5
    s_cselect_b32 s52, s52, 1879048192
    s_cmp_eq_u32 s45, 0
    s_cselect_b32 s52, s52, 1879048192
    v_lshl_add_u32 v56, v57, 2, s52
    v_lshlrev_b32 v57, 1, v57
    v_add_u32 v57, 96512, v57
    v_lshrrev_b32 v58, 5, v1
    v_lshlrev_b32 v58, 10, v58
    v_and_b32 v59, 31, v1
    v_lshl_add_u32 v58, v59, 2, v58
    s_lshl_b32 s52, s3, 13
    s_lshl_b32 s54, s44, 11
    s_add_u32 s52, s52, s54
    v_add_u32 v58, s52, v58
    v_min_u32 v54, 191, v0
    v_lshlrev_b32 v52, 4, v54
    v_lshlrev_b32 v54, 3, v54
    v_add_u32 v54, 6144, v54
    v_and_b32 v53, 15, v0
    s_mov_b32 s100, 0
    s_cmp_eq_u32 s49, 0
    s_cbranch_scc1 HOOKD
    s_cmp_lt_u32 s46, 20
    s_cbranch_scc1 GFB
    s_sleep 18
GFB:
    s_sleep 8
F1S:
    v_add_u32 v14, 12288, v14
    v_add_u32 v52, 12288, v52
    v_add_u32 v54, 12288, v54
    s_mov_b32 s51, 0
F1P:
    buffer_load_dword v16, v58, s[16:19], s49 offen offset:0 sc1
    buffer_load_dword v17, v58, s[16:19], s49 offen offset:128 sc1
    buffer_load_dword v18, v58, s[16:19], s49 offen offset:256 sc1
    buffer_load_dword v19, v58, s[16:19], s49 offen offset:384 sc1
    buffer_load_dword v20, v58, s[16:19], s49 offen offset:512 sc1
    buffer_load_dword v21, v58, s[16:19], s49 offen offset:640 sc1
    buffer_load_dword v22, v58, s[16:19], s49 offen offset:768 sc1
    buffer_load_dword v23, v58, s[16:19], s49 offen offset:896 sc1
F1W:
    s_waitcnt vmcnt(0)
    v_pk_add_f32 v[16:17], v[16:17], v[18:19]
    v_pk_add_f32 v[20:21], v[20:21], v[22:23]
    v_pk_add_f32 v[16:17], v[16:17], v[20:21]
    v_add_f32 v16, v16, v17
    v_mov_b32 v17, v16
    s_nop 1
    v_permlane32_swap_b32 v16, v17
    v_add_f32 v16, v16, v17
    v_cmp_u_f32 vcc, v16, v16
    s_cbranch_vccz F1OK
    s_add_u32 s51, s51, 1
    s_sleep 1
    s_cmp_lt_u32 s51, 0x8000
    s_cbranch_scc1 F1P
F1OK:
    v_cvt_pk_bf16_f32 v16, v16, v16
    ds_write_b16 v57, v16
    v_and_b32 v16, 0xffff0000, v16
    s_mov_b32 exec_hi, 0
    s_cmp_eq_u32 s50, 0
    s_cbranch_scc1 SLOW7
    buffer_store_dword v16, v56, s[16:19], s49 offen
PUBD7:
    s_mov_b64 exec, -1
    s_cmp_eq_u32 s49, 0
    s_waitcnt lgkmcnt(0)
    s_barrier
    s_cbranch_scc1 HOOKK
F1R:
    ds_read_b128 v[20:23], v2 offset:256
    ds_read_b128 v[24:27], v2 offset:320
    ds_read_b128 v[28:31], v2 offset:384
    ds_read_b128 v[32:35], v2 offset:448
    s_waitcnt lgkmcnt(3)
    v_mfma_f32_16x16x32_bf16 v[40:43], v[20:23], v[64:67], 0
    v_mfma_f32_16x16x32_bf16 v[44:47], v[20:23], v[20:23], 0
    s_waitcnt lgkmcnt(2)
    v_mfma_f32_16x16x32_bf16 v[40:43], v[24:27], v[68:71], v[40:43]
    v_mfma_f32_16x16x32_bf16 v[44:47], v[24:27], v[24:27], v[44:47]
    s_waitcnt lgkmcnt(1)
    v_mfma_f32_16x16x32_bf16 v[40:43], v[28:31], v[72:75], v[40:43]
    v_mfma_f32_16x16x32_bf16 v[44:47], v[28:31], v[28:31], v[44:47]
    s_waitcnt lgkmcnt(0)
    v_mfma_f32_16x16x32_bf16 v[40:43], v[32:35], v[76:79], v[40:43]
    v_mfma_f32_16x16x32_bf16 v[44:47], v[32:35], v[32:35], v[44:47]
    s_mov_b64 exec, 0xffff
    s_nop 3
    s_cmp_eq_u32 s50, 0
    s_cbranch_scc1 SLOW8
    buffer_store_dword v40, v14, s[16:19], s62 offen
    s_mov_b64 exec, 1
    buffer_store_dwordx2 v[44:45], v15, s[16:19], s62 offen
PUBD8:
    s_cmp_eq_u32 s49, 0
    s_cbranch_scc1 HOOKM
F1X:
    s_mov_b64 exec, -1
    s_cmp_lt_u32 s46, 20
    s_cbranch_scc1 STX
    v_and_b32 v58, 7, v1
    v_cmp_gt_u32 vcc, 5, v58
    v_lshlrev_b32 v58, 3, v58
    v_add_u32 v58, 20224, v58
    v_mov_b32 v59, 1879048192
    v_cndmask_b32 v58, v59, v58, vcc
    s_lshl_b32 s52, s57, 8
    s_lshl_b32 s54, s44, 6
    s_add_u32 s52, s52, s54
    s_add_u32 s52, s52, 84480
    s_cmp_eq_u32 s45, 0
    s_cselect_b32 s52, s52, 1879048192
    v_lshl_add_u32 v59, v53, 2, s52
    s_cmp_eq_u32 s44, 3
    s_cselect_b32 s53, 1879048192, s62
    s_mov_b32 s51, 0
    s_cmp_eq_u32 s49, 0
    s_cbranch_scc1 HOOKI
    s_nop 3
W20:
    s_nop 11
    buffer_load_dword v76, v59, s[16:19], s49 offen sc1
    buffer_load_dwordx2 v[74:75], v58, s[16:19], s62 offen sc1
    buffer_load_dwordx4 v[64:67], v52, s[16:19], s53 offen offset:0 sc1
    buffer_load_dwordx4 v[68:71], v52, s[16:19], s53 offen offset:3072 sc1
    buffer_load_dwordx2 v[72:73], v54, s[16:19], s53 offen sc1
    s_lshl_b32 s52, s57, 12
    s_lshl_b32 s54, s44, 10
    s_add_u32 s52, s52, s54
    s_lshl_b32 s54, s45, 7
    s_add_u32 s52, s52, s54
    s_add_u32 s52, s52, 40960
    v_lshl_add_u32 v14, v1, 2, s52
    v_lshlrev_b32 v57, 1, v0
    v_add_u32 v57, 96768, v57
    s_mov_b32 s51, 0
    s_nop 15
    s_nop 13
W2P:
    buffer_load_dword v76, v59, s[16:19], s49 offen sc1
    buffer_load_dwordx2 v[74:75], v58, s[16:19], s62 offen sc1
    buffer_load_dwordx4 v[64:67], v52, s[16:19], s53 offen offset:0 sc1
    buffer_load_dwordx4 v[68:71], v52, s[16:19], s53 offen offset:3072 sc1
    buffer_load_dwordx2 v[72:73], v54, s[16:19], s53 offen sc1
    s_waitcnt vmcnt(5)
W2C:
    v_add_f32_dpp v36, v74, v74 quad_perm:[1,0,3,2] row_mask:0xf bank_mask:0xf
    v_add_f32_dpp v37, v75, v75 quad_perm:[1,0,3,2] row_mask:0xf bank_mask:0xf
    v_pk_add_f32 v[18:19], v[64:65], v[66:67]
    v_add_f32_dpp v36, v36, v36 quad_perm:[2,3,0,1] row_mask:0xf bank_mask:0xf
    v_add_f32_dpp v37, v37, v37 quad_perm:[2,3,0,1] row_mask:0xf bank_mask:0xf
    v_pk_add_f32 v[20:21], v[68:69], v[70:71]
    v_add_f32_dpp v36, v36, v36 row_half_mirror row_mask:0xf bank_mask:0xf
    v_add_f32_dpp v37, v37, v37 row_half_mirror row_mask:0xf bank_mask:0xf
    v_add_f32 v16, v18, v19
    v_add_f32 v17, v20, v21
    v_mul_f32 v37, 0x3acccccd, v37
    v_fmamk_f32 v36, v36, 0x3acccccd, v11
    v_fma_f32 v36, -v37, v37, v36
    v_rsq_f32 v36, v36
    v_pk_add_f32 v[16:17], v[16:17], v[72:73]
    v_pk_fma_f32 v[16:17], v[36:37], v[126:127], v[16:17] op_sel:[1,0,0] op_sel_hi:[1,1,1] neg_lo:[1,0,0] neg_hi:[1,0,0]
    v_pk_mul_f32 v[16:17], v[16:17], v[36:37] op_sel_hi:[1,0]
    v_mul_f32 v18, 0xbfb8aa3b, v16
    v_exp_f32 v18, v18
    v_mul_f32 v16, v16, v17
    v_add_f32 v18, 1.0, v18
    v_rcp_f32 v18, v18
    v_cmp_u_f32 vcc, v16, v76
    v_mul_f32 v16, v16, v18
    s_cbranch_vccz W2OK
    s_add_u32 s51, s51, 1
    s_cmp_lt_u32 s51, 0x8000
    s_cbranch_scc1 W2P
W2OK:
    v_cvt_pk_bf16_f32 v16, v16, v16
    ds_write_b16 v57, v16
    s_waitcnt lgkmcnt(0)
    s_barrier
    ds_read_b128 v[16:19], v2 offset:512
    ds_read_b128 v[20:23], v2 offset:576
    ds_read_b128 v[24:27], v2 offset:640
    ds_read_b128 v[28:31], v2 offset:704
    ds_read_b128 v[32:35], v2 offset:768
    ds_read_b128 v[36:39], v2 offset:832
    s_waitcnt lgkmcnt(5)
    v_mfma_f32_16x16x32_bf16 v[40:43], v[16:19], v[80:83], 0
    s_waitcnt lgkmcnt(4)
    v_mfma_f32_16x16x32_bf16 v[40:43], v[20:23], v[84:87], v[40:43]
    s_waitcnt lgkmcnt(3)
    v_mfma_f32_16x16x32_bf16 v[40:43], v[24:27], v[88:91], v[40:43]
    s_waitcnt lgkmcnt(2)
    v_mfma_f32_16x16x32_bf16 v[40:43], v[28:31], v[92:95], v[40:43]
    s_waitcnt lgkmcnt(1)
    v_mfma_f32_16x16x32_bf16 v[40:43], v[32:35], v[96:99], v[40:43]
    s_waitcnt lgkmcnt(0)
    v_mfma_f32_16x16x32_bf16 v[40:43], v[36:39], v[100:103], v[40:43]
    s_mov_b64 exec, 0xffff
    s_waitcnt vmcnt(0)
    s_nop 5
    v_add_f32 v40, v40, v76
    buffer_store_dword v40, v14, s[16:19], s49 offen sc1
    s_mov_b64 exec, -1
STX:
    s_cmp_lg_u32 s49, 0
    s_cbranch_scc1 LAST
    s_branch LOOP
LAST:
    s_and_b32 s52, s2, 0xc7
    s_cmp_eq_u32 s52, 0
    s_cbranch_scc1 LOOP
    s_endpgm
FINAL:
    s_cmp_eq_u32 s44, 3
    s_cbranch_scc1 FINX
    v_cvt_pk_bf16_f32 v30, v30, v30
    v_lshlrev_b32 v20, 1, v29
    s_mul_i32 s52, s48, 160
    s_mov_b32 exec_lo, s60
    s_mov_b32 exec_hi, 0
    buffer_store_short v30, v20, s[36:39], s52 offen
    s_mov_b64 exec, -1
FINX:
DONE:
    s_endpgm
HOOKL:
    s_cmp_lg_u32 s49, 0
    s_cbranch_scc1 HL2
    s_cmp_lt_u32 s46, 30
    s_cbranch_scc1 NOGSW
    v_mov_b32 v20, 20224
    s_mov_b32 s51, 0
GSW:
    buffer_load_dword v21, v20, s[16:19], s62 offen sc1
    s_waitcnt vmcnt(0)
    v_cmp_u_f32 vcc, v21, v21
    s_cbranch_vccz NOGSW
    s_add_u32 s51, s51, 1
    s_sleep 2
    s_cmp_lt_u32 s51, 0x8000
    s_cbranch_scc1 GSW
NOGSW:
    s_cmp_ge_u32 s46, 30
    s_cselect_b32 s53, 10, 0
    s_sub_u32 s53, s46, s53
    v_min_u32 v27, 17, v1
    v_lshlrev_b32 v27, 7, v27
    s_mul_i32 s52, s45, 45312
    s_mul_i32 s54, s53, 2304
    s_add_u32 s52, s52, s54
    s_add_u32 s52, s52, 409600
    buffer_load_dword v27, v27, s[16:19], s52 offen sc1
    v_lshlrev_b32 v24, 3, v0
    s_mul_i32 s52, s47, 12288
    s_add_u32 s52, s52, 1441792
    s_mov_b32 s51, 0
QCPA:
    s_add_u32 s53, s52, 0
    buffer_load_dwordx2 v[32:33], v24, s[16:19], s53 offen offset:0 sc1
    buffer_load_dwordx2 v[34:35], v24, s[16:19], s53 offen offset:1536 sc1
    s_add_u32 s53, s52, 3072
    buffer_load_dwordx2 v[36:37], v24, s[16:19], s53 offen offset:0 sc1
    buffer_load_dwordx2 v[38:39], v24, s[16:19], s53 offen offset:1536 sc1
    s_add_u32 s53, s52, 6144
    buffer_load_dwordx2 v[40:41], v24, s[16:19], s53 offen offset:0 sc1
    buffer_load_dwordx2 v[42:43], v24, s[16:19], s53 offen offset:1536 sc1
    s_add_u32 s53, s52, 9216
    buffer_load_dwordx2 v[20:21], v24, s[16:19], s53 offen offset:0 sc1
    buffer_load_dwordx2 v[22:23], v24, s[16:19], s53 offen offset:1536 sc1
    s_cmp_lg_u32 s51, 0
    s_cbranch_scc1 QCWA
    s_sleep 26
QCWA:
    s_waitcnt vmcnt(0)
    v_bitop3_b32 v33, v32, v33, s101 bitop3:0x96
    v_bitop3_b32 v35, v34, v35, s101 bitop3:0x96
    v_bitop3_b32 v37, v36, v37, s101 bitop3:0x96
    v_bitop3_b32 v39, v38, v39, s101 bitop3:0x96
    v_bitop3_b32 v41, v40, v41, s101 bitop3:0x96
    v_bitop3_b32 v43, v42, v43, s101 bitop3:0x96
    v_bitop3_b32 v21, v20, v21, s101 bitop3:0x96
    v_bitop3_b32 v23, v22, v23, s101 bitop3:0x96
    v_add_f32 v13, v32, v34
    v_add_f32 v13, v13, v36
    v_add_f32 v13, v13, v38
    v_add_f32 v13, v13, v40
    v_add_f32 v13, v13, v42
    v_add_f32 v13, v13, v20
    v_add_f32 v13, v13, v22
    v_or_b32 v33, v33, v35
    v_or_b32 v33, v33, v37
    v_or_b32 v33, v33, v39
    v_or_b32 v33, v33, v41
    v_or_b32 v33, v33, v43
    v_or_b32 v33, v33, v21
    v_or_b32 v33, v33, v23
    v_cmp_ne_u32 vcc, 0, v33
    s_cbranch_vccz QCOKA
    s_add_u32 s51, s51, 1
    s_sleep 2
    s_cmp_lt_u32 s51, 0x8000
    s_cbranch_scc1 QCPA
QCOKA:
    s_branch GYB
HL2:
    s_sleep 21
    s_branch GYB
HOOKA:
    s_nop 3
    s_lshl_b32 s52, s44, 6
    s_add_u32 s52, s52, 98816
    v_lshl_add_u32 v14, v1, 2, s52
    ds_write_b32 v14, v17 offset:8704
    v_fma_f32 v16, -v84, v17, v16
    v_mul_f32 v16, v16, v85
    ds_write_b32 v14, v16 offset:0
    ds_write_b32 v14, v21 offset:8960
    v_fma_f32 v20, -v84, v21, v20
    v_mul_f32 v20, v20, v85
    ds_write_b32 v14, v20 offset:256
    ds_write_b32 v14, v25 offset:9216
    v_fma_f32 v24, -v84, v25, v24
    v_mul_f32 v24, v24, v85
    ds_write_b32 v14, v24 offset:512
    s_mov_b64 exec, -1
    s_add_u32 s44, s44, 1
    s_cmp_lt_u32 s44, 4
    s_cbranch_scc1 LOOP
    s_mov_b32 s44, 3
    v_lshlrev_b32 v14, 2, v1
    v_add_u32 v14, 98816, v14
    ds_read2st64_b32 v[16:17], v14 offset0:0 offset1:1
    ds_read_b32 v18, v14 offset:512
    s_lshl_b32 s52, s47, 13
    s_lshl_b32 s54, s48, 10
    s_add_u32 s52, s52, s54
    s_add_u32 s52, s52, 1114112
    s_waitcnt lgkmcnt(0)
    v_bitop3_b32 v19, v16, v17, v18 bitop3:0x96
    v_xor_b32 v19, v19, v89
    buffer_store_dwordx4 v[16:19], v88, s[16:19], s52 offen sc1
    s_sleep 24
    v_and_b32 v15, 0xe1, v1
    v_lshlrev_b32 v15, 1, v15
    v_bfe_u32 v14, v1, 4, 1
    v_lshl_add_u32 v15, v14, 3, v15
    v_bfe_u32 v14, v1, 3, 1
    v_lshl_add_u32 v15, v14, 5, v15
    v_bfe_u32 v14, v1, 2, 1
    v_lshl_add_u32 v15, v14, 2, v15
    v_bfe_u32 v14, v1, 1, 1
    v_lshl_add_u32 v15, v14, 4, v15
    v_add_u32 v15, 98304, v15
    s_lshl_b32 s52, s47, 13
    s_add_u32 s52, s52, 1114112
    s_add_u32 s53, s52, 4096
    s_mov_b32 s51, 0
Q0P:
    buffer_load_dwordx4 v[16:19], v88, s[16:19], s52 offen offset:0 sc1
    buffer_load_dwordx4 v[20:23], v88, s[16:19], s52 offen offset:1024 sc1
    buffer_load_dwordx4 v[24:27], v88, s[16:19], s52 offen offset:2048 sc1
    buffer_load_dwordx4 v[28:31], v88, s[16:19], s52 offen offset:3072 sc1
    buffer_load_dwordx4 v[32:35], v88, s[16:19], s53 offen offset:0 sc1
    buffer_load_dwordx4 v[36:39], v88, s[16:19], s53 offen offset:1024 sc1
    buffer_load_dwordx4 v[40:43], v88, s[16:19], s53 offen offset:2048 sc1
    buffer_load_dwordx4 v[44:47], v88, s[16:19], s53 offen offset:3072 sc1
    v_mov_b32 v48, 0
    s_waitcnt vmcnt(0)
    v_bitop3_b32 v49, v16, v17, v18 bitop3:0x96
    v_bitop3_b32 v49, v49, v19, v89 bitop3:0x96
    v_or_b32 v48, v48, v49
    v_bitop3_b32 v49, v20, v21, v22 bitop3:0x96
    v_bitop3_b32 v49, v49, v23, v89 bitop3:0x96
    v_or_b32 v48, v48, v49
    v_bitop3_b32 v49, v24, v25, v26 bitop3:0x96
    v_bitop3_b32 v49, v49, v27, v89 bitop3:0x96
    v_or_b32 v48, v48, v49
    v_bitop3_b32 v49, v28, v29, v30 bitop3:0x96
    v_bitop3_b32 v49, v49, v31, v89 bitop3:0x96
    v_or_b32 v48, v48, v49
    v_bitop3_b32 v49, v32, v33, v34 bitop3:0x96
    v_bitop3_b32 v49, v49, v35, v89 bitop3:0x96
    v_or_b32 v48, v48, v49
    v_bitop3_b32 v49, v36, v37, v38 bitop3:0x96
    v_bitop3_b32 v49, v49, v39, v89 bitop3:0x96
    v_or_b32 v48, v48, v49
    v_bitop3_b32 v49, v40, v41, v42 bitop3:0x96
    v_bitop3_b32 v49, v49, v43, v89 bitop3:0x96
    v_or_b32 v48, v48, v49
    v_bitop3_b32 v49, v44, v45, v46 bitop3:0x96
    v_bitop3_b32 v49, v49, v47, v89 bitop3:0x96
    v_or_b32 v48, v48, v49
    v_cmp_ne_u32 vcc, 0, v48
    s_cbranch_vccz Q0OK
    s_add_u32 s51, s51, 1
    s_sleep 4
    s_cmp_lt_u32 s51, 0x8000
    s_cbranch_scc1 Q0P
Q0OK:
    v_pk_add_f32 v[16:17], v[16:17], v[20:21]
    v_add_f32 v18, v18, v22
    v_pk_add_f32 v[16:17], v[16:17], v[24:25]
    v_add_f32 v18, v18, v26
    v_pk_add_f32 v[16:17], v[16:17], v[28:29]
    v_add_f32 v18, v18, v30
    v_pk_add_f32 v[16:17], v[16:17], v[32:33]
    v_add_f32 v18, v18, v34
    v_pk_add_f32 v[16:17], v[16:17], v[36:37]
    v_add_f32 v18, v18, v38
    v_pk_add_f32 v[16:17], v[16:17], v[40:41]
    v_add_f32 v18, v18, v42
    v_pk_add_f32 v[16:17], v[16:17], v[44:45]
    v_add_f32 v18, v18, v46
    v_cvt_pk_bf16_f32 v16, v16, v17
    v_cvt_pk_bf16_f32 v18, v18, v18
    ds_write_b16 v15, v16
    ds_write_b16_d16_hi v15, v16 offset:128
    ds_write_b16 v15, v18 offset:256
    s_mov_b32 s51, 0
HSP:
    s_mov_b32 s52, 1376256
    buffer_load_dwordx4 v[24:27], v88, s[16:19], s52 offen sc1
    s_waitcnt vmcnt(0)
    v_xor_b32 v20, s5, v24
    v_xor_b32 v21, s5, v25
    v_xor_b32 v22, s5, v26
    v_xor_b32 v23, s5, v27
    v_or3_b32 v20, v20, v21, v22
    v_or_b32 v20, v20, v23
    v_cmp_lt_u32 vcc, 15, v20
    s_cbranch_vccz HSOK
    s_add_u32 s51, s51, 1
    s_sleep 8
    s_cmp_lt_u32 s51, 0x8000
    s_cbranch_scc1 HSP
HSOK:
    v_cmp_ne_u32 vcc, 0, v20
    s_lshl_b32 s52, s45, 3
    s_lshr_b64 s[60:61], vcc, s52
    s_and_b32 s52, s60, 0xff
    s_cselect_b32 s50, 0, 1
    v_mov_b32 v38, 98784
    v_or_b32 v39, s50, v89
    ds_write_b32 v38, v39
    v_and_b32 v21, 0xffff0000, v86
    v_lshlrev_b32 v20, 16, v86
    buffer_store_dwordx2 v[20:21], v87, s[16:19], 0 offen sc1
    s_branch ENTRY
HOOKE:
    s_cmp_lg_u32 s44, 3
    s_cbranch_scc1 QFRAG
    s_waitcnt lgkmcnt(0)
    s_barrier
    s_waitcnt vmcnt(26)
    buffer_load_dwordx4 a[0:3], v80, s[8:11], s96 offen offset:0 nt
    s_waitcnt vmcnt(26)
    buffer_load_dwordx4 a[8:11], v80, s[8:11], s96 offen offset:128 nt
    s_waitcnt vmcnt(26)
    buffer_load_dwordx4 a[16:19], v80, s[8:11], s96 offen offset:256 nt
    s_add_u32 s96, s96, s97
    s_waitcnt vmcnt(26)
    buffer_load_dwordx4 a[4:7], v80, s[8:11], s96 offen offset:0 nt
    s_waitcnt vmcnt(26)
    buffer_load_dwordx4 a[12:15], v80, s[8:11], s96 offen offset:128 nt
    s_waitcnt vmcnt(26)
    buffer_load_dwordx4 a[20:23], v80, s[8:11], s96 offen offset:256 nt
    s_add_u32 s96, s96, s97
    s_waitcnt vmcnt(26)
    buffer_load_dwordx4 a[24:27], v80, s[8:11], s96 offen offset:0 nt
    s_waitcnt vmcnt(26)
    buffer_load_dwordx4 a[32:35], v80, s[8:11], s96 offen offset:128 nt
    s_waitcnt vmcnt(26)
    buffer_load_dwordx4 a[40:43], v80, s[8:11], s96 offen offset:256 nt
    s_add_u32 s96, s96, s97
    s_waitcnt vmcnt(26)
    buffer_load_dwordx4 a[28:31], v80, s[8:11], s96 offen offset:0 nt
    s_waitcnt vmcnt(26)
    buffer_load_dwordx4 a[36:39], v80, s[8:11], s96 offen offset:128 nt
    s_waitcnt vmcnt(26)
    buffer_load_dwordx4 a[44:47], v80, s[8:11], s96 offen offset:256 nt
    s_add_u32 s96, s96, s97
    s_waitcnt vmcnt(26)
    buffer_load_dwordx4 a[48:51], v80, s[8:11], s96 offen offset:0 nt
    s_waitcnt vmcnt(26)
    buffer_load_dwordx4 a[56:59], v80, s[8:11], s96 offen offset:128 nt
    s_waitcnt vmcnt(26)
    buffer_load_dwordx4 a[64:67], v80, s[8:11], s96 offen offset:256 nt
    s_add_u32 s96, s96, s97
    s_waitcnt vmcnt(26)
    buffer_load_dwordx4 a[52:55], v80, s[8:11], s96 offen offset:0 nt
    s_waitcnt vmcnt(26)
    buffer_load_dwordx4 a[60:63], v80, s[8:11], s96 offen offset:128 nt
    s_waitcnt vmcnt(26)
    buffer_load_dwordx4 a[68:71], v80, s[8:11], s96 offen offset:256 nt
    s_add_u32 s96, s96, s97
    s_waitcnt vmcnt(26)
    buffer_load_dwordx4 a[72:75], v80, s[8:11], s96 offen offset:0 nt
    s_waitcnt vmcnt(26)
    buffer_load_dwordx4 a[80:83], v80, s[8:11], s96 offen offset:128 nt
    s_waitcnt vmcnt(26)
    buffer_load_dwordx4 a[88:91], v80, s[8:11], s96 offen offset:256 nt
    s_add_u32 s96, s96, s97
    s_waitcnt vmcnt(26)
    buffer_load_dwordx4 a[76:79], v80, s[8:11], s96 offen offset:0 nt
    s_waitcnt vmcnt(26)
    buffer_load_dwordx4 a[84:87], v80, s[8:11], s96 offen offset:128 nt
    s_waitcnt vmcnt(26)
    buffer_load_dwordx4 a[92:95], v80, s[8:11], s96 offen offset:256 nt
    s_add_u32 s96, s96, s97
    s_waitcnt vmcnt(26)
    buffer_load_dwordx4 a[96:99], v80, s[8:11], s96 offen offset:0 nt
    s_waitcnt vmcnt(26)
    buffer_load_dwordx4 a[104:107], v80, s[8:11], s96 offen offset:128 nt
    s_waitcnt vmcnt(26)
    buffer_load_dwordx4 a[112:115], v80, s[8:11], s96 offen offset:256 nt
    s_add_u32 s96, s96, s97
    s_waitcnt vmcnt(26)
    buffer_load_dwordx4 a[100:103], v80, s[8:11], s96 offen offset:0 nt
    s_waitcnt vmcnt(26)
    buffer_load_dwordx4 a[108:111], v80, s[8:11], s96 offen offset:128 nt
    s_waitcnt vmcnt(26)
    buffer_load_dwordx4 a[116:119], v80, s[8:11], s96 offen offset:256 nt
    s_add_u32 s96, s96, s97
    s_waitcnt vmcnt(26)
    buffer_load_dwordx4 a[120:123], v80, s[8:11], s96 offen offset:0 nt
    s_waitcnt vmcnt(26)
    buffer_load_dwordx4 a[128:131], v80, s[8:11], s96 offen offset:128 nt
    s_waitcnt vmcnt(26)
    buffer_load_dwordx4 a[136:139], v80, s[8:11], s96 offen offset:256 nt
    s_add_u32 s96, s96, s97
    s_waitcnt vmcnt(26)
    buffer_load_dwordx4 a[124:127], v80, s[8:11], s96 offen offset:0 nt
    s_waitcnt vmcnt(26)
    buffer_load_dwordx4 a[132:135], v80, s[8:11], s96 offen offset:128 nt
    s_waitcnt vmcnt(26)
    buffer_load_dwordx4 a[140:143], v80, s[8:11], s96 offen offset:256 nt
    s_add_u32 s96, s96, s97
    s_waitcnt vmcnt(26)
    buffer_load_dwordx4 a[144:147], v80, s[8:11], s96 offen offset:0 nt
    s_waitcnt vmcnt(26)
    buffer_load_dwordx4 a[152:155], v80, s[8:11], s96 offen offset:128 nt
    s_waitcnt vmcnt(26)
    buffer_load_dwordx4 a[160:163], v80, s[8:11], s96 offen offset:256 nt
    s_add_u32 s96, s96, s97
    s_waitcnt vmcnt(26)
    buffer_load_dwordx4 a[148:151], v80, s[8:11], s96 offen offset:0 nt
    s_waitcnt vmcnt(26)
    buffer_load_dwordx4 a[156:159], v80, s[8:11], s96 offen offset:128 nt
    s_waitcnt vmcnt(26)
    buffer_load_dwordx4 a[164:167], v80, s[8:11], s96 offen offset:256 nt
    s_add_u32 s96, s96, s97
    s_waitcnt vmcnt(26)
    buffer_load_dwordx4 a[168:171], v80, s[8:11], s96 offen offset:0 nt
    s_waitcnt vmcnt(26)
    buffer_load_dwordx4 a[176:179], v80, s[8:11], s96 offen offset:128 nt
    s_waitcnt vmcnt(26)
    buffer_load_dwordx4 a[184:187], v80, s[8:11], s96 offen offset:256 nt
    s_add_u32 s96, s96, s97
    s_waitcnt vmcnt(26)
    buffer_load_dwordx4 a[172:175], v80, s[8:11], s96 offen offset:0 nt
    s_waitcnt vmcnt(26)
    buffer_load_dwordx4 a[180:183], v80, s[8:11], s96 offen offset:128 nt
    s_waitcnt vmcnt(26)
    buffer_load_dwordx4 a[188:191], v80, s[8:11], s96 offen offset:256 nt
    s_lshl_b32 s97, s97, 1
    s_waitcnt vmcnt(26)
    buffer_load_dwordx4 a[192:195], v82, s[12:15], s55 offen offset:0 nt
    s_waitcnt vmcnt(26)
    buffer_load_dwordx4 a[200:203], v82, s[12:15], s55 offen offset:128 nt
    s_waitcnt vmcnt(26)
    buffer_load_dwordx4 a[208:211], v82, s[12:15], s55 offen offset:256 nt
    s_waitcnt vmcnt(26)
    buffer_load_dwordx4 a[216:219], v82, s[12:15], s55 offen offset:384 nt
    s_waitcnt vmcnt(26)
    buffer_load_dwordx4 a[224:227], v82, s[12:15], s55 offen offset:512 nt
    s_waitcnt vmcnt(26)
    buffer_load_dwordx4 a[232:235], v82, s[12:15], s55 offen offset:640 nt
    s_add_u32 s55, s55, s97
    s_waitcnt vmcnt(26)
    buffer_load_dwordx4 a[196:199], v82, s[12:15], s55 offen offset:0 nt
    s_waitcnt vmcnt(26)
    buffer_load_dwordx4 a[204:207], v82, s[12:15], s55 offen offset:128 nt
    s_waitcnt vmcnt(26)
    buffer_load_dwordx4 a[212:215], v82, s[12:15], s55 offen offset:256 nt
    s_waitcnt vmcnt(26)
    buffer_load_dwordx4 a[220:223], v82, s[12:15], s55 offen offset:384 nt
    s_waitcnt vmcnt(26)
    buffer_load_dwordx4 a[228:231], v82, s[12:15], s55 offen offset:512 nt
    s_waitcnt vmcnt(26)
    buffer_load_dwordx4 a[236:239], v82, s[12:15], s55 offen offset:640 nt
    s_add_u32 s55, s55, s97
    s_waitcnt vmcnt(26)
    buffer_load_dwordx4 a[240:243], v82, s[12:15], s55 offen offset:0 nt
    s_waitcnt vmcnt(26)
    buffer_load_dwordx4 a[248:251], v82, s[12:15], s55 offen offset:128 nt
    s_waitcnt vmcnt(26)
    buffer_load_dwordx4 v[128:131], v82, s[12:15], s55 offen offset:256 nt
    s_waitcnt vmcnt(26)
    buffer_load_dwordx4 v[136:139], v82, s[12:15], s55 offen offset:384 nt
    s_waitcnt vmcnt(26)
    buffer_load_dwordx4 v[144:147], v82, s[12:15], s55 offen offset:512 nt
    s_waitcnt vmcnt(26)
    buffer_load_dwordx4 v[152:155], v82, s[12:15], s55 offen offset:640 nt
    s_add_u32 s55, s55, s97
    s_waitcnt vmcnt(26)
    buffer_load_dwordx4 a[244:247], v82, s[12:15], s55 offen offset:0 nt
    s_waitcnt vmcnt(26)
    buffer_load_dwordx4 a[252:255], v82, s[12:15], s55 offen offset:128 nt
    s_waitcnt vmcnt(26)
    buffer_load_dwordx4 v[132:135], v82, s[12:15], s55 offen offset:256 nt
    s_waitcnt vmcnt(26)
    buffer_load_dwordx4 v[140:143], v82, s[12:15], s55 offen offset:384 nt
    s_waitcnt vmcnt(26)
    buffer_load_dwordx4 v[148:151], v82, s[12:15], s55 offen offset:512 nt
    s_waitcnt vmcnt(26)
    buffer_load_dwordx4 v[156:159], v82, s[12:15], s55 offen offset:640 nt
    s_add_u32 s55, s55, s97
    s_waitcnt vmcnt(26)
    buffer_load_dwordx4 v[160:163], v82, s[12:15], s55 offen offset:0 nt
    s_waitcnt vmcnt(26)
    buffer_load_dwordx4 v[168:171], v82, s[12:15], s55 offen offset:128 nt
    s_waitcnt vmcnt(26)
    buffer_load_dwordx4 v[176:179], v82, s[12:15], s55 offen offset:256 nt
    s_waitcnt vmcnt(26)
    buffer_load_dwordx4 v[184:187], v82, s[12:15], s55 offen offset:384 nt
    s_waitcnt vmcnt(26)
    buffer_load_dwordx4 v[192:195], v82, s[12:15], s55 offen offset:512 nt
    s_waitcnt vmcnt(26)
    buffer_load_dwordx4 v[200:203], v82, s[12:15], s55 offen offset:640 nt
    s_add_u32 s55, s55, s97
    s_waitcnt vmcnt(26)
    buffer_load_dwordx4 v[164:167], v82, s[12:15], s55 offen offset:0 nt
    s_waitcnt vmcnt(26)
    buffer_load_dwordx4 v[172:175], v82, s[12:15], s55 offen offset:128 nt
    s_waitcnt vmcnt(26)
    buffer_load_dwordx4 v[180:183], v82, s[12:15], s55 offen offset:256 nt
    s_waitcnt vmcnt(26)
    buffer_load_dwordx4 v[188:191], v82, s[12:15], s55 offen offset:384 nt
    s_waitcnt vmcnt(26)
    buffer_load_dwordx4 v[196:199], v82, s[12:15], s55 offen offset:512 nt
    s_waitcnt vmcnt(26)
    buffer_load_dwordx4 v[204:207], v82, s[12:15], s55 offen offset:640 nt
    s_add_u32 s55, s55, s97
    s_waitcnt vmcnt(26)
    buffer_load_dwordx4 v[208:211], v82, s[12:15], s55 offen offset:0 nt
    s_waitcnt vmcnt(26)
    buffer_load_dwordx4 v[216:219], v82, s[12:15], s55 offen offset:128 nt
    s_waitcnt vmcnt(26)
    buffer_load_dwordx4 v[224:227], v82, s[12:15], s55 offen offset:256 nt
    s_waitcnt vmcnt(26)
    buffer_load_dwordx4 v[232:235], v82, s[12:15], s55 offen offset:384 nt
    s_waitcnt vmcnt(26)
    buffer_load_dwordx4 v[240:243], v82, s[12:15], s55 offen offset:512 nt
    s_waitcnt vmcnt(26)
    buffer_load_dwordx4 v[248:251], v82, s[12:15], s55 offen offset:640 nt
    s_add_u32 s55, s55, s97
    s_barrier
    s_waitcnt vmcnt(26)
    buffer_load_dwordx4 v[212:215], v82, s[12:15], s55 offen offset:0 nt
    s_waitcnt vmcnt(26)
    buffer_load_dwordx4 v[220:223], v82, s[12:15], s55 offen offset:128 nt
    s_waitcnt vmcnt(26)
    buffer_load_dwordx4 v[228:231], v82, s[12:15], s55 offen offset:256 nt
    s_waitcnt vmcnt(26)
    buffer_load_dwordx4 v[236:239], v82, s[12:15], s55 offen offset:384 nt
    s_waitcnt vmcnt(26)
    buffer_load_dwordx4 v[244:247], v82, s[12:15], s55 offen offset:512 nt
    s_waitcnt vmcnt(26)
    buffer_load_dwordx4 v[252:255], v82, s[12:15], s55 offen offset:640 nt
    s_branch QFRAG
HOOKF:
    v_mov_b32 v40, 98784
    ds_read_b32 v40, v40
    s_mov_b32 s6, 0
    s_waitcnt lgkmcnt(0)
    v_readfirstlane_b32 s101, v40
    s_and_b32 s50, s101, 1
    s_and_b32 s101, s101, 0xfffffff0
    s_waitcnt vmcnt(48)
    s_branch QK
HOOKC:
    s_cmp_eq_u32 s44, 3
    s_cbranch_scc1 EXB
    v_min_u32 v83, 8, v1
    v_lshlrev_b32 v83, 7, v83
    s_mul_i32 s52, s45, 28160
    s_mul_i32 s54, s46, 1152
    s_add_u32 s52, s52, s54
    s_add_u32 s52, s52, 81920
    buffer_load_dword v83, v83, s[16:19], s52 offen sc1
    v_lshrrev_b32 v54, 3, v1
    v_and_b32 v53, 7, v1
    v_and_b32 v55, 2, v54
    v_xor_b32 v53, v53, v55
    s_and_b32 s52, s44, 1
    s_lshl_b32 s52, s52, 2
    v_xor_b32 v53, s52, v53
    v_mul_u32_u24 v55, 1280, v54
    v_lshl_add_u32 v55, v53, 4, v55
    s_barrier
    s_cmp_ge_u32 s46, 20
    s_cbranch_scc1 HC8
    s_mul_i32 s52, s45, 983040
    s_mul_i32 s54, s56, 491520
    s_add_u32 s52, s52, s54
    s_lshl_b32 s54, s57, 7
    s_add_u32 s52, s52, s54
    s_mul_i32 s54, s44, 10240
    s_add_u32 s52, s52, s54
    s_lshl_b32 s53, s44, 10
DMA1:
    s_mov_b32 m0, s53
    s_add_u32 s53, s53, 3072
    buffer_load_dwordx4 v55, s[24:27], s52 offen nt lds
    v_xor_b32 v55, 64, v55
    s_add_u32 s52, s52, 30720
    s_cmp_lt_u32 s53, 49152
    s_cbranch_scc1 DMA1
    s_branch HC9
HC8:
HC9:
    s_branch EXB
HOOKG:
    v_and_b32 v71, 3, v1
    v_lshlrev_b32 v71, 3, v71
    v_bfe_u32 v72, v1, 2, 2
    v_lshl_add_u32 v71, v72, 7, v71
    v_lshrrev_b32 v72, 4, v1
    v_lshl_add_u32 v71, v72, 10, v71
    v_bfe_u32 v72, v1, 3, 2
    v_lshl_add_u32 v71, v72, 5, v71
    s_mul_i32 s52, s44, 12288
    v_add_u32 v71, s52, v71
    v_xor_b32 v72, 32, v71
    v_xor_b32 v73, 64, v71
    v_xor_b32 v74, 96, v71
    v_lshrrev_b32 v14, 5, v1
    v_lshlrev_b32 v14, 11, v14
    v_and_b32 v15, 31, v1
    v_lshl_add_u32 v14, v15, 2, v14
    s_lshl_b32 s52, s57, 12
    s_lshl_b32 s54, s45, 8
    s_add_u32 s52, s52, s54
    s_lshl_b32 s54, s56, 7
    s_add_u32 s52, s52, s54
    v_add_u32 v14, s52, v14
    s_lshl_b32 s52, s44, 9
    s_add_u32 s52, s52, 104960
    v_lshl_add_u32 v15, v15, 4, s52
    v_and_b32 v64, 15, v1
    v_lshlrev_b32 v64, 4, v64
    v_lshl_add_u32 v64, v31, 2, v64
    v_add_u32 v64, 104960, v64
    s_cmp_lg_u32 s44, 3
    s_cbranch_scc1 QCNA
    v_lshlrev_b32 v38, 2, v1
    v_add_u32 v39, 107520, v38
    v_lshlrev_b32 v38, 1, v38
    ds_read_b32 v32, v39 offset:0
    ds_read_b32 v34, v39 offset:256
    ds_read_b32 v36, v39 offset:512
    s_mul_i32 s52, s47, 12288
    s_mul_i32 s54, s48, 1536
    s_add_u32 s52, s52, s54
    s_add_u32 s52, s52, 1441792
    s_waitcnt lgkmcnt(0)
    v_xor_b32 v33, s101, v32
    v_xor_b32 v35, s101, v34
    v_xor_b32 v37, s101, v36
    s_cmp_eq_u32 s50, 0
    s_cbranch_scc1 SLOW3
    buffer_store_dwordx2 v[32:33], v38, s[16:19], s52 offen offset:0
    buffer_store_dwordx2 v[34:35], v38, s[16:19], s52 offen offset:512
    buffer_store_dwordx2 v[36:37], v38, s[16:19], s52 offen offset:1024
PUBD3:
    s_branch QCMA
QCNA:
    s_waitcnt vmcnt(1)
QCMA:
    s_barrier
    s_branch WO0
HOOKG2:
    ds_read_b64_tr_b16 v[80:81], v71 offset:0
    ds_read_b64_tr_b16 v[82:83], v71 offset:512
    ds_read_b64_tr_b16 v[96:97], v71 offset:4096
    ds_read_b64_tr_b16 v[98:99], v71 offset:4608
    ds_read_b64_tr_b16 v[112:113], v71 offset:8192
    ds_read_b64_tr_b16 v[114:115], v71 offset:8704
    ds_read_b64_tr_b16 v[84:85], v72 offset:0
    ds_read_b64_tr_b16 v[86:87], v72 offset:512
    ds_read_b64_tr_b16 v[100:101], v72 offset:4096
    ds_read_b64_tr_b16 v[102:103], v72 offset:4608
    ds_read_b64_tr_b16 v[116:117], v72 offset:8192
    ds_read_b64_tr_b16 v[118:119], v72 offset:8704
    ds_read_b64_tr_b16 v[88:89], v73 offset:0
    ds_read_b64_tr_b16 v[90:91], v73 offset:512
    ds_read_b64_tr_b16 v[104:105], v73 offset:4096
    ds_read_b64_tr_b16 v[106:107], v73 offset:4608
    ds_read_b64_tr_b16 v[120:121], v73 offset:8192
    ds_read_b64_tr_b16 v[122:123], v73 offset:8704
    ds_read_b64_tr_b16 v[92:93], v74 offset:0
    ds_read_b64_tr_b16 v[94:95], v74 offset:512
    ds_read_b64_tr_b16 v[108:109], v74 offset:4096
    ds_read_b64_tr_b16 v[110:111], v74 offset:4608
    ds_read_b64_tr_b16 v[124:125], v74 offset:8192
    ds_read_b64_tr_b16 v[126:127], v74 offset:8704
    s_waitcnt lgkmcnt(0)
    s_branch WOP
HOOKG3:
    s_cmp_lg_u32 s49, 0
    s_cbranch_scc1 WOX
    v_and_b32 v71, 3, v1
    v_lshlrev_b32 v71, 3, v71
    v_bfe_u32 v72, v1, 2, 2
    v_lshl_add_u32 v71, v72, 7, v71
    v_lshrrev_b32 v72, 4, v1
    v_lshl_add_u32 v71, v72, 10, v71
    v_bfe_u32 v72, v1, 3, 2
    v_lshl_add_u32 v71, v72, 5, v71
    s_lshl_b32 s52, s44, 5
    v_xor_b32 v71, s52, v71
    s_cmp_lg_u32 s44, 3
    s_cbranch_scc1 QCNB
    v_lshlrev_b32 v38, 2, v1
    v_add_u32 v39, 107520, v38
    v_lshlrev_b32 v38, 1, v38
    ds_read_b32 v32, v39 offset:0
    ds_read_b32 v34, v39 offset:256
    ds_read_b32 v36, v39 offset:512
    s_mul_i32 s52, s47, 12288
    s_mul_i32 s54, s48, 1536
    s_add_u32 s52, s52, s54
    s_add_u32 s52, s52, 1441792
    s_waitcnt lgkmcnt(0)
    v_xor_b32 v33, s101, v32
    v_xor_b32 v35, s101, v34
    v_xor_b32 v37, s101, v36
    s_cmp_eq_u32 s50, 0
    s_cbranch_scc1 SLOW4
    buffer_store_dwordx2 v[32:33], v38, s[16:19], s52 offen offset:0
    buffer_store_dwordx2 v[34:35], v38, s[16:19], s52 offen offset:512
    buffer_store_dwordx2 v[36:37], v38, s[16:19], s52 offen offset:1024
PUBD4:
    s_branch QCMB
QCNB:
    s_cmp_ge_u32 s46, 30
    s_cbranch_scc1 QCMB
    v_lshrrev_b32 v33, 3, v1
    v_and_b32 v32, 7, v1
    v_and_b32 v34, 2, v33
    v_xor_b32 v32, v32, v34
    s_and_b32 s52, s44, 1
    s_lshl_b32 s52, s52, 2
    v_xor_b32 v32, s52, v32
    v_mul_u32_u24 v34, 3072, v33
    v_lshl_add_u32 v34, v32, 4, v34
    s_mul_i32 s52, s3, 393216
    s_mul_i32 s54, s45, 384
    s_add_u32 s52, s52, s54
    s_lshl_b32 s54, s59, 7
    s_add_u32 s52, s52, s54
    s_mul_i32 s54, s44, 24576
    s_add_u32 s52, s52, s54
    s_lshl_b32 s53, s44, 10
    s_add_u32 s53, s53, 49152
DMA2:
    s_mov_b32 m0, s53
    s_add_u32 s53, s53, 3072
    buffer_load_dwordx4 v34, s[28:31], s52 offen nt lds
    v_xor_b32 v34, 64, v34
    s_add_u32 s52, s52, 73728
    s_cmp_lt_u32 s53, 65536
    s_cbranch_scc1 DMA2
    v_lshrrev_b32 v33, 3, v1
    v_and_b32 v32, 7, v1
    v_and_b32 v34, 2, v33
    v_xor_b32 v32, v32, v34
    s_and_b32 s52, s44, 1
    s_lshl_b32 s52, s52, 2
    v_xor_b32 v32, s52, v32
    v_mul_u32_u24 v34, 1280, v33
    v_lshl_add_u32 v34, v32, 4, v34
    s_mul_i32 s52, s45, 245760
    s_lshl_b32 s54, s57, 7
    s_add_u32 s52, s52, s54
    s_mul_i32 s54, s44, 10240
    s_add_u32 s52, s52, s54
    s_lshl_b32 s53, s44, 10
DMA3:
    s_mov_b32 m0, s53
    s_add_u32 s53, s53, 3072
    buffer_load_dwordx4 v34, s[24:27], s52 offen nt lds
    v_xor_b32 v34, 64, v34
    s_add_u32 s52, s52, 30720
    s_cmp_lt_u32 s53, 24576
    s_cbranch_scc1 DMA3
    s_waitcnt vmcnt(0)
    s_waitcnt vmcnt(1)
QCMB:
    s_barrier
    ds_read_b64_tr_b16 v[80:81], v71 offset:0
    ds_read_b64_tr_b16 v[82:83], v71 offset:512
    ds_read_b64_tr_b16 v[84:85], v71 offset:4096
    ds_read_b64_tr_b16 v[86:87], v71 offset:4608
    ds_read_b64_tr_b16 v[88:89], v71 offset:8192
    ds_read_b64_tr_b16 v[90:91], v71 offset:8704
    ds_read_b64_tr_b16 v[92:93], v71 offset:12288
    ds_read_b64_tr_b16 v[94:95], v71 offset:12800
    ds_read_b64_tr_b16 v[96:97], v71 offset:16384
    ds_read_b64_tr_b16 v[98:99], v71 offset:16896
    ds_read_b64_tr_b16 v[100:101], v71 offset:20480
    ds_read_b64_tr_b16 v[102:103], v71 offset:20992
    s_branch WOX
HOOKJ:
    s_cmp_ge_u32 s46, 20
    s_cbranch_scc1 F1NB
    s_cmp_eq_u32 s44, 3
    s_cbranch_scc1 F1NB
    v_lshrrev_b32 v33, 3, v1
    v_and_b32 v32, 7, v1
    v_and_b32 v34, 2, v33
    v_xor_b32 v32, v32, v34
    s_and_b32 s52, s44, 1
    s_lshl_b32 s52, s52, 2
    v_xor_b32 v32, s52, v32
    v_mul_u32_u24 v34, 3072, v33
    v_lshl_add_u32 v34, v32, 4, v34
    s_mul_i32 s52, s3, 393216
    s_mul_i32 s54, s45, 384
    s_add_u32 s52, s52, s54
    s_lshl_b32 s54, s59, 7
    s_add_u32 s52, s52, s54
    s_mul_i32 s54, s44, 24576
    s_add_u32 s52, s52, s54
    s_lshl_b32 s53, s44, 10
    s_add_u32 s53, s53, 49152
DMA4:
    s_mov_b32 m0, s53
    s_add_u32 s53, s53, 3072
    buffer_load_dwordx4 v34, s[28:31], s52 offen nt lds
    v_xor_b32 v34, 64, v34
    s_add_u32 s52, s52, 73728
    s_cmp_lt_u32 s53, 65536
    s_cbranch_scc1 DMA4
    s_branch F1NB
HOOKK:
    ds_read_b64_tr_b16 v[64:65], v61 offset:49152
    ds_read_b64_tr_b16 v[66:67], v61 offset:49664
    ds_read_b64_tr_b16 v[68:69], v61 offset:53248
    ds_read_b64_tr_b16 v[70:71], v61 offset:53760
    ds_read_b64_tr_b16 v[72:73], v61 offset:57344
    ds_read_b64_tr_b16 v[74:75], v61 offset:57856
    ds_read_b64_tr_b16 v[76:77], v61 offset:61440
    ds_read_b64_tr_b16 v[78:79], v61 offset:61952
    s_branch F1R
HOOKM:
    s_mov_b64 exec, 0xffff
    s_add_u32 s53, s62, 8192
    s_cmp_eq_u32 s50, 0
    s_cbranch_scc1 SLOW5
    buffer_store_dword v41, v14, s[16:19], s53 offen
PUBD5:
    s_branch F1X
HOOKD:
    v_mov_b64 v[44:45], -1
    v_lshlrev_b32 v47, 3, v1
    s_mul_i32 s52, s46, 1536
    s_mul_i32 s54, s44, 384
    s_add_u32 s52, s52, s54
    v_add_u32 v46, s52, v47
    v_cmp_gt_u32 vcc, 45312, v46
    s_lshl_b32 s52, s2, 9
    s_lshl_b32 s54, s44, 7
    s_add_u32 s52, s52, s54
    v_add_u32 v47, s52, v47
    s_and_b32 exec_lo, vcc_lo, -1
    s_and_b32 exec_hi, vcc_hi, 0xffff
    s_cbranch_execz HD1
    s_cmp_eq_u32 s50, 0
    s_cbranch_scc1 SLOW6
    buffer_store_dwordx2 v[44:45], v46, s[16:19], s63 offen
PUBD6:
HD1:
    s_mov_b64 exec, -1
    v_cmp_gt_u32 vcc, 87040, v47
    s_mov_b32 s52, 327680
    s_and_b32 exec_lo, vcc_lo, 0xffff
    s_mov_b32 exec_hi, 0
    s_cbranch_execz HD2
    buffer_store_dwordx2 v[44:45], v47, s[16:19], s52 offen sc1
HD2:
    s_mov_b64 exec, -1
    s_cmp_lt_u32 s46, 20
    s_cbranch_scc1 F1S
    s_mov_b32 s100, 3
    s_cmp_eq_u32 s44, 3
    s_cbranch_scc1 F1S
    v_lshlrev_b32 v32, 3, v0
    s_mul_i32 s52, s47, 12288
    s_add_u32 s52, s52, 1441792
    s_mov_b32 s51, 0
QCPB:
    s_add_u32 s53, s52, 0
    buffer_load_dwordx2 v[16:17], v32, s[16:19], s53 offen offset:0 sc1
    buffer_load_dwordx2 v[18:19], v32, s[16:19], s53 offen offset:1536 sc1
    s_add_u32 s53, s52, 3072
    buffer_load_dwordx2 v[20:21], v32, s[16:19], s53 offen offset:0 sc1
    buffer_load_dwordx2 v[22:23], v32, s[16:19], s53 offen offset:1536 sc1
    s_add_u32 s53, s52, 6144
    buffer_load_dwordx2 v[24:25], v32, s[16:19], s53 offen offset:0 sc1
    buffer_load_dwordx2 v[26:27], v32, s[16:19], s53 offen offset:1536 sc1
    s_add_u32 s53, s52, 9216
    buffer_load_dwordx2 v[28:29], v32, s[16:19], s53 offen offset:0 sc1
    buffer_load_dwordx2 v[30:31], v32, s[16:19], s53 offen offset:1536 sc1
    s_waitcnt vmcnt(0)
    v_bitop3_b32 v17, v16, v17, s101 bitop3:0x96
    v_bitop3_b32 v19, v18, v19, s101 bitop3:0x96
    v_bitop3_b32 v21, v20, v21, s101 bitop3:0x96
    v_bitop3_b32 v23, v22, v23, s101 bitop3:0x96
    v_bitop3_b32 v25, v24, v25, s101 bitop3:0x96
    v_bitop3_b32 v27, v26, v27, s101 bitop3:0x96
    v_bitop3_b32 v29, v28, v29, s101 bitop3:0x96
    v_bitop3_b32 v31, v30, v31, s101 bitop3:0x96
    v_add_f32 v13, v16, v18
    v_add_f32 v13, v13, v20
    v_add_f32 v13, v13, v22
    v_add_f32 v13, v13, v24
    v_add_f32 v13, v13, v26
    v_add_f32 v13, v13, v28
    v_add_f32 v13, v13, v30
    v_or_b32 v17, v17, v19
    v_or_b32 v17, v17, v21
    v_or_b32 v17, v17, v23
    v_or_b32 v17, v17, v25
    v_or_b32 v17, v17, v27
    v_or_b32 v17, v17, v29
    v_or_b32 v17, v17, v31
    v_cmp_ne_u32 vcc, 0, v17
    s_cbranch_vccz QCOKB
    s_add_u32 s51, s51, 1
    s_sleep 2
    s_cmp_lt_u32 s51, 0x8000
    s_cbranch_scc1 QCPB
QCOKB:
    s_branch F1S
HOOKI:
    s_lshl_b32 s52, s57, 12
    s_lshl_b32 s54, s44, 10
    s_add_u32 s52, s52, s54
    s_lshl_b32 s54, s45, 7
    s_add_u32 s52, s52, s54
    s_add_u32 s52, s52, 40960
    v_lshl_add_u32 v14, v1, 2, s52
    v_lshlrev_b32 v57, 1, v0
    v_add_u32 v57, 96768, v57
    s_nop 7
GCP:
    buffer_load_dword v76, v59, s[16:19], s49 offen sc1
    buffer_load_dwordx2 v[74:75], v58, s[16:19], s62 offen sc1
    buffer_load_dwordx4 v[64:67], v52, s[16:19], s53 offen offset:0 sc1
    buffer_load_dwordx4 v[68:71], v52, s[16:19], s53 offen offset:3072 sc1
    buffer_load_dwordx2 v[72:73], v54, s[16:19], s53 offen sc1
    s_add_u32 s52, s62, 8192
    buffer_load_dwordx4 v[104:107], v52, s[16:19], s52 offen offset:0 sc1
    buffer_load_dwordx4 v[108:111], v52, s[16:19], s52 offen offset:3072 sc1
    buffer_load_dwordx2 v[112:113], v54, s[16:19], s52 offen sc1
    s_waitcnt vmcnt(0)
    v_pk_add_f32 v[104:105], v[104:105], v[106:107]
    v_pk_add_f32 v[108:109], v[108:109], v[110:111]
    v_add_f32 v126, v104, v105
    v_add_f32 v127, v108, v109
    v_pk_add_f32 v[126:127], v[126:127], v[112:113]
    v_cmp_u_f32 vcc, v126, v127
    s_cbranch_vccz GCOK
    s_add_u32 s51, s51, 1
    s_cmp_lt_u32 s51, 0x8000
    s_cbranch_scc1 GCP
GCOK:
    s_branch W2C
SLOW0:
    buffer_store_dword v30, v28, s[16:19], s49 offen sc1
    s_branch PUBD0
SLOW1:
    buffer_store_dword v16, v14, s[16:19], s62 offen offset:0 sc1
    buffer_store_dword v20, v14, s[16:19], s62 offen offset:1024 sc1
    buffer_store_dword v24, v14, s[16:19], s62 offen offset:2048 sc1
    s_mov_b64 exec, 1
    buffer_store_dwordx2 v[28:29], v15, s[16:19], s62 offen sc1
    s_branch PUBD1
SLOW2:
    buffer_store_dword v24, v14, s[16:19], s62 offen sc1
    s_branch PUBD2
SLOW3:
    buffer_store_dwordx2 v[32:33], v38, s[16:19], s52 offen offset:0 sc1
    buffer_store_dwordx2 v[34:35], v38, s[16:19], s52 offen offset:512 sc1
    buffer_store_dwordx2 v[36:37], v38, s[16:19], s52 offen offset:1024 sc1
    s_branch PUBD3
SLOW4:
    buffer_store_dwordx2 v[32:33], v38, s[16:19], s52 offen offset:0 sc1
    buffer_store_dwordx2 v[34:35], v38, s[16:19], s52 offen offset:512 sc1
    buffer_store_dwordx2 v[36:37], v38, s[16:19], s52 offen offset:1024 sc1
    s_branch PUBD4
SLOW5:
    buffer_store_dword v41, v14, s[16:19], s53 offen sc1
    s_branch PUBD5
SLOW6:
    buffer_store_dwordx2 v[44:45], v46, s[16:19], s63 offen sc1
    s_branch PUBD6
SLOW7:
    buffer_store_dword v16, v56, s[16:19], s49 offen sc1
    s_branch PUBD7
SLOW8:
    buffer_store_dword v40, v14, s[16:19], s62 offen sc1
    s_mov_b64 exec, 1
    buffer_store_dwordx2 v[44:45], v15, s[16:19], s62 offen sc1
    s_branch PUBD8
CODEEND:
    s_endpgm
.section .rodata,"a"
.p2align 6
.amdhsa_kernel interleave_layers__sliding_block_cached__glu_gated_swiglu__decode_kernel
  .amdhsa_next_free_vgpr 512
  .amdhsa_next_free_sgpr 102
  .amdhsa_accum_offset 256
  .amdhsa_group_segment_fixed_size 0
  .amdhsa_kernarg_size 96
  .amdhsa_user_sgpr_count 2
  .amdhsa_user_sgpr_kernarg_segment_ptr 1
  .amdhsa_system_sgpr_workgroup_id_x 1
.end_amdhsa_kernel
```

```asm
; @launch grid=(256,1,1) block=(256,1,1) lds=108288
.amdgcn_target "amdgcn-amd-amdhsa--gfx950"
.text
.globl interleave_layers__sliding_block_cached__glu_gated_swiglu__decode_kernel
.p2align 8
.type interleave_layers__sliding_block_cached__glu_gated_swiglu__decode_kernel,@function
interleave_layers__sliding_block_cached__glu_gated_swiglu__decode_kernel:
    s_cmp_ge_u32 s2, 256
    s_cbranch_scc1 DONE
    s_load_dwordx16 s[64:79], s[0:1], 0
    s_load_dwordx8 s[80:87], s[0:1], 64
    s_memrealtime s[98:99]
    s_getpc_b64 s[60:61]
PCREF:
    v_lshlrev_b32 v14, 7, v0
    v_cmp_gt_u32 vcc, CODEEND-PCREF, v14
    v_mov_b32 v15, s61
    s_and_saveexec_b64 s[88:89], vcc
    s_cbranch_execz NOPF
    v_add_co_u32 v14, vcc, s60, v14
    s_nop 1
    v_addc_co_u32 v15, vcc, 0, v15, vcc
    global_load_dword v79, v[14:15], off
NOPF:
    s_mov_b64 exec, s[88:89]
    v_and_b32 v1, 63, v0
    v_lshrrev_b32 v13, 6, v0
    s_and_b32 s45, s2, 7
    v_readfirstlane_b32 s44, v13
    s_lshr_b32 s46, s2, 3
    s_lshr_b32 s7, s46, 3
    s_lshl_b32 s52, s45, 2
    s_add_u32 s47, s7, s52
    s_and_b32 s48, s46, 7
    v_lshrrev_b32 v19, 4, v1
    v_bfe_u32 v21, v1, 1, 3
    v_and_b32 v20, 1, v1
    v_mul_u32_u24 v80, 384, v21
    v_lshl_add_u32 v80, v20, 4, v80
    v_lshl_add_u32 v80, v19, 5, v80
    s_mul_i32 s52, s48, 3
    s_lshl_b32 s54, s44, 0
    s_add_u32 s52, s52, s54
    s_add_u32 s53, s48, 384
    s_cmp_eq_u32 s44, 3
    s_cselect_b32 s52, s53, s52
    s_cselect_b32 s97, 8, 24
    s_mulk_i32 s97, 3072
    s_mul_i32 s55, s47, 12582912
    s_mul_i32 s54, s52, 3072
    s_add_u32 s55, s55, s54
    s_add_u32 s55, s55, 11010048
    s_mov_b32 s96, s55
    s_waitcnt lgkmcnt(0)
    s_mov_b32 s8, s66
    s_and_b32 s9, s67, 0xffff
    s_mov_b32 s10, 402653184
    s_mov_b32 s11, 0x20000
    s_mov_b32 s6, 1
    s_mov_b32 s100, 0
    s_cmp_eq_u32 s44, 3
    s_cbranch_scc1 SETUP
    buffer_load_dwordx4 a[0:3], v80, s[8:11], s96 offen offset:0 nt
    buffer_load_dwordx4 a[8:11], v80, s[8:11], s96 offen offset:128 nt
    buffer_load_dwordx4 a[16:19], v80, s[8:11], s96 offen offset:256 nt
    s_add_u32 s96, s96, s97
    buffer_load_dwordx4 a[4:7], v80, s[8:11], s96 offen offset:0 nt
    buffer_load_dwordx4 a[12:15], v80, s[8:11], s96 offen offset:128 nt
    buffer_load_dwordx4 a[20:23], v80, s[8:11], s96 offen offset:256 nt
    s_add_u32 s96, s96, s97
    buffer_load_dwordx4 a[24:27], v80, s[8:11], s96 offen offset:0 nt
    buffer_load_dwordx4 a[32:35], v80, s[8:11], s96 offen offset:128 nt
    buffer_load_dwordx4 a[40:43], v80, s[8:11], s96 offen offset:256 nt
    s_add_u32 s96, s96, s97
SETUP:
    s_mov_b32 s16, s86
    s_and_b32 s17, s87, 0xffff
    s_mov_b32 s18, 1610612736
    s_mov_b32 s19, 0x20000
    s_mov_b32 s12, s68
    s_and_b32 s13, s69, 0xffff
    s_mov_b32 s14, 402653184
    s_mov_b32 s15, 0x20000
    s_mov_b32 s20, s70
    s_and_b32 s21, s71, 0xffff
    s_mov_b32 s22, 7864320
    s_mov_b32 s23, 0x20000
    s_mov_b32 s32, s64
    s_and_b32 s33, s65, 0xffff
    s_mov_b32 s34, 1280
    s_mov_b32 s35, 0x20000
    s_mov_b32 s36, s82
    s_and_b32 s37, s83, 0xffff
    s_mov_b32 s38, 1280
    s_mov_b32 s39, 0x20000
    s_mov_b32 s40, s84
    s_and_b32 s41, s85, 0xffff
    s_mov_b32 s42, 256
    s_mov_b32 s43, 0x20000
    v_mov_b32 v87, 1879048192
    v_mov_b32 v88, 1879048192
    s_cmp_lg_u32 s44, 3
    s_cbranch_scc1 SETUP2
    v_mov_b32 v32, -1
    v_mov_b32 v33, -1
    v_mov_b32 v34, -1
    v_mov_b32 v35, -1
    s_cmp_lg_u32 s2, 0
    s_cbranch_scc1 NONW
    s_or_b32 s101, s98, 0x20
    s_and_b32 s101, s101, 0xffffffe0
    v_mov_b32 v24, s101
    v_mov_b32 v25, 0
    s_mov_b64 exec, 1
    buffer_store_dword v24, v25, s[40:43], 0 offen sc1
    s_mov_b64 exec, -1
NONW:
    v_lshlrev_b32 v24, 4, v1
    v_lshlrev_b32 v27, 2, v1
    s_mul_i32 s52, s2, 1536
    v_lshlrev_b32 v28, 3, v1
    buffer_store_dwordx4 v[32:35], v24, s[16:19], s52 offen sc1
    buffer_store_dwordx2 v[32:33], v28, s[16:19], s52 offen offset:1024 sc1
    v_mov_b32 v26, 1879048192
    v_mov_b32 v88, v24
    v_cmp_gt_u32 vcc, 40, v1
    v_lshlrev_b32 v27, 2, v1
    buffer_load_dwordx4 v[44:47], v24, s[32:35], 0 offen
    buffer_load_dword v48, v27, s[32:35], 0 offen offset:1024
    v_cndmask_b32 v28, v26, v27, vcc
    s_mul_i32 s52, s48, 160
    buffer_load_dword v86, v28, s[32:35], s52 offen
    s_mul_i32 s52, s48, 320
    s_add_u32 s52, s52, 131072
    s_and_b32 s53, s2, 0xc7
    s_cmp_eq_u32 s53, 0
    s_cselect_b32 s52, s52, 1879048192
    v_lshl_add_u32 v87, v1, 3, s52
    v_cndmask_b32 v87, v26, v87, vcc
    v_add_u32 v24, 0, v1
    v_mul_u32_u24 v36, 171, v24
    v_lshrrev_b32 v36, 12, v36
    v_mul_u32_u24 v37, 24, v36
    v_sub_u32 v37, v24, v37
    v_and_b32 v24, 2, v36
    v_xor_b32 v37, v37, v24
    v_mul_u32_u24 v36, 12288, v36
    v_lshl_add_u32 v38, v37, 4, v36
    v_add_u32 v24, 64, v1
    v_mul_u32_u24 v36, 171, v24
    v_lshrrev_b32 v36, 12, v36
    v_mul_u32_u24 v37, 24, v36
    v_sub_u32 v37, v24, v37
    v_and_b32 v24, 2, v36
    v_xor_b32 v37, v37, v24
    v_mul_u32_u24 v36, 12288, v36
    v_lshl_add_u32 v39, v37, 4, v36
    v_add_u32 v24, 128, v1
    v_mul_u32_u24 v36, 171, v24
    v_lshrrev_b32 v36, 12, v36
    v_mul_u32_u24 v37, 24, v36
    v_sub_u32 v37, v24, v37
    v_and_b32 v24, 2, v36
    v_xor_b32 v37, v37, v24
    v_mul_u32_u24 v36, 12288, v36
    v_lshl_add_u32 v40, v37, 4, v36
    s_mul_i32 s52, s48, 983040
    s_mul_i32 s54, s47, 384
    s_add_u32 s52, s52, s54
    s_mov_b32 s53, 65536
WQL:
    s_add_u32 m0, s53, 0
    s_nop 0
    buffer_load_dwordx4 v38, s[20:23], s52 offen nt lds
    v_xor_b32 v38, 64, v38
    s_add_u32 m0, s53, 1024
    s_nop 0
    buffer_load_dwordx4 v39, s[20:23], s52 offen nt lds
    v_xor_b32 v39, 64, v39
    s_add_u32 m0, s53, 2048
    s_nop 0
    buffer_load_dwordx4 v40, s[20:23], s52 offen nt lds
    v_xor_b32 v40, 64, v40
    s_add_u32 s52, s52, 98304
    s_add_u32 s53, s53, 3072
    s_cmp_lt_u32 s53, 96256
    s_cbranch_scc1 WQL
    v_mov_b32 v37, 0
    buffer_load_dword v89, v37, s[40:43], 0 offen sc1
    s_barrier
    s_waitcnt vmcnt(31)
    v_mov_b32 v36, 0x3f803f80
    v_mov_b32 v37, v36
    v_cndmask_b32 v36, 0, v36, vcc
    v_add_u32 v27, 96256, v27
    ds_write_b32 v27, v36 offset:1024
    ds_write_b32 v27, v37 offset:1280
    ds_write_b32 v27, v86
    v_mov_b64 v[36:37], 0
    ds_write_b32 v27, v36 offset:10752
    ds_write_b32 v27, v36 offset:11008
    v_mov_b32 v38, 0x3f803f80
    v_dot2_f32_bf16 v36, v44, v44, v36
    v_dot2_f32_bf16 v37, v44, v38, v37
    v_dot2_f32_bf16 v36, v45, v45, v36
    v_dot2_f32_bf16 v37, v45, v38, v37
    v_dot2_f32_bf16 v36, v46, v46, v36
    v_dot2_f32_bf16 v37, v46, v38, v37
    v_dot2_f32_bf16 v36, v47, v47, v36
    v_dot2_f32_bf16 v37, v47, v38, v37
    v_dot2_f32_bf16 v36, v48, v48, v36
    v_dot2_f32_bf16 v37, v48, v38, v37
    s_nop 2
    v_add_f32_dpp v36, v36, v36 quad_perm:[1,0,3,2] row_mask:0xf bank_mask:0xf
    v_add_f32_dpp v37, v37, v37 quad_perm:[1,0,3,2] row_mask:0xf bank_mask:0xf
    s_nop 0
    v_add_f32_dpp v36, v36, v36 quad_perm:[2,3,0,1] row_mask:0xf bank_mask:0xf
    v_add_f32_dpp v37, v37, v37 quad_perm:[2,3,0,1] row_mask:0xf bank_mask:0xf
    s_nop 0
    v_add_f32_dpp v36, v36, v36 row_half_mirror row_mask:0xf bank_mask:0xf
    v_add_f32_dpp v37, v37, v37 row_half_mirror row_mask:0xf bank_mask:0xf
    s_nop 0
    v_add_f32_dpp v36, v36, v36 row_mirror row_mask:0xf bank_mask:0xf
    v_add_f32_dpp v37, v37, v37 row_mirror row_mask:0xf bank_mask:0xf
    s_nop 0
    v_mov_b32 v39, v36
    s_nop 1
    v_permlane16_swap_b32 v36, v39
    v_add_f32 v36, v36, v39
    v_mov_b32 v39, v37
    s_nop 1
    v_permlane16_swap_b32 v37, v39
    v_add_f32 v37, v37, v39
    v_mov_b32 v39, v36
    s_nop 1
    v_permlane32_swap_b32 v36, v39
    v_add_f32 v36, v36, v39
    v_mov_b32 v39, v37
    s_nop 1
    v_permlane32_swap_b32 v37, v39
    v_add_f32 v37, v37, v39
    v_mov_b32 v39, 0x3727c5ac
    v_mul_f32 v37, 0x3acccccd, v37
    v_fmamk_f32 v36, v36, 0x3acccccd, v39
    v_fma_f32 v36, -v37, v37, v36
    v_rsq_f32 v36, v36
    v_mov_b32 v84, v37
    v_mul_f32 v85, 0x3dd53b94, v36
SETUP2:
    s_mov_b32 s32, s72
    s_and_b32 s33, s73, 0xffff
    s_mov_b32 s34, 7864320
    s_mov_b32 s35, 0x20000
    s_cmp_ge_u32 s46, 10
    s_cselect_b32 s56, 1, 0
    s_cmp_ge_u32 s46, 20
    s_cselect_b32 s52, 2, s56
    s_mul_i32 s52, s52, 10
    s_sub_u32 s57, s46, s52
    s_min_u32 s4, s46, 29
    s_cmp_ge_u32 s4, 15
    s_cselect_b32 s58, 1, 0
    s_mul_i32 s52, s58, 15
    s_sub_u32 s52, s4, s52
    s_mul_i32 s59, s52, 52
    s_lshr_b32 s59, s59, 8
    s_mul_i32 s53, s59, 5
    s_sub_u32 s3, s52, s53
    s_cmp_ge_u32 s46, 20
    s_cselect_b32 s24, s80, s72
    s_cselect_b32 s25, s81, s73
    s_mov_b32 s26, 7864320
    s_cselect_b32 s26, 1966080, s26
    s_and_b32 s25, s25, 0xffff
    s_mov_b32 s27, 0x20000
    s_cmp_eq_u32 s58, 1
    s_cselect_b32 s28, s78, s76
    s_cselect_b32 s29, s79, s77
    s_and_b32 s29, s29, 0xffff
    s_mov_b32 s30, 1966080
    s_mov_b32 s31, 0x20000
    s_mov_b32 s49, 0
    s_mul_i32 s63, s45, 45312
    s_add_u32 s63, s63, 529408
    s_mul_i32 s62, s45, 28160
    s_add_u32 s62, s62, 136192
    s_mov_b32 s50, 0
    s_mov_b32 s0, 0
    v_and_b32 v24, 15, v1
    v_cmp_eq_u32 vcc, 1, v24
    v_mov_b32 v25, 96256
    v_mov_b32 v26, 97280
    v_cndmask_b32 v2, v25, v26, vcc
    v_lshl_add_u32 v2, v19, 4, v2
    v_and_b32 v24, 3, v1
    v_lshlrev_b32 v24, 4, v24
    v_and_b32 v25, 1, v19
    v_lshl_add_u32 v24, v25, 6, v24
    v_add_u32 v24, 98304, v24
    v_bfe_u32 v25, v1, 2, 2
    v_lshrrev_b32 v27, 5, v1
    v_sub_u32 v25, v25, v27
    v_mov_b32 v26, 107008
    v_cmp_eq_u32 vcc, 0, v25
    s_nop 1
    v_cndmask_b32 v3, v26, v24, vcc
    v_cmp_eq_u32 vcc, 2, v25
    s_nop 1
    v_cndmask_b32 v4, v26, v24, vcc
    v_and_b32 v24, 3, v1
    v_cmp_eq_u32 vcc, 3, v24
    v_mov_b32 v25, 0xffff
    v_mov_b32 v26, 0xffff0000
    v_cndmask_b32 v25, v25, v26, vcc
    v_cndmask_b32 v24, v24, 0, vcc
    v_or_b32 v24, 12, v24
    v_mul_u32_u24 v24, 0x1111, v24
    v_mul_u32_u24 v26, 0xaaaa, v20
    v_add_u32 v26, 0x4444, v26
    v_lshl_add_u32 v7, v24, 16, v26
    v_and_b32 v24, 4, v1
    v_cmp_eq_u32 vcc, 0, v24
    s_nop 1
    v_cndmask_b32 v5, 0, v25, vcc
    v_cndmask_b32 v6, v25, 0, vcc
    v_mul_u32_u24 v82, s97, v27
    v_bfe_u32 v24, v1, 3, 1
    v_mul_u32_u24 v24, 1536, v24
    v_add_u32 v82, v82, v24
    v_and_b32 v24, 1, v19
    v_mul_u32_u24 v24, 768, v24
    v_add_u32 v82, v82, v24
    v_and_b32 v24, 7, v1
    v_lshl_add_u32 v82, v24, 4, v82
    s_mul_i32 s52, s7, 6144
    s_add_u32 s52, s52, 20480
    v_lshl_add_u32 v8, v0, 4, s52
    s_lshl_b32 s52, s7, 6
    s_add_u32 s52, s52, 45056
    v_lshl_add_u32 v9, v24, 3, s52
    v_and_b32 v10, 0xe1, v0
    v_lshlrev_b32 v10, 1, v10
    v_bfe_u32 v24, v0, 4, 1
    v_lshl_add_u32 v10, v24, 3, v10
    v_bfe_u32 v24, v0, 3, 1
    v_lshl_add_u32 v10, v24, 5, v10
    v_bfe_u32 v24, v0, 2, 1
    v_lshl_add_u32 v10, v24, 2, v10
    v_bfe_u32 v24, v0, 1, 1
    v_lshl_add_u32 v10, v24, 4, v10
    v_add_u32 v10, 98304, v10
    v_mov_b32 v11, 0x3727c5ac
    v_mov_b32 v12, 98752
    s_cmp_lg_u32 s44, 3
    s_cbranch_scc1 KBAR
    s_lshr_b32 s53, s2, 4
    s_and_b32 s51, s2, 15
    s_lshl_b32 s52, s53, 14
    s_lshl_b32 s54, s51, 9
    s_add_u32 s52, s52, s54
    s_add_u32 s52, s52, 1835008
    s_and_b32 s53, s46, 1
    s_lshl_b32 s53, s53, 13
    s_add_u32 s52, s52, s53
    s_xor_b32 s53, s52, 8192
    s_memtime s[88:89]
    s_waitcnt lgkmcnt(0)
    s_buffer_load_dword s1, s[16:19], s52
    s_waitcnt lgkmcnt(0)
    s_memtime s[90:91]
    s_waitcnt lgkmcnt(0)
    s_buffer_load_dword s1, s[16:19], s53
    s_waitcnt lgkmcnt(0)
    s_memtime s[92:93]
    s_waitcnt lgkmcnt(0)
    s_sub_u32 s88, s90, s88
    s_sub_u32 s90, s92, s90
    s_cmp_lt_u32 s90, s88
    s_cselect_b32 s1, 1, 0
    s_xor_b32 s1, s1, s46
    s_getreg_b32 s52, hwreg(HW_REG_XCC_ID)
    s_lshr_b32 s52, s52, 2
    s_xor_b32 s1, s1, s52
    s_and_b32 s1, s1, 1
    s_lshl_b32 s1, s1, 4
    s_mov_b32 s51, 0
    v_mov_b32 v37, 0
NOP:
    s_waitcnt vmcnt(0)
    v_readfirstlane_b32 s5, v89
    s_cmp_lg_u32 s5, 0
    s_cbranch_scc1 NOOK
    buffer_load_dword v89, v37, s[40:43], 0 offen sc1
    s_add_u32 s51, s51, 1
    s_sleep 4
    s_cmp_lt_u32 s51, 0x8000
    s_cbranch_scc1 NOP
NOOK:
    s_getreg_b32 s52, hwreg(HW_REG_XCC_ID)
    s_and_b32 s52, s52, 15
    s_or_b32 s5, s5, s52
    s_or_b32 s1, s1, s5
    v_mov_b32 v36, s1
    s_lshl_b32 s52, s45, 7
    s_lshl_b32 s54, s46, 2
    s_add_u32 s52, s52, s54
    s_add_u32 s52, s52, 1376256
    s_mov_b64 exec, 1
    buffer_store_dword v36, v37, s[16:19], s52 offen sc1
    s_mov_b64 exec, -1
    s_mov_b32 s44, 0
    s_branch LOOP
KBAR:
    s_barrier
    s_waitcnt vmcnt(8)
    buffer_load_dwordx4 a[28:31], v80, s[8:11], s96 offen offset:0 nt
    s_waitcnt vmcnt(8)
    buffer_load_dwordx4 a[36:39], v80, s[8:11], s96 offen offset:128 nt
    s_waitcnt vmcnt(8)
    buffer_load_dwordx4 a[44:47], v80, s[8:11], s96 offen offset:256 nt
    s_add_u32 s96, s96, s97
    s_waitcnt vmcnt(8)
    buffer_load_dwordx4 a[48:51], v80, s[8:11], s96 offen offset:0 nt
    s_waitcnt vmcnt(8)
    buffer_load_dwordx4 a[56:59], v80, s[8:11], s96 offen offset:128 nt
    s_waitcnt vmcnt(8)
    buffer_load_dwordx4 a[64:67], v80, s[8:11], s96 offen offset:256 nt
    s_add_u32 s96, s96, s97
    s_waitcnt vmcnt(8)
    buffer_load_dwordx4 a[52:55], v80, s[8:11], s96 offen offset:0 nt
    s_waitcnt vmcnt(8)
    buffer_load_dwordx4 a[60:63], v80, s[8:11], s96 offen offset:128 nt
    s_waitcnt vmcnt(8)
    buffer_load_dwordx4 a[68:71], v80, s[8:11], s96 offen offset:256 nt
    s_add_u32 s96, s96, s97
    s_waitcnt vmcnt(8)
    buffer_load_dwordx4 a[72:75], v80, s[8:11], s96 offen offset:0 nt
    s_waitcnt vmcnt(8)
    buffer_load_dwordx4 a[80:83], v80, s[8:11], s96 offen offset:128 nt
    s_waitcnt vmcnt(8)
    buffer_load_dwordx4 a[88:91], v80, s[8:11], s96 offen offset:256 nt
    s_add_u32 s96, s96, s97
    s_waitcnt vmcnt(8)
    buffer_load_dwordx4 a[76:79], v80, s[8:11], s96 offen offset:0 nt
    s_waitcnt vmcnt(8)
    buffer_load_dwordx4 a[84:87], v80, s[8:11], s96 offen offset:128 nt
    s_waitcnt vmcnt(8)
    buffer_load_dwordx4 a[92:95], v80, s[8:11], s96 offen offset:256 nt
    s_add_u32 s96, s96, s97
    s_waitcnt vmcnt(8)
    buffer_load_dwordx4 a[96:99], v80, s[8:11], s96 offen offset:0 nt
    s_waitcnt vmcnt(8)
    buffer_load_dwordx4 a[104:107], v80, s[8:11], s96 offen offset:128 nt
    s_waitcnt vmcnt(8)
    buffer_load_dwordx4 a[112:115], v80, s[8:11], s96 offen offset:256 nt
    s_add_u32 s96, s96, s97
    s_waitcnt vmcnt(8)
    buffer_load_dwordx4 a[100:103], v80, s[8:11], s96 offen offset:0 nt
    s_waitcnt vmcnt(8)
    buffer_load_dwordx4 a[108:111], v80, s[8:11], s96 offen offset:128 nt
    s_waitcnt vmcnt(8)
    buffer_load_dwordx4 a[116:119], v80, s[8:11], s96 offen offset:256 nt
    s_add_u32 s96, s96, s97
    s_waitcnt vmcnt(8)
    buffer_load_dwordx4 a[120:123], v80, s[8:11], s96 offen offset:0 nt
    s_waitcnt vmcnt(8)
    buffer_load_dwordx4 a[128:131], v80, s[8:11], s96 offen offset:128 nt
    s_waitcnt vmcnt(8)
    buffer_load_dwordx4 a[136:139], v80, s[8:11], s96 offen offset:256 nt
    s_add_u32 s96, s96, s97
    s_waitcnt vmcnt(8)
    buffer_load_dwordx4 a[124:127], v80, s[8:11], s96 offen offset:0 nt
    s_waitcnt vmcnt(8)
    buffer_load_dwordx4 a[132:135], v80, s[8:11], s96 offen offset:128 nt
    s_waitcnt vmcnt(8)
    buffer_load_dwordx4 a[140:143], v80, s[8:11], s96 offen offset:256 nt
    s_add_u32 s96, s96, s97
    s_waitcnt vmcnt(8)
    buffer_load_dwordx4 a[144:147], v80, s[8:11], s96 offen offset:0 nt
    s_waitcnt vmcnt(8)
    buffer_load_dwordx4 a[152:155], v80, s[8:11], s96 offen offset:128 nt
    s_waitcnt vmcnt(8)
    buffer_load_dwordx4 a[160:163], v80, s[8:11], s96 offen offset:256 nt
    s_add_u32 s96, s96, s97
    s_waitcnt vmcnt(8)
    buffer_load_dwordx4 a[148:151], v80, s[8:11], s96 offen offset:0 nt
    s_waitcnt vmcnt(8)
    buffer_load_dwordx4 a[156:159], v80, s[8:11], s96 offen offset:128 nt
    s_waitcnt vmcnt(8)
    buffer_load_dwordx4 a[164:167], v80, s[8:11], s96 offen offset:256 nt
    s_add_u32 s96, s96, s97
    s_waitcnt vmcnt(8)
    buffer_load_dwordx4 a[168:171], v80, s[8:11], s96 offen offset:0 nt
    s_waitcnt vmcnt(8)
    buffer_load_dwordx4 a[176:179], v80, s[8:11], s96 offen offset:128 nt
    s_waitcnt vmcnt(8)
    buffer_load_dwordx4 a[184:187], v80, s[8:11], s96 offen offset:256 nt
    s_add_u32 s96, s96, s97
    s_waitcnt vmcnt(8)
    buffer_load_dwordx4 a[172:175], v80, s[8:11], s96 offen offset:0 nt
    s_waitcnt vmcnt(8)
    buffer_load_dwordx4 a[180:183], v80, s[8:11], s96 offen offset:128 nt
    s_waitcnt vmcnt(8)
    buffer_load_dwordx4 a[188:191], v80, s[8:11], s96 offen offset:256 nt
    s_lshl_b32 s97, s97, 1
    s_waitcnt vmcnt(8)
    buffer_load_dwordx4 a[192:195], v82, s[12:15], s55 offen offset:0 nt
    s_waitcnt vmcnt(8)
    buffer_load_dwordx4 a[200:203], v82, s[12:15], s55 offen offset:128 nt
    s_waitcnt vmcnt(8)
    buffer_load_dwordx4 a[208:211], v82, s[12:15], s55 offen offset:256 nt
    s_waitcnt vmcnt(8)
    buffer_load_dwordx4 a[216:219], v82, s[12:15], s55 offen offset:384 nt
    s_waitcnt vmcnt(8)
    buffer_load_dwordx4 a[224:227], v82, s[12:15], s55 offen offset:512 nt
    s_waitcnt vmcnt(8)
    buffer_load_dwordx4 a[232:235], v82, s[12:15], s55 offen offset:640 nt
    s_add_u32 s55, s55, s97
    s_waitcnt vmcnt(8)
    buffer_load_dwordx4 a[196:199], v82, s[12:15], s55 offen offset:0 nt
    s_waitcnt vmcnt(8)
    buffer_load_dwordx4 a[204:207], v82, s[12:15], s55 offen offset:128 nt
    s_waitcnt vmcnt(8)
    buffer_load_dwordx4 a[212:215], v82, s[12:15], s55 offen offset:256 nt
    s_waitcnt vmcnt(8)
    buffer_load_dwordx4 a[220:223], v82, s[12:15], s55 offen offset:384 nt
    s_waitcnt vmcnt(8)
    buffer_load_dwordx4 a[228:231], v82, s[12:15], s55 offen offset:512 nt
    s_waitcnt vmcnt(8)
    buffer_load_dwordx4 a[236:239], v82, s[12:15], s55 offen offset:640 nt
    s_add_u32 s55, s55, s97
    s_waitcnt vmcnt(8)
    buffer_load_dwordx4 a[240:243], v82, s[12:15], s55 offen offset:0 nt
    s_waitcnt vmcnt(8)
    buffer_load_dwordx4 a[248:251], v82, s[12:15], s55 offen offset:128 nt
    s_waitcnt vmcnt(8)
    buffer_load_dwordx4 v[128:131], v82, s[12:15], s55 offen offset:256 nt
    s_waitcnt vmcnt(8)
    buffer_load_dwordx4 v[136:139], v82, s[12:15], s55 offen offset:384 nt
    s_waitcnt vmcnt(8)
    buffer_load_dwordx4 v[144:147], v82, s[12:15], s55 offen offset:512 nt
    s_waitcnt vmcnt(8)
    buffer_load_dwordx4 v[152:155], v82, s[12:15], s55 offen offset:640 nt
    s_add_u32 s55, s55, s97
    s_waitcnt vmcnt(8)
    buffer_load_dwordx4 a[244:247], v82, s[12:15], s55 offen offset:0 nt
    s_waitcnt vmcnt(8)
    buffer_load_dwordx4 a[252:255], v82, s[12:15], s55 offen offset:128 nt
    s_waitcnt vmcnt(8)
    buffer_load_dwordx4 v[132:135], v82, s[12:15], s55 offen offset:256 nt
    s_waitcnt vmcnt(8)
    buffer_load_dwordx4 v[140:143], v82, s[12:15], s55 offen offset:384 nt
    s_waitcnt vmcnt(8)
    buffer_load_dwordx4 v[148:151], v82, s[12:15], s55 offen offset:512 nt
    s_waitcnt vmcnt(8)
    buffer_load_dwordx4 v[156:159], v82, s[12:15], s55 offen offset:640 nt
    s_add_u32 s55, s55, s97
    s_waitcnt vmcnt(8)
    buffer_load_dwordx4 v[160:163], v82, s[12:15], s55 offen offset:0 nt
    s_waitcnt vmcnt(8)
    buffer_load_dwordx4 v[168:171], v82, s[12:15], s55 offen offset:128 nt
    s_waitcnt vmcnt(8)
    buffer_load_dwordx4 v[176:179], v82, s[12:15], s55 offen offset:256 nt
    s_waitcnt vmcnt(8)
    buffer_load_dwordx4 v[184:187], v82, s[12:15], s55 offen offset:384 nt
    s_waitcnt vmcnt(8)
    buffer_load_dwordx4 v[192:195], v82, s[12:15], s55 offen offset:512 nt
    s_waitcnt vmcnt(8)
    buffer_load_dwordx4 v[200:203], v82, s[12:15], s55 offen offset:640 nt
    s_add_u32 s55, s55, s97
    s_waitcnt vmcnt(8)
    buffer_load_dwordx4 v[164:167], v82, s[12:15], s55 offen offset:0 nt
    s_waitcnt vmcnt(8)
    buffer_load_dwordx4 v[172:175], v82, s[12:15], s55 offen offset:128 nt
    s_waitcnt vmcnt(8)
    buffer_load_dwordx4 v[180:183], v82, s[12:15], s55 offen offset:256 nt
    s_waitcnt vmcnt(8)
    buffer_load_dwordx4 v[188:191], v82, s[12:15], s55 offen offset:384 nt
    s_waitcnt vmcnt(8)
    buffer_load_dwordx4 v[196:199], v82, s[12:15], s55 offen offset:512 nt
    s_waitcnt vmcnt(8)
    buffer_load_dwordx4 v[204:207], v82, s[12:15], s55 offen offset:640 nt
    s_add_u32 s55, s55, s97
    s_waitcnt vmcnt(8)
    buffer_load_dwordx4 v[208:211], v82, s[12:15], s55 offen offset:0 nt
    s_waitcnt vmcnt(8)
    buffer_load_dwordx4 v[216:219], v82, s[12:15], s55 offen offset:128 nt
    s_waitcnt vmcnt(8)
    buffer_load_dwordx4 v[224:227], v82, s[12:15], s55 offen offset:256 nt
    s_waitcnt vmcnt(8)
    buffer_load_dwordx4 v[232:235], v82, s[12:15], s55 offen offset:384 nt
    s_waitcnt vmcnt(8)
    buffer_load_dwordx4 v[240:243], v82, s[12:15], s55 offen offset:512 nt
    s_waitcnt vmcnt(8)
    buffer_load_dwordx4 v[248:251], v82, s[12:15], s55 offen offset:640 nt
    s_add_u32 s55, s55, s97
    s_waitcnt vmcnt(8)
    buffer_load_dwordx4 v[212:215], v82, s[12:15], s55 offen offset:0 nt
    s_waitcnt vmcnt(8)
    buffer_load_dwordx4 v[220:223], v82, s[12:15], s55 offen offset:128 nt
    s_waitcnt vmcnt(8)
    buffer_load_dwordx4 v[228:231], v82, s[12:15], s55 offen offset:256 nt
    s_barrier
    s_waitcnt vmcnt(8)
    buffer_load_dwordx4 v[236:239], v82, s[12:15], s55 offen offset:384 nt
    s_waitcnt vmcnt(8)
    buffer_load_dwordx4 v[244:247], v82, s[12:15], s55 offen offset:512 nt
    s_waitcnt vmcnt(8)
    buffer_load_dwordx4 v[252:255], v82, s[12:15], s55 offen offset:640 nt
    s_branch ENTRY
LOOP:
    v_and_b32 v16, 3, v1
    v_lshrrev_b32 v17, 4, v1
    v_bfe_u32 v18, v1, 2, 2
    v_lshlrev_b32 v16, 3, v16
    v_mul_u32_u24 v18, 384, v18
    v_add_u32 v16, v16, v18
    v_bfe_u32 v18, v1, 3, 2
    v_xor_b32 v18, s44, v18
    v_lshl_add_u32 v16, v18, 5, v16
    v_add_u32 v16, 65536, v16
    v_and_b32 v18, 1, v17
    v_mul_u32_u24 v17, 3072, v17
    v_mul_u32_u24 v18, 3072, v18
    v_add_u32 v17, v17, v16
    v_add_u32 v18, v18, v16
    ds_read_b64_tr_b16 v[44:45], v17 offset:0
    ds_read_b64_tr_b16 v[46:47], v17 offset:1536
    ds_read_b64_tr_b16 v[56:57], v17 offset:128
    ds_read_b64_tr_b16 v[58:59], v17 offset:1664
    ds_read_b64_tr_b16 v[68:69], v17 offset:256
    ds_read_b64_tr_b16 v[70:71], v17 offset:1792
    ds_read_b64_tr_b16 v[48:49], v17 offset:12288
    ds_read_b64_tr_b16 v[50:51], v17 offset:13824
    ds_read_b64_tr_b16 v[60:61], v17 offset:12416
    ds_read_b64_tr_b16 v[62:63], v17 offset:13952
    ds_read_b64_tr_b16 v[72:73], v17 offset:12544
    ds_read_b64_tr_b16 v[74:75], v17 offset:14080
    ds_read_b64_tr_b16 v[52:53], v18 offset:24576
    ds_read_b64_tr_b16 v[54:55], v18 offset:26112
    ds_read_b64_tr_b16 v[64:65], v18 offset:24704
    ds_read_b64_tr_b16 v[66:67], v18 offset:26240
    ds_read_b64_tr_b16 v[76:77], v18 offset:24832
    ds_read_b64_tr_b16 v[78:79], v18 offset:26368
    s_cmp_lg_u32 s6, 0
    s_cbranch_scc1 QA0
    v_and_b32 v29, 31, v1
    v_lshl_add_u32 v29, s44, 5, v29
    s_cmp_eq_u32 s44, 3
    s_cbranch_scc1 Y2N
    v_min_u32 v20, 79, v29
    s_mul_i32 s52, s48, 80
    v_add_u32 v20, s52, v20
    v_lshrrev_b32 v26, 5, v20
    v_lshlrev_b32 v26, 10, v26
    v_lshrrev_b32 v21, 8, v20
    v_lshl_add_u32 v26, v21, 13, v26
    v_and_b32 v20, 31, v20
    v_lshl_add_u32 v26, v20, 2, v26
    v_lshrrev_b32 v20, 5, v1
    v_lshl_add_u32 v26, v20, 9, v26
    s_add_u32 s52, s0, 81920
    v_add_u32 v26, s52, v26
    s_sub_u32 s52, s46, 20
    s_cmp_ge_u32 s52, 10
    s_cbranch_scc1 HOOKL
    v_lshlrev_b32 v24, 3, v0
    s_mul_i32 s52, s47, 12288
    s_add_u32 s52, s52, 1441792
    s_mov_b32 s51, 0
QCPB:
    s_add_u32 s53, s52, 0
    buffer_load_dwordx2 v[32:33], v24, s[16:19], s53 offen offset:0 sc1
    buffer_load_dwordx2 v[34:35], v24, s[16:19], s53 offen offset:1536 sc1
    s_add_u32 s53, s52, 3072
    buffer_load_dwordx2 v[36:37], v24, s[16:19], s53 offen offset:0 sc1
    buffer_load_dwordx2 v[38:39], v24, s[16:19], s53 offen offset:1536 sc1
    s_add_u32 s53, s52, 6144
    buffer_load_dwordx2 v[40:41], v24, s[16:19], s53 offen offset:0 sc1
    buffer_load_dwordx2 v[42:43], v24, s[16:19], s53 offen offset:1536 sc1
    s_add_u32 s53, s52, 9216
    buffer_load_dwordx2 v[20:21], v24, s[16:19], s53 offen offset:0 sc1
    buffer_load_dwordx2 v[22:23], v24, s[16:19], s53 offen offset:1536 sc1
    s_cmp_lg_u32 s51, 0
    s_cbranch_scc1 QCWB
    s_sleep 5
QCWB:
    s_waitcnt vmcnt(0)
    v_bitop3_b32 v33, v32, v33, s101 bitop3:0x96
    v_bitop3_b32 v35, v34, v35, s101 bitop3:0x96
    v_bitop3_b32 v37, v36, v37, s101 bitop3:0x96
    v_bitop3_b32 v39, v38, v39, s101 bitop3:0x96
    v_bitop3_b32 v41, v40, v41, s101 bitop3:0x96
    v_bitop3_b32 v43, v42, v43, s101 bitop3:0x96
    v_bitop3_b32 v21, v20, v21, s101 bitop3:0x96
    v_bitop3_b32 v23, v22, v23, s101 bitop3:0x96
    v_add_f32 v13, v32, v34
    v_add_f32 v13, v13, v36
    v_add_f32 v13, v13, v38
    v_add_f32 v13, v13, v40
    v_add_f32 v13, v13, v42
    v_add_f32 v13, v13, v20
    v_add_f32 v13, v13, v22
    v_or_b32 v33, v33, v35
    v_or_b32 v33, v33, v37
    v_or_b32 v33, v33, v39
    v_or_b32 v33, v33, v41
    v_or_b32 v33, v33, v43
    v_or_b32 v33, v33, v21
    v_or_b32 v33, v33, v23
    v_cmp_ne_u32 vcc, 0, v33
    s_cbranch_vccz QCOKB
    s_add_u32 s51, s51, 1
    s_sleep 2
    s_cmp_lt_u32 s51, 0x8000
    s_cbranch_scc1 QCPB
QCOKB:
GYB:
    buffer_load_dword v22, v26, s[16:19], s49 offen offset:0 sc1
    buffer_load_dword v23, v26, s[16:19], s49 offen offset:128 sc1
    buffer_load_dword v24, v26, s[16:19], s49 offen offset:256 sc1
    buffer_load_dword v25, v26, s[16:19], s49 offen offset:384 sc1
Y2N:
    s_lshr_b32 s53, s48, 2
    s_mul_i32 s52, s7, 6144
    s_lshl_b32 s54, s44, 8
    s_add_u32 s52, s52, s54
    s_mul_i32 s54, s53, 3056
    s_add_u32 s52, s52, s54
    s_lshl_b32 s54, s48, 2
    s_add_u32 s52, s52, s54
    s_add_u32 s52, s52, 20480
    v_lshl_add_u32 v14, v1, 4, s52
    s_lshl_b32 s52, s7, 6
    s_lshl_b32 s54, s48, 3
    s_add_u32 s52, s52, s54
    s_add_u32 s52, s52, 45056
    v_mov_b32 v15, s52
    s_mul_i32 s52, s48, 320
    s_add_u32 s52, s52, 131072
    s_and_b32 s53, s2, 0xc7
    s_cmp_eq_u32 s53, 0
    s_cselect_b32 s52, s52, 1879048192
    v_lshl_add_u32 v28, v29, 2, s52
    v_lshlrev_b32 v19, 1, v29
    v_add_u32 v19, 96256, v19
    v_cmp_gt_u32 vcc, 80, v29
    s_mov_b64 s[60:61], vcc
    s_mov_b32 s51, 0
    s_cmp_eq_u32 s44, 3
    s_cbranch_scc1 Y2OK
    s_branch Y2W
Y2P:
    buffer_load_dword v22, v26, s[16:19], s49 offen offset:0 sc1
    buffer_load_dword v23, v26, s[16:19], s49 offen offset:128 sc1
    buffer_load_dword v24, v26, s[16:19], s49 offen offset:256 sc1
    buffer_load_dword v25, v26, s[16:19], s49 offen offset:384 sc1
Y2W:
    s_waitcnt vmcnt(0)
    v_pk_add_f32 v[22:23], v[22:23], v[24:25]
    v_add_f32 v30, v22, v23
    v_mov_b32 v31, v30
    s_nop 1
    v_permlane32_swap_b32 v30, v31
    v_add_f32 v30, v30, v31
    v_cmp_u_f32 vcc, v30, v30
    s_cbranch_vccz Y2OK
    s_add_u32 s51, s51, 1
    s_sleep 1
    s_cmp_lt_u32 s51, 0x8000
    s_cbranch_scc1 Y2P
Y2OK:
    s_cmp_lg_u32 s49, 0
    s_cbranch_scc1 FINAL
    s_mov_b32 s49, 393216
    s_mov_b32 s62, s63
    s_cmp_eq_u32 s44, 3
    s_cbranch_scc1 QX
    v_cvt_pk_bf16_f32 v30, v30, v30
    v_cndmask_b32 v30, 0, v30, s[60:61]
    ds_write_b16 v19, v30
    v_and_b32 v30, 0xffff0000, v30
    s_mov_b32 exec_lo, s60
    s_mov_b32 exec_hi, 0
    s_cmp_eq_u32 s50, 0
    s_cbranch_scc1 SLOW0
    buffer_store_dword v30, v28, s[16:19], s49 offen
PUBD0:
    s_mov_b64 exec, -1
QX:
    s_waitcnt lgkmcnt(0)
    s_barrier
QA0:
    ds_read_b128 v[32:35], v2 offset:0
    ds_read_b128 v[36:39], v2 offset:64
    ds_read_b128 v[40:43], v2 offset:128
    s_waitcnt lgkmcnt(2)
    v_mfma_f32_16x16x32_bf16 v[28:31], v[32:35], v[32:35], 0
    v_mfma_f32_16x16x32_bf16 v[16:19], v[32:35], v[44:47], 0
    v_mfma_f32_16x16x32_bf16 v[20:23], v[32:35], v[56:59], 0
    v_mfma_f32_16x16x32_bf16 v[24:27], v[32:35], v[68:71], 0
    s_waitcnt lgkmcnt(1)
    v_mfma_f32_16x16x32_bf16 v[28:31], v[36:39], v[36:39], v[28:31]
    v_mfma_f32_16x16x32_bf16 v[16:19], v[36:39], v[48:51], v[16:19]
    v_mfma_f32_16x16x32_bf16 v[20:23], v[36:39], v[60:63], v[20:23]
    v_mfma_f32_16x16x32_bf16 v[24:27], v[36:39], v[72:75], v[24:27]
    s_waitcnt lgkmcnt(0)
    v_mfma_f32_16x16x32_bf16 v[16:19], v[40:43], v[52:55], v[16:19]
    v_mfma_f32_16x16x32_bf16 v[20:23], v[40:43], v[64:67], v[20:23]
    v_mfma_f32_16x16x32_bf16 v[24:27], v[40:43], v[76:79], v[24:27]
    v_mfma_f32_16x16x32_bf16 v[28:31], v[40:43], v[40:43], v[28:31]
    s_mov_b64 exec, 0xffff
    s_cmp_lg_u32 s6, 0
    s_cbranch_scc1 HOOKA
    s_cmp_eq_u32 s50, 0
    s_cbranch_scc1 SLOW1
    buffer_store_dword v16, v14, s[16:19], s62 offen offset:0
    buffer_store_dword v20, v14, s[16:19], s62 offen offset:1024
    buffer_store_dword v24, v14, s[16:19], s62 offen offset:2048
    s_mov_b64 exec, 1
    buffer_store_dwordx2 v[28:29], v15, s[16:19], s62 offen
PUBD1:
    s_mov_b64 exec, -1
ENTRY:
    s_mov_b32 s51, 0
    v_mov_b64 v[64:65], 0
    v_mov_b64 v[66:67], 0
    v_mov_b64 v[68:69], 0
    v_mov_b64 v[70:71], 0
    v_mov_b64 v[72:73], 0
    v_mov_b64 v[74:75], 0
    v_mov_b64 v[76:77], 0
    v_mov_b64 v[78:79], 0
    s_cmp_eq_u32 s49, 0
    s_cselect_b32 s53, 3, s44
    s_cmp_eq_u32 s53, 3
    s_cbranch_scc1 EN0
    s_nop 15
    buffer_load_dwordx2 v[62:63], v9, s[16:19], s62 offen sc1
    buffer_load_dwordx4 v[44:47], v8, s[16:19], s62 offen offset:0 sc1
    buffer_load_dwordx4 v[48:51], v8, s[16:19], s62 offen offset:3072 sc1
EN0:
    v_lshrrev_b32 v14, 2, v1
    v_lshlrev_b32 v14, 7, v14
    v_and_b32 v15, 3, v1
    v_lshl_add_u32 v14, v15, 2, v14
    s_mul_i32 s52, s7, 3072
    s_mul_i32 s54, s44, 768
    s_add_u32 s52, s52, s54
    s_lshl_b32 s54, s48, 4
    s_add_u32 s52, s52, s54
    v_add_u32 v14, s52, v14
    s_lshl_b32 s52, s7, 5
    s_lshl_b32 s54, s48, 2
    s_add_u32 s52, s52, s54
    s_add_u32 s52, s52, 19968
    v_writelane_b32 v14, s52, 24
    v_and_b32 v15, 7, v1
    v_lshlrev_b32 v15, 5, v15
    v_bfe_u32 v61, v1, 4, 1
    v_lshl_add_u32 v15, v61, 4, v15
    v_lshrrev_b32 v61, 5, v1
    v_mul_u32_u24 v61, 768, v61
    v_add_u32 v15, v15, v61
    s_mul_i32 s52, s44, 1536
    s_add_u32 s52, s52, 98816
    v_add_u32 v15, s52, v15
    s_mul_i32 s52, s44, 192
    s_add_u32 s52, s52, 98816
    v_min_u32 v60, 23, v1
    v_lshl_add_u32 v60, v60, 3, s52
    s_lshl_b32 s52, s44, 3
    s_add_u32 s52, s52, 98752
    v_mov_b32 v61, s52
    s_cmp_eq_u32 s49, 0
    s_cbranch_scc1 HOOKE
    s_cmp_eq_u32 s53, 3
    s_cbranch_scc1 ENOK2
    s_nop 5
ENP:
    buffer_load_dwordx2 v[62:63], v9, s[16:19], s62 offen sc1
    buffer_load_dwordx4 v[44:47], v8, s[16:19], s62 offen offset:0 sc1
    buffer_load_dwordx4 v[48:51], v8, s[16:19], s62 offen offset:3072 sc1
    s_waitcnt vmcnt(3)
    v_add_f32_dpp v32, v62, v62 quad_perm:[1,0,3,2] row_mask:0xf bank_mask:0xf
    v_add_f32_dpp v33, v63, v63 quad_perm:[1,0,3,2] row_mask:0xf bank_mask:0xf
    v_pk_add_f32 v[16:17], v[44:45], v[46:47]
    v_add_f32_dpp v32, v32, v32 quad_perm:[2,3,0,1] row_mask:0xf bank_mask:0xf
    v_add_f32_dpp v33, v33, v33 quad_perm:[2,3,0,1] row_mask:0xf bank_mask:0xf
    v_pk_add_f32 v[20:21], v[48:49], v[50:51]
    v_add_f32_dpp v32, v32, v32 row_half_mirror row_mask:0xf bank_mask:0xf
    v_add_f32_dpp v33, v33, v33 row_half_mirror row_mask:0xf bank_mask:0xf
    v_pk_add_f32 v[16:17], v[16:17], v[20:21]
    v_mul_f32 v33, 0x3acccccd, v33
    v_fmamk_f32 v32, v32, 0x3acccccd, v11
    v_fma_f32 v32, -v33, v33, v32
    v_rsq_f32 v32, v32
    v_add_f32 v16, v16, v17
    v_mul_f32 v32, 0x3dd53b94, v32
    v_fma_f32 v16, -v33, v13, v16
    v_mul_f32 v16, v16, v32
    v_cmp_u_f32 vcc, v16, v16
    s_cbranch_vccz ENOK
    s_add_u32 s51, s51, 1
    s_cmp_lt_u32 s51, 0x8000
    s_cbranch_scc1 ENP
ENOK:
    v_cvt_pk_bf16_f32 v16, v16, v16
    ds_write_b16 v10, v16
ENOK2:
    s_waitcnt lgkmcnt(0)
    s_barrier
QFRAG:
    ds_read_b128 v[16:19], v3 offset:0
    ds_read_b128 v[20:23], v3 offset:128
    ds_read_b128 v[24:27], v3 offset:256
    ds_read_b128 v[28:31], v4 offset:0
    ds_read_b128 v[32:35], v4 offset:128
    ds_read_b128 v[36:39], v4 offset:256
    s_cmp_eq_u32 s49, 0
    s_cbranch_scc1 HOOKF
    s_waitcnt vmcnt(0)
QK:
    v_mov_b64 v[40:41], 0
    v_mov_b64 v[42:43], 0
    v_mov_b64 v[44:45], 0
    v_mov_b64 v[46:47], 0
    v_mov_b64 v[48:49], 0
    v_mov_b64 v[50:51], 0
    s_waitcnt lgkmcnt(5)
    v_smfmac_f32_16x16x64_bf16 v[64:67], v[16:19], a[0:7], v7
    s_waitcnt lgkmcnt(4)
    v_smfmac_f32_16x16x64_bf16 v[64:67], v[20:23], a[8:15], v7
    s_waitcnt lgkmcnt(3)
    v_smfmac_f32_16x16x64_bf16 v[64:67], v[24:27], a[16:23], v7
    s_waitcnt lgkmcnt(2)
    v_smfmac_f32_16x16x64_bf16 v[64:67], v[28:31], a[24:31], v7
    s_waitcnt lgkmcnt(1)
    v_smfmac_f32_16x16x64_bf16 v[64:67], v[32:35], a[32:39], v7
    s_waitcnt lgkmcnt(0)
    v_smfmac_f32_16x16x64_bf16 v[64:67], v[36:39], a[40:47], v7
    v_smfmac_f32_16x16x64_bf16 v[68:71], v[16:19], a[48:55], v7
    v_smfmac_f32_16x16x64_bf16 v[68:71], v[20:23], a[56:63], v7
    v_smfmac_f32_16x16x64_bf16 v[68:71], v[24:27], a[64:71], v7
    v_smfmac_f32_16x16x64_bf16 v[68:71], v[28:31], a[72:79], v7
    v_smfmac_f32_16x16x64_bf16 v[68:71], v[32:35], a[80:87], v7
    v_smfmac_f32_16x16x64_bf16 v[68:71], v[36:39], a[88:95], v7
    v_smfmac_f32_16x16x64_bf16 v[72:75], v[16:19], a[96:103], v7
    v_smfmac_f32_16x16x64_bf16 v[72:75], v[20:23], a[104:111], v7
    v_smfmac_f32_16x16x64_bf16 v[72:75], v[24:27], a[112:119], v7
    v_mov_b32_dpp v52, v64 quad_perm:[0,0,2,2] row_mask:0xf bank_mask:0xf
    v_smfmac_f32_16x16x64_bf16 v[72:75], v[28:31], a[120:127], v7
    v_add_f32_dpp v52, v65, v52 quad_perm:[0,0,2,2] row_mask:0xf bank_mask:0xf
    v_smfmac_f32_16x16x64_bf16 v[72:75], v[32:35], a[128:135], v7
    v_add_f32_dpp v52, v66, v52 quad_perm:[1,1,3,3] row_mask:0xf bank_mask:0xf
    v_smfmac_f32_16x16x64_bf16 v[72:75], v[36:39], a[136:143], v7
    v_add_f32_dpp v52, v67, v52 quad_perm:[1,1,3,3] row_mask:0xf bank_mask:0xf
    v_smfmac_f32_16x16x64_bf16 v[76:79], v[16:19], a[144:151], v7
    v_smfmac_f32_16x16x64_bf16 v[76:79], v[20:23], a[152:159], v7
    v_smfmac_f32_16x16x64_bf16 v[76:79], v[24:27], a[160:167], v7
    v_mov_b32_dpp v53, v68 quad_perm:[0,0,2,2] row_mask:0xf bank_mask:0xf
    v_smfmac_f32_16x16x64_bf16 v[76:79], v[28:31], a[168:175], v7
    v_add_f32_dpp v53, v69, v53 quad_perm:[0,0,2,2] row_mask:0xf bank_mask:0xf
    v_smfmac_f32_16x16x64_bf16 v[76:79], v[32:35], a[176:183], v7
    v_add_f32_dpp v53, v70, v53 quad_perm:[1,1,3,3] row_mask:0xf bank_mask:0xf
    v_smfmac_f32_16x16x64_bf16 v[76:79], v[36:39], a[184:191], v7
    v_add_f32_dpp v53, v71, v53 quad_perm:[1,1,3,3] row_mask:0xf bank_mask:0xf
    v_mov_b32_dpp v54, v72 quad_perm:[0,0,2,2] row_mask:0xf bank_mask:0xf
    v_add_f32_dpp v54, v73, v54 quad_perm:[0,0,2,2] row_mask:0xf bank_mask:0xf
    v_add_f32_dpp v54, v74, v54 quad_perm:[1,1,3,3] row_mask:0xf bank_mask:0xf
    v_add_f32_dpp v54, v75, v54 quad_perm:[1,1,3,3] row_mask:0xf bank_mask:0xf
    v_max3_f32 v62, v52, v53, v54
    s_nop 1
    v_mov_b32_dpp v55, v76 quad_perm:[0,0,2,2] row_mask:0xf bank_mask:0xf
    v_add_f32_dpp v55, v77, v55 quad_perm:[0,0,2,2] row_mask:0xf bank_mask:0xf
    v_add_f32_dpp v55, v78, v55 quad_perm:[1,1,3,3] row_mask:0xf bank_mask:0xf
    v_add_f32_dpp v55, v79, v55 quad_perm:[1,1,3,3] row_mask:0xf bank_mask:0xf
    v_max_f32 v62, v62, v55
    s_nop 1
    v_max_f32_dpp v62, v62, v62 quad_perm:[2,3,0,1] row_mask:0xf bank_mask:0xf
    s_nop 1
    v_max_f32_dpp v62, v62, v62 row_ror:4 row_mask:0xf bank_mask:0xf
    s_nop 1
    v_max_f32_dpp v62, v62, v62 row_ror:8 row_mask:0xf bank_mask:0xf
    v_mov_b32 v63, v62
    s_nop 1
    v_permlane16_swap_b32 v62, v63
    v_max_f32 v62, v62, v63
    v_mov_b32 v63, v62
    s_nop 1
    v_permlane32_swap_b32 v62, v63
    v_max_f32 v62, v62, v63
    v_sub_f32 v52, v52, v62
    v_exp_f32 v52, v52
    s_nop 0
    v_cvt_pk_bf16_f32 v56, v52, v52
    v_mov_b32 v63, v52
    s_nop 0
    v_and_b32_dpp v16, v56, v5 quad_perm:[0,0,0,0] row_mask:0xf bank_mask:0xf
    v_and_b32_dpp v19, v56, v6 quad_perm:[0,0,0,0] row_mask:0xf bank_mask:0xf
    s_nop 0
    v_mov_b32_dpp v17, v16 row_shr:4 row_mask:0xf bank_mask:0xf bound_ctrl:0
    v_mov_b32_dpp v18, v19 row_shl:4 row_mask:0xf bank_mask:0xf bound_ctrl:0
    s_nop 0
    s_waitcnt vmcnt(36)
    v_smfmac_f32_16x16x64_bf16 v[40:43], v[16:19], a[192:199], v7 abid:1
    v_and_b32_dpp v20, v56, v5 quad_perm:[2,2,2,2] row_mask:0xf bank_mask:0xf
    v_and_b32_dpp v23, v56, v6 quad_perm:[2,2,2,2] row_mask:0xf bank_mask:0xf
    v_smfmac_f32_16x16x64_bf16 v[44:47], v[16:19], a[200:207], v7 abid:1
    v_mov_b32_dpp v21, v20 row_shr:4 row_mask:0xf bank_mask:0xf bound_ctrl:0
    v_mov_b32_dpp v22, v23 row_shl:4 row_mask:0xf bank_mask:0xf bound_ctrl:0
    v_sub_f32 v53, v53, v62
    v_exp_f32 v53, v53
    v_smfmac_f32_16x16x64_bf16 v[48:51], v[16:19], a[208:215], v7 abid:1
    v_cvt_pk_bf16_f32 v57, v53, v53
    v_add_f32 v63, v63, v53
    v_smfmac_f32_16x16x64_bf16 v[40:43], v[20:23], a[216:223], v7 abid:1
    v_and_b32_dpp v16, v57, v5 quad_perm:[0,0,0,0] row_mask:0xf bank_mask:0xf
    v_and_b32_dpp v19, v57, v6 quad_perm:[0,0,0,0] row_mask:0xf bank_mask:0xf
    v_smfmac_f32_16x16x64_bf16 v[44:47], v[20:23], a[224:231], v7 abid:1
    v_mov_b32_dpp v17, v16 row_shr:4 row_mask:0xf bank_mask:0xf bound_ctrl:0
    v_mov_b32_dpp v18, v19 row_shl:4 row_mask:0xf bank_mask:0xf bound_ctrl:0
    v_smfmac_f32_16x16x64_bf16 v[48:51], v[20:23], a[232:239], v7 abid:1
    s_waitcnt vmcnt(24)
    v_smfmac_f32_16x16x64_bf16 v[40:43], v[16:19], a[240:247], v7 abid:1
    v_and_b32_dpp v20, v57, v5 quad_perm:[2,2,2,2] row_mask:0xf bank_mask:0xf
    v_and_b32_dpp v23, v57, v6 quad_perm:[2,2,2,2] row_mask:0xf bank_mask:0xf
    v_smfmac_f32_16x16x64_bf16 v[44:47], v[16:19], a[248:255], v7 abid:1
    v_mov_b32_dpp v21, v20 row_shr:4 row_mask:0xf bank_mask:0xf bound_ctrl:0
    v_mov_b32_dpp v22, v23 row_shl:4 row_mask:0xf bank_mask:0xf bound_ctrl:0
    v_sub_f32 v54, v54, v62
    v_exp_f32 v54, v54
    v_smfmac_f32_16x16x64_bf16 v[48:51], v[16:19], v[128:135], v7 abid:1
    v_cvt_pk_bf16_f32 v56, v54, v54
    v_add_f32 v63, v63, v54
    v_smfmac_f32_16x16x64_bf16 v[40:43], v[20:23], v[136:143], v7 abid:1
    v_and_b32_dpp v16, v56, v5 quad_perm:[0,0,0,0] row_mask:0xf bank_mask:0xf
    v_and_b32_dpp v19, v56, v6 quad_perm:[0,0,0,0] row_mask:0xf bank_mask:0xf
    v_smfmac_f32_16x16x64_bf16 v[44:47], v[20:23], v[144:151], v7 abid:1
    v_mov_b32_dpp v17, v16 row_shr:4 row_mask:0xf bank_mask:0xf bound_ctrl:0
    v_mov_b32_dpp v18, v19 row_shl:4 row_mask:0xf bank_mask:0xf bound_ctrl:0
    v_smfmac_f32_16x16x64_bf16 v[48:51], v[20:23], v[152:159], v7 abid:1
    s_waitcnt vmcnt(12)
    v_smfmac_f32_16x16x64_bf16 v[40:43], v[16:19], v[160:167], v7 abid:1
    v_and_b32_dpp v20, v56, v5 quad_perm:[2,2,2,2] row_mask:0xf bank_mask:0xf
    v_and_b32_dpp v23, v56, v6 quad_perm:[2,2,2,2] row_mask:0xf bank_mask:0xf
    v_smfmac_f32_16x16x64_bf16 v[44:47], v[16:19], v[168:175], v7 abid:1
    v_mov_b32_dpp v21, v20 row_shr:4 row_mask:0xf bank_mask:0xf bound_ctrl:0
    v_mov_b32_dpp v22, v23 row_shl:4 row_mask:0xf bank_mask:0xf bound_ctrl:0
    v_sub_f32 v55, v55, v62
    v_exp_f32 v55, v55
    v_smfmac_f32_16x16x64_bf16 v[48:51], v[16:19], v[176:183], v7 abid:1
    v_cvt_pk_bf16_f32 v57, v55, v55
    v_add_f32 v63, v63, v55
    v_smfmac_f32_16x16x64_bf16 v[40:43], v[20:23], v[184:191], v7 abid:1
    v_and_b32_dpp v16, v57, v5 quad_perm:[0,0,0,0] row_mask:0xf bank_mask:0xf
    v_and_b32_dpp v19, v57, v6 quad_perm:[0,0,0,0] row_mask:0xf bank_mask:0xf
    v_smfmac_f32_16x16x64_bf16 v[44:47], v[20:23], v[192:199], v7 abid:1
    v_mov_b32_dpp v17, v16 row_shr:4 row_mask:0xf bank_mask:0xf bound_ctrl:0
    v_mov_b32_dpp v18, v19 row_shl:4 row_mask:0xf bank_mask:0xf bound_ctrl:0
    v_smfmac_f32_16x16x64_bf16 v[48:51], v[20:23], v[200:207], v7 abid:1
    s_waitcnt vmcnt(0)
    v_smfmac_f32_16x16x64_bf16 v[40:43], v[16:19], v[208:215], v7 abid:1
    v_add_f32_dpp v63, v63, v63 quad_perm:[2,3,0,1] row_mask:0xf bank_mask:0xf
    v_and_b32_dpp v20, v57, v5 quad_perm:[2,2,2,2] row_mask:0xf bank_mask:0xf
    v_and_b32_dpp v23, v57, v6 quad_perm:[2,2,2,2] row_mask:0xf bank_mask:0xf
    v_add_f32_dpp v63, v63, v63 row_ror:4 row_mask:0xf bank_mask:0xf
    v_smfmac_f32_16x16x64_bf16 v[44:47], v[16:19], v[216:223], v7 abid:1
    v_mov_b32_dpp v21, v20 row_shr:4 row_mask:0xf bank_mask:0xf bound_ctrl:0
    v_mov_b32_dpp v22, v23 row_shl:4 row_mask:0xf bank_mask:0xf bound_ctrl:0
    v_add_f32_dpp v63, v63, v63 row_ror:8 row_mask:0xf bank_mask:0xf
    v_mov_b32 v58, v63
    v_smfmac_f32_16x16x64_bf16 v[48:51], v[16:19], v[224:231], v7 abid:1
    s_nop 0
    v_permlane16_swap_b32 v63, v58
    v_smfmac_f32_16x16x64_bf16 v[40:43], v[20:23], v[232:239], v7 abid:1
    v_add_f32 v63, v63, v58
    v_mov_b32 v58, v63
    v_smfmac_f32_16x16x64_bf16 v[44:47], v[20:23], v[240:247], v7 abid:1
    v_smfmac_f32_16x16x64_bf16 v[48:51], v[20:23], v[248:255], v7 abid:1
    v_permlane32_swap_b32 v63, v58
    v_add_f32 v63, v63, v58
    ds_write_b64 v61, v[62:63]
    s_mov_b32 exec_lo, 0x00ff00ff
    s_mov_b32 exec_hi, 0xff00ff00
    s_nop 0
    ds_write_b128 v15, v[40:43] offset:0
    ds_write_b128 v15, v[44:47] offset:256
    ds_write_b128 v15, v[48:51] offset:512
    s_mov_b64 exec, -1
    v_cmp_eq_u32 s[60:61], 24, v1
    s_cmp_eq_u32 s49, 0
    s_cbranch_scc1 HOOKC
EXB:
    s_waitcnt lgkmcnt(0)
    s_barrier
    ds_read_b128 v[16:19], v12
    ds_read_b128 v[20:23], v12 offset:16
    ds_read_b64 v[24:25], v60 offset:0
    ds_read_b64 v[26:27], v60 offset:768
    ds_read_b64 v[28:29], v60 offset:1536
    ds_read_b64 v[30:31], v60 offset:2304
    ds_read_b64 v[32:33], v60 offset:3072
    ds_read_b64 v[34:35], v60 offset:3840
    ds_read_b64 v[36:37], v60 offset:4608
    ds_read_b64 v[38:39], v60 offset:5376
    s_waitcnt lgkmcnt(8)
    v_max_f32 v40, v16, v18
    v_max3_f32 v40, v40, v20, v22
    v_sub_f32 v16, v16, v40
    v_sub_f32 v18, v18, v40
    v_sub_f32 v20, v20, v40
    v_sub_f32 v22, v22, v40
    v_exp_f32 v16, v16
    v_exp_f32 v18, v18
    v_exp_f32 v20, v20
    v_exp_f32 v22, v22
    v_mul_f32 v41, v16, v17
    v_fmac_f32 v41, v18, v19
    v_fmac_f32 v41, v20, v21
    v_fmac_f32 v41, v22, v23
    v_rcp_f32 v42, v41
    v_log_f32 v43, v41
    s_waitcnt lgkmcnt(0)
    v_pk_add_f32 v[24:25], v[24:25], v[26:27]
    v_pk_add_f32 v[28:29], v[28:29], v[30:31]
    v_pk_add_f32 v[32:33], v[32:33], v[34:35]
    v_pk_add_f32 v[36:37], v[36:37], v[38:39]
    v_pk_mul_f32 v[24:25], v[24:25], v[16:17] op_sel_hi:[1,0]
    v_pk_fma_f32 v[24:25], v[28:29], v[18:19], v[24:25] op_sel_hi:[1,0,1]
    v_pk_fma_f32 v[24:25], v[32:33], v[20:21], v[24:25] op_sel_hi:[1,0,1]
    v_pk_fma_f32 v[24:25], v[36:37], v[22:23], v[24:25] op_sel_hi:[1,0,1]
    v_pk_mul_f32 v[24:25], v[24:25], v[42:43] op_sel_hi:[1,0]
    v_add_f32 v43, v43, v40
    v_cvt_pk_bf16_f32 v24, v24, v25
    s_mov_b64 exec, 0x1ffffff
    v_cndmask_b32 v24, v24, v43, s[60:61]
    s_cmp_eq_u32 s50, 0
    s_cbranch_scc1 SLOW2
    buffer_store_dword v24, v14, s[16:19], s62 offen
PUBD2:
    s_mov_b64 exec, -1
    s_cmp_ge_u32 s46, 20
    s_cbranch_scc1 HOOKG3
    v_and_b32 v30, 7, v1
    v_lshrrev_b32 v31, 4, v1
    v_lshlrev_b32 v58, 4, v30
    v_lshl_add_u32 v58, v31, 7, v58
    s_mul_i32 s52, s56, 6144
    s_mul_i32 s54, s44, 1536
    s_add_u32 s52, s52, s54
    v_add_u32 v58, s52, v58
    s_lshr_b32 s53, s44, 1
    s_lshl_b32 s52, s56, 6
    s_lshl_b32 s54, s53, 5
    s_add_u32 s52, s52, s54
    s_add_u32 s52, s52, 19968
    v_lshl_add_u32 v59, v31, 2, v30
    v_and_b32 v59, 7, v59
    v_lshl_add_u32 v59, v59, 2, s52
    s_lshl_b32 s52, s57, 8
    s_add_u32 s52, s52, 131072
    s_or_b32 s53, s45, s56
    s_cmp_eq_u32 s53, 0
    s_cselect_b32 s52, s52, 1879048192
    v_lshl_add_u32 v61, v1, 2, s52
    v_mov_b64 v[44:45], 0
    v_mov_b64 v[46:47], 0
    v_mov_b64 v[48:49], 0
    v_mov_b64 v[50:51], 0
    v_mov_b64 v[52:53], 0
    v_mov_b64 v[54:55], 0
    s_mov_b32 s60, 0x00ff00ff
    s_mov_b32 s61, 0x00ff00ff
    s_mov_b32 s51, 0
    s_cmp_eq_u32 s49, 0
    s_cbranch_scc1 HOOKG
WO0:
    buffer_load_dword v57, v61, s[16:19], s49 offen sc1
    buffer_load_dword v56, v59, s[16:19], s62 offen sc1
    s_mov_b64 exec, s[60:61]
    buffer_load_dwordx4 v[44:47], v58, s[16:19], s62 offen offset:0 sc1
    buffer_load_dwordx4 v[48:51], v58, s[16:19], s62 offen offset:512 sc1
    buffer_load_dwordx4 v[52:55], v58, s[16:19], s62 offen offset:1024 sc1
    s_mov_b64 exec, -1
    s_cmp_eq_u32 s49, 0
    s_cbranch_scc1 HOOKG2
    s_nop 15
    s_nop 7
    v_lshrrev_b32 v14, 5, v1
    v_lshlrev_b32 v14, 11, v14
    v_and_b32 v15, 31, v1
    v_lshl_add_u32 v14, v15, 2, v14
    s_lshr_b32 s53, s57, 1
    s_lshl_b32 s52, s57, 12
    s_lshl_b32 s54, s53, 13
    s_add_u32 s52, s52, s54
    s_lshl_b32 s54, s45, 8
    s_add_u32 s52, s52, s54
    s_lshl_b32 s54, s56, 7
    s_add_u32 s52, s52, s54
    v_add_u32 v14, s52, v14
    s_xor_b32 s1, s0, 8192
    s_add_u32 s1, s1, s49
    s_add_u32 s99, s0, s49
    s_lshl_b32 s52, s44, 9
    s_add_u32 s52, s52, 104960
    v_lshl_add_u32 v15, v15, 4, s52
    v_and_b32 v64, 15, v1
    v_lshlrev_b32 v64, 4, v64
    v_lshl_add_u32 v64, v31, 2, v64
    v_add_u32 v64, 104960, v64
WOP:
    buffer_load_dword v57, v61, s[16:19], s49 offen sc1
    buffer_load_dword v56, v59, s[16:19], s62 offen sc1
    s_mov_b64 exec, s[60:61]
    buffer_load_dwordx4 v[44:47], v58, s[16:19], s62 offen offset:0 sc1
    buffer_load_dwordx4 v[48:51], v58, s[16:19], s62 offen offset:512 sc1
    buffer_load_dwordx4 v[52:55], v58, s[16:19], s62 offen offset:1024 sc1
    s_mov_b64 exec, -1
    s_waitcnt vmcnt(5)
WOC:
    v_max3_u32 v63, v44, v48, v52
    v_mov_b32 v32, v56
    v_max_u32 v63, v63, v32
    v_cmp_eq_u32 vcc, -1, v63
    s_cbranch_vccnz WOAG
    v_mfma_f32_16x16x32_bf16 v[16:19], v[44:47], v[80:83], 0
    v_max_f32_dpp v33, v32, v32 quad_perm:[1,0,3,2] row_mask:0xf bank_mask:0xf
    s_nop 0
    v_mfma_f32_16x16x32_bf16 v[16:19], v[48:51], v[96:99], v[16:19]
    v_max_f32_dpp v33, v33, v33 quad_perm:[2,3,0,1] row_mask:0xf bank_mask:0xf
    s_nop 0
    v_mfma_f32_16x16x32_bf16 v[16:19], v[52:55], v[112:115], v[16:19]
    v_max_f32_dpp v33, v33, v33 row_half_mirror row_mask:0xf bank_mask:0xf
    v_sub_f32 v34, v32, v33
    v_mfma_f32_16x16x32_bf16 v[20:23], v[44:47], v[84:87], 0
    v_exp_f32 v34, v34
    s_nop 0
    v_mfma_f32_16x16x32_bf16 v[20:23], v[48:51], v[100:103], v[20:23]
    v_add_f32_dpp v33, v34, v34 quad_perm:[1,0,3,2] row_mask:0xf bank_mask:0xf
    s_nop 0
    v_mfma_f32_16x16x32_bf16 v[20:23], v[52:55], v[116:119], v[20:23]
    v_add_f32_dpp v33, v33, v33 quad_perm:[2,3,0,1] row_mask:0xf bank_mask:0xf
    s_nop 0
    v_mfma_f32_16x16x32_bf16 v[24:27], v[44:47], v[88:91], 0
    v_add_f32_dpp v33, v33, v33 row_half_mirror row_mask:0xf bank_mask:0xf
    v_rcp_f32 v33, v33
    v_mfma_f32_16x16x32_bf16 v[24:27], v[48:51], v[104:107], v[24:27]
    v_mul_f32 v34, v34, v33
    s_nop 0
    v_mfma_f32_16x16x32_bf16 v[24:27], v[52:55], v[120:123], v[24:27]
    v_mul_f32_dpp v36, v34, v16 row_newbcast:0 row_mask:0xf bank_mask:0xf
    v_fmac_f32_dpp v36, v34, v17 row_newbcast:1 row_mask:0xf bank_mask:0xf
    v_mfma_f32_16x16x32_bf16 v[28:31], v[44:47], v[92:95], 0
    v_fmac_f32_dpp v36, v34, v18 row_newbcast:2 row_mask:0xf bank_mask:0xf
    v_fmac_f32_dpp v36, v34, v19 row_newbcast:3 row_mask:0xf bank_mask:0xf
    v_mfma_f32_16x16x32_bf16 v[28:31], v[48:51], v[108:111], v[28:31]
    v_mul_f32_dpp v37, v34, v20 row_newbcast:0 row_mask:0xf bank_mask:0xf
    v_fmac_f32_dpp v37, v34, v21 row_newbcast:1 row_mask:0xf bank_mask:0xf
    v_mfma_f32_16x16x32_bf16 v[28:31], v[52:55], v[124:127], v[28:31]
    v_fmac_f32_dpp v37, v34, v22 row_newbcast:2 row_mask:0xf bank_mask:0xf
    v_fmac_f32_dpp v37, v34, v23 row_newbcast:3 row_mask:0xf bank_mask:0xf
    v_cmp_u_f32 vcc, v36, v57
    v_mul_f32_dpp v38, v34, v24 row_newbcast:0 row_mask:0xf bank_mask:0xf
    v_fmac_f32_dpp v38, v34, v25 row_newbcast:1 row_mask:0xf bank_mask:0xf
    v_fmac_f32_dpp v38, v34, v26 row_newbcast:2 row_mask:0xf bank_mask:0xf
    v_fmac_f32_dpp v38, v34, v27 row_newbcast:3 row_mask:0xf bank_mask:0xf
    s_mov_b32 exec_hi, 0
    v_mul_f32_dpp v39, v34, v28 row_newbcast:0 row_mask:0xf bank_mask:0xf
    v_fmac_f32_dpp v39, v34, v29 row_newbcast:1 row_mask:0xf bank_mask:0xf
    v_fmac_f32_dpp v39, v34, v30 row_newbcast:2 row_mask:0xf bank_mask:0xf
    v_fmac_f32_dpp v39, v34, v31 row_newbcast:3 row_mask:0xf bank_mask:0xf
    s_cbranch_vccz WOOK
    s_mov_b64 exec, -1
WOAG:
    s_add_u32 s51, s51, 1
    s_cmp_lt_u32 s51, 0x8000
    s_cbranch_scc1 WOP
    s_mov_b32 exec_hi, 0
WOOK:
    ds_write_b128 v15, v[36:39]
    s_mov_b64 exec, -1
    s_cmp_lg_u32 s44, 3
    s_waitcnt lgkmcnt(0)
    s_barrier
    s_cbranch_scc1 WOX
    ds_read2st64_b32 v[16:17], v64 offset0:0 offset1:1
    ds_read2st64_b32 v[18:19], v64 offset0:2 offset1:3
    ds_read2st64_b32 v[20:21], v64 offset0:4 offset1:5
    ds_read2st64_b32 v[22:23], v64 offset0:6 offset1:7
    s_waitcnt lgkmcnt(2)
    v_pk_add_f32 v[16:17], v[16:17], v[18:19]
    v_add_f32 v16, v16, v57
    s_waitcnt lgkmcnt(0)
    v_pk_add_f32 v[20:21], v[20:21], v[22:23]
    v_pk_add_f32 v[16:17], v[16:17], v[20:21]
    v_add_f32 v16, v16, v17
    buffer_store_dword v16, v14, s[16:19], s1 offen sc1
    buffer_store_dword v16, v14, s[16:19], s99 offen sc1
WOX:
    s_cmp_ge_u32 s46, 30
    s_cbranch_scc1 STX
    s_cmp_eq_u32 s44, 3
    s_cbranch_scc1 F1W3
    s_waitcnt vmcnt(0)
F1W3:
    s_waitcnt vmcnt(2)
F1E:
    v_and_b32 v61, 3, v1
    v_lshlrev_b32 v61, 3, v61
    v_bfe_u32 v60, v1, 2, 2
    v_lshl_add_u32 v61, v60, 7, v61
    v_lshrrev_b32 v60, 4, v1
    v_lshl_add_u32 v61, v60, 10, v61
    v_bfe_u32 v60, v1, 3, 2
    v_lshl_add_u32 v61, v60, 5, v61
    s_lshl_b32 s52, s44, 5
    v_xor_b32 v61, s52, v61
    ds_read_b64_tr_b16 v[64:65], v61 offset:49152
    ds_read_b64_tr_b16 v[66:67], v61 offset:49664
    ds_read_b64_tr_b16 v[68:69], v61 offset:53248
    ds_read_b64_tr_b16 v[70:71], v61 offset:53760
    ds_read_b64_tr_b16 v[72:73], v61 offset:57344
    ds_read_b64_tr_b16 v[74:75], v61 offset:57856
    ds_read_b64_tr_b16 v[76:77], v61 offset:61440
    ds_read_b64_tr_b16 v[78:79], v61 offset:61952
    s_lshl_b32 s52, s59, 6
    s_lshl_b32 s54, s44, 4
    s_add_u32 s52, s52, s54
    v_add_u32 v14, s52, v1
    s_mul_i32 s52, s58, 3072
    s_lshl_b32 s54, s3, 2
    s_add_u32 s52, s52, s54
    s_lshl_b32 s53, s58, 2
    s_add_u32 s53, s53, 6144
    s_cmp_eq_u32 s3, 4
    s_cselect_b32 s52, s53, s52
    s_cselect_b32 s53, 3, 4
    v_lshlrev_b32 v14, s53, v14
    v_add_u32 v14, s52, v14
    s_lshl_b32 s52, s4, 3
    s_add_u32 s52, s52, 20224
    v_mov_b32 v15, s52
    v_and_b32 v57, 31, v1
    v_lshl_add_u32 v57, s44, 5, v57
    s_lshl_b32 s52, s4, 9
    s_add_u32 s52, s52, 133632
    s_cmp_lt_u32 s4, 5
    s_cselect_b32 s52, s52, 1879048192
    s_cmp_eq_u32 s45, 0
    s_cselect_b32 s52, s52, 1879048192
    v_lshl_add_u32 v56, v57, 2, s52
    v_lshlrev_b32 v57, 1, v57
    v_add_u32 v57, 96512, v57
    v_lshrrev_b32 v58, 5, v1
    v_lshlrev_b32 v58, 10, v58
    v_and_b32 v59, 31, v1
    v_lshl_add_u32 v58, v59, 2, v58
    s_lshl_b32 s52, s3, 14
    s_lshl_b32 s54, s44, 11
    s_add_u32 s52, s52, s54
    s_lshl_b32 s54, s0, 0
    s_add_u32 s52, s52, s54
    v_add_u32 v58, s52, v58
    v_min_u32 v54, 191, v0
    v_lshlrev_b32 v52, 4, v54
    v_lshlrev_b32 v54, 3, v54
    v_add_u32 v54, 6144, v54
    v_and_b32 v53, 15, v0
    s_mov_b32 s100, 0
    s_cmp_eq_u32 s49, 0
    s_cbranch_scc1 HOOKD
    s_cmp_lt_u32 s46, 20
    s_cbranch_scc1 GFB
    s_sleep 18
GFB:
    s_sleep 8
F1S:
    v_add_u32 v14, 12288, v14
    v_add_u32 v52, 12288, v52
    v_add_u32 v54, 12288, v54
    s_mov_b32 s51, 0
F1P:
    buffer_load_dword v16, v58, s[16:19], s49 offen offset:0 sc1
    buffer_load_dword v17, v58, s[16:19], s49 offen offset:128 sc1
    buffer_load_dword v18, v58, s[16:19], s49 offen offset:256 sc1
    buffer_load_dword v19, v58, s[16:19], s49 offen offset:384 sc1
    buffer_load_dword v20, v58, s[16:19], s49 offen offset:512 sc1
    buffer_load_dword v21, v58, s[16:19], s49 offen offset:640 sc1
    buffer_load_dword v22, v58, s[16:19], s49 offen offset:768 sc1
    buffer_load_dword v23, v58, s[16:19], s49 offen offset:896 sc1
    s_cmp_eq_u32 s100, 3
    s_cbranch_scc1 HOOKH
F1W:
    s_waitcnt vmcnt(0)
    v_pk_add_f32 v[16:17], v[16:17], v[18:19]
    v_pk_add_f32 v[20:21], v[20:21], v[22:23]
    v_pk_add_f32 v[16:17], v[16:17], v[20:21]
    v_add_f32 v16, v16, v17
    v_mov_b32 v17, v16
    s_nop 1
    v_permlane32_swap_b32 v16, v17
    v_add_f32 v16, v16, v17
    v_cmp_u_f32 vcc, v16, v16
    s_cbranch_vccz F1OK
    s_add_u32 s51, s51, 1
    s_sleep 1
    s_cmp_lt_u32 s51, 0x8000
    s_cbranch_scc1 F1P
F1OK:
    v_cvt_pk_bf16_f32 v16, v16, v16
    ds_write_b16 v57, v16
    v_and_b32 v16, 0xffff0000, v16
    s_mov_b32 exec_hi, 0
    s_cmp_eq_u32 s50, 0
    s_cbranch_scc1 SLOW7
    buffer_store_dword v16, v56, s[16:19], s49 offen
PUBD7:
    s_mov_b64 exec, -1
    s_waitcnt lgkmcnt(0)
    s_barrier
    ds_read_b128 v[20:23], v2 offset:256
    ds_read_b128 v[24:27], v2 offset:320
    ds_read_b128 v[28:31], v2 offset:384
    ds_read_b128 v[32:35], v2 offset:448
    s_waitcnt lgkmcnt(3)
    v_mfma_f32_16x16x32_bf16 v[40:43], v[20:23], v[64:67], 0
    v_mfma_f32_16x16x32_bf16 v[44:47], v[20:23], v[20:23], 0
    s_waitcnt lgkmcnt(2)
    v_mfma_f32_16x16x32_bf16 v[40:43], v[24:27], v[68:71], v[40:43]
    v_mfma_f32_16x16x32_bf16 v[44:47], v[24:27], v[24:27], v[44:47]
    s_waitcnt lgkmcnt(1)
    v_mfma_f32_16x16x32_bf16 v[40:43], v[28:31], v[72:75], v[40:43]
    v_mfma_f32_16x16x32_bf16 v[44:47], v[28:31], v[28:31], v[44:47]
    s_waitcnt lgkmcnt(0)
    v_mfma_f32_16x16x32_bf16 v[40:43], v[32:35], v[76:79], v[40:43]
    v_mfma_f32_16x16x32_bf16 v[44:47], v[32:35], v[32:35], v[44:47]
    s_mov_b64 exec, 0xffff
    s_nop 3
    s_cmp_eq_u32 s50, 0
    s_cbranch_scc1 SLOW8
    buffer_store_dword v40, v14, s[16:19], s62 offen
    s_mov_b64 exec, 1
    buffer_store_dwordx2 v[44:45], v15, s[16:19], s62 offen
PUBD8:
    s_mov_b64 exec, -1
    s_cmp_lt_u32 s46, 20
    s_cbranch_scc1 STX
    v_and_b32 v58, 7, v1
    v_cmp_gt_u32 vcc, 5, v58
    v_lshlrev_b32 v58, 3, v58
    v_add_u32 v58, 20224, v58
    v_mov_b32 v59, 1879048192
    v_cndmask_b32 v58, v59, v58, vcc
    s_lshl_b32 s52, s57, 8
    s_lshl_b32 s54, s44, 6
    s_add_u32 s52, s52, s54
    s_add_u32 s52, s52, 133632
    s_cmp_eq_u32 s45, 0
    s_cselect_b32 s52, s52, 1879048192
    v_lshl_add_u32 v59, v53, 2, s52
    s_cmp_eq_u32 s44, 3
    s_cselect_b32 s53, 1879048192, s62
    s_mov_b32 s51, 0
    s_cmp_eq_u32 s49, 0
    s_cbranch_scc1 HOOKI
    s_nop 3
W20:
    s_nop 11
    buffer_load_dword v76, v59, s[16:19], s49 offen sc1
    buffer_load_dwordx2 v[74:75], v58, s[16:19], s62 offen sc1
    buffer_load_dwordx4 v[64:67], v52, s[16:19], s53 offen offset:0 sc1
    buffer_load_dwordx4 v[68:71], v52, s[16:19], s53 offen offset:3072 sc1
    buffer_load_dwordx2 v[72:73], v54, s[16:19], s53 offen sc1
    s_lshr_b32 s1, s57, 2
    s_lshr_b32 s99, s44, 1
    s_lshl_b32 s52, s57, 11
    s_lshl_b32 s54, s1, 13
    s_add_u32 s52, s52, s54
    s_mul_i32 s54, s99, 896
    s_add_u32 s52, s52, s54
    s_lshl_b32 s54, s44, 6
    s_add_u32 s52, s52, s54
    s_lshl_b32 s54, s45, 7
    s_add_u32 s52, s52, s54
    s_add_u32 s52, s52, 81920
    v_lshl_add_u32 v14, v53, 2, s52
    v_bfe_u32 v15, v1, 4, 1
    v_lshl_add_u32 v14, v15, 13, v14
    v_lshlrev_b32 v57, 1, v0
    v_add_u32 v57, 96768, v57
    s_mov_b32 s51, 0
    s_nop 15
    s_nop 13
W2P:
    buffer_load_dword v76, v59, s[16:19], s49 offen sc1
    buffer_load_dwordx2 v[74:75], v58, s[16:19], s62 offen sc1
    buffer_load_dwordx4 v[64:67], v52, s[16:19], s53 offen offset:0 sc1
    buffer_load_dwordx4 v[68:71], v52, s[16:19], s53 offen offset:3072 sc1
    buffer_load_dwordx2 v[72:73], v54, s[16:19], s53 offen sc1
    s_waitcnt vmcnt(5)
W2C:
    v_add_f32_dpp v36, v74, v74 quad_perm:[1,0,3,2] row_mask:0xf bank_mask:0xf
    v_add_f32_dpp v37, v75, v75 quad_perm:[1,0,3,2] row_mask:0xf bank_mask:0xf
    v_pk_add_f32 v[18:19], v[64:65], v[66:67]
    v_add_f32_dpp v36, v36, v36 quad_perm:[2,3,0,1] row_mask:0xf bank_mask:0xf
    v_add_f32_dpp v37, v37, v37 quad_perm:[2,3,0,1] row_mask:0xf bank_mask:0xf
    v_pk_add_f32 v[20:21], v[68:69], v[70:71]
    v_add_f32_dpp v36, v36, v36 row_half_mirror row_mask:0xf bank_mask:0xf
    v_add_f32_dpp v37, v37, v37 row_half_mirror row_mask:0xf bank_mask:0xf
    v_add_f32 v16, v18, v19
    v_add_f32 v17, v20, v21
    v_mul_f32 v37, 0x3acccccd, v37
    v_fmamk_f32 v36, v36, 0x3acccccd, v11
    v_fma_f32 v36, -v37, v37, v36
    v_rsq_f32 v36, v36
    v_pk_add_f32 v[16:17], v[16:17], v[72:73]
    v_pk_fma_f32 v[16:17], v[36:37], v[126:127], v[16:17] op_sel:[1,0,0] op_sel_hi:[1,1,1] neg_lo:[1,0,0] neg_hi:[1,0,0]
    v_pk_mul_f32 v[16:17], v[16:17], v[36:37] op_sel_hi:[1,0]
    v_mul_f32 v18, 0xbfb8aa3b, v16
    v_exp_f32 v18, v18
    v_mul_f32 v16, v16, v17
    v_add_f32 v18, 1.0, v18
    v_rcp_f32 v18, v18
    v_cmp_u_f32 vcc, v16, v76
    v_mul_f32 v16, v16, v18
    s_cbranch_vccz W2OK
    s_add_u32 s51, s51, 1
    s_cmp_lt_u32 s51, 0x8000
    s_cbranch_scc1 W2P
W2OK:
    v_cvt_pk_bf16_f32 v16, v16, v16
    ds_write_b16 v57, v16
    s_waitcnt lgkmcnt(0)
    s_barrier
    ds_read_b128 v[16:19], v2 offset:512
    ds_read_b128 v[20:23], v2 offset:576
    ds_read_b128 v[24:27], v2 offset:640
    ds_read_b128 v[28:31], v2 offset:704
    ds_read_b128 v[32:35], v2 offset:768
    ds_read_b128 v[36:39], v2 offset:832
    s_waitcnt lgkmcnt(5)
    v_mfma_f32_16x16x32_bf16 v[40:43], v[16:19], v[80:83], 0
    s_waitcnt lgkmcnt(4)
    v_mfma_f32_16x16x32_bf16 v[40:43], v[20:23], v[84:87], v[40:43]
    s_waitcnt lgkmcnt(3)
    v_mfma_f32_16x16x32_bf16 v[40:43], v[24:27], v[88:91], v[40:43]
    s_waitcnt lgkmcnt(2)
    v_mfma_f32_16x16x32_bf16 v[40:43], v[28:31], v[92:95], v[40:43]
    s_waitcnt lgkmcnt(1)
    v_mfma_f32_16x16x32_bf16 v[40:43], v[32:35], v[96:99], v[40:43]
    s_waitcnt lgkmcnt(0)
    v_mfma_f32_16x16x32_bf16 v[40:43], v[36:39], v[100:103], v[40:43]
    s_mov_b32 exec_hi, 0
    s_waitcnt vmcnt(0)
    s_nop 5
    v_add_f32 v40, v40, v76
    buffer_store_dword v40, v14, s[16:19], s49 offen sc1
    s_mov_b64 exec, -1
STX:
    s_cmp_lg_u32 s49, 0
    s_cbranch_scc1 LAST
    s_branch LOOP
LAST:
    s_and_b32 s52, s2, 0xc7
    s_cmp_eq_u32 s52, 0
    s_cbranch_scc1 LOOP
    s_endpgm
FINAL:
    s_cmp_eq_u32 s44, 3
    s_cbranch_scc1 FINX
    v_cvt_pk_bf16_f32 v30, v30, v30
    v_lshlrev_b32 v20, 1, v29
    s_mul_i32 s52, s48, 160
    s_mov_b32 exec_lo, s60
    s_mov_b32 exec_hi, 0
    buffer_store_short v30, v20, s[36:39], s52 offen
    s_mov_b64 exec, -1
FINX:
DONE:
    s_endpgm
HOOKL:
    s_cmp_lg_u32 s49, 0
    s_cbranch_scc1 HL2
    s_cmp_lt_u32 s46, 30
    s_cbranch_scc1 NOGSW
    v_mov_b32 v20, 20224
    s_mov_b32 s51, 0
GSW:
    buffer_load_dword v21, v20, s[16:19], s62 offen sc1
    s_waitcnt vmcnt(0)
    v_cmp_u_f32 vcc, v21, v21
    s_cbranch_vccz NOGSW
    s_add_u32 s51, s51, 1
    s_sleep 2
    s_cmp_lt_u32 s51, 0x8000
    s_cbranch_scc1 GSW
NOGSW:
    s_cmp_ge_u32 s46, 30
    s_cselect_b32 s53, 10, 0
    s_sub_u32 s53, s46, s53
    v_min_u32 v27, 17, v1
    v_lshlrev_b32 v27, 7, v27
    s_mul_i32 s52, s45, 45312
    s_mul_i32 s54, s53, 2304
    s_add_u32 s52, s52, s54
    s_add_u32 s52, s52, 524288
    buffer_load_dword v27, v27, s[16:19], s52 offen sc1
    v_lshlrev_b32 v24, 3, v0
    s_mul_i32 s52, s47, 12288
    s_add_u32 s52, s52, 1441792
    s_mov_b32 s51, 0
QCPA:
    s_add_u32 s53, s52, 0
    buffer_load_dwordx2 v[32:33], v24, s[16:19], s53 offen offset:0 sc1
    buffer_load_dwordx2 v[34:35], v24, s[16:19], s53 offen offset:1536 sc1
    s_add_u32 s53, s52, 3072
    buffer_load_dwordx2 v[36:37], v24, s[16:19], s53 offen offset:0 sc1
    buffer_load_dwordx2 v[38:39], v24, s[16:19], s53 offen offset:1536 sc1
    s_add_u32 s53, s52, 6144
    buffer_load_dwordx2 v[40:41], v24, s[16:19], s53 offen offset:0 sc1
    buffer_load_dwordx2 v[42:43], v24, s[16:19], s53 offen offset:1536 sc1
    s_add_u32 s53, s52, 9216
    buffer_load_dwordx2 v[20:21], v24, s[16:19], s53 offen offset:0 sc1
    buffer_load_dwordx2 v[22:23], v24, s[16:19], s53 offen offset:1536 sc1
    s_cmp_lg_u32 s51, 0
    s_cbranch_scc1 QCWA
    s_sleep 26
QCWA:
    s_waitcnt vmcnt(0)
    v_bitop3_b32 v33, v32, v33, s101 bitop3:0x96
    v_bitop3_b32 v35, v34, v35, s101 bitop3:0x96
    v_bitop3_b32 v37, v36, v37, s101 bitop3:0x96
    v_bitop3_b32 v39, v38, v39, s101 bitop3:0x96
    v_bitop3_b32 v41, v40, v41, s101 bitop3:0x96
    v_bitop3_b32 v43, v42, v43, s101 bitop3:0x96
    v_bitop3_b32 v21, v20, v21, s101 bitop3:0x96
    v_bitop3_b32 v23, v22, v23, s101 bitop3:0x96
    v_add_f32 v13, v32, v34
    v_add_f32 v13, v13, v36
    v_add_f32 v13, v13, v38
    v_add_f32 v13, v13, v40
    v_add_f32 v13, v13, v42
    v_add_f32 v13, v13, v20
    v_add_f32 v13, v13, v22
    v_or_b32 v33, v33, v35
    v_or_b32 v33, v33, v37
    v_or_b32 v33, v33, v39
    v_or_b32 v33, v33, v41
    v_or_b32 v33, v33, v43
    v_or_b32 v33, v33, v21
    v_or_b32 v33, v33, v23
    v_cmp_ne_u32 vcc, 0, v33
    s_cbranch_vccz QCOKA
    s_add_u32 s51, s51, 1
    s_sleep 2
    s_cmp_lt_u32 s51, 0x8000
    s_cbranch_scc1 QCPA
QCOKA:
    s_branch GYB
HL2:
    s_sleep 21
    s_branch GYB
HOOKA:
    s_nop 3
    s_lshl_b32 s52, s44, 6
    s_add_u32 s52, s52, 98816
    v_lshl_add_u32 v14, v1, 2, s52
    ds_write_b32 v14, v17 offset:8704
    v_fma_f32 v16, -v84, v17, v16
    v_mul_f32 v16, v16, v85
    ds_write_b32 v14, v16 offset:0
    ds_write_b32 v14, v21 offset:8960
    v_fma_f32 v20, -v84, v21, v20
    v_mul_f32 v20, v20, v85
    ds_write_b32 v14, v20 offset:256
    ds_write_b32 v14, v25 offset:9216
    v_fma_f32 v24, -v84, v25, v24
    v_mul_f32 v24, v24, v85
    ds_write_b32 v14, v24 offset:512
    s_mov_b64 exec, -1
    s_add_u32 s44, s44, 1
    s_cmp_lt_u32 s44, 4
    s_cbranch_scc1 LOOP
    s_mov_b32 s44, 3
    v_lshlrev_b32 v14, 2, v1
    v_add_u32 v14, 98816, v14
    ds_read2st64_b32 v[16:17], v14 offset0:0 offset1:1
    ds_read_b32 v18, v14 offset:512
    s_lshl_b32 s52, s47, 13
    s_lshl_b32 s54, s48, 10
    s_add_u32 s52, s52, s54
    s_add_u32 s52, s52, 1114112
    s_waitcnt lgkmcnt(0)
    v_bitop3_b32 v19, v16, v17, v18 bitop3:0x96
    v_xor_b32 v19, v19, v89
    buffer_store_dwordx4 v[16:19], v88, s[16:19], s52 offen sc1
    s_sleep 24
    v_and_b32 v15, 0xe1, v1
    v_lshlrev_b32 v15, 1, v15
    v_bfe_u32 v14, v1, 4, 1
    v_lshl_add_u32 v15, v14, 3, v15
    v_bfe_u32 v14, v1, 3, 1
    v_lshl_add_u32 v15, v14, 5, v15
    v_bfe_u32 v14, v1, 2, 1
    v_lshl_add_u32 v15, v14, 2, v15
    v_bfe_u32 v14, v1, 1, 1
    v_lshl_add_u32 v15, v14, 4, v15
    v_add_u32 v15, 98304, v15
    s_lshl_b32 s52, s47, 13
    s_add_u32 s52, s52, 1114112
    s_add_u32 s53, s52, 4096
    s_mov_b32 s51, 0
Q0P:
    buffer_load_dwordx4 v[16:19], v88, s[16:19], s52 offen offset:0 sc1
    buffer_load_dwordx4 v[20:23], v88, s[16:19], s52 offen offset:1024 sc1
    buffer_load_dwordx4 v[24:27], v88, s[16:19], s52 offen offset:2048 sc1
    buffer_load_dwordx4 v[28:31], v88, s[16:19], s52 offen offset:3072 sc1
    buffer_load_dwordx4 v[32:35], v88, s[16:19], s53 offen offset:0 sc1
    buffer_load_dwordx4 v[36:39], v88, s[16:19], s53 offen offset:1024 sc1
    buffer_load_dwordx4 v[40:43], v88, s[16:19], s53 offen offset:2048 sc1
    buffer_load_dwordx4 v[44:47], v88, s[16:19], s53 offen offset:3072 sc1
    v_mov_b32 v48, 0
    s_waitcnt vmcnt(0)
    v_bitop3_b32 v49, v16, v17, v18 bitop3:0x96
    v_bitop3_b32 v49, v49, v19, v89 bitop3:0x96
    v_or_b32 v48, v48, v49
    v_bitop3_b32 v49, v20, v21, v22 bitop3:0x96
    v_bitop3_b32 v49, v49, v23, v89 bitop3:0x96
    v_or_b32 v48, v48, v49
    v_bitop3_b32 v49, v24, v25, v26 bitop3:0x96
    v_bitop3_b32 v49, v49, v27, v89 bitop3:0x96
    v_or_b32 v48, v48, v49
    v_bitop3_b32 v49, v28, v29, v30 bitop3:0x96
    v_bitop3_b32 v49, v49, v31, v89 bitop3:0x96
    v_or_b32 v48, v48, v49
    v_bitop3_b32 v49, v32, v33, v34 bitop3:0x96
    v_bitop3_b32 v49, v49, v35, v89 bitop3:0x96
    v_or_b32 v48, v48, v49
    v_bitop3_b32 v49, v36, v37, v38 bitop3:0x96
    v_bitop3_b32 v49, v49, v39, v89 bitop3:0x96
    v_or_b32 v48, v48, v49
    v_bitop3_b32 v49, v40, v41, v42 bitop3:0x96
    v_bitop3_b32 v49, v49, v43, v89 bitop3:0x96
    v_or_b32 v48, v48, v49
    v_bitop3_b32 v49, v44, v45, v46 bitop3:0x96
    v_bitop3_b32 v49, v49, v47, v89 bitop3:0x96
    v_or_b32 v48, v48, v49
    v_cmp_ne_u32 vcc, 0, v48
    s_cbranch_vccz Q0OK
    s_add_u32 s51, s51, 1
    s_sleep 4
    s_cmp_lt_u32 s51, 0x8000
    s_cbranch_scc1 Q0P
Q0OK:
    v_pk_add_f32 v[16:17], v[16:17], v[20:21]
    v_add_f32 v18, v18, v22
    v_pk_add_f32 v[16:17], v[16:17], v[24:25]
    v_add_f32 v18, v18, v26
    v_pk_add_f32 v[16:17], v[16:17], v[28:29]
    v_add_f32 v18, v18, v30
    v_pk_add_f32 v[16:17], v[16:17], v[32:33]
    v_add_f32 v18, v18, v34
    v_pk_add_f32 v[16:17], v[16:17], v[36:37]
    v_add_f32 v18, v18, v38
    v_pk_add_f32 v[16:17], v[16:17], v[40:41]
    v_add_f32 v18, v18, v42
    v_pk_add_f32 v[16:17], v[16:17], v[44:45]
    v_add_f32 v18, v18, v46
    v_cvt_pk_bf16_f32 v16, v16, v17
    v_cvt_pk_bf16_f32 v18, v18, v18
    ds_write_b16 v15, v16
    ds_write_b16_d16_hi v15, v16 offset:128
    ds_write_b16 v15, v18 offset:256
    s_mov_b32 s51, 0
HSP:
    s_mov_b32 s52, 1376256
    buffer_load_dwordx4 v[24:27], v88, s[16:19], s52 offen sc1
    s_waitcnt vmcnt(0)
    v_xor_b32 v20, s5, v24
    v_xor_b32 v21, s5, v25
    v_xor_b32 v22, s5, v26
    v_xor_b32 v23, s5, v27
    v_or3_b32 v20, v20, v21, v22
    v_or_b32 v20, v20, v23
    v_cmp_lt_u32 vcc, 31, v20
    s_cbranch_vccz HSOK
    s_add_u32 s51, s51, 1
    s_sleep 8
    s_cmp_lt_u32 s51, 0x8000
    s_cbranch_scc1 HSP
HSOK:
    s_mov_b32 s53, 0
    v_and_b32 v24, 16, v24
    v_cmp_ne_u32 vcc, 0, v24
    s_bcnt1_i32_b64 s52, vcc
    s_add_u32 s53, s53, s52
    v_and_b32 v25, 16, v25
    v_cmp_ne_u32 vcc, 0, v25
    s_bcnt1_i32_b64 s52, vcc
    s_add_u32 s53, s53, s52
    v_and_b32 v26, 16, v26
    v_cmp_ne_u32 vcc, 0, v26
    s_bcnt1_i32_b64 s52, vcc
    s_add_u32 s53, s53, s52
    v_and_b32 v27, 16, v27
    v_cmp_ne_u32 vcc, 0, v27
    s_bcnt1_i32_b64 s52, vcc
    s_add_u32 s53, s53, s52
    v_and_b32 v20, 15, v20
    s_cmp_gt_u32 s53, 128
    s_cselect_b32 s53, 2, 0
    s_lshr_b32 s52, s5, 1
    s_xor_b32 s53, s53, s52
    s_and_b32 s53, s53, 2
    s_lshl_b32 s52, s45, 3
    v_cmp_ne_u32 vcc, 0, v20
    s_lshr_b64 s[60:61], vcc, s52
    s_and_b32 s52, s60, 0xff
    s_cselect_b32 s50, 0, 1
    v_mov_b32 v38, 98784
    s_or_b32 s53, s53, s50
    v_or_b32 v39, s53, v89
    ds_write_b32 v38, v39
    v_and_b32 v21, 0xffff0000, v86
    v_lshlrev_b32 v20, 16, v86
    buffer_store_dwordx2 v[20:21], v87, s[16:19], 0 offen sc1
    s_branch ENTRY
HOOKE:
    s_cmp_lg_u32 s44, 3
    s_cbranch_scc1 QFRAG
    s_waitcnt lgkmcnt(0)
    s_barrier
    s_waitcnt vmcnt(26)
    buffer_load_dwordx4 a[0:3], v80, s[8:11], s96 offen offset:0 nt
    s_waitcnt vmcnt(26)
    buffer_load_dwordx4 a[8:11], v80, s[8:11], s96 offen offset:128 nt
    s_waitcnt vmcnt(26)
    buffer_load_dwordx4 a[16:19], v80, s[8:11], s96 offen offset:256 nt
    s_add_u32 s96, s96, s97
    s_waitcnt vmcnt(26)
    buffer_load_dwordx4 a[4:7], v80, s[8:11], s96 offen offset:0 nt
    s_waitcnt vmcnt(26)
    buffer_load_dwordx4 a[12:15], v80, s[8:11], s96 offen offset:128 nt
    s_waitcnt vmcnt(26)
    buffer_load_dwordx4 a[20:23], v80, s[8:11], s96 offen offset:256 nt
    s_add_u32 s96, s96, s97
    s_waitcnt vmcnt(26)
    buffer_load_dwordx4 a[24:27], v80, s[8:11], s96 offen offset:0 nt
    s_waitcnt vmcnt(26)
    buffer_load_dwordx4 a[32:35], v80, s[8:11], s96 offen offset:128 nt
    s_waitcnt vmcnt(26)
    buffer_load_dwordx4 a[40:43], v80, s[8:11], s96 offen offset:256 nt
    s_add_u32 s96, s96, s97
    s_waitcnt vmcnt(26)
    buffer_load_dwordx4 a[28:31], v80, s[8:11], s96 offen offset:0 nt
    s_waitcnt vmcnt(26)
    buffer_load_dwordx4 a[36:39], v80, s[8:11], s96 offen offset:128 nt
    s_waitcnt vmcnt(26)
    buffer_load_dwordx4 a[44:47], v80, s[8:11], s96 offen offset:256 nt
    s_add_u32 s96, s96, s97
    s_waitcnt vmcnt(26)
    buffer_load_dwordx4 a[48:51], v80, s[8:11], s96 offen offset:0 nt
    s_waitcnt vmcnt(26)
    buffer_load_dwordx4 a[56:59], v80, s[8:11], s96 offen offset:128 nt
    s_waitcnt vmcnt(26)
    buffer_load_dwordx4 a[64:67], v80, s[8:11], s96 offen offset:256 nt
    s_add_u32 s96, s96, s97
    s_waitcnt vmcnt(26)
    buffer_load_dwordx4 a[52:55], v80, s[8:11], s96 offen offset:0 nt
    s_waitcnt vmcnt(26)
    buffer_load_dwordx4 a[60:63], v80, s[8:11], s96 offen offset:128 nt
    s_waitcnt vmcnt(26)
    buffer_load_dwordx4 a[68:71], v80, s[8:11], s96 offen offset:256 nt
    s_add_u32 s96, s96, s97
    s_waitcnt vmcnt(26)
    buffer_load_dwordx4 a[72:75], v80, s[8:11], s96 offen offset:0 nt
    s_waitcnt vmcnt(26)
    buffer_load_dwordx4 a[80:83], v80, s[8:11], s96 offen offset:128 nt
    s_waitcnt vmcnt(26)
    buffer_load_dwordx4 a[88:91], v80, s[8:11], s96 offen offset:256 nt
    s_add_u32 s96, s96, s97
    s_waitcnt vmcnt(26)
    buffer_load_dwordx4 a[76:79], v80, s[8:11], s96 offen offset:0 nt
    s_waitcnt vmcnt(26)
    buffer_load_dwordx4 a[84:87], v80, s[8:11], s96 offen offset:128 nt
    s_waitcnt vmcnt(26)
    buffer_load_dwordx4 a[92:95], v80, s[8:11], s96 offen offset:256 nt
    s_add_u32 s96, s96, s97
    s_waitcnt vmcnt(26)
    buffer_load_dwordx4 a[96:99], v80, s[8:11], s96 offen offset:0 nt
    s_waitcnt vmcnt(26)
    buffer_load_dwordx4 a[104:107], v80, s[8:11], s96 offen offset:128 nt
    s_waitcnt vmcnt(26)
    buffer_load_dwordx4 a[112:115], v80, s[8:11], s96 offen offset:256 nt
    s_add_u32 s96, s96, s97
    s_waitcnt vmcnt(26)
    buffer_load_dwordx4 a[100:103], v80, s[8:11], s96 offen offset:0 nt
    s_waitcnt vmcnt(26)
    buffer_load_dwordx4 a[108:111], v80, s[8:11], s96 offen offset:128 nt
    s_waitcnt vmcnt(26)
    buffer_load_dwordx4 a[116:119], v80, s[8:11], s96 offen offset:256 nt
    s_add_u32 s96, s96, s97
    s_waitcnt vmcnt(26)
    buffer_load_dwordx4 a[120:123], v80, s[8:11], s96 offen offset:0 nt
    s_waitcnt vmcnt(26)
    buffer_load_dwordx4 a[128:131], v80, s[8:11], s96 offen offset:128 nt
    s_waitcnt vmcnt(26)
    buffer_load_dwordx4 a[136:139], v80, s[8:11], s96 offen offset:256 nt
    s_add_u32 s96, s96, s97
    s_waitcnt vmcnt(26)
    buffer_load_dwordx4 a[124:127], v80, s[8:11], s96 offen offset:0 nt
    s_waitcnt vmcnt(26)
    buffer_load_dwordx4 a[132:135], v80, s[8:11], s96 offen offset:128 nt
    s_waitcnt vmcnt(26)
    buffer_load_dwordx4 a[140:143], v80, s[8:11], s96 offen offset:256 nt
    s_add_u32 s96, s96, s97
    s_waitcnt vmcnt(26)
    buffer_load_dwordx4 a[144:147], v80, s[8:11], s96 offen offset:0 nt
    s_waitcnt vmcnt(26)
    buffer_load_dwordx4 a[152:155], v80, s[8:11], s96 offen offset:128 nt
    s_waitcnt vmcnt(26)
    buffer_load_dwordx4 a[160:163], v80, s[8:11], s96 offen offset:256 nt
    s_add_u32 s96, s96, s97
    s_waitcnt vmcnt(26)
    buffer_load_dwordx4 a[148:151], v80, s[8:11], s96 offen offset:0 nt
    s_waitcnt vmcnt(26)
    buffer_load_dwordx4 a[156:159], v80, s[8:11], s96 offen offset:128 nt
    s_waitcnt vmcnt(26)
    buffer_load_dwordx4 a[164:167], v80, s[8:11], s96 offen offset:256 nt
    s_add_u32 s96, s96, s97
    s_waitcnt vmcnt(26)
    buffer_load_dwordx4 a[168:171], v80, s[8:11], s96 offen offset:0 nt
    s_waitcnt vmcnt(26)
    buffer_load_dwordx4 a[176:179], v80, s[8:11], s96 offen offset:128 nt
    s_waitcnt vmcnt(26)
    buffer_load_dwordx4 a[184:187], v80, s[8:11], s96 offen offset:256 nt
    s_add_u32 s96, s96, s97
    s_waitcnt vmcnt(26)
    buffer_load_dwordx4 a[172:175], v80, s[8:11], s96 offen offset:0 nt
    s_waitcnt vmcnt(26)
    buffer_load_dwordx4 a[180:183], v80, s[8:11], s96 offen offset:128 nt
    s_waitcnt vmcnt(26)
    buffer_load_dwordx4 a[188:191], v80, s[8:11], s96 offen offset:256 nt
    s_lshl_b32 s97, s97, 1
    s_waitcnt vmcnt(26)
    buffer_load_dwordx4 a[192:195], v82, s[12:15], s55 offen offset:0 nt
    s_waitcnt vmcnt(26)
    buffer_load_dwordx4 a[200:203], v82, s[12:15], s55 offen offset:128 nt
    s_waitcnt vmcnt(26)
    buffer_load_dwordx4 a[208:211], v82, s[12:15], s55 offen offset:256 nt
    s_waitcnt vmcnt(26)
    buffer_load_dwordx4 a[216:219], v82, s[12:15], s55 offen offset:384 nt
    s_waitcnt vmcnt(26)
    buffer_load_dwordx4 a[224:227], v82, s[12:15], s55 offen offset:512 nt
    s_waitcnt vmcnt(26)
    buffer_load_dwordx4 a[232:235], v82, s[12:15], s55 offen offset:640 nt
    s_add_u32 s55, s55, s97
    s_waitcnt vmcnt(26)
    buffer_load_dwordx4 a[196:199], v82, s[12:15], s55 offen offset:0 nt
    s_waitcnt vmcnt(26)
    buffer_load_dwordx4 a[204:207], v82, s[12:15], s55 offen offset:128 nt
    s_waitcnt vmcnt(26)
    buffer_load_dwordx4 a[212:215], v82, s[12:15], s55 offen offset:256 nt
    s_waitcnt vmcnt(26)
    buffer_load_dwordx4 a[220:223], v82, s[12:15], s55 offen offset:384 nt
    s_waitcnt vmcnt(26)
    buffer_load_dwordx4 a[228:231], v82, s[12:15], s55 offen offset:512 nt
    s_waitcnt vmcnt(26)
    buffer_load_dwordx4 a[236:239], v82, s[12:15], s55 offen offset:640 nt
    s_add_u32 s55, s55, s97
    s_waitcnt vmcnt(26)
    buffer_load_dwordx4 a[240:243], v82, s[12:15], s55 offen offset:0 nt
    s_waitcnt vmcnt(26)
    buffer_load_dwordx4 a[248:251], v82, s[12:15], s55 offen offset:128 nt
    s_waitcnt vmcnt(26)
    buffer_load_dwordx4 v[128:131], v82, s[12:15], s55 offen offset:256 nt
    s_waitcnt vmcnt(26)
    buffer_load_dwordx4 v[136:139], v82, s[12:15], s55 offen offset:384 nt
    s_waitcnt vmcnt(26)
    buffer_load_dwordx4 v[144:147], v82, s[12:15], s55 offen offset:512 nt
    s_waitcnt vmcnt(26)
    buffer_load_dwordx4 v[152:155], v82, s[12:15], s55 offen offset:640 nt
    s_add_u32 s55, s55, s97
    s_waitcnt vmcnt(26)
    buffer_load_dwordx4 a[244:247], v82, s[12:15], s55 offen offset:0 nt
    s_waitcnt vmcnt(26)
    buffer_load_dwordx4 a[252:255], v82, s[12:15], s55 offen offset:128 nt
    s_waitcnt vmcnt(26)
    buffer_load_dwordx4 v[132:135], v82, s[12:15], s55 offen offset:256 nt
    s_waitcnt vmcnt(26)
    buffer_load_dwordx4 v[140:143], v82, s[12:15], s55 offen offset:384 nt
    s_waitcnt vmcnt(26)
    buffer_load_dwordx4 v[148:151], v82, s[12:15], s55 offen offset:512 nt
    s_waitcnt vmcnt(26)
    buffer_load_dwordx4 v[156:159], v82, s[12:15], s55 offen offset:640 nt
    s_add_u32 s55, s55, s97
    s_waitcnt vmcnt(26)
    buffer_load_dwordx4 v[160:163], v82, s[12:15], s55 offen offset:0 nt
    s_waitcnt vmcnt(26)
    buffer_load_dwordx4 v[168:171], v82, s[12:15], s55 offen offset:128 nt
    s_waitcnt vmcnt(26)
    buffer_load_dwordx4 v[176:179], v82, s[12:15], s55 offen offset:256 nt
    s_waitcnt vmcnt(26)
    buffer_load_dwordx4 v[184:187], v82, s[12:15], s55 offen offset:384 nt
    s_waitcnt vmcnt(26)
    buffer_load_dwordx4 v[192:195], v82, s[12:15], s55 offen offset:512 nt
    s_waitcnt vmcnt(26)
    buffer_load_dwordx4 v[200:203], v82, s[12:15], s55 offen offset:640 nt
    s_add_u32 s55, s55, s97
    s_waitcnt vmcnt(26)
    buffer_load_dwordx4 v[164:167], v82, s[12:15], s55 offen offset:0 nt
    s_waitcnt vmcnt(26)
    buffer_load_dwordx4 v[172:175], v82, s[12:15], s55 offen offset:128 nt
    s_waitcnt vmcnt(26)
    buffer_load_dwordx4 v[180:183], v82, s[12:15], s55 offen offset:256 nt
    s_waitcnt vmcnt(26)
    buffer_load_dwordx4 v[188:191], v82, s[12:15], s55 offen offset:384 nt
    s_waitcnt vmcnt(26)
    buffer_load_dwordx4 v[196:199], v82, s[12:15], s55 offen offset:512 nt
    s_waitcnt vmcnt(26)
    buffer_load_dwordx4 v[204:207], v82, s[12:15], s55 offen offset:640 nt
    s_add_u32 s55, s55, s97
    s_waitcnt vmcnt(26)
    buffer_load_dwordx4 v[208:211], v82, s[12:15], s55 offen offset:0 nt
    s_waitcnt vmcnt(26)
    buffer_load_dwordx4 v[216:219], v82, s[12:15], s55 offen offset:128 nt
    s_waitcnt vmcnt(26)
    buffer_load_dwordx4 v[224:227], v82, s[12:15], s55 offen offset:256 nt
    s_waitcnt vmcnt(26)
    buffer_load_dwordx4 v[232:235], v82, s[12:15], s55 offen offset:384 nt
    s_waitcnt vmcnt(26)
    buffer_load_dwordx4 v[240:243], v82, s[12:15], s55 offen offset:512 nt
    s_waitcnt vmcnt(26)
    buffer_load_dwordx4 v[248:251], v82, s[12:15], s55 offen offset:640 nt
    s_add_u32 s55, s55, s97
    s_barrier
    s_waitcnt vmcnt(26)
    buffer_load_dwordx4 v[212:215], v82, s[12:15], s55 offen offset:0 nt
    s_waitcnt vmcnt(26)
    buffer_load_dwordx4 v[220:223], v82, s[12:15], s55 offen offset:128 nt
    s_waitcnt vmcnt(26)
    buffer_load_dwordx4 v[228:231], v82, s[12:15], s55 offen offset:256 nt
    s_waitcnt vmcnt(26)
    buffer_load_dwordx4 v[236:239], v82, s[12:15], s55 offen offset:384 nt
    s_waitcnt vmcnt(26)
    buffer_load_dwordx4 v[244:247], v82, s[12:15], s55 offen offset:512 nt
    s_waitcnt vmcnt(26)
    buffer_load_dwordx4 v[252:255], v82, s[12:15], s55 offen offset:640 nt
    s_branch QFRAG
HOOKF:
    v_mov_b32 v40, 98784
    ds_read_b32 v40, v40
    s_mov_b32 s6, 0
    s_waitcnt lgkmcnt(0)
    v_readfirstlane_b32 s101, v40
    s_and_b32 s50, s101, 1
    s_and_b32 s0, s101, 2
    s_lshl_b32 s0, s0, 12
    s_and_b32 s101, s101, 0xffffffe0
    s_waitcnt vmcnt(48)
    s_branch QK
HOOKC:
    s_cmp_eq_u32 s44, 3
    s_cbranch_scc1 EXB
    v_min_u32 v83, 8, v1
    v_lshlrev_b32 v83, 7, v83
    s_mul_i32 s52, s45, 28160
    s_mul_i32 s54, s46, 1152
    s_add_u32 s52, s52, s54
    s_add_u32 s52, s52, 131072
    buffer_load_dword v83, v83, s[16:19], s52 offen sc1
    v_lshrrev_b32 v58, 3, v1
    v_and_b32 v57, 7, v1
    v_and_b32 v56, 2, v58
    v_xor_b32 v57, v57, v56
    s_and_b32 s52, s44, 1
    s_lshl_b32 s52, s52, 2
    v_xor_b32 v57, s52, v57
    v_mul_u32_u24 v56, 3072, v58
    v_lshl_add_u32 v56, v57, 4, v56
    v_lshrrev_b32 v58, 3, v1
    v_and_b32 v57, 7, v1
    v_and_b32 v55, 2, v58
    v_xor_b32 v57, v57, v55
    s_and_b32 s52, s44, 1
    s_lshl_b32 s52, s52, 2
    v_xor_b32 v57, s52, v57
    v_mul_u32_u24 v55, 1280, v58
    v_lshl_add_u32 v55, v57, 4, v55
    s_barrier
    s_cmp_ge_u32 s46, 20
    s_cbranch_scc1 HC8
    s_mul_i32 s52, s45, 983040
    s_mul_i32 s54, s56, 491520
    s_add_u32 s52, s52, s54
    s_lshl_b32 s54, s57, 7
    s_add_u32 s52, s52, s54
    s_mul_i32 s54, s44, 10240
    s_add_u32 s52, s52, s54
    s_lshl_b32 s53, s44, 10
DMA1:
    s_mov_b32 m0, s53
    s_add_u32 s53, s53, 3072
    buffer_load_dwordx4 v55, s[24:27], s52 offen nt lds
    v_xor_b32 v55, 64, v55
    s_add_u32 s52, s52, 30720
    s_cmp_lt_u32 s53, 49152
    s_cbranch_scc1 DMA1
HC8:
    s_cmp_ge_u32 s46, 30
    s_cbranch_scc1 HC7
    s_mul_i32 s52, s3, 393216
    s_mul_i32 s54, s45, 384
    s_add_u32 s52, s52, s54
    s_lshl_b32 s54, s59, 7
    s_add_u32 s52, s52, s54
    s_mul_i32 s54, s44, 24576
    s_add_u32 s52, s52, s54
    s_lshl_b32 s53, s44, 10
    s_add_u32 s53, s53, 49152
DMA2:
    s_mov_b32 m0, s53
    s_add_u32 s53, s53, 3072
    buffer_load_dwordx4 v56, s[28:31], s52 offen nt lds
    v_xor_b32 v56, 64, v56
    s_add_u32 s52, s52, 73728
    s_cmp_lt_u32 s53, 65536
    s_cbranch_scc1 DMA2
    s_cmp_lt_u32 s46, 20
    s_cbranch_scc1 HC9
HC7:
    s_sub_u32 s53, s46, 20
    s_cmp_ge_u32 s53, 6
    s_cselect_b32 s51, 240, 0
    v_lshlrev_b32 v55, 4, v1
    s_mul_i32 s52, s45, 983040
    s_mul_i32 s54, s53, 30720
    s_add_u32 s52, s52, s54
    s_mul_i32 s54, s51, 1280
    s_add_u32 s52, s52, s54
    s_lshl_b32 s54, s44, 10
    s_add_u32 s52, s52, s54
    s_add_u32 s52, s52, 307200
    s_lshl_b32 s53, s44, 10
    s_add_u32 s53, s53, 24576
    s_mov_b32 m0, s53
    s_nop 0
    buffer_load_dwordx4 v55, s[32:35], s52 offen lds
    s_add_u32 s52, s52, 3072
    buffer_load_dwordx4 v55, s[32:35], s52 offen lds
    s_add_u32 s52, s52, 3072
    buffer_load_dwordx4 v55, s[32:35], s52 offen lds
    s_add_u32 s52, s52, 3072
    buffer_load_dwordx4 v55, s[32:35], s52 offen lds
    s_add_u32 s52, s52, 3072
    buffer_load_dwordx4 v55, s[32:35], s52 offen lds
    s_add_u32 s52, s52, 3072
    buffer_load_dwordx4 v55, s[32:35], s52 offen lds
    s_add_u32 s52, s52, 3072
    buffer_load_dwordx4 v55, s[32:35], s52 offen lds
    s_add_u32 s52, s52, 3072
    buffer_load_dwordx4 v55, s[32:35], s52 offen lds
    s_add_u32 s52, s52, 3072
    buffer_load_dwordx4 v55, s[32:35], s52 offen lds
    s_add_u32 s52, s52, 3072
    buffer_load_dwordx4 v55, s[32:35], s52 offen lds
    s_add_u32 s52, s52, 3072
HC9:
    s_branch EXB
HOOKG:
    v_and_b32 v71, 3, v1
    v_lshlrev_b32 v71, 3, v71
    v_bfe_u32 v72, v1, 2, 2
    v_lshl_add_u32 v71, v72, 7, v71
    v_lshrrev_b32 v72, 4, v1
    v_lshl_add_u32 v71, v72, 10, v71
    v_bfe_u32 v72, v1, 3, 2
    v_lshl_add_u32 v71, v72, 5, v71
    s_mul_i32 s52, s44, 12288
    v_add_u32 v71, s52, v71
    v_xor_b32 v72, 32, v71
    v_xor_b32 v73, 64, v71
    v_xor_b32 v74, 96, v71
    v_lshrrev_b32 v14, 5, v1
    v_lshlrev_b32 v14, 11, v14
    v_and_b32 v15, 31, v1
    v_lshl_add_u32 v14, v15, 2, v14
    s_lshr_b32 s53, s57, 1
    s_lshl_b32 s52, s57, 12
    s_lshl_b32 s54, s53, 13
    s_add_u32 s52, s52, s54
    s_lshl_b32 s54, s45, 8
    s_add_u32 s52, s52, s54
    s_lshl_b32 s54, s56, 7
    s_add_u32 s52, s52, s54
    v_add_u32 v14, s52, v14
    s_xor_b32 s1, s0, 8192
    s_add_u32 s1, s1, s49
    s_add_u32 s99, s0, s49
    s_lshl_b32 s52, s44, 9
    s_add_u32 s52, s52, 104960
    v_lshl_add_u32 v15, v15, 4, s52
    v_and_b32 v64, 15, v1
    v_lshlrev_b32 v64, 4, v64
    v_lshl_add_u32 v64, v31, 2, v64
    v_add_u32 v64, 104960, v64
    s_cmp_lg_u32 s44, 3
    s_cbranch_scc1 QCNA
    v_lshlrev_b32 v38, 2, v1
    v_add_u32 v39, 107520, v38
    v_lshlrev_b32 v38, 1, v38
    ds_read_b32 v32, v39 offset:0
    ds_read_b32 v34, v39 offset:256
    ds_read_b32 v36, v39 offset:512
    s_mul_i32 s52, s47, 12288
    s_mul_i32 s54, s48, 1536
    s_add_u32 s52, s52, s54
    s_add_u32 s52, s52, 1441792
    s_waitcnt lgkmcnt(0)
    v_xor_b32 v33, s101, v32
    v_xor_b32 v35, s101, v34
    v_xor_b32 v37, s101, v36
    s_cmp_eq_u32 s50, 0
    s_cbranch_scc1 SLOW3
    buffer_store_dwordx2 v[32:33], v38, s[16:19], s52 offen offset:0
    buffer_store_dwordx2 v[34:35], v38, s[16:19], s52 offen offset:512
    buffer_store_dwordx2 v[36:37], v38, s[16:19], s52 offen offset:1024
PUBD3:
    s_branch QCMA
QCNA:
    s_waitcnt vmcnt(1)
QCMA:
    s_barrier
    s_branch WO0
HOOKG2:
    ds_read_b64_tr_b16 v[80:81], v71 offset:0
    ds_read_b64_tr_b16 v[82:83], v71 offset:512
    ds_read_b64_tr_b16 v[96:97], v71 offset:4096
    ds_read_b64_tr_b16 v[98:99], v71 offset:4608
    ds_read_b64_tr_b16 v[112:113], v71 offset:8192
    ds_read_b64_tr_b16 v[114:115], v71 offset:8704
    ds_read_b64_tr_b16 v[84:85], v72 offset:0
    ds_read_b64_tr_b16 v[86:87], v72 offset:512
    ds_read_b64_tr_b16 v[100:101], v72 offset:4096
    ds_read_b64_tr_b16 v[102:103], v72 offset:4608
    ds_read_b64_tr_b16 v[116:117], v72 offset:8192
    ds_read_b64_tr_b16 v[118:119], v72 offset:8704
    ds_read_b64_tr_b16 v[88:89], v73 offset:0
    ds_read_b64_tr_b16 v[90:91], v73 offset:512
    ds_read_b64_tr_b16 v[104:105], v73 offset:4096
    ds_read_b64_tr_b16 v[106:107], v73 offset:4608
    ds_read_b64_tr_b16 v[120:121], v73 offset:8192
    ds_read_b64_tr_b16 v[122:123], v73 offset:8704
    ds_read_b64_tr_b16 v[92:93], v74 offset:0
    ds_read_b64_tr_b16 v[94:95], v74 offset:512
    ds_read_b64_tr_b16 v[108:109], v74 offset:4096
    ds_read_b64_tr_b16 v[110:111], v74 offset:4608
    ds_read_b64_tr_b16 v[124:125], v74 offset:8192
    ds_read_b64_tr_b16 v[126:127], v74 offset:8704
    s_waitcnt lgkmcnt(0)
    s_branch WOP
HOOKG3:
    s_cmp_lg_u32 s49, 0
    s_cbranch_scc1 WOX
    s_cmp_lg_u32 s44, 3
    s_cbranch_scc1 QCNB
    v_lshlrev_b32 v38, 2, v1
    v_add_u32 v39, 107520, v38
    v_lshlrev_b32 v38, 1, v38
    ds_read_b32 v32, v39 offset:0
    ds_read_b32 v34, v39 offset:256
    ds_read_b32 v36, v39 offset:512
    s_mul_i32 s52, s47, 12288
    s_mul_i32 s54, s48, 1536
    s_add_u32 s52, s52, s54
    s_add_u32 s52, s52, 1441792
    s_waitcnt lgkmcnt(0)
    v_xor_b32 v33, s101, v32
    v_xor_b32 v35, s101, v34
    v_xor_b32 v37, s101, v36
    s_cmp_eq_u32 s50, 0
    s_cbranch_scc1 SLOW4
    buffer_store_dwordx2 v[32:33], v38, s[16:19], s52 offen offset:0
    buffer_store_dwordx2 v[34:35], v38, s[16:19], s52 offen offset:512
    buffer_store_dwordx2 v[36:37], v38, s[16:19], s52 offen offset:1024
PUBD4:
    s_branch QCMB
QCNB:
    s_waitcnt vmcnt(1)
QCMB:
    s_barrier
    s_cmp_lg_u32 s46, 31
    s_cbranch_scc1 EW1
    s_cmp_lg_u32 s44, 0
    s_cbranch_scc1 WOX
    v_and_b32 v32, 31, v1
    v_lshlrev_b32 v32, 2, v32
    v_add_u32 v32, 19968, v32
    s_mov_b32 s51, 0
    s_lshl_b32 s52, s45, 7
    s_add_u32 s52, s52, 118784
    v_lshlrev_b32 v34, 13, v1
EWP:
    buffer_load_dword v33, v32, s[16:19], s62 offen sc1
    s_waitcnt vmcnt(0)
    v_cmp_u_f32 vcc, v33, v33
    s_cbranch_vccz EWOK
    s_add_u32 s51, s51, 1
    s_cmp_lt_u32 s51, 0x8000
    s_cbranch_scc1 EWP
EWOK:
    s_mov_b64 exec, 3
    buffer_store_dword v34, v34, s[16:19], s52 offen sc1
    s_mov_b64 exec, -1
EW1:
    s_cmp_ge_u32 s46, 30
    s_cbranch_scc1 WOX
    s_cmp_eq_u32 s44, 3
    s_cbranch_scc1 HD0
    v_lshrrev_b32 v33, 3, v1
    v_and_b32 v32, 7, v1
    v_and_b32 v34, 2, v33
    v_xor_b32 v32, v32, v34
    s_and_b32 s52, s44, 1
    s_lshl_b32 s52, s52, 2
    v_xor_b32 v32, s52, v32
    v_mul_u32_u24 v34, 1280, v33
    v_lshl_add_u32 v34, v32, 4, v34
    s_mul_i32 s52, s45, 245760
    s_lshl_b32 s54, s57, 7
    s_add_u32 s52, s52, s54
    s_mul_i32 s54, s44, 10240
    s_add_u32 s52, s52, s54
    s_lshl_b32 s53, s44, 10
DMA3:
    s_mov_b32 m0, s53
    s_add_u32 s53, s53, 3072
    buffer_load_dwordx4 v34, s[24:27], s52 offen nt lds
    v_xor_b32 v34, 64, v34
    s_add_u32 s52, s52, 30720
    s_cmp_lt_u32 s53, 24576
    s_cbranch_scc1 DMA3
HD0:
    v_mov_b64 v[36:37], -1
    v_mov_b64 v[38:39], -1
    v_mov_b32 v43, 1879048192
    s_mul_i32 s52, s57, 5120
    s_mul_i32 s54, s44, 1280
    s_add_u32 s52, s52, s54
    v_lshl_add_u32 v40, v1, 4, s52
    s_add_u32 s52, s52, 1024
    v_lshl_add_u32 v41, v1, 2, s52
    v_cmp_gt_u32 vcc, 45312, v40
    s_lshl_b32 s52, s57, 14
    s_lshl_b32 s54, s45, 11
    s_add_u32 s52, s52, s54
    s_lshl_b32 s54, s44, 9
    s_add_u32 s52, s52, s54
    v_cndmask_b32 v40, v43, v40, vcc
    v_cmp_gt_u32 vcc, 45312, v41
    v_lshl_add_u32 v42, v1, 3, s52
    s_mov_b32 s52, 393216
    v_cndmask_b32 v41, v43, v41, vcc
    v_cmp_gt_u32 vcc, 136192, v42
    s_nop 1
    v_cndmask_b32 v42, v43, v42, vcc
    s_cmp_eq_u32 s50, 0
    s_cbranch_scc1 SLOW5
    buffer_store_dwordx4 v[36:39], v40, s[16:19], s63 offen
    buffer_store_dword v36, v41, s[16:19], s63 offen
PUBD5:
    buffer_store_dwordx2 v[36:37], v42, s[16:19], s52 offen sc1
    s_branch F1E
HOOKD:
    ds_read_b128 v[20:23], v2 offset:256
    ds_read_b128 v[24:27], v2 offset:320
    ds_read_b128 v[28:31], v2 offset:384
    ds_read_b128 v[32:35], v2 offset:448
    s_waitcnt lgkmcnt(0)
    v_mfma_f32_16x16x32_bf16 v[40:43], v[20:23], v[64:67], 0
    v_mfma_f32_16x16x32_bf16 v[40:43], v[24:27], v[68:71], v[40:43]
    v_mfma_f32_16x16x32_bf16 v[40:43], v[28:31], v[72:75], v[40:43]
    v_mfma_f32_16x16x32_bf16 v[40:43], v[32:35], v[76:79], v[40:43]
    s_add_u32 s53, s62, 20480
    s_mov_b64 exec, 0xffff
    s_nop 5
    s_cmp_eq_u32 s50, 0
    s_cbranch_scc1 SLOW6
    buffer_store_dword v41, v14, s[16:19], s53 offen
PUBD6:
    s_mov_b64 exec, -1
    v_and_b32 v16, 7, v1
    v_lshlrev_b32 v16, 7, v16
    s_add_u32 s52, s0, 118784
    s_mov_b32 s51, 0
EWQ:
    buffer_load_dword v17, v16, s[16:19], s52 offen sc1
    s_waitcnt vmcnt(0)
    v_cmp_u_f32 vcc, v17, v17
    s_cbranch_vccz EWQK
    s_add_u32 s51, s51, 1
    s_sleep 1
    s_cmp_lt_u32 s51, 0x8000
    s_cbranch_scc1 EWQ
EWQK:
    s_sleep 4
    s_cmp_lt_u32 s46, 20
    s_cbranch_scc1 F1S
    s_mov_b32 s100, 3
    s_branch F1S
HOOKH:
    s_add_u32 s52, s62, 8192
    buffer_load_dwordx4 v[104:107], v52, s[16:19], s52 offen offset:0 sc1
    buffer_load_dwordx4 v[108:111], v52, s[16:19], s52 offen offset:3072 sc1
    buffer_load_dwordx2 v[112:113], v54, s[16:19], s52 offen sc1
    s_branch F1W
GCP:
    s_add_u32 s52, s62, 8192
    buffer_load_dwordx4 v[104:107], v52, s[16:19], s52 offen offset:0 sc1
    buffer_load_dwordx4 v[108:111], v52, s[16:19], s52 offen offset:3072 sc1
    buffer_load_dwordx2 v[112:113], v54, s[16:19], s52 offen sc1
    s_waitcnt vmcnt(0)
HOOKI:
    v_pk_add_f32 v[104:105], v[104:105], v[106:107]
    v_pk_add_f32 v[108:109], v[108:109], v[110:111]
    v_add_f32 v126, v104, v105
    v_add_f32 v127, v108, v109
    v_pk_add_f32 v[126:127], v[126:127], v[112:113]
    v_cmp_u_f32 vcc, v126, v127
    s_cbranch_vccz GCOK
    s_add_u32 s51, s51, 1
    s_cmp_lt_u32 s51, 0x8000
    s_cbranch_scc1 GCP
GCOK:
    ds_read_b64_tr_b16 v[80:81], v61 offset:0
    ds_read_b64_tr_b16 v[82:83], v61 offset:512
    ds_read_b64_tr_b16 v[84:85], v61 offset:4096
    ds_read_b64_tr_b16 v[86:87], v61 offset:4608
    ds_read_b64_tr_b16 v[88:89], v61 offset:8192
    ds_read_b64_tr_b16 v[90:91], v61 offset:8704
    ds_read_b64_tr_b16 v[92:93], v61 offset:12288
    ds_read_b64_tr_b16 v[94:95], v61 offset:12800
    ds_read_b64_tr_b16 v[96:97], v61 offset:16384
    ds_read_b64_tr_b16 v[98:99], v61 offset:16896
    ds_read_b64_tr_b16 v[100:101], v61 offset:20480
    ds_read_b64_tr_b16 v[102:103], v61 offset:20992
    s_branch W20
SLOW0:
    buffer_store_dword v30, v28, s[16:19], s49 offen sc1
    s_branch PUBD0
SLOW1:
    buffer_store_dword v16, v14, s[16:19], s62 offen offset:0 sc1
    buffer_store_dword v20, v14, s[16:19], s62 offen offset:1024 sc1
    buffer_store_dword v24, v14, s[16:19], s62 offen offset:2048 sc1
    s_mov_b64 exec, 1
    buffer_store_dwordx2 v[28:29], v15, s[16:19], s62 offen sc1
    s_branch PUBD1
SLOW2:
    buffer_store_dword v24, v14, s[16:19], s62 offen sc1
    s_branch PUBD2
SLOW3:
    buffer_store_dwordx2 v[32:33], v38, s[16:19], s52 offen offset:0 sc1
    buffer_store_dwordx2 v[34:35], v38, s[16:19], s52 offen offset:512 sc1
    buffer_store_dwordx2 v[36:37], v38, s[16:19], s52 offen offset:1024 sc1
    s_branch PUBD3
SLOW4:
    buffer_store_dwordx2 v[32:33], v38, s[16:19], s52 offen offset:0 sc1
    buffer_store_dwordx2 v[34:35], v38, s[16:19], s52 offen offset:512 sc1
    buffer_store_dwordx2 v[36:37], v38, s[16:19], s52 offen offset:1024 sc1
    s_branch PUBD4
SLOW5:
    buffer_store_dwordx4 v[36:39], v40, s[16:19], s63 offen sc1
    buffer_store_dword v36, v41, s[16:19], s63 offen sc1
    s_branch PUBD5
SLOW6:
    buffer_store_dword v41, v14, s[16:19], s53 offen sc1
    s_branch PUBD6
SLOW7:
    buffer_store_dword v16, v56, s[16:19], s49 offen sc1
    s_branch PUBD7
SLOW8:
    buffer_store_dword v40, v14, s[16:19], s62 offen sc1
    s_mov_b64 exec, 1
    buffer_store_dwordx2 v[44:45], v15, s[16:19], s62 offen sc1
    s_branch PUBD8
CODEEND:
    s_endpgm
.section .rodata,"a"
.p2align 6
.amdhsa_kernel interleave_layers__sliding_block_cached__glu_gated_swiglu__decode_kernel
  .amdhsa_next_free_vgpr 512
  .amdhsa_next_free_sgpr 102
  .amdhsa_accum_offset 256
  .amdhsa_group_segment_fixed_size 0
  .amdhsa_kernarg_size 96
  .amdhsa_user_sgpr_count 2
  .amdhsa_user_sgpr_kernarg_segment_ptr 1
  .amdhsa_system_sgpr_workgroup_id_x 1
.end_amdhsa_kernel
```

```asm
; @launch grid=(256,1,1) block=(256,1,1) lds=108288
.amdgcn_target "amdgcn-amd-amdhsa--gfx950"
.text
.globl interleave_layers__sliding_block_cached__glu_gated_swiglu__decode_kernel
.p2align 8
.type interleave_layers__sliding_block_cached__glu_gated_swiglu__decode_kernel,@function
interleave_layers__sliding_block_cached__glu_gated_swiglu__decode_kernel:
    s_cmp_ge_u32 s2, 256
    s_cbranch_scc1 DONE
    s_load_dwordx16 s[64:79], s[0:1], 0
    s_load_dwordx8 s[80:87], s[0:1], 64
    s_memrealtime s[98:99]
    s_getpc_b64 s[60:61]
PCREF:
    v_lshlrev_b32 v14, 7, v0
    v_cmp_gt_u32 vcc, CODEEND-PCREF, v14
    v_mov_b32 v15, s61
    s_and_saveexec_b64 s[88:89], vcc
    s_cbranch_execz NOPF
    v_add_co_u32 v14, vcc, s60, v14
    s_nop 1
    v_addc_co_u32 v15, vcc, 0, v15, vcc
    global_load_dword v79, v[14:15], off
NOPF:
    s_mov_b64 exec, s[88:89]
    v_and_b32 v1, 63, v0
    v_lshrrev_b32 v13, 6, v0
    s_and_b32 s45, s2, 7
    v_readfirstlane_b32 s44, v13
    s_lshr_b32 s46, s2, 3
    s_lshr_b32 s7, s46, 3
    s_lshl_b32 s52, s45, 2
    s_add_u32 s47, s7, s52
    s_and_b32 s48, s46, 7
    v_lshrrev_b32 v19, 4, v1
    v_bfe_u32 v21, v1, 1, 3
    v_and_b32 v20, 1, v1
    v_mul_u32_u24 v80, 384, v21
    v_lshl_add_u32 v80, v20, 4, v80
    v_lshl_add_u32 v80, v19, 5, v80
    s_mul_i32 s52, s48, 3
    s_lshl_b32 s54, s44, 0
    s_add_u32 s52, s52, s54
    s_add_u32 s53, s48, 384
    s_cmp_eq_u32 s44, 3
    s_cselect_b32 s52, s53, s52
    s_cselect_b32 s97, 8, 24
    s_mulk_i32 s97, 3072
    s_mul_i32 s55, s47, 12582912
    s_mul_i32 s54, s52, 3072
    s_add_u32 s55, s55, s54
    s_add_u32 s55, s55, 11010048
    s_mov_b32 s96, s55
    s_waitcnt lgkmcnt(0)
    s_mov_b32 s8, s66
    s_and_b32 s9, s67, 0xffff
    s_mov_b32 s10, 402653184
    s_mov_b32 s11, 0x20000
    s_mov_b32 s6, 1
    s_mov_b32 s100, 0
    s_cmp_eq_u32 s44, 3
    s_cbranch_scc1 SETUP
    buffer_load_dwordx4 a[0:3], v80, s[8:11], s96 offen offset:0 nt
    buffer_load_dwordx4 a[8:11], v80, s[8:11], s96 offen offset:128 nt
    buffer_load_dwordx4 a[16:19], v80, s[8:11], s96 offen offset:256 nt
    s_add_u32 s96, s96, s97
    buffer_load_dwordx4 a[4:7], v80, s[8:11], s96 offen offset:0 nt
    buffer_load_dwordx4 a[12:15], v80, s[8:11], s96 offen offset:128 nt
    buffer_load_dwordx4 a[20:23], v80, s[8:11], s96 offen offset:256 nt
    s_add_u32 s96, s96, s97
    buffer_load_dwordx4 a[24:27], v80, s[8:11], s96 offen offset:0 nt
    buffer_load_dwordx4 a[32:35], v80, s[8:11], s96 offen offset:128 nt
    buffer_load_dwordx4 a[40:43], v80, s[8:11], s96 offen offset:256 nt
    s_add_u32 s96, s96, s97
SETUP:
    s_mov_b32 s16, s86
    s_and_b32 s17, s87, 0xffff
    s_mov_b32 s18, 1610612736
    s_mov_b32 s19, 0x20000
    s_mov_b32 s12, s68
    s_and_b32 s13, s69, 0xffff
    s_mov_b32 s14, 402653184
    s_mov_b32 s15, 0x20000
    s_mov_b32 s20, s70
    s_and_b32 s21, s71, 0xffff
    s_mov_b32 s22, 7864320
    s_mov_b32 s23, 0x20000
    s_mov_b32 s32, s64
    s_and_b32 s33, s65, 0xffff
    s_mov_b32 s34, 1280
    s_mov_b32 s35, 0x20000
    s_mov_b32 s36, s82
    s_and_b32 s37, s83, 0xffff
    s_mov_b32 s38, 1280
    s_mov_b32 s39, 0x20000
    s_mov_b32 s40, s84
    s_and_b32 s41, s85, 0xffff
    s_mov_b32 s42, 256
    s_mov_b32 s43, 0x20000
    v_mov_b32 v87, 1879048192
    v_mov_b32 v88, 1879048192
    s_cmp_lg_u32 s44, 3
    s_cbranch_scc1 SETUP2
    v_mov_b32 v32, -1
    v_mov_b32 v33, -1
    v_mov_b32 v34, -1
    v_mov_b32 v35, -1
    s_cmp_lg_u32 s2, 0
    s_cbranch_scc1 NONW
    s_or_b32 s101, s98, 0x20
    s_and_b32 s101, s101, 0xffffffe0
    v_mov_b32 v24, s101
    v_mov_b32 v25, 0
    s_mov_b64 exec, 1
    buffer_store_dword v24, v25, s[40:43], 0 offen sc1
    s_mov_b64 exec, -1
NONW:
    v_lshlrev_b32 v24, 4, v1
    v_lshlrev_b32 v27, 2, v1
    s_mul_i32 s52, s2, 1536
    v_lshlrev_b32 v28, 3, v1
    buffer_store_dwordx4 v[32:35], v24, s[16:19], s52 offen sc1
    buffer_store_dwordx2 v[32:33], v28, s[16:19], s52 offen offset:1024 sc1
    v_mov_b32 v26, 1879048192
    v_mov_b32 v88, v24
    v_cmp_gt_u32 vcc, 40, v1
    v_lshlrev_b32 v27, 2, v1
    buffer_load_dwordx4 v[44:47], v24, s[32:35], 0 offen
    buffer_load_dword v48, v27, s[32:35], 0 offen offset:1024
    v_cndmask_b32 v28, v26, v27, vcc
    s_mul_i32 s52, s48, 160
    buffer_load_dword v86, v28, s[32:35], s52 offen
    s_mul_i32 s52, s48, 320
    s_add_u32 s52, s52, 131072
    s_and_b32 s53, s2, 0xc7
    s_cmp_eq_u32 s53, 0
    s_cselect_b32 s52, s52, 1879048192
    v_lshl_add_u32 v87, v1, 3, s52
    v_cndmask_b32 v87, v26, v87, vcc
    v_add_u32 v24, 0, v1
    v_mul_u32_u24 v36, 171, v24
    v_lshrrev_b32 v36, 12, v36
    v_mul_u32_u24 v37, 24, v36
    v_sub_u32 v37, v24, v37
    v_and_b32 v24, 2, v36
    v_xor_b32 v37, v37, v24
    v_mul_u32_u24 v36, 12288, v36
    v_lshl_add_u32 v38, v37, 4, v36
    v_add_u32 v24, 64, v1
    v_mul_u32_u24 v36, 171, v24
    v_lshrrev_b32 v36, 12, v36
    v_mul_u32_u24 v37, 24, v36
    v_sub_u32 v37, v24, v37
    v_and_b32 v24, 2, v36
    v_xor_b32 v37, v37, v24
    v_mul_u32_u24 v36, 12288, v36
    v_lshl_add_u32 v39, v37, 4, v36
    v_add_u32 v24, 128, v1
    v_mul_u32_u24 v36, 171, v24
    v_lshrrev_b32 v36, 12, v36
    v_mul_u32_u24 v37, 24, v36
    v_sub_u32 v37, v24, v37
    v_and_b32 v24, 2, v36
    v_xor_b32 v37, v37, v24
    v_mul_u32_u24 v36, 12288, v36
    v_lshl_add_u32 v40, v37, 4, v36
    s_mul_i32 s52, s48, 983040
    s_mul_i32 s54, s47, 384
    s_add_u32 s52, s52, s54
    s_mov_b32 s53, 65536
WQL:
    s_add_u32 m0, s53, 0
    s_nop 0
    buffer_load_dwordx4 v38, s[20:23], s52 offen nt lds
    v_xor_b32 v38, 64, v38
    s_add_u32 m0, s53, 1024
    s_nop 0
    buffer_load_dwordx4 v39, s[20:23], s52 offen nt lds
    v_xor_b32 v39, 64, v39
    s_add_u32 m0, s53, 2048
    s_nop 0
    buffer_load_dwordx4 v40, s[20:23], s52 offen nt lds
    v_xor_b32 v40, 64, v40
    s_add_u32 s52, s52, 98304
    s_add_u32 s53, s53, 3072
    s_cmp_lt_u32 s53, 96256
    s_cbranch_scc1 WQL
    v_mov_b32 v37, 0
    buffer_load_dword v89, v37, s[40:43], 0 offen sc1
    s_barrier
    s_waitcnt vmcnt(31)
    v_mov_b32 v36, 0x3f803f80
    v_mov_b32 v37, v36
    v_cndmask_b32 v36, 0, v36, vcc
    v_add_u32 v27, 96256, v27
    ds_write_b32 v27, v36 offset:1024
    ds_write_b32 v27, v37 offset:1280
    ds_write_b32 v27, v86
    v_mov_b64 v[36:37], 0
    ds_write_b32 v27, v36 offset:10752
    ds_write_b32 v27, v36 offset:11008
    v_mov_b32 v38, 0x3f803f80
    v_dot2_f32_bf16 v36, v44, v44, v36
    v_dot2_f32_bf16 v37, v44, v38, v37
    v_dot2_f32_bf16 v36, v45, v45, v36
    v_dot2_f32_bf16 v37, v45, v38, v37
    v_dot2_f32_bf16 v36, v46, v46, v36
    v_dot2_f32_bf16 v37, v46, v38, v37
    v_dot2_f32_bf16 v36, v47, v47, v36
    v_dot2_f32_bf16 v37, v47, v38, v37
    v_dot2_f32_bf16 v36, v48, v48, v36
    v_dot2_f32_bf16 v37, v48, v38, v37
    s_nop 2
    v_add_f32_dpp v36, v36, v36 quad_perm:[1,0,3,2] row_mask:0xf bank_mask:0xf
    v_add_f32_dpp v37, v37, v37 quad_perm:[1,0,3,2] row_mask:0xf bank_mask:0xf
    s_nop 0
    v_add_f32_dpp v36, v36, v36 quad_perm:[2,3,0,1] row_mask:0xf bank_mask:0xf
    v_add_f32_dpp v37, v37, v37 quad_perm:[2,3,0,1] row_mask:0xf bank_mask:0xf
    s_nop 0
    v_add_f32_dpp v36, v36, v36 row_half_mirror row_mask:0xf bank_mask:0xf
    v_add_f32_dpp v37, v37, v37 row_half_mirror row_mask:0xf bank_mask:0xf
    s_nop 0
    v_add_f32_dpp v36, v36, v36 row_mirror row_mask:0xf bank_mask:0xf
    v_add_f32_dpp v37, v37, v37 row_mirror row_mask:0xf bank_mask:0xf
    s_nop 0
    v_mov_b32 v39, v36
    s_nop 1
    v_permlane16_swap_b32 v36, v39
    v_add_f32 v36, v36, v39
    v_mov_b32 v39, v37
    s_nop 1
    v_permlane16_swap_b32 v37, v39
    v_add_f32 v37, v37, v39
    v_mov_b32 v39, v36
    s_nop 1
    v_permlane32_swap_b32 v36, v39
    v_add_f32 v36, v36, v39
    v_mov_b32 v39, v37
    s_nop 1
    v_permlane32_swap_b32 v37, v39
    v_add_f32 v37, v37, v39
    v_mov_b32 v39, 0x3727c5ac
    v_mul_f32 v37, 0x3acccccd, v37
    v_fmamk_f32 v36, v36, 0x3acccccd, v39
    v_fma_f32 v36, -v37, v37, v36
    v_rsq_f32 v36, v36
    v_mov_b32 v84, v37
    v_mul_f32 v85, 0x3dd53b94, v36
SETUP2:
    s_mov_b32 s32, s72
    s_and_b32 s33, s73, 0xffff
    s_mov_b32 s34, 7864320
    s_mov_b32 s35, 0x20000
    s_cmp_ge_u32 s46, 10
    s_cselect_b32 s56, 1, 0
    s_cmp_ge_u32 s46, 20
    s_cselect_b32 s52, 2, s56
    s_mul_i32 s52, s52, 10
    s_sub_u32 s57, s46, s52
    s_min_u32 s4, s46, 29
    s_cmp_ge_u32 s4, 15
    s_cselect_b32 s58, 1, 0
    s_mul_i32 s52, s58, 15
    s_sub_u32 s52, s4, s52
    s_mul_i32 s59, s52, 52
    s_lshr_b32 s59, s59, 8
    s_mul_i32 s53, s59, 5
    s_sub_u32 s3, s52, s53
    s_cmp_ge_u32 s46, 20
    s_cselect_b32 s24, s80, s72
    s_cselect_b32 s25, s81, s73
    s_mov_b32 s26, 7864320
    s_cselect_b32 s26, 1966080, s26
    s_and_b32 s25, s25, 0xffff
    s_mov_b32 s27, 0x20000
    s_cmp_eq_u32 s58, 1
    s_cselect_b32 s28, s78, s76
    s_cselect_b32 s29, s79, s77
    s_and_b32 s29, s29, 0xffff
    s_mov_b32 s30, 1966080
    s_mov_b32 s31, 0x20000
    s_mov_b32 s49, 0
    s_mul_i32 s63, s45, 45312
    s_add_u32 s63, s63, 529408
    s_mul_i32 s62, s45, 28160
    s_add_u32 s62, s62, 136192
    s_mov_b32 s50, 0
    s_mov_b32 s0, 0
    v_and_b32 v24, 15, v1
    v_cmp_eq_u32 vcc, 1, v24
    v_mov_b32 v25, 96256
    v_mov_b32 v26, 97280
    v_cndmask_b32 v2, v25, v26, vcc
    v_lshl_add_u32 v2, v19, 4, v2
    v_and_b32 v24, 3, v1
    v_lshlrev_b32 v24, 4, v24
    v_and_b32 v25, 1, v19
    v_lshl_add_u32 v24, v25, 6, v24
    v_add_u32 v24, 98304, v24
    v_bfe_u32 v25, v1, 2, 2
    v_lshrrev_b32 v27, 5, v1
    v_sub_u32 v25, v25, v27
    v_mov_b32 v26, 107008
    v_cmp_eq_u32 vcc, 0, v25
    s_nop 1
    v_cndmask_b32 v3, v26, v24, vcc
    v_cmp_eq_u32 vcc, 2, v25
    s_nop 1
    v_cndmask_b32 v4, v26, v24, vcc
    v_and_b32 v24, 3, v1
    v_cmp_eq_u32 vcc, 3, v24
    v_mov_b32 v25, 0xffff
    v_mov_b32 v26, 0xffff0000
    v_cndmask_b32 v25, v25, v26, vcc
    v_cndmask_b32 v24, v24, 0, vcc
    v_or_b32 v24, 12, v24
    v_mul_u32_u24 v24, 0x1111, v24
    v_mul_u32_u24 v26, 0xaaaa, v20
    v_add_u32 v26, 0x4444, v26
    v_lshl_add_u32 v7, v24, 16, v26
    v_and_b32 v24, 4, v1
    v_cmp_eq_u32 vcc, 0, v24
    s_nop 1
    v_cndmask_b32 v5, 0, v25, vcc
    v_cndmask_b32 v6, v25, 0, vcc
    v_mul_u32_u24 v82, s97, v27
    v_bfe_u32 v24, v1, 3, 1
    v_mul_u32_u24 v24, 1536, v24
    v_add_u32 v82, v82, v24
    v_and_b32 v24, 1, v19
    v_mul_u32_u24 v24, 768, v24
    v_add_u32 v82, v82, v24
    v_and_b32 v24, 7, v1
    v_lshl_add_u32 v82, v24, 4, v82
    s_mul_i32 s52, s7, 6144
    s_add_u32 s52, s52, 20480
    v_lshl_add_u32 v8, v0, 4, s52
    s_lshl_b32 s52, s7, 6
    s_add_u32 s52, s52, 45056
    v_lshl_add_u32 v9, v24, 3, s52
    v_and_b32 v10, 0xe1, v0
    v_lshlrev_b32 v10, 1, v10
    v_bfe_u32 v24, v0, 4, 1
    v_lshl_add_u32 v10, v24, 3, v10
    v_bfe_u32 v24, v0, 3, 1
    v_lshl_add_u32 v10, v24, 5, v10
    v_bfe_u32 v24, v0, 2, 1
    v_lshl_add_u32 v10, v24, 2, v10
    v_bfe_u32 v24, v0, 1, 1
    v_lshl_add_u32 v10, v24, 4, v10
    v_add_u32 v10, 98304, v10
    v_mov_b32 v11, 0x3727c5ac
    v_mov_b32 v12, 98752
    s_cmp_lg_u32 s44, 3
    s_cbranch_scc1 KBAR
    s_lshr_b32 s53, s2, 4
    s_and_b32 s51, s2, 15
    s_lshl_b32 s52, s53, 14
    s_lshl_b32 s54, s51, 9
    s_add_u32 s52, s52, s54
    s_add_u32 s52, s52, 1835008
    s_and_b32 s53, s46, 1
    s_lshl_b32 s53, s53, 13
    s_add_u32 s52, s52, s53
    s_xor_b32 s53, s52, 8192
    s_memtime s[88:89]
    s_waitcnt lgkmcnt(0)
    s_buffer_load_dword s1, s[16:19], s52
    s_waitcnt lgkmcnt(0)
    s_memtime s[90:91]
    s_waitcnt lgkmcnt(0)
    s_buffer_load_dword s1, s[16:19], s53
    s_waitcnt lgkmcnt(0)
    s_memtime s[92:93]
    s_waitcnt lgkmcnt(0)
    s_sub_u32 s88, s90, s88
    s_sub_u32 s90, s92, s90
    s_cmp_lt_u32 s90, s88
    s_cselect_b32 s1, 1, 0
    s_xor_b32 s1, s1, s46
    s_getreg_b32 s52, hwreg(HW_REG_XCC_ID)
    s_lshr_b32 s52, s52, 2
    s_xor_b32 s1, s1, s52
    s_and_b32 s1, s1, 1
    s_lshl_b32 s1, s1, 4
    s_mov_b32 s51, 0
    v_mov_b32 v37, 0
NOP:
    s_waitcnt vmcnt(0)
    v_readfirstlane_b32 s5, v89
    s_cmp_lg_u32 s5, 0
    s_cbranch_scc1 NOOK
    buffer_load_dword v89, v37, s[40:43], 0 offen sc1
    s_add_u32 s51, s51, 1
    s_sleep 4
    s_cmp_lt_u32 s51, 0x8000
    s_cbranch_scc1 NOP
NOOK:
    s_getreg_b32 s52, hwreg(HW_REG_XCC_ID)
    s_and_b32 s52, s52, 15
    s_or_b32 s5, s5, s52
    s_or_b32 s1, s1, s5
    v_mov_b32 v36, s1
    s_lshl_b32 s52, s45, 7
    s_lshl_b32 s54, s46, 2
    s_add_u32 s52, s52, s54
    s_add_u32 s52, s52, 1376256
    s_mov_b64 exec, 1
    buffer_store_dword v36, v37, s[16:19], s52 offen sc1
    s_mov_b64 exec, -1
    s_mov_b32 s44, 0
    s_branch LOOP
KBAR:
    s_barrier
    s_waitcnt vmcnt(8)
    buffer_load_dwordx4 a[28:31], v80, s[8:11], s96 offen offset:0 nt
    s_waitcnt vmcnt(8)
    buffer_load_dwordx4 a[36:39], v80, s[8:11], s96 offen offset:128 nt
    s_waitcnt vmcnt(8)
    buffer_load_dwordx4 a[44:47], v80, s[8:11], s96 offen offset:256 nt
    s_add_u32 s96, s96, s97
    s_waitcnt vmcnt(8)
    buffer_load_dwordx4 a[48:51], v80, s[8:11], s96 offen offset:0 nt
    s_waitcnt vmcnt(8)
    buffer_load_dwordx4 a[56:59], v80, s[8:11], s96 offen offset:128 nt
    s_waitcnt vmcnt(8)
    buffer_load_dwordx4 a[64:67], v80, s[8:11], s96 offen offset:256 nt
    s_add_u32 s96, s96, s97
    s_waitcnt vmcnt(8)
    buffer_load_dwordx4 a[52:55], v80, s[8:11], s96 offen offset:0 nt
    s_waitcnt vmcnt(8)
    buffer_load_dwordx4 a[60:63], v80, s[8:11], s96 offen offset:128 nt
    s_waitcnt vmcnt(8)
    buffer_load_dwordx4 a[68:71], v80, s[8:11], s96 offen offset:256 nt
    s_add_u32 s96, s96, s97
    s_waitcnt vmcnt(8)
    buffer_load_dwordx4 a[72:75], v80, s[8:11], s96 offen offset:0 nt
    s_waitcnt vmcnt(8)
    buffer_load_dwordx4 a[80:83], v80, s[8:11], s96 offen offset:128 nt
    s_waitcnt vmcnt(8)
    buffer_load_dwordx4 a[88:91], v80, s[8:11], s96 offen offset:256 nt
    s_add_u32 s96, s96, s97
    s_waitcnt vmcnt(8)
    buffer_load_dwordx4 a[76:79], v80, s[8:11], s96 offen offset:0 nt
    s_waitcnt vmcnt(8)
    buffer_load_dwordx4 a[84:87], v80, s[8:11], s96 offen offset:128 nt
    s_waitcnt vmcnt(8)
    buffer_load_dwordx4 a[92:95], v80, s[8:11], s96 offen offset:256 nt
    s_add_u32 s96, s96, s97
    s_waitcnt vmcnt(8)
    buffer_load_dwordx4 a[96:99], v80, s[8:11], s96 offen offset:0 nt
    s_waitcnt vmcnt(8)
    buffer_load_dwordx4 a[104:107], v80, s[8:11], s96 offen offset:128 nt
    s_waitcnt vmcnt(8)
    buffer_load_dwordx4 a[112:115], v80, s[8:11], s96 offen offset:256 nt
    s_add_u32 s96, s96, s97
    s_waitcnt vmcnt(8)
    buffer_load_dwordx4 a[100:103], v80, s[8:11], s96 offen offset:0 nt
    s_waitcnt vmcnt(8)
    buffer_load_dwordx4 a[108:111], v80, s[8:11], s96 offen offset:128 nt
    s_waitcnt vmcnt(8)
    buffer_load_dwordx4 a[116:119], v80, s[8:11], s96 offen offset:256 nt
    s_add_u32 s96, s96, s97
    s_waitcnt vmcnt(8)
    buffer_load_dwordx4 a[120:123], v80, s[8:11], s96 offen offset:0 nt
    s_waitcnt vmcnt(8)
    buffer_load_dwordx4 a[128:131], v80, s[8:11], s96 offen offset:128 nt
    s_waitcnt vmcnt(8)
    buffer_load_dwordx4 a[136:139], v80, s[8:11], s96 offen offset:256 nt
    s_add_u32 s96, s96, s97
    s_waitcnt vmcnt(8)
    buffer_load_dwordx4 a[124:127], v80, s[8:11], s96 offen offset:0 nt
    s_waitcnt vmcnt(8)
    buffer_load_dwordx4 a[132:135], v80, s[8:11], s96 offen offset:128 nt
    s_waitcnt vmcnt(8)
    buffer_load_dwordx4 a[140:143], v80, s[8:11], s96 offen offset:256 nt
    s_add_u32 s96, s96, s97
    s_waitcnt vmcnt(8)
    buffer_load_dwordx4 a[144:147], v80, s[8:11], s96 offen offset:0 nt
    s_waitcnt vmcnt(8)
    buffer_load_dwordx4 a[152:155], v80, s[8:11], s96 offen offset:128 nt
    s_waitcnt vmcnt(8)
    buffer_load_dwordx4 a[160:163], v80, s[8:11], s96 offen offset:256 nt
    s_add_u32 s96, s96, s97
    s_waitcnt vmcnt(8)
    buffer_load_dwordx4 a[148:151], v80, s[8:11], s96 offen offset:0 nt
    s_waitcnt vmcnt(8)
    buffer_load_dwordx4 a[156:159], v80, s[8:11], s96 offen offset:128 nt
    s_waitcnt vmcnt(8)
    buffer_load_dwordx4 a[164:167], v80, s[8:11], s96 offen offset:256 nt
    s_add_u32 s96, s96, s97
    s_waitcnt vmcnt(8)
    buffer_load_dwordx4 a[168:171], v80, s[8:11], s96 offen offset:0 nt
    s_waitcnt vmcnt(8)
    buffer_load_dwordx4 a[176:179], v80, s[8:11], s96 offen offset:128 nt
    s_waitcnt vmcnt(8)
    buffer_load_dwordx4 a[184:187], v80, s[8:11], s96 offen offset:256 nt
    s_add_u32 s96, s96, s97
    s_waitcnt vmcnt(8)
    buffer_load_dwordx4 a[172:175], v80, s[8:11], s96 offen offset:0 nt
    s_waitcnt vmcnt(8)
    buffer_load_dwordx4 a[180:183], v80, s[8:11], s96 offen offset:128 nt
    s_waitcnt vmcnt(8)
    buffer_load_dwordx4 a[188:191], v80, s[8:11], s96 offen offset:256 nt
    s_lshl_b32 s97, s97, 1
    s_waitcnt vmcnt(8)
    buffer_load_dwordx4 a[192:195], v82, s[12:15], s55 offen offset:0 nt
    s_waitcnt vmcnt(8)
    buffer_load_dwordx4 a[200:203], v82, s[12:15], s55 offen offset:128 nt
    s_waitcnt vmcnt(8)
    buffer_load_dwordx4 a[208:211], v82, s[12:15], s55 offen offset:256 nt
    s_waitcnt vmcnt(8)
    buffer_load_dwordx4 a[216:219], v82, s[12:15], s55 offen offset:384 nt
    s_waitcnt vmcnt(8)
    buffer_load_dwordx4 a[224:227], v82, s[12:15], s55 offen offset:512 nt
    s_waitcnt vmcnt(8)
    buffer_load_dwordx4 a[232:235], v82, s[12:15], s55 offen offset:640 nt
    s_add_u32 s55, s55, s97
    s_waitcnt vmcnt(8)
    buffer_load_dwordx4 a[196:199], v82, s[12:15], s55 offen offset:0 nt
    s_waitcnt vmcnt(8)
    buffer_load_dwordx4 a[204:207], v82, s[12:15], s55 offen offset:128 nt
    s_waitcnt vmcnt(8)
    buffer_load_dwordx4 a[212:215], v82, s[12:15], s55 offen offset:256 nt
    s_waitcnt vmcnt(8)
    buffer_load_dwordx4 a[220:223], v82, s[12:15], s55 offen offset:384 nt
    s_waitcnt vmcnt(8)
    buffer_load_dwordx4 a[228:231], v82, s[12:15], s55 offen offset:512 nt
    s_waitcnt vmcnt(8)
    buffer_load_dwordx4 a[236:239], v82, s[12:15], s55 offen offset:640 nt
    s_add_u32 s55, s55, s97
    s_waitcnt vmcnt(8)
    buffer_load_dwordx4 a[240:243], v82, s[12:15], s55 offen offset:0 nt
    s_waitcnt vmcnt(8)
    buffer_load_dwordx4 a[248:251], v82, s[12:15], s55 offen offset:128 nt
    s_waitcnt vmcnt(8)
    buffer_load_dwordx4 v[128:131], v82, s[12:15], s55 offen offset:256 nt
    s_waitcnt vmcnt(8)
    buffer_load_dwordx4 v[136:139], v82, s[12:15], s55 offen offset:384 nt
    s_waitcnt vmcnt(8)
    buffer_load_dwordx4 v[144:147], v82, s[12:15], s55 offen offset:512 nt
    s_waitcnt vmcnt(8)
    buffer_load_dwordx4 v[152:155], v82, s[12:15], s55 offen offset:640 nt
    s_add_u32 s55, s55, s97
    s_waitcnt vmcnt(8)
    buffer_load_dwordx4 a[244:247], v82, s[12:15], s55 offen offset:0 nt
    s_waitcnt vmcnt(8)
    buffer_load_dwordx4 a[252:255], v82, s[12:15], s55 offen offset:128 nt
    s_waitcnt vmcnt(8)
    buffer_load_dwordx4 v[132:135], v82, s[12:15], s55 offen offset:256 nt
    s_waitcnt vmcnt(8)
    buffer_load_dwordx4 v[140:143], v82, s[12:15], s55 offen offset:384 nt
    s_waitcnt vmcnt(8)
    buffer_load_dwordx4 v[148:151], v82, s[12:15], s55 offen offset:512 nt
    s_waitcnt vmcnt(8)
    buffer_load_dwordx4 v[156:159], v82, s[12:15], s55 offen offset:640 nt
    s_add_u32 s55, s55, s97
    s_waitcnt vmcnt(8)
    buffer_load_dwordx4 v[160:163], v82, s[12:15], s55 offen offset:0 nt
    s_waitcnt vmcnt(8)
    buffer_load_dwordx4 v[168:171], v82, s[12:15], s55 offen offset:128 nt
    s_waitcnt vmcnt(8)
    buffer_load_dwordx4 v[176:179], v82, s[12:15], s55 offen offset:256 nt
    s_waitcnt vmcnt(8)
    buffer_load_dwordx4 v[184:187], v82, s[12:15], s55 offen offset:384 nt
    s_waitcnt vmcnt(8)
    buffer_load_dwordx4 v[192:195], v82, s[12:15], s55 offen offset:512 nt
    s_waitcnt vmcnt(8)
    buffer_load_dwordx4 v[200:203], v82, s[12:15], s55 offen offset:640 nt
    s_add_u32 s55, s55, s97
    s_waitcnt vmcnt(8)
    buffer_load_dwordx4 v[164:167], v82, s[12:15], s55 offen offset:0 nt
    s_waitcnt vmcnt(8)
    buffer_load_dwordx4 v[172:175], v82, s[12:15], s55 offen offset:128 nt
    s_waitcnt vmcnt(8)
    buffer_load_dwordx4 v[180:183], v82, s[12:15], s55 offen offset:256 nt
    s_waitcnt vmcnt(8)
    buffer_load_dwordx4 v[188:191], v82, s[12:15], s55 offen offset:384 nt
    s_waitcnt vmcnt(8)
    buffer_load_dwordx4 v[196:199], v82, s[12:15], s55 offen offset:512 nt
    s_waitcnt vmcnt(8)
    buffer_load_dwordx4 v[204:207], v82, s[12:15], s55 offen offset:640 nt
    s_add_u32 s55, s55, s97
    s_waitcnt vmcnt(8)
    buffer_load_dwordx4 v[208:211], v82, s[12:15], s55 offen offset:0 nt
    s_waitcnt vmcnt(8)
    buffer_load_dwordx4 v[216:219], v82, s[12:15], s55 offen offset:128 nt
    s_waitcnt vmcnt(8)
    buffer_load_dwordx4 v[224:227], v82, s[12:15], s55 offen offset:256 nt
    s_waitcnt vmcnt(8)
    buffer_load_dwordx4 v[232:235], v82, s[12:15], s55 offen offset:384 nt
    s_waitcnt vmcnt(8)
    buffer_load_dwordx4 v[240:243], v82, s[12:15], s55 offen offset:512 nt
    s_waitcnt vmcnt(8)
    buffer_load_dwordx4 v[248:251], v82, s[12:15], s55 offen offset:640 nt
    s_add_u32 s55, s55, s97
    s_waitcnt vmcnt(8)
    buffer_load_dwordx4 v[212:215], v82, s[12:15], s55 offen offset:0 nt
    s_waitcnt vmcnt(8)
    buffer_load_dwordx4 v[220:223], v82, s[12:15], s55 offen offset:128 nt
    s_waitcnt vmcnt(8)
    buffer_load_dwordx4 v[228:231], v82, s[12:15], s55 offen offset:256 nt
    s_barrier
    s_waitcnt vmcnt(8)
    buffer_load_dwordx4 v[236:239], v82, s[12:15], s55 offen offset:384 nt
    s_waitcnt vmcnt(8)
    buffer_load_dwordx4 v[244:247], v82, s[12:15], s55 offen offset:512 nt
    s_waitcnt vmcnt(8)
    buffer_load_dwordx4 v[252:255], v82, s[12:15], s55 offen offset:640 nt
    s_branch ENTRY
LOOP:
    v_and_b32 v16, 3, v1
    v_lshrrev_b32 v17, 4, v1
    v_bfe_u32 v18, v1, 2, 2
    v_lshlrev_b32 v16, 3, v16
    v_mul_u32_u24 v18, 384, v18
    v_add_u32 v16, v16, v18
    v_bfe_u32 v18, v1, 3, 2
    v_xor_b32 v18, s44, v18
    v_lshl_add_u32 v16, v18, 5, v16
    v_add_u32 v16, 65536, v16
    v_and_b32 v18, 1, v17
    v_mul_u32_u24 v17, 3072, v17
    v_mul_u32_u24 v18, 3072, v18
    v_add_u32 v17, v17, v16
    v_add_u32 v18, v18, v16
    ds_read_b64_tr_b16 v[44:45], v17 offset:0
    ds_read_b64_tr_b16 v[46:47], v17 offset:1536
    ds_read_b64_tr_b16 v[56:57], v17 offset:128
    ds_read_b64_tr_b16 v[58:59], v17 offset:1664
    ds_read_b64_tr_b16 v[68:69], v17 offset:256
    ds_read_b64_tr_b16 v[70:71], v17 offset:1792
    ds_read_b64_tr_b16 v[48:49], v17 offset:12288
    ds_read_b64_tr_b16 v[50:51], v17 offset:13824
    ds_read_b64_tr_b16 v[60:61], v17 offset:12416
    ds_read_b64_tr_b16 v[62:63], v17 offset:13952
    ds_read_b64_tr_b16 v[72:73], v17 offset:12544
    ds_read_b64_tr_b16 v[74:75], v17 offset:14080
    ds_read_b64_tr_b16 v[52:53], v18 offset:24576
    ds_read_b64_tr_b16 v[54:55], v18 offset:26112
    ds_read_b64_tr_b16 v[64:65], v18 offset:24704
    ds_read_b64_tr_b16 v[66:67], v18 offset:26240
    ds_read_b64_tr_b16 v[76:77], v18 offset:24832
    ds_read_b64_tr_b16 v[78:79], v18 offset:26368
    s_cmp_lg_u32 s6, 0
    s_cbranch_scc1 QA0
    v_and_b32 v29, 31, v1
    v_lshl_add_u32 v29, s44, 5, v29
    s_cmp_eq_u32 s44, 3
    s_cbranch_scc1 Y2N
    v_min_u32 v20, 79, v29
    s_mul_i32 s52, s48, 80
    v_add_u32 v20, s52, v20
    v_lshrrev_b32 v26, 5, v20
    v_lshlrev_b32 v26, 10, v26
    v_lshrrev_b32 v21, 8, v20
    v_lshl_add_u32 v26, v21, 13, v26
    v_and_b32 v20, 31, v20
    v_lshl_add_u32 v26, v20, 2, v26
    v_lshrrev_b32 v20, 5, v1
    v_lshl_add_u32 v26, v20, 9, v26
    s_add_u32 s52, s0, 81920
    v_add_u32 v26, s52, v26
    s_sub_u32 s52, s46, 20
    s_cmp_ge_u32 s52, 10
    s_cbranch_scc1 HOOKL
    v_lshlrev_b32 v27, 3, v0
    s_mul_i32 s52, s47, 12288
    s_add_u32 s52, s52, 1441792
    s_add_u32 s53, s52, 0
    buffer_load_dwordx2 v[32:33], v27, s[16:19], s53 offen offset:0 sc1
    buffer_load_dwordx2 v[34:35], v27, s[16:19], s53 offen offset:1536 sc1
    s_add_u32 s53, s52, 3072
    buffer_load_dwordx2 v[36:37], v27, s[16:19], s53 offen offset:0 sc1
    buffer_load_dwordx2 v[38:39], v27, s[16:19], s53 offen offset:1536 sc1
    s_add_u32 s53, s52, 6144
    buffer_load_dwordx2 v[40:41], v27, s[16:19], s53 offen offset:0 sc1
    buffer_load_dwordx2 v[42:43], v27, s[16:19], s53 offen offset:1536 sc1
    s_add_u32 s53, s52, 9216
    buffer_load_dwordx2 v[16:17], v27, s[16:19], s53 offen offset:0 sc1
    buffer_load_dwordx2 v[20:21], v27, s[16:19], s53 offen offset:1536 sc1
    s_sleep 3
GYB:
    buffer_load_dword v22, v26, s[16:19], s49 offen offset:0 sc1
    buffer_load_dword v23, v26, s[16:19], s49 offen offset:128 sc1
    buffer_load_dword v24, v26, s[16:19], s49 offen offset:256 sc1
    buffer_load_dword v25, v26, s[16:19], s49 offen offset:384 sc1
Y2N:
    s_lshr_b32 s53, s48, 2
    s_mul_i32 s52, s7, 6144
    s_lshl_b32 s54, s44, 8
    s_add_u32 s52, s52, s54
    s_mul_i32 s54, s53, 3056
    s_add_u32 s52, s52, s54
    s_lshl_b32 s54, s48, 2
    s_add_u32 s52, s52, s54
    s_add_u32 s52, s52, 20480
    v_lshl_add_u32 v14, v1, 4, s52
    s_lshl_b32 s52, s7, 6
    s_lshl_b32 s54, s48, 3
    s_add_u32 s52, s52, s54
    s_add_u32 s52, s52, 45056
    v_mov_b32 v15, s52
    s_mul_i32 s52, s48, 320
    s_add_u32 s52, s52, 131072
    s_and_b32 s53, s2, 0xc7
    s_cmp_eq_u32 s53, 0
    s_cselect_b32 s52, s52, 1879048192
    v_lshl_add_u32 v28, v29, 2, s52
    v_lshlrev_b32 v19, 1, v29
    v_add_u32 v19, 96256, v19
    v_cmp_gt_u32 vcc, 80, v29
    s_mov_b64 s[60:61], vcc
    s_mov_b32 s51, 0
    s_cmp_eq_u32 s44, 3
    s_cbranch_scc1 Y2OK
    s_cmp_lg_u32 s49, 0
    s_cbranch_scc1 Y2W
    s_waitcnt vmcnt(4)
QCP:
    v_bitop3_b32 v33, v32, v33, s101 bitop3:0x96
    v_bitop3_b32 v35, v34, v35, s101 bitop3:0x96
    v_bitop3_b32 v37, v36, v37, s101 bitop3:0x96
    v_bitop3_b32 v39, v38, v39, s101 bitop3:0x96
    v_bitop3_b32 v41, v40, v41, s101 bitop3:0x96
    v_bitop3_b32 v43, v42, v43, s101 bitop3:0x96
    v_bitop3_b32 v17, v16, v17, s101 bitop3:0x96
    v_bitop3_b32 v21, v20, v21, s101 bitop3:0x96
    v_add_f32 v13, v32, v34
    v_add_f32 v13, v13, v36
    v_add_f32 v13, v13, v38
    v_add_f32 v13, v13, v40
    v_add_f32 v13, v13, v42
    v_add_f32 v13, v13, v16
    v_add_f32 v13, v13, v20
    v_or3_b32 v33, v33, v35, v37
    v_or3_b32 v33, v33, v39, v41
    v_or3_b32 v33, v33, v43, v17
    v_or_b32 v33, v33, v21
    v_cmp_ne_u32 vcc, 0, v33
    s_cbranch_vccz Y2W
    v_lshlrev_b32 v27, 3, v0
    s_mul_i32 s52, s47, 12288
    s_add_u32 s52, s52, 1441792
    s_add_u32 s53, s52, 0
    buffer_load_dwordx2 v[32:33], v27, s[16:19], s53 offen offset:0 sc1
    buffer_load_dwordx2 v[34:35], v27, s[16:19], s53 offen offset:1536 sc1
    s_add_u32 s53, s52, 3072
    buffer_load_dwordx2 v[36:37], v27, s[16:19], s53 offen offset:0 sc1
    buffer_load_dwordx2 v[38:39], v27, s[16:19], s53 offen offset:1536 sc1
    s_add_u32 s53, s52, 6144
    buffer_load_dwordx2 v[40:41], v27, s[16:19], s53 offen offset:0 sc1
    buffer_load_dwordx2 v[42:43], v27, s[16:19], s53 offen offset:1536 sc1
    s_add_u32 s53, s52, 9216
    buffer_load_dwordx2 v[16:17], v27, s[16:19], s53 offen offset:0 sc1
    buffer_load_dwordx2 v[20:21], v27, s[16:19], s53 offen offset:1536 sc1
    s_waitcnt vmcnt(0)
    s_add_u32 s51, s51, 1
    s_sleep 2
    s_cmp_lt_u32 s51, 0x8000
    s_cbranch_scc1 QCP
    s_branch Y2W
Y2P:
    buffer_load_dword v22, v26, s[16:19], s49 offen offset:0 sc1
    buffer_load_dword v23, v26, s[16:19], s49 offen offset:128 sc1
    buffer_load_dword v24, v26, s[16:19], s49 offen offset:256 sc1
    buffer_load_dword v25, v26, s[16:19], s49 offen offset:384 sc1
Y2W:
    s_waitcnt vmcnt(0)
    v_pk_add_f32 v[22:23], v[22:23], v[24:25]
    v_add_f32 v30, v22, v23
    v_mov_b32 v31, v30
    s_nop 1
    v_permlane32_swap_b32 v30, v31
    v_add_f32 v30, v30, v31
    v_cmp_u_f32 vcc, v30, v30
    s_cbranch_vccz Y2OK
    s_add_u32 s51, s51, 1
    s_sleep 1
    s_cmp_lt_u32 s51, 0x8000
    s_cbranch_scc1 Y2P
Y2OK:
    s_cmp_lg_u32 s49, 0
    s_cbranch_scc1 FINAL
    s_mov_b32 s49, 393216
    s_mov_b32 s62, s63
    s_cmp_eq_u32 s44, 3
    s_cbranch_scc1 QX
    v_cvt_pk_bf16_f32 v30, v30, v30
    v_cndmask_b32 v30, 0, v30, s[60:61]
    ds_write_b16 v19, v30
    v_and_b32 v30, 0xffff0000, v30
    s_mov_b32 exec_lo, s60
    s_mov_b32 exec_hi, 0
    s_cmp_eq_u32 s50, 0
    s_cbranch_scc1 SLOW0
    buffer_store_dword v30, v28, s[16:19], s49 offen
PUBD0:
    s_mov_b64 exec, -1
QX:
    s_waitcnt lgkmcnt(0)
    s_barrier
QA0:
    ds_read_b128 v[32:35], v2 offset:0
    ds_read_b128 v[36:39], v2 offset:64
    ds_read_b128 v[40:43], v2 offset:128
    s_waitcnt lgkmcnt(2)
    v_mfma_f32_16x16x32_bf16 v[28:31], v[32:35], v[32:35], 0
    v_mfma_f32_16x16x32_bf16 v[16:19], v[32:35], v[44:47], 0
    v_mfma_f32_16x16x32_bf16 v[20:23], v[32:35], v[56:59], 0
    v_mfma_f32_16x16x32_bf16 v[24:27], v[32:35], v[68:71], 0
    s_waitcnt lgkmcnt(1)
    v_mfma_f32_16x16x32_bf16 v[28:31], v[36:39], v[36:39], v[28:31]
    v_mfma_f32_16x16x32_bf16 v[16:19], v[36:39], v[48:51], v[16:19]
    v_mfma_f32_16x16x32_bf16 v[20:23], v[36:39], v[60:63], v[20:23]
    v_mfma_f32_16x16x32_bf16 v[24:27], v[36:39], v[72:75], v[24:27]
    s_waitcnt lgkmcnt(0)
    v_mfma_f32_16x16x32_bf16 v[16:19], v[40:43], v[52:55], v[16:19]
    v_mfma_f32_16x16x32_bf16 v[20:23], v[40:43], v[64:67], v[20:23]
    v_mfma_f32_16x16x32_bf16 v[24:27], v[40:43], v[76:79], v[24:27]
    v_mfma_f32_16x16x32_bf16 v[28:31], v[40:43], v[40:43], v[28:31]
    s_mov_b64 exec, 0xffff
    s_cmp_lg_u32 s6, 0
    s_cbranch_scc1 HOOKA
    s_cmp_eq_u32 s50, 0
    s_cbranch_scc1 SLOW1
    buffer_store_dword v16, v14, s[16:19], s62 offen offset:0
    buffer_store_dword v20, v14, s[16:19], s62 offen offset:1024
    buffer_store_dword v24, v14, s[16:19], s62 offen offset:2048
    s_mov_b64 exec, 1
    buffer_store_dwordx2 v[28:29], v15, s[16:19], s62 offen
PUBD1:
    s_mov_b64 exec, -1
ENTRY:
    s_mov_b32 s51, 0
    v_mov_b64 v[64:65], 0
    v_mov_b64 v[66:67], 0
    v_mov_b64 v[68:69], 0
    v_mov_b64 v[70:71], 0
    v_mov_b64 v[72:73], 0
    v_mov_b64 v[74:75], 0
    v_mov_b64 v[76:77], 0
    v_mov_b64 v[78:79], 0
    s_cmp_eq_u32 s49, 0
    s_cselect_b32 s53, 3, s44
    s_cmp_eq_u32 s53, 3
    s_cbranch_scc1 EN0
    s_nop 15
    buffer_load_dwordx2 v[62:63], v9, s[16:19], s62 offen sc1
    buffer_load_dwordx4 v[44:47], v8, s[16:19], s62 offen offset:0 sc1
    buffer_load_dwordx4 v[48:51], v8, s[16:19], s62 offen offset:3072 sc1
EN0:
    v_lshrrev_b32 v14, 2, v1
    v_lshlrev_b32 v14, 7, v14
    v_and_b32 v15, 3, v1
    v_lshl_add_u32 v14, v15, 2, v14
    s_mul_i32 s52, s7, 3072
    s_mul_i32 s54, s44, 768
    s_add_u32 s52, s52, s54
    s_lshl_b32 s54, s48, 4
    s_add_u32 s52, s52, s54
    v_add_u32 v14, s52, v14
    s_lshl_b32 s52, s7, 5
    s_lshl_b32 s54, s48, 2
    s_add_u32 s52, s52, s54
    s_add_u32 s52, s52, 19968
    v_writelane_b32 v14, s52, 24
    v_and_b32 v15, 7, v1
    v_lshlrev_b32 v15, 5, v15
    v_bfe_u32 v61, v1, 4, 1
    v_lshl_add_u32 v15, v61, 4, v15
    v_lshrrev_b32 v61, 5, v1
    v_mul_u32_u24 v61, 768, v61
    v_add_u32 v15, v15, v61
    s_mul_i32 s52, s44, 1536
    s_add_u32 s52, s52, 98816
    v_add_u32 v15, s52, v15
    s_mul_i32 s52, s44, 192
    s_add_u32 s52, s52, 98816
    v_min_u32 v60, 23, v1
    v_lshl_add_u32 v60, v60, 3, s52
    s_lshl_b32 s52, s44, 3
    s_add_u32 s52, s52, 98752
    v_mov_b32 v61, s52
    s_cmp_eq_u32 s49, 0
    s_cbranch_scc1 HOOKE
    s_cmp_eq_u32 s53, 3
    s_cbranch_scc1 ENOK2
    s_nop 5
ENP:
    buffer_load_dwordx2 v[62:63], v9, s[16:19], s62 offen sc1
    buffer_load_dwordx4 v[44:47], v8, s[16:19], s62 offen offset:0 sc1
    buffer_load_dwordx4 v[48:51], v8, s[16:19], s62 offen offset:3072 sc1
    s_waitcnt vmcnt(3)
    v_add_f32_dpp v32, v62, v62 quad_perm:[1,0,3,2] row_mask:0xf bank_mask:0xf
    v_add_f32_dpp v33, v63, v63 quad_perm:[1,0,3,2] row_mask:0xf bank_mask:0xf
    v_pk_add_f32 v[16:17], v[44:45], v[46:47]
    v_add_f32_dpp v32, v32, v32 quad_perm:[2,3,0,1] row_mask:0xf bank_mask:0xf
    v_add_f32_dpp v33, v33, v33 quad_perm:[2,3,0,1] row_mask:0xf bank_mask:0xf
    v_pk_add_f32 v[20:21], v[48:49], v[50:51]
    v_add_f32_dpp v32, v32, v32 row_half_mirror row_mask:0xf bank_mask:0xf
    v_add_f32_dpp v33, v33, v33 row_half_mirror row_mask:0xf bank_mask:0xf
    v_pk_add_f32 v[16:17], v[16:17], v[20:21]
    v_mul_f32 v33, 0x3acccccd, v33
    v_fmamk_f32 v32, v32, 0x3acccccd, v11
    v_fma_f32 v32, -v33, v33, v32
    v_rsq_f32 v32, v32
    v_add_f32 v16, v16, v17
    v_mul_f32 v32, 0x3dd53b94, v32
    v_fma_f32 v16, -v33, v13, v16
    v_mul_f32 v16, v16, v32
    v_cmp_u_f32 vcc, v16, v16
    s_cbranch_vccz ENOK
    s_add_u32 s51, s51, 1
    s_cmp_lt_u32 s51, 0x8000
    s_cbranch_scc1 ENP
ENOK:
    v_cvt_pk_bf16_f32 v16, v16, v16
    ds_write_b16 v10, v16
ENOK2:
    s_waitcnt lgkmcnt(0)
    s_barrier
QFRAG:
    ds_read_b128 v[16:19], v3 offset:0
    ds_read_b128 v[20:23], v3 offset:128
    ds_read_b128 v[24:27], v3 offset:256
    ds_read_b128 v[28:31], v4 offset:0
    ds_read_b128 v[32:35], v4 offset:128
    ds_read_b128 v[36:39], v4 offset:256
    s_cmp_eq_u32 s49, 0
    s_cbranch_scc1 HOOKF
    s_waitcnt vmcnt(0)
QK:
    v_mov_b64 v[40:41], 0
    v_mov_b64 v[42:43], 0
    v_mov_b64 v[44:45], 0
    v_mov_b64 v[46:47], 0
    v_mov_b64 v[48:49], 0
    v_mov_b64 v[50:51], 0
    s_waitcnt lgkmcnt(5)
    v_smfmac_f32_16x16x64_bf16 v[64:67], v[16:19], a[0:7], v7
    s_waitcnt lgkmcnt(4)
    v_smfmac_f32_16x16x64_bf16 v[64:67], v[20:23], a[8:15], v7
    s_waitcnt lgkmcnt(3)
    v_smfmac_f32_16x16x64_bf16 v[64:67], v[24:27], a[16:23], v7
    s_waitcnt lgkmcnt(2)
    v_smfmac_f32_16x16x64_bf16 v[64:67], v[28:31], a[24:31], v7
    s_waitcnt lgkmcnt(1)
    v_smfmac_f32_16x16x64_bf16 v[64:67], v[32:35], a[32:39], v7
    s_waitcnt lgkmcnt(0)
    v_smfmac_f32_16x16x64_bf16 v[64:67], v[36:39], a[40:47], v7
    v_smfmac_f32_16x16x64_bf16 v[68:71], v[16:19], a[48:55], v7
    v_smfmac_f32_16x16x64_bf16 v[68:71], v[20:23], a[56:63], v7
    v_smfmac_f32_16x16x64_bf16 v[68:71], v[24:27], a[64:71], v7
    v_smfmac_f32_16x16x64_bf16 v[68:71], v[28:31], a[72:79], v7
    v_smfmac_f32_16x16x64_bf16 v[68:71], v[32:35], a[80:87], v7
    v_smfmac_f32_16x16x64_bf16 v[68:71], v[36:39], a[88:95], v7
    v_smfmac_f32_16x16x64_bf16 v[72:75], v[16:19], a[96:103], v7
    v_smfmac_f32_16x16x64_bf16 v[72:75], v[20:23], a[104:111], v7
    v_smfmac_f32_16x16x64_bf16 v[72:75], v[24:27], a[112:119], v7
    v_mov_b32_dpp v52, v64 quad_perm:[0,0,2,2] row_mask:0xf bank_mask:0xf
    v_smfmac_f32_16x16x64_bf16 v[72:75], v[28:31], a[120:127], v7
    v_add_f32_dpp v52, v65, v52 quad_perm:[0,0,2,2] row_mask:0xf bank_mask:0xf
    v_smfmac_f32_16x16x64_bf16 v[72:75], v[32:35], a[128:135], v7
    v_add_f32_dpp v52, v66, v52 quad_perm:[1,1,3,3] row_mask:0xf bank_mask:0xf
    v_smfmac_f32_16x16x64_bf16 v[72:75], v[36:39], a[136:143], v7
    v_add_f32_dpp v52, v67, v52 quad_perm:[1,1,3,3] row_mask:0xf bank_mask:0xf
    v_smfmac_f32_16x16x64_bf16 v[76:79], v[16:19], a[144:151], v7
    v_smfmac_f32_16x16x64_bf16 v[76:79], v[20:23], a[152:159], v7
    v_smfmac_f32_16x16x64_bf16 v[76:79], v[24:27], a[160:167], v7
    v_mov_b32_dpp v53, v68 quad_perm:[0,0,2,2] row_mask:0xf bank_mask:0xf
    v_smfmac_f32_16x16x64_bf16 v[76:79], v[28:31], a[168:175], v7
    v_add_f32_dpp v53, v69, v53 quad_perm:[0,0,2,2] row_mask:0xf bank_mask:0xf
    v_smfmac_f32_16x16x64_bf16 v[76:79], v[32:35], a[176:183], v7
    v_add_f32_dpp v53, v70, v53 quad_perm:[1,1,3,3] row_mask:0xf bank_mask:0xf
    v_smfmac_f32_16x16x64_bf16 v[76:79], v[36:39], a[184:191], v7
    v_add_f32_dpp v53, v71, v53 quad_perm:[1,1,3,3] row_mask:0xf bank_mask:0xf
    v_mov_b32_dpp v54, v72 quad_perm:[0,0,2,2] row_mask:0xf bank_mask:0xf
    v_add_f32_dpp v54, v73, v54 quad_perm:[0,0,2,2] row_mask:0xf bank_mask:0xf
    v_add_f32_dpp v54, v74, v54 quad_perm:[1,1,3,3] row_mask:0xf bank_mask:0xf
    v_add_f32_dpp v54, v75, v54 quad_perm:[1,1,3,3] row_mask:0xf bank_mask:0xf
    v_max3_f32 v62, v52, v53, v54
    s_nop 1
    v_mov_b32_dpp v55, v76 quad_perm:[0,0,2,2] row_mask:0xf bank_mask:0xf
    v_add_f32_dpp v55, v77, v55 quad_perm:[0,0,2,2] row_mask:0xf bank_mask:0xf
    v_add_f32_dpp v55, v78, v55 quad_perm:[1,1,3,3] row_mask:0xf bank_mask:0xf
    v_add_f32_dpp v55, v79, v55 quad_perm:[1,1,3,3] row_mask:0xf bank_mask:0xf
    v_max_f32 v62, v62, v55
    s_nop 1
    v_max_f32_dpp v62, v62, v62 quad_perm:[2,3,0,1] row_mask:0xf bank_mask:0xf
    s_nop 1
    v_max_f32_dpp v62, v62, v62 row_ror:4 row_mask:0xf bank_mask:0xf
    s_nop 1
    v_max_f32_dpp v62, v62, v62 row_ror:8 row_mask:0xf bank_mask:0xf
    v_mov_b32 v63, v62
    s_nop 1
    v_permlane16_swap_b32 v62, v63
    v_max_f32 v62, v62, v63
    v_mov_b32 v63, v62
    s_nop 1
    v_permlane32_swap_b32 v62, v63
    v_max_f32 v62, v62, v63
    v_sub_f32 v52, v52, v62
    v_exp_f32 v52, v52
    s_nop 0
    v_cvt_pk_bf16_f32 v56, v52, v52
    v_mov_b32 v63, v52
    s_nop 0
    v_and_b32_dpp v16, v56, v5 quad_perm:[0,0,0,0] row_mask:0xf bank_mask:0xf
    v_and_b32_dpp v19, v56, v6 quad_perm:[0,0,0,0] row_mask:0xf bank_mask:0xf
    s_nop 0
    v_mov_b32_dpp v17, v16 row_shr:4 row_mask:0xf bank_mask:0xf bound_ctrl:0
    v_mov_b32_dpp v18, v19 row_shl:4 row_mask:0xf bank_mask:0xf bound_ctrl:0
    s_nop 0
    s_waitcnt vmcnt(36)
    v_smfmac_f32_16x16x64_bf16 v[40:43], v[16:19], a[192:199], v7 abid:1
    v_and_b32_dpp v20, v56, v5 quad_perm:[2,2,2,2] row_mask:0xf bank_mask:0xf
    v_and_b32_dpp v23, v56, v6 quad_perm:[2,2,2,2] row_mask:0xf bank_mask:0xf
    v_smfmac_f32_16x16x64_bf16 v[44:47], v[16:19], a[200:207], v7 abid:1
    v_mov_b32_dpp v21, v20 row_shr:4 row_mask:0xf bank_mask:0xf bound_ctrl:0
    v_mov_b32_dpp v22, v23 row_shl:4 row_mask:0xf bank_mask:0xf bound_ctrl:0
    v_sub_f32 v53, v53, v62
    v_exp_f32 v53, v53
    v_smfmac_f32_16x16x64_bf16 v[48:51], v[16:19], a[208:215], v7 abid:1
    v_cvt_pk_bf16_f32 v57, v53, v53
    v_add_f32 v63, v63, v53
    v_smfmac_f32_16x16x64_bf16 v[40:43], v[20:23], a[216:223], v7 abid:1
    v_and_b32_dpp v16, v57, v5 quad_perm:[0,0,0,0] row_mask:0xf bank_mask:0xf
    v_and_b32_dpp v19, v57, v6 quad_perm:[0,0,0,0] row_mask:0xf bank_mask:0xf
    v_smfmac_f32_16x16x64_bf16 v[44:47], v[20:23], a[224:231], v7 abid:1
    v_mov_b32_dpp v17, v16 row_shr:4 row_mask:0xf bank_mask:0xf bound_ctrl:0
    v_mov_b32_dpp v18, v19 row_shl:4 row_mask:0xf bank_mask:0xf bound_ctrl:0
    v_smfmac_f32_16x16x64_bf16 v[48:51], v[20:23], a[232:239], v7 abid:1
    s_waitcnt vmcnt(24)
    v_smfmac_f32_16x16x64_bf16 v[40:43], v[16:19], a[240:247], v7 abid:1
    v_and_b32_dpp v20, v57, v5 quad_perm:[2,2,2,2] row_mask:0xf bank_mask:0xf
    v_and_b32_dpp v23, v57, v6 quad_perm:[2,2,2,2] row_mask:0xf bank_mask:0xf
    v_smfmac_f32_16x16x64_bf16 v[44:47], v[16:19], a[248:255], v7 abid:1
    v_mov_b32_dpp v21, v20 row_shr:4 row_mask:0xf bank_mask:0xf bound_ctrl:0
    v_mov_b32_dpp v22, v23 row_shl:4 row_mask:0xf bank_mask:0xf bound_ctrl:0
    v_sub_f32 v54, v54, v62
    v_exp_f32 v54, v54
    v_smfmac_f32_16x16x64_bf16 v[48:51], v[16:19], v[128:135], v7 abid:1
    v_cvt_pk_bf16_f32 v56, v54, v54
    v_add_f32 v63, v63, v54
    v_smfmac_f32_16x16x64_bf16 v[40:43], v[20:23], v[136:143], v7 abid:1
    v_and_b32_dpp v16, v56, v5 quad_perm:[0,0,0,0] row_mask:0xf bank_mask:0xf
    v_and_b32_dpp v19, v56, v6 quad_perm:[0,0,0,0] row_mask:0xf bank_mask:0xf
    v_smfmac_f32_16x16x64_bf16 v[44:47], v[20:23], v[144:151], v7 abid:1
    v_mov_b32_dpp v17, v16 row_shr:4 row_mask:0xf bank_mask:0xf bound_ctrl:0
    v_mov_b32_dpp v18, v19 row_shl:4 row_mask:0xf bank_mask:0xf bound_ctrl:0
    v_smfmac_f32_16x16x64_bf16 v[48:51], v[20:23], v[152:159], v7 abid:1
    s_waitcnt vmcnt(12)
    v_smfmac_f32_16x16x64_bf16 v[40:43], v[16:19], v[160:167], v7 abid:1
    v_and_b32_dpp v20, v56, v5 quad_perm:[2,2,2,2] row_mask:0xf bank_mask:0xf
    v_and_b32_dpp v23, v56, v6 quad_perm:[2,2,2,2] row_mask:0xf bank_mask:0xf
    v_smfmac_f32_16x16x64_bf16 v[44:47], v[16:19], v[168:175], v7 abid:1
    v_mov_b32_dpp v21, v20 row_shr:4 row_mask:0xf bank_mask:0xf bound_ctrl:0
    v_mov_b32_dpp v22, v23 row_shl:4 row_mask:0xf bank_mask:0xf bound_ctrl:0
    v_sub_f32 v55, v55, v62
    v_exp_f32 v55, v55
    v_smfmac_f32_16x16x64_bf16 v[48:51], v[16:19], v[176:183], v7 abid:1
    v_cvt_pk_bf16_f32 v57, v55, v55
    v_add_f32 v63, v63, v55
    v_smfmac_f32_16x16x64_bf16 v[40:43], v[20:23], v[184:191], v7 abid:1
    v_and_b32_dpp v16, v57, v5 quad_perm:[0,0,0,0] row_mask:0xf bank_mask:0xf
    v_and_b32_dpp v19, v57, v6 quad_perm:[0,0,0,0] row_mask:0xf bank_mask:0xf
    v_smfmac_f32_16x16x64_bf16 v[44:47], v[20:23], v[192:199], v7 abid:1
    v_mov_b32_dpp v17, v16 row_shr:4 row_mask:0xf bank_mask:0xf bound_ctrl:0
    v_mov_b32_dpp v18, v19 row_shl:4 row_mask:0xf bank_mask:0xf bound_ctrl:0
    v_smfmac_f32_16x16x64_bf16 v[48:51], v[20:23], v[200:207], v7 abid:1
    s_waitcnt vmcnt(0)
    v_smfmac_f32_16x16x64_bf16 v[40:43], v[16:19], v[208:215], v7 abid:1
    v_add_f32_dpp v63, v63, v63 quad_perm:[2,3,0,1] row_mask:0xf bank_mask:0xf
    v_and_b32_dpp v20, v57, v5 quad_perm:[2,2,2,2] row_mask:0xf bank_mask:0xf
    v_and_b32_dpp v23, v57, v6 quad_perm:[2,2,2,2] row_mask:0xf bank_mask:0xf
    v_add_f32_dpp v63, v63, v63 row_ror:4 row_mask:0xf bank_mask:0xf
    v_smfmac_f32_16x16x64_bf16 v[44:47], v[16:19], v[216:223], v7 abid:1
    v_mov_b32_dpp v21, v20 row_shr:4 row_mask:0xf bank_mask:0xf bound_ctrl:0
    v_mov_b32_dpp v22, v23 row_shl:4 row_mask:0xf bank_mask:0xf bound_ctrl:0
    v_add_f32_dpp v63, v63, v63 row_ror:8 row_mask:0xf bank_mask:0xf
    v_mov_b32 v58, v63
    v_smfmac_f32_16x16x64_bf16 v[48:51], v[16:19], v[224:231], v7 abid:1
    s_nop 0
    v_permlane16_swap_b32 v63, v58
    v_smfmac_f32_16x16x64_bf16 v[40:43], v[20:23], v[232:239], v7 abid:1
    v_add_f32 v63, v63, v58
    v_mov_b32 v58, v63
    v_smfmac_f32_16x16x64_bf16 v[44:47], v[20:23], v[240:247], v7 abid:1
    v_smfmac_f32_16x16x64_bf16 v[48:51], v[20:23], v[248:255], v7 abid:1
    v_permlane32_swap_b32 v63, v58
    v_add_f32 v63, v63, v58
    ds_write_b64 v61, v[62:63]
    s_mov_b32 exec_lo, 0x00ff00ff
    s_mov_b32 exec_hi, 0xff00ff00
    s_nop 0
    ds_write_b128 v15, v[40:43] offset:0
    ds_write_b128 v15, v[44:47] offset:256
    ds_write_b128 v15, v[48:51] offset:512
    s_mov_b64 exec, -1
    v_cmp_eq_u32 s[60:61], 24, v1
    s_cmp_eq_u32 s49, 0
    s_cbranch_scc1 HOOKC
EXB:
    s_waitcnt lgkmcnt(0)
    s_barrier
    ds_read_b128 v[16:19], v12
    ds_read_b128 v[20:23], v12 offset:16
    ds_read_b64 v[24:25], v60 offset:0
    ds_read_b64 v[26:27], v60 offset:768
    ds_read_b64 v[28:29], v60 offset:1536
    ds_read_b64 v[30:31], v60 offset:2304
    ds_read_b64 v[32:33], v60 offset:3072
    ds_read_b64 v[34:35], v60 offset:3840
    ds_read_b64 v[36:37], v60 offset:4608
    ds_read_b64 v[38:39], v60 offset:5376
    s_waitcnt lgkmcnt(8)
    v_max_f32 v40, v16, v18
    v_max3_f32 v40, v40, v20, v22
    v_sub_f32 v16, v16, v40
    v_sub_f32 v18, v18, v40
    v_sub_f32 v20, v20, v40
    v_sub_f32 v22, v22, v40
    v_exp_f32 v16, v16
    v_exp_f32 v18, v18
    v_exp_f32 v20, v20
    v_exp_f32 v22, v22
    v_mul_f32 v41, v16, v17
    v_fmac_f32 v41, v18, v19
    v_fmac_f32 v41, v20, v21
    v_fmac_f32 v41, v22, v23
    v_rcp_f32 v42, v41
    v_log_f32 v43, v41
    s_waitcnt lgkmcnt(0)
    v_pk_add_f32 v[24:25], v[24:25], v[26:27]
    v_pk_add_f32 v[28:29], v[28:29], v[30:31]
    v_pk_add_f32 v[32:33], v[32:33], v[34:35]
    v_pk_add_f32 v[36:37], v[36:37], v[38:39]
    v_pk_mul_f32 v[24:25], v[24:25], v[16:17] op_sel_hi:[1,0]
    v_pk_fma_f32 v[24:25], v[28:29], v[18:19], v[24:25] op_sel_hi:[1,0,1]
    v_pk_fma_f32 v[24:25], v[32:33], v[20:21], v[24:25] op_sel_hi:[1,0,1]
    v_pk_fma_f32 v[24:25], v[36:37], v[22:23], v[24:25] op_sel_hi:[1,0,1]
    v_pk_mul_f32 v[24:25], v[24:25], v[42:43] op_sel_hi:[1,0]
    v_add_f32 v43, v43, v40
    v_cvt_pk_bf16_f32 v24, v24, v25
    s_mov_b64 exec, 0x1ffffff
    v_cndmask_b32 v24, v24, v43, s[60:61]
    s_cmp_eq_u32 s50, 0
    s_cbranch_scc1 SLOW2
    buffer_store_dword v24, v14, s[16:19], s62 offen
PUBD2:
    s_mov_b64 exec, -1
    s_cmp_ge_u32 s46, 20
    s_cbranch_scc1 HOOKG3
    v_and_b32 v30, 7, v1
    v_lshrrev_b32 v31, 4, v1
    v_lshlrev_b32 v58, 4, v30
    v_lshl_add_u32 v58, v31, 7, v58
    s_mul_i32 s52, s56, 6144
    s_mul_i32 s54, s44, 1536
    s_add_u32 s52, s52, s54
    v_add_u32 v58, s52, v58
    s_lshr_b32 s53, s44, 1
    s_lshl_b32 s52, s56, 6
    s_lshl_b32 s54, s53, 5
    s_add_u32 s52, s52, s54
    s_add_u32 s52, s52, 19968
    v_lshl_add_u32 v59, v31, 2, v30
    v_and_b32 v59, 7, v59
    v_lshl_add_u32 v59, v59, 2, s52
    s_lshl_b32 s52, s57, 8
    s_add_u32 s52, s52, 131072
    s_or_b32 s53, s45, s56
    s_cmp_eq_u32 s53, 0
    s_cselect_b32 s52, s52, 1879048192
    v_lshl_add_u32 v61, v1, 2, s52
    v_mov_b64 v[44:45], 0
    v_mov_b64 v[46:47], 0
    v_mov_b64 v[48:49], 0
    v_mov_b64 v[50:51], 0
    v_mov_b64 v[52:53], 0
    v_mov_b64 v[54:55], 0
    s_mov_b32 s60, 0x00ff00ff
    s_mov_b32 s61, 0x00ff00ff
    s_mov_b32 s51, 0
    s_cmp_eq_u32 s49, 0
    s_cbranch_scc1 HOOKG
WO0:
    buffer_load_dword v57, v61, s[16:19], s49 offen sc1
    buffer_load_dword v56, v59, s[16:19], s62 offen sc1
    s_mov_b64 exec, s[60:61]
    buffer_load_dwordx4 v[44:47], v58, s[16:19], s62 offen offset:0 sc1
    buffer_load_dwordx4 v[48:51], v58, s[16:19], s62 offen offset:512 sc1
    buffer_load_dwordx4 v[52:55], v58, s[16:19], s62 offen offset:1024 sc1
    s_mov_b64 exec, -1
    s_cmp_eq_u32 s49, 0
    s_cbranch_scc1 HOOKG2
    s_nop 15
    s_nop 7
    v_lshrrev_b32 v14, 5, v1
    v_lshlrev_b32 v14, 11, v14
    v_and_b32 v15, 31, v1
    v_lshl_add_u32 v14, v15, 2, v14
    s_lshr_b32 s53, s57, 1
    s_lshl_b32 s52, s57, 12
    s_lshl_b32 s54, s53, 13
    s_add_u32 s52, s52, s54
    s_lshl_b32 s54, s45, 8
    s_add_u32 s52, s52, s54
    s_lshl_b32 s54, s56, 7
    s_add_u32 s52, s52, s54
    v_add_u32 v14, s52, v14
    s_xor_b32 s1, s0, 8192
    s_add_u32 s1, s1, s49
    s_add_u32 s99, s0, s49
    s_lshl_b32 s52, s44, 9
    s_add_u32 s52, s52, 104960
    v_lshl_add_u32 v15, v15, 4, s52
    v_and_b32 v64, 15, v1
    v_lshlrev_b32 v64, 4, v64
    v_lshl_add_u32 v64, v31, 2, v64
    v_add_u32 v64, 104960, v64
WOP:
    buffer_load_dword v57, v61, s[16:19], s49 offen sc1
    buffer_load_dword v56, v59, s[16:19], s62 offen sc1
    s_mov_b64 exec, s[60:61]
    buffer_load_dwordx4 v[44:47], v58, s[16:19], s62 offen offset:0 sc1
    buffer_load_dwordx4 v[48:51], v58, s[16:19], s62 offen offset:512 sc1
    buffer_load_dwordx4 v[52:55], v58, s[16:19], s62 offen offset:1024 sc1
    s_mov_b64 exec, -1
    s_waitcnt vmcnt(5)
WOC:
    v_max3_u32 v63, v44, v48, v52
    v_mov_b32 v32, v56
    v_max_u32 v63, v63, v32
    v_cmp_eq_u32 vcc, -1, v63
    s_cbranch_vccnz WOAG
    v_mfma_f32_16x16x32_bf16 v[16:19], v[44:47], v[80:83], 0
    v_max_f32_dpp v33, v32, v32 quad_perm:[1,0,3,2] row_mask:0xf bank_mask:0xf
    s_nop 0
    v_mfma_f32_16x16x32_bf16 v[16:19], v[48:51], v[96:99], v[16:19]
    v_max_f32_dpp v33, v33, v33 quad_perm:[2,3,0,1] row_mask:0xf bank_mask:0xf
    s_nop 0
    v_mfma_f32_16x16x32_bf16 v[16:19], v[52:55], v[112:115], v[16:19]
    v_max_f32_dpp v33, v33, v33 row_half_mirror row_mask:0xf bank_mask:0xf
    v_sub_f32 v34, v32, v33
    v_mfma_f32_16x16x32_bf16 v[20:23], v[44:47], v[84:87], 0
    v_exp_f32 v34, v34
    s_nop 0
    v_mfma_f32_16x16x32_bf16 v[20:23], v[48:51], v[100:103], v[20:23]
    v_add_f32_dpp v33, v34, v34 quad_perm:[1,0,3,2] row_mask:0xf bank_mask:0xf
    s_nop 0
    v_mfma_f32_16x16x32_bf16 v[20:23], v[52:55], v[116:119], v[20:23]
    v_add_f32_dpp v33, v33, v33 quad_perm:[2,3,0,1] row_mask:0xf bank_mask:0xf
    s_nop 0
    v_mfma_f32_16x16x32_bf16 v[24:27], v[44:47], v[88:91], 0
    v_add_f32_dpp v33, v33, v33 row_half_mirror row_mask:0xf bank_mask:0xf
    v_rcp_f32 v33, v33
    v_mfma_f32_16x16x32_bf16 v[24:27], v[48:51], v[104:107], v[24:27]
    v_mul_f32 v34, v34, v33
    s_nop 0
    v_mfma_f32_16x16x32_bf16 v[24:27], v[52:55], v[120:123], v[24:27]
    v_mul_f32_dpp v36, v34, v16 row_newbcast:0 row_mask:0xf bank_mask:0xf
    v_fmac_f32_dpp v36, v34, v17 row_newbcast:1 row_mask:0xf bank_mask:0xf
    v_mfma_f32_16x16x32_bf16 v[28:31], v[44:47], v[92:95], 0
    v_fmac_f32_dpp v36, v34, v18 row_newbcast:2 row_mask:0xf bank_mask:0xf
    v_fmac_f32_dpp v36, v34, v19 row_newbcast:3 row_mask:0xf bank_mask:0xf
    v_mfma_f32_16x16x32_bf16 v[28:31], v[48:51], v[108:111], v[28:31]
    v_mul_f32_dpp v37, v34, v20 row_newbcast:0 row_mask:0xf bank_mask:0xf
    v_fmac_f32_dpp v37, v34, v21 row_newbcast:1 row_mask:0xf bank_mask:0xf
    v_mfma_f32_16x16x32_bf16 v[28:31], v[52:55], v[124:127], v[28:31]
    v_fmac_f32_dpp v37, v34, v22 row_newbcast:2 row_mask:0xf bank_mask:0xf
    v_fmac_f32_dpp v37, v34, v23 row_newbcast:3 row_mask:0xf bank_mask:0xf
    v_cmp_u_f32 vcc, v36, v57
    v_mul_f32_dpp v38, v34, v24 row_newbcast:0 row_mask:0xf bank_mask:0xf
    v_fmac_f32_dpp v38, v34, v25 row_newbcast:1 row_mask:0xf bank_mask:0xf
    v_fmac_f32_dpp v38, v34, v26 row_newbcast:2 row_mask:0xf bank_mask:0xf
    v_fmac_f32_dpp v38, v34, v27 row_newbcast:3 row_mask:0xf bank_mask:0xf
    s_mov_b32 exec_hi, 0
    v_mul_f32_dpp v39, v34, v28 row_newbcast:0 row_mask:0xf bank_mask:0xf
    v_fmac_f32_dpp v39, v34, v29 row_newbcast:1 row_mask:0xf bank_mask:0xf
    v_fmac_f32_dpp v39, v34, v30 row_newbcast:2 row_mask:0xf bank_mask:0xf
    v_fmac_f32_dpp v39, v34, v31 row_newbcast:3 row_mask:0xf bank_mask:0xf
    s_cbranch_vccz WOOK
    s_mov_b64 exec, -1
WOAG:
    s_add_u32 s51, s51, 1
    s_cmp_lt_u32 s51, 0x8000
    s_cbranch_scc1 WOP
    s_mov_b32 exec_hi, 0
WOOK:
    ds_write_b128 v15, v[36:39]
    s_mov_b64 exec, -1
    s_cmp_lg_u32 s44, 3
    s_waitcnt lgkmcnt(0)
    s_barrier
    s_cbranch_scc1 WOX
    ds_read2st64_b32 v[16:17], v64 offset0:0 offset1:1
    ds_read2st64_b32 v[18:19], v64 offset0:2 offset1:3
    ds_read2st64_b32 v[20:21], v64 offset0:4 offset1:5
    ds_read2st64_b32 v[22:23], v64 offset0:6 offset1:7
    s_waitcnt lgkmcnt(2)
    v_pk_add_f32 v[16:17], v[16:17], v[18:19]
    v_add_f32 v16, v16, v57
    s_waitcnt lgkmcnt(0)
    v_pk_add_f32 v[20:21], v[20:21], v[22:23]
    v_pk_add_f32 v[16:17], v[16:17], v[20:21]
    v_add_f32 v16, v16, v17
    buffer_store_dword v16, v14, s[16:19], s1 offen sc1
    buffer_store_dword v16, v14, s[16:19], s99 offen sc1
WOX:
    s_cmp_ge_u32 s46, 30
    s_cbranch_scc1 STX
    s_cmp_eq_u32 s44, 3
    s_cbranch_scc1 F1W3
    s_waitcnt vmcnt(0)
F1W3:
    s_waitcnt vmcnt(2)
F1E:
    v_and_b32 v61, 3, v1
    v_lshlrev_b32 v61, 3, v61
    v_bfe_u32 v60, v1, 2, 2
    v_lshl_add_u32 v61, v60, 7, v61
    v_lshrrev_b32 v60, 4, v1
    v_lshl_add_u32 v61, v60, 10, v61
    v_bfe_u32 v60, v1, 3, 2
    v_lshl_add_u32 v61, v60, 5, v61
    s_lshl_b32 s52, s44, 5
    v_xor_b32 v61, s52, v61
    ds_read_b64_tr_b16 v[64:65], v61 offset:49152
    ds_read_b64_tr_b16 v[66:67], v61 offset:49664
    ds_read_b64_tr_b16 v[68:69], v61 offset:53248
    ds_read_b64_tr_b16 v[70:71], v61 offset:53760
    ds_read_b64_tr_b16 v[72:73], v61 offset:57344
    ds_read_b64_tr_b16 v[74:75], v61 offset:57856
    ds_read_b64_tr_b16 v[76:77], v61 offset:61440
    ds_read_b64_tr_b16 v[78:79], v61 offset:61952
    s_lshl_b32 s52, s59, 6
    s_lshl_b32 s54, s44, 4
    s_add_u32 s52, s52, s54
    v_add_u32 v14, s52, v1
    s_mul_i32 s52, s58, 3072
    s_lshl_b32 s54, s3, 2
    s_add_u32 s52, s52, s54
    s_lshl_b32 s53, s58, 2
    s_add_u32 s53, s53, 6144
    s_cmp_eq_u32 s3, 4
    s_cselect_b32 s52, s53, s52
    s_cselect_b32 s53, 3, 4
    v_lshlrev_b32 v14, s53, v14
    v_add_u32 v14, s52, v14
    s_lshl_b32 s52, s4, 3
    s_add_u32 s52, s52, 20224
    v_mov_b32 v15, s52
    v_and_b32 v57, 31, v1
    v_lshl_add_u32 v57, s44, 5, v57
    s_lshl_b32 s52, s4, 9
    s_add_u32 s52, s52, 133632
    s_cmp_lt_u32 s4, 5
    s_cselect_b32 s52, s52, 1879048192
    s_cmp_eq_u32 s45, 0
    s_cselect_b32 s52, s52, 1879048192
    v_lshl_add_u32 v56, v57, 2, s52
    v_lshlrev_b32 v57, 1, v57
    v_add_u32 v57, 96512, v57
    v_lshrrev_b32 v58, 5, v1
    v_lshlrev_b32 v58, 10, v58
    v_and_b32 v59, 31, v1
    v_lshl_add_u32 v58, v59, 2, v58
    s_lshl_b32 s52, s3, 14
    s_lshl_b32 s54, s44, 11
    s_add_u32 s52, s52, s54
    s_lshl_b32 s54, s0, 0
    s_add_u32 s52, s52, s54
    v_add_u32 v58, s52, v58
    v_min_u32 v54, 191, v0
    v_lshlrev_b32 v52, 4, v54
    v_lshlrev_b32 v54, 3, v54
    v_add_u32 v54, 6144, v54
    v_and_b32 v53, 15, v0
    s_mov_b32 s100, 0
    s_cmp_eq_u32 s49, 0
    s_cbranch_scc1 HOOKD
    s_cmp_lt_u32 s46, 20
    s_cbranch_scc1 GFB
    s_sleep 14
GFB:
    s_sleep 8
F1S:
    v_add_u32 v14, 12288, v14
    v_add_u32 v52, 12288, v52
    v_add_u32 v54, 12288, v54
    s_mov_b32 s51, 0
F1P:
    buffer_load_dword v16, v58, s[16:19], s49 offen offset:0 sc1
    buffer_load_dword v17, v58, s[16:19], s49 offen offset:128 sc1
    buffer_load_dword v18, v58, s[16:19], s49 offen offset:256 sc1
    buffer_load_dword v19, v58, s[16:19], s49 offen offset:384 sc1
    buffer_load_dword v20, v58, s[16:19], s49 offen offset:512 sc1
    buffer_load_dword v21, v58, s[16:19], s49 offen offset:640 sc1
    buffer_load_dword v22, v58, s[16:19], s49 offen offset:768 sc1
    buffer_load_dword v23, v58, s[16:19], s49 offen offset:896 sc1
    s_cmp_eq_u32 s100, 3
    s_cbranch_scc1 HOOKH
F1W:
    s_waitcnt vmcnt(0)
    v_pk_add_f32 v[16:17], v[16:17], v[18:19]
    v_pk_add_f32 v[20:21], v[20:21], v[22:23]
    v_pk_add_f32 v[16:17], v[16:17], v[20:21]
    v_add_f32 v16, v16, v17
    v_mov_b32 v17, v16
    s_nop 1
    v_permlane32_swap_b32 v16, v17
    v_add_f32 v16, v16, v17
    v_cmp_u_f32 vcc, v16, v16
    s_cbranch_vccz F1OK
    s_add_u32 s51, s51, 1
    s_sleep 1
    s_cmp_lt_u32 s51, 0x8000
    s_cbranch_scc1 F1P
F1OK:
    v_cvt_pk_bf16_f32 v16, v16, v16
    ds_write_b16 v57, v16
    v_and_b32 v16, 0xffff0000, v16
    s_mov_b32 exec_hi, 0
    s_cmp_eq_u32 s50, 0
    s_cbranch_scc1 SLOW7
    buffer_store_dword v16, v56, s[16:19], s49 offen
PUBD7:
    s_mov_b64 exec, -1
    s_waitcnt lgkmcnt(0)
    s_barrier
    ds_read_b128 v[20:23], v2 offset:256
    ds_read_b128 v[24:27], v2 offset:320
    ds_read_b128 v[28:31], v2 offset:384
    ds_read_b128 v[32:35], v2 offset:448
    s_waitcnt lgkmcnt(3)
    v_mfma_f32_16x16x32_bf16 v[40:43], v[20:23], v[64:67], 0
    v_mfma_f32_16x16x32_bf16 v[44:47], v[20:23], v[20:23], 0
    s_waitcnt lgkmcnt(2)
    v_mfma_f32_16x16x32_bf16 v[40:43], v[24:27], v[68:71], v[40:43]
    v_mfma_f32_16x16x32_bf16 v[44:47], v[24:27], v[24:27], v[44:47]
    s_waitcnt lgkmcnt(1)
    v_mfma_f32_16x16x32_bf16 v[40:43], v[28:31], v[72:75], v[40:43]
    v_mfma_f32_16x16x32_bf16 v[44:47], v[28:31], v[28:31], v[44:47]
    s_waitcnt lgkmcnt(0)
    v_mfma_f32_16x16x32_bf16 v[40:43], v[32:35], v[76:79], v[40:43]
    v_mfma_f32_16x16x32_bf16 v[44:47], v[32:35], v[32:35], v[44:47]
    s_mov_b64 exec, 0xffff
    s_nop 3
    s_cmp_eq_u32 s50, 0
    s_cbranch_scc1 SLOW8
    buffer_store_dword v40, v14, s[16:19], s62 offen
    s_mov_b64 exec, 1
    buffer_store_dwordx2 v[44:45], v15, s[16:19], s62 offen
PUBD8:
    s_mov_b64 exec, -1
    s_cmp_lt_u32 s46, 20
    s_cbranch_scc1 STX
    v_and_b32 v58, 7, v1
    v_cmp_gt_u32 vcc, 5, v58
    v_lshlrev_b32 v58, 3, v58
    v_add_u32 v58, 20224, v58
    v_mov_b32 v59, 1879048192
    v_cndmask_b32 v58, v59, v58, vcc
    s_lshl_b32 s52, s57, 8
    s_lshl_b32 s54, s44, 6
    s_add_u32 s52, s52, s54
    s_add_u32 s52, s52, 133632
    s_cmp_eq_u32 s45, 0
    s_cselect_b32 s52, s52, 1879048192
    v_lshl_add_u32 v59, v53, 2, s52
    s_cmp_eq_u32 s44, 3
    s_cselect_b32 s53, 1879048192, s62
    s_nop 3
W20:
    s_nop 11
    buffer_load_dword v76, v59, s[16:19], s49 offen sc1
    buffer_load_dwordx2 v[74:75], v58, s[16:19], s62 offen sc1
    buffer_load_dwordx4 v[64:67], v52, s[16:19], s53 offen offset:0 sc1
    buffer_load_dwordx4 v[68:71], v52, s[16:19], s53 offen offset:3072 sc1
    buffer_load_dwordx2 v[72:73], v54, s[16:19], s53 offen sc1
    s_lshr_b32 s1, s57, 2
    s_lshr_b32 s99, s44, 1
    s_lshl_b32 s52, s57, 11
    s_lshl_b32 s54, s1, 13
    s_add_u32 s52, s52, s54
    s_mul_i32 s54, s99, 896
    s_add_u32 s52, s52, s54
    s_lshl_b32 s54, s44, 6
    s_add_u32 s52, s52, s54
    s_lshl_b32 s54, s45, 7
    s_add_u32 s52, s52, s54
    s_add_u32 s52, s52, 81920
    v_lshl_add_u32 v14, v53, 2, s52
    v_bfe_u32 v15, v1, 4, 1
    v_lshl_add_u32 v14, v15, 13, v14
    v_lshlrev_b32 v57, 1, v0
    v_add_u32 v57, 96768, v57
    s_mov_b32 s51, 0
    s_cmp_eq_u32 s49, 0
    s_cbranch_scc1 HOOKI
    s_nop 15
    s_nop 7
W2P:
    buffer_load_dword v76, v59, s[16:19], s49 offen sc1
    buffer_load_dwordx2 v[74:75], v58, s[16:19], s62 offen sc1
    buffer_load_dwordx4 v[64:67], v52, s[16:19], s53 offen offset:0 sc1
    buffer_load_dwordx4 v[68:71], v52, s[16:19], s53 offen offset:3072 sc1
    buffer_load_dwordx2 v[72:73], v54, s[16:19], s53 offen sc1
    s_waitcnt vmcnt(5)
W2C:
    v_add_f32_dpp v36, v74, v74 quad_perm:[1,0,3,2] row_mask:0xf bank_mask:0xf
    v_add_f32_dpp v37, v75, v75 quad_perm:[1,0,3,2] row_mask:0xf bank_mask:0xf
    v_pk_add_f32 v[18:19], v[64:65], v[66:67]
    v_add_f32_dpp v36, v36, v36 quad_perm:[2,3,0,1] row_mask:0xf bank_mask:0xf
    v_add_f32_dpp v37, v37, v37 quad_perm:[2,3,0,1] row_mask:0xf bank_mask:0xf
    v_pk_add_f32 v[20:21], v[68:69], v[70:71]
    v_add_f32_dpp v36, v36, v36 row_half_mirror row_mask:0xf bank_mask:0xf
    v_add_f32_dpp v37, v37, v37 row_half_mirror row_mask:0xf bank_mask:0xf
    v_add_f32 v16, v18, v19
    v_add_f32 v17, v20, v21
    v_mul_f32 v37, 0x3acccccd, v37
    v_fmamk_f32 v36, v36, 0x3acccccd, v11
    v_fma_f32 v36, -v37, v37, v36
    v_rsq_f32 v36, v36
    v_pk_add_f32 v[16:17], v[16:17], v[72:73]
    v_pk_fma_f32 v[16:17], v[36:37], v[126:127], v[16:17] op_sel:[1,0,0] op_sel_hi:[1,1,1] neg_lo:[1,0,0] neg_hi:[1,0,0]
    v_pk_mul_f32 v[16:17], v[16:17], v[36:37] op_sel_hi:[1,0]
    v_mul_f32 v18, 0xbfb8aa3b, v16
    v_exp_f32 v18, v18
    v_mul_f32 v16, v16, v17
    v_add_f32 v18, 1.0, v18
    v_rcp_f32 v18, v18
    v_cmp_u_f32 vcc, v16, v76
    v_mul_f32 v16, v16, v18
    s_cbranch_vccz W2OK
    s_add_u32 s51, s51, 1
    s_cmp_lt_u32 s51, 0x8000
    s_cbranch_scc1 W2P
W2OK:
    v_cvt_pk_bf16_f32 v16, v16, v16
    ds_write_b16 v57, v16
    s_waitcnt lgkmcnt(0)
    s_barrier
    ds_read_b128 v[16:19], v2 offset:512
    ds_read_b128 v[20:23], v2 offset:576
    ds_read_b128 v[24:27], v2 offset:640
    ds_read_b128 v[28:31], v2 offset:704
    ds_read_b128 v[32:35], v2 offset:768
    ds_read_b128 v[36:39], v2 offset:832
    s_waitcnt lgkmcnt(5)
    v_mfma_f32_16x16x32_bf16 v[40:43], v[16:19], v[80:83], 0
    s_waitcnt lgkmcnt(4)
    v_mfma_f32_16x16x32_bf16 v[40:43], v[20:23], v[84:87], v[40:43]
    s_waitcnt lgkmcnt(3)
    v_mfma_f32_16x16x32_bf16 v[40:43], v[24:27], v[88:91], v[40:43]
    s_waitcnt lgkmcnt(2)
    v_mfma_f32_16x16x32_bf16 v[40:43], v[28:31], v[92:95], v[40:43]
    s_waitcnt lgkmcnt(1)
    v_mfma_f32_16x16x32_bf16 v[40:43], v[32:35], v[96:99], v[40:43]
    s_waitcnt lgkmcnt(0)
    v_mfma_f32_16x16x32_bf16 v[40:43], v[36:39], v[100:103], v[40:43]
    s_mov_b32 exec_hi, 0
    s_waitcnt vmcnt(0)
    s_nop 5
    v_add_f32 v40, v40, v76
    buffer_store_dword v40, v14, s[16:19], s49 offen sc1
    s_mov_b64 exec, -1
STX:
    s_cmp_lg_u32 s49, 0
    s_cbranch_scc1 LAST
    s_branch LOOP
LAST:
    s_and_b32 s52, s2, 0xc7
    s_cmp_eq_u32 s52, 0
    s_cbranch_scc1 LOOP
    s_endpgm
FINAL:
    s_cmp_eq_u32 s44, 3
    s_cbranch_scc1 FINX
    v_cvt_pk_bf16_f32 v30, v30, v30
    v_lshlrev_b32 v20, 1, v29
    s_mul_i32 s52, s48, 160
    s_mov_b32 exec_lo, s60
    s_mov_b32 exec_hi, 0
    buffer_store_short v30, v20, s[36:39], s52 offen
    s_mov_b64 exec, -1
FINX:
DONE:
    s_endpgm
HOOKL:
    s_cmp_lg_u32 s49, 0
    s_cbranch_scc1 HL2
    s_cmp_lt_u32 s46, 30
    s_cbranch_scc1 NOGSW
    v_mov_b32 v20, 20224
    s_mov_b32 s51, 0
GSW:
    buffer_load_dword v21, v20, s[16:19], s62 offen sc1
    s_waitcnt vmcnt(0)
    v_cmp_u_f32 vcc, v21, v21
    s_cbranch_vccz NOGSW
    s_add_u32 s51, s51, 1
    s_sleep 2
    s_cmp_lt_u32 s51, 0x8000
    s_cbranch_scc1 GSW
NOGSW:
    s_cmp_ge_u32 s46, 30
    s_cselect_b32 s53, 10, 0
    s_sub_u32 s53, s46, s53
    v_min_u32 v31, 17, v1
    v_lshlrev_b32 v31, 7, v31
    s_mul_i32 s52, s45, 45312
    s_mul_i32 s54, s53, 2304
    s_add_u32 s52, s52, s54
    s_add_u32 s52, s52, 524288
    buffer_load_dword v31, v31, s[16:19], s52 offen sc1
    v_lshlrev_b32 v27, 3, v0
    s_mul_i32 s52, s47, 12288
    s_add_u32 s52, s52, 1441792
    s_add_u32 s53, s52, 0
    buffer_load_dwordx2 v[32:33], v27, s[16:19], s53 offen offset:0 sc1
    buffer_load_dwordx2 v[34:35], v27, s[16:19], s53 offen offset:1536 sc1
    s_add_u32 s53, s52, 3072
    buffer_load_dwordx2 v[36:37], v27, s[16:19], s53 offen offset:0 sc1
    buffer_load_dwordx2 v[38:39], v27, s[16:19], s53 offen offset:1536 sc1
    s_add_u32 s53, s52, 6144
    buffer_load_dwordx2 v[40:41], v27, s[16:19], s53 offen offset:0 sc1
    buffer_load_dwordx2 v[42:43], v27, s[16:19], s53 offen offset:1536 sc1
    s_add_u32 s53, s52, 9216
    buffer_load_dwordx2 v[16:17], v27, s[16:19], s53 offen offset:0 sc1
    buffer_load_dwordx2 v[20:21], v27, s[16:19], s53 offen offset:1536 sc1
    s_sleep 21
    s_branch GYB
HL2:
    s_sleep 20
    s_branch GYB
HOOKA:
    s_nop 3
    s_lshl_b32 s52, s44, 6
    s_add_u32 s52, s52, 98816
    v_lshl_add_u32 v14, v1, 2, s52
    ds_write_b32 v14, v17 offset:8704
    v_fma_f32 v16, -v84, v17, v16
    v_mul_f32 v16, v16, v85
    ds_write_b32 v14, v16 offset:0
    ds_write_b32 v14, v21 offset:8960
    v_fma_f32 v20, -v84, v21, v20
    v_mul_f32 v20, v20, v85
    ds_write_b32 v14, v20 offset:256
    ds_write_b32 v14, v25 offset:9216
    v_fma_f32 v24, -v84, v25, v24
    v_mul_f32 v24, v24, v85
    ds_write_b32 v14, v24 offset:512
    s_mov_b64 exec, -1
    s_add_u32 s44, s44, 1
    s_cmp_lt_u32 s44, 4
    s_cbranch_scc1 LOOP
    s_mov_b32 s44, 3
    v_lshlrev_b32 v14, 2, v1
    v_add_u32 v14, 98816, v14
    ds_read2st64_b32 v[16:17], v14 offset0:0 offset1:1
    ds_read_b32 v18, v14 offset:512
    s_lshl_b32 s52, s47, 13
    s_lshl_b32 s54, s48, 10
    s_add_u32 s52, s52, s54
    s_add_u32 s52, s52, 1114112
    s_waitcnt lgkmcnt(0)
    v_bitop3_b32 v19, v16, v17, v18 bitop3:0x96
    v_xor_b32 v19, v19, v89
    buffer_store_dwordx4 v[16:19], v88, s[16:19], s52 offen sc1
    s_sleep 24
    v_and_b32 v15, 0xe1, v1
    v_lshlrev_b32 v15, 1, v15
    v_bfe_u32 v14, v1, 4, 1
    v_lshl_add_u32 v15, v14, 3, v15
    v_bfe_u32 v14, v1, 3, 1
    v_lshl_add_u32 v15, v14, 5, v15
    v_bfe_u32 v14, v1, 2, 1
    v_lshl_add_u32 v15, v14, 2, v15
    v_bfe_u32 v14, v1, 1, 1
    v_lshl_add_u32 v15, v14, 4, v15
    v_add_u32 v15, 98304, v15
    s_lshl_b32 s52, s47, 13
    s_add_u32 s52, s52, 1114112
    s_add_u32 s53, s52, 4096
    s_mov_b32 s51, 0
Q0P:
    buffer_load_dwordx4 v[16:19], v88, s[16:19], s52 offen offset:0 sc1
    buffer_load_dwordx4 v[20:23], v88, s[16:19], s52 offen offset:1024 sc1
    buffer_load_dwordx4 v[24:27], v88, s[16:19], s52 offen offset:2048 sc1
    buffer_load_dwordx4 v[28:31], v88, s[16:19], s52 offen offset:3072 sc1
    buffer_load_dwordx4 v[32:35], v88, s[16:19], s53 offen offset:0 sc1
    buffer_load_dwordx4 v[36:39], v88, s[16:19], s53 offen offset:1024 sc1
    buffer_load_dwordx4 v[40:43], v88, s[16:19], s53 offen offset:2048 sc1
    buffer_load_dwordx4 v[44:47], v88, s[16:19], s53 offen offset:3072 sc1
    v_mov_b32 v48, 0
    s_waitcnt vmcnt(0)
    v_bitop3_b32 v49, v16, v17, v18 bitop3:0x96
    v_bitop3_b32 v49, v49, v19, v89 bitop3:0x96
    v_or_b32 v48, v48, v49
    v_bitop3_b32 v49, v20, v21, v22 bitop3:0x96
    v_bitop3_b32 v49, v49, v23, v89 bitop3:0x96
    v_or_b32 v48, v48, v49
    v_bitop3_b32 v49, v24, v25, v26 bitop3:0x96
    v_bitop3_b32 v49, v49, v27, v89 bitop3:0x96
    v_or_b32 v48, v48, v49
    v_bitop3_b32 v49, v28, v29, v30 bitop3:0x96
    v_bitop3_b32 v49, v49, v31, v89 bitop3:0x96
    v_or_b32 v48, v48, v49
    v_bitop3_b32 v49, v32, v33, v34 bitop3:0x96
    v_bitop3_b32 v49, v49, v35, v89 bitop3:0x96
    v_or_b32 v48, v48, v49
    v_bitop3_b32 v49, v36, v37, v38 bitop3:0x96
    v_bitop3_b32 v49, v49, v39, v89 bitop3:0x96
    v_or_b32 v48, v48, v49
    v_bitop3_b32 v49, v40, v41, v42 bitop3:0x96
    v_bitop3_b32 v49, v49, v43, v89 bitop3:0x96
    v_or_b32 v48, v48, v49
    v_bitop3_b32 v49, v44, v45, v46 bitop3:0x96
    v_bitop3_b32 v49, v49, v47, v89 bitop3:0x96
    v_or_b32 v48, v48, v49
    v_cmp_ne_u32 vcc, 0, v48
    s_cbranch_vccz Q0OK
    s_add_u32 s51, s51, 1
    s_sleep 4
    s_cmp_lt_u32 s51, 0x8000
    s_cbranch_scc1 Q0P
Q0OK:
    v_pk_add_f32 v[16:17], v[16:17], v[20:21]
    v_add_f32 v18, v18, v22
    v_pk_add_f32 v[16:17], v[16:17], v[24:25]
    v_add_f32 v18, v18, v26
    v_pk_add_f32 v[16:17], v[16:17], v[28:29]
    v_add_f32 v18, v18, v30
    v_pk_add_f32 v[16:17], v[16:17], v[32:33]
    v_add_f32 v18, v18, v34
    v_pk_add_f32 v[16:17], v[16:17], v[36:37]
    v_add_f32 v18, v18, v38
    v_pk_add_f32 v[16:17], v[16:17], v[40:41]
    v_add_f32 v18, v18, v42
    v_pk_add_f32 v[16:17], v[16:17], v[44:45]
    v_add_f32 v18, v18, v46
    v_cvt_pk_bf16_f32 v16, v16, v17
    v_cvt_pk_bf16_f32 v18, v18, v18
    ds_write_b16 v15, v16
    ds_write_b16_d16_hi v15, v16 offset:128
    ds_write_b16 v15, v18 offset:256
    s_mov_b32 s51, 0
HSP:
    s_mov_b32 s52, 1376256
    buffer_load_dwordx4 v[24:27], v88, s[16:19], s52 offen sc1
    s_waitcnt vmcnt(0)
    v_xor_b32 v20, s5, v24
    v_xor_b32 v21, s5, v25
    v_xor_b32 v22, s5, v26
    v_xor_b32 v23, s5, v27
    v_or3_b32 v20, v20, v21, v22
    v_or_b32 v20, v20, v23
    v_cmp_lt_u32 vcc, 31, v20
    s_cbranch_vccz HSOK
    s_add_u32 s51, s51, 1
    s_sleep 8
    s_cmp_lt_u32 s51, 0x8000
    s_cbranch_scc1 HSP
HSOK:
    s_mov_b32 s53, 0
    v_and_b32 v24, 16, v24
    v_cmp_ne_u32 vcc, 0, v24
    s_bcnt1_i32_b64 s52, vcc
    s_add_u32 s53, s53, s52
    v_and_b32 v25, 16, v25
    v_cmp_ne_u32 vcc, 0, v25
    s_bcnt1_i32_b64 s52, vcc
    s_add_u32 s53, s53, s52
    v_and_b32 v26, 16, v26
    v_cmp_ne_u32 vcc, 0, v26
    s_bcnt1_i32_b64 s52, vcc
    s_add_u32 s53, s53, s52
    v_and_b32 v27, 16, v27
    v_cmp_ne_u32 vcc, 0, v27
    s_bcnt1_i32_b64 s52, vcc
    s_add_u32 s53, s53, s52
    v_and_b32 v20, 15, v20
    s_cmp_gt_u32 s53, 128
    s_cselect_b32 s53, 2, 0
    s_lshr_b32 s52, s5, 1
    s_xor_b32 s53, s53, s52
    s_and_b32 s53, s53, 2
    s_lshl_b32 s52, s45, 3
    v_cmp_ne_u32 vcc, 0, v20
    s_lshr_b64 s[60:61], vcc, s52
    s_and_b32 s52, s60, 0xff
    s_cselect_b32 s50, 0, 1
    v_mov_b32 v38, 98784
    s_or_b32 s53, s53, s50
    v_or_b32 v39, s53, v89
    ds_write_b32 v38, v39
    v_and_b32 v21, 0xffff0000, v86
    v_lshlrev_b32 v20, 16, v86
    buffer_store_dwordx2 v[20:21], v87, s[16:19], 0 offen sc1
    s_branch ENTRY
HOOKE:
    s_cmp_lg_u32 s44, 3
    s_cbranch_scc1 QFRAG
    s_waitcnt lgkmcnt(0)
    s_barrier
    s_waitcnt vmcnt(26)
    buffer_load_dwordx4 a[0:3], v80, s[8:11], s96 offen offset:0 nt
    s_waitcnt vmcnt(26)
    buffer_load_dwordx4 a[8:11], v80, s[8:11], s96 offen offset:128 nt
    s_waitcnt vmcnt(26)
    buffer_load_dwordx4 a[16:19], v80, s[8:11], s96 offen offset:256 nt
    s_add_u32 s96, s96, s97
    s_waitcnt vmcnt(26)
    buffer_load_dwordx4 a[4:7], v80, s[8:11], s96 offen offset:0 nt
    s_waitcnt vmcnt(26)
    buffer_load_dwordx4 a[12:15], v80, s[8:11], s96 offen offset:128 nt
    s_waitcnt vmcnt(26)
    buffer_load_dwordx4 a[20:23], v80, s[8:11], s96 offen offset:256 nt
    s_add_u32 s96, s96, s97
    s_waitcnt vmcnt(26)
    buffer_load_dwordx4 a[24:27], v80, s[8:11], s96 offen offset:0 nt
    s_waitcnt vmcnt(26)
    buffer_load_dwordx4 a[32:35], v80, s[8:11], s96 offen offset:128 nt
    s_waitcnt vmcnt(26)
    buffer_load_dwordx4 a[40:43], v80, s[8:11], s96 offen offset:256 nt
    s_add_u32 s96, s96, s97
    s_waitcnt vmcnt(26)
    buffer_load_dwordx4 a[28:31], v80, s[8:11], s96 offen offset:0 nt
    s_waitcnt vmcnt(26)
    buffer_load_dwordx4 a[36:39], v80, s[8:11], s96 offen offset:128 nt
    s_waitcnt vmcnt(26)
    buffer_load_dwordx4 a[44:47], v80, s[8:11], s96 offen offset:256 nt
    s_add_u32 s96, s96, s97
    s_waitcnt vmcnt(26)
    buffer_load_dwordx4 a[48:51], v80, s[8:11], s96 offen offset:0 nt
    s_waitcnt vmcnt(26)
    buffer_load_dwordx4 a[56:59], v80, s[8:11], s96 offen offset:128 nt
    s_waitcnt vmcnt(26)
    buffer_load_dwordx4 a[64:67], v80, s[8:11], s96 offen offset:256 nt
    s_add_u32 s96, s96, s97
    s_waitcnt vmcnt(26)
    buffer_load_dwordx4 a[52:55], v80, s[8:11], s96 offen offset:0 nt
    s_waitcnt vmcnt(26)
    buffer_load_dwordx4 a[60:63], v80, s[8:11], s96 offen offset:128 nt
    s_waitcnt vmcnt(26)
    buffer_load_dwordx4 a[68:71], v80, s[8:11], s96 offen offset:256 nt
    s_add_u32 s96, s96, s97
    s_waitcnt vmcnt(26)
    buffer_load_dwordx4 a[72:75], v80, s[8:11], s96 offen offset:0 nt
    s_waitcnt vmcnt(26)
    buffer_load_dwordx4 a[80:83], v80, s[8:11], s96 offen offset:128 nt
    s_waitcnt vmcnt(26)
    buffer_load_dwordx4 a[88:91], v80, s[8:11], s96 offen offset:256 nt
    s_add_u32 s96, s96, s97
    s_waitcnt vmcnt(26)
    buffer_load_dwordx4 a[76:79], v80, s[8:11], s96 offen offset:0 nt
    s_waitcnt vmcnt(26)
    buffer_load_dwordx4 a[84:87], v80, s[8:11], s96 offen offset:128 nt
    s_waitcnt vmcnt(26)
    buffer_load_dwordx4 a[92:95], v80, s[8:11], s96 offen offset:256 nt
    s_add_u32 s96, s96, s97
    s_waitcnt vmcnt(26)
    buffer_load_dwordx4 a[96:99], v80, s[8:11], s96 offen offset:0 nt
    s_waitcnt vmcnt(26)
    buffer_load_dwordx4 a[104:107], v80, s[8:11], s96 offen offset:128 nt
    s_waitcnt vmcnt(26)
    buffer_load_dwordx4 a[112:115], v80, s[8:11], s96 offen offset:256 nt
    s_add_u32 s96, s96, s97
    s_waitcnt vmcnt(26)
    buffer_load_dwordx4 a[100:103], v80, s[8:11], s96 offen offset:0 nt
    s_waitcnt vmcnt(26)
    buffer_load_dwordx4 a[108:111], v80, s[8:11], s96 offen offset:128 nt
    s_waitcnt vmcnt(26)
    buffer_load_dwordx4 a[116:119], v80, s[8:11], s96 offen offset:256 nt
    s_add_u32 s96, s96, s97
    s_waitcnt vmcnt(26)
    buffer_load_dwordx4 a[120:123], v80, s[8:11], s96 offen offset:0 nt
    s_waitcnt vmcnt(26)
    buffer_load_dwordx4 a[128:131], v80, s[8:11], s96 offen offset:128 nt
    s_waitcnt vmcnt(26)
    buffer_load_dwordx4 a[136:139], v80, s[8:11], s96 offen offset:256 nt
    s_add_u32 s96, s96, s97
    s_waitcnt vmcnt(26)
    buffer_load_dwordx4 a[124:127], v80, s[8:11], s96 offen offset:0 nt
    s_waitcnt vmcnt(26)
    buffer_load_dwordx4 a[132:135], v80, s[8:11], s96 offen offset:128 nt
    s_waitcnt vmcnt(26)
    buffer_load_dwordx4 a[140:143], v80, s[8:11], s96 offen offset:256 nt
    s_add_u32 s96, s96, s97
    s_waitcnt vmcnt(26)
    buffer_load_dwordx4 a[144:147], v80, s[8:11], s96 offen offset:0 nt
    s_waitcnt vmcnt(26)
    buffer_load_dwordx4 a[152:155], v80, s[8:11], s96 offen offset:128 nt
    s_waitcnt vmcnt(26)
    buffer_load_dwordx4 a[160:163], v80, s[8:11], s96 offen offset:256 nt
    s_add_u32 s96, s96, s97
    s_waitcnt vmcnt(26)
    buffer_load_dwordx4 a[148:151], v80, s[8:11], s96 offen offset:0 nt
    s_waitcnt vmcnt(26)
    buffer_load_dwordx4 a[156:159], v80, s[8:11], s96 offen offset:128 nt
    s_waitcnt vmcnt(26)
    buffer_load_dwordx4 a[164:167], v80, s[8:11], s96 offen offset:256 nt
    s_add_u32 s96, s96, s97
    s_waitcnt vmcnt(26)
    buffer_load_dwordx4 a[168:171], v80, s[8:11], s96 offen offset:0 nt
    s_waitcnt vmcnt(26)
    buffer_load_dwordx4 a[176:179], v80, s[8:11], s96 offen offset:128 nt
    s_waitcnt vmcnt(26)
    buffer_load_dwordx4 a[184:187], v80, s[8:11], s96 offen offset:256 nt
    s_add_u32 s96, s96, s97
    s_waitcnt vmcnt(26)
    buffer_load_dwordx4 a[172:175], v80, s[8:11], s96 offen offset:0 nt
    s_waitcnt vmcnt(26)
    buffer_load_dwordx4 a[180:183], v80, s[8:11], s96 offen offset:128 nt
    s_waitcnt vmcnt(26)
    buffer_load_dwordx4 a[188:191], v80, s[8:11], s96 offen offset:256 nt
    s_lshl_b32 s97, s97, 1
    s_waitcnt vmcnt(26)
    buffer_load_dwordx4 a[192:195], v82, s[12:15], s55 offen offset:0 nt
    s_waitcnt vmcnt(26)
    buffer_load_dwordx4 a[200:203], v82, s[12:15], s55 offen offset:128 nt
    s_waitcnt vmcnt(26)
    buffer_load_dwordx4 a[208:211], v82, s[12:15], s55 offen offset:256 nt
    s_waitcnt vmcnt(26)
    buffer_load_dwordx4 a[216:219], v82, s[12:15], s55 offen offset:384 nt
    s_waitcnt vmcnt(26)
    buffer_load_dwordx4 a[224:227], v82, s[12:15], s55 offen offset:512 nt
    s_waitcnt vmcnt(26)
    buffer_load_dwordx4 a[232:235], v82, s[12:15], s55 offen offset:640 nt
    s_add_u32 s55, s55, s97
    s_waitcnt vmcnt(26)
    buffer_load_dwordx4 a[196:199], v82, s[12:15], s55 offen offset:0 nt
    s_waitcnt vmcnt(26)
    buffer_load_dwordx4 a[204:207], v82, s[12:15], s55 offen offset:128 nt
    s_waitcnt vmcnt(26)
    buffer_load_dwordx4 a[212:215], v82, s[12:15], s55 offen offset:256 nt
    s_waitcnt vmcnt(26)
    buffer_load_dwordx4 a[220:223], v82, s[12:15], s55 offen offset:384 nt
    s_waitcnt vmcnt(26)
    buffer_load_dwordx4 a[228:231], v82, s[12:15], s55 offen offset:512 nt
    s_waitcnt vmcnt(26)
    buffer_load_dwordx4 a[236:239], v82, s[12:15], s55 offen offset:640 nt
    s_add_u32 s55, s55, s97
    s_waitcnt vmcnt(26)
    buffer_load_dwordx4 a[240:243], v82, s[12:15], s55 offen offset:0 nt
    s_waitcnt vmcnt(26)
    buffer_load_dwordx4 a[248:251], v82, s[12:15], s55 offen offset:128 nt
    s_waitcnt vmcnt(26)
    buffer_load_dwordx4 v[128:131], v82, s[12:15], s55 offen offset:256 nt
    s_waitcnt vmcnt(26)
    buffer_load_dwordx4 v[136:139], v82, s[12:15], s55 offen offset:384 nt
    s_waitcnt vmcnt(26)
    buffer_load_dwordx4 v[144:147], v82, s[12:15], s55 offen offset:512 nt
    s_waitcnt vmcnt(26)
    buffer_load_dwordx4 v[152:155], v82, s[12:15], s55 offen offset:640 nt
    s_add_u32 s55, s55, s97
    s_waitcnt vmcnt(26)
    buffer_load_dwordx4 a[244:247], v82, s[12:15], s55 offen offset:0 nt
    s_waitcnt vmcnt(26)
    buffer_load_dwordx4 a[252:255], v82, s[12:15], s55 offen offset:128 nt
    s_waitcnt vmcnt(26)
    buffer_load_dwordx4 v[132:135], v82, s[12:15], s55 offen offset:256 nt
    s_waitcnt vmcnt(26)
    buffer_load_dwordx4 v[140:143], v82, s[12:15], s55 offen offset:384 nt
    s_waitcnt vmcnt(26)
    buffer_load_dwordx4 v[148:151], v82, s[12:15], s55 offen offset:512 nt
    s_waitcnt vmcnt(26)
    buffer_load_dwordx4 v[156:159], v82, s[12:15], s55 offen offset:640 nt
    s_add_u32 s55, s55, s97
    s_waitcnt vmcnt(26)
    buffer_load_dwordx4 v[160:163], v82, s[12:15], s55 offen offset:0 nt
    s_waitcnt vmcnt(26)
    buffer_load_dwordx4 v[168:171], v82, s[12:15], s55 offen offset:128 nt
    s_waitcnt vmcnt(26)
    buffer_load_dwordx4 v[176:179], v82, s[12:15], s55 offen offset:256 nt
    s_waitcnt vmcnt(26)
    buffer_load_dwordx4 v[184:187], v82, s[12:15], s55 offen offset:384 nt
    s_waitcnt vmcnt(26)
    buffer_load_dwordx4 v[192:195], v82, s[12:15], s55 offen offset:512 nt
    s_waitcnt vmcnt(26)
    buffer_load_dwordx4 v[200:203], v82, s[12:15], s55 offen offset:640 nt
    s_add_u32 s55, s55, s97
    s_waitcnt vmcnt(26)
    buffer_load_dwordx4 v[164:167], v82, s[12:15], s55 offen offset:0 nt
    s_waitcnt vmcnt(26)
    buffer_load_dwordx4 v[172:175], v82, s[12:15], s55 offen offset:128 nt
    s_waitcnt vmcnt(26)
    buffer_load_dwordx4 v[180:183], v82, s[12:15], s55 offen offset:256 nt
    s_waitcnt vmcnt(26)
    buffer_load_dwordx4 v[188:191], v82, s[12:15], s55 offen offset:384 nt
    s_waitcnt vmcnt(26)
    buffer_load_dwordx4 v[196:199], v82, s[12:15], s55 offen offset:512 nt
    s_waitcnt vmcnt(26)
    buffer_load_dwordx4 v[204:207], v82, s[12:15], s55 offen offset:640 nt
    s_add_u32 s55, s55, s97
    s_waitcnt vmcnt(26)
    buffer_load_dwordx4 v[208:211], v82, s[12:15], s55 offen offset:0 nt
    s_waitcnt vmcnt(26)
    buffer_load_dwordx4 v[216:219], v82, s[12:15], s55 offen offset:128 nt
    s_waitcnt vmcnt(26)
    buffer_load_dwordx4 v[224:227], v82, s[12:15], s55 offen offset:256 nt
    s_waitcnt vmcnt(26)
    buffer_load_dwordx4 v[232:235], v82, s[12:15], s55 offen offset:384 nt
    s_waitcnt vmcnt(26)
    buffer_load_dwordx4 v[240:243], v82, s[12:15], s55 offen offset:512 nt
    s_waitcnt vmcnt(26)
    buffer_load_dwordx4 v[248:251], v82, s[12:15], s55 offen offset:640 nt
    s_add_u32 s55, s55, s97
    s_barrier
    s_waitcnt vmcnt(26)
    buffer_load_dwordx4 v[212:215], v82, s[12:15], s55 offen offset:0 nt
    s_waitcnt vmcnt(26)
    buffer_load_dwordx4 v[220:223], v82, s[12:15], s55 offen offset:128 nt
    s_waitcnt vmcnt(26)
    buffer_load_dwordx4 v[228:231], v82, s[12:15], s55 offen offset:256 nt
    s_waitcnt vmcnt(26)
    buffer_load_dwordx4 v[236:239], v82, s[12:15], s55 offen offset:384 nt
    s_waitcnt vmcnt(26)
    buffer_load_dwordx4 v[244:247], v82, s[12:15], s55 offen offset:512 nt
    s_waitcnt vmcnt(26)
    buffer_load_dwordx4 v[252:255], v82, s[12:15], s55 offen offset:640 nt
    s_branch QFRAG
HOOKF:
    v_mov_b32 v40, 98784
    ds_read_b32 v40, v40
    s_mov_b32 s6, 0
    s_waitcnt lgkmcnt(0)
    v_readfirstlane_b32 s101, v40
    s_and_b32 s50, s101, 1
    s_and_b32 s0, s101, 2
    s_lshl_b32 s0, s0, 12
    s_and_b32 s101, s101, 0xffffffe0
    s_waitcnt vmcnt(48)
    s_branch QK
HOOKC:
    s_cmp_eq_u32 s44, 3
    s_cbranch_scc1 EXB
    v_min_u32 v83, 8, v1
    v_lshlrev_b32 v83, 7, v83
    s_mul_i32 s52, s45, 28160
    s_mul_i32 s54, s46, 1152
    s_add_u32 s52, s52, s54
    s_add_u32 s52, s52, 131072
    buffer_load_dword v83, v83, s[16:19], s52 offen sc1
    v_lshrrev_b32 v58, 3, v1
    v_and_b32 v57, 7, v1
    v_and_b32 v56, 2, v58
    v_xor_b32 v57, v57, v56
    s_and_b32 s52, s44, 1
    s_lshl_b32 s52, s52, 2
    v_xor_b32 v57, s52, v57
    v_mul_u32_u24 v56, 3072, v58
    v_lshl_add_u32 v56, v57, 4, v56
    v_lshrrev_b32 v58, 3, v1
    v_and_b32 v57, 7, v1
    v_and_b32 v55, 2, v58
    v_xor_b32 v57, v57, v55
    s_and_b32 s52, s44, 1
    s_lshl_b32 s52, s52, 2
    v_xor_b32 v57, s52, v57
    v_mul_u32_u24 v55, 1280, v58
    v_lshl_add_u32 v55, v57, 4, v55
    s_barrier
    s_cmp_ge_u32 s46, 20
    s_cbranch_scc1 HC8
    s_mul_i32 s52, s45, 983040
    s_mul_i32 s54, s56, 491520
    s_add_u32 s52, s52, s54
    s_lshl_b32 s54, s57, 7
    s_add_u32 s52, s52, s54
    s_mul_i32 s54, s44, 10240
    s_add_u32 s52, s52, s54
    s_lshl_b32 s53, s44, 10
DMA1:
    s_mov_b32 m0, s53
    s_add_u32 s53, s53, 3072
    buffer_load_dwordx4 v55, s[24:27], s52 offen nt lds
    v_xor_b32 v55, 64, v55
    s_add_u32 s52, s52, 30720
    s_cmp_lt_u32 s53, 49152
    s_cbranch_scc1 DMA1
HC8:
    s_cmp_ge_u32 s46, 30
    s_cbranch_scc1 HC7
    s_mul_i32 s52, s3, 393216
    s_mul_i32 s54, s45, 384
    s_add_u32 s52, s52, s54
    s_lshl_b32 s54, s59, 7
    s_add_u32 s52, s52, s54
    s_mul_i32 s54, s44, 24576
    s_add_u32 s52, s52, s54
    s_lshl_b32 s53, s44, 10
    s_add_u32 s53, s53, 49152
DMA2:
    s_mov_b32 m0, s53
    s_add_u32 s53, s53, 3072
    buffer_load_dwordx4 v56, s[28:31], s52 offen nt lds
    v_xor_b32 v56, 64, v56
    s_add_u32 s52, s52, 73728
    s_cmp_lt_u32 s53, 65536
    s_cbranch_scc1 DMA2
    s_cmp_lt_u32 s46, 20
    s_cbranch_scc1 HC9
HC7:
    s_sub_u32 s53, s46, 20
    s_cmp_ge_u32 s53, 6
    s_cselect_b32 s51, 240, 0
    v_lshlrev_b32 v55, 4, v1
    s_mul_i32 s52, s45, 983040
    s_mul_i32 s54, s53, 30720
    s_add_u32 s52, s52, s54
    s_mul_i32 s54, s51, 1280
    s_add_u32 s52, s52, s54
    s_lshl_b32 s54, s44, 10
    s_add_u32 s52, s52, s54
    s_add_u32 s52, s52, 307200
    s_lshl_b32 s53, s44, 10
    s_add_u32 s53, s53, 24576
    s_mov_b32 m0, s53
    s_nop 0
    buffer_load_dwordx4 v55, s[32:35], s52 offen lds
    s_add_u32 s52, s52, 3072
    buffer_load_dwordx4 v55, s[32:35], s52 offen lds
    s_add_u32 s52, s52, 3072
    buffer_load_dwordx4 v55, s[32:35], s52 offen lds
    s_add_u32 s52, s52, 3072
    buffer_load_dwordx4 v55, s[32:35], s52 offen lds
    s_add_u32 s52, s52, 3072
    buffer_load_dwordx4 v55, s[32:35], s52 offen lds
    s_add_u32 s52, s52, 3072
    buffer_load_dwordx4 v55, s[32:35], s52 offen lds
    s_add_u32 s52, s52, 3072
    buffer_load_dwordx4 v55, s[32:35], s52 offen lds
    s_add_u32 s52, s52, 3072
    buffer_load_dwordx4 v55, s[32:35], s52 offen lds
    s_add_u32 s52, s52, 3072
    buffer_load_dwordx4 v55, s[32:35], s52 offen lds
    s_add_u32 s52, s52, 3072
    buffer_load_dwordx4 v55, s[32:35], s52 offen lds
    s_add_u32 s52, s52, 3072
HC9:
    s_branch EXB
HOOKG:
    v_and_b32 v71, 3, v1
    v_lshlrev_b32 v71, 3, v71
    v_bfe_u32 v72, v1, 2, 2
    v_lshl_add_u32 v71, v72, 7, v71
    v_lshrrev_b32 v72, 4, v1
    v_lshl_add_u32 v71, v72, 10, v71
    v_bfe_u32 v72, v1, 3, 2
    v_lshl_add_u32 v71, v72, 5, v71
    s_mul_i32 s52, s44, 12288
    v_add_u32 v71, s52, v71
    v_xor_b32 v72, 32, v71
    v_xor_b32 v73, 64, v71
    v_xor_b32 v74, 96, v71
    v_lshrrev_b32 v14, 5, v1
    v_lshlrev_b32 v14, 11, v14
    v_and_b32 v15, 31, v1
    v_lshl_add_u32 v14, v15, 2, v14
    s_lshr_b32 s53, s57, 1
    s_lshl_b32 s52, s57, 12
    s_lshl_b32 s54, s53, 13
    s_add_u32 s52, s52, s54
    s_lshl_b32 s54, s45, 8
    s_add_u32 s52, s52, s54
    s_lshl_b32 s54, s56, 7
    s_add_u32 s52, s52, s54
    v_add_u32 v14, s52, v14
    s_xor_b32 s1, s0, 8192
    s_add_u32 s1, s1, s49
    s_add_u32 s99, s0, s49
    s_lshl_b32 s52, s44, 9
    s_add_u32 s52, s52, 104960
    v_lshl_add_u32 v15, v15, 4, s52
    v_and_b32 v64, 15, v1
    v_lshlrev_b32 v64, 4, v64
    v_lshl_add_u32 v64, v31, 2, v64
    v_add_u32 v64, 104960, v64
    s_cmp_lg_u32 s44, 3
    s_cbranch_scc1 QCNA
    v_lshlrev_b32 v38, 2, v1
    v_add_u32 v39, 107520, v38
    v_lshlrev_b32 v38, 1, v38
    ds_read_b32 v32, v39 offset:0
    ds_read_b32 v34, v39 offset:256
    ds_read_b32 v36, v39 offset:512
    s_mul_i32 s52, s47, 12288
    s_mul_i32 s54, s48, 1536
    s_add_u32 s52, s52, s54
    s_add_u32 s52, s52, 1441792
    s_waitcnt lgkmcnt(0)
    v_xor_b32 v33, s101, v32
    v_xor_b32 v35, s101, v34
    v_xor_b32 v37, s101, v36
    s_cmp_eq_u32 s50, 0
    s_cbranch_scc1 SLOW3
    buffer_store_dwordx2 v[32:33], v38, s[16:19], s52 offen offset:0
    buffer_store_dwordx2 v[34:35], v38, s[16:19], s52 offen offset:512
    buffer_store_dwordx2 v[36:37], v38, s[16:19], s52 offen offset:1024
PUBD3:
    s_branch QCMA
QCNA:
    s_waitcnt vmcnt(1)
QCMA:
    s_barrier
    s_branch WO0
HOOKG2:
    ds_read_b64_tr_b16 v[80:81], v71 offset:0
    ds_read_b64_tr_b16 v[82:83], v71 offset:512
    ds_read_b64_tr_b16 v[96:97], v71 offset:4096
    ds_read_b64_tr_b16 v[98:99], v71 offset:4608
    ds_read_b64_tr_b16 v[112:113], v71 offset:8192
    ds_read_b64_tr_b16 v[114:115], v71 offset:8704
    ds_read_b64_tr_b16 v[84:85], v72 offset:0
    ds_read_b64_tr_b16 v[86:87], v72 offset:512
    ds_read_b64_tr_b16 v[100:101], v72 offset:4096
    ds_read_b64_tr_b16 v[102:103], v72 offset:4608
    ds_read_b64_tr_b16 v[116:117], v72 offset:8192
    ds_read_b64_tr_b16 v[118:119], v72 offset:8704
    ds_read_b64_tr_b16 v[88:89], v73 offset:0
    ds_read_b64_tr_b16 v[90:91], v73 offset:512
    ds_read_b64_tr_b16 v[104:105], v73 offset:4096
    ds_read_b64_tr_b16 v[106:107], v73 offset:4608
    ds_read_b64_tr_b16 v[120:121], v73 offset:8192
    ds_read_b64_tr_b16 v[122:123], v73 offset:8704
    ds_read_b64_tr_b16 v[92:93], v74 offset:0
    ds_read_b64_tr_b16 v[94:95], v74 offset:512
    ds_read_b64_tr_b16 v[108:109], v74 offset:4096
    ds_read_b64_tr_b16 v[110:111], v74 offset:4608
    ds_read_b64_tr_b16 v[124:125], v74 offset:8192
    ds_read_b64_tr_b16 v[126:127], v74 offset:8704
    s_waitcnt lgkmcnt(0)
    s_branch WOP
HOOKG3:
    s_cmp_lg_u32 s49, 0
    s_cbranch_scc1 WOX
    s_cmp_lg_u32 s44, 3
    s_cbranch_scc1 QCNB
    v_lshlrev_b32 v38, 2, v1
    v_add_u32 v39, 107520, v38
    v_lshlrev_b32 v38, 1, v38
    ds_read_b32 v32, v39 offset:0
    ds_read_b32 v34, v39 offset:256
    ds_read_b32 v36, v39 offset:512
    s_mul_i32 s52, s47, 12288
    s_mul_i32 s54, s48, 1536
    s_add_u32 s52, s52, s54
    s_add_u32 s52, s52, 1441792
    s_waitcnt lgkmcnt(0)
    v_xor_b32 v33, s101, v32
    v_xor_b32 v35, s101, v34
    v_xor_b32 v37, s101, v36
    s_cmp_eq_u32 s50, 0
    s_cbranch_scc1 SLOW4
    buffer_store_dwordx2 v[32:33], v38, s[16:19], s52 offen offset:0
    buffer_store_dwordx2 v[34:35], v38, s[16:19], s52 offen offset:512
    buffer_store_dwordx2 v[36:37], v38, s[16:19], s52 offen offset:1024
PUBD4:
    s_branch QCMB
QCNB:
    s_waitcnt vmcnt(1)
QCMB:
    s_barrier
    s_cmp_lg_u32 s46, 31
    s_cbranch_scc1 EW1
    s_cmp_lg_u32 s44, 0
    s_cbranch_scc1 WOX
    v_and_b32 v32, 31, v1
    v_lshlrev_b32 v32, 2, v32
    v_add_u32 v32, 19968, v32
    s_mov_b32 s51, 0
    s_lshl_b32 s52, s45, 7
    s_add_u32 s52, s52, 118784
    v_lshlrev_b32 v34, 13, v1
EWP:
    buffer_load_dword v33, v32, s[16:19], s62 offen sc1
    s_waitcnt vmcnt(0)
    v_cmp_u_f32 vcc, v33, v33
    s_cbranch_vccz EWOK
    s_add_u32 s51, s51, 1
    s_cmp_lt_u32 s51, 0x8000
    s_cbranch_scc1 EWP
EWOK:
    s_mov_b64 exec, 3
    buffer_store_dword v34, v34, s[16:19], s52 offen sc1
    s_mov_b64 exec, -1
EW1:
    s_cmp_ge_u32 s46, 30
    s_cbranch_scc1 WOX
    s_cmp_eq_u32 s44, 3
    s_cbranch_scc1 HD0
    v_lshrrev_b32 v33, 3, v1
    v_and_b32 v32, 7, v1
    v_and_b32 v34, 2, v33
    v_xor_b32 v32, v32, v34
    s_and_b32 s52, s44, 1
    s_lshl_b32 s52, s52, 2
    v_xor_b32 v32, s52, v32
    v_mul_u32_u24 v34, 1280, v33
    v_lshl_add_u32 v34, v32, 4, v34
    s_mul_i32 s52, s45, 245760
    s_lshl_b32 s54, s57, 7
    s_add_u32 s52, s52, s54
    s_mul_i32 s54, s44, 10240
    s_add_u32 s52, s52, s54
    s_lshl_b32 s53, s44, 10
DMA3:
    s_mov_b32 m0, s53
    s_add_u32 s53, s53, 3072
    buffer_load_dwordx4 v34, s[24:27], s52 offen nt lds
    v_xor_b32 v34, 64, v34
    s_add_u32 s52, s52, 30720
    s_cmp_lt_u32 s53, 24576
    s_cbranch_scc1 DMA3
HD0:
    v_mov_b64 v[36:37], -1
    v_mov_b64 v[38:39], -1
    v_mov_b32 v43, 1879048192
    s_mul_i32 s52, s57, 5120
    s_mul_i32 s54, s44, 1280
    s_add_u32 s52, s52, s54
    v_lshl_add_u32 v40, v1, 4, s52
    s_add_u32 s52, s52, 1024
    v_lshl_add_u32 v41, v1, 2, s52
    v_cmp_gt_u32 vcc, 45312, v40
    s_lshl_b32 s52, s57, 14
    s_lshl_b32 s54, s45, 11
    s_add_u32 s52, s52, s54
    s_lshl_b32 s54, s44, 9
    s_add_u32 s52, s52, s54
    v_cndmask_b32 v40, v43, v40, vcc
    v_cmp_gt_u32 vcc, 45312, v41
    v_lshl_add_u32 v42, v1, 3, s52
    s_mov_b32 s52, 393216
    v_cndmask_b32 v41, v43, v41, vcc
    v_cmp_gt_u32 vcc, 136192, v42
    s_nop 1
    v_cndmask_b32 v42, v43, v42, vcc
    s_cmp_eq_u32 s50, 0
    s_cbranch_scc1 SLOW5
    buffer_store_dwordx4 v[36:39], v40, s[16:19], s63 offen
    buffer_store_dword v36, v41, s[16:19], s63 offen
PUBD5:
    buffer_store_dwordx2 v[36:37], v42, s[16:19], s52 offen sc1
    s_branch F1E
HOOKD:
    ds_read_b128 v[20:23], v2 offset:256
    ds_read_b128 v[24:27], v2 offset:320
    ds_read_b128 v[28:31], v2 offset:384
    ds_read_b128 v[32:35], v2 offset:448
    s_waitcnt lgkmcnt(0)
    v_mfma_f32_16x16x32_bf16 v[40:43], v[20:23], v[64:67], 0
    v_mfma_f32_16x16x32_bf16 v[40:43], v[24:27], v[68:71], v[40:43]
    v_mfma_f32_16x16x32_bf16 v[40:43], v[28:31], v[72:75], v[40:43]
    v_mfma_f32_16x16x32_bf16 v[40:43], v[32:35], v[76:79], v[40:43]
    s_add_u32 s53, s62, 20480
    s_mov_b64 exec, 0xffff
    s_nop 5
    s_cmp_eq_u32 s50, 0
    s_cbranch_scc1 SLOW6
    buffer_store_dword v41, v14, s[16:19], s53 offen
PUBD6:
    s_mov_b64 exec, -1
    v_and_b32 v16, 7, v1
    v_lshlrev_b32 v16, 7, v16
    s_add_u32 s52, s0, 118784
    s_mov_b32 s51, 0
EWQ:
    buffer_load_dword v17, v16, s[16:19], s52 offen sc1
    s_waitcnt vmcnt(0)
    v_cmp_u_f32 vcc, v17, v17
    s_cbranch_vccz EWQK
    s_add_u32 s51, s51, 1
    s_sleep 1
    s_cmp_lt_u32 s51, 0x8000
    s_cbranch_scc1 EWQ
EWQK:
    s_sleep 1
    s_cmp_lt_u32 s46, 20
    s_cbranch_scc1 F1S
    s_mov_b32 s100, 3
    s_branch F1S
HOOKH:
    s_add_u32 s52, s62, 8192
    buffer_load_dwordx4 v[104:107], v52, s[16:19], s52 offen offset:0 sc1
    buffer_load_dwordx4 v[108:111], v52, s[16:19], s52 offen offset:3072 sc1
    buffer_load_dwordx2 v[112:113], v54, s[16:19], s52 offen sc1
    s_branch F1W
GCP:
    s_add_u32 s52, s62, 8192
    buffer_load_dwordx4 v[104:107], v52, s[16:19], s52 offen offset:0 sc1
    buffer_load_dwordx4 v[108:111], v52, s[16:19], s52 offen offset:3072 sc1
    buffer_load_dwordx2 v[112:113], v54, s[16:19], s52 offen sc1
    s_waitcnt vmcnt(0)
HOOKI:
    v_pk_add_f32 v[104:105], v[104:105], v[106:107]
    v_pk_add_f32 v[108:109], v[108:109], v[110:111]
    v_add_f32 v126, v104, v105
    v_add_f32 v127, v108, v109
    v_pk_add_f32 v[126:127], v[126:127], v[112:113]
    v_cmp_u_f32 vcc, v126, v127
    s_cbranch_vccz GCOK
    s_add_u32 s51, s51, 1
    s_cmp_lt_u32 s51, 0x8000
    s_cbranch_scc1 GCP
GCOK:
    ds_read_b64_tr_b16 v[80:81], v61 offset:0
    ds_read_b64_tr_b16 v[82:83], v61 offset:512
    ds_read_b64_tr_b16 v[84:85], v61 offset:4096
    ds_read_b64_tr_b16 v[86:87], v61 offset:4608
    ds_read_b64_tr_b16 v[88:89], v61 offset:8192
    ds_read_b64_tr_b16 v[90:91], v61 offset:8704
    ds_read_b64_tr_b16 v[92:93], v61 offset:12288
    ds_read_b64_tr_b16 v[94:95], v61 offset:12800
    ds_read_b64_tr_b16 v[96:97], v61 offset:16384
    ds_read_b64_tr_b16 v[98:99], v61 offset:16896
    ds_read_b64_tr_b16 v[100:101], v61 offset:20480
    ds_read_b64_tr_b16 v[102:103], v61 offset:20992
    s_branch W2P
SLOW0:
    buffer_store_dword v30, v28, s[16:19], s49 offen sc1
    s_branch PUBD0
SLOW1:
    buffer_store_dword v16, v14, s[16:19], s62 offen offset:0 sc1
    buffer_store_dword v20, v14, s[16:19], s62 offen offset:1024 sc1
    buffer_store_dword v24, v14, s[16:19], s62 offen offset:2048 sc1
    s_mov_b64 exec, 1
    buffer_store_dwordx2 v[28:29], v15, s[16:19], s62 offen sc1
    s_branch PUBD1
SLOW2:
    buffer_store_dword v24, v14, s[16:19], s62 offen sc1
    s_branch PUBD2
SLOW3:
    buffer_store_dwordx2 v[32:33], v38, s[16:19], s52 offen offset:0 sc1
    buffer_store_dwordx2 v[34:35], v38, s[16:19], s52 offen offset:512 sc1
    buffer_store_dwordx2 v[36:37], v38, s[16:19], s52 offen offset:1024 sc1
    s_branch PUBD3
SLOW4:
    buffer_store_dwordx2 v[32:33], v38, s[16:19], s52 offen offset:0 sc1
    buffer_store_dwordx2 v[34:35], v38, s[16:19], s52 offen offset:512 sc1
    buffer_store_dwordx2 v[36:37], v38, s[16:19], s52 offen offset:1024 sc1
    s_branch PUBD4
SLOW5:
    buffer_store_dwordx4 v[36:39], v40, s[16:19], s63 offen sc1
    buffer_store_dword v36, v41, s[16:19], s63 offen sc1
    s_branch PUBD5
SLOW6:
    buffer_store_dword v41, v14, s[16:19], s53 offen sc1
    s_branch PUBD6
SLOW7:
    buffer_store_dword v16, v56, s[16:19], s49 offen sc1
    s_branch PUBD7
SLOW8:
    buffer_store_dword v40, v14, s[16:19], s62 offen sc1
    s_mov_b64 exec, 1
    buffer_store_dwordx2 v[44:45], v15, s[16:19], s62 offen sc1
    s_branch PUBD8
CODEEND:
    s_endpgm
.section .rodata,"a"
.p2align 6
.amdhsa_kernel interleave_layers__sliding_block_cached__glu_gated_swiglu__decode_kernel
  .amdhsa_next_free_vgpr 512
  .amdhsa_next_free_sgpr 102
  .amdhsa_accum_offset 256
  .amdhsa_group_segment_fixed_size 0
  .amdhsa_kernarg_size 96
  .amdhsa_user_sgpr_count 2
  .amdhsa_user_sgpr_kernarg_segment_ptr 1
  .amdhsa_system_sgpr_workgroup_id_x 1
.end_amdhsa_kernel
```

```asm
; @launch grid=(256,1,1) block=(256,1,1) lds=108288
.amdgcn_target "amdgcn-amd-amdhsa--gfx950"
.text
.globl interleave_layers__sliding_block_cached__glu_gated_swiglu__decode_kernel
.p2align 8
.type interleave_layers__sliding_block_cached__glu_gated_swiglu__decode_kernel,@function
interleave_layers__sliding_block_cached__glu_gated_swiglu__decode_kernel:
    s_cmp_ge_u32 s2, 256
    s_cbranch_scc1 DONE
    s_load_dwordx16 s[64:79], s[0:1], 0
    s_load_dwordx8 s[80:87], s[0:1], 64
    s_memrealtime s[98:99]
    s_getpc_b64 s[60:61]
PCREF:
    v_lshlrev_b32 v14, 7, v0
    v_cmp_gt_u32 vcc, CODEEND-PCREF, v14
    v_mov_b32 v15, s61
    s_and_saveexec_b64 s[88:89], vcc
    s_cbranch_execz NOPF
    v_add_co_u32 v14, vcc, s60, v14
    s_nop 1
    v_addc_co_u32 v15, vcc, 0, v15, vcc
    global_load_dword v79, v[14:15], off
NOPF:
    s_mov_b64 exec, s[88:89]
    v_and_b32 v1, 63, v0
    v_lshrrev_b32 v13, 6, v0
    s_and_b32 s45, s2, 7
    v_readfirstlane_b32 s44, v13
    s_lshr_b32 s46, s2, 3
    s_lshr_b32 s7, s46, 3
    s_lshl_b32 s52, s45, 2
    s_add_u32 s47, s7, s52
    s_and_b32 s48, s46, 7
    v_lshrrev_b32 v19, 4, v1
    v_bfe_u32 v21, v1, 1, 3
    v_and_b32 v20, 1, v1
    v_mul_u32_u24 v80, 384, v21
    v_lshl_add_u32 v80, v20, 4, v80
    v_lshl_add_u32 v80, v19, 5, v80
    s_mul_i32 s52, s48, 3
    s_lshl_b32 s54, s44, 0
    s_add_u32 s52, s52, s54
    s_add_u32 s53, s48, 384
    s_cmp_eq_u32 s44, 3
    s_cselect_b32 s52, s53, s52
    s_cselect_b32 s97, 8, 24
    s_mulk_i32 s97, 3072
    s_mul_i32 s55, s47, 12582912
    s_mul_i32 s54, s52, 3072
    s_add_u32 s55, s55, s54
    s_add_u32 s55, s55, 11010048
    s_mov_b32 s96, s55
    s_waitcnt lgkmcnt(0)
    s_mov_b32 s8, s66
    s_and_b32 s9, s67, 0xffff
    s_mov_b32 s10, 402653184
    s_mov_b32 s11, 0x20000
    s_mov_b32 s6, 1
    s_mov_b32 s100, 0
    s_cmp_eq_u32 s44, 3
    s_cbranch_scc1 SETUP
    buffer_load_dwordx4 a[0:3], v80, s[8:11], s96 offen offset:0 nt
    buffer_load_dwordx4 a[8:11], v80, s[8:11], s96 offen offset:128 nt
    buffer_load_dwordx4 a[16:19], v80, s[8:11], s96 offen offset:256 nt
    s_add_u32 s96, s96, s97
    buffer_load_dwordx4 a[4:7], v80, s[8:11], s96 offen offset:0 nt
    buffer_load_dwordx4 a[12:15], v80, s[8:11], s96 offen offset:128 nt
    buffer_load_dwordx4 a[20:23], v80, s[8:11], s96 offen offset:256 nt
    s_add_u32 s96, s96, s97
SETUP:
    s_mov_b32 s16, s86
    s_and_b32 s17, s87, 0xffff
    s_mov_b32 s18, 1610612736
    s_mov_b32 s19, 0x20000
    s_mov_b32 s12, s68
    s_and_b32 s13, s69, 0xffff
    s_mov_b32 s14, 402653184
    s_mov_b32 s15, 0x20000
    s_mov_b32 s20, s70
    s_and_b32 s21, s71, 0xffff
    s_mov_b32 s22, 7864320
    s_mov_b32 s23, 0x20000
    s_mov_b32 s32, s64
    s_and_b32 s33, s65, 0xffff
    s_mov_b32 s34, 1280
    s_mov_b32 s35, 0x20000
    s_mov_b32 s36, s82
    s_and_b32 s37, s83, 0xffff
    s_mov_b32 s38, 1280
    s_mov_b32 s39, 0x20000
    s_mov_b32 s40, s84
    s_and_b32 s41, s85, 0xffff
    s_mov_b32 s42, 256
    s_mov_b32 s43, 0x20000
    v_mov_b32 v87, 1879048192
    v_mov_b32 v88, 1879048192
    v_mov_b32 v120, 1879048192
    v_mov_b32 v121, 1879048192
    v_mov_b32 v122, 1879048192
    s_cmp_lg_u32 s44, 3
    s_cbranch_scc1 SETUP2
    v_mov_b32 v32, -1
    v_mov_b32 v33, -1
    v_mov_b32 v34, -1
    v_mov_b32 v35, -1
    s_cmp_lg_u32 s2, 0
    s_cbranch_scc1 NONW
    s_or_b32 s101, s98, 0x20
    s_and_b32 s101, s101, 0xffffffe0
    v_mov_b32 v24, s101
    v_mov_b32 v25, 0
    s_mov_b64 exec, 1
    buffer_store_dword v24, v25, s[40:43], 0 offen sc1
    s_mov_b64 exec, -1
NONW:
    v_lshlrev_b32 v24, 4, v1
    v_lshlrev_b32 v27, 2, v1
    s_mul_i32 s52, s2, 1536
    v_lshlrev_b32 v28, 3, v1
    buffer_store_dwordx4 v[32:35], v24, s[16:19], s52 offen sc1
    buffer_store_dwordx2 v[32:33], v28, s[16:19], s52 offen offset:1024 sc1
    v_mov_b32 v26, 1879048192
    v_mov_b32 v88, v24
    v_cmp_gt_u32 vcc, 40, v1
    v_lshlrev_b32 v27, 2, v1
    buffer_load_dwordx4 v[44:47], v24, s[32:35], 0 offen
    buffer_load_dword v48, v27, s[32:35], 0 offen offset:1024
    v_cndmask_b32 v28, v26, v27, vcc
    s_mul_i32 s52, s48, 160
    buffer_load_dword v86, v28, s[32:35], s52 offen
    s_mul_i32 s52, s48, 320
    s_add_u32 s52, s52, 131072
    s_and_b32 s53, s2, 0xc7
    s_cmp_eq_u32 s53, 0
    s_cselect_b32 s52, s52, 1879048192
    v_lshl_add_u32 v87, v1, 3, s52
    v_cndmask_b32 v87, v26, v87, vcc
    v_add_u32 v24, 0, v1
    v_mul_u32_u24 v36, 171, v24
    v_lshrrev_b32 v36, 12, v36
    v_mul_u32_u24 v37, 24, v36
    v_sub_u32 v37, v24, v37
    v_and_b32 v24, 2, v36
    v_xor_b32 v37, v37, v24
    v_mul_u32_u24 v36, 12288, v36
    v_lshl_add_u32 v38, v37, 4, v36
    v_add_u32 v24, 64, v1
    v_mul_u32_u24 v36, 171, v24
    v_lshrrev_b32 v36, 12, v36
    v_mul_u32_u24 v37, 24, v36
    v_sub_u32 v37, v24, v37
    v_and_b32 v24, 2, v36
    v_xor_b32 v37, v37, v24
    v_mul_u32_u24 v36, 12288, v36
    v_lshl_add_u32 v39, v37, 4, v36
    v_add_u32 v24, 128, v1
    v_mul_u32_u24 v36, 171, v24
    v_lshrrev_b32 v36, 12, v36
    v_mul_u32_u24 v37, 24, v36
    v_sub_u32 v37, v24, v37
    v_and_b32 v24, 2, v36
    v_xor_b32 v37, v37, v24
    v_mul_u32_u24 v36, 12288, v36
    v_lshl_add_u32 v40, v37, 4, v36
    s_mul_i32 s52, s48, 983040
    s_mul_i32 s54, s47, 384
    s_add_u32 s52, s52, s54
    s_mov_b32 s53, 65536
WQL:
    s_add_u32 m0, s53, 0
    s_nop 0
    buffer_load_dwordx4 v38, s[20:23], s52 offen nt lds
    v_xor_b32 v38, 64, v38
    s_add_u32 m0, s53, 1024
    s_nop 0
    buffer_load_dwordx4 v39, s[20:23], s52 offen nt lds
    v_xor_b32 v39, 64, v39
    s_add_u32 m0, s53, 2048
    s_nop 0
    buffer_load_dwordx4 v40, s[20:23], s52 offen nt lds
    v_xor_b32 v40, 64, v40
    s_add_u32 s52, s52, 98304
    s_add_u32 s53, s53, 3072
    s_cmp_lt_u32 s53, 96256
    s_cbranch_scc1 WQL
    v_mov_b32 v37, 0
    buffer_load_dword v89, v37, s[40:43], 0 offen sc1
    s_barrier
    s_waitcnt vmcnt(31)
    v_mov_b32 v36, 0x3f803f80
    v_mov_b32 v37, v36
    v_cndmask_b32 v36, 0, v36, vcc
    v_add_u32 v27, 96256, v27
    ds_write_b32 v27, v36 offset:1024
    ds_write_b32 v27, v37 offset:1280
    ds_write_b32 v27, v86
    v_mov_b64 v[36:37], 0
    ds_write_b32 v27, v36 offset:10752
    ds_write_b32 v27, v36 offset:11008
    v_mov_b32 v38, 0x3f803f80
    v_dot2_f32_bf16 v36, v44, v44, v36
    v_dot2_f32_bf16 v37, v44, v38, v37
    v_dot2_f32_bf16 v36, v45, v45, v36
    v_dot2_f32_bf16 v37, v45, v38, v37
    v_dot2_f32_bf16 v36, v46, v46, v36
    v_dot2_f32_bf16 v37, v46, v38, v37
    v_dot2_f32_bf16 v36, v47, v47, v36
    v_dot2_f32_bf16 v37, v47, v38, v37
    v_dot2_f32_bf16 v36, v48, v48, v36
    v_dot2_f32_bf16 v37, v48, v38, v37
    s_nop 2
    v_add_f32_dpp v36, v36, v36 quad_perm:[1,0,3,2] row_mask:0xf bank_mask:0xf
    v_add_f32_dpp v37, v37, v37 quad_perm:[1,0,3,2] row_mask:0xf bank_mask:0xf
    s_nop 0
    v_add_f32_dpp v36, v36, v36 quad_perm:[2,3,0,1] row_mask:0xf bank_mask:0xf
    v_add_f32_dpp v37, v37, v37 quad_perm:[2,3,0,1] row_mask:0xf bank_mask:0xf
    s_nop 0
    v_add_f32_dpp v36, v36, v36 row_half_mirror row_mask:0xf bank_mask:0xf
    v_add_f32_dpp v37, v37, v37 row_half_mirror row_mask:0xf bank_mask:0xf
    s_nop 0
    v_add_f32_dpp v36, v36, v36 row_mirror row_mask:0xf bank_mask:0xf
    v_add_f32_dpp v37, v37, v37 row_mirror row_mask:0xf bank_mask:0xf
    s_nop 0
    v_mov_b32 v39, v36
    s_nop 1
    v_permlane16_swap_b32 v36, v39
    v_add_f32 v36, v36, v39
    v_mov_b32 v39, v37
    s_nop 1
    v_permlane16_swap_b32 v37, v39
    v_add_f32 v37, v37, v39
    v_mov_b32 v39, v36
    s_nop 1
    v_permlane32_swap_b32 v36, v39
    v_add_f32 v36, v36, v39
    v_mov_b32 v39, v37
    s_nop 1
    v_permlane32_swap_b32 v37, v39
    v_add_f32 v37, v37, v39
    v_mov_b32 v39, 0x3727c5ac
    v_mul_f32 v37, 0x3acccccd, v37
    v_fmamk_f32 v36, v36, 0x3acccccd, v39
    v_fma_f32 v36, -v37, v37, v36
    v_rsq_f32 v36, v36
    v_mov_b32 v84, v37
    v_mul_f32 v85, 0x3dd53b94, v36
SETUP2:
    s_mov_b32 s32, s72
    s_and_b32 s33, s73, 0xffff
    s_mov_b32 s34, 7864320
    s_mov_b32 s35, 0x20000
    s_cmp_ge_u32 s46, 10
    s_cselect_b32 s56, 1, 0
    s_cmp_ge_u32 s46, 20
    s_cselect_b32 s52, 2, s56
    s_mul_i32 s52, s52, 10
    s_sub_u32 s57, s46, s52
    s_min_u32 s4, s46, 29
    s_cmp_ge_u32 s4, 15
    s_cselect_b32 s58, 1, 0
    s_mul_i32 s52, s58, 15
    s_sub_u32 s52, s4, s52
    s_mul_i32 s59, s52, 52
    s_lshr_b32 s59, s59, 8
    s_mul_i32 s53, s59, 5
    s_sub_u32 s3, s52, s53
    s_cmp_ge_u32 s46, 20
    s_cselect_b32 s24, s80, s72
    s_cselect_b32 s25, s81, s73
    s_mov_b32 s26, 7864320
    s_cselect_b32 s26, 1966080, s26
    s_and_b32 s25, s25, 0xffff
    s_mov_b32 s27, 0x20000
    s_cmp_eq_u32 s58, 1
    s_cselect_b32 s28, s78, s76
    s_cselect_b32 s29, s79, s77
    s_and_b32 s29, s29, 0xffff
    s_mov_b32 s30, 1966080
    s_mov_b32 s31, 0x20000
    s_mov_b32 s49, 0
    s_mul_i32 s63, s45, 45312
    s_add_u32 s63, s63, 529408
    s_mul_i32 s62, s45, 28160
    s_add_u32 s62, s62, 136192
    s_mov_b32 s50, 0
    s_mov_b32 s0, 0
    v_and_b32 v24, 15, v1
    v_cmp_eq_u32 vcc, 1, v24
    v_mov_b32 v25, 96256
    v_mov_b32 v26, 97280
    v_cndmask_b32 v2, v25, v26, vcc
    v_lshl_add_u32 v2, v19, 4, v2
    v_and_b32 v24, 3, v1
    v_lshlrev_b32 v24, 4, v24
    v_and_b32 v25, 1, v19
    v_lshl_add_u32 v24, v25, 6, v24
    v_add_u32 v24, 98304, v24
    v_bfe_u32 v25, v1, 2, 2
    v_lshrrev_b32 v27, 5, v1
    v_sub_u32 v25, v25, v27
    v_mov_b32 v26, 107008
    v_cmp_eq_u32 vcc, 0, v25
    s_nop 1
    v_cndmask_b32 v3, v26, v24, vcc
    v_cmp_eq_u32 vcc, 2, v25
    s_nop 1
    v_cndmask_b32 v4, v26, v24, vcc
    v_and_b32 v24, 3, v1
    v_cmp_eq_u32 vcc, 3, v24
    v_mov_b32 v25, 0xffff
    v_mov_b32 v26, 0xffff0000
    v_cndmask_b32 v25, v25, v26, vcc
    v_cndmask_b32 v24, v24, 0, vcc
    v_or_b32 v24, 12, v24
    v_mul_u32_u24 v24, 0x1111, v24
    v_mul_u32_u24 v26, 0xaaaa, v20
    v_add_u32 v26, 0x4444, v26
    v_lshl_add_u32 v7, v24, 16, v26
    v_and_b32 v24, 4, v1
    v_cmp_eq_u32 vcc, 0, v24
    s_nop 1
    v_cndmask_b32 v5, 0, v25, vcc
    v_cndmask_b32 v6, v25, 0, vcc
    v_mul_u32_u24 v82, s97, v27
    v_bfe_u32 v24, v1, 3, 1
    v_mul_u32_u24 v24, 1536, v24
    v_add_u32 v82, v82, v24
    v_and_b32 v24, 1, v19
    v_mul_u32_u24 v24, 768, v24
    v_add_u32 v82, v82, v24
    v_and_b32 v24, 7, v1
    v_lshl_add_u32 v82, v24, 4, v82
    s_mul_i32 s52, s7, 6144
    s_add_u32 s52, s52, 20480
    v_lshl_add_u32 v8, v0, 4, s52
    s_lshl_b32 s52, s7, 6
    s_add_u32 s52, s52, 45056
    v_lshl_add_u32 v9, v24, 3, s52
    v_and_b32 v10, 0xe1, v0
    v_lshlrev_b32 v10, 1, v10
    v_bfe_u32 v24, v0, 4, 1
    v_lshl_add_u32 v10, v24, 3, v10
    v_bfe_u32 v24, v0, 3, 1
    v_lshl_add_u32 v10, v24, 5, v10
    v_bfe_u32 v24, v0, 2, 1
    v_lshl_add_u32 v10, v24, 2, v10
    v_bfe_u32 v24, v0, 1, 1
    v_lshl_add_u32 v10, v24, 4, v10
    v_add_u32 v10, 98304, v10
    v_mov_b32 v11, 0x3727c5ac
    v_mov_b32 v12, 98752
    s_cmp_lg_u32 s44, 3
    s_cbranch_scc1 KBAR
    s_lshr_b32 s53, s2, 4
    s_and_b32 s51, s2, 15
    s_lshl_b32 s52, s53, 14
    s_lshl_b32 s54, s51, 9
    s_add_u32 s52, s52, s54
    s_add_u32 s52, s52, 1835008
    s_and_b32 s53, s46, 1
    s_lshl_b32 s53, s53, 13
    s_add_u32 s52, s52, s53
    s_xor_b32 s53, s52, 8192
    s_memtime s[88:89]
    s_waitcnt lgkmcnt(0)
    s_buffer_load_dword s1, s[16:19], s52
    s_waitcnt lgkmcnt(0)
    s_memtime s[90:91]
    s_waitcnt lgkmcnt(0)
    s_buffer_load_dword s1, s[16:19], s53
    s_waitcnt lgkmcnt(0)
    s_memtime s[92:93]
    s_waitcnt lgkmcnt(0)
    s_sub_u32 s88, s90, s88
    s_sub_u32 s90, s92, s90
    s_cmp_lt_u32 s90, s88
    s_cselect_b32 s1, 1, 0
    s_xor_b32 s1, s1, s46
    s_getreg_b32 s52, hwreg(HW_REG_XCC_ID)
    s_lshr_b32 s52, s52, 2
    s_xor_b32 s1, s1, s52
    s_and_b32 s1, s1, 1
    s_lshl_b32 s1, s1, 4
    s_mov_b32 s51, 0
    v_mov_b32 v37, 0
NOP:
    s_waitcnt vmcnt(0)
    v_readfirstlane_b32 s5, v89
    s_cmp_lg_u32 s5, 0
    s_cbranch_scc1 NOOK
    buffer_load_dword v89, v37, s[40:43], 0 offen sc1
    s_add_u32 s51, s51, 1
    s_sleep 4
    s_cmp_lt_u32 s51, 0x8000
    s_cbranch_scc1 NOP
NOOK:
    s_getreg_b32 s52, hwreg(HW_REG_XCC_ID)
    s_and_b32 s52, s52, 15
    s_or_b32 s5, s5, s52
    s_or_b32 s1, s1, s5
    v_mov_b32 v36, s1
    s_lshl_b32 s52, s45, 7
    s_lshl_b32 s54, s46, 2
    s_add_u32 s52, s52, s54
    s_add_u32 s52, s52, 1376256
    s_mov_b64 exec, 1
    buffer_store_dword v36, v37, s[16:19], s52 offen sc1
    s_mov_b64 exec, -1
    s_mov_b32 s44, 0
    s_branch LOOP
KBAR:
    s_barrier
    s_waitcnt vmcnt(7)
    buffer_load_dwordx4 a[24:27], v80, s[8:11], s96 offen offset:0 nt
    s_waitcnt vmcnt(7)
    buffer_load_dwordx4 a[32:35], v80, s[8:11], s96 offen offset:128 nt
    s_waitcnt vmcnt(7)
    buffer_load_dwordx4 a[40:43], v80, s[8:11], s96 offen offset:256 nt
    s_add_u32 s96, s96, s97
    s_waitcnt vmcnt(7)
    buffer_load_dwordx4 a[28:31], v80, s[8:11], s96 offen offset:0 nt
    s_waitcnt vmcnt(7)
    buffer_load_dwordx4 a[36:39], v80, s[8:11], s96 offen offset:128 nt
    s_waitcnt vmcnt(7)
    buffer_load_dwordx4 a[44:47], v80, s[8:11], s96 offen offset:256 nt
    s_add_u32 s96, s96, s97
    s_waitcnt vmcnt(7)
    buffer_load_dwordx4 a[48:51], v80, s[8:11], s96 offen offset:0 nt
    s_waitcnt vmcnt(7)
    buffer_load_dwordx4 a[56:59], v80, s[8:11], s96 offen offset:128 nt
    s_waitcnt vmcnt(7)
    buffer_load_dwordx4 a[64:67], v80, s[8:11], s96 offen offset:256 nt
    s_add_u32 s96, s96, s97
    s_waitcnt vmcnt(7)
    buffer_load_dwordx4 a[52:55], v80, s[8:11], s96 offen offset:0 nt
    s_waitcnt vmcnt(7)
    buffer_load_dwordx4 a[60:63], v80, s[8:11], s96 offen offset:128 nt
    s_waitcnt vmcnt(7)
    buffer_load_dwordx4 a[68:71], v80, s[8:11], s96 offen offset:256 nt
    s_add_u32 s96, s96, s97
    s_waitcnt vmcnt(7)
    buffer_load_dwordx4 a[72:75], v80, s[8:11], s96 offen offset:0 nt
    s_waitcnt vmcnt(7)
    buffer_load_dwordx4 a[80:83], v80, s[8:11], s96 offen offset:128 nt
    s_waitcnt vmcnt(7)
    buffer_load_dwordx4 a[88:91], v80, s[8:11], s96 offen offset:256 nt
    s_add_u32 s96, s96, s97
    s_waitcnt vmcnt(7)
    buffer_load_dwordx4 a[76:79], v80, s[8:11], s96 offen offset:0 nt
    s_waitcnt vmcnt(7)
    buffer_load_dwordx4 a[84:87], v80, s[8:11], s96 offen offset:128 nt
    s_waitcnt vmcnt(7)
    buffer_load_dwordx4 a[92:95], v80, s[8:11], s96 offen offset:256 nt
    s_add_u32 s96, s96, s97
    s_waitcnt vmcnt(7)
    buffer_load_dwordx4 a[96:99], v80, s[8:11], s96 offen offset:0 nt
    s_waitcnt vmcnt(7)
    buffer_load_dwordx4 a[104:107], v80, s[8:11], s96 offen offset:128 nt
    s_waitcnt vmcnt(7)
    buffer_load_dwordx4 a[112:115], v80, s[8:11], s96 offen offset:256 nt
    s_add_u32 s96, s96, s97
    s_waitcnt vmcnt(7)
    buffer_load_dwordx4 a[100:103], v80, s[8:11], s96 offen offset:0 nt
    s_waitcnt vmcnt(7)
    buffer_load_dwordx4 a[108:111], v80, s[8:11], s96 offen offset:128 nt
    s_waitcnt vmcnt(7)
    buffer_load_dwordx4 a[116:119], v80, s[8:11], s96 offen offset:256 nt
    s_add_u32 s96, s96, s97
    s_waitcnt vmcnt(7)
    buffer_load_dwordx4 a[120:123], v80, s[8:11], s96 offen offset:0 nt
    s_waitcnt vmcnt(7)
    buffer_load_dwordx4 a[128:131], v80, s[8:11], s96 offen offset:128 nt
    s_waitcnt vmcnt(7)
    buffer_load_dwordx4 a[136:139], v80, s[8:11], s96 offen offset:256 nt
    s_add_u32 s96, s96, s97
    s_waitcnt vmcnt(7)
    buffer_load_dwordx4 a[124:127], v80, s[8:11], s96 offen offset:0 nt
    s_waitcnt vmcnt(7)
    buffer_load_dwordx4 a[132:135], v80, s[8:11], s96 offen offset:128 nt
    s_waitcnt vmcnt(7)
    buffer_load_dwordx4 a[140:143], v80, s[8:11], s96 offen offset:256 nt
    s_add_u32 s96, s96, s97
    s_waitcnt vmcnt(7)
    buffer_load_dwordx4 a[144:147], v80, s[8:11], s96 offen offset:0 nt
    s_waitcnt vmcnt(7)
    buffer_load_dwordx4 a[152:155], v80, s[8:11], s96 offen offset:128 nt
    s_waitcnt vmcnt(7)
    buffer_load_dwordx4 a[160:163], v80, s[8:11], s96 offen offset:256 nt
    s_add_u32 s96, s96, s97
    s_waitcnt vmcnt(7)
    buffer_load_dwordx4 a[148:151], v80, s[8:11], s96 offen offset:0 nt
    s_waitcnt vmcnt(7)
    buffer_load_dwordx4 a[156:159], v80, s[8:11], s96 offen offset:128 nt
    s_waitcnt vmcnt(7)
    buffer_load_dwordx4 a[164:167], v80, s[8:11], s96 offen offset:256 nt
    s_add_u32 s96, s96, s97
    s_waitcnt vmcnt(7)
    buffer_load_dwordx4 a[168:171], v80, s[8:11], s96 offen offset:0 nt
    s_waitcnt vmcnt(7)
    buffer_load_dwordx4 a[176:179], v80, s[8:11], s96 offen offset:128 nt
    s_waitcnt vmcnt(7)
    buffer_load_dwordx4 a[184:187], v80, s[8:11], s96 offen offset:256 nt
    s_add_u32 s96, s96, s97
    s_waitcnt vmcnt(7)
    buffer_load_dwordx4 a[172:175], v80, s[8:11], s96 offen offset:0 nt
    s_waitcnt vmcnt(7)
    buffer_load_dwordx4 a[180:183], v80, s[8:11], s96 offen offset:128 nt
    s_waitcnt vmcnt(7)
    buffer_load_dwordx4 a[188:191], v80, s[8:11], s96 offen offset:256 nt
    s_lshl_b32 s97, s97, 1
    s_waitcnt vmcnt(7)
    buffer_load_dwordx4 a[192:195], v82, s[12:15], s55 offen offset:0 nt
    s_waitcnt vmcnt(7)
    buffer_load_dwordx4 a[200:203], v82, s[12:15], s55 offen offset:128 nt
    s_waitcnt vmcnt(7)
    buffer_load_dwordx4 a[208:211], v82, s[12:15], s55 offen offset:256 nt
    s_waitcnt vmcnt(7)
    buffer_load_dwordx4 a[216:219], v82, s[12:15], s55 offen offset:384 nt
    s_waitcnt vmcnt(7)
    buffer_load_dwordx4 a[224:227], v82, s[12:15], s55 offen offset:512 nt
    s_waitcnt vmcnt(7)
    buffer_load_dwordx4 a[232:235], v82, s[12:15], s55 offen offset:640 nt
    s_add_u32 s55, s55, s97
    s_waitcnt vmcnt(7)
    buffer_load_dwordx4 a[196:199], v82, s[12:15], s55 offen offset:0 nt
    s_waitcnt vmcnt(7)
    buffer_load_dwordx4 a[204:207], v82, s[12:15], s55 offen offset:128 nt
    s_waitcnt vmcnt(7)
    buffer_load_dwordx4 a[212:215], v82, s[12:15], s55 offen offset:256 nt
    s_waitcnt vmcnt(7)
    buffer_load_dwordx4 a[220:223], v82, s[12:15], s55 offen offset:384 nt
    s_waitcnt vmcnt(7)
    buffer_load_dwordx4 a[228:231], v82, s[12:15], s55 offen offset:512 nt
    s_waitcnt vmcnt(7)
    buffer_load_dwordx4 a[236:239], v82, s[12:15], s55 offen offset:640 nt
    s_add_u32 s55, s55, s97
    s_waitcnt vmcnt(7)
    buffer_load_dwordx4 a[240:243], v82, s[12:15], s55 offen offset:0 nt
    s_waitcnt vmcnt(7)
    buffer_load_dwordx4 a[248:251], v82, s[12:15], s55 offen offset:128 nt
    s_waitcnt vmcnt(7)
    buffer_load_dwordx4 v[128:131], v82, s[12:15], s55 offen offset:256 nt
    s_waitcnt vmcnt(7)
    buffer_load_dwordx4 v[136:139], v82, s[12:15], s55 offen offset:384 nt
    s_waitcnt vmcnt(7)
    buffer_load_dwordx4 v[144:147], v82, s[12:15], s55 offen offset:512 nt
    s_waitcnt vmcnt(7)
    buffer_load_dwordx4 v[152:155], v82, s[12:15], s55 offen offset:640 nt
    s_add_u32 s55, s55, s97
    s_waitcnt vmcnt(7)
    buffer_load_dwordx4 a[244:247], v82, s[12:15], s55 offen offset:0 nt
    s_waitcnt vmcnt(7)
    buffer_load_dwordx4 a[252:255], v82, s[12:15], s55 offen offset:128 nt
    s_waitcnt vmcnt(7)
    buffer_load_dwordx4 v[132:135], v82, s[12:15], s55 offen offset:256 nt
    s_waitcnt vmcnt(7)
    buffer_load_dwordx4 v[140:143], v82, s[12:15], s55 offen offset:384 nt
    s_waitcnt vmcnt(7)
    buffer_load_dwordx4 v[148:151], v82, s[12:15], s55 offen offset:512 nt
    s_waitcnt vmcnt(7)
    buffer_load_dwordx4 v[156:159], v82, s[12:15], s55 offen offset:640 nt
    s_add_u32 s55, s55, s97
    s_waitcnt vmcnt(7)
    buffer_load_dwordx4 v[160:163], v82, s[12:15], s55 offen offset:0 nt
    s_waitcnt vmcnt(7)
    buffer_load_dwordx4 v[168:171], v82, s[12:15], s55 offen offset:128 nt
    s_waitcnt vmcnt(7)
    buffer_load_dwordx4 v[176:179], v82, s[12:15], s55 offen offset:256 nt
    s_waitcnt vmcnt(7)
    buffer_load_dwordx4 v[184:187], v82, s[12:15], s55 offen offset:384 nt
    s_waitcnt vmcnt(7)
    buffer_load_dwordx4 v[192:195], v82, s[12:15], s55 offen offset:512 nt
    s_waitcnt vmcnt(7)
    buffer_load_dwordx4 v[200:203], v82, s[12:15], s55 offen offset:640 nt
    s_add_u32 s55, s55, s97
    s_waitcnt vmcnt(7)
    buffer_load_dwordx4 v[164:167], v82, s[12:15], s55 offen offset:0 nt
    s_waitcnt vmcnt(7)
    buffer_load_dwordx4 v[172:175], v82, s[12:15], s55 offen offset:128 nt
    s_waitcnt vmcnt(7)
    buffer_load_dwordx4 v[180:183], v82, s[12:15], s55 offen offset:256 nt
    s_waitcnt vmcnt(7)
    buffer_load_dwordx4 v[188:191], v82, s[12:15], s55 offen offset:384 nt
    s_waitcnt vmcnt(7)
    buffer_load_dwordx4 v[196:199], v82, s[12:15], s55 offen offset:512 nt
    s_waitcnt vmcnt(7)
    buffer_load_dwordx4 v[204:207], v82, s[12:15], s55 offen offset:640 nt
    s_add_u32 s55, s55, s97
    s_waitcnt vmcnt(7)
    buffer_load_dwordx4 v[208:211], v82, s[12:15], s55 offen offset:0 nt
    s_waitcnt vmcnt(7)
    buffer_load_dwordx4 v[216:219], v82, s[12:15], s55 offen offset:128 nt
    s_waitcnt vmcnt(7)
    buffer_load_dwordx4 v[224:227], v82, s[12:15], s55 offen offset:256 nt
    s_waitcnt vmcnt(7)
    buffer_load_dwordx4 v[232:235], v82, s[12:15], s55 offen offset:384 nt
    s_waitcnt vmcnt(7)
    buffer_load_dwordx4 v[240:243], v82, s[12:15], s55 offen offset:512 nt
    s_waitcnt vmcnt(7)
    buffer_load_dwordx4 v[248:251], v82, s[12:15], s55 offen offset:640 nt
    s_add_u32 s55, s55, s97
    s_waitcnt vmcnt(7)
    buffer_load_dwordx4 v[212:215], v82, s[12:15], s55 offen offset:0 nt
    s_waitcnt vmcnt(7)
    buffer_load_dwordx4 v[220:223], v82, s[12:15], s55 offen offset:128 nt
    s_waitcnt vmcnt(7)
    buffer_load_dwordx4 v[228:231], v82, s[12:15], s55 offen offset:256 nt
    s_barrier
    s_waitcnt vmcnt(7)
    buffer_load_dwordx4 v[236:239], v82, s[12:15], s55 offen offset:384 nt
    s_waitcnt vmcnt(7)
    buffer_load_dwordx4 v[244:247], v82, s[12:15], s55 offen offset:512 nt
    s_waitcnt vmcnt(7)
    buffer_load_dwordx4 v[252:255], v82, s[12:15], s55 offen offset:640 nt
    s_branch ENTRY
LOOP:
    v_and_b32 v16, 3, v1
    v_lshrrev_b32 v17, 4, v1
    v_bfe_u32 v18, v1, 2, 2
    v_lshlrev_b32 v16, 3, v16
    v_mul_u32_u24 v18, 384, v18
    v_add_u32 v16, v16, v18
    v_bfe_u32 v18, v1, 3, 2
    v_xor_b32 v18, s44, v18
    v_lshl_add_u32 v16, v18, 5, v16
    v_add_u32 v16, 65536, v16
    v_and_b32 v18, 1, v17
    v_mul_u32_u24 v17, 3072, v17
    v_mul_u32_u24 v18, 3072, v18
    v_add_u32 v17, v17, v16
    v_add_u32 v18, v18, v16
    ds_read_b64_tr_b16 v[44:45], v17 offset:0
    ds_read_b64_tr_b16 v[46:47], v17 offset:1536
    ds_read_b64_tr_b16 v[56:57], v17 offset:128
    ds_read_b64_tr_b16 v[58:59], v17 offset:1664
    ds_read_b64_tr_b16 v[68:69], v17 offset:256
    ds_read_b64_tr_b16 v[70:71], v17 offset:1792
    ds_read_b64_tr_b16 v[48:49], v17 offset:12288
    ds_read_b64_tr_b16 v[50:51], v17 offset:13824
    ds_read_b64_tr_b16 v[60:61], v17 offset:12416
    ds_read_b64_tr_b16 v[62:63], v17 offset:13952
    ds_read_b64_tr_b16 v[72:73], v17 offset:12544
    ds_read_b64_tr_b16 v[74:75], v17 offset:14080
    ds_read_b64_tr_b16 v[52:53], v18 offset:24576
    ds_read_b64_tr_b16 v[54:55], v18 offset:26112
    ds_read_b64_tr_b16 v[64:65], v18 offset:24704
    ds_read_b64_tr_b16 v[66:67], v18 offset:26240
    ds_read_b64_tr_b16 v[76:77], v18 offset:24832
    ds_read_b64_tr_b16 v[78:79], v18 offset:26368
    s_cmp_lg_u32 s6, 0
    s_cbranch_scc1 QA0
    v_and_b32 v29, 31, v1
    v_lshl_add_u32 v29, s44, 5, v29
    s_cmp_eq_u32 s44, 3
    s_cbranch_scc1 Y2N
    v_min_u32 v20, 79, v29
    s_mul_i32 s52, s48, 80
    v_add_u32 v20, s52, v20
    v_lshrrev_b32 v26, 5, v20
    v_lshlrev_b32 v26, 10, v26
    v_lshrrev_b32 v21, 8, v20
    v_lshl_add_u32 v26, v21, 13, v26
    v_and_b32 v20, 31, v20
    v_lshl_add_u32 v26, v20, 2, v26
    v_lshrrev_b32 v20, 5, v1
    v_lshl_add_u32 v26, v20, 9, v26
    s_add_u32 s52, s0, 81920
    v_add_u32 v26, s52, v26
    s_sub_u32 s52, s46, 20
    s_cmp_ge_u32 s52, 10
    s_cbranch_scc1 HOOKL
    v_lshlrev_b32 v27, 3, v0
    s_mul_i32 s52, s47, 12288
    s_add_u32 s52, s52, 1441792
    s_add_u32 s53, s52, 0
    buffer_load_dwordx2 v[32:33], v27, s[16:19], s53 offen offset:0 sc1
    buffer_load_dwordx2 v[34:35], v27, s[16:19], s53 offen offset:1536 sc1
    s_add_u32 s53, s52, 3072
    buffer_load_dwordx2 v[36:37], v27, s[16:19], s53 offen offset:0 sc1
    buffer_load_dwordx2 v[38:39], v27, s[16:19], s53 offen offset:1536 sc1
    s_add_u32 s53, s52, 6144
    buffer_load_dwordx2 v[40:41], v27, s[16:19], s53 offen offset:0 sc1
    buffer_load_dwordx2 v[42:43], v27, s[16:19], s53 offen offset:1536 sc1
    s_add_u32 s53, s52, 9216
    buffer_load_dwordx2 v[16:17], v27, s[16:19], s53 offen offset:0 sc1
    buffer_load_dwordx2 v[20:21], v27, s[16:19], s53 offen offset:1536 sc1
    s_sleep 3
GYB:
    buffer_load_dword v22, v26, s[16:19], s49 offen offset:0 sc1
    buffer_load_dword v23, v26, s[16:19], s49 offen offset:128 sc1
    buffer_load_dword v24, v26, s[16:19], s49 offen offset:256 sc1
    buffer_load_dword v25, v26, s[16:19], s49 offen offset:384 sc1
Y2N:
    s_lshr_b32 s53, s48, 2
    s_mul_i32 s52, s7, 6144
    s_lshl_b32 s54, s44, 8
    s_add_u32 s52, s52, s54
    s_mul_i32 s54, s53, 3056
    s_add_u32 s52, s52, s54
    s_lshl_b32 s54, s48, 2
    s_add_u32 s52, s52, s54
    s_add_u32 s52, s52, 20480
    v_lshl_add_u32 v14, v1, 4, s52
    s_lshl_b32 s52, s7, 6
    s_lshl_b32 s54, s48, 3
    s_add_u32 s52, s52, s54
    s_add_u32 s52, s52, 45056
    v_mov_b32 v15, s52
    s_mul_i32 s52, s48, 320
    s_add_u32 s52, s52, 131072
    s_and_b32 s53, s2, 0xc7
    s_cmp_eq_u32 s53, 0
    s_cselect_b32 s52, s52, 1879048192
    v_lshl_add_u32 v28, v29, 2, s52
    v_cmp_gt_u32 vcc, 80, v29
    v_mov_b32 v19, 100
    s_mov_b64 s[60:61], vcc
    v_cndmask_b32 v19, v19, v29, vcc
    v_lshlrev_b32 v19, 1, v19
    v_add_u32 v19, 96256, v19
    s_mov_b32 s51, 0
    s_cmp_eq_u32 s44, 3
    s_cbranch_scc1 Y2OK
    s_cmp_lg_u32 s49, 0
    s_cbranch_scc1 Y2W
    s_waitcnt vmcnt(4)
QCP:
    v_bitop3_b32 v33, v32, v33, s101 bitop3:0x96
    v_bitop3_b32 v35, v34, v35, s101 bitop3:0x96
    v_bitop3_b32 v37, v36, v37, s101 bitop3:0x96
    v_bitop3_b32 v39, v38, v39, s101 bitop3:0x96
    v_bitop3_b32 v41, v40, v41, s101 bitop3:0x96
    v_bitop3_b32 v43, v42, v43, s101 bitop3:0x96
    v_bitop3_b32 v17, v16, v17, s101 bitop3:0x96
    v_bitop3_b32 v21, v20, v21, s101 bitop3:0x96
    v_add_f32 v13, v32, v34
    v_add_f32 v13, v13, v36
    v_add_f32 v13, v13, v38
    v_add_f32 v13, v13, v40
    v_add_f32 v13, v13, v42
    v_add_f32 v13, v13, v16
    v_add_f32 v13, v13, v20
    v_or3_b32 v33, v33, v35, v37
    v_or3_b32 v33, v33, v39, v41
    v_or3_b32 v33, v33, v43, v17
    v_or_b32 v33, v33, v21
    v_cmp_ne_u32 vcc, 0, v33
    s_cbranch_vccz Y2W
    v_lshlrev_b32 v27, 3, v0
    s_mul_i32 s52, s47, 12288
    s_add_u32 s52, s52, 1441792
    s_add_u32 s53, s52, 0
    buffer_load_dwordx2 v[32:33], v27, s[16:19], s53 offen offset:0 sc1
    buffer_load_dwordx2 v[34:35], v27, s[16:19], s53 offen offset:1536 sc1
    s_add_u32 s53, s52, 3072
    buffer_load_dwordx2 v[36:37], v27, s[16:19], s53 offen offset:0 sc1
    buffer_load_dwordx2 v[38:39], v27, s[16:19], s53 offen offset:1536 sc1
    s_add_u32 s53, s52, 6144
    buffer_load_dwordx2 v[40:41], v27, s[16:19], s53 offen offset:0 sc1
    buffer_load_dwordx2 v[42:43], v27, s[16:19], s53 offen offset:1536 sc1
    s_add_u32 s53, s52, 9216
    buffer_load_dwordx2 v[16:17], v27, s[16:19], s53 offen offset:0 sc1
    buffer_load_dwordx2 v[20:21], v27, s[16:19], s53 offen offset:1536 sc1
    s_waitcnt vmcnt(0)
    s_add_u32 s51, s51, 1
    s_sleep 2
    s_cmp_lt_u32 s51, 0x8000
    s_cbranch_scc1 QCP
    s_branch Y2W
Y2P:
    buffer_load_dword v22, v26, s[16:19], s49 offen offset:0 sc1
    buffer_load_dword v23, v26, s[16:19], s49 offen offset:128 sc1
    buffer_load_dword v24, v26, s[16:19], s49 offen offset:256 sc1
    buffer_load_dword v25, v26, s[16:19], s49 offen offset:384 sc1
Y2W:
    s_waitcnt vmcnt(0)
    v_pk_add_f32 v[22:23], v[22:23], v[24:25]
    v_add_f32 v30, v22, v23
    v_mov_b32 v31, v30
    s_nop 1
    v_permlane32_swap_b32 v30, v31
    v_add_f32 v30, v30, v31
    v_cmp_u_f32 vcc, v30, v30
    v_cvt_pk_bf16_f32 v30, v30, v30
    ds_write_b16 v19, v30
    s_cbranch_vccz Y2OK
    s_add_u32 s51, s51, 1
    s_sleep 1
    s_cmp_lt_u32 s51, 0x8000
    s_cbranch_scc1 Y2P
Y2OK:
    s_cmp_lg_u32 s49, 0
    s_cbranch_scc1 FINAL
    s_mov_b32 s49, 393216
    s_mov_b32 s62, s63
    s_cmp_eq_u32 s44, 3
    s_cbranch_scc1 QX
    v_and_b32 v30, 0xffff0000, v30
    s_mov_b32 exec_lo, s60
    s_mov_b32 exec_hi, 0
    s_cmp_eq_u32 s50, 0
    s_cbranch_scc1 SLOW0
    buffer_store_dword v30, v28, s[16:19], s49 offen
PUBD0:
    s_mov_b64 exec, -1
QX:
    s_waitcnt lgkmcnt(0)
    s_barrier
QA0:
    ds_read_b128 v[32:35], v2 offset:0
    ds_read_b128 v[36:39], v2 offset:64
    ds_read_b128 v[40:43], v2 offset:128
    s_waitcnt lgkmcnt(2)
    v_mfma_f32_16x16x32_bf16 v[28:31], v[32:35], v[32:35], 0
    v_mfma_f32_16x16x32_bf16 v[16:19], v[32:35], v[44:47], 0
    v_mfma_f32_16x16x32_bf16 v[20:23], v[32:35], v[56:59], 0
    v_mfma_f32_16x16x32_bf16 v[24:27], v[32:35], v[68:71], 0
    s_waitcnt lgkmcnt(1)
    v_mfma_f32_16x16x32_bf16 v[28:31], v[36:39], v[36:39], v[28:31]
    v_mfma_f32_16x16x32_bf16 v[16:19], v[36:39], v[48:51], v[16:19]
    v_mfma_f32_16x16x32_bf16 v[20:23], v[36:39], v[60:63], v[20:23]
    v_mfma_f32_16x16x32_bf16 v[24:27], v[36:39], v[72:75], v[24:27]
    s_waitcnt lgkmcnt(0)
    v_mfma_f32_16x16x32_bf16 v[16:19], v[40:43], v[52:55], v[16:19]
    v_mfma_f32_16x16x32_bf16 v[20:23], v[40:43], v[64:67], v[20:23]
    v_mfma_f32_16x16x32_bf16 v[24:27], v[40:43], v[76:79], v[24:27]
    v_mfma_f32_16x16x32_bf16 v[28:31], v[40:43], v[40:43], v[28:31]
    s_mov_b64 exec, 0xffff
    s_cmp_lg_u32 s6, 0
    s_cbranch_scc1 HOOKA
    s_cmp_eq_u32 s50, 0
    s_cbranch_scc1 SLOW1
    buffer_store_dword v16, v14, s[16:19], s62 offen offset:0
    buffer_store_dword v20, v14, s[16:19], s62 offen offset:1024
    buffer_store_dword v24, v14, s[16:19], s62 offen offset:2048
    s_mov_b64 exec, 1
    buffer_store_dwordx2 v[28:29], v15, s[16:19], s62 offen
PUBD1:
    s_mov_b64 exec, -1
ENTRY:
    s_mov_b32 s51, 0
    v_mov_b64 v[64:65], 0
    v_mov_b64 v[66:67], 0
    v_mov_b64 v[68:69], 0
    v_mov_b64 v[70:71], 0
    v_mov_b64 v[72:73], 0
    v_mov_b64 v[74:75], 0
    v_mov_b64 v[76:77], 0
    v_mov_b64 v[78:79], 0
    s_cmp_eq_u32 s49, 0
    s_cselect_b32 s53, 3, s44
    s_cmp_eq_u32 s53, 3
    s_cbranch_scc1 EN0
    s_nop 15
    buffer_load_dwordx2 v[62:63], v9, s[16:19], s62 offen sc1
    buffer_load_dwordx4 v[44:47], v8, s[16:19], s62 offen offset:0 sc1
    buffer_load_dwordx4 v[48:51], v8, s[16:19], s62 offen offset:3072 sc1
EN0:
    v_lshrrev_b32 v14, 2, v1
    v_lshlrev_b32 v14, 7, v14
    v_and_b32 v15, 3, v1
    v_lshl_add_u32 v14, v15, 2, v14
    s_mul_i32 s52, s7, 3072
    s_mul_i32 s54, s44, 768
    s_add_u32 s52, s52, s54
    s_lshl_b32 s54, s48, 4
    s_add_u32 s52, s52, s54
    v_add_u32 v14, s52, v14
    s_lshl_b32 s52, s7, 5
    s_lshl_b32 s54, s48, 2
    s_add_u32 s52, s52, s54
    s_add_u32 s52, s52, 19968
    v_writelane_b32 v14, s52, 24
    v_and_b32 v15, 7, v1
    v_lshlrev_b32 v15, 5, v15
    v_bfe_u32 v61, v1, 4, 1
    v_lshl_add_u32 v15, v61, 4, v15
    v_lshrrev_b32 v61, 5, v1
    v_mul_u32_u24 v61, 768, v61
    v_add_u32 v15, v15, v61
    s_mul_i32 s52, s44, 1536
    s_add_u32 s52, s52, 98816
    v_add_u32 v15, s52, v15
    s_mul_i32 s52, s44, 192
    s_add_u32 s52, s52, 98816
    v_min_u32 v60, 23, v1
    v_lshl_add_u32 v60, v60, 3, s52
    s_lshl_b32 s52, s44, 3
    s_add_u32 s52, s52, 98752
    v_mov_b32 v61, s52
    s_cmp_eq_u32 s49, 0
    s_cbranch_scc1 HOOKE
    s_cmp_eq_u32 s53, 3
    s_cbranch_scc1 ENOK2
    s_nop 5
ENP:
    buffer_load_dwordx2 v[62:63], v9, s[16:19], s62 offen sc1
    buffer_load_dwordx4 v[44:47], v8, s[16:19], s62 offen offset:0 sc1
    buffer_load_dwordx4 v[48:51], v8, s[16:19], s62 offen offset:3072 sc1
    s_waitcnt vmcnt(3)
    v_add_f32_dpp v32, v62, v62 quad_perm:[1,0,3,2] row_mask:0xf bank_mask:0xf
    v_add_f32_dpp v33, v63, v63 quad_perm:[1,0,3,2] row_mask:0xf bank_mask:0xf
    v_pk_add_f32 v[16:17], v[44:45], v[46:47]
    v_add_f32_dpp v32, v32, v32 quad_perm:[2,3,0,1] row_mask:0xf bank_mask:0xf
    v_add_f32_dpp v33, v33, v33 quad_perm:[2,3,0,1] row_mask:0xf bank_mask:0xf
    v_pk_add_f32 v[20:21], v[48:49], v[50:51]
    v_add_f32_dpp v32, v32, v32 row_half_mirror row_mask:0xf bank_mask:0xf
    v_add_f32_dpp v33, v33, v33 row_half_mirror row_mask:0xf bank_mask:0xf
    v_pk_add_f32 v[16:17], v[16:17], v[20:21]
    v_mul_f32 v33, 0x3acccccd, v33
    v_fmamk_f32 v32, v32, 0x3acccccd, v11
    v_fma_f32 v32, -v33, v33, v32
    v_rsq_f32 v32, v32
    v_add_f32 v16, v16, v17
    v_mul_f32 v32, 0x3dd53b94, v32
    v_fma_f32 v16, -v33, v13, v16
    v_mul_f32 v16, v16, v32
    v_cvt_pk_bf16_f32 v17, v16, v16
    ds_write_b16 v10, v17
    v_cmp_u_f32 vcc, v16, v16
    s_cbranch_vccz ENOK
    s_add_u32 s51, s51, 1
    s_cmp_lt_u32 s51, 0x8000
    s_cbranch_scc1 ENP
ENOK:
ENOK2:
    s_waitcnt lgkmcnt(0)
    s_barrier
QFRAG:
    ds_read_b128 v[16:19], v3 offset:0
    ds_read_b128 v[20:23], v3 offset:128
    ds_read_b128 v[24:27], v3 offset:256
    ds_read_b128 v[28:31], v4 offset:0
    ds_read_b128 v[32:35], v4 offset:128
    ds_read_b128 v[36:39], v4 offset:256
    s_cmp_eq_u32 s49, 0
    s_cbranch_scc1 HOOKF
    s_waitcnt vmcnt(0)
QK:
    v_mov_b64 v[40:41], 0
    v_mov_b64 v[42:43], 0
    v_mov_b64 v[44:45], 0
    v_mov_b64 v[46:47], 0
    v_mov_b64 v[48:49], 0
    v_mov_b64 v[50:51], 0
    s_waitcnt lgkmcnt(5)
    v_smfmac_f32_16x16x64_bf16 v[64:67], v[16:19], a[0:7], v7
    s_waitcnt lgkmcnt(4)
    v_smfmac_f32_16x16x64_bf16 v[64:67], v[20:23], a[8:15], v7
    s_waitcnt lgkmcnt(3)
    v_smfmac_f32_16x16x64_bf16 v[64:67], v[24:27], a[16:23], v7
    s_waitcnt lgkmcnt(2)
    v_smfmac_f32_16x16x64_bf16 v[64:67], v[28:31], a[24:31], v7
    s_waitcnt lgkmcnt(1)
    v_smfmac_f32_16x16x64_bf16 v[64:67], v[32:35], a[32:39], v7
    s_waitcnt lgkmcnt(0)
    v_smfmac_f32_16x16x64_bf16 v[64:67], v[36:39], a[40:47], v7
    v_smfmac_f32_16x16x64_bf16 v[68:71], v[16:19], a[48:55], v7
    v_smfmac_f32_16x16x64_bf16 v[68:71], v[20:23], a[56:63], v7
    v_smfmac_f32_16x16x64_bf16 v[68:71], v[24:27], a[64:71], v7
    v_smfmac_f32_16x16x64_bf16 v[68:71], v[28:31], a[72:79], v7
    v_smfmac_f32_16x16x64_bf16 v[68:71], v[32:35], a[80:87], v7
    v_smfmac_f32_16x16x64_bf16 v[68:71], v[36:39], a[88:95], v7
    v_smfmac_f32_16x16x64_bf16 v[72:75], v[16:19], a[96:103], v7
    v_smfmac_f32_16x16x64_bf16 v[72:75], v[20:23], a[104:111], v7
    v_smfmac_f32_16x16x64_bf16 v[72:75], v[24:27], a[112:119], v7
    v_mov_b32_dpp v52, v64 quad_perm:[0,0,2,2] row_mask:0xf bank_mask:0xf
    v_smfmac_f32_16x16x64_bf16 v[72:75], v[28:31], a[120:127], v7
    v_add_f32_dpp v52, v65, v52 quad_perm:[0,0,2,2] row_mask:0xf bank_mask:0xf
    v_smfmac_f32_16x16x64_bf16 v[72:75], v[32:35], a[128:135], v7
    v_add_f32_dpp v52, v66, v52 quad_perm:[1,1,3,3] row_mask:0xf bank_mask:0xf
    v_smfmac_f32_16x16x64_bf16 v[72:75], v[36:39], a[136:143], v7
    v_add_f32_dpp v52, v67, v52 quad_perm:[1,1,3,3] row_mask:0xf bank_mask:0xf
    v_smfmac_f32_16x16x64_bf16 v[76:79], v[16:19], a[144:151], v7
    v_smfmac_f32_16x16x64_bf16 v[76:79], v[20:23], a[152:159], v7
    v_smfmac_f32_16x16x64_bf16 v[76:79], v[24:27], a[160:167], v7
    v_mov_b32_dpp v53, v68 quad_perm:[0,0,2,2] row_mask:0xf bank_mask:0xf
    v_smfmac_f32_16x16x64_bf16 v[76:79], v[28:31], a[168:175], v7
    v_add_f32_dpp v53, v69, v53 quad_perm:[0,0,2,2] row_mask:0xf bank_mask:0xf
    v_smfmac_f32_16x16x64_bf16 v[76:79], v[32:35], a[176:183], v7
    v_add_f32_dpp v53, v70, v53 quad_perm:[1,1,3,3] row_mask:0xf bank_mask:0xf
    v_smfmac_f32_16x16x64_bf16 v[76:79], v[36:39], a[184:191], v7
    v_add_f32_dpp v53, v71, v53 quad_perm:[1,1,3,3] row_mask:0xf bank_mask:0xf
    v_mov_b32_dpp v54, v72 quad_perm:[0,0,2,2] row_mask:0xf bank_mask:0xf
    v_add_f32_dpp v54, v73, v54 quad_perm:[0,0,2,2] row_mask:0xf bank_mask:0xf
    v_add_f32_dpp v54, v74, v54 quad_perm:[1,1,3,3] row_mask:0xf bank_mask:0xf
    v_add_f32_dpp v54, v75, v54 quad_perm:[1,1,3,3] row_mask:0xf bank_mask:0xf
    v_max3_f32 v62, v52, v53, v54
    s_nop 1
    v_mov_b32_dpp v55, v76 quad_perm:[0,0,2,2] row_mask:0xf bank_mask:0xf
    v_add_f32_dpp v55, v77, v55 quad_perm:[0,0,2,2] row_mask:0xf bank_mask:0xf
    v_add_f32_dpp v55, v78, v55 quad_perm:[1,1,3,3] row_mask:0xf bank_mask:0xf
    v_add_f32_dpp v55, v79, v55 quad_perm:[1,1,3,3] row_mask:0xf bank_mask:0xf
    v_max_f32 v62, v62, v55
    s_nop 1
    v_max_f32_dpp v62, v62, v62 quad_perm:[2,3,0,1] row_mask:0xf bank_mask:0xf
    s_nop 1
    v_max_f32_dpp v62, v62, v62 row_ror:4 row_mask:0xf bank_mask:0xf
    s_nop 1
    v_max_f32_dpp v62, v62, v62 row_ror:8 row_mask:0xf bank_mask:0xf
    v_mov_b32 v63, v62
    s_nop 1
    v_permlane16_swap_b32 v62, v63
    v_max_f32 v62, v62, v63
    v_mov_b32 v63, v62
    s_nop 1
    v_permlane32_swap_b32 v62, v63
    v_max_f32 v62, v62, v63
    v_sub_f32 v52, v52, v62
    v_exp_f32 v52, v52
    s_nop 0
    v_cvt_pk_bf16_f32 v56, v52, v52
    v_mov_b32 v63, v52
    s_nop 0
    v_and_b32_dpp v16, v56, v5 quad_perm:[0,0,0,0] row_mask:0xf bank_mask:0xf
    v_and_b32_dpp v19, v56, v6 quad_perm:[0,0,0,0] row_mask:0xf bank_mask:0xf
    s_nop 0
    v_mov_b32_dpp v17, v16 row_shr:4 row_mask:0xf bank_mask:0xf bound_ctrl:0
    v_mov_b32_dpp v18, v19 row_shl:4 row_mask:0xf bank_mask:0xf bound_ctrl:0
    s_nop 0
    s_waitcnt vmcnt(36)
    v_smfmac_f32_16x16x64_bf16 v[40:43], v[16:19], a[192:199], v7 abid:1
    v_and_b32_dpp v20, v56, v5 quad_perm:[2,2,2,2] row_mask:0xf bank_mask:0xf
    v_and_b32_dpp v23, v56, v6 quad_perm:[2,2,2,2] row_mask:0xf bank_mask:0xf
    v_smfmac_f32_16x16x64_bf16 v[44:47], v[16:19], a[200:207], v7 abid:1
    v_mov_b32_dpp v21, v20 row_shr:4 row_mask:0xf bank_mask:0xf bound_ctrl:0
    v_mov_b32_dpp v22, v23 row_shl:4 row_mask:0xf bank_mask:0xf bound_ctrl:0
    v_sub_f32 v53, v53, v62
    v_exp_f32 v53, v53
    v_smfmac_f32_16x16x64_bf16 v[48:51], v[16:19], a[208:215], v7 abid:1
    v_cvt_pk_bf16_f32 v57, v53, v53
    v_add_f32 v63, v63, v53
    v_smfmac_f32_16x16x64_bf16 v[40:43], v[20:23], a[216:223], v7 abid:1
    v_and_b32_dpp v16, v57, v5 quad_perm:[0,0,0,0] row_mask:0xf bank_mask:0xf
    v_and_b32_dpp v19, v57, v6 quad_perm:[0,0,0,0] row_mask:0xf bank_mask:0xf
    v_smfmac_f32_16x16x64_bf16 v[44:47], v[20:23], a[224:231], v7 abid:1
    v_mov_b32_dpp v17, v16 row_shr:4 row_mask:0xf bank_mask:0xf bound_ctrl:0
    v_mov_b32_dpp v18, v19 row_shl:4 row_mask:0xf bank_mask:0xf bound_ctrl:0
    v_smfmac_f32_16x16x64_bf16 v[48:51], v[20:23], a[232:239], v7 abid:1
    s_waitcnt vmcnt(24)
    v_smfmac_f32_16x16x64_bf16 v[40:43], v[16:19], a[240:247], v7 abid:1
    v_and_b32_dpp v20, v57, v5 quad_perm:[2,2,2,2] row_mask:0xf bank_mask:0xf
    v_and_b32_dpp v23, v57, v6 quad_perm:[2,2,2,2] row_mask:0xf bank_mask:0xf
    v_smfmac_f32_16x16x64_bf16 v[44:47], v[16:19], a[248:255], v7 abid:1
    v_mov_b32_dpp v21, v20 row_shr:4 row_mask:0xf bank_mask:0xf bound_ctrl:0
    v_mov_b32_dpp v22, v23 row_shl:4 row_mask:0xf bank_mask:0xf bound_ctrl:0
    v_sub_f32 v54, v54, v62
    v_exp_f32 v54, v54
    v_smfmac_f32_16x16x64_bf16 v[48:51], v[16:19], v[128:135], v7 abid:1
    v_cvt_pk_bf16_f32 v56, v54, v54
    v_add_f32 v63, v63, v54
    v_smfmac_f32_16x16x64_bf16 v[40:43], v[20:23], v[136:143], v7 abid:1
    v_and_b32_dpp v16, v56, v5 quad_perm:[0,0,0,0] row_mask:0xf bank_mask:0xf
    v_and_b32_dpp v19, v56, v6 quad_perm:[0,0,0,0] row_mask:0xf bank_mask:0xf
    v_smfmac_f32_16x16x64_bf16 v[44:47], v[20:23], v[144:151], v7 abid:1
    v_mov_b32_dpp v17, v16 row_shr:4 row_mask:0xf bank_mask:0xf bound_ctrl:0
    v_mov_b32_dpp v18, v19 row_shl:4 row_mask:0xf bank_mask:0xf bound_ctrl:0
    v_smfmac_f32_16x16x64_bf16 v[48:51], v[20:23], v[152:159], v7 abid:1
    s_waitcnt vmcnt(12)
    v_smfmac_f32_16x16x64_bf16 v[40:43], v[16:19], v[160:167], v7 abid:1
    v_and_b32_dpp v20, v56, v5 quad_perm:[2,2,2,2] row_mask:0xf bank_mask:0xf
    v_and_b32_dpp v23, v56, v6 quad_perm:[2,2,2,2] row_mask:0xf bank_mask:0xf
    v_smfmac_f32_16x16x64_bf16 v[44:47], v[16:19], v[168:175], v7 abid:1
    v_mov_b32_dpp v21, v20 row_shr:4 row_mask:0xf bank_mask:0xf bound_ctrl:0
    v_mov_b32_dpp v22, v23 row_shl:4 row_mask:0xf bank_mask:0xf bound_ctrl:0
    v_sub_f32 v55, v55, v62
    v_exp_f32 v55, v55
    v_smfmac_f32_16x16x64_bf16 v[48:51], v[16:19], v[176:183], v7 abid:1
    v_cvt_pk_bf16_f32 v57, v55, v55
    v_add_f32 v63, v63, v55
    v_smfmac_f32_16x16x64_bf16 v[40:43], v[20:23], v[184:191], v7 abid:1
    v_and_b32_dpp v16, v57, v5 quad_perm:[0,0,0,0] row_mask:0xf bank_mask:0xf
    v_and_b32_dpp v19, v57, v6 quad_perm:[0,0,0,0] row_mask:0xf bank_mask:0xf
    v_smfmac_f32_16x16x64_bf16 v[44:47], v[20:23], v[192:199], v7 abid:1
    v_mov_b32_dpp v17, v16 row_shr:4 row_mask:0xf bank_mask:0xf bound_ctrl:0
    v_mov_b32_dpp v18, v19 row_shl:4 row_mask:0xf bank_mask:0xf bound_ctrl:0
    v_smfmac_f32_16x16x64_bf16 v[48:51], v[20:23], v[200:207], v7 abid:1
    s_waitcnt vmcnt(0)
    v_smfmac_f32_16x16x64_bf16 v[40:43], v[16:19], v[208:215], v7 abid:1
    v_add_f32_dpp v63, v63, v63 quad_perm:[2,3,0,1] row_mask:0xf bank_mask:0xf
    v_and_b32_dpp v20, v57, v5 quad_perm:[2,2,2,2] row_mask:0xf bank_mask:0xf
    v_and_b32_dpp v23, v57, v6 quad_perm:[2,2,2,2] row_mask:0xf bank_mask:0xf
    v_add_f32_dpp v63, v63, v63 row_ror:4 row_mask:0xf bank_mask:0xf
    v_smfmac_f32_16x16x64_bf16 v[44:47], v[16:19], v[216:223], v7 abid:1
    v_mov_b32_dpp v21, v20 row_shr:4 row_mask:0xf bank_mask:0xf bound_ctrl:0
    v_mov_b32_dpp v22, v23 row_shl:4 row_mask:0xf bank_mask:0xf bound_ctrl:0
    v_add_f32_dpp v63, v63, v63 row_ror:8 row_mask:0xf bank_mask:0xf
    v_mov_b32 v58, v63
    v_smfmac_f32_16x16x64_bf16 v[48:51], v[16:19], v[224:231], v7 abid:1
    s_nop 0
    v_permlane16_swap_b32 v63, v58
    v_smfmac_f32_16x16x64_bf16 v[40:43], v[20:23], v[232:239], v7 abid:1
    v_add_f32 v63, v63, v58
    v_mov_b32 v58, v63
    v_smfmac_f32_16x16x64_bf16 v[44:47], v[20:23], v[240:247], v7 abid:1
    v_smfmac_f32_16x16x64_bf16 v[48:51], v[20:23], v[248:255], v7 abid:1
    v_permlane32_swap_b32 v63, v58
    v_add_f32 v63, v63, v58
    ds_write_b64 v61, v[62:63]
    s_mov_b32 exec_lo, 0x00ff00ff
    s_mov_b32 exec_hi, 0xff00ff00
    s_nop 0
    ds_write_b128 v15, v[40:43] offset:0
    ds_write_b128 v15, v[44:47] offset:256
    ds_write_b128 v15, v[48:51] offset:512
    s_mov_b64 exec, -1
    v_cmp_eq_u32 s[60:61], 24, v1
    s_cmp_eq_u32 s49, 0
    s_cbranch_scc1 HOOKC
EXB:
    s_waitcnt lgkmcnt(0)
    s_barrier
    ds_read_b128 v[16:19], v12
    ds_read_b128 v[20:23], v12 offset:16
    ds_read_b64 v[24:25], v60 offset:0
    ds_read_b64 v[26:27], v60 offset:768
    ds_read_b64 v[28:29], v60 offset:1536
    ds_read_b64 v[30:31], v60 offset:2304
    ds_read_b64 v[32:33], v60 offset:3072
    ds_read_b64 v[34:35], v60 offset:3840
    ds_read_b64 v[36:37], v60 offset:4608
    ds_read_b64 v[38:39], v60 offset:5376
    s_waitcnt lgkmcnt(8)
    v_max_f32 v40, v16, v18
    v_max3_f32 v40, v40, v20, v22
    v_sub_f32 v16, v16, v40
    v_sub_f32 v18, v18, v40
    v_sub_f32 v20, v20, v40
    v_sub_f32 v22, v22, v40
    v_exp_f32 v16, v16
    v_exp_f32 v18, v18
    v_exp_f32 v20, v20
    v_exp_f32 v22, v22
    v_mul_f32 v41, v16, v17
    v_fmac_f32 v41, v18, v19
    v_fmac_f32 v41, v20, v21
    v_fmac_f32 v41, v22, v23
    v_rcp_f32 v42, v41
    v_log_f32 v43, v41
    s_waitcnt lgkmcnt(0)
    v_pk_add_f32 v[24:25], v[24:25], v[26:27]
    v_pk_add_f32 v[28:29], v[28:29], v[30:31]
    v_pk_add_f32 v[32:33], v[32:33], v[34:35]
    v_pk_add_f32 v[36:37], v[36:37], v[38:39]
    v_pk_mul_f32 v[24:25], v[24:25], v[16:17] op_sel_hi:[1,0]
    v_pk_fma_f32 v[24:25], v[28:29], v[18:19], v[24:25] op_sel_hi:[1,0,1]
    v_pk_fma_f32 v[24:25], v[32:33], v[20:21], v[24:25] op_sel_hi:[1,0,1]
    v_pk_fma_f32 v[24:25], v[36:37], v[22:23], v[24:25] op_sel_hi:[1,0,1]
    v_pk_mul_f32 v[24:25], v[24:25], v[42:43] op_sel_hi:[1,0]
    v_add_f32 v43, v43, v40
    v_cvt_pk_bf16_f32 v24, v24, v25
    s_mov_b64 exec, 0x1ffffff
    v_cndmask_b32 v24, v24, v43, s[60:61]
    s_cmp_eq_u32 s50, 0
    s_cbranch_scc1 SLOW2
    buffer_store_dword v24, v14, s[16:19], s62 offen
PUBD2:
    s_mov_b64 exec, -1
    s_cmp_ge_u32 s46, 20
    s_cbranch_scc1 HOOKG3
    v_and_b32 v30, 7, v1
    v_lshrrev_b32 v31, 4, v1
    v_lshlrev_b32 v58, 4, v30
    v_lshl_add_u32 v58, v31, 7, v58
    s_mul_i32 s52, s56, 6144
    s_mul_i32 s54, s44, 1536
    s_add_u32 s52, s52, s54
    v_add_u32 v58, s52, v58
    s_lshr_b32 s53, s44, 1
    s_lshl_b32 s52, s56, 6
    s_lshl_b32 s54, s53, 5
    s_add_u32 s52, s52, s54
    s_add_u32 s52, s52, 19968
    v_lshl_add_u32 v59, v31, 2, v30
    v_and_b32 v59, 7, v59
    v_lshl_add_u32 v59, v59, 2, s52
    s_lshl_b32 s52, s57, 8
    s_add_u32 s52, s52, 131072
    s_or_b32 s53, s45, s56
    s_cmp_eq_u32 s53, 0
    s_cselect_b32 s52, s52, 1879048192
    v_lshl_add_u32 v61, v1, 2, s52
    v_mov_b64 v[44:45], 0
    v_mov_b64 v[46:47], 0
    v_mov_b64 v[48:49], 0
    v_mov_b64 v[50:51], 0
    v_mov_b64 v[52:53], 0
    v_mov_b64 v[54:55], 0
    s_mov_b32 s60, 0x00ff00ff
    s_mov_b32 s61, 0x00ff00ff
    s_mov_b32 s51, 0
    s_cmp_eq_u32 s49, 0
    s_cbranch_scc1 HOOKG
WO0:
    buffer_load_dword v57, v61, s[16:19], s49 offen sc1
    buffer_load_dword v56, v59, s[16:19], s62 offen sc1
    s_mov_b64 exec, s[60:61]
    buffer_load_dwordx4 v[44:47], v58, s[16:19], s62 offen offset:0 sc1
    buffer_load_dwordx4 v[48:51], v58, s[16:19], s62 offen offset:512 sc1
    buffer_load_dwordx4 v[52:55], v58, s[16:19], s62 offen offset:1024 sc1
    s_mov_b64 exec, -1
    s_cmp_eq_u32 s49, 0
    s_cbranch_scc1 HOOKG2
    s_nop 15
    s_nop 7
    v_lshrrev_b32 v14, 5, v1
    v_lshlrev_b32 v14, 11, v14
    v_and_b32 v15, 31, v1
    v_lshl_add_u32 v14, v15, 2, v14
    s_lshr_b32 s53, s57, 1
    s_lshl_b32 s52, s57, 12
    s_lshl_b32 s54, s53, 13
    s_add_u32 s52, s52, s54
    s_lshl_b32 s54, s45, 8
    s_add_u32 s52, s52, s54
    s_lshl_b32 s54, s56, 7
    s_add_u32 s52, s52, s54
    v_add_u32 v14, s52, v14
    s_xor_b32 s1, s0, 8192
    s_add_u32 s1, s1, s49
    s_add_u32 s99, s0, s49
    s_lshl_b32 s52, s44, 9
    s_add_u32 s52, s52, 104960
    v_lshl_add_u32 v15, v15, 4, s52
    v_and_b32 v64, 15, v1
    v_lshlrev_b32 v64, 4, v64
    v_lshl_add_u32 v64, v31, 2, v64
    v_add_u32 v64, 104960, v64
WOP:
    buffer_load_dword v57, v61, s[16:19], s49 offen sc1
    buffer_load_dword v56, v59, s[16:19], s62 offen sc1
    s_mov_b64 exec, s[60:61]
    buffer_load_dwordx4 v[44:47], v58, s[16:19], s62 offen offset:0 sc1
    buffer_load_dwordx4 v[48:51], v58, s[16:19], s62 offen offset:512 sc1
    buffer_load_dwordx4 v[52:55], v58, s[16:19], s62 offen offset:1024 sc1
    s_mov_b64 exec, -1
    s_waitcnt vmcnt(5)
WOC:
    v_max3_u32 v63, v44, v48, v52
    v_mov_b32 v32, v56
    v_max_u32 v63, v63, v32
    v_cmp_eq_u32 vcc, -1, v63
    s_cbranch_vccnz WOAG
    v_mfma_f32_16x16x32_bf16 v[16:19], v[44:47], v[80:83], 0
    v_max_f32_dpp v33, v32, v32 quad_perm:[1,0,3,2] row_mask:0xf bank_mask:0xf
    s_nop 0
    v_mfma_f32_16x16x32_bf16 v[16:19], v[48:51], v[96:99], v[16:19]
    v_max_f32_dpp v33, v33, v33 quad_perm:[2,3,0,1] row_mask:0xf bank_mask:0xf
    s_nop 0
    v_mfma_f32_16x16x32_bf16 v[16:19], v[52:55], v[112:115], v[16:19]
    v_max_f32_dpp v33, v33, v33 row_half_mirror row_mask:0xf bank_mask:0xf
    v_sub_f32 v34, v32, v33
    v_mfma_f32_16x16x32_bf16 v[20:23], v[44:47], v[84:87], 0
    v_exp_f32 v34, v34
    s_nop 0
    v_mfma_f32_16x16x32_bf16 v[20:23], v[48:51], v[100:103], v[20:23]
    v_add_f32_dpp v33, v34, v34 quad_perm:[1,0,3,2] row_mask:0xf bank_mask:0xf
    s_nop 0
    v_mfma_f32_16x16x32_bf16 v[20:23], v[52:55], v[116:119], v[20:23]
    v_add_f32_dpp v33, v33, v33 quad_perm:[2,3,0,1] row_mask:0xf bank_mask:0xf
    s_nop 0
    v_mfma_f32_16x16x32_bf16 v[24:27], v[44:47], v[88:91], 0
    v_add_f32_dpp v33, v33, v33 row_half_mirror row_mask:0xf bank_mask:0xf
    v_rcp_f32 v33, v33
    v_mfma_f32_16x16x32_bf16 v[24:27], v[48:51], v[104:107], v[24:27]
    v_mul_f32 v34, v34, v33
    s_nop 0
    v_mfma_f32_16x16x32_bf16 v[24:27], v[52:55], v[120:123], v[24:27]
    v_mul_f32_dpp v36, v34, v16 row_newbcast:0 row_mask:0xf bank_mask:0xf
    v_fmac_f32_dpp v36, v34, v17 row_newbcast:1 row_mask:0xf bank_mask:0xf
    v_mfma_f32_16x16x32_bf16 v[28:31], v[44:47], v[92:95], 0
    v_fmac_f32_dpp v36, v34, v18 row_newbcast:2 row_mask:0xf bank_mask:0xf
    v_fmac_f32_dpp v36, v34, v19 row_newbcast:3 row_mask:0xf bank_mask:0xf
    v_mfma_f32_16x16x32_bf16 v[28:31], v[48:51], v[108:111], v[28:31]
    v_mul_f32_dpp v37, v34, v20 row_newbcast:0 row_mask:0xf bank_mask:0xf
    v_fmac_f32_dpp v37, v34, v21 row_newbcast:1 row_mask:0xf bank_mask:0xf
    v_mfma_f32_16x16x32_bf16 v[28:31], v[52:55], v[124:127], v[28:31]
    v_fmac_f32_dpp v37, v34, v22 row_newbcast:2 row_mask:0xf bank_mask:0xf
    v_fmac_f32_dpp v37, v34, v23 row_newbcast:3 row_mask:0xf bank_mask:0xf
    v_cmp_u_f32 vcc, v36, v57
    v_mul_f32_dpp v38, v34, v24 row_newbcast:0 row_mask:0xf bank_mask:0xf
    v_fmac_f32_dpp v38, v34, v25 row_newbcast:1 row_mask:0xf bank_mask:0xf
    v_fmac_f32_dpp v38, v34, v26 row_newbcast:2 row_mask:0xf bank_mask:0xf
    v_fmac_f32_dpp v38, v34, v27 row_newbcast:3 row_mask:0xf bank_mask:0xf
    s_mov_b32 exec_hi, 0
    v_mul_f32_dpp v39, v34, v28 row_newbcast:0 row_mask:0xf bank_mask:0xf
    v_fmac_f32_dpp v39, v34, v29 row_newbcast:1 row_mask:0xf bank_mask:0xf
    v_fmac_f32_dpp v39, v34, v30 row_newbcast:2 row_mask:0xf bank_mask:0xf
    v_fmac_f32_dpp v39, v34, v31 row_newbcast:3 row_mask:0xf bank_mask:0xf
    s_cbranch_vccz WOOK
    s_mov_b64 exec, -1
WOAG:
    s_add_u32 s51, s51, 1
    s_cmp_lt_u32 s51, 0x8000
    s_cbranch_scc1 WOP
    s_mov_b32 exec_hi, 0
WOOK:
    ds_write_b128 v15, v[36:39]
    s_mov_b64 exec, -1
    s_cmp_lg_u32 s44, 3
    s_waitcnt lgkmcnt(0)
    s_barrier
    s_cbranch_scc1 WOX
    ds_read2st64_b32 v[16:17], v64 offset0:0 offset1:1
    ds_read2st64_b32 v[18:19], v64 offset0:2 offset1:3
    ds_read2st64_b32 v[20:21], v64 offset0:4 offset1:5
    ds_read2st64_b32 v[22:23], v64 offset0:6 offset1:7
    s_waitcnt lgkmcnt(2)
    v_pk_add_f32 v[16:17], v[16:17], v[18:19]
    v_add_f32 v16, v16, v57
    s_waitcnt lgkmcnt(0)
    v_pk_add_f32 v[20:21], v[20:21], v[22:23]
    v_pk_add_f32 v[16:17], v[16:17], v[20:21]
    v_add_f32 v16, v16, v17
    buffer_store_dword v16, v14, s[16:19], s1 offen sc1
    buffer_store_dword v16, v14, s[16:19], s99 offen sc1
WOX:
    s_cmp_ge_u32 s46, 30
    s_cbranch_scc1 STX
    s_cmp_eq_u32 s44, 3
    s_cbranch_scc1 F1W3
    s_waitcnt vmcnt(0)
F1W3:
    s_waitcnt vmcnt(2)
F1E:
    v_and_b32 v61, 3, v1
    v_lshlrev_b32 v61, 3, v61
    v_bfe_u32 v60, v1, 2, 2
    v_lshl_add_u32 v61, v60, 7, v61
    v_lshrrev_b32 v60, 4, v1
    v_lshl_add_u32 v61, v60, 10, v61
    v_bfe_u32 v60, v1, 3, 2
    v_lshl_add_u32 v61, v60, 5, v61
    s_lshl_b32 s52, s44, 5
    v_xor_b32 v61, s52, v61
    ds_read_b64_tr_b16 v[64:65], v61 offset:49152
    ds_read_b64_tr_b16 v[66:67], v61 offset:49664
    ds_read_b64_tr_b16 v[68:69], v61 offset:53248
    ds_read_b64_tr_b16 v[70:71], v61 offset:53760
    ds_read_b64_tr_b16 v[72:73], v61 offset:57344
    ds_read_b64_tr_b16 v[74:75], v61 offset:57856
    ds_read_b64_tr_b16 v[76:77], v61 offset:61440
    ds_read_b64_tr_b16 v[78:79], v61 offset:61952
    s_lshl_b32 s52, s59, 6
    s_lshl_b32 s54, s44, 4
    s_add_u32 s52, s52, s54
    v_add_u32 v14, s52, v1
    s_mul_i32 s52, s58, 3072
    s_lshl_b32 s54, s3, 2
    s_add_u32 s52, s52, s54
    s_lshl_b32 s53, s58, 2
    s_add_u32 s53, s53, 6144
    s_cmp_eq_u32 s3, 4
    s_cselect_b32 s52, s53, s52
    s_cselect_b32 s53, 3, 4
    v_lshlrev_b32 v14, s53, v14
    v_add_u32 v14, s52, v14
    s_lshl_b32 s52, s4, 3
    s_add_u32 s52, s52, 20224
    v_mov_b32 v15, s52
    v_and_b32 v57, 31, v1
    v_lshl_add_u32 v57, s44, 5, v57
    s_lshl_b32 s52, s4, 9
    s_add_u32 s52, s52, 133632
    s_cmp_lt_u32 s4, 5
    s_cselect_b32 s52, s52, 1879048192
    s_cmp_eq_u32 s45, 0
    s_cselect_b32 s52, s52, 1879048192
    v_lshl_add_u32 v56, v57, 2, s52
    v_lshlrev_b32 v57, 1, v57
    v_add_u32 v57, 96512, v57
    v_lshrrev_b32 v58, 5, v1
    v_lshlrev_b32 v58, 10, v58
    v_and_b32 v59, 31, v1
    v_lshl_add_u32 v58, v59, 2, v58
    s_lshl_b32 s52, s3, 14
    s_lshl_b32 s54, s44, 11
    s_add_u32 s52, s52, s54
    s_lshl_b32 s54, s0, 0
    s_add_u32 s52, s52, s54
    v_add_u32 v58, s52, v58
    v_min_u32 v54, 191, v0
    v_lshlrev_b32 v52, 4, v54
    v_lshlrev_b32 v54, 3, v54
    v_add_u32 v54, 6144, v54
    v_and_b32 v53, 15, v0
    s_mov_b32 s100, 0
    s_cmp_eq_u32 s49, 0
    s_cbranch_scc1 HOOKD
    s_cmp_lt_u32 s46, 20
    s_cbranch_scc1 GFB
    s_sleep 14
GFB:
    s_sleep 8
F1S:
    v_add_u32 v14, 12288, v14
    v_add_u32 v52, 12288, v52
    v_add_u32 v54, 12288, v54
    s_mov_b32 s51, 0
F1P:
    s_cmp_eq_u32 s100, 3
    s_cbranch_scc1 HOOKH
F1W:
    buffer_load_dword v44, v58, s[16:19], s49 offen offset:0 sc1
    buffer_load_dword v45, v58, s[16:19], s49 offen offset:128 sc1
    buffer_load_dword v46, v58, s[16:19], s49 offen offset:256 sc1
    buffer_load_dword v47, v58, s[16:19], s49 offen offset:384 sc1
    buffer_load_dword v48, v58, s[16:19], s49 offen offset:512 sc1
    buffer_load_dword v49, v58, s[16:19], s49 offen offset:640 sc1
    buffer_load_dword v50, v58, s[16:19], s49 offen offset:768 sc1
    buffer_load_dword v51, v58, s[16:19], s49 offen offset:896 sc1
    s_waitcnt vmcnt(0)
    v_pk_add_f32 v[16:17], v[44:45], v[46:47]
    v_pk_add_f32 v[18:19], v[48:49], v[50:51]
    v_pk_add_f32 v[16:17], v[16:17], v[18:19]
    v_add_f32 v16, v16, v17
    v_mov_b32 v17, v16
    s_nop 1
    v_permlane32_swap_b32 v16, v17
    v_add_f32 v16, v16, v17
    v_cmp_u_f32 vcc, v16, v16
    v_cvt_pk_bf16_f32 v16, v16, v16
    ds_write_b16 v57, v16
    s_cbranch_vccz F1OK
    s_add_u32 s51, s51, 1
    s_sleep 1
    s_cmp_lt_u32 s51, 0x8000
    s_cbranch_scc1 F1P
F1OK:
    v_and_b32 v16, 0xffff0000, v16
    s_mov_b32 exec_hi, 0
    s_cmp_eq_u32 s50, 0
    s_cbranch_scc1 SLOW7
    buffer_store_dword v16, v56, s[16:19], s49 offen
PUBD7:
    s_mov_b64 exec, -1
    s_waitcnt lgkmcnt(0)
    s_barrier
    ds_read_b128 v[20:23], v2 offset:256
    ds_read_b128 v[24:27], v2 offset:320
    ds_read_b128 v[28:31], v2 offset:384
    ds_read_b128 v[32:35], v2 offset:448
    s_waitcnt lgkmcnt(3)
    v_mfma_f32_16x16x32_bf16 v[40:43], v[20:23], v[64:67], 0
    v_mfma_f32_16x16x32_bf16 v[36:39], v[20:23], v[20:23], 0
    s_waitcnt lgkmcnt(2)
    v_mfma_f32_16x16x32_bf16 v[40:43], v[24:27], v[68:71], v[40:43]
    v_mfma_f32_16x16x32_bf16 v[36:39], v[24:27], v[24:27], v[36:39]
    s_waitcnt lgkmcnt(1)
    v_mfma_f32_16x16x32_bf16 v[40:43], v[28:31], v[72:75], v[40:43]
    v_mfma_f32_16x16x32_bf16 v[36:39], v[28:31], v[28:31], v[36:39]
    s_waitcnt lgkmcnt(0)
    v_mfma_f32_16x16x32_bf16 v[40:43], v[32:35], v[76:79], v[40:43]
    v_mfma_f32_16x16x32_bf16 v[36:39], v[32:35], v[32:35], v[36:39]
    s_mov_b64 exec, 0xffff
    s_waitcnt vmcnt(1)
    s_nop 2
    s_cmp_eq_u32 s50, 0
    s_cbranch_scc1 SLOW8
    buffer_store_dword v40, v14, s[16:19], s62 offen
    s_mov_b64 exec, 1
    buffer_store_dwordx2 v[36:37], v15, s[16:19], s62 offen
PUBD8:
    s_mov_b64 exec, -1
    s_cmp_lt_u32 s46, 20
    s_cbranch_scc1 STX
    v_and_b32 v58, 7, v1
    v_cmp_gt_u32 vcc, 5, v58
    v_lshlrev_b32 v58, 3, v58
    v_add_u32 v58, 20224, v58
    v_mov_b32 v59, 1879048192
    v_cndmask_b32 v58, v59, v58, vcc
    s_lshl_b32 s52, s57, 8
    s_lshl_b32 s54, s44, 6
    s_add_u32 s52, s52, s54
    s_add_u32 s52, s52, 133632
    s_cmp_eq_u32 s45, 0
    s_cselect_b32 s52, s52, 1879048192
    v_lshl_add_u32 v59, v53, 2, s52
    s_cmp_eq_u32 s44, 3
    s_cselect_b32 s53, 1879048192, s62
    s_nop 3
W20:
    s_nop 11
    buffer_load_dword v76, v59, s[16:19], s49 offen sc1
    buffer_load_dwordx2 v[74:75], v58, s[16:19], s62 offen sc1
    buffer_load_dwordx4 v[64:67], v52, s[16:19], s53 offen offset:0 sc1
    buffer_load_dwordx4 v[68:71], v52, s[16:19], s53 offen offset:3072 sc1
    buffer_load_dwordx2 v[72:73], v54, s[16:19], s53 offen sc1
    s_lshr_b32 s1, s57, 2
    s_lshr_b32 s99, s44, 1
    s_lshl_b32 s52, s57, 11
    s_lshl_b32 s54, s1, 13
    s_add_u32 s52, s52, s54
    s_mul_i32 s54, s99, 896
    s_add_u32 s52, s52, s54
    s_lshl_b32 s54, s44, 6
    s_add_u32 s52, s52, s54
    s_lshl_b32 s54, s45, 7
    s_add_u32 s52, s52, s54
    s_add_u32 s52, s52, 81920
    v_lshl_add_u32 v14, v53, 2, s52
    v_bfe_u32 v15, v1, 4, 1
    v_lshl_add_u32 v14, v15, 13, v14
    v_lshlrev_b32 v57, 1, v0
    v_add_u32 v57, 96768, v57
    s_mov_b32 s51, 0
    s_cmp_eq_u32 s49, 0
    s_cbranch_scc1 HOOKI
    s_nop 15
    s_nop 7
W2P:
    buffer_load_dword v76, v59, s[16:19], s49 offen sc1
    buffer_load_dwordx2 v[74:75], v58, s[16:19], s62 offen sc1
    buffer_load_dwordx4 v[64:67], v52, s[16:19], s53 offen offset:0 sc1
    buffer_load_dwordx4 v[68:71], v52, s[16:19], s53 offen offset:3072 sc1
    buffer_load_dwordx2 v[72:73], v54, s[16:19], s53 offen sc1
    s_waitcnt vmcnt(5)
W2C:
    v_add_f32_dpp v36, v74, v74 quad_perm:[1,0,3,2] row_mask:0xf bank_mask:0xf
    v_add_f32_dpp v37, v75, v75 quad_perm:[1,0,3,2] row_mask:0xf bank_mask:0xf
    v_pk_add_f32 v[18:19], v[64:65], v[66:67]
    v_add_f32_dpp v36, v36, v36 quad_perm:[2,3,0,1] row_mask:0xf bank_mask:0xf
    v_add_f32_dpp v37, v37, v37 quad_perm:[2,3,0,1] row_mask:0xf bank_mask:0xf
    v_pk_add_f32 v[20:21], v[68:69], v[70:71]
    v_add_f32_dpp v36, v36, v36 row_half_mirror row_mask:0xf bank_mask:0xf
    v_add_f32_dpp v37, v37, v37 row_half_mirror row_mask:0xf bank_mask:0xf
    v_add_f32 v16, v18, v19
    v_add_f32 v17, v20, v21
    v_mul_f32 v37, 0x3acccccd, v37
    v_fmamk_f32 v36, v36, 0x3acccccd, v11
    v_fma_f32 v36, -v37, v37, v36
    v_rsq_f32 v36, v36
    v_pk_add_f32 v[16:17], v[16:17], v[72:73]
    v_pk_fma_f32 v[16:17], v[36:37], v[126:127], v[16:17] op_sel:[1,0,0] op_sel_hi:[1,1,1] neg_lo:[1,0,0] neg_hi:[1,0,0]
    v_pk_mul_f32 v[16:17], v[16:17], v[36:37] op_sel_hi:[1,0]
    v_mul_f32 v18, 0xbfb8aa3b, v16
    v_exp_f32 v18, v18
    v_mul_f32 v16, v16, v17
    v_add_f32 v18, 1.0, v18
    v_rcp_f32 v18, v18
    v_cmp_u_f32 vcc, v16, v76
    v_mul_f32 v16, v16, v18
    v_cvt_pk_bf16_f32 v16, v16, v16
    ds_write_b16 v57, v16
    s_cbranch_vccz W2OK
    s_add_u32 s51, s51, 1
    s_cmp_lt_u32 s51, 0x8000
    s_cbranch_scc1 W2P
W2OK:
    s_waitcnt lgkmcnt(0)
    s_barrier
    ds_read_b128 v[16:19], v2 offset:512
    ds_read_b128 v[20:23], v2 offset:576
    ds_read_b128 v[24:27], v2 offset:640
    ds_read_b128 v[28:31], v2 offset:704
    ds_read_b128 v[32:35], v2 offset:768
    ds_read_b128 v[36:39], v2 offset:832
    s_waitcnt lgkmcnt(5)
    v_mfma_f32_16x16x32_bf16 v[40:43], v[16:19], v[80:83], 0
    s_waitcnt lgkmcnt(4)
    v_mfma_f32_16x16x32_bf16 v[40:43], v[20:23], v[84:87], v[40:43]
    s_waitcnt lgkmcnt(3)
    v_mfma_f32_16x16x32_bf16 v[40:43], v[24:27], v[88:91], v[40:43]
    s_waitcnt lgkmcnt(2)
    v_mfma_f32_16x16x32_bf16 v[40:43], v[28:31], v[92:95], v[40:43]
    s_waitcnt lgkmcnt(1)
    v_mfma_f32_16x16x32_bf16 v[40:43], v[32:35], v[96:99], v[40:43]
    s_waitcnt lgkmcnt(0)
    v_mfma_f32_16x16x32_bf16 v[40:43], v[36:39], v[100:103], v[40:43]
    s_mov_b32 exec_hi, 0
    s_waitcnt vmcnt(0)
    s_nop 5
    v_add_f32 v40, v40, v76
    buffer_store_dword v40, v14, s[16:19], s49 offen sc1
    s_mov_b64 exec, -1
STX:
    s_cmp_lg_u32 s49, 0
    s_cbranch_scc1 LAST
    s_branch LOOP
LAST:
    s_and_b32 s52, s2, 0xc7
    s_cmp_eq_u32 s52, 0
    s_cbranch_scc1 LOOP
    s_endpgm
FINAL:
    s_cmp_eq_u32 s44, 3
    s_cbranch_scc1 FINX
    v_lshlrev_b32 v20, 1, v29
    s_mul_i32 s52, s48, 160
    s_mov_b32 exec_lo, s60
    s_mov_b32 exec_hi, 0
    buffer_store_short v30, v20, s[36:39], s52 offen
    s_mov_b64 exec, -1
FINX:
DONE:
    s_endpgm
HOOKL:
    s_cmp_lg_u32 s49, 0
    s_cbranch_scc1 HL2
    s_cmp_lt_u32 s46, 30
    s_cbranch_scc1 NOGSW
    v_mov_b32 v20, 20224
    s_mov_b32 s51, 0
GSW:
    buffer_load_dword v21, v20, s[16:19], s62 offen sc1
    s_waitcnt vmcnt(0)
    v_cmp_u_f32 vcc, v21, v21
    s_cbranch_vccz NOGSW
    s_add_u32 s51, s51, 1
    s_sleep 2
    s_cmp_lt_u32 s51, 0x8000
    s_cbranch_scc1 GSW
NOGSW:
    s_cmp_ge_u32 s46, 30
    s_cselect_b32 s53, 10, 0
    s_sub_u32 s53, s46, s53
    v_min_u32 v31, 17, v1
    v_lshlrev_b32 v31, 7, v31
    s_mul_i32 s52, s45, 45312
    s_mul_i32 s54, s53, 2304
    s_add_u32 s52, s52, s54
    s_add_u32 s52, s52, 524288
    buffer_load_dword v31, v31, s[16:19], s52 offen sc1
    v_lshlrev_b32 v27, 3, v0
    s_mul_i32 s52, s47, 12288
    s_add_u32 s52, s52, 1441792
    s_add_u32 s53, s52, 0
    buffer_load_dwordx2 v[32:33], v27, s[16:19], s53 offen offset:0 sc1
    buffer_load_dwordx2 v[34:35], v27, s[16:19], s53 offen offset:1536 sc1
    s_add_u32 s53, s52, 3072
    buffer_load_dwordx2 v[36:37], v27, s[16:19], s53 offen offset:0 sc1
    buffer_load_dwordx2 v[38:39], v27, s[16:19], s53 offen offset:1536 sc1
    s_add_u32 s53, s52, 6144
    buffer_load_dwordx2 v[40:41], v27, s[16:19], s53 offen offset:0 sc1
    buffer_load_dwordx2 v[42:43], v27, s[16:19], s53 offen offset:1536 sc1
    s_add_u32 s53, s52, 9216
    buffer_load_dwordx2 v[16:17], v27, s[16:19], s53 offen offset:0 sc1
    buffer_load_dwordx2 v[20:21], v27, s[16:19], s53 offen offset:1536 sc1
    s_sleep 21
    s_branch GYB
HL2:
    s_sleep 20
    s_branch GYB
HOOKA:
    s_nop 3
    s_lshl_b32 s52, s44, 6
    s_add_u32 s52, s52, 98816
    v_lshl_add_u32 v14, v1, 2, s52
    ds_write_b32 v14, v17 offset:8704
    v_fma_f32 v16, -v84, v17, v16
    v_mul_f32 v16, v16, v85
    ds_write_b32 v14, v16 offset:0
    ds_write_b32 v14, v21 offset:8960
    v_fma_f32 v20, -v84, v21, v20
    v_mul_f32 v20, v20, v85
    ds_write_b32 v14, v20 offset:256
    ds_write_b32 v14, v25 offset:9216
    v_fma_f32 v24, -v84, v25, v24
    v_mul_f32 v24, v24, v85
    ds_write_b32 v14, v24 offset:512
    s_mov_b64 exec, -1
    s_add_u32 s44, s44, 1
    s_cmp_lt_u32 s44, 4
    s_cbranch_scc1 LOOP
    s_mov_b32 s44, 3
    v_lshlrev_b32 v14, 2, v1
    v_add_u32 v14, 98816, v14
    ds_read2st64_b32 v[16:17], v14 offset0:0 offset1:1
    ds_read_b32 v18, v14 offset:512
    s_lshl_b32 s52, s47, 13
    s_lshl_b32 s54, s48, 10
    s_add_u32 s52, s52, s54
    s_add_u32 s52, s52, 1114112
    s_waitcnt lgkmcnt(0)
    v_bitop3_b32 v19, v16, v17, v18 bitop3:0x96
    v_xor_b32 v19, v19, v89
    buffer_store_dwordx4 v[16:19], v88, s[16:19], s52 offen sc1
    s_sleep 24
    v_and_b32 v15, 0xe1, v1
    v_lshlrev_b32 v15, 1, v15
    v_bfe_u32 v14, v1, 4, 1
    v_lshl_add_u32 v15, v14, 3, v15
    v_bfe_u32 v14, v1, 3, 1
    v_lshl_add_u32 v15, v14, 5, v15
    v_bfe_u32 v14, v1, 2, 1
    v_lshl_add_u32 v15, v14, 2, v15
    v_bfe_u32 v14, v1, 1, 1
    v_lshl_add_u32 v15, v14, 4, v15
    v_add_u32 v15, 98304, v15
    s_lshl_b32 s52, s47, 13
    s_add_u32 s52, s52, 1114112
    s_add_u32 s53, s52, 4096
    s_mov_b32 s51, 0
Q0P:
    buffer_load_dwordx4 v[16:19], v88, s[16:19], s52 offen offset:0 sc1
    buffer_load_dwordx4 v[20:23], v88, s[16:19], s52 offen offset:1024 sc1
    buffer_load_dwordx4 v[24:27], v88, s[16:19], s52 offen offset:2048 sc1
    buffer_load_dwordx4 v[28:31], v88, s[16:19], s52 offen offset:3072 sc1
    buffer_load_dwordx4 v[32:35], v88, s[16:19], s53 offen offset:0 sc1
    buffer_load_dwordx4 v[36:39], v88, s[16:19], s53 offen offset:1024 sc1
    buffer_load_dwordx4 v[40:43], v88, s[16:19], s53 offen offset:2048 sc1
    buffer_load_dwordx4 v[44:47], v88, s[16:19], s53 offen offset:3072 sc1
    v_mov_b32 v48, 0
    s_waitcnt vmcnt(0)
    v_bitop3_b32 v49, v16, v17, v18 bitop3:0x96
    v_bitop3_b32 v49, v49, v19, v89 bitop3:0x96
    v_or_b32 v48, v48, v49
    v_bitop3_b32 v49, v20, v21, v22 bitop3:0x96
    v_bitop3_b32 v49, v49, v23, v89 bitop3:0x96
    v_or_b32 v48, v48, v49
    v_bitop3_b32 v49, v24, v25, v26 bitop3:0x96
    v_bitop3_b32 v49, v49, v27, v89 bitop3:0x96
    v_or_b32 v48, v48, v49
    v_bitop3_b32 v49, v28, v29, v30 bitop3:0x96
    v_bitop3_b32 v49, v49, v31, v89 bitop3:0x96
    v_or_b32 v48, v48, v49
    v_bitop3_b32 v49, v32, v33, v34 bitop3:0x96
    v_bitop3_b32 v49, v49, v35, v89 bitop3:0x96
    v_or_b32 v48, v48, v49
    v_bitop3_b32 v49, v36, v37, v38 bitop3:0x96
    v_bitop3_b32 v49, v49, v39, v89 bitop3:0x96
    v_or_b32 v48, v48, v49
    v_bitop3_b32 v49, v40, v41, v42 bitop3:0x96
    v_bitop3_b32 v49, v49, v43, v89 bitop3:0x96
    v_or_b32 v48, v48, v49
    v_bitop3_b32 v49, v44, v45, v46 bitop3:0x96
    v_bitop3_b32 v49, v49, v47, v89 bitop3:0x96
    v_or_b32 v48, v48, v49
    v_cmp_ne_u32 vcc, 0, v48
    s_cbranch_vccz Q0OK
    s_add_u32 s51, s51, 1
    s_sleep 4
    s_cmp_lt_u32 s51, 0x8000
    s_cbranch_scc1 Q0P
Q0OK:
    v_pk_add_f32 v[16:17], v[16:17], v[20:21]
    v_add_f32 v18, v18, v22
    v_pk_add_f32 v[16:17], v[16:17], v[24:25]
    v_add_f32 v18, v18, v26
    v_pk_add_f32 v[16:17], v[16:17], v[28:29]
    v_add_f32 v18, v18, v30
    v_pk_add_f32 v[16:17], v[16:17], v[32:33]
    v_add_f32 v18, v18, v34
    v_pk_add_f32 v[16:17], v[16:17], v[36:37]
    v_add_f32 v18, v18, v38
    v_pk_add_f32 v[16:17], v[16:17], v[40:41]
    v_add_f32 v18, v18, v42
    v_pk_add_f32 v[16:17], v[16:17], v[44:45]
    v_add_f32 v18, v18, v46
    v_cvt_pk_bf16_f32 v16, v16, v17
    v_cvt_pk_bf16_f32 v18, v18, v18
    ds_write_b16 v15, v16
    ds_write_b16_d16_hi v15, v16 offset:128
    ds_write_b16 v15, v18 offset:256
    s_mov_b32 s51, 0
HSP:
    s_mov_b32 s52, 1376256
    buffer_load_dwordx4 v[24:27], v88, s[16:19], s52 offen sc1
    s_waitcnt vmcnt(0)
    v_xor_b32 v20, s5, v24
    v_xor_b32 v21, s5, v25
    v_xor_b32 v22, s5, v26
    v_xor_b32 v23, s5, v27
    v_or3_b32 v20, v20, v21, v22
    v_or_b32 v20, v20, v23
    v_cmp_lt_u32 vcc, 31, v20
    s_cbranch_vccz HSOK
    s_add_u32 s51, s51, 1
    s_sleep 8
    s_cmp_lt_u32 s51, 0x8000
    s_cbranch_scc1 HSP
HSOK:
    s_mov_b32 s53, 0
    v_and_b32 v24, 16, v24
    v_cmp_ne_u32 vcc, 0, v24
    s_bcnt1_i32_b64 s52, vcc
    s_add_u32 s53, s53, s52
    v_and_b32 v25, 16, v25
    v_cmp_ne_u32 vcc, 0, v25
    s_bcnt1_i32_b64 s52, vcc
    s_add_u32 s53, s53, s52
    v_and_b32 v26, 16, v26
    v_cmp_ne_u32 vcc, 0, v26
    s_bcnt1_i32_b64 s52, vcc
    s_add_u32 s53, s53, s52
    v_and_b32 v27, 16, v27
    v_cmp_ne_u32 vcc, 0, v27
    s_bcnt1_i32_b64 s52, vcc
    s_add_u32 s53, s53, s52
    v_and_b32 v20, 15, v20
    s_cmp_gt_u32 s53, 128
    s_cselect_b32 s53, 2, 0
    s_lshr_b32 s52, s5, 1
    s_xor_b32 s53, s53, s52
    s_and_b32 s53, s53, 2
    s_lshl_b32 s52, s45, 3
    v_cmp_ne_u32 vcc, 0, v20
    s_lshr_b64 s[60:61], vcc, s52
    s_and_b32 s52, s60, 0xff
    s_cselect_b32 s50, 0, 1
    v_mov_b32 v38, 98784
    s_or_b32 s53, s53, s50
    v_or_b32 v39, s53, v89
    ds_write_b32 v38, v39
    v_and_b32 v21, 0xffff0000, v86
    v_lshlrev_b32 v20, 16, v86
    buffer_store_dwordx2 v[20:21], v87, s[16:19], 0 offen sc1
    s_branch ENTRY
HOOKE:
    s_cmp_lg_u32 s44, 3
    s_cbranch_scc1 QFRAG
    s_waitcnt lgkmcnt(0)
    s_barrier
    s_waitcnt vmcnt(23)
    buffer_load_dwordx4 a[0:3], v80, s[8:11], s96 offen offset:0 nt
    s_waitcnt vmcnt(23)
    buffer_load_dwordx4 a[8:11], v80, s[8:11], s96 offen offset:128 nt
    s_waitcnt vmcnt(23)
    buffer_load_dwordx4 a[16:19], v80, s[8:11], s96 offen offset:256 nt
    s_add_u32 s96, s96, s97
    s_waitcnt vmcnt(23)
    buffer_load_dwordx4 a[4:7], v80, s[8:11], s96 offen offset:0 nt
    s_waitcnt vmcnt(23)
    buffer_load_dwordx4 a[12:15], v80, s[8:11], s96 offen offset:128 nt
    s_waitcnt vmcnt(23)
    buffer_load_dwordx4 a[20:23], v80, s[8:11], s96 offen offset:256 nt
    s_add_u32 s96, s96, s97
    s_waitcnt vmcnt(23)
    buffer_load_dwordx4 a[24:27], v80, s[8:11], s96 offen offset:0 nt
    s_waitcnt vmcnt(23)
    buffer_load_dwordx4 a[32:35], v80, s[8:11], s96 offen offset:128 nt
    s_waitcnt vmcnt(23)
    buffer_load_dwordx4 a[40:43], v80, s[8:11], s96 offen offset:256 nt
    s_add_u32 s96, s96, s97
    s_waitcnt vmcnt(23)
    buffer_load_dwordx4 a[28:31], v80, s[8:11], s96 offen offset:0 nt
    s_waitcnt vmcnt(23)
    buffer_load_dwordx4 a[36:39], v80, s[8:11], s96 offen offset:128 nt
    s_waitcnt vmcnt(23)
    buffer_load_dwordx4 a[44:47], v80, s[8:11], s96 offen offset:256 nt
    s_add_u32 s96, s96, s97
    s_waitcnt vmcnt(23)
    buffer_load_dwordx4 a[48:51], v80, s[8:11], s96 offen offset:0 nt
    s_waitcnt vmcnt(23)
    buffer_load_dwordx4 a[56:59], v80, s[8:11], s96 offen offset:128 nt
    s_waitcnt vmcnt(23)
    buffer_load_dwordx4 a[64:67], v80, s[8:11], s96 offen offset:256 nt
    s_add_u32 s96, s96, s97
    s_waitcnt vmcnt(23)
    buffer_load_dwordx4 a[52:55], v80, s[8:11], s96 offen offset:0 nt
    s_waitcnt vmcnt(23)
    buffer_load_dwordx4 a[60:63], v80, s[8:11], s96 offen offset:128 nt
    s_waitcnt vmcnt(23)
    buffer_load_dwordx4 a[68:71], v80, s[8:11], s96 offen offset:256 nt
    s_add_u32 s96, s96, s97
    s_waitcnt vmcnt(23)
    buffer_load_dwordx4 a[72:75], v80, s[8:11], s96 offen offset:0 nt
    s_waitcnt vmcnt(23)
    buffer_load_dwordx4 a[80:83], v80, s[8:11], s96 offen offset:128 nt
    s_waitcnt vmcnt(23)
    buffer_load_dwordx4 a[88:91], v80, s[8:11], s96 offen offset:256 nt
    s_add_u32 s96, s96, s97
    s_waitcnt vmcnt(23)
    buffer_load_dwordx4 a[76:79], v80, s[8:11], s96 offen offset:0 nt
    s_waitcnt vmcnt(23)
    buffer_load_dwordx4 a[84:87], v80, s[8:11], s96 offen offset:128 nt
    s_waitcnt vmcnt(23)
    buffer_load_dwordx4 a[92:95], v80, s[8:11], s96 offen offset:256 nt
    s_add_u32 s96, s96, s97
    s_waitcnt vmcnt(23)
    buffer_load_dwordx4 a[96:99], v80, s[8:11], s96 offen offset:0 nt
    s_waitcnt vmcnt(23)
    buffer_load_dwordx4 a[104:107], v80, s[8:11], s96 offen offset:128 nt
    s_waitcnt vmcnt(23)
    buffer_load_dwordx4 a[112:115], v80, s[8:11], s96 offen offset:256 nt
    s_add_u32 s96, s96, s97
    s_waitcnt vmcnt(23)
    buffer_load_dwordx4 a[100:103], v80, s[8:11], s96 offen offset:0 nt
    s_waitcnt vmcnt(23)
    buffer_load_dwordx4 a[108:111], v80, s[8:11], s96 offen offset:128 nt
    s_waitcnt vmcnt(23)
    buffer_load_dwordx4 a[116:119], v80, s[8:11], s96 offen offset:256 nt
    s_add_u32 s96, s96, s97
    s_waitcnt vmcnt(23)
    buffer_load_dwordx4 a[120:123], v80, s[8:11], s96 offen offset:0 nt
    s_waitcnt vmcnt(23)
    buffer_load_dwordx4 a[128:131], v80, s[8:11], s96 offen offset:128 nt
    s_waitcnt vmcnt(23)
    buffer_load_dwordx4 a[136:139], v80, s[8:11], s96 offen offset:256 nt
    s_add_u32 s96, s96, s97
    s_waitcnt vmcnt(23)
    buffer_load_dwordx4 a[124:127], v80, s[8:11], s96 offen offset:0 nt
    s_waitcnt vmcnt(23)
    buffer_load_dwordx4 a[132:135], v80, s[8:11], s96 offen offset:128 nt
    s_waitcnt vmcnt(23)
    buffer_load_dwordx4 a[140:143], v80, s[8:11], s96 offen offset:256 nt
    s_add_u32 s96, s96, s97
    s_waitcnt vmcnt(23)
    buffer_load_dwordx4 a[144:147], v80, s[8:11], s96 offen offset:0 nt
    s_waitcnt vmcnt(23)
    buffer_load_dwordx4 a[152:155], v80, s[8:11], s96 offen offset:128 nt
    s_waitcnt vmcnt(23)
    buffer_load_dwordx4 a[160:163], v80, s[8:11], s96 offen offset:256 nt
    s_add_u32 s96, s96, s97
    s_waitcnt vmcnt(23)
    buffer_load_dwordx4 a[148:151], v80, s[8:11], s96 offen offset:0 nt
    s_waitcnt vmcnt(23)
    buffer_load_dwordx4 a[156:159], v80, s[8:11], s96 offen offset:128 nt
    s_waitcnt vmcnt(23)
    buffer_load_dwordx4 a[164:167], v80, s[8:11], s96 offen offset:256 nt
    s_add_u32 s96, s96, s97
    s_waitcnt vmcnt(23)
    buffer_load_dwordx4 a[168:171], v80, s[8:11], s96 offen offset:0 nt
    s_waitcnt vmcnt(23)
    buffer_load_dwordx4 a[176:179], v80, s[8:11], s96 offen offset:128 nt
    s_waitcnt vmcnt(23)
    buffer_load_dwordx4 a[184:187], v80, s[8:11], s96 offen offset:256 nt
    s_add_u32 s96, s96, s97
    s_waitcnt vmcnt(23)
    buffer_load_dwordx4 a[172:175], v80, s[8:11], s96 offen offset:0 nt
    s_waitcnt vmcnt(23)
    buffer_load_dwordx4 a[180:183], v80, s[8:11], s96 offen offset:128 nt
    s_waitcnt vmcnt(23)
    buffer_load_dwordx4 a[188:191], v80, s[8:11], s96 offen offset:256 nt
    s_lshl_b32 s97, s97, 1
    s_waitcnt vmcnt(23)
    buffer_load_dwordx4 a[192:195], v82, s[12:15], s55 offen offset:0 nt
    s_waitcnt vmcnt(23)
    buffer_load_dwordx4 a[200:203], v82, s[12:15], s55 offen offset:128 nt
    s_waitcnt vmcnt(23)
    buffer_load_dwordx4 a[208:211], v82, s[12:15], s55 offen offset:256 nt
    s_waitcnt vmcnt(23)
    buffer_load_dwordx4 a[216:219], v82, s[12:15], s55 offen offset:384 nt
    s_waitcnt vmcnt(23)
    buffer_load_dwordx4 a[224:227], v82, s[12:15], s55 offen offset:512 nt
    s_waitcnt vmcnt(23)
    buffer_load_dwordx4 a[232:235], v82, s[12:15], s55 offen offset:640 nt
    s_add_u32 s55, s55, s97
    s_waitcnt vmcnt(23)
    buffer_load_dwordx4 a[196:199], v82, s[12:15], s55 offen offset:0 nt
    s_waitcnt vmcnt(23)
    buffer_load_dwordx4 a[204:207], v82, s[12:15], s55 offen offset:128 nt
    s_waitcnt vmcnt(23)
    buffer_load_dwordx4 a[212:215], v82, s[12:15], s55 offen offset:256 nt
    s_waitcnt vmcnt(23)
    buffer_load_dwordx4 a[220:223], v82, s[12:15], s55 offen offset:384 nt
    s_waitcnt vmcnt(23)
    buffer_load_dwordx4 a[228:231], v82, s[12:15], s55 offen offset:512 nt
    s_waitcnt vmcnt(23)
    buffer_load_dwordx4 a[236:239], v82, s[12:15], s55 offen offset:640 nt
    s_add_u32 s55, s55, s97
    s_waitcnt vmcnt(23)
    buffer_load_dwordx4 a[240:243], v82, s[12:15], s55 offen offset:0 nt
    s_waitcnt vmcnt(23)
    buffer_load_dwordx4 a[248:251], v82, s[12:15], s55 offen offset:128 nt
    s_waitcnt vmcnt(23)
    buffer_load_dwordx4 v[128:131], v82, s[12:15], s55 offen offset:256 nt
    s_waitcnt vmcnt(23)
    buffer_load_dwordx4 v[136:139], v82, s[12:15], s55 offen offset:384 nt
    s_waitcnt vmcnt(23)
    buffer_load_dwordx4 v[144:147], v82, s[12:15], s55 offen offset:512 nt
    s_waitcnt vmcnt(23)
    buffer_load_dwordx4 v[152:155], v82, s[12:15], s55 offen offset:640 nt
    s_add_u32 s55, s55, s97
    s_waitcnt vmcnt(23)
    buffer_load_dwordx4 a[244:247], v82, s[12:15], s55 offen offset:0 nt
    s_waitcnt vmcnt(23)
    buffer_load_dwordx4 a[252:255], v82, s[12:15], s55 offen offset:128 nt
    s_waitcnt vmcnt(23)
    buffer_load_dwordx4 v[132:135], v82, s[12:15], s55 offen offset:256 nt
    s_waitcnt vmcnt(23)
    buffer_load_dwordx4 v[140:143], v82, s[12:15], s55 offen offset:384 nt
    s_waitcnt vmcnt(23)
    buffer_load_dwordx4 v[148:151], v82, s[12:15], s55 offen offset:512 nt
    s_waitcnt vmcnt(23)
    buffer_load_dwordx4 v[156:159], v82, s[12:15], s55 offen offset:640 nt
    s_add_u32 s55, s55, s97
    s_waitcnt vmcnt(23)
    buffer_load_dwordx4 v[160:163], v82, s[12:15], s55 offen offset:0 nt
    s_waitcnt vmcnt(23)
    buffer_load_dwordx4 v[168:171], v82, s[12:15], s55 offen offset:128 nt
    s_waitcnt vmcnt(23)
    buffer_load_dwordx4 v[176:179], v82, s[12:15], s55 offen offset:256 nt
    s_waitcnt vmcnt(23)
    buffer_load_dwordx4 v[184:187], v82, s[12:15], s55 offen offset:384 nt
    s_waitcnt vmcnt(23)
    buffer_load_dwordx4 v[192:195], v82, s[12:15], s55 offen offset:512 nt
    s_waitcnt vmcnt(23)
    buffer_load_dwordx4 v[200:203], v82, s[12:15], s55 offen offset:640 nt
    s_add_u32 s55, s55, s97
    s_waitcnt vmcnt(23)
    buffer_load_dwordx4 v[164:167], v82, s[12:15], s55 offen offset:0 nt
    s_waitcnt vmcnt(23)
    buffer_load_dwordx4 v[172:175], v82, s[12:15], s55 offen offset:128 nt
    s_waitcnt vmcnt(23)
    buffer_load_dwordx4 v[180:183], v82, s[12:15], s55 offen offset:256 nt
    s_waitcnt vmcnt(23)
    buffer_load_dwordx4 v[188:191], v82, s[12:15], s55 offen offset:384 nt
    s_waitcnt vmcnt(23)
    buffer_load_dwordx4 v[196:199], v82, s[12:15], s55 offen offset:512 nt
    s_waitcnt vmcnt(23)
    buffer_load_dwordx4 v[204:207], v82, s[12:15], s55 offen offset:640 nt
    s_add_u32 s55, s55, s97
    s_waitcnt vmcnt(23)
    buffer_load_dwordx4 v[208:211], v82, s[12:15], s55 offen offset:0 nt
    s_waitcnt vmcnt(23)
    buffer_load_dwordx4 v[216:219], v82, s[12:15], s55 offen offset:128 nt
    s_waitcnt vmcnt(23)
    buffer_load_dwordx4 v[224:227], v82, s[12:15], s55 offen offset:256 nt
    s_waitcnt vmcnt(23)
    buffer_load_dwordx4 v[232:235], v82, s[12:15], s55 offen offset:384 nt
    s_waitcnt vmcnt(23)
    buffer_load_dwordx4 v[240:243], v82, s[12:15], s55 offen offset:512 nt
    s_waitcnt vmcnt(23)
    buffer_load_dwordx4 v[248:251], v82, s[12:15], s55 offen offset:640 nt
    s_add_u32 s55, s55, s97
    s_barrier
    s_waitcnt vmcnt(23)
    buffer_load_dwordx4 v[212:215], v82, s[12:15], s55 offen offset:0 nt
    s_waitcnt vmcnt(23)
    buffer_load_dwordx4 v[220:223], v82, s[12:15], s55 offen offset:128 nt
    s_waitcnt vmcnt(23)
    buffer_load_dwordx4 v[228:231], v82, s[12:15], s55 offen offset:256 nt
    s_waitcnt vmcnt(23)
    buffer_load_dwordx4 v[236:239], v82, s[12:15], s55 offen offset:384 nt
    s_waitcnt vmcnt(23)
    buffer_load_dwordx4 v[244:247], v82, s[12:15], s55 offen offset:512 nt
    s_waitcnt vmcnt(23)
    buffer_load_dwordx4 v[252:255], v82, s[12:15], s55 offen offset:640 nt
    s_branch QFRAG
HOOKF:
    v_mov_b32 v40, 98784
    ds_read_b32 v40, v40
    s_mov_b32 s6, 0
    s_waitcnt lgkmcnt(0)
    v_readfirstlane_b32 s101, v40
    s_and_b32 s50, s101, 1
    s_and_b32 s0, s101, 2
    s_lshl_b32 s0, s0, 12
    s_and_b32 s101, s101, 0xffffffe0
    s_waitcnt vmcnt(48)
    s_branch QK
HOOKC:
    s_cmp_eq_u32 s44, 3
    s_cbranch_scc1 EXB
    v_min_u32 v83, 8, v1
    v_lshlrev_b32 v83, 7, v83
    s_mul_i32 s52, s45, 28160
    s_mul_i32 s54, s46, 1152
    s_add_u32 s52, s52, s54
    s_add_u32 s52, s52, 131072
    buffer_load_dword v83, v83, s[16:19], s52 offen sc1
    v_lshrrev_b32 v58, 3, v1
    v_and_b32 v57, 7, v1
    v_and_b32 v56, 2, v58
    v_xor_b32 v57, v57, v56
    s_and_b32 s52, s44, 1
    s_lshl_b32 s52, s52, 2
    v_xor_b32 v57, s52, v57
    v_mul_u32_u24 v56, 3072, v58
    v_lshl_add_u32 v56, v57, 4, v56
    v_lshrrev_b32 v58, 3, v1
    v_and_b32 v57, 7, v1
    v_and_b32 v55, 2, v58
    v_xor_b32 v57, v57, v55
    s_and_b32 s52, s44, 1
    s_lshl_b32 s52, s52, 2
    v_xor_b32 v57, s52, v57
    v_mul_u32_u24 v55, 1280, v58
    v_lshl_add_u32 v55, v57, 4, v55
    s_barrier
    s_cmp_ge_u32 s46, 20
    s_cbranch_scc1 HC8
    s_mul_i32 s52, s45, 983040
    s_mul_i32 s54, s56, 491520
    s_add_u32 s52, s52, s54
    s_lshl_b32 s54, s57, 7
    s_add_u32 s52, s52, s54
    s_mul_i32 s54, s44, 10240
    s_add_u32 s52, s52, s54
    s_lshl_b32 s53, s44, 10
DMA1:
    s_mov_b32 m0, s53
    s_add_u32 s53, s53, 3072
    buffer_load_dwordx4 v55, s[24:27], s52 offen nt lds
    v_xor_b32 v55, 64, v55
    s_add_u32 s52, s52, 30720
    s_cmp_lt_u32 s53, 49152
    s_cbranch_scc1 DMA1
HC8:
    s_cmp_ge_u32 s46, 30
    s_cbranch_scc1 HC7
    s_mul_i32 s52, s3, 393216
    s_mul_i32 s54, s45, 384
    s_add_u32 s52, s52, s54
    s_lshl_b32 s54, s59, 7
    s_add_u32 s52, s52, s54
    s_mul_i32 s54, s44, 24576
    s_add_u32 s52, s52, s54
    s_lshl_b32 s53, s44, 10
    s_add_u32 s53, s53, 49152
DMA2:
    s_mov_b32 m0, s53
    s_add_u32 s53, s53, 3072
    buffer_load_dwordx4 v56, s[28:31], s52 offen nt lds
    v_xor_b32 v56, 64, v56
    s_add_u32 s52, s52, 73728
    s_cmp_lt_u32 s53, 65536
    s_cbranch_scc1 DMA2
    s_cmp_lt_u32 s46, 20
    s_cbranch_scc1 HC9
HC7:
HC9:
    s_branch EXB
HOOKG:
    v_and_b32 v71, 3, v1
    v_lshlrev_b32 v71, 3, v71
    v_bfe_u32 v72, v1, 2, 2
    v_lshl_add_u32 v71, v72, 7, v71
    v_lshrrev_b32 v72, 4, v1
    v_lshl_add_u32 v71, v72, 10, v71
    v_bfe_u32 v72, v1, 3, 2
    v_lshl_add_u32 v71, v72, 5, v71
    s_mul_i32 s52, s44, 12288
    v_add_u32 v71, s52, v71
    v_xor_b32 v72, 32, v71
    v_xor_b32 v73, 64, v71
    v_xor_b32 v74, 96, v71
    v_lshrrev_b32 v14, 5, v1
    v_lshlrev_b32 v14, 11, v14
    v_and_b32 v15, 31, v1
    v_lshl_add_u32 v14, v15, 2, v14
    s_lshr_b32 s53, s57, 1
    s_lshl_b32 s52, s57, 12
    s_lshl_b32 s54, s53, 13
    s_add_u32 s52, s52, s54
    s_lshl_b32 s54, s45, 8
    s_add_u32 s52, s52, s54
    s_lshl_b32 s54, s56, 7
    s_add_u32 s52, s52, s54
    v_add_u32 v14, s52, v14
    s_xor_b32 s1, s0, 8192
    s_add_u32 s1, s1, s49
    s_add_u32 s99, s0, s49
    s_lshl_b32 s52, s44, 9
    s_add_u32 s52, s52, 104960
    v_lshl_add_u32 v15, v15, 4, s52
    v_and_b32 v64, 15, v1
    v_lshlrev_b32 v64, 4, v64
    v_lshl_add_u32 v64, v31, 2, v64
    v_add_u32 v64, 104960, v64
    s_cmp_lg_u32 s44, 3
    s_cbranch_scc1 QCNA
    v_lshlrev_b32 v38, 2, v1
    v_add_u32 v39, 107520, v38
    v_lshlrev_b32 v38, 1, v38
    ds_read_b32 v32, v39 offset:0
    ds_read_b32 v34, v39 offset:256
    ds_read_b32 v36, v39 offset:512
    s_mul_i32 s52, s47, 12288
    s_mul_i32 s54, s48, 1536
    s_add_u32 s52, s52, s54
    s_add_u32 s52, s52, 1441792
    s_waitcnt lgkmcnt(0)
    v_xor_b32 v33, s101, v32
    v_xor_b32 v35, s101, v34
    v_xor_b32 v37, s101, v36
    s_cmp_eq_u32 s50, 0
    s_cbranch_scc1 SLOW3
    buffer_store_dwordx2 v[32:33], v38, s[16:19], s52 offen offset:0
    buffer_store_dwordx2 v[34:35], v38, s[16:19], s52 offen offset:512
    buffer_store_dwordx2 v[36:37], v38, s[16:19], s52 offen offset:1024
PUBD3:
    s_branch QCMA
QCNA:
    s_waitcnt vmcnt(1)
QCMA:
    s_barrier
    s_branch WO0
HOOKG2:
    ds_read_b64_tr_b16 v[80:81], v71 offset:0
    ds_read_b64_tr_b16 v[82:83], v71 offset:512
    ds_read_b64_tr_b16 v[96:97], v71 offset:4096
    ds_read_b64_tr_b16 v[98:99], v71 offset:4608
    ds_read_b64_tr_b16 v[112:113], v71 offset:8192
    ds_read_b64_tr_b16 v[114:115], v71 offset:8704
    ds_read_b64_tr_b16 v[84:85], v72 offset:0
    ds_read_b64_tr_b16 v[86:87], v72 offset:512
    ds_read_b64_tr_b16 v[100:101], v72 offset:4096
    ds_read_b64_tr_b16 v[102:103], v72 offset:4608
    ds_read_b64_tr_b16 v[116:117], v72 offset:8192
    ds_read_b64_tr_b16 v[118:119], v72 offset:8704
    ds_read_b64_tr_b16 v[88:89], v73 offset:0
    ds_read_b64_tr_b16 v[90:91], v73 offset:512
    ds_read_b64_tr_b16 v[104:105], v73 offset:4096
    ds_read_b64_tr_b16 v[106:107], v73 offset:4608
    ds_read_b64_tr_b16 v[120:121], v73 offset:8192
    ds_read_b64_tr_b16 v[122:123], v73 offset:8704
    ds_read_b64_tr_b16 v[92:93], v74 offset:0
    ds_read_b64_tr_b16 v[94:95], v74 offset:512
    ds_read_b64_tr_b16 v[108:109], v74 offset:4096
    ds_read_b64_tr_b16 v[110:111], v74 offset:4608
    ds_read_b64_tr_b16 v[124:125], v74 offset:8192
    ds_read_b64_tr_b16 v[126:127], v74 offset:8704
    s_waitcnt lgkmcnt(0)
    s_branch WOP
HOOKG3:
    s_cmp_lg_u32 s49, 0
    s_cbranch_scc1 WOX
    s_cmp_lg_u32 s44, 3
    s_cbranch_scc1 QCNB
    v_lshlrev_b32 v38, 2, v1
    v_add_u32 v39, 107520, v38
    v_lshlrev_b32 v38, 1, v38
    ds_read_b32 v32, v39 offset:0
    ds_read_b32 v34, v39 offset:256
    ds_read_b32 v36, v39 offset:512
    s_mul_i32 s52, s47, 12288
    s_mul_i32 s54, s48, 1536
    s_add_u32 s52, s52, s54
    s_add_u32 s52, s52, 1441792
    s_waitcnt lgkmcnt(0)
    v_xor_b32 v33, s101, v32
    v_xor_b32 v35, s101, v34
    v_xor_b32 v37, s101, v36
    s_cmp_eq_u32 s50, 0
    s_cbranch_scc1 SLOW4
    buffer_store_dwordx2 v[32:33], v38, s[16:19], s52 offen offset:0
    buffer_store_dwordx2 v[34:35], v38, s[16:19], s52 offen offset:512
    buffer_store_dwordx2 v[36:37], v38, s[16:19], s52 offen offset:1024
PUBD4:
    s_branch QCMB
QCNB:
    s_waitcnt vmcnt(1)
QCMB:
    s_barrier
    s_cmp_lg_u32 s46, 31
    s_cbranch_scc1 EW1
    s_cmp_lg_u32 s44, 0
    s_cbranch_scc1 WOX
    v_and_b32 v32, 31, v1
    v_lshlrev_b32 v32, 2, v32
    v_add_u32 v32, 19968, v32
    s_mov_b32 s51, 0
    s_lshl_b32 s52, s45, 7
    s_add_u32 s52, s52, 118784
    v_lshlrev_b32 v34, 13, v1
EWP:
    buffer_load_dword v33, v32, s[16:19], s62 offen sc1
    s_waitcnt vmcnt(0)
    v_cmp_u_f32 vcc, v33, v33
    s_cbranch_vccz EWOK
    s_add_u32 s51, s51, 1
    s_cmp_lt_u32 s51, 0x8000
    s_cbranch_scc1 EWP
EWOK:
    s_mov_b64 exec, 3
    buffer_store_dword v34, v34, s[16:19], s52 offen sc1
    s_mov_b64 exec, -1
EW1:
    s_cmp_ge_u32 s46, 30
    s_cbranch_scc1 WOX
    s_cmp_eq_u32 s44, 3
    s_cbranch_scc1 HD0
    v_lshrrev_b32 v33, 3, v1
    v_and_b32 v32, 7, v1
    v_and_b32 v34, 2, v33
    v_xor_b32 v32, v32, v34
    s_and_b32 s52, s44, 1
    s_lshl_b32 s52, s52, 2
    v_xor_b32 v32, s52, v32
    v_mul_u32_u24 v34, 1280, v33
    v_lshl_add_u32 v34, v32, 4, v34
    s_mul_i32 s52, s45, 245760
    s_lshl_b32 s54, s57, 7
    s_add_u32 s52, s52, s54
    s_mul_i32 s54, s44, 10240
    s_add_u32 s52, s52, s54
    s_lshl_b32 s53, s44, 10
DMA3:
    s_mov_b32 m0, s53
    s_add_u32 s53, s53, 3072
    buffer_load_dwordx4 v34, s[24:27], s52 offen nt lds
    v_xor_b32 v34, 64, v34
    s_add_u32 s52, s52, 30720
    s_cmp_lt_u32 s53, 24576
    s_cbranch_scc1 DMA3
HD0:
    v_mov_b64 v[36:37], -1
    v_mov_b64 v[38:39], -1
    v_mov_b32 v43, 1879048192
    s_mul_i32 s52, s57, 5120
    s_mul_i32 s54, s44, 1280
    s_add_u32 s52, s52, s54
    v_lshl_add_u32 v40, v1, 4, s52
    s_add_u32 s52, s52, 1024
    v_lshl_add_u32 v41, v1, 2, s52
    v_cmp_gt_u32 vcc, 45312, v40
    s_lshl_b32 s52, s57, 14
    s_lshl_b32 s54, s45, 11
    s_add_u32 s52, s52, s54
    s_lshl_b32 s54, s44, 9
    s_add_u32 s52, s52, s54
    v_cndmask_b32 v40, v43, v40, vcc
    v_cmp_gt_u32 vcc, 45312, v41
    v_lshl_add_u32 v42, v1, 3, s52
    s_mov_b32 s52, 393216
    v_cndmask_b32 v41, v43, v41, vcc
    v_cmp_gt_u32 vcc, 136192, v42
    s_nop 1
    v_cndmask_b32 v42, v43, v42, vcc
    v_mov_b32 v120, v40
    v_mov_b32 v121, v41
    v_mov_b32 v122, v42
    v_mov_b64 v[116:117], -1
    v_mov_b64 v[118:119], -1
    s_branch F1E
HOOKD:
    ds_read_b128 v[20:23], v2 offset:256
    ds_read_b128 v[24:27], v2 offset:320
    ds_read_b128 v[28:31], v2 offset:384
    ds_read_b128 v[32:35], v2 offset:448
    s_waitcnt lgkmcnt(0)
    v_mfma_f32_16x16x32_bf16 v[40:43], v[20:23], v[64:67], 0
    v_mfma_f32_16x16x32_bf16 v[40:43], v[24:27], v[68:71], v[40:43]
    v_mfma_f32_16x16x32_bf16 v[40:43], v[28:31], v[72:75], v[40:43]
    v_mfma_f32_16x16x32_bf16 v[40:43], v[32:35], v[76:79], v[40:43]
    s_add_u32 s53, s62, 20480
    s_mov_b64 exec, 0xffff
    s_nop 5
    s_cmp_eq_u32 s50, 0
    s_cbranch_scc1 SLOW5
    buffer_store_dword v41, v14, s[16:19], s53 offen
PUBD5:
    s_mov_b64 exec, -1
    v_and_b32 v16, 7, v1
    v_lshlrev_b32 v16, 7, v16
    s_add_u32 s52, s0, 118784
    s_mov_b32 s51, 0
EWQ:
    buffer_load_dword v17, v16, s[16:19], s52 offen sc1
    s_waitcnt vmcnt(0)
    v_cmp_u_f32 vcc, v17, v17
    s_cbranch_vccz EWQK
    s_add_u32 s51, s51, 1
    s_sleep 1
    s_cmp_lt_u32 s51, 0x8000
    s_cbranch_scc1 EWQ
EWQK:
    s_sleep 1
    s_cmp_lt_u32 s46, 20
    s_cbranch_scc1 F1S
    s_mov_b32 s100, 3
    s_cmp_eq_u32 s50, 0
    s_cbranch_scc1 SLOW6
    buffer_store_dwordx4 v[116:119], v120, s[16:19], s63 offen
    buffer_store_dword v116, v121, s[16:19], s63 offen
PUBD6:
    s_mov_b32 s52, 393216
    buffer_store_dwordx2 v[116:117], v122, s[16:19], s52 offen sc1
    s_branch F1S
HOOKH:
    s_add_u32 s52, s62, 8192
    buffer_load_dwordx4 v[104:107], v52, s[16:19], s52 offen offset:0 sc1
    buffer_load_dwordx4 v[108:111], v52, s[16:19], s52 offen offset:3072 sc1
    buffer_load_dwordx2 v[112:113], v54, s[16:19], s52 offen sc1
    s_branch F1W
GCP:
    s_add_u32 s52, s62, 8192
    buffer_load_dwordx4 v[104:107], v52, s[16:19], s52 offen offset:0 sc1
    buffer_load_dwordx4 v[108:111], v52, s[16:19], s52 offen offset:3072 sc1
    buffer_load_dwordx2 v[112:113], v54, s[16:19], s52 offen sc1
    s_waitcnt vmcnt(0)
HOOKI:
    v_pk_add_f32 v[104:105], v[104:105], v[106:107]
    v_pk_add_f32 v[108:109], v[108:109], v[110:111]
    v_add_f32 v126, v104, v105
    v_add_f32 v127, v108, v109
    v_pk_add_f32 v[126:127], v[126:127], v[112:113]
    v_cmp_u_f32 vcc, v126, v127
    s_cbranch_vccz GCOK
    s_add_u32 s51, s51, 1
    s_cmp_lt_u32 s51, 0x8000
    s_cbranch_scc1 GCP
GCOK:
    ds_read_b64_tr_b16 v[80:81], v61 offset:0
    ds_read_b64_tr_b16 v[82:83], v61 offset:512
    ds_read_b64_tr_b16 v[84:85], v61 offset:4096
    ds_read_b64_tr_b16 v[86:87], v61 offset:4608
    ds_read_b64_tr_b16 v[88:89], v61 offset:8192
    ds_read_b64_tr_b16 v[90:91], v61 offset:8704
    ds_read_b64_tr_b16 v[92:93], v61 offset:12288
    ds_read_b64_tr_b16 v[94:95], v61 offset:12800
    ds_read_b64_tr_b16 v[96:97], v61 offset:16384
    ds_read_b64_tr_b16 v[98:99], v61 offset:16896
    ds_read_b64_tr_b16 v[100:101], v61 offset:20480
    ds_read_b64_tr_b16 v[102:103], v61 offset:20992
    s_branch W2P
SLOW0:
    buffer_store_dword v30, v28, s[16:19], s49 offen sc1
    s_branch PUBD0
SLOW1:
    buffer_store_dword v16, v14, s[16:19], s62 offen offset:0 sc1
    buffer_store_dword v20, v14, s[16:19], s62 offen offset:1024 sc1
    buffer_store_dword v24, v14, s[16:19], s62 offen offset:2048 sc1
    s_mov_b64 exec, 1
    buffer_store_dwordx2 v[28:29], v15, s[16:19], s62 offen sc1
    s_branch PUBD1
SLOW2:
    buffer_store_dword v24, v14, s[16:19], s62 offen sc1
    s_branch PUBD2
SLOW3:
    buffer_store_dwordx2 v[32:33], v38, s[16:19], s52 offen offset:0 sc1
    buffer_store_dwordx2 v[34:35], v38, s[16:19], s52 offen offset:512 sc1
    buffer_store_dwordx2 v[36:37], v38, s[16:19], s52 offen offset:1024 sc1
    s_branch PUBD3
SLOW4:
    buffer_store_dwordx2 v[32:33], v38, s[16:19], s52 offen offset:0 sc1
    buffer_store_dwordx2 v[34:35], v38, s[16:19], s52 offen offset:512 sc1
    buffer_store_dwordx2 v[36:37], v38, s[16:19], s52 offen offset:1024 sc1
    s_branch PUBD4
SLOW5:
    buffer_store_dword v41, v14, s[16:19], s53 offen sc1
    s_branch PUBD5
SLOW6:
    buffer_store_dwordx4 v[116:119], v120, s[16:19], s63 offen sc1
    buffer_store_dword v116, v121, s[16:19], s63 offen sc1
    s_branch PUBD6
SLOW7:
    buffer_store_dword v16, v56, s[16:19], s49 offen sc1
    s_branch PUBD7
SLOW8:
    buffer_store_dword v40, v14, s[16:19], s62 offen sc1
    s_mov_b64 exec, 1
    buffer_store_dwordx2 v[36:37], v15, s[16:19], s62 offen sc1
    s_branch PUBD8
CODEEND:
    s_endpgm
.section .rodata,"a"
.p2align 6
.amdhsa_kernel interleave_layers__sliding_block_cached__glu_gated_swiglu__decode_kernel
  .amdhsa_next_free_vgpr 512
  .amdhsa_next_free_sgpr 102
  .amdhsa_accum_offset 256
  .amdhsa_group_segment_fixed_size 0
  .amdhsa_kernarg_size 96
  .amdhsa_user_sgpr_count 2
  .amdhsa_user_sgpr_kernarg_segment_ptr 1
  .amdhsa_system_sgpr_workgroup_id_x 1
.end_amdhsa_kernel
```

```asm
; @launch grid=(256,1,1) block=(256,1,1) lds=143104
.amdgcn_target "amdgcn-amd-amdhsa--gfx950"
.text
.globl interleave_layers__sliding_block_cached__glu_gated_swiglu__decode_kernel
.p2align 8
.type interleave_layers__sliding_block_cached__glu_gated_swiglu__decode_kernel,@function
interleave_layers__sliding_block_cached__glu_gated_swiglu__decode_kernel:
    s_cmp_ge_u32 s2, 256
    s_cbranch_scc1 DONE
    s_load_dwordx16 s[64:79], s[0:1], 0
    s_load_dwordx8 s[80:87], s[0:1], 64
    s_memrealtime s[98:99]
    s_getpc_b64 s[60:61]
PCREF:
    v_lshlrev_b32 v14, 7, v0
    v_cmp_gt_u32 vcc, CODEEND-PCREF, v14
    v_mov_b32 v15, s61
    s_and_saveexec_b64 s[88:89], vcc
    s_cbranch_execz NOPF
    v_add_co_u32 v14, vcc, s60, v14
    s_nop 1
    v_addc_co_u32 v15, vcc, 0, v15, vcc
    global_load_dword v79, v[14:15], off
NOPF:
    s_mov_b64 exec, s[88:89]
    v_and_b32 v1, 63, v0
    v_lshrrev_b32 v13, 6, v0
    s_and_b32 s45, s2, 7
    v_readfirstlane_b32 s44, v13
    s_lshr_b32 s46, s2, 3
    s_lshr_b32 s7, s46, 3
    s_lshl_b32 s52, s45, 2
    s_add_u32 s47, s7, s52
    s_and_b32 s48, s46, 7
    v_lshrrev_b32 v19, 4, v1
    v_bfe_u32 v21, v1, 1, 3
    v_and_b32 v20, 1, v1
    v_mul_u32_u24 v80, 384, v21
    v_lshl_add_u32 v80, v20, 4, v80
    v_lshl_add_u32 v80, v19, 5, v80
    s_mul_i32 s52, s48, 3
    s_lshl_b32 s54, s44, 0
    s_add_u32 s52, s52, s54
    s_add_u32 s53, s48, 384
    s_cmp_eq_u32 s44, 3
    s_cselect_b32 s52, s53, s52
    s_cselect_b32 s97, 8, 24
    s_mulk_i32 s97, 3072
    s_mul_i32 s55, s47, 12582912
    s_mul_i32 s54, s52, 3072
    s_add_u32 s55, s55, s54
    s_add_u32 s55, s55, 11010048
    s_mov_b32 s96, s55
    s_waitcnt lgkmcnt(0)
    s_mov_b32 s8, s66
    s_and_b32 s9, s67, 0xffff
    s_mov_b32 s10, 402653184
    s_mov_b32 s11, 0x20000
    s_mov_b32 s6, 1
    s_mov_b32 s100, 0
    s_cmp_eq_u32 s44, 3
    s_cbranch_scc1 SETUP
    buffer_load_dwordx4 a[0:3], v80, s[8:11], s96 offen offset:0 nt
    buffer_load_dwordx4 a[8:11], v80, s[8:11], s96 offen offset:128 nt
    buffer_load_dwordx4 a[16:19], v80, s[8:11], s96 offen offset:256 nt
    s_add_u32 s96, s96, s97
    buffer_load_dwordx4 a[4:7], v80, s[8:11], s96 offen offset:0 nt
    buffer_load_dwordx4 a[12:15], v80, s[8:11], s96 offen offset:128 nt
    buffer_load_dwordx4 a[20:23], v80, s[8:11], s96 offen offset:256 nt
    s_add_u32 s96, s96, s97
SETUP:
    s_mov_b32 s16, s86
    s_and_b32 s17, s87, 0xffff
    s_mov_b32 s18, 1610612736
    s_mov_b32 s19, 0x20000
    s_mov_b32 s12, s68
    s_and_b32 s13, s69, 0xffff
    s_mov_b32 s14, 402653184
    s_mov_b32 s15, 0x20000
    s_mov_b32 s20, s70
    s_and_b32 s21, s71, 0xffff
    s_mov_b32 s22, 7864320
    s_mov_b32 s23, 0x20000
    s_mov_b32 s32, s64
    s_and_b32 s33, s65, 0xffff
    s_mov_b32 s34, 1280
    s_mov_b32 s35, 0x20000
    s_mov_b32 s36, s82
    s_and_b32 s37, s83, 0xffff
    s_mov_b32 s38, 1280
    s_mov_b32 s39, 0x20000
    s_mov_b32 s40, s84
    s_and_b32 s41, s85, 0xffff
    s_mov_b32 s42, 256
    s_mov_b32 s43, 0x20000
    v_mov_b32 v87, 1879048192
    v_mov_b32 v88, 1879048192
    v_mov_b32 v120, 1879048192
    v_mov_b32 v121, 1879048192
    v_mov_b32 v122, 1879048192
    s_cmp_lg_u32 s44, 3
    s_cbranch_scc1 SETUP2
    v_mov_b32 v32, -1
    v_mov_b32 v33, -1
    v_mov_b32 v34, -1
    v_mov_b32 v35, -1
    s_cmp_lg_u32 s2, 0
    s_cbranch_scc1 NONW
    s_or_b32 s101, s98, 0x20
    s_and_b32 s101, s101, 0xffffffe0
    v_mov_b32 v24, s101
    v_mov_b32 v25, 0
    s_mov_b64 exec, 1
    buffer_store_dword v24, v25, s[40:43], 0 offen sc1
    s_mov_b64 exec, -1
NONW:
    v_lshlrev_b32 v24, 4, v1
    v_lshlrev_b32 v27, 2, v1
    s_mul_i32 s52, s2, 1536
    v_lshlrev_b32 v28, 3, v1
    buffer_store_dwordx4 v[32:35], v24, s[16:19], s52 offen sc1
    buffer_store_dwordx2 v[32:33], v28, s[16:19], s52 offen offset:1024 sc1
    v_mov_b32 v26, 1879048192
    v_mov_b32 v88, v24
    v_cmp_gt_u32 vcc, 40, v1
    v_lshlrev_b32 v27, 2, v1
    buffer_load_dwordx4 v[44:47], v24, s[32:35], 0 offen
    buffer_load_dword v48, v27, s[32:35], 0 offen offset:1024
    v_cndmask_b32 v28, v26, v27, vcc
    s_mul_i32 s52, s48, 160
    buffer_load_dword v86, v28, s[32:35], s52 offen
    s_mul_i32 s52, s48, 320
    s_add_u32 s52, s52, 131072
    s_and_b32 s53, s2, 0xc7
    s_cmp_eq_u32 s53, 0
    s_cselect_b32 s52, s52, 1879048192
    v_lshl_add_u32 v87, v1, 3, s52
    v_cndmask_b32 v87, v26, v87, vcc
    v_add_u32 v24, 0, v1
    v_mul_u32_u24 v36, 171, v24
    v_lshrrev_b32 v36, 12, v36
    v_mul_u32_u24 v37, 24, v36
    v_sub_u32 v37, v24, v37
    v_and_b32 v24, 2, v36
    v_xor_b32 v37, v37, v24
    v_mul_u32_u24 v36, 12288, v36
    v_lshl_add_u32 v38, v37, 4, v36
    v_add_u32 v24, 64, v1
    v_mul_u32_u24 v36, 171, v24
    v_lshrrev_b32 v36, 12, v36
    v_mul_u32_u24 v37, 24, v36
    v_sub_u32 v37, v24, v37
    v_and_b32 v24, 2, v36
    v_xor_b32 v37, v37, v24
    v_mul_u32_u24 v36, 12288, v36
    v_lshl_add_u32 v39, v37, 4, v36
    v_add_u32 v24, 128, v1
    v_mul_u32_u24 v36, 171, v24
    v_lshrrev_b32 v36, 12, v36
    v_mul_u32_u24 v37, 24, v36
    v_sub_u32 v37, v24, v37
    v_and_b32 v24, 2, v36
    v_xor_b32 v37, v37, v24
    v_mul_u32_u24 v36, 12288, v36
    v_lshl_add_u32 v40, v37, 4, v36
    s_mul_i32 s52, s48, 983040
    s_mul_i32 s54, s47, 384
    s_add_u32 s52, s52, s54
    s_mov_b32 s53, 65536
WQL:
    s_add_u32 m0, s53, 0
    s_nop 0
    buffer_load_dwordx4 v38, s[20:23], s52 offen nt lds
    v_xor_b32 v38, 64, v38
    s_add_u32 m0, s53, 1024
    s_nop 0
    buffer_load_dwordx4 v39, s[20:23], s52 offen nt lds
    v_xor_b32 v39, 64, v39
    s_add_u32 m0, s53, 2048
    s_nop 0
    buffer_load_dwordx4 v40, s[20:23], s52 offen nt lds
    v_xor_b32 v40, 64, v40
    s_add_u32 s52, s52, 98304
    s_add_u32 s53, s53, 3072
    s_cmp_lt_u32 s53, 96256
    s_cbranch_scc1 WQL
    v_mov_b32 v37, 0
    buffer_load_dword v89, v37, s[40:43], 0 offen sc1
    s_barrier
    s_waitcnt vmcnt(31)
    v_mov_b32 v36, 0x3f803f80
    v_mov_b32 v37, v36
    v_cndmask_b32 v36, 0, v36, vcc
    v_add_u32 v27, 96256, v27
    ds_write_b32 v27, v36 offset:1152
    ds_write_b32 v27, v37 offset:1408
    ds_write_b32 v27, v86
    v_mov_b64 v[36:37], 0
    ds_write_b32 v27, v36 offset:12800
    ds_write_b32 v27, v36 offset:13056
    v_mov_b32 v38, 0x3f803f80
    v_dot2_f32_bf16 v36, v44, v44, v36
    v_dot2_f32_bf16 v37, v44, v38, v37
    v_dot2_f32_bf16 v36, v45, v45, v36
    v_dot2_f32_bf16 v37, v45, v38, v37
    v_dot2_f32_bf16 v36, v46, v46, v36
    v_dot2_f32_bf16 v37, v46, v38, v37
    v_dot2_f32_bf16 v36, v47, v47, v36
    v_dot2_f32_bf16 v37, v47, v38, v37
    v_dot2_f32_bf16 v36, v48, v48, v36
    v_dot2_f32_bf16 v37, v48, v38, v37
    s_nop 2
    v_add_f32_dpp v36, v36, v36 quad_perm:[1,0,3,2] row_mask:0xf bank_mask:0xf
    v_add_f32_dpp v37, v37, v37 quad_perm:[1,0,3,2] row_mask:0xf bank_mask:0xf
    s_nop 0
    v_add_f32_dpp v36, v36, v36 quad_perm:[2,3,0,1] row_mask:0xf bank_mask:0xf
    v_add_f32_dpp v37, v37, v37 quad_perm:[2,3,0,1] row_mask:0xf bank_mask:0xf
    s_nop 0
    v_add_f32_dpp v36, v36, v36 row_half_mirror row_mask:0xf bank_mask:0xf
    v_add_f32_dpp v37, v37, v37 row_half_mirror row_mask:0xf bank_mask:0xf
    s_nop 0
    v_add_f32_dpp v36, v36, v36 row_mirror row_mask:0xf bank_mask:0xf
    v_add_f32_dpp v37, v37, v37 row_mirror row_mask:0xf bank_mask:0xf
    s_nop 0
    v_mov_b32 v39, v36
    s_nop 1
    v_permlane16_swap_b32 v36, v39
    v_add_f32 v36, v36, v39
    v_mov_b32 v39, v37
    s_nop 1
    v_permlane16_swap_b32 v37, v39
    v_add_f32 v37, v37, v39
    v_mov_b32 v39, v36
    s_nop 1
    v_permlane32_swap_b32 v36, v39
    v_add_f32 v36, v36, v39
    v_mov_b32 v39, v37
    s_nop 1
    v_permlane32_swap_b32 v37, v39
    v_add_f32 v37, v37, v39
    v_mov_b32 v39, 0x3727c5ac
    v_mul_f32 v37, 0x3acccccd, v37
    v_fmamk_f32 v36, v36, 0x3acccccd, v39
    v_fma_f32 v36, -v37, v37, v36
    v_rsq_f32 v36, v36
    v_mov_b32 v84, v37
    v_mul_f32 v85, 0x3dd53b94, v36
SETUP2:
    s_cmp_ge_u32 s46, 10
    s_cselect_b32 s56, 1, 0
    s_cmp_ge_u32 s46, 20
    s_cselect_b32 s52, 2, s56
    s_mul_i32 s52, s52, 10
    s_sub_u32 s57, s46, s52
    s_min_u32 s4, s46, 29
    s_cmp_ge_u32 s4, 15
    s_cselect_b32 s58, 1, 0
    s_mul_i32 s52, s58, 15
    s_sub_u32 s52, s4, s52
    s_mul_i32 s59, s52, 52
    s_lshr_b32 s59, s59, 8
    s_mul_i32 s53, s59, 5
    s_sub_u32 s3, s52, s53
    s_cmp_ge_u32 s46, 20
    s_cselect_b32 s24, s80, s72
    s_cselect_b32 s25, s81, s73
    s_mov_b32 s26, 7864320
    s_cselect_b32 s26, 1966080, s26
    s_and_b32 s25, s25, 0xffff
    s_mov_b32 s27, 0x20000
    s_cmp_eq_u32 s58, 1
    s_cselect_b32 s28, s78, s76
    s_cselect_b32 s29, s79, s77
    s_and_b32 s29, s29, 0xffff
    s_mov_b32 s30, 1966080
    s_mov_b32 s31, 0x20000
    s_mov_b32 s49, 0
    s_mul_i32 s63, s45, 45312
    s_add_u32 s63, s63, 529408
    s_mul_i32 s62, s45, 28160
    s_add_u32 s62, s62, 136192
    s_mov_b32 s50, 0
    s_mov_b32 s0, 0
    v_and_b32 v24, 15, v1
    v_cmp_eq_u32 vcc, 1, v24
    v_mov_b32 v25, 96256
    v_mov_b32 v26, 97408
    v_cndmask_b32 v2, v25, v26, vcc
    v_lshl_add_u32 v2, v19, 4, v2
    v_and_b32 v24, 3, v1
    v_lshlrev_b32 v24, 4, v24
    v_and_b32 v25, 1, v19
    v_lshl_add_u32 v24, v25, 6, v24
    v_add_u32 v24, 98304, v24
    v_bfe_u32 v25, v1, 2, 2
    v_lshrrev_b32 v27, 5, v1
    v_sub_u32 v25, v25, v27
    v_mov_b32 v26, 109184
    v_cmp_eq_u32 vcc, 0, v25
    s_nop 1
    v_cndmask_b32 v3, v26, v24, vcc
    v_cmp_eq_u32 vcc, 2, v25
    s_nop 1
    v_cndmask_b32 v4, v26, v24, vcc
    v_and_b32 v24, 3, v1
    v_cmp_eq_u32 vcc, 3, v24
    v_mov_b32 v25, 0xffff
    v_mov_b32 v26, 0xffff0000
    v_cndmask_b32 v25, v25, v26, vcc
    v_cndmask_b32 v24, v24, 0, vcc
    v_or_b32 v24, 12, v24
    v_mul_u32_u24 v24, 0x1111, v24
    v_bfe_u32 v26, v1, 1, 1
    v_mul_u32_u24 v26, 0xaaaa, v26
    v_add_u32 v26, 0x4444, v26
    v_lshl_add_u32 v7, v24, 16, v26
    v_and_b32 v24, 4, v1
    v_cmp_eq_u32 vcc, 0, v24
    s_nop 1
    v_cndmask_b32 v5, 0, v25, vcc
    v_cndmask_b32 v6, v25, 0, vcc
    v_mul_u32_u24 v82, s97, v27
    v_bfe_u32 v24, v1, 3, 1
    v_mul_u32_u24 v24, 1536, v24
    v_add_u32 v82, v82, v24
    v_and_b32 v24, 1, v19
    v_mul_u32_u24 v24, 768, v24
    v_add_u32 v82, v82, v24
    v_and_b32 v24, 7, v1
    v_lshl_add_u32 v82, v24, 4, v82
    s_mul_i32 s52, s7, 6144
    s_add_u32 s52, s52, 20480
    v_lshl_add_u32 v8, v0, 4, s52
    s_lshl_b32 s52, s7, 6
    s_add_u32 s52, s52, 45056
    v_lshl_add_u32 v9, v24, 3, s52
    v_and_b32 v10, 0xe1, v0
    v_lshlrev_b32 v10, 1, v10
    v_bfe_u32 v24, v0, 4, 1
    v_lshl_add_u32 v10, v24, 3, v10
    v_bfe_u32 v24, v0, 3, 1
    v_lshl_add_u32 v10, v24, 4, v10
    v_bfe_u32 v24, v0, 2, 1
    v_lshl_add_u32 v10, v24, 2, v10
    v_bfe_u32 v24, v0, 1, 1
    v_lshl_add_u32 v10, v24, 5, v10
    v_add_u32 v10, 98304, v10
    v_mov_b32 v11, 0x3727c5ac
    v_lshlrev_b32 v12, 4, v0
    v_add_u32 v12, 110336, v12
    s_cmp_lg_u32 s44, 3
    s_cbranch_scc1 KBAR
    s_lshr_b32 s53, s2, 4
    s_and_b32 s51, s2, 15
    s_lshl_b32 s52, s53, 14
    s_lshl_b32 s54, s51, 9
    s_add_u32 s52, s52, s54
    s_add_u32 s52, s52, 1835008
    s_and_b32 s53, s46, 1
    s_lshl_b32 s53, s53, 13
    s_add_u32 s52, s52, s53
    s_xor_b32 s53, s52, 8192
    s_memtime s[88:89]
    s_waitcnt lgkmcnt(0)
    s_buffer_load_dword s1, s[16:19], s52
    s_waitcnt lgkmcnt(0)
    s_memtime s[90:91]
    s_waitcnt lgkmcnt(0)
    s_buffer_load_dword s1, s[16:19], s53
    s_waitcnt lgkmcnt(0)
    s_memtime s[92:93]
    s_waitcnt lgkmcnt(0)
    s_sub_u32 s88, s90, s88
    s_sub_u32 s90, s92, s90
    s_cmp_lt_u32 s90, s88
    s_cselect_b32 s1, 1, 0
    s_xor_b32 s1, s1, s46
    s_getreg_b32 s52, hwreg(HW_REG_XCC_ID)
    s_lshr_b32 s52, s52, 2
    s_xor_b32 s1, s1, s52
    s_and_b32 s1, s1, 1
    s_lshl_b32 s1, s1, 4
    s_mov_b32 s51, 0
    v_mov_b32 v37, 0
NOP:
    s_waitcnt vmcnt(0)
    v_readfirstlane_b32 s5, v89
    s_cmp_lg_u32 s5, 0
    s_cbranch_scc1 NOOK
    buffer_load_dword v89, v37, s[40:43], 0 offen sc1
    s_add_u32 s51, s51, 1
    s_sleep 4
    s_cmp_lt_u32 s51, 0x8000
    s_cbranch_scc1 NOP
NOOK:
    s_getreg_b32 s52, hwreg(HW_REG_XCC_ID)
    s_and_b32 s52, s52, 15
    s_or_b32 s5, s5, s52
    s_or_b32 s1, s1, s5
    v_mov_b32 v36, s1
    s_lshl_b32 s52, s45, 7
    s_lshl_b32 s54, s46, 2
    s_add_u32 s52, s52, s54
    s_add_u32 s52, s52, 1376256
    s_mov_b64 exec, 1
    buffer_store_dword v36, v37, s[16:19], s52 offen sc1
    s_mov_b64 exec, -1
    s_mov_b32 s44, 0
    s_branch Q0L
KBAR:
    s_barrier
    s_waitcnt vmcnt(7)
    buffer_load_dwordx4 a[24:27], v80, s[8:11], s96 offen offset:0 nt
    s_waitcnt vmcnt(7)
    buffer_load_dwordx4 a[32:35], v80, s[8:11], s96 offen offset:128 nt
    s_waitcnt vmcnt(7)
    buffer_load_dwordx4 a[40:43], v80, s[8:11], s96 offen offset:256 nt
    s_add_u32 s96, s96, s97
    s_waitcnt vmcnt(7)
    buffer_load_dwordx4 a[28:31], v80, s[8:11], s96 offen offset:0 nt
    s_waitcnt vmcnt(7)
    buffer_load_dwordx4 a[36:39], v80, s[8:11], s96 offen offset:128 nt
    s_waitcnt vmcnt(7)
    buffer_load_dwordx4 a[44:47], v80, s[8:11], s96 offen offset:256 nt
    s_add_u32 s96, s96, s97
    s_waitcnt vmcnt(7)
    buffer_load_dwordx4 a[48:51], v80, s[8:11], s96 offen offset:0 nt
    s_waitcnt vmcnt(7)
    buffer_load_dwordx4 a[56:59], v80, s[8:11], s96 offen offset:128 nt
    s_waitcnt vmcnt(7)
    buffer_load_dwordx4 a[64:67], v80, s[8:11], s96 offen offset:256 nt
    s_add_u32 s96, s96, s97
    s_waitcnt vmcnt(7)
    buffer_load_dwordx4 a[52:55], v80, s[8:11], s96 offen offset:0 nt
    s_waitcnt vmcnt(7)
    buffer_load_dwordx4 a[60:63], v80, s[8:11], s96 offen offset:128 nt
    s_waitcnt vmcnt(7)
    buffer_load_dwordx4 a[68:71], v80, s[8:11], s96 offen offset:256 nt
    s_add_u32 s96, s96, s97
    s_waitcnt vmcnt(7)
    buffer_load_dwordx4 a[72:75], v80, s[8:11], s96 offen offset:0 nt
    s_waitcnt vmcnt(7)
    buffer_load_dwordx4 a[80:83], v80, s[8:11], s96 offen offset:128 nt
    s_waitcnt vmcnt(7)
    buffer_load_dwordx4 a[88:91], v80, s[8:11], s96 offen offset:256 nt
    s_add_u32 s96, s96, s97
    s_waitcnt vmcnt(7)
    buffer_load_dwordx4 a[76:79], v80, s[8:11], s96 offen offset:0 nt
    s_waitcnt vmcnt(7)
    buffer_load_dwordx4 a[84:87], v80, s[8:11], s96 offen offset:128 nt
    s_waitcnt vmcnt(7)
    buffer_load_dwordx4 a[92:95], v80, s[8:11], s96 offen offset:256 nt
    s_add_u32 s96, s96, s97
    s_waitcnt vmcnt(7)
    buffer_load_dwordx4 a[96:99], v80, s[8:11], s96 offen offset:0 nt
    s_waitcnt vmcnt(7)
    buffer_load_dwordx4 a[104:107], v80, s[8:11], s96 offen offset:128 nt
    s_waitcnt vmcnt(7)
    buffer_load_dwordx4 a[112:115], v80, s[8:11], s96 offen offset:256 nt
    s_add_u32 s96, s96, s97
    s_waitcnt vmcnt(7)
    buffer_load_dwordx4 a[100:103], v80, s[8:11], s96 offen offset:0 nt
    s_waitcnt vmcnt(7)
    buffer_load_dwordx4 a[108:111], v80, s[8:11], s96 offen offset:128 nt
    s_waitcnt vmcnt(7)
    buffer_load_dwordx4 a[116:119], v80, s[8:11], s96 offen offset:256 nt
    s_add_u32 s96, s96, s97
    s_waitcnt vmcnt(7)
    buffer_load_dwordx4 a[120:123], v80, s[8:11], s96 offen offset:0 nt
    s_waitcnt vmcnt(7)
    buffer_load_dwordx4 a[128:131], v80, s[8:11], s96 offen offset:128 nt
    s_waitcnt vmcnt(7)
    buffer_load_dwordx4 a[136:139], v80, s[8:11], s96 offen offset:256 nt
    s_add_u32 s96, s96, s97
    s_waitcnt vmcnt(7)
    buffer_load_dwordx4 a[124:127], v80, s[8:11], s96 offen offset:0 nt
    s_waitcnt vmcnt(7)
    buffer_load_dwordx4 a[132:135], v80, s[8:11], s96 offen offset:128 nt
    s_waitcnt vmcnt(7)
    buffer_load_dwordx4 a[140:143], v80, s[8:11], s96 offen offset:256 nt
    s_add_u32 s96, s96, s97
    s_waitcnt vmcnt(7)
    buffer_load_dwordx4 a[144:147], v80, s[8:11], s96 offen offset:0 nt
    s_waitcnt vmcnt(7)
    buffer_load_dwordx4 a[152:155], v80, s[8:11], s96 offen offset:128 nt
    s_waitcnt vmcnt(7)
    buffer_load_dwordx4 a[160:163], v80, s[8:11], s96 offen offset:256 nt
    s_add_u32 s96, s96, s97
    s_waitcnt vmcnt(7)
    buffer_load_dwordx4 a[148:151], v80, s[8:11], s96 offen offset:0 nt
    s_waitcnt vmcnt(7)
    buffer_load_dwordx4 a[156:159], v80, s[8:11], s96 offen offset:128 nt
    s_waitcnt vmcnt(7)
    buffer_load_dwordx4 a[164:167], v80, s[8:11], s96 offen offset:256 nt
    s_add_u32 s96, s96, s97
    s_waitcnt vmcnt(7)
    buffer_load_dwordx4 a[168:171], v80, s[8:11], s96 offen offset:0 nt
    s_waitcnt vmcnt(7)
    buffer_load_dwordx4 a[176:179], v80, s[8:11], s96 offen offset:128 nt
    s_waitcnt vmcnt(7)
    buffer_load_dwordx4 a[184:187], v80, s[8:11], s96 offen offset:256 nt
    s_add_u32 s96, s96, s97
    s_waitcnt vmcnt(7)
    buffer_load_dwordx4 a[172:175], v80, s[8:11], s96 offen offset:0 nt
    s_waitcnt vmcnt(7)
    buffer_load_dwordx4 a[180:183], v80, s[8:11], s96 offen offset:128 nt
    s_waitcnt vmcnt(7)
    buffer_load_dwordx4 a[188:191], v80, s[8:11], s96 offen offset:256 nt
    s_lshl_b32 s97, s97, 1
    s_waitcnt vmcnt(7)
    buffer_load_dwordx4 a[192:195], v82, s[12:15], s55 offen offset:0 nt
    s_waitcnt vmcnt(7)
    buffer_load_dwordx4 a[200:203], v82, s[12:15], s55 offen offset:128 nt
    s_waitcnt vmcnt(7)
    buffer_load_dwordx4 a[208:211], v82, s[12:15], s55 offen offset:256 nt
    s_waitcnt vmcnt(7)
    buffer_load_dwordx4 a[216:219], v82, s[12:15], s55 offen offset:384 nt
    s_waitcnt vmcnt(7)
    buffer_load_dwordx4 a[224:227], v82, s[12:15], s55 offen offset:512 nt
    s_waitcnt vmcnt(7)
    buffer_load_dwordx4 a[232:235], v82, s[12:15], s55 offen offset:640 nt
    s_add_u32 s55, s55, s97
    s_waitcnt vmcnt(7)
    buffer_load_dwordx4 a[196:199], v82, s[12:15], s55 offen offset:0 nt
    s_waitcnt vmcnt(7)
    buffer_load_dwordx4 a[204:207], v82, s[12:15], s55 offen offset:128 nt
    s_waitcnt vmcnt(7)
    buffer_load_dwordx4 a[212:215], v82, s[12:15], s55 offen offset:256 nt
    s_waitcnt vmcnt(7)
    buffer_load_dwordx4 a[220:223], v82, s[12:15], s55 offen offset:384 nt
    s_waitcnt vmcnt(7)
    buffer_load_dwordx4 a[228:231], v82, s[12:15], s55 offen offset:512 nt
    s_waitcnt vmcnt(7)
    buffer_load_dwordx4 a[236:239], v82, s[12:15], s55 offen offset:640 nt
    s_add_u32 s55, s55, s97
    s_waitcnt vmcnt(7)
    buffer_load_dwordx4 a[240:243], v82, s[12:15], s55 offen offset:0 nt
    s_waitcnt vmcnt(7)
    buffer_load_dwordx4 a[248:251], v82, s[12:15], s55 offen offset:128 nt
    s_waitcnt vmcnt(7)
    buffer_load_dwordx4 v[128:131], v82, s[12:15], s55 offen offset:256 nt
    s_waitcnt vmcnt(7)
    buffer_load_dwordx4 v[136:139], v82, s[12:15], s55 offen offset:384 nt
    s_waitcnt vmcnt(7)
    buffer_load_dwordx4 v[144:147], v82, s[12:15], s55 offen offset:512 nt
    s_waitcnt vmcnt(7)
    buffer_load_dwordx4 v[152:155], v82, s[12:15], s55 offen offset:640 nt
    s_add_u32 s55, s55, s97
    s_waitcnt vmcnt(7)
    buffer_load_dwordx4 a[244:247], v82, s[12:15], s55 offen offset:0 nt
    s_waitcnt vmcnt(7)
    buffer_load_dwordx4 a[252:255], v82, s[12:15], s55 offen offset:128 nt
    s_waitcnt vmcnt(7)
    buffer_load_dwordx4 v[132:135], v82, s[12:15], s55 offen offset:256 nt
    s_waitcnt vmcnt(7)
    buffer_load_dwordx4 v[140:143], v82, s[12:15], s55 offen offset:384 nt
    s_waitcnt vmcnt(7)
    buffer_load_dwordx4 v[148:151], v82, s[12:15], s55 offen offset:512 nt
    s_waitcnt vmcnt(7)
    buffer_load_dwordx4 v[156:159], v82, s[12:15], s55 offen offset:640 nt
    s_add_u32 s55, s55, s97
    s_waitcnt vmcnt(7)
    buffer_load_dwordx4 v[160:163], v82, s[12:15], s55 offen offset:0 nt
    s_waitcnt vmcnt(7)
    buffer_load_dwordx4 v[168:171], v82, s[12:15], s55 offen offset:128 nt
    s_waitcnt vmcnt(7)
    buffer_load_dwordx4 v[176:179], v82, s[12:15], s55 offen offset:256 nt
    s_waitcnt vmcnt(7)
    buffer_load_dwordx4 v[184:187], v82, s[12:15], s55 offen offset:384 nt
    s_waitcnt vmcnt(7)
    buffer_load_dwordx4 v[192:195], v82, s[12:15], s55 offen offset:512 nt
    s_waitcnt vmcnt(7)
    buffer_load_dwordx4 v[200:203], v82, s[12:15], s55 offen offset:640 nt
    s_add_u32 s55, s55, s97
    s_waitcnt vmcnt(7)
    buffer_load_dwordx4 v[164:167], v82, s[12:15], s55 offen offset:0 nt
    s_waitcnt vmcnt(7)
    buffer_load_dwordx4 v[172:175], v82, s[12:15], s55 offen offset:128 nt
    s_waitcnt vmcnt(7)
    buffer_load_dwordx4 v[180:183], v82, s[12:15], s55 offen offset:256 nt
    s_waitcnt vmcnt(7)
    buffer_load_dwordx4 v[188:191], v82, s[12:15], s55 offen offset:384 nt
    s_waitcnt vmcnt(7)
    buffer_load_dwordx4 v[196:199], v82, s[12:15], s55 offen offset:512 nt
    s_waitcnt vmcnt(7)
    buffer_load_dwordx4 v[204:207], v82, s[12:15], s55 offen offset:640 nt
    s_add_u32 s55, s55, s97
    s_waitcnt vmcnt(7)
    buffer_load_dwordx4 v[208:211], v82, s[12:15], s55 offen offset:0 nt
    s_waitcnt vmcnt(7)
    buffer_load_dwordx4 v[216:219], v82, s[12:15], s55 offen offset:128 nt
    s_waitcnt vmcnt(7)
    buffer_load_dwordx4 v[224:227], v82, s[12:15], s55 offen offset:256 nt
    s_waitcnt vmcnt(7)
    buffer_load_dwordx4 v[232:235], v82, s[12:15], s55 offen offset:384 nt
    s_waitcnt vmcnt(7)
    buffer_load_dwordx4 v[240:243], v82, s[12:15], s55 offen offset:512 nt
    s_waitcnt vmcnt(7)
    buffer_load_dwordx4 v[248:251], v82, s[12:15], s55 offen offset:640 nt
    s_add_u32 s55, s55, s97
    s_waitcnt vmcnt(7)
    buffer_load_dwordx4 v[212:215], v82, s[12:15], s55 offen offset:0 nt
    s_waitcnt vmcnt(7)
    buffer_load_dwordx4 v[220:223], v82, s[12:15], s55 offen offset:128 nt
    s_waitcnt vmcnt(7)
    buffer_load_dwordx4 v[228:231], v82, s[12:15], s55 offen offset:256 nt
    s_barrier
    s_waitcnt vmcnt(7)
    buffer_load_dwordx4 v[236:239], v82, s[12:15], s55 offen offset:384 nt
    s_waitcnt vmcnt(7)
    buffer_load_dwordx4 v[244:247], v82, s[12:15], s55 offen offset:512 nt
    s_waitcnt vmcnt(7)
    buffer_load_dwordx4 v[252:255], v82, s[12:15], s55 offen offset:640 nt
    s_branch TABLES
LOOP:
    ds_read_b128 v[14:17], v12 offset:24576
    ds_read_b128 v[18:21], v12 offset:28672
    s_mov_b32 s55, s99
    s_mov_b32 s51, 0
    s_cmp_lg_u32 s49, 0
    s_cbranch_scc1 FINAL
    s_waitcnt lgkmcnt(0)
QTR:
    ds_read_b64_tr_b16 v[44:45], v19 offset:0
    ds_read_b64_tr_b16 v[46:47], v19 offset:1536
    ds_read_b64_tr_b16 v[56:57], v19 offset:128
    ds_read_b64_tr_b16 v[58:59], v19 offset:1664
    ds_read_b64_tr_b16 v[68:69], v19 offset:256
    ds_read_b64_tr_b16 v[70:71], v19 offset:1792
    ds_read_b64_tr_b16 v[48:49], v19 offset:12288
    ds_read_b64_tr_b16 v[50:51], v19 offset:13824
    ds_read_b64_tr_b16 v[60:61], v19 offset:12416
    ds_read_b64_tr_b16 v[62:63], v19 offset:13952
    ds_read_b64_tr_b16 v[72:73], v19 offset:12544
    ds_read_b64_tr_b16 v[74:75], v19 offset:14080
    ds_read_b64_tr_b16 v[52:53], v20 offset:24576
    ds_read_b64_tr_b16 v[54:55], v20 offset:26112
    ds_read_b64_tr_b16 v[64:65], v20 offset:24704
    ds_read_b64_tr_b16 v[66:67], v20 offset:26240
    ds_read_b64_tr_b16 v[76:77], v20 offset:24832
    ds_read_b64_tr_b16 v[78:79], v20 offset:26368
    s_cmp_lg_u32 s6, 0
    s_cbranch_scc1 QA0
    s_mov_b32 s96, s62
    s_mov_b32 s49, 393216
    s_mov_b32 s62, s63
    s_cmp_lg_u32 s50, 0
    s_cselect_b32 s32, s62, 1610612736
    s_cselect_b32 s33, 1610612736, s62
    s_cmp_lg_u32 s50, 0
    s_cselect_b32 s34, s49, 1610612736
    s_cselect_b32 s35, 1610612736, s49
    s_add_u32 s99, s49, s0
    s_xor_b32 s1, s99, 8192
    s_cmp_eq_u32 s44, 3
    s_cbranch_scc1 QX
    s_sub_u32 s52, s46, 20
    s_cmp_ge_u32 s52, 10
    s_cbranch_scc1 HOOKL
    v_lshlrev_b32 v30, 3, v0
    s_mul_i32 s52, s47, 12288
    s_add_u32 s52, s52, 1441792
    s_add_u32 s53, s52, 0
    buffer_load_dwordx2 v[32:33], v30, s[16:19], s53 offen offset:0 sc1
    buffer_load_dwordx2 v[34:35], v30, s[16:19], s53 offen offset:1536 sc1
    s_add_u32 s53, s52, 3072
    buffer_load_dwordx2 v[36:37], v30, s[16:19], s53 offen offset:0 sc1
    buffer_load_dwordx2 v[38:39], v30, s[16:19], s53 offen offset:1536 sc1
    s_add_u32 s53, s52, 6144
    buffer_load_dwordx2 v[40:41], v30, s[16:19], s53 offen offset:0 sc1
    buffer_load_dwordx2 v[42:43], v30, s[16:19], s53 offen offset:1536 sc1
    s_add_u32 s53, s52, 9216
    buffer_load_dwordx2 v[26:27], v30, s[16:19], s53 offen offset:0 sc1
    buffer_load_dwordx2 v[28:29], v30, s[16:19], s53 offen offset:1536 sc1
    s_sleep 5
GYB:
    buffer_load_dword v22, v16, s[16:19], s55 offen offset:0 sc1
    buffer_load_dword v23, v16, s[16:19], s55 offen offset:128 sc1
    buffer_load_dword v24, v16, s[16:19], s55 offen offset:256 sc1
    buffer_load_dword v25, v16, s[16:19], s55 offen offset:384 sc1
    s_waitcnt vmcnt(4)
QCP:
    v_bitop3_b32 v33, v32, v33, s101 bitop3:0x96
    v_bitop3_b32 v35, v34, v35, s101 bitop3:0x96
    v_bitop3_b32 v37, v36, v37, s101 bitop3:0x96
    v_bitop3_b32 v39, v38, v39, s101 bitop3:0x96
    v_bitop3_b32 v41, v40, v41, s101 bitop3:0x96
    v_bitop3_b32 v43, v42, v43, s101 bitop3:0x96
    v_bitop3_b32 v27, v26, v27, s101 bitop3:0x96
    v_bitop3_b32 v29, v28, v29, s101 bitop3:0x96
    v_add_f32 v13, v32, v34
    v_add_f32 v13, v13, v36
    v_add_f32 v13, v13, v38
    v_add_f32 v13, v13, v40
    v_add_f32 v13, v13, v42
    v_add_f32 v13, v13, v26
    v_add_f32 v13, v13, v28
    v_or3_b32 v33, v33, v35, v37
    v_or3_b32 v33, v33, v39, v41
    v_or3_b32 v33, v33, v43, v27
    v_or_b32 v33, v33, v29
    v_cmp_ne_u32 vcc, 0, v33
    s_cbranch_vccnz QCA
Y2W:
    s_waitcnt vmcnt(0)
    v_pk_add_f32 v[22:23], v[22:23], v[24:25]
    v_add_f32 v30, v22, v23
    v_mov_b32 v31, v30
    s_nop 1
    v_permlane32_swap_b32 v30, v31
    v_add_f32 v30, v30, v31
    v_cmp_u_f32 vcc, v30, v30
    v_cvt_pk_bf16_f32 v30, v30, v30
    ds_write_b16 v17, v30
    s_cbranch_vccnz AGY2P
OKY2P:
    v_and_b32 v30, 0xffff0000, v30
    buffer_store_dword v30, v18, s[16:19], s34 offen offset:0
    s_cmp_eq_u32 s50, 0
    s_cbranch_scc1 SLOW1
PUBD1:
QX:
    s_waitcnt lgkmcnt(0)
    s_barrier
QA0:
    ds_read_b128 v[32:35], v2 offset:0
    ds_read_b128 v[36:39], v2 offset:64
    ds_read_b128 v[40:43], v2 offset:128
    s_cmp_lg_u32 s6, 0
    s_waitcnt lgkmcnt(2)
    v_mfma_f32_16x16x32_bf16 v[28:31], v[32:35], v[32:35], 0
    v_mfma_f32_16x16x32_bf16 v[16:19], v[32:35], v[44:47], 0
    v_mfma_f32_16x16x32_bf16 v[20:23], v[32:35], v[56:59], 0
    v_mfma_f32_16x16x32_bf16 v[24:27], v[32:35], v[68:71], 0
    s_waitcnt lgkmcnt(1)
    v_mfma_f32_16x16x32_bf16 v[28:31], v[36:39], v[36:39], v[28:31]
    v_mfma_f32_16x16x32_bf16 v[16:19], v[36:39], v[48:51], v[16:19]
    v_mfma_f32_16x16x32_bf16 v[20:23], v[36:39], v[60:63], v[20:23]
    v_mfma_f32_16x16x32_bf16 v[24:27], v[36:39], v[72:75], v[24:27]
    s_waitcnt lgkmcnt(0)
    v_mfma_f32_16x16x32_bf16 v[16:19], v[40:43], v[52:55], v[16:19]
    v_mfma_f32_16x16x32_bf16 v[20:23], v[40:43], v[64:67], v[20:23]
    v_mfma_f32_16x16x32_bf16 v[24:27], v[40:43], v[76:79], v[24:27]
    v_mfma_f32_16x16x32_bf16 v[28:31], v[40:43], v[40:43], v[28:31]
    s_cbranch_scc1 HOOKA
    v_mov_b64 v[64:65], 0
    v_mov_b64 v[66:67], 0
    v_mov_b64 v[68:69], 0
    v_mov_b64 v[70:71], 0
    buffer_store_dword v16, v14, s[16:19], s32 offen offset:0
    buffer_store_dword v20, v14, s[16:19], s32 offen offset:1024
    buffer_store_dword v24, v14, s[16:19], s32 offen offset:2048
    buffer_store_dwordx2 v[28:29], v15, s[16:19], s32 offen offset:0
    s_cmp_eq_u32 s50, 0
    s_cbranch_scc1 SLOW2
PUBD2:
    ds_read_b64 v[14:15], v12 offset:0
    ds_read_b64 v[60:61], v12 offset:8
    s_cmp_eq_u32 s44, 3
    s_cbranch_scc1 EN3
    v_mov_b32 v36, v36
    v_mov_b32 v36, v36
    v_mov_b32 v36, v36
    v_mov_b32 v36, v36
    v_mov_b32 v36, v36
    v_mov_b32 v36, v36
    v_mov_b32 v36, v36
    v_mov_b32 v36, v36
    v_mov_b32 v36, v36
    v_mov_b32 v36, v36
    v_mov_b32 v36, v36
    v_mov_b32 v36, v36
    v_mov_b32 v36, v36
    v_mov_b32 v36, v36
    v_mov_b32 v36, v36
    v_mov_b32 v36, v36
    v_mov_b32 v36, v36
    v_mov_b32 v36, v36
    v_mov_b32 v36, v36
    v_mov_b32 v36, v36
    v_mov_b32 v36, v36
    v_mov_b32 v36, v36
    v_mov_b32 v36, v36
    v_mov_b32 v36, v36
    v_mov_b32 v36, v36
    v_mov_b32 v36, v36
    v_mov_b32 v36, v36
    v_mov_b32 v36, v36
    v_mov_b32 v36, v36
    v_mov_b32 v36, v36
    v_mov_b32 v36, v36
    v_mov_b32 v36, v36
    buffer_load_dwordx2 v[62:63], v9, s[16:19], s62 offen sc1
    buffer_load_dwordx4 v[52:55], v8, s[16:19], s62 offen offset:0 sc1
    buffer_load_dwordx4 v[56:59], v8, s[16:19], s62 offen offset:3072 sc1
    v_mov_b64 v[72:73], 0
    v_mov_b64 v[74:75], 0
    v_mov_b64 v[76:77], 0
    v_mov_b64 v[78:79], 0
    v_mov_b64 v[40:41], 0
    v_mov_b64 v[42:43], 0
    v_mov_b64 v[44:45], 0
    v_mov_b64 v[46:47], 0
    v_mov_b64 v[48:49], 0
    v_mov_b64 v[50:51], 0
    s_mov_b32 s51, 0
    v_mov_b32 v36, v36
    v_mov_b32 v36, v36
    v_mov_b32 v36, v36
    v_mov_b32 v36, v36
    v_mov_b32 v36, v36
    v_mov_b32 v36, v36
    v_mov_b32 v36, v36
    v_mov_b32 v36, v36
    v_mov_b32 v36, v36
    v_mov_b32 v36, v36
ENP:
    buffer_load_dwordx2 v[62:63], v9, s[16:19], s62 offen sc1
    buffer_load_dwordx4 v[52:55], v8, s[16:19], s62 offen offset:0 sc1
    buffer_load_dwordx4 v[56:59], v8, s[16:19], s62 offen offset:3072 sc1
    s_waitcnt vmcnt(3)
    v_add_f32_dpp v32, v62, v62 quad_perm:[1,0,3,2] row_mask:0xf bank_mask:0xf
    v_add_f32_dpp v33, v63, v63 quad_perm:[1,0,3,2] row_mask:0xf bank_mask:0xf
    v_pk_add_f32 v[16:17], v[52:53], v[54:55]
    v_add_f32_dpp v32, v32, v32 quad_perm:[2,3,0,1] row_mask:0xf bank_mask:0xf
    v_add_f32_dpp v33, v33, v33 quad_perm:[2,3,0,1] row_mask:0xf bank_mask:0xf
    v_pk_add_f32 v[20:21], v[56:57], v[58:59]
    v_add_f32_dpp v32, v32, v32 row_half_mirror row_mask:0xf bank_mask:0xf
    v_add_f32_dpp v33, v33, v33 row_half_mirror row_mask:0xf bank_mask:0xf
    v_pk_add_f32 v[16:17], v[16:17], v[20:21]
    v_mul_f32 v33, 0x3acccccd, v33
    v_fmamk_f32 v32, v32, 0x3acccccd, v11
    v_fma_f32 v32, -v33, v33, v32
    v_rsq_f32 v32, v32
    v_add_f32 v16, v16, v17
    v_mul_f32 v32, 0x3dd53b94, v32
    v_fma_f32 v16, -v33, v13, v16
    v_mul_f32 v16, v16, v32
    v_cvt_pk_bf16_f32 v17, v16, v16
    ds_write_b16 v10, v17
    v_cmp_u_f32 vcc, v16, v16
    s_cbranch_vccnz AGENP
OKENP:
ENOK2:
    s_waitcnt lgkmcnt(0)
    s_barrier
QFRAG:
    ds_read_b128 v[16:19], v3 offset:0
    ds_read_b128 v[20:23], v3 offset:128
    ds_read_b128 v[24:27], v3 offset:256
    ds_read_b128 v[28:31], v4 offset:0
    ds_read_b128 v[32:35], v4 offset:128
    ds_read_b128 v[36:39], v4 offset:256
    s_cmp_eq_u32 s49, 0
    s_cbranch_scc1 HOOKF
    s_waitcnt vmcnt(0)
QK:
    s_waitcnt lgkmcnt(5)
    v_smfmac_f32_16x16x64_bf16 v[64:67], v[16:19], a[0:7], v7
    s_waitcnt lgkmcnt(4)
    v_smfmac_f32_16x16x64_bf16 v[64:67], v[20:23], a[8:15], v7
    s_waitcnt lgkmcnt(3)
    v_smfmac_f32_16x16x64_bf16 v[64:67], v[24:27], a[16:23], v7
    s_waitcnt lgkmcnt(2)
    v_smfmac_f32_16x16x64_bf16 v[64:67], v[28:31], a[24:31], v7
    s_waitcnt lgkmcnt(1)
    v_smfmac_f32_16x16x64_bf16 v[64:67], v[32:35], a[32:39], v7
    s_waitcnt lgkmcnt(0)
    v_smfmac_f32_16x16x64_bf16 v[64:67], v[36:39], a[40:47], v7
    v_smfmac_f32_16x16x64_bf16 v[68:71], v[16:19], a[48:55], v7
    v_smfmac_f32_16x16x64_bf16 v[68:71], v[20:23], a[56:63], v7
    v_smfmac_f32_16x16x64_bf16 v[68:71], v[24:27], a[64:71], v7
    v_smfmac_f32_16x16x64_bf16 v[68:71], v[28:31], a[72:79], v7
    v_smfmac_f32_16x16x64_bf16 v[68:71], v[32:35], a[80:87], v7
    v_smfmac_f32_16x16x64_bf16 v[68:71], v[36:39], a[88:95], v7
    v_smfmac_f32_16x16x64_bf16 v[72:75], v[16:19], a[96:103], v7
    v_smfmac_f32_16x16x64_bf16 v[72:75], v[20:23], a[104:111], v7
    v_smfmac_f32_16x16x64_bf16 v[72:75], v[24:27], a[112:119], v7
    v_pk_add_f32 v[64:65], v[64:65], v[66:67]
    v_smfmac_f32_16x16x64_bf16 v[72:75], v[28:31], a[120:127], v7
    v_smfmac_f32_16x16x64_bf16 v[72:75], v[32:35], a[128:135], v7
    v_add_f32_dpp v52, v65, v64 quad_perm:[1,1,3,3] row_mask:0xf bank_mask:0xf
    v_smfmac_f32_16x16x64_bf16 v[72:75], v[36:39], a[136:143], v7
    v_smfmac_f32_16x16x64_bf16 v[76:79], v[16:19], a[144:151], v7
    v_smfmac_f32_16x16x64_bf16 v[76:79], v[20:23], a[152:159], v7
    v_smfmac_f32_16x16x64_bf16 v[76:79], v[24:27], a[160:167], v7
    v_pk_add_f32 v[68:69], v[68:69], v[70:71]
    v_smfmac_f32_16x16x64_bf16 v[76:79], v[28:31], a[168:175], v7
    v_smfmac_f32_16x16x64_bf16 v[76:79], v[32:35], a[176:183], v7
    v_add_f32_dpp v53, v69, v68 quad_perm:[1,1,3,3] row_mask:0xf bank_mask:0xf
    v_smfmac_f32_16x16x64_bf16 v[76:79], v[36:39], a[184:191], v7
    v_pk_add_f32 v[72:73], v[72:73], v[74:75]
    v_max_f32 v62, v52, v53
    s_nop 0
    v_add_f32_dpp v54, v73, v72 quad_perm:[1,1,3,3] row_mask:0xf bank_mask:0xf
    v_mov_b32 v63, v63
    v_mov_b32 v63, v63
    v_mov_b32 v63, v63
    v_mov_b32 v63, v63
    v_pk_add_f32 v[76:77], v[76:77], v[78:79]
    s_nop 1
    v_add_f32_dpp v55, v77, v76 quad_perm:[1,1,3,3] row_mask:0xf bank_mask:0xf
    v_max3_f32 v62, v62, v54, v55
    s_nop 1
    v_max_f32_dpp v62, v62, v62 quad_perm:[2,3,0,1] row_mask:0xf bank_mask:0xf
    s_nop 1
    v_max_f32_dpp v62, v62, v62 row_ror:4 row_mask:0xf bank_mask:0xf
    s_nop 1
    v_max_f32_dpp v62, v62, v62 row_ror:8 row_mask:0xf bank_mask:0xf
    v_mov_b32 v63, v62
    s_nop 1
    v_permlane16_swap_b32 v62, v63
    v_max_f32 v62, v62, v63
    v_mov_b32 v63, v62
    s_nop 1
    v_permlane32_swap_b32 v62, v63
    v_max_f32 v62, v62, v63
    v_pk_add_f32 v[52:53], v[52:53], v[62:63] op_sel_hi:[1,0] neg_lo:[0,1] neg_hi:[0,1]
    v_exp_f32 v52, v52
    v_pk_add_f32 v[54:55], v[54:55], v[62:63] op_sel_hi:[1,0] neg_lo:[0,1] neg_hi:[0,1]
    v_cvt_pk_bf16_f32 v56, v52, v52
    v_exp_f32 v53, v53
    v_exp_f32 v54, v54
    v_and_b32_dpp v16, v56, v5 quad_perm:[0,0,0,0] row_mask:0xf bank_mask:0xf
    v_and_b32_dpp v19, v56, v6 quad_perm:[0,0,0,0] row_mask:0xf bank_mask:0xf
    v_exp_f32 v55, v55
    v_mov_b32_dpp v17, v16 row_shr:4 row_mask:0xf bank_mask:0xf bound_ctrl:0
    v_mov_b32_dpp v18, v19 row_shl:4 row_mask:0xf bank_mask:0xf bound_ctrl:0
    v_cvt_pk_bf16_f32 v57, v53, v53
    s_waitcnt vmcnt(36)
    v_smfmac_f32_16x16x64_bf16 v[40:43], v[16:19], a[192:199], v7 abid:1
    ds_read_b128 v[64:67], v12 offset:4096
    v_and_b32_dpp v20, v56, v5 quad_perm:[2,2,2,2] row_mask:0xf bank_mask:0xf
    v_and_b32_dpp v23, v56, v6 quad_perm:[2,2,2,2] row_mask:0xf bank_mask:0xf
    v_smfmac_f32_16x16x64_bf16 v[44:47], v[16:19], a[200:207], v7 abid:1
    v_mov_b32_dpp v21, v20 row_shr:4 row_mask:0xf bank_mask:0xf bound_ctrl:0
    v_mov_b32_dpp v22, v23 row_shl:4 row_mask:0xf bank_mask:0xf bound_ctrl:0
    v_cvt_pk_bf16_f32 v58, v54, v54
    v_pk_add_f32 v[24:25], v[52:53], v[54:55]
    v_smfmac_f32_16x16x64_bf16 v[48:51], v[16:19], a[208:215], v7 abid:1
    v_smfmac_f32_16x16x64_bf16 v[40:43], v[20:23], a[216:223], v7 abid:1
    ds_read_b128 v[68:71], v12 offset:8192
    v_and_b32_dpp v16, v57, v5 quad_perm:[0,0,0,0] row_mask:0xf bank_mask:0xf
    v_and_b32_dpp v19, v57, v6 quad_perm:[0,0,0,0] row_mask:0xf bank_mask:0xf
    v_smfmac_f32_16x16x64_bf16 v[44:47], v[20:23], a[224:231], v7 abid:1
    v_mov_b32_dpp v17, v16 row_shr:4 row_mask:0xf bank_mask:0xf bound_ctrl:0
    v_mov_b32_dpp v18, v19 row_shl:4 row_mask:0xf bank_mask:0xf bound_ctrl:0
    v_cvt_pk_bf16_f32 v59, v55, v55
    v_add_f32 v63, v24, v25
    v_smfmac_f32_16x16x64_bf16 v[48:51], v[20:23], a[232:239], v7 abid:1
    s_waitcnt vmcnt(24)
    v_smfmac_f32_16x16x64_bf16 v[40:43], v[16:19], a[240:247], v7 abid:1
    v_and_b32_dpp v20, v57, v5 quad_perm:[2,2,2,2] row_mask:0xf bank_mask:0xf
    v_and_b32_dpp v23, v57, v6 quad_perm:[2,2,2,2] row_mask:0xf bank_mask:0xf
    v_smfmac_f32_16x16x64_bf16 v[44:47], v[16:19], a[248:255], v7 abid:1
    v_mov_b32_dpp v21, v20 row_shr:4 row_mask:0xf bank_mask:0xf bound_ctrl:0
    v_mov_b32_dpp v22, v23 row_shl:4 row_mask:0xf bank_mask:0xf bound_ctrl:0
    v_add_f32_dpp v63, v63, v63 quad_perm:[2,3,0,1] row_mask:0xf bank_mask:0xf
    v_smfmac_f32_16x16x64_bf16 v[48:51], v[16:19], v[128:135], v7 abid:1
    v_smfmac_f32_16x16x64_bf16 v[40:43], v[20:23], v[136:143], v7 abid:1
    v_add_f32_dpp v63, v63, v63 row_ror:4 row_mask:0xf bank_mask:0xf
    v_and_b32_dpp v16, v58, v5 quad_perm:[0,0,0,0] row_mask:0xf bank_mask:0xf
    v_and_b32_dpp v19, v58, v6 quad_perm:[0,0,0,0] row_mask:0xf bank_mask:0xf
    v_smfmac_f32_16x16x64_bf16 v[44:47], v[20:23], v[144:151], v7 abid:1
    v_mov_b32_dpp v17, v16 row_shr:4 row_mask:0xf bank_mask:0xf bound_ctrl:0
    v_mov_b32_dpp v18, v19 row_shl:4 row_mask:0xf bank_mask:0xf bound_ctrl:0
    v_add_f32_dpp v63, v63, v63 row_ror:8 row_mask:0xf bank_mask:0xf
    v_mov_b32 v24, v63
    v_smfmac_f32_16x16x64_bf16 v[48:51], v[20:23], v[152:159], v7 abid:1
    s_waitcnt vmcnt(12)
    v_smfmac_f32_16x16x64_bf16 v[40:43], v[16:19], v[160:167], v7 abid:1
    v_permlane16_swap_b32 v63, v24
    v_add_f32 v63, v63, v24
    v_and_b32_dpp v20, v58, v5 quad_perm:[2,2,2,2] row_mask:0xf bank_mask:0xf
    v_and_b32_dpp v23, v58, v6 quad_perm:[2,2,2,2] row_mask:0xf bank_mask:0xf
    v_smfmac_f32_16x16x64_bf16 v[44:47], v[16:19], v[168:175], v7 abid:1
    v_mov_b32_dpp v21, v20 row_shr:4 row_mask:0xf bank_mask:0xf bound_ctrl:0
    v_mov_b32_dpp v22, v23 row_shl:4 row_mask:0xf bank_mask:0xf bound_ctrl:0
    v_mov_b32 v24, v63
    v_smfmac_f32_16x16x64_bf16 v[48:51], v[16:19], v[176:183], v7 abid:1
    v_smfmac_f32_16x16x64_bf16 v[40:43], v[20:23], v[184:191], v7 abid:1
    v_permlane32_swap_b32 v63, v24
    v_add_f32 v63, v63, v24
    v_and_b32_dpp v16, v59, v5 quad_perm:[0,0,0,0] row_mask:0xf bank_mask:0xf
    v_and_b32_dpp v19, v59, v6 quad_perm:[0,0,0,0] row_mask:0xf bank_mask:0xf
    v_smfmac_f32_16x16x64_bf16 v[44:47], v[20:23], v[192:199], v7 abid:1
    v_mov_b32_dpp v17, v16 row_shr:4 row_mask:0xf bank_mask:0xf bound_ctrl:0
    v_mov_b32_dpp v18, v19 row_shl:4 row_mask:0xf bank_mask:0xf bound_ctrl:0
    s_waitcnt lgkmcnt(0)
    ds_write2_b32 v71, v62, v63 offset0:0 offset1:4
    v_smfmac_f32_16x16x64_bf16 v[48:51], v[20:23], v[200:207], v7 abid:1
    s_waitcnt vmcnt(0)
    v_smfmac_f32_16x16x64_bf16 v[40:43], v[16:19], v[208:215], v7 abid:1
    v_and_b32_dpp v20, v59, v5 quad_perm:[2,2,2,2] row_mask:0xf bank_mask:0xf
    v_and_b32_dpp v23, v59, v6 quad_perm:[2,2,2,2] row_mask:0xf bank_mask:0xf
    v_smfmac_f32_16x16x64_bf16 v[44:47], v[16:19], v[216:223], v7 abid:1
    v_mov_b32_dpp v21, v20 row_shr:4 row_mask:0xf bank_mask:0xf bound_ctrl:0
    v_mov_b32_dpp v22, v23 row_shl:4 row_mask:0xf bank_mask:0xf bound_ctrl:0
    s_mov_b32 vcc_lo, 0x00ff00ff
    v_smfmac_f32_16x16x64_bf16 v[48:51], v[16:19], v[224:231], v7 abid:1
    v_smfmac_f32_16x16x64_bf16 v[40:43], v[20:23], v[232:239], v7 abid:1
    v_smfmac_f32_16x16x64_bf16 v[44:47], v[20:23], v[240:247], v7 abid:1
    v_smfmac_f32_16x16x64_bf16 v[48:51], v[20:23], v[248:255], v7 abid:1
    s_mov_b32 vcc_hi, 0xff00ff00
    v_cmp_eq_u32 s[60:61], 24, v1
    v_mov_b32 v24, v24
    v_mov_b32 v24, v24
    v_mov_b32 v24, v24
    v_mov_b32 v24, v24
    v_mov_b32 v24, v24
    v_cndmask_b32_dpp v40, v44, v40, vcc row_ror:8 row_mask:0xf bank_mask:0xf
    v_cndmask_b32_dpp v41, v45, v41, vcc row_ror:8 row_mask:0xf bank_mask:0xf
    v_cndmask_b32_dpp v42, v46, v42, vcc row_ror:8 row_mask:0xf bank_mask:0xf
    v_cndmask_b32_dpp v43, v47, v43, vcc row_ror:8 row_mask:0xf bank_mask:0xf
    ds_write_b128 v15, v[40:43]
    v_cndmask_b32_dpp v48, v50, v48, vcc row_ror:8 row_mask:0xf bank_mask:0xf
    v_cndmask_b32_dpp v49, v51, v49, vcc row_ror:8 row_mask:0xf bank_mask:0xf
    ds_write_b64 v61, v[48:49]
    s_cmp_eq_u32 s49, 0
    s_cbranch_scc1 HOOKC
EXB:
    s_waitcnt lgkmcnt(0)
    s_barrier
    ds_read_b128 v[16:19], v70
    ds_read_b128 v[20:23], v70 offset:16
    ds_read_b64 v[24:25], v60 offset:0
    v_mov_b32 v44, v44
    ds_read_b64 v[26:27], v60 offset:768
    ds_read_b64 v[28:29], v60 offset:1536
    v_mov_b32 v44, v44
    ds_read_b64 v[30:31], v60 offset:2304
    ds_read_b64 v[32:33], v60 offset:3072
    v_mov_b32 v44, v44
    ds_read_b64 v[34:35], v60 offset:3840
    ds_read_b64 v[36:37], v60 offset:4608
    v_mov_b32 v44, v44
    ds_read_b64 v[38:39], v60 offset:5376
    s_mov_b32 s51, 0
    s_cmp_eq_u32 s49, 0
    s_cselect_b32 s52, 20, s46
    s_waitcnt lgkmcnt(9)
    v_max3_f32 v40, v16, v17, v18
    v_max_f32 v40, v40, v19
    v_pk_add_f32 v[16:17], v[16:17], v[40:41] op_sel_hi:[1,0] neg_lo:[0,1] neg_hi:[0,1]
    v_pk_add_f32 v[18:19], v[18:19], v[40:41] op_sel_hi:[1,0] neg_lo:[0,1] neg_hi:[0,1]
    v_exp_f32 v16, v16
    v_exp_f32 v17, v17
    v_exp_f32 v18, v18
    v_exp_f32 v19, v19
    s_waitcnt lgkmcnt(0)
    v_pk_mul_f32 v[20:21], v[20:21], v[16:17]
    v_pk_fma_f32 v[20:21], v[22:23], v[18:19], v[20:21]
    v_add_f32 v41, v20, v21
    v_rcp_f32 v42, v41
    v_log_f32 v43, v41
    v_pk_add_f32 v[24:25], v[24:25], v[26:27]
    v_pk_add_f32 v[28:29], v[28:29], v[30:31]
    v_pk_add_f32 v[32:33], v[32:33], v[34:35]
    v_pk_add_f32 v[36:37], v[36:37], v[38:39]
    v_pk_mul_f32 v[24:25], v[24:25], v[16:17] op_sel_hi:[1,0]
    v_pk_fma_f32 v[24:25], v[28:29], v[16:17], v[24:25] op_sel:[0,1,0] op_sel_hi:[1,1,1]
    v_pk_fma_f32 v[24:25], v[32:33], v[18:19], v[24:25] op_sel:[0,0,0] op_sel_hi:[1,0,1]
    v_pk_fma_f32 v[24:25], v[36:37], v[18:19], v[24:25] op_sel:[0,1,0] op_sel_hi:[1,1,1]
    v_pk_mul_f32 v[24:25], v[24:25], v[42:43] op_sel_hi:[1,0]
    v_add_f32 v43, v43, v40
    v_cvt_pk_bf16_f32 v24, v24, v25
    v_cndmask_b32 v24, v24, v43, s[60:61]
    buffer_store_dword v24, v14, s[16:19], s32 offen offset:0
    s_cmp_eq_u32 s50, 0
    s_cbranch_scc1 SLOW3
PUBD3:
    s_cmp_ge_u32 s52, 20
    s_cbranch_scc1 HOOKG
    v_mov_b32 v40, v40
    v_mov_b32 v40, v40
    v_mov_b32 v40, v40
    v_mov_b32 v40, v40
    v_mov_b32 v40, v40
    v_mov_b32 v40, v40
    v_mov_b32 v40, v40
    v_mov_b32 v40, v40
    v_mov_b32 v40, v40
    v_mov_b32 v40, v40
    v_mov_b32 v40, v40
    v_mov_b32 v40, v40
    v_mov_b32 v40, v40
    v_mov_b32 v40, v40
    v_mov_b32 v40, v40
    v_mov_b32 v40, v40
    buffer_load_dword v56, v65, s[16:19], s62 offen sc1
    buffer_load_dwordx4 v[44:47], v64, s[16:19], s62 offen offset:0 sc1
    buffer_load_dwordx4 v[48:51], v64, s[16:19], s62 offen offset:512 sc1
    buffer_load_dwordx4 v[52:55], v64, s[16:19], s62 offen offset:1024 sc1
    buffer_load_dword v57, v66, s[16:19], s49 offen sc1
    v_mov_b32 v40, v40
    v_mov_b32 v40, v40
    v_mov_b32 v40, v40
    v_mov_b32 v40, v40
    v_mov_b32 v40, v40
    v_mov_b32 v40, v40
    v_mov_b32 v40, v40
    v_mov_b32 v40, v40
    v_mov_b32 v40, v40
    v_mov_b32 v40, v40
    v_mov_b32 v40, v40
    v_mov_b32 v40, v40
    v_mov_b32 v40, v40
    v_mov_b32 v40, v40
    v_mov_b32 v40, v40
    v_mov_b32 v40, v40
    v_mov_b32 v40, v40
    v_mov_b32 v40, v40
    v_mov_b32 v40, v40
    v_mov_b32 v40, v40
WOP:
    buffer_load_dword v56, v65, s[16:19], s62 offen sc1
    buffer_load_dwordx4 v[44:47], v64, s[16:19], s62 offen offset:0 sc1
    buffer_load_dwordx4 v[48:51], v64, s[16:19], s62 offen offset:512 sc1
    buffer_load_dwordx4 v[52:55], v64, s[16:19], s62 offen offset:1024 sc1
    buffer_load_dword v57, v66, s[16:19], s49 offen sc1
    v_mov_b32 v40, v40
    v_mov_b32 v40, v40
    v_mov_b32 v40, v40
    v_mov_b32 v40, v40
    s_waitcnt vmcnt(5)
WOC:
    v_max3_u32 v63, v44, v48, v52
    v_mov_b32 v32, v56
    v_max_u32 v63, v63, v32
    v_cmp_eq_u32 vcc, -1, v63
    s_cbranch_vccnz AGWOP
    v_mfma_f32_16x16x32_bf16 v[16:19], v[44:47], v[80:83], 0
    v_max_f32_dpp v33, v32, v32 quad_perm:[1,0,3,2] row_mask:0xf bank_mask:0xf
    s_nop 0
    v_mfma_f32_16x16x32_bf16 v[16:19], v[48:51], v[96:99], v[16:19]
    v_max_f32_dpp v33, v33, v33 quad_perm:[2,3,0,1] row_mask:0xf bank_mask:0xf
    s_nop 0
    v_mfma_f32_16x16x32_bf16 v[16:19], v[52:55], v[112:115], v[16:19]
    v_max_f32_dpp v33, v33, v33 row_half_mirror row_mask:0xf bank_mask:0xf
    v_sub_f32 v34, v32, v33
    v_mfma_f32_16x16x32_bf16 v[20:23], v[44:47], v[84:87], 0
    v_exp_f32 v34, v34
    s_nop 0
    v_mfma_f32_16x16x32_bf16 v[20:23], v[48:51], v[100:103], v[20:23]
    v_add_f32_dpp v33, v34, v34 quad_perm:[1,0,3,2] row_mask:0xf bank_mask:0xf
    s_nop 0
    v_mfma_f32_16x16x32_bf16 v[20:23], v[52:55], v[116:119], v[20:23]
    v_add_f32_dpp v33, v33, v33 quad_perm:[2,3,0,1] row_mask:0xf bank_mask:0xf
    s_nop 0
    v_mfma_f32_16x16x32_bf16 v[24:27], v[44:47], v[88:91], 0
    v_add_f32_dpp v33, v33, v33 row_half_mirror row_mask:0xf bank_mask:0xf
    v_rcp_f32 v33, v33
    v_mfma_f32_16x16x32_bf16 v[24:27], v[48:51], v[104:107], v[24:27]
    v_mul_f32 v34, v34, v33
    s_nop 0
    v_mfma_f32_16x16x32_bf16 v[24:27], v[52:55], v[120:123], v[24:27]
    v_mul_f32_dpp v36, v34, v16 row_newbcast:0 row_mask:0xf bank_mask:0xf
    v_fmac_f32_dpp v36, v34, v17 row_newbcast:1 row_mask:0xf bank_mask:0xf
    v_mfma_f32_16x16x32_bf16 v[28:31], v[44:47], v[92:95], 0
    v_fmac_f32_dpp v36, v34, v18 row_newbcast:2 row_mask:0xf bank_mask:0xf
    v_fmac_f32_dpp v36, v34, v19 row_newbcast:3 row_mask:0xf bank_mask:0xf
    v_mfma_f32_16x16x32_bf16 v[28:31], v[48:51], v[108:111], v[28:31]
    v_mul_f32_dpp v37, v34, v20 row_newbcast:0 row_mask:0xf bank_mask:0xf
    v_fmac_f32_dpp v37, v34, v21 row_newbcast:1 row_mask:0xf bank_mask:0xf
    v_mfma_f32_16x16x32_bf16 v[28:31], v[52:55], v[124:127], v[28:31]
    v_fmac_f32_dpp v37, v34, v22 row_newbcast:2 row_mask:0xf bank_mask:0xf
    v_fmac_f32_dpp v37, v34, v23 row_newbcast:3 row_mask:0xf bank_mask:0xf
    v_cmp_u_f32 vcc, v36, v57
    v_mul_f32_dpp v38, v34, v24 row_newbcast:0 row_mask:0xf bank_mask:0xf
    v_fmac_f32_dpp v38, v34, v25 row_newbcast:1 row_mask:0xf bank_mask:0xf
    v_fmac_f32_dpp v38, v34, v26 row_newbcast:2 row_mask:0xf bank_mask:0xf
    v_fmac_f32_dpp v38, v34, v27 row_newbcast:3 row_mask:0xf bank_mask:0xf
    s_mov_b32 exec_hi, 0
    v_mul_f32_dpp v39, v34, v28 row_newbcast:0 row_mask:0xf bank_mask:0xf
    v_fmac_f32_dpp v39, v34, v29 row_newbcast:1 row_mask:0xf bank_mask:0xf
    v_fmac_f32_dpp v39, v34, v30 row_newbcast:2 row_mask:0xf bank_mask:0xf
    v_fmac_f32_dpp v39, v34, v31 row_newbcast:3 row_mask:0xf bank_mask:0xf
    ds_write_b128 v68, v[36:39]
    s_mov_b64 exec, -1
    s_cbranch_vccnz AGWOP
OKWOP:
    s_cmp_lg_u32 s44, 3
    s_waitcnt lgkmcnt(0)
    s_barrier
    s_cbranch_scc1 WOX
    ds_read2st64_b32 v[16:17], v69 offset0:0 offset1:1
    ds_read2st64_b32 v[18:19], v69 offset0:2 offset1:3
    ds_read2st64_b32 v[20:21], v69 offset0:4 offset1:5
    ds_read2st64_b32 v[22:23], v69 offset0:6 offset1:7
    s_waitcnt lgkmcnt(2)
    v_pk_add_f32 v[16:17], v[16:17], v[18:19]
    v_add_f32 v16, v16, v57
    s_waitcnt lgkmcnt(0)
    v_pk_add_f32 v[20:21], v[20:21], v[22:23]
    v_pk_add_f32 v[16:17], v[16:17], v[20:21]
    v_add_f32 v16, v16, v17
    buffer_store_dword v16, v67, s[16:19], s1 offen sc1
    buffer_store_dword v16, v67, s[16:19], s99 offen sc1
WOX:
    s_cmp_ge_u32 s46, 30
    s_cbranch_scc1 STX
    s_cmp_eq_u32 s44, 3
    s_cbranch_scc1 F1W3
    s_waitcnt vmcnt(0)
F1W3:
    s_waitcnt vmcnt(2)
F1E:
    ds_read_b128 v[56:59], v12 offset:16384
    ds_read_b128 v[52:55], v12 offset:12288
    ds_read_b128 v[60:63], v12 offset:20480
    s_mov_b32 s100, 0
    s_mov_b32 s51, 0
    s_waitcnt lgkmcnt(0)
    ds_read_b64_tr_b16 v[64:65], v57 offset:49152
    ds_read_b64_tr_b16 v[66:67], v57 offset:49664
    ds_read_b64_tr_b16 v[68:69], v57 offset:53248
    ds_read_b64_tr_b16 v[70:71], v57 offset:53760
    ds_read_b64_tr_b16 v[72:73], v57 offset:57344
    ds_read_b64_tr_b16 v[74:75], v57 offset:57856
    ds_read_b64_tr_b16 v[76:77], v57 offset:61440
    ds_read_b64_tr_b16 v[78:79], v57 offset:61952
    s_cmp_eq_u32 s49, 0
    s_cbranch_scc1 HOOKD
    s_cmp_lt_u32 s46, 20
    s_cbranch_scc1 GFB
    s_sleep 11
GFB:
    s_sleep 11
F1W:
    buffer_load_dword v44, v52, s[16:19], s99 offen offset:0 sc1
    buffer_load_dword v45, v52, s[16:19], s99 offen offset:128 sc1
    buffer_load_dword v46, v52, s[16:19], s99 offen offset:256 sc1
    buffer_load_dword v47, v52, s[16:19], s99 offen offset:384 sc1
    buffer_load_dword v48, v52, s[16:19], s99 offen offset:512 sc1
    buffer_load_dword v49, v52, s[16:19], s99 offen offset:640 sc1
    buffer_load_dword v50, v52, s[16:19], s99 offen offset:768 sc1
    buffer_load_dword v51, v52, s[16:19], s99 offen offset:896 sc1
    s_waitcnt vmcnt(0)
    v_pk_add_f32 v[16:17], v[44:45], v[46:47]
    v_pk_add_f32 v[18:19], v[48:49], v[50:51]
    v_pk_add_f32 v[16:17], v[16:17], v[18:19]
    v_add_f32 v16, v16, v17
    v_mov_b32 v17, v16
    s_nop 1
    v_permlane32_swap_b32 v16, v17
    v_add_f32 v16, v16, v17
    v_cmp_u_f32 vcc, v16, v16
    v_cvt_pk_bf16_f32 v16, v16, v16
    ds_write_b16 v53, v16
    s_cbranch_vccnz AGF1P
OKF1P:
    v_and_b32 v16, 0xffff0000, v16
    buffer_store_dword v16, v54, s[16:19], s34 offen offset:0
    s_cmp_eq_u32 s50, 0
    s_cbranch_scc1 SLOW8
PUBD8:
    s_waitcnt lgkmcnt(0)
    s_barrier
    ds_read_b128 v[20:23], v2 offset:256
    ds_read_b128 v[24:27], v2 offset:320
    ds_read_b128 v[28:31], v2 offset:384
    ds_read_b128 v[32:35], v2 offset:448
    s_waitcnt lgkmcnt(3)
    v_mfma_f32_16x16x32_bf16 v[40:43], v[20:23], v[64:67], 0
    v_mfma_f32_16x16x32_bf16 v[36:39], v[20:23], v[20:23], 0
    s_waitcnt lgkmcnt(2)
    v_mfma_f32_16x16x32_bf16 v[40:43], v[24:27], v[68:71], v[40:43]
    v_mfma_f32_16x16x32_bf16 v[36:39], v[24:27], v[24:27], v[36:39]
    s_waitcnt lgkmcnt(1)
    v_mfma_f32_16x16x32_bf16 v[40:43], v[28:31], v[72:75], v[40:43]
    v_mfma_f32_16x16x32_bf16 v[36:39], v[28:31], v[28:31], v[36:39]
    s_waitcnt lgkmcnt(0)
    v_mfma_f32_16x16x32_bf16 v[40:43], v[32:35], v[76:79], v[40:43]
    v_mfma_f32_16x16x32_bf16 v[36:39], v[32:35], v[32:35], v[36:39]
    s_mov_b32 s51, 0
    s_nop 5
    buffer_store_dword v40, v55, s[16:19], s32 offen offset:0
    buffer_store_dwordx2 v[36:37], v56, s[16:19], s32 offen offset:0
    s_cmp_eq_u32 s50, 0
    s_cbranch_scc1 SLOW9
PUBD9:
    s_cmp_lt_u32 s46, 20
    s_cbranch_scc1 STX
    v_mov_b32 v44, v44
    v_mov_b32 v44, v44
    v_mov_b32 v44, v44
    v_mov_b32 v44, v44
    v_mov_b32 v44, v44
    v_mov_b32 v44, v44
    v_mov_b32 v44, v44
    v_mov_b32 v44, v44
    v_mov_b32 v44, v44
    v_mov_b32 v44, v44
    v_mov_b32 v44, v44
    v_mov_b32 v44, v44
    v_mov_b32 v44, v44
    v_mov_b32 v44, v44
    v_mov_b32 v44, v44
    v_mov_b32 v44, v44
    v_mov_b32 v44, v44
    v_mov_b32 v44, v44
    v_mov_b32 v44, v44
    v_mov_b32 v44, v44
    v_mov_b32 v44, v44
    v_mov_b32 v44, v44
    v_mov_b32 v44, v44
    v_mov_b32 v44, v44
    v_mov_b32 v44, v44
    v_mov_b32 v44, v44
    v_mov_b32 v44, v44
    v_mov_b32 v44, v44
    v_mov_b32 v44, v44
    v_mov_b32 v44, v44
    buffer_load_dwordx2 v[74:75], v60, s[16:19], s62 offen sc1
    buffer_load_dwordx4 v[64:67], v58, s[16:19], s62 offen offset:0 sc1
    buffer_load_dwordx4 v[68:71], v58, s[16:19], s62 offen offset:3072 sc1
    buffer_load_dwordx2 v[72:73], v59, s[16:19], s62 offen sc1
    buffer_load_dword v76, v61, s[16:19], s49 offen sc1
    s_cmp_eq_u32 s49, 0
    s_cbranch_scc1 HOOKI
    v_mov_b32 v44, v44
    v_mov_b32 v44, v44
    v_mov_b32 v44, v44
    v_mov_b32 v44, v44
    v_mov_b32 v44, v44
    v_mov_b32 v44, v44
    v_mov_b32 v44, v44
    v_mov_b32 v44, v44
    v_mov_b32 v44, v44
    v_mov_b32 v44, v44
    v_mov_b32 v44, v44
    v_mov_b32 v44, v44
    v_mov_b32 v44, v44
    v_mov_b32 v44, v44
    v_mov_b32 v44, v44
    v_mov_b32 v44, v44
    v_mov_b32 v44, v44
    v_mov_b32 v44, v44
    v_mov_b32 v44, v44
    v_mov_b32 v44, v44
W2P:
    buffer_load_dwordx2 v[74:75], v60, s[16:19], s62 offen sc1
    buffer_load_dwordx4 v[64:67], v58, s[16:19], s62 offen offset:0 sc1
    buffer_load_dwordx4 v[68:71], v58, s[16:19], s62 offen offset:3072 sc1
    buffer_load_dwordx2 v[72:73], v59, s[16:19], s62 offen sc1
    buffer_load_dword v76, v61, s[16:19], s49 offen sc1
    s_waitcnt vmcnt(5)
    v_add_f32_dpp v46, v74, v74 quad_perm:[1,0,3,2] row_mask:0xf bank_mask:0xf
    v_add_f32_dpp v47, v75, v75 quad_perm:[1,0,3,2] row_mask:0xf bank_mask:0xf
    v_pk_add_f32 v[18:19], v[64:65], v[66:67]
    v_add_f32_dpp v46, v46, v46 quad_perm:[2,3,0,1] row_mask:0xf bank_mask:0xf
    v_add_f32_dpp v47, v47, v47 quad_perm:[2,3,0,1] row_mask:0xf bank_mask:0xf
    v_pk_add_f32 v[20:21], v[68:69], v[70:71]
    v_add_f32_dpp v46, v46, v46 row_half_mirror row_mask:0xf bank_mask:0xf
    v_add_f32_dpp v47, v47, v47 row_half_mirror row_mask:0xf bank_mask:0xf
    v_add_f32 v16, v18, v19
    v_add_f32 v17, v20, v21
    v_mul_f32 v47, 0x3acccccd, v47
    v_fmamk_f32 v46, v46, 0x3acccccd, v11
    v_fma_f32 v46, -v47, v47, v46
    v_rsq_f32 v46, v46
    v_pk_add_f32 v[16:17], v[16:17], v[72:73]
    v_pk_fma_f32 v[16:17], v[46:47], v[126:127], v[16:17] op_sel:[1,0,0] op_sel_hi:[1,1,1] neg_lo:[1,0,0] neg_hi:[1,0,0]
    v_pk_mul_f32 v[16:17], v[16:17], v[46:47] op_sel_hi:[1,0]
    v_mul_f32 v18, 0xbfb8aa3b, v16
    v_exp_f32 v18, v18
    v_mul_f32 v16, v16, v17
    v_add_f32 v18, 1.0, v18
    v_rcp_f32 v18, v18
    v_cmp_u_f32 vcc, v16, v76
    v_mul_f32 v16, v16, v18
    v_cvt_pk_bf16_f32 v16, v16, v16
    ds_write_b16 v63, v16
    s_cbranch_vccnz AGW2P
OKW2P:
    s_waitcnt lgkmcnt(0)
    s_barrier
    ds_read_b128 v[16:19], v2 offset:512
    ds_read_b128 v[20:23], v2 offset:576
    ds_read_b128 v[24:27], v2 offset:640
    ds_read_b128 v[28:31], v2 offset:704
    ds_read_b128 v[32:35], v2 offset:768
    ds_read_b128 v[36:39], v2 offset:832
    v_mov_b32 v40, v76
    s_nop 0
    s_waitcnt lgkmcnt(5)
    v_mfma_f32_16x16x32_bf16 v[40:43], v[16:19], v[80:83], v[40:43]
    s_waitcnt lgkmcnt(4)
    v_mfma_f32_16x16x32_bf16 v[40:43], v[20:23], v[84:87], v[40:43]
    s_waitcnt lgkmcnt(3)
    v_mfma_f32_16x16x32_bf16 v[40:43], v[24:27], v[88:91], v[40:43]
    s_waitcnt lgkmcnt(2)
    v_mfma_f32_16x16x32_bf16 v[40:43], v[28:31], v[92:95], v[40:43]
    s_waitcnt lgkmcnt(1)
    v_mfma_f32_16x16x32_bf16 v[40:43], v[32:35], v[96:99], v[40:43]
    s_waitcnt lgkmcnt(0)
    v_mfma_f32_16x16x32_bf16 v[40:43], v[36:39], v[100:103], v[40:43]
    s_waitcnt vmcnt(0)
    s_nop 6
    buffer_store_dword v40, v62, s[16:19], s49 offen sc1
STX:
    s_cmp_lg_u32 s49, 0
    s_cbranch_scc1 LAST
    s_branch LOOP
LAST:
    s_and_b32 s52, s2, 0xc7
    s_cmp_eq_u32 s52, 0
    s_cbranch_scc1 LOOP
    s_endpgm
FINAL:
    s_cmp_eq_u32 s44, 3
    s_cbranch_scc1 FINX
    s_sleep 22
    s_waitcnt lgkmcnt(0)
Y3P:
    buffer_load_dword v22, v16, s[16:19], s55 offen offset:0 sc1
    buffer_load_dword v23, v16, s[16:19], s55 offen offset:128 sc1
    buffer_load_dword v24, v16, s[16:19], s55 offen offset:256 sc1
    buffer_load_dword v25, v16, s[16:19], s55 offen offset:384 sc1
    s_waitcnt vmcnt(0)
    v_pk_add_f32 v[22:23], v[22:23], v[24:25]
    v_add_f32 v30, v22, v23
    v_mov_b32 v31, v30
    s_nop 1
    v_permlane32_swap_b32 v30, v31
    v_add_f32 v30, v30, v31
    v_cmp_u_f32 vcc, v30, v30
    v_cvt_pk_bf16_f32 v30, v30, v30
    s_cbranch_vccnz AGY3P
OKY3P:
    buffer_store_short v30, v21, s[36:39], 0 offen
FINX:
DONE:
    s_endpgm
TABLES:
    v_mov_b32 v23, 1879048192
    v_and_b32 v24, 15, v1
    v_lshrrev_b32 v25, 4, v1
    v_and_b32 v26, 7, v1
    v_and_b32 v27, 31, v1
    v_lshrrev_b32 v28, 5, v1
    v_and_b32 v29, 31, v1
    v_lshl_add_u32 v29, s44, 5, v29
    v_lshrrev_b32 v16, 2, v1
    v_lshlrev_b32 v16, 7, v16
    v_and_b32 v20, 3, v1
    v_lshl_add_u32 v16, v20, 2, v16
    s_mul_i32 s52, s7, 3072
    s_mul_i32 s54, s44, 768
    s_add_u32 s52, s52, s54
    s_lshl_b32 s54, s48, 4
    s_add_u32 s52, s52, s54
    v_add_u32 v16, s52, v16
    v_cmp_gt_u32 vcc, 24, v1
    s_nop 1
    v_cndmask_b32 v16, v23, v16, vcc
    s_lshl_b32 s52, s7, 5
    s_lshl_b32 s54, s48, 2
    s_add_u32 s52, s52, s54
    s_add_u32 s52, s52, 19968
    v_writelane_b32 v16, s52, 24
    v_lshlrev_b32 v17, 4, v26
    v_and_b32 v20, 1, v25
    v_lshl_add_u32 v17, v20, 7, v17
    v_mul_u32_u24 v20, 768, v28
    v_add_u32 v17, v17, v20
    s_mul_i32 s52, s44, 1536
    s_add_u32 s52, s52, 98816
    v_add_u32 v17, s52, v17
    v_bfe_u32 v20, v1, 3, 1
    v_xor_b32 v20, v20, v28
    v_lshl_add_u32 v19, v20, 3, v17
    v_add_u32 v19, 512, v19
    v_lshl_add_u32 v17, v20, 8, v17
    s_mul_i32 s52, s44, 24
    v_min_u32 v21, 23, v1
    v_add_u32 v21, s52, v21
    v_lshrrev_b32 v18, 5, v21
    v_lshlrev_b32 v18, 8, v18
    v_bfe_u32 v20, v21, 1, 1
    v_lshl_add_u32 v18, v20, 7, v18
    v_bfe_u32 v20, v21, 2, 3
    v_lshl_add_u32 v18, v20, 4, v18
    v_bfe_u32 v20, v21, 0, 1
    v_lshl_add_u32 v18, v20, 3, v18
    v_add_u32 v18, 98816, v18
    ds_write_b128 v12, v[16:19] offset:0
    v_lshlrev_b32 v16, 4, v26
    v_lshl_add_u32 v16, v25, 7, v16
    s_mul_i32 s52, s56, 6144
    s_mul_i32 s54, s44, 1536
    s_add_u32 s52, s52, s54
    v_add_u32 v16, s52, v16
    v_cmp_gt_u32 vcc, 8, v24
    s_nop 1
    v_cndmask_b32 v16, v23, v16, vcc
    s_lshr_b32 s53, s44, 1
    s_lshl_b32 s52, s56, 6
    s_lshl_b32 s54, s53, 5
    s_add_u32 s52, s52, s54
    s_add_u32 s52, s52, 19968
    v_lshl_add_u32 v17, v25, 2, v26
    v_and_b32 v17, 7, v17
    v_lshl_add_u32 v17, v17, 2, s52
    s_lshl_b32 s52, s57, 8
    s_add_u32 s52, s52, 131072
    s_or_b32 s53, s45, s56
    s_cmp_eq_u32 s53, 0
    s_cselect_b32 s52, s52, 1879048192
    v_lshl_add_u32 v18, v1, 2, s52
    v_lshlrev_b32 v19, 11, v28
    v_lshl_add_u32 v19, v27, 2, v19
    s_lshr_b32 s53, s57, 1
    s_lshl_b32 s52, s57, 12
    s_lshl_b32 s54, s53, 13
    s_add_u32 s52, s52, s54
    s_lshl_b32 s54, s45, 8
    s_add_u32 s52, s52, s54
    s_lshl_b32 s54, s56, 7
    s_add_u32 s52, s52, s54
    v_add_u32 v19, s52, v19
    ds_write_b128 v12, v[16:19] offset:4096
    s_lshl_b32 s52, s44, 9
    s_add_u32 s52, s52, 104960
    v_lshl_add_u32 v16, v27, 4, s52
    v_lshl_add_u32 v16, v28, 11, v16
    v_lshlrev_b32 v17, 4, v24
    v_lshl_add_u32 v17, v25, 2, v17
    v_add_u32 v17, 104960, v17
    v_mov_b32 v18, 98752
    s_lshl_b32 s52, s44, 2
    s_add_u32 s52, s52, 98752
    v_mov_b32 v19, 98792
    v_writelane_b32 v19, s52, 0
    ds_write_b128 v12, v[16:19] offset:8192
    v_lshlrev_b32 v16, 10, v28
    v_lshl_add_u32 v16, v27, 2, v16
    s_lshl_b32 s52, s3, 14
    s_lshl_b32 s54, s44, 11
    s_add_u32 s52, s52, s54
    v_add_u32 v16, s52, v16
    v_lshlrev_b32 v17, 1, v29
    v_add_u32 v17, 96512, v17
    s_lshl_b32 s52, s4, 9
    s_add_u32 s52, s52, 133632
    s_cmp_lt_u32 s4, 5
    s_cselect_b32 s52, s52, 1879048192
    s_cmp_eq_u32 s45, 0
    s_cselect_b32 s52, s52, 1879048192
    v_lshl_add_u32 v18, v29, 2, s52
    v_cmp_gt_u32 vcc, 32, v1
    s_nop 1
    v_cndmask_b32 v18, v23, v18, vcc
    s_lshl_b32 s52, s59, 6
    s_lshl_b32 s54, s44, 4
    s_add_u32 s52, s52, s54
    v_add_u32 v19, s52, v1
    s_mul_i32 s52, s58, 3072
    s_lshl_b32 s54, s3, 2
    s_add_u32 s52, s52, s54
    s_add_u32 s52, s52, 12288
    s_lshl_b32 s53, s58, 2
    s_add_u32 s53, s53, 18432
    s_cmp_eq_u32 s3, 4
    s_cselect_b32 s52, s53, s52
    s_cselect_b32 s53, 3, 4
    v_lshlrev_b32 v19, s53, v19
    v_add_u32 v19, s52, v19
    v_cmp_gt_u32 vcc, 16, v1
    s_nop 1
    v_cndmask_b32 v19, v23, v19, vcc
    ds_write_b128 v12, v[16:19] offset:12288
    s_lshl_b32 s52, s4, 3
    s_add_u32 s52, s52, 20224
    v_mov_b32 v16, v23
    v_writelane_b32 v16, s52, 0
    v_and_b32 v17, 3, v1
    v_lshlrev_b32 v17, 3, v17
    v_bfe_u32 v20, v1, 2, 2
    v_lshl_add_u32 v17, v20, 7, v17
    v_lshrrev_b32 v20, 4, v1
    v_lshl_add_u32 v17, v20, 10, v17
    v_bfe_u32 v20, v1, 3, 2
    v_lshl_add_u32 v17, v20, 5, v17
    s_lshl_b32 s52, s44, 5
    v_xor_b32 v17, s52, v17
    v_lshlrev_b32 v18, 4, v0
    v_add_u32 v18, 12288, v18
    v_lshlrev_b32 v19, 3, v0
    v_add_u32 v19, 18432, v19
    v_cmp_gt_u32 vcc, 192, v0
    s_nop 1
    v_cndmask_b32 v18, v23, v18, vcc
    v_cndmask_b32 v19, v23, v19, vcc
    ds_write_b128 v12, v[16:19] offset:16384
    v_lshlrev_b32 v16, 3, v26
    v_add_u32 v16, 20224, v16
    v_cmp_gt_u32 vcc, 5, v26
    s_nop 1
    v_cndmask_b32 v16, v23, v16, vcc
    s_lshl_b32 s52, s57, 8
    s_lshl_b32 s54, s44, 6
    s_add_u32 s52, s52, s54
    s_add_u32 s52, s52, 133632
    s_cmp_eq_u32 s45, 0
    s_cselect_b32 s52, s52, 1879048192
    v_lshl_add_u32 v17, v24, 2, s52
    s_lshr_b32 s53, s57, 2
    s_lshr_b32 s51, s44, 1
    s_lshl_b32 s52, s57, 11
    s_lshl_b32 s54, s53, 13
    s_add_u32 s52, s52, s54
    s_mul_i32 s54, s51, 896
    s_add_u32 s52, s52, s54
    s_lshl_b32 s54, s44, 6
    s_add_u32 s52, s52, s54
    s_lshl_b32 s54, s45, 7
    s_add_u32 s52, s52, s54
    s_add_u32 s52, s52, 81920
    v_lshl_add_u32 v18, v24, 2, s52
    v_lshl_add_u32 v18, v25, 13, v18
    v_cmp_gt_u32 vcc, 32, v1
    s_nop 1
    v_cndmask_b32 v18, v23, v18, vcc
    v_lshlrev_b32 v19, 1, v0
    v_add_u32 v19, 96768, v19
    ds_write_b128 v12, v[16:19] offset:20480
    s_lshr_b32 s53, s48, 2
    s_mul_i32 s52, s7, 6144
    s_lshl_b32 s54, s44, 8
    s_add_u32 s52, s52, s54
    s_mul_i32 s54, s53, 3056
    s_add_u32 s52, s52, s54
    s_lshl_b32 s54, s48, 2
    s_add_u32 s52, s52, s54
    s_add_u32 s52, s52, 20480
    v_lshl_add_u32 v16, v1, 4, s52
    v_cmp_gt_u32 vcc, 16, v1
    s_nop 1
    v_cndmask_b32 v16, v23, v16, vcc
    s_lshl_b32 s52, s7, 6
    s_lshl_b32 s54, s48, 3
    s_add_u32 s52, s52, s54
    s_add_u32 s52, s52, 45056
    v_mov_b32 v17, v23
    v_writelane_b32 v17, s52, 0
    s_mul_i32 s52, s48, 80
    v_add_u32 v20, s52, v29
    v_lshrrev_b32 v18, 5, v20
    v_lshlrev_b32 v18, 10, v18
    v_lshrrev_b32 v21, 8, v20
    v_lshl_add_u32 v18, v21, 13, v18
    v_and_b32 v21, 31, v20
    v_lshl_add_u32 v18, v21, 2, v18
    v_lshl_add_u32 v18, v28, 9, v18
    v_add_u32 v18, 81920, v18
    v_cmp_gt_u32 vcc, 80, v29
    s_nop 1
    v_cndmask_b32 v18, v23, v18, vcc
    v_lshlrev_b32 v19, 1, v29
    v_add_u32 v19, 96256, v19
    ds_write_b128 v12, v[16:19] offset:24576
    s_and_b32 s53, s2, 0xc7
    s_cmp_eq_u32 s53, 0
    s_mov_b32 s52, 131072
    s_cselect_b32 s52, s52, 1879048192
    v_lshl_add_u32 v16, v20, 2, s52
    v_lshlrev_b32 v19, 1, v20
    s_and_b32 vcc_hi, vcc_hi, 0
    s_nop 1
    v_cndmask_b32 v16, v23, v16, vcc
    v_cndmask_b32 v19, v23, v19, vcc
    v_and_b32 v21, 3, v1
    v_lshrrev_b32 v17, 4, v1
    v_bfe_u32 v18, v1, 2, 2
    v_lshlrev_b32 v21, 3, v21
    v_mul_u32_u24 v18, 384, v18
    v_add_u32 v21, v21, v18
    v_bfe_u32 v18, v1, 3, 2
    v_xor_b32 v18, s44, v18
    v_lshl_add_u32 v21, v18, 5, v21
    v_add_u32 v21, 65536, v21
    v_and_b32 v18, 1, v17
    v_mul_u32_u24 v17, 3072, v17
    v_mul_u32_u24 v18, 3072, v18
    v_add_u32 v17, v17, v21
    v_add_u32 v18, v18, v21
    ds_write_b128 v12, v[16:19] offset:28672
    s_branch ENTRY0
HOOKL:
    s_cmp_lt_u32 s46, 30
    s_cbranch_scc1 NOGSW
    v_mov_b32 v30, 20224
GSW:
    buffer_load_dword v31, v30, s[16:19], s96 offen sc1
    s_waitcnt vmcnt(0)
    v_cmp_u_f32 vcc, v31, v31
    s_cbranch_vccz NOGSW
    s_add_u32 s51, s51, 1
    s_sleep 2
    s_cmp_lt_u32 s51, 0x8000
    s_cbranch_scc1 GSW
NOGSW:
    s_cmp_ge_u32 s46, 30
    s_cselect_b32 s53, 10, 0
    s_sub_u32 s53, s46, s53
    v_min_u32 v31, 17, v1
    v_lshlrev_b32 v31, 7, v31
    s_mul_i32 s52, s45, 45312
    s_mul_i32 s54, s53, 2304
    s_add_u32 s52, s52, s54
    s_add_u32 s52, s52, 524288
    buffer_load_dword v31, v31, s[16:19], s52 offen sc1
    v_lshlrev_b32 v30, 3, v0
    s_mul_i32 s52, s47, 12288
    s_add_u32 s52, s52, 1441792
    s_add_u32 s53, s52, 0
    buffer_load_dwordx2 v[32:33], v30, s[16:19], s53 offen offset:0 sc1
    buffer_load_dwordx2 v[34:35], v30, s[16:19], s53 offen offset:1536 sc1
    s_add_u32 s53, s52, 3072
    buffer_load_dwordx2 v[36:37], v30, s[16:19], s53 offen offset:0 sc1
    buffer_load_dwordx2 v[38:39], v30, s[16:19], s53 offen offset:1536 sc1
    s_add_u32 s53, s52, 6144
    buffer_load_dwordx2 v[40:41], v30, s[16:19], s53 offen offset:0 sc1
    buffer_load_dwordx2 v[42:43], v30, s[16:19], s53 offen offset:1536 sc1
    s_add_u32 s53, s52, 9216
    buffer_load_dwordx2 v[26:27], v30, s[16:19], s53 offen offset:0 sc1
    buffer_load_dwordx2 v[28:29], v30, s[16:19], s53 offen offset:1536 sc1
    s_sleep 20
    s_mov_b32 s51, 0
    s_branch GYB
QCA:
    v_lshlrev_b32 v30, 3, v0
    s_mul_i32 s52, s47, 12288
    s_add_u32 s52, s52, 1441792
    s_add_u32 s53, s52, 0
    buffer_load_dwordx2 v[32:33], v30, s[16:19], s53 offen offset:0 sc1
    buffer_load_dwordx2 v[34:35], v30, s[16:19], s53 offen offset:1536 sc1
    s_add_u32 s53, s52, 3072
    buffer_load_dwordx2 v[36:37], v30, s[16:19], s53 offen offset:0 sc1
    buffer_load_dwordx2 v[38:39], v30, s[16:19], s53 offen offset:1536 sc1
    s_add_u32 s53, s52, 6144
    buffer_load_dwordx2 v[40:41], v30, s[16:19], s53 offen offset:0 sc1
    buffer_load_dwordx2 v[42:43], v30, s[16:19], s53 offen offset:1536 sc1
    s_add_u32 s53, s52, 9216
    buffer_load_dwordx2 v[26:27], v30, s[16:19], s53 offen offset:0 sc1
    buffer_load_dwordx2 v[28:29], v30, s[16:19], s53 offen offset:1536 sc1
    s_waitcnt vmcnt(0)
    s_add_u32 s51, s51, 1
    s_sleep 2
    s_cmp_lt_u32 s51, 0x8000
    s_cbranch_scc1 QCP
    s_branch Y2W
Y2P:
    buffer_load_dword v22, v16, s[16:19], s55 offen offset:0 sc1
    buffer_load_dword v23, v16, s[16:19], s55 offen offset:128 sc1
    buffer_load_dword v24, v16, s[16:19], s55 offen offset:256 sc1
    buffer_load_dword v25, v16, s[16:19], s55 offen offset:384 sc1
    s_branch Y2W
AGY2P:
    s_add_u32 s51, s51, 1
    s_sleep 1
    s_cmp_lt_u32 s51, 0x8000
    s_cbranch_scc1 Y2P
    s_branch OKY2P
Q0L:
    v_and_b32 v21, 3, v1
    v_lshrrev_b32 v19, 4, v1
    v_bfe_u32 v20, v1, 2, 2
    v_lshlrev_b32 v21, 3, v21
    v_mul_u32_u24 v20, 384, v20
    v_add_u32 v21, v21, v20
    v_bfe_u32 v20, v1, 3, 2
    v_xor_b32 v20, s44, v20
    v_lshl_add_u32 v21, v20, 5, v21
    v_add_u32 v21, 65536, v21
    v_and_b32 v20, 1, v19
    v_mul_u32_u24 v19, 3072, v19
    v_mul_u32_u24 v20, 3072, v20
    v_add_u32 v19, v19, v21
    v_add_u32 v20, v20, v21
    s_branch QTR
HOOKA:
    s_mov_b64 exec, 0xffff
    s_nop 3
    s_lshl_b32 s52, s44, 6
    s_add_u32 s52, s52, 98816
    v_lshl_add_u32 v14, v1, 2, s52
    ds_write_b32 v14, v17 offset:10752
    v_fma_f32 v16, -v84, v17, v16
    v_mul_f32 v16, v16, v85
    ds_write_b32 v14, v16 offset:0
    ds_write_b32 v14, v21 offset:11008
    v_fma_f32 v20, -v84, v21, v20
    v_mul_f32 v20, v20, v85
    ds_write_b32 v14, v20 offset:256
    ds_write_b32 v14, v25 offset:11264
    v_fma_f32 v24, -v84, v25, v24
    v_mul_f32 v24, v24, v85
    ds_write_b32 v14, v24 offset:512
    s_mov_b64 exec, -1
    s_add_u32 s44, s44, 1
    s_cmp_lt_u32 s44, 4
    s_cbranch_scc1 Q0L
    s_mov_b32 s44, 3
    v_lshlrev_b32 v14, 2, v1
    v_add_u32 v14, 98816, v14
    ds_read2st64_b32 v[16:17], v14 offset0:0 offset1:1
    ds_read_b32 v18, v14 offset:512
    s_lshl_b32 s52, s47, 13
    s_lshl_b32 s54, s48, 10
    s_add_u32 s52, s52, s54
    s_add_u32 s52, s52, 1114112
    s_waitcnt lgkmcnt(0)
    v_bitop3_b32 v19, v16, v17, v18 bitop3:0x96
    v_xor_b32 v19, v19, v89
    buffer_store_dwordx4 v[16:19], v88, s[16:19], s52 offen sc1
    s_sleep 24
    v_and_b32 v15, 0xe1, v1
    v_lshlrev_b32 v15, 1, v15
    v_bfe_u32 v14, v1, 4, 1
    v_lshl_add_u32 v15, v14, 3, v15
    v_bfe_u32 v14, v1, 3, 1
    v_lshl_add_u32 v15, v14, 4, v15
    v_bfe_u32 v14, v1, 2, 1
    v_lshl_add_u32 v15, v14, 2, v15
    v_bfe_u32 v14, v1, 1, 1
    v_lshl_add_u32 v15, v14, 5, v15
    v_add_u32 v15, 98304, v15
    s_lshl_b32 s52, s47, 13
    s_add_u32 s52, s52, 1114112
    s_add_u32 s53, s52, 4096
    s_mov_b32 s51, 0
Q0P:
    buffer_load_dwordx4 v[16:19], v88, s[16:19], s52 offen offset:0 sc1
    buffer_load_dwordx4 v[20:23], v88, s[16:19], s52 offen offset:1024 sc1
    buffer_load_dwordx4 v[24:27], v88, s[16:19], s52 offen offset:2048 sc1
    buffer_load_dwordx4 v[28:31], v88, s[16:19], s52 offen offset:3072 sc1
    buffer_load_dwordx4 v[32:35], v88, s[16:19], s53 offen offset:0 sc1
    buffer_load_dwordx4 v[36:39], v88, s[16:19], s53 offen offset:1024 sc1
    buffer_load_dwordx4 v[40:43], v88, s[16:19], s53 offen offset:2048 sc1
    buffer_load_dwordx4 v[44:47], v88, s[16:19], s53 offen offset:3072 sc1
    v_mov_b32 v48, 0
    s_waitcnt vmcnt(0)
    v_bitop3_b32 v49, v16, v17, v18 bitop3:0x96
    v_bitop3_b32 v49, v49, v19, v89 bitop3:0x96
    v_or_b32 v48, v48, v49
    v_bitop3_b32 v49, v20, v21, v22 bitop3:0x96
    v_bitop3_b32 v49, v49, v23, v89 bitop3:0x96
    v_or_b32 v48, v48, v49
    v_bitop3_b32 v49, v24, v25, v26 bitop3:0x96
    v_bitop3_b32 v49, v49, v27, v89 bitop3:0x96
    v_or_b32 v48, v48, v49
    v_bitop3_b32 v49, v28, v29, v30 bitop3:0x96
    v_bitop3_b32 v49, v49, v31, v89 bitop3:0x96
    v_or_b32 v48, v48, v49
    v_bitop3_b32 v49, v32, v33, v34 bitop3:0x96
    v_bitop3_b32 v49, v49, v35, v89 bitop3:0x96
    v_or_b32 v48, v48, v49
    v_bitop3_b32 v49, v36, v37, v38 bitop3:0x96
    v_bitop3_b32 v49, v49, v39, v89 bitop3:0x96
    v_or_b32 v48, v48, v49
    v_bitop3_b32 v49, v40, v41, v42 bitop3:0x96
    v_bitop3_b32 v49, v49, v43, v89 bitop3:0x96
    v_or_b32 v48, v48, v49
    v_bitop3_b32 v49, v44, v45, v46 bitop3:0x96
    v_bitop3_b32 v49, v49, v47, v89 bitop3:0x96
    v_or_b32 v48, v48, v49
    v_cmp_ne_u32 vcc, 0, v48
    s_cbranch_vccz Q0OK
    s_add_u32 s51, s51, 1
    s_sleep 4
    s_cmp_lt_u32 s51, 0x8000
    s_cbranch_scc1 Q0P
Q0OK:
    v_pk_add_f32 v[16:17], v[16:17], v[20:21]
    v_add_f32 v18, v18, v22
    v_pk_add_f32 v[16:17], v[16:17], v[24:25]
    v_add_f32 v18, v18, v26
    v_pk_add_f32 v[16:17], v[16:17], v[28:29]
    v_add_f32 v18, v18, v30
    v_pk_add_f32 v[16:17], v[16:17], v[32:33]
    v_add_f32 v18, v18, v34
    v_pk_add_f32 v[16:17], v[16:17], v[36:37]
    v_add_f32 v18, v18, v38
    v_pk_add_f32 v[16:17], v[16:17], v[40:41]
    v_add_f32 v18, v18, v42
    v_pk_add_f32 v[16:17], v[16:17], v[44:45]
    v_add_f32 v18, v18, v46
    v_cvt_pk_bf16_f32 v16, v16, v17
    v_cvt_pk_bf16_f32 v18, v18, v18
    ds_write_b16 v15, v16
    ds_write_b16_d16_hi v15, v16 offset:128
    ds_write_b16 v15, v18 offset:256
    s_mov_b32 s51, 0
HSP:
    s_mov_b32 s52, 1376256
    buffer_load_dwordx4 v[24:27], v88, s[16:19], s52 offen sc1
    s_waitcnt vmcnt(0)
    v_xor_b32 v20, s5, v24
    v_xor_b32 v21, s5, v25
    v_xor_b32 v22, s5, v26
    v_xor_b32 v23, s5, v27
    v_or3_b32 v20, v20, v21, v22
    v_or_b32 v20, v20, v23
    v_cmp_lt_u32 vcc, 31, v20
    s_cbranch_vccz HSOK
    s_add_u32 s51, s51, 1
    s_sleep 8
    s_cmp_lt_u32 s51, 0x8000
    s_cbranch_scc1 HSP
HSOK:
    s_mov_b32 s53, 0
    v_and_b32 v24, 16, v24
    v_cmp_ne_u32 vcc, 0, v24
    s_bcnt1_i32_b64 s52, vcc
    s_add_u32 s53, s53, s52
    v_and_b32 v25, 16, v25
    v_cmp_ne_u32 vcc, 0, v25
    s_bcnt1_i32_b64 s52, vcc
    s_add_u32 s53, s53, s52
    v_and_b32 v26, 16, v26
    v_cmp_ne_u32 vcc, 0, v26
    s_bcnt1_i32_b64 s52, vcc
    s_add_u32 s53, s53, s52
    v_and_b32 v27, 16, v27
    v_cmp_ne_u32 vcc, 0, v27
    s_bcnt1_i32_b64 s52, vcc
    s_add_u32 s53, s53, s52
    v_and_b32 v20, 15, v20
    s_cmp_gt_u32 s53, 128
    s_cselect_b32 s53, 2, 0
    s_lshr_b32 s52, s5, 1
    s_xor_b32 s53, s53, s52
    s_and_b32 s53, s53, 2
    s_lshl_b32 s52, s45, 3
    v_cmp_ne_u32 vcc, 0, v20
    s_lshr_b64 s[60:61], vcc, s52
    s_and_b32 s52, s60, 0xff
    s_cselect_b32 s50, 0, 1
    v_mov_b32 v38, 98784
    s_or_b32 s53, s53, s50
    v_or_b32 v39, s53, v89
    ds_write_b32 v38, v39
    v_and_b32 v21, 0xffff0000, v86
    v_lshlrev_b32 v20, 16, v86
    buffer_store_dwordx2 v[20:21], v87, s[16:19], 0 offen sc1
    s_branch TABLES
EN3:
    v_mov_b64 v[72:73], 0
    v_mov_b64 v[74:75], 0
    v_mov_b64 v[76:77], 0
    v_mov_b64 v[78:79], 0
    v_mov_b64 v[40:41], 0
    v_mov_b64 v[42:43], 0
    v_mov_b64 v[44:45], 0
    v_mov_b64 v[46:47], 0
    v_mov_b64 v[48:49], 0
    v_mov_b64 v[50:51], 0
    s_branch ENOK2
ENTRY0:
    ds_read_b64 v[14:15], v12 offset:0
    ds_read_b64 v[60:61], v12 offset:8
    v_mov_b64 v[64:65], 0
    v_mov_b64 v[66:67], 0
    v_mov_b64 v[68:69], 0
    v_mov_b64 v[70:71], 0
    v_mov_b64 v[72:73], 0
    v_mov_b64 v[74:75], 0
    v_mov_b64 v[76:77], 0
    v_mov_b64 v[78:79], 0
    v_mov_b64 v[40:41], 0
    v_mov_b64 v[42:43], 0
    v_mov_b64 v[44:45], 0
    v_mov_b64 v[46:47], 0
    v_mov_b64 v[48:49], 0
    v_mov_b64 v[50:51], 0
    s_cmp_lg_u32 s44, 3
    s_cbranch_scc1 QFRAG
    s_waitcnt lgkmcnt(0)
    s_barrier
    s_waitcnt vmcnt(23)
    buffer_load_dwordx4 a[0:3], v80, s[8:11], s96 offen offset:0 nt
    s_waitcnt vmcnt(23)
    buffer_load_dwordx4 a[8:11], v80, s[8:11], s96 offen offset:128 nt
    s_waitcnt vmcnt(23)
    buffer_load_dwordx4 a[16:19], v80, s[8:11], s96 offen offset:256 nt
    s_add_u32 s96, s96, s97
    s_waitcnt vmcnt(23)
    buffer_load_dwordx4 a[4:7], v80, s[8:11], s96 offen offset:0 nt
    s_waitcnt vmcnt(23)
    buffer_load_dwordx4 a[12:15], v80, s[8:11], s96 offen offset:128 nt
    s_waitcnt vmcnt(23)
    buffer_load_dwordx4 a[20:23], v80, s[8:11], s96 offen offset:256 nt
    s_add_u32 s96, s96, s97
    s_waitcnt vmcnt(23)
    buffer_load_dwordx4 a[24:27], v80, s[8:11], s96 offen offset:0 nt
    s_waitcnt vmcnt(23)
    buffer_load_dwordx4 a[32:35], v80, s[8:11], s96 offen offset:128 nt
    s_waitcnt vmcnt(23)
    buffer_load_dwordx4 a[40:43], v80, s[8:11], s96 offen offset:256 nt
    s_add_u32 s96, s96, s97
    s_waitcnt vmcnt(23)
    buffer_load_dwordx4 a[28:31], v80, s[8:11], s96 offen offset:0 nt
    s_waitcnt vmcnt(23)
    buffer_load_dwordx4 a[36:39], v80, s[8:11], s96 offen offset:128 nt
    s_waitcnt vmcnt(23)
    buffer_load_dwordx4 a[44:47], v80, s[8:11], s96 offen offset:256 nt
    s_add_u32 s96, s96, s97
    s_waitcnt vmcnt(23)
    buffer_load_dwordx4 a[48:51], v80, s[8:11], s96 offen offset:0 nt
    s_waitcnt vmcnt(23)
    buffer_load_dwordx4 a[56:59], v80, s[8:11], s96 offen offset:128 nt
    s_waitcnt vmcnt(23)
    buffer_load_dwordx4 a[64:67], v80, s[8:11], s96 offen offset:256 nt
    s_add_u32 s96, s96, s97
    s_waitcnt vmcnt(23)
    buffer_load_dwordx4 a[52:55], v80, s[8:11], s96 offen offset:0 nt
    s_waitcnt vmcnt(23)
    buffer_load_dwordx4 a[60:63], v80, s[8:11], s96 offen offset:128 nt
    s_waitcnt vmcnt(23)
    buffer_load_dwordx4 a[68:71], v80, s[8:11], s96 offen offset:256 nt
    s_add_u32 s96, s96, s97
    s_waitcnt vmcnt(23)
    buffer_load_dwordx4 a[72:75], v80, s[8:11], s96 offen offset:0 nt
    s_waitcnt vmcnt(23)
    buffer_load_dwordx4 a[80:83], v80, s[8:11], s96 offen offset:128 nt
    s_waitcnt vmcnt(23)
    buffer_load_dwordx4 a[88:91], v80, s[8:11], s96 offen offset:256 nt
    s_add_u32 s96, s96, s97
    s_waitcnt vmcnt(23)
    buffer_load_dwordx4 a[76:79], v80, s[8:11], s96 offen offset:0 nt
    s_waitcnt vmcnt(23)
    buffer_load_dwordx4 a[84:87], v80, s[8:11], s96 offen offset:128 nt
    s_waitcnt vmcnt(23)
    buffer_load_dwordx4 a[92:95], v80, s[8:11], s96 offen offset:256 nt
    s_add_u32 s96, s96, s97
    s_waitcnt vmcnt(23)
    buffer_load_dwordx4 a[96:99], v80, s[8:11], s96 offen offset:0 nt
    s_waitcnt vmcnt(23)
    buffer_load_dwordx4 a[104:107], v80, s[8:11], s96 offen offset:128 nt
    s_waitcnt vmcnt(23)
    buffer_load_dwordx4 a[112:115], v80, s[8:11], s96 offen offset:256 nt
    s_add_u32 s96, s96, s97
    s_waitcnt vmcnt(23)
    buffer_load_dwordx4 a[100:103], v80, s[8:11], s96 offen offset:0 nt
    s_waitcnt vmcnt(23)
    buffer_load_dwordx4 a[108:111], v80, s[8:11], s96 offen offset:128 nt
    s_waitcnt vmcnt(23)
    buffer_load_dwordx4 a[116:119], v80, s[8:11], s96 offen offset:256 nt
    s_add_u32 s96, s96, s97
    s_waitcnt vmcnt(23)
    buffer_load_dwordx4 a[120:123], v80, s[8:11], s96 offen offset:0 nt
    s_waitcnt vmcnt(23)
    buffer_load_dwordx4 a[128:131], v80, s[8:11], s96 offen offset:128 nt
    s_waitcnt vmcnt(23)
    buffer_load_dwordx4 a[136:139], v80, s[8:11], s96 offen offset:256 nt
    s_add_u32 s96, s96, s97
    s_waitcnt vmcnt(23)
    buffer_load_dwordx4 a[124:127], v80, s[8:11], s96 offen offset:0 nt
    s_waitcnt vmcnt(23)
    buffer_load_dwordx4 a[132:135], v80, s[8:11], s96 offen offset:128 nt
    s_waitcnt vmcnt(23)
    buffer_load_dwordx4 a[140:143], v80, s[8:11], s96 offen offset:256 nt
    s_add_u32 s96, s96, s97
    s_waitcnt vmcnt(23)
    buffer_load_dwordx4 a[144:147], v80, s[8:11], s96 offen offset:0 nt
    s_waitcnt vmcnt(23)
    buffer_load_dwordx4 a[152:155], v80, s[8:11], s96 offen offset:128 nt
    s_waitcnt vmcnt(23)
    buffer_load_dwordx4 a[160:163], v80, s[8:11], s96 offen offset:256 nt
    s_add_u32 s96, s96, s97
    s_waitcnt vmcnt(23)
    buffer_load_dwordx4 a[148:151], v80, s[8:11], s96 offen offset:0 nt
    s_waitcnt vmcnt(23)
    buffer_load_dwordx4 a[156:159], v80, s[8:11], s96 offen offset:128 nt
    s_waitcnt vmcnt(23)
    buffer_load_dwordx4 a[164:167], v80, s[8:11], s96 offen offset:256 nt
    s_add_u32 s96, s96, s97
    s_waitcnt vmcnt(23)
    buffer_load_dwordx4 a[168:171], v80, s[8:11], s96 offen offset:0 nt
    s_waitcnt vmcnt(23)
    buffer_load_dwordx4 a[176:179], v80, s[8:11], s96 offen offset:128 nt
    s_waitcnt vmcnt(23)
    buffer_load_dwordx4 a[184:187], v80, s[8:11], s96 offen offset:256 nt
    s_add_u32 s96, s96, s97
    s_waitcnt vmcnt(23)
    buffer_load_dwordx4 a[172:175], v80, s[8:11], s96 offen offset:0 nt
    s_waitcnt vmcnt(23)
    buffer_load_dwordx4 a[180:183], v80, s[8:11], s96 offen offset:128 nt
    s_waitcnt vmcnt(23)
    buffer_load_dwordx4 a[188:191], v80, s[8:11], s96 offen offset:256 nt
    s_lshl_b32 s97, s97, 1
    s_waitcnt vmcnt(23)
    buffer_load_dwordx4 a[192:195], v82, s[12:15], s55 offen offset:0 nt
    s_waitcnt vmcnt(23)
    buffer_load_dwordx4 a[200:203], v82, s[12:15], s55 offen offset:128 nt
    s_waitcnt vmcnt(23)
    buffer_load_dwordx4 a[208:211], v82, s[12:15], s55 offen offset:256 nt
    s_waitcnt vmcnt(23)
    buffer_load_dwordx4 a[216:219], v82, s[12:15], s55 offen offset:384 nt
    s_waitcnt vmcnt(23)
    buffer_load_dwordx4 a[224:227], v82, s[12:15], s55 offen offset:512 nt
    s_waitcnt vmcnt(23)
    buffer_load_dwordx4 a[232:235], v82, s[12:15], s55 offen offset:640 nt
    s_add_u32 s55, s55, s97
    s_waitcnt vmcnt(23)
    buffer_load_dwordx4 a[196:199], v82, s[12:15], s55 offen offset:0 nt
    s_waitcnt vmcnt(23)
    buffer_load_dwordx4 a[204:207], v82, s[12:15], s55 offen offset:128 nt
    s_waitcnt vmcnt(23)
    buffer_load_dwordx4 a[212:215], v82, s[12:15], s55 offen offset:256 nt
    s_waitcnt vmcnt(23)
    buffer_load_dwordx4 a[220:223], v82, s[12:15], s55 offen offset:384 nt
    s_waitcnt vmcnt(23)
    buffer_load_dwordx4 a[228:231], v82, s[12:15], s55 offen offset:512 nt
    s_waitcnt vmcnt(23)
    buffer_load_dwordx4 a[236:239], v82, s[12:15], s55 offen offset:640 nt
    s_add_u32 s55, s55, s97
    s_waitcnt vmcnt(23)
    buffer_load_dwordx4 a[240:243], v82, s[12:15], s55 offen offset:0 nt
    s_waitcnt vmcnt(23)
    buffer_load_dwordx4 a[248:251], v82, s[12:15], s55 offen offset:128 nt
    s_waitcnt vmcnt(23)
    buffer_load_dwordx4 v[128:131], v82, s[12:15], s55 offen offset:256 nt
    s_waitcnt vmcnt(23)
    buffer_load_dwordx4 v[136:139], v82, s[12:15], s55 offen offset:384 nt
    s_waitcnt vmcnt(23)
    buffer_load_dwordx4 v[144:147], v82, s[12:15], s55 offen offset:512 nt
    s_waitcnt vmcnt(23)
    buffer_load_dwordx4 v[152:155], v82, s[12:15], s55 offen offset:640 nt
    s_add_u32 s55, s55, s97
    s_waitcnt vmcnt(23)
    buffer_load_dwordx4 a[244:247], v82, s[12:15], s55 offen offset:0 nt
    s_waitcnt vmcnt(23)
    buffer_load_dwordx4 a[252:255], v82, s[12:15], s55 offen offset:128 nt
    s_waitcnt vmcnt(23)
    buffer_load_dwordx4 v[132:135], v82, s[12:15], s55 offen offset:256 nt
    s_waitcnt vmcnt(23)
    buffer_load_dwordx4 v[140:143], v82, s[12:15], s55 offen offset:384 nt
    s_waitcnt vmcnt(23)
    buffer_load_dwordx4 v[148:151], v82, s[12:15], s55 offen offset:512 nt
    s_waitcnt vmcnt(23)
    buffer_load_dwordx4 v[156:159], v82, s[12:15], s55 offen offset:640 nt
    s_add_u32 s55, s55, s97
    s_waitcnt vmcnt(23)
    buffer_load_dwordx4 v[160:163], v82, s[12:15], s55 offen offset:0 nt
    s_waitcnt vmcnt(23)
    buffer_load_dwordx4 v[168:171], v82, s[12:15], s55 offen offset:128 nt
    s_waitcnt vmcnt(23)
    buffer_load_dwordx4 v[176:179], v82, s[12:15], s55 offen offset:256 nt
    s_waitcnt vmcnt(23)
    buffer_load_dwordx4 v[184:187], v82, s[12:15], s55 offen offset:384 nt
    s_waitcnt vmcnt(23)
    buffer_load_dwordx4 v[192:195], v82, s[12:15], s55 offen offset:512 nt
    s_waitcnt vmcnt(23)
    buffer_load_dwordx4 v[200:203], v82, s[12:15], s55 offen offset:640 nt
    s_add_u32 s55, s55, s97
    s_waitcnt vmcnt(23)
    buffer_load_dwordx4 v[164:167], v82, s[12:15], s55 offen offset:0 nt
    s_waitcnt vmcnt(23)
    buffer_load_dwordx4 v[172:175], v82, s[12:15], s55 offen offset:128 nt
    s_waitcnt vmcnt(23)
    buffer_load_dwordx4 v[180:183], v82, s[12:15], s55 offen offset:256 nt
    s_waitcnt vmcnt(23)
    buffer_load_dwordx4 v[188:191], v82, s[12:15], s55 offen offset:384 nt
    s_waitcnt vmcnt(23)
    buffer_load_dwordx4 v[196:199], v82, s[12:15], s55 offen offset:512 nt
    s_waitcnt vmcnt(23)
    buffer_load_dwordx4 v[204:207], v82, s[12:15], s55 offen offset:640 nt
    s_add_u32 s55, s55, s97
    s_waitcnt vmcnt(23)
    buffer_load_dwordx4 v[208:211], v82, s[12:15], s55 offen offset:0 nt
    s_waitcnt vmcnt(23)
    buffer_load_dwordx4 v[216:219], v82, s[12:15], s55 offen offset:128 nt
    s_waitcnt vmcnt(23)
    buffer_load_dwordx4 v[224:227], v82, s[12:15], s55 offen offset:256 nt
    s_waitcnt vmcnt(23)
    buffer_load_dwordx4 v[232:235], v82, s[12:15], s55 offen offset:384 nt
    s_waitcnt vmcnt(23)
    buffer_load_dwordx4 v[240:243], v82, s[12:15], s55 offen offset:512 nt
    s_waitcnt vmcnt(23)
    buffer_load_dwordx4 v[248:251], v82, s[12:15], s55 offen offset:640 nt
    s_add_u32 s55, s55, s97
    s_barrier
    s_waitcnt vmcnt(23)
    buffer_load_dwordx4 v[212:215], v82, s[12:15], s55 offen offset:0 nt
    s_waitcnt vmcnt(23)
    buffer_load_dwordx4 v[220:223], v82, s[12:15], s55 offen offset:128 nt
    s_waitcnt vmcnt(23)
    buffer_load_dwordx4 v[228:231], v82, s[12:15], s55 offen offset:256 nt
    s_waitcnt vmcnt(23)
    buffer_load_dwordx4 v[236:239], v82, s[12:15], s55 offen offset:384 nt
    s_waitcnt vmcnt(23)
    buffer_load_dwordx4 v[244:247], v82, s[12:15], s55 offen offset:512 nt
    s_waitcnt vmcnt(23)
    buffer_load_dwordx4 v[252:255], v82, s[12:15], s55 offen offset:640 nt
    s_branch QFRAG
HOOKF:
    v_mov_b32 v52, 98784
    ds_read_b32 v52, v52
    s_mov_b32 s6, 0
    s_waitcnt lgkmcnt(0)
    v_readfirstlane_b32 s101, v52
    s_and_b32 s50, s101, 1
    s_and_b32 s0, s101, 2
    s_lshl_b32 s0, s0, 12
    s_and_b32 s101, s101, 0xffffffe0
    s_cmp_lg_u32 s50, 0
    s_cselect_b32 s32, s62, 1610612736
    s_cselect_b32 s33, 1610612736, s62
    s_cmp_lg_u32 s50, 0
    s_cselect_b32 s34, s49, 1610612736
    s_cselect_b32 s35, 1610612736, s49
    s_add_u32 s99, s49, s0
    s_xor_b32 s1, s99, 8192
    s_waitcnt vmcnt(48)
    s_branch QK
AGENP:
    s_add_u32 s51, s51, 1
    s_cmp_lt_u32 s51, 0x8000
    s_cbranch_scc1 ENP
    s_branch OKENP
HOOKC:
    s_cmp_eq_u32 s44, 3
    s_cbranch_scc1 EXB
    v_min_u32 v83, 8, v1
    v_lshlrev_b32 v83, 7, v83
    s_mul_i32 s52, s45, 28160
    s_mul_i32 s54, s46, 1152
    s_add_u32 s52, s52, s54
    s_add_u32 s52, s52, 131072
    buffer_load_dword v83, v83, s[16:19], s52 offen sc1
    v_lshrrev_b32 v58, 3, v1
    v_and_b32 v57, 7, v1
    v_and_b32 v56, 2, v58
    v_xor_b32 v57, v57, v56
    s_and_b32 s52, s44, 1
    s_lshl_b32 s52, s52, 2
    v_xor_b32 v57, s52, v57
    v_mul_u32_u24 v56, 3072, v58
    v_lshl_add_u32 v56, v57, 4, v56
    v_lshrrev_b32 v58, 3, v1
    v_and_b32 v57, 7, v1
    v_and_b32 v55, 2, v58
    v_xor_b32 v57, v57, v55
    s_and_b32 s52, s44, 1
    s_lshl_b32 s52, s52, 2
    v_xor_b32 v57, s52, v57
    v_mul_u32_u24 v55, 1280, v58
    v_lshl_add_u32 v55, v57, 4, v55
    s_barrier
    s_cmp_ge_u32 s46, 20
    s_cbranch_scc1 HC8
    s_mul_i32 s52, s45, 983040
    s_mul_i32 s54, s56, 491520
    s_add_u32 s52, s52, s54
    s_lshl_b32 s54, s57, 7
    s_add_u32 s52, s52, s54
    s_mul_i32 s54, s44, 10240
    s_add_u32 s52, s52, s54
    s_lshl_b32 s53, s44, 10
DMA1:
    s_mov_b32 m0, s53
    s_add_u32 s53, s53, 3072
    buffer_load_dwordx4 v55, s[24:27], s52 offen nt lds
    v_xor_b32 v55, 64, v55
    s_add_u32 s52, s52, 30720
    s_cmp_lt_u32 s53, 49152
    s_cbranch_scc1 DMA1
HC8:
    s_cmp_ge_u32 s46, 30
    s_cbranch_scc1 EXB
    s_mul_i32 s52, s3, 393216
    s_mul_i32 s54, s45, 384
    s_add_u32 s52, s52, s54
    s_lshl_b32 s54, s59, 7
    s_add_u32 s52, s52, s54
    s_mul_i32 s54, s44, 24576
    s_add_u32 s52, s52, s54
    s_lshl_b32 s53, s44, 10
    s_add_u32 s53, s53, 49152
DMA2:
    s_mov_b32 m0, s53
    s_add_u32 s53, s53, 3072
    buffer_load_dwordx4 v56, s[28:31], s52 offen nt lds
    v_xor_b32 v56, 64, v56
    s_add_u32 s52, s52, 73728
    s_cmp_lt_u32 s53, 65536
    s_cbranch_scc1 DMA2
    s_branch EXB
HOOKG:
    s_cmp_lg_u32 s49, 0
    s_cbranch_scc1 WOX
    s_cmp_ge_u32 s46, 20
    s_cbranch_scc1 HOOKG3
    v_and_b32 v72, 3, v1
    v_lshlrev_b32 v72, 3, v72
    v_bfe_u32 v73, v1, 2, 2
    v_lshl_add_u32 v72, v73, 7, v72
    v_lshrrev_b32 v73, 4, v1
    v_lshl_add_u32 v72, v73, 10, v72
    v_bfe_u32 v73, v1, 3, 2
    v_lshl_add_u32 v72, v73, 5, v72
    s_mul_i32 s52, s44, 12288
    v_add_u32 v72, s52, v72
    v_xor_b32 v73, 32, v72
    v_xor_b32 v74, 64, v72
    v_xor_b32 v75, 96, v72
    s_cmp_lg_u32 s44, 3
    s_cbranch_scc1 QCNA
    v_lshlrev_b32 v38, 2, v1
    v_add_u32 v39, 109568, v38
    v_lshlrev_b32 v38, 1, v38
    ds_read_b32 v32, v39 offset:0
    ds_read_b32 v34, v39 offset:256
    ds_read_b32 v36, v39 offset:512
    s_mul_i32 s52, s47, 12288
    s_mul_i32 s54, s48, 1536
    s_add_u32 s52, s52, s54
    s_add_u32 s52, s52, 1441792
    s_cmp_lg_u32 s50, 0
    s_cselect_b32 s53, s52, 1610612736
    s_cselect_b32 s54, 1610612736, s52
    s_waitcnt lgkmcnt(0)
    v_xor_b32 v33, s101, v32
    v_xor_b32 v35, s101, v34
    v_xor_b32 v37, s101, v36
    buffer_store_dwordx2 v[32:33], v38, s[16:19], s53 offen offset:0
    buffer_store_dwordx2 v[34:35], v38, s[16:19], s53 offen offset:512
    buffer_store_dwordx2 v[36:37], v38, s[16:19], s53 offen offset:1024
    s_cmp_eq_u32 s50, 0
    s_cbranch_scc1 SLOW4
PUBD4:
    s_branch QCMA
QCNA:
    s_waitcnt vmcnt(1)
QCMA:
    s_barrier
    buffer_load_dword v56, v65, s[16:19], s62 offen sc1
    buffer_load_dwordx4 v[44:47], v64, s[16:19], s62 offen offset:0 sc1
    buffer_load_dwordx4 v[48:51], v64, s[16:19], s62 offen offset:512 sc1
    buffer_load_dwordx4 v[52:55], v64, s[16:19], s62 offen offset:1024 sc1
    buffer_load_dword v57, v66, s[16:19], s49 offen sc1
    ds_read_b64_tr_b16 v[80:81], v72 offset:0
    ds_read_b64_tr_b16 v[82:83], v72 offset:512
    ds_read_b64_tr_b16 v[96:97], v72 offset:4096
    ds_read_b64_tr_b16 v[98:99], v72 offset:4608
    ds_read_b64_tr_b16 v[112:113], v72 offset:8192
    ds_read_b64_tr_b16 v[114:115], v72 offset:8704
    ds_read_b64_tr_b16 v[84:85], v73 offset:0
    ds_read_b64_tr_b16 v[86:87], v73 offset:512
    ds_read_b64_tr_b16 v[100:101], v73 offset:4096
    ds_read_b64_tr_b16 v[102:103], v73 offset:4608
    ds_read_b64_tr_b16 v[116:117], v73 offset:8192
    ds_read_b64_tr_b16 v[118:119], v73 offset:8704
    ds_read_b64_tr_b16 v[88:89], v74 offset:0
    ds_read_b64_tr_b16 v[90:91], v74 offset:512
    ds_read_b64_tr_b16 v[104:105], v74 offset:4096
    ds_read_b64_tr_b16 v[106:107], v74 offset:4608
    ds_read_b64_tr_b16 v[120:121], v74 offset:8192
    ds_read_b64_tr_b16 v[122:123], v74 offset:8704
    ds_read_b64_tr_b16 v[92:93], v75 offset:0
    ds_read_b64_tr_b16 v[94:95], v75 offset:512
    ds_read_b64_tr_b16 v[108:109], v75 offset:4096
    ds_read_b64_tr_b16 v[110:111], v75 offset:4608
    ds_read_b64_tr_b16 v[124:125], v75 offset:8192
    ds_read_b64_tr_b16 v[126:127], v75 offset:8704
    s_waitcnt lgkmcnt(0) vmcnt(0)
    s_branch WOC
HOOKG3:
    s_cmp_lg_u32 s44, 3
    s_cbranch_scc1 QCNB
    v_lshlrev_b32 v38, 2, v1
    v_add_u32 v39, 109568, v38
    v_lshlrev_b32 v38, 1, v38
    ds_read_b32 v32, v39 offset:0
    ds_read_b32 v34, v39 offset:256
    ds_read_b32 v36, v39 offset:512
    s_mul_i32 s52, s47, 12288
    s_mul_i32 s54, s48, 1536
    s_add_u32 s52, s52, s54
    s_add_u32 s52, s52, 1441792
    s_cmp_lg_u32 s50, 0
    s_cselect_b32 s53, s52, 1610612736
    s_cselect_b32 s54, 1610612736, s52
    s_waitcnt lgkmcnt(0)
    v_xor_b32 v33, s101, v32
    v_xor_b32 v35, s101, v34
    v_xor_b32 v37, s101, v36
    buffer_store_dwordx2 v[32:33], v38, s[16:19], s53 offen offset:0
    buffer_store_dwordx2 v[34:35], v38, s[16:19], s53 offen offset:512
    buffer_store_dwordx2 v[36:37], v38, s[16:19], s53 offen offset:1024
    s_cmp_eq_u32 s50, 0
    s_cbranch_scc1 SLOW5
PUBD5:
    s_branch QCMB
QCNB:
    s_waitcnt vmcnt(1)
QCMB:
    s_barrier
    s_cmp_lg_u32 s46, 31
    s_cbranch_scc1 EW1
    s_cmp_lg_u32 s44, 0
    s_cbranch_scc1 WOX
    v_and_b32 v32, 31, v1
    v_lshlrev_b32 v32, 2, v32
    v_add_u32 v32, 19968, v32
    s_lshl_b32 s52, s45, 7
    s_add_u32 s52, s52, 118784
    v_lshlrev_b32 v34, 13, v1
EWP:
    buffer_load_dword v33, v32, s[16:19], s62 offen sc1
    s_waitcnt vmcnt(0)
    v_cmp_u_f32 vcc, v33, v33
    s_cbranch_vccz EWOK
    s_add_u32 s51, s51, 1
    s_cmp_lt_u32 s51, 0x8000
    s_cbranch_scc1 EWP
EWOK:
    s_mov_b64 exec, 3
    buffer_store_dword v34, v34, s[16:19], s52 offen sc1
    s_mov_b64 exec, -1
EW1:
    s_cmp_ge_u32 s46, 30
    s_cbranch_scc1 WOX
    s_cmp_eq_u32 s44, 3
    s_cbranch_scc1 HD0
    v_lshrrev_b32 v33, 3, v1
    v_and_b32 v32, 7, v1
    v_and_b32 v34, 2, v33
    v_xor_b32 v32, v32, v34
    s_and_b32 s52, s44, 1
    s_lshl_b32 s52, s52, 2
    v_xor_b32 v32, s52, v32
    v_mul_u32_u24 v34, 1280, v33
    v_lshl_add_u32 v34, v32, 4, v34
    s_mul_i32 s52, s45, 245760
    s_lshl_b32 s54, s57, 7
    s_add_u32 s52, s52, s54
    s_mul_i32 s54, s44, 10240
    s_add_u32 s52, s52, s54
    s_lshl_b32 s53, s44, 10
DMA3:
    s_mov_b32 m0, s53
    s_add_u32 s53, s53, 3072
    buffer_load_dwordx4 v34, s[24:27], s52 offen nt lds
    v_xor_b32 v34, 64, v34
    s_add_u32 s52, s52, 30720
    s_cmp_lt_u32 s53, 24576
    s_cbranch_scc1 DMA3
HD0:
    v_mov_b64 v[116:117], -1
    v_mov_b64 v[118:119], -1
    v_mov_b32 v23, 1879048192
    s_mul_i32 s52, s57, 5120
    s_mul_i32 s54, s44, 1280
    s_add_u32 s52, s52, s54
    v_lshl_add_u32 v120, v1, 4, s52
    s_add_u32 s52, s52, 1024
    v_lshl_add_u32 v121, v1, 2, s52
    s_lshl_b32 s52, s57, 14
    s_lshl_b32 s54, s45, 11
    s_add_u32 s52, s52, s54
    s_lshl_b32 s54, s44, 9
    s_add_u32 s52, s52, s54
    v_lshl_add_u32 v122, v1, 3, s52
    v_cmp_gt_u32 vcc, 45312, v120
    s_nop 1
    v_cndmask_b32 v120, v23, v120, vcc
    v_cmp_gt_u32 vcc, 45312, v121
    s_nop 1
    v_cndmask_b32 v121, v23, v121, vcc
    v_cmp_gt_u32 vcc, 136192, v122
    s_nop 1
    v_cndmask_b32 v122, v23, v122, vcc
    s_branch F1E
AGWOP:
    s_add_u32 s51, s51, 1
    s_cmp_lt_u32 s51, 0x8000
    s_cbranch_scc1 WOP
    s_branch OKWOP
HOOKD:
    ds_read_b128 v[20:23], v2 offset:256
    ds_read_b128 v[24:27], v2 offset:320
    ds_read_b128 v[28:31], v2 offset:384
    ds_read_b128 v[32:35], v2 offset:448
    s_waitcnt lgkmcnt(0)
    v_mfma_f32_16x16x32_bf16 v[40:43], v[20:23], v[64:67], 0
    v_mfma_f32_16x16x32_bf16 v[40:43], v[24:27], v[68:71], v[40:43]
    v_mfma_f32_16x16x32_bf16 v[40:43], v[28:31], v[72:75], v[40:43]
    v_mfma_f32_16x16x32_bf16 v[40:43], v[32:35], v[76:79], v[40:43]
    s_add_u32 s52, s62, 8192
    s_cmp_lg_u32 s50, 0
    s_cselect_b32 s53, s52, 1610612736
    s_cselect_b32 s54, 1610612736, s52
    s_nop 3
    buffer_store_dword v41, v55, s[16:19], s53 offen offset:0
    s_cmp_eq_u32 s50, 0
    s_cbranch_scc1 SLOW6
PUBD6:
    v_and_b32 v16, 7, v1
    v_lshlrev_b32 v16, 7, v16
    s_add_u32 s52, s0, 118784
EWQ:
    buffer_load_dword v17, v16, s[16:19], s52 offen sc1
    s_waitcnt vmcnt(0)
    v_cmp_u_f32 vcc, v17, v17
    s_cbranch_vccz EWQK
    s_add_u32 s51, s51, 1
    s_sleep 1
    s_cmp_lt_u32 s51, 0x8000
    s_cbranch_scc1 EWQ
EWQK:
    s_sleep 1
    s_mov_b32 s51, 0
    s_cmp_lt_u32 s46, 20
    s_cbranch_scc1 F1W
    s_mov_b32 s100, 3
    s_cmp_lg_u32 s50, 0
    s_cselect_b32 s53, s63, 1610612736
    s_cselect_b32 s54, 1610612736, s63
    buffer_store_dwordx4 v[116:119], v120, s[16:19], s53 offen offset:0
    buffer_store_dword v116, v121, s[16:19], s53 offen offset:0
    s_cmp_eq_u32 s50, 0
    s_cbranch_scc1 SLOW7
PUBD7:
    s_mov_b32 s52, 393216
    buffer_store_dwordx2 v[116:117], v122, s[16:19], s52 offen sc1
F1P:
    s_cmp_lg_u32 s100, 3
    s_cbranch_scc1 F1W
    s_add_u32 s52, s62, 8192
    buffer_load_dwordx4 v[104:107], v58, s[16:19], s52 offen offset:0 sc1
    buffer_load_dwordx4 v[108:111], v58, s[16:19], s52 offen offset:3072 sc1
    buffer_load_dwordx2 v[112:113], v59, s[16:19], s52 offen sc1
    s_branch F1W
GCP:
    s_add_u32 s52, s62, 8192
    buffer_load_dwordx4 v[104:107], v58, s[16:19], s52 offen offset:0 sc1
    buffer_load_dwordx4 v[108:111], v58, s[16:19], s52 offen offset:3072 sc1
    buffer_load_dwordx2 v[112:113], v59, s[16:19], s52 offen sc1
    s_waitcnt vmcnt(0)
HOOKI:
    v_pk_add_f32 v[104:105], v[104:105], v[106:107]
    v_pk_add_f32 v[108:109], v[108:109], v[110:111]
    v_add_f32 v126, v104, v105
    v_add_f32 v127, v108, v109
    v_pk_add_f32 v[126:127], v[126:127], v[112:113]
    v_cmp_u_f32 vcc, v126, v127
    s_cbranch_vccz GCOK
    s_add_u32 s51, s51, 1
    s_cmp_lt_u32 s51, 0x8000
    s_cbranch_scc1 GCP
GCOK:
    ds_read_b64_tr_b16 v[80:81], v57 offset:0
    ds_read_b64_tr_b16 v[82:83], v57 offset:512
    ds_read_b64_tr_b16 v[84:85], v57 offset:4096
    ds_read_b64_tr_b16 v[86:87], v57 offset:4608
    ds_read_b64_tr_b16 v[88:89], v57 offset:8192
    ds_read_b64_tr_b16 v[90:91], v57 offset:8704
    ds_read_b64_tr_b16 v[92:93], v57 offset:12288
    ds_read_b64_tr_b16 v[94:95], v57 offset:12800
    ds_read_b64_tr_b16 v[96:97], v57 offset:16384
    ds_read_b64_tr_b16 v[98:99], v57 offset:16896
    ds_read_b64_tr_b16 v[100:101], v57 offset:20480
    ds_read_b64_tr_b16 v[102:103], v57 offset:20992
    s_branch W2P
AGF1P:
    s_add_u32 s51, s51, 1
    s_sleep 1
    s_cmp_lt_u32 s51, 0x8000
    s_cbranch_scc1 F1P
    s_branch OKF1P
AGW2P:
    s_add_u32 s51, s51, 1
    s_cmp_lt_u32 s51, 0x8000
    s_cbranch_scc1 W2P
    s_branch OKW2P
AGY3P:
    s_add_u32 s51, s51, 1
    s_sleep 1
    s_cmp_lt_u32 s51, 0x8000
    s_cbranch_scc1 Y3P
    s_branch OKY3P
SLOW1:
    buffer_store_dword v30, v18, s[16:19], s35 offen offset:0 sc1
    s_branch PUBD1
SLOW2:
    buffer_store_dword v16, v14, s[16:19], s33 offen offset:0 sc1
    buffer_store_dword v20, v14, s[16:19], s33 offen offset:1024 sc1
    buffer_store_dword v24, v14, s[16:19], s33 offen offset:2048 sc1
    buffer_store_dwordx2 v[28:29], v15, s[16:19], s33 offen offset:0 sc1
    s_branch PUBD2
SLOW3:
    buffer_store_dword v24, v14, s[16:19], s33 offen offset:0 sc1
    s_branch PUBD3
SLOW4:
    buffer_store_dwordx2 v[32:33], v38, s[16:19], s54 offen offset:0 sc1
    buffer_store_dwordx2 v[34:35], v38, s[16:19], s54 offen offset:512 sc1
    buffer_store_dwordx2 v[36:37], v38, s[16:19], s54 offen offset:1024 sc1
    s_branch PUBD4
SLOW5:
    buffer_store_dwordx2 v[32:33], v38, s[16:19], s54 offen offset:0 sc1
    buffer_store_dwordx2 v[34:35], v38, s[16:19], s54 offen offset:512 sc1
    buffer_store_dwordx2 v[36:37], v38, s[16:19], s54 offen offset:1024 sc1
    s_branch PUBD5
SLOW6:
    buffer_store_dword v41, v55, s[16:19], s54 offen offset:0 sc1
    s_branch PUBD6
SLOW7:
    buffer_store_dwordx4 v[116:119], v120, s[16:19], s54 offen offset:0 sc1
    buffer_store_dword v116, v121, s[16:19], s54 offen offset:0 sc1
    s_branch PUBD7
SLOW8:
    buffer_store_dword v16, v54, s[16:19], s35 offen offset:0 sc1
    s_branch PUBD8
SLOW9:
    buffer_store_dword v40, v55, s[16:19], s33 offen offset:0 sc1
    buffer_store_dwordx2 v[36:37], v56, s[16:19], s33 offen offset:0 sc1
    s_branch PUBD9
CODEEND:
    s_endpgm
.section .rodata,"a"
.p2align 6
.amdhsa_kernel interleave_layers__sliding_block_cached__glu_gated_swiglu__decode_kernel
  .amdhsa_next_free_vgpr 512
  .amdhsa_next_free_sgpr 102
  .amdhsa_accum_offset 256
  .amdhsa_group_segment_fixed_size 0
  .amdhsa_kernarg_size 96
  .amdhsa_user_sgpr_count 2
  .amdhsa_user_sgpr_kernarg_segment_ptr 1
  .amdhsa_system_sgpr_workgroup_id_x 1
.end_amdhsa_kernel
```

```asm
; @launch grid=(256,1,1) block=(256,1,1) lds=143104
.amdgcn_target "amdgcn-amd-amdhsa--gfx950"
.text
.globl interleave_layers__sliding_block_cached__glu_gated_swiglu__decode_kernel
.p2align 8
.type interleave_layers__sliding_block_cached__glu_gated_swiglu__decode_kernel,@function
interleave_layers__sliding_block_cached__glu_gated_swiglu__decode_kernel:
    s_cmp_ge_u32 s2, 256
    s_cbranch_scc1 DONE
    s_load_dwordx16 s[64:79], s[0:1], 0
    s_load_dwordx8 s[80:87], s[0:1], 64
    s_memrealtime s[98:99]
    s_getpc_b64 s[60:61]
PCREF:
    v_lshlrev_b32 v14, 7, v0
    v_cmp_gt_u32 vcc, CODEEND-PCREF, v14
    v_mov_b32 v15, s61
    s_and_saveexec_b64 s[88:89], vcc
    s_cbranch_execz NOPF
    v_add_co_u32 v14, vcc, s60, v14
    s_nop 1
    v_addc_co_u32 v15, vcc, 0, v15, vcc
    global_load_dword v79, v[14:15], off
NOPF:
    s_mov_b64 exec, s[88:89]
    v_and_b32 v1, 63, v0
    v_lshrrev_b32 v13, 6, v0
    s_and_b32 s45, s2, 7
    v_readfirstlane_b32 s44, v13
    s_lshr_b32 s46, s2, 3
    s_lshr_b32 s7, s46, 3
    s_lshl_b32 s52, s45, 2
    s_add_u32 s47, s7, s52
    s_and_b32 s48, s46, 7
    v_lshrrev_b32 v19, 4, v1
    v_bfe_u32 v21, v1, 1, 3
    v_and_b32 v20, 1, v1
    v_mul_u32_u24 v80, 384, v21
    v_lshl_add_u32 v80, v20, 4, v80
    v_lshl_add_u32 v80, v19, 5, v80
    s_mul_i32 s52, s48, 3
    s_lshl_b32 s54, s44, 0
    s_add_u32 s52, s52, s54
    s_add_u32 s53, s48, 384
    s_cmp_eq_u32 s44, 3
    s_cselect_b32 s52, s53, s52
    s_cselect_b32 s97, 8, 24
    s_mulk_i32 s97, 3072
    s_mul_i32 s55, s47, 12582912
    s_mul_i32 s54, s52, 3072
    s_add_u32 s55, s55, s54
    s_add_u32 s55, s55, 11010048
    s_mov_b32 s96, s55
    s_waitcnt lgkmcnt(0)
    s_mov_b32 s8, s66
    s_and_b32 s9, s67, 0xffff
    s_mov_b32 s10, 402653184
    s_mov_b32 s11, 0x20000
    s_mov_b32 s6, 1
    s_mov_b32 s100, 0
    s_cmp_eq_u32 s44, 3
    s_cbranch_scc1 SETUP
    buffer_load_dwordx4 a[0:3], v80, s[8:11], s96 offen offset:0 nt
    buffer_load_dwordx4 a[8:11], v80, s[8:11], s96 offen offset:128 nt
    buffer_load_dwordx4 a[16:19], v80, s[8:11], s96 offen offset:256 nt
    s_add_u32 s96, s96, s97
    buffer_load_dwordx4 a[4:7], v80, s[8:11], s96 offen offset:0 nt
    buffer_load_dwordx4 a[12:15], v80, s[8:11], s96 offen offset:128 nt
    buffer_load_dwordx4 a[20:23], v80, s[8:11], s96 offen offset:256 nt
    s_add_u32 s96, s96, s97
SETUP:
    s_mov_b32 s16, s86
    s_and_b32 s17, s87, 0xffff
    s_mov_b32 s18, 1610612736
    s_mov_b32 s19, 0x20000
    s_mov_b32 s12, s68
    s_and_b32 s13, s69, 0xffff
    s_mov_b32 s14, 402653184
    s_mov_b32 s15, 0x20000
    s_mov_b32 s20, s70
    s_and_b32 s21, s71, 0xffff
    s_mov_b32 s22, 7864320
    s_mov_b32 s23, 0x20000
    s_mov_b32 s32, s64
    s_and_b32 s33, s65, 0xffff
    s_mov_b32 s34, 1280
    s_mov_b32 s35, 0x20000
    s_mov_b32 s36, s82
    s_and_b32 s37, s83, 0xffff
    s_mov_b32 s38, 1280
    s_mov_b32 s39, 0x20000
    s_mov_b32 s40, s84
    s_and_b32 s41, s85, 0xffff
    s_mov_b32 s42, 256
    s_mov_b32 s43, 0x20000
    v_mov_b32 v76, 1879048192
    v_mov_b32 v87, 1879048192
    v_mov_b32 v88, 1879048192
    v_mov_b32 v120, 1879048192
    v_mov_b32 v121, 1879048192
    v_mov_b32 v122, 1879048192
    s_cmp_lg_u32 s44, 3
    s_cbranch_scc1 SETUP2
    v_mov_b32 v32, -1
    v_mov_b32 v33, -1
    v_mov_b32 v34, -1
    v_mov_b32 v35, -1
    s_cmp_lg_u32 s2, 0
    s_cbranch_scc1 NONW
    s_or_b32 s101, s98, 0x20
    s_and_b32 s101, s101, 0xffffffe0
    v_mov_b32 v24, s101
    v_mov_b32 v25, 0
    s_mov_b64 exec, 1
    buffer_store_dword v24, v25, s[40:43], 0 offen sc1
    s_mov_b64 exec, -1
NONW:
    v_lshlrev_b32 v24, 4, v1
    v_lshlrev_b32 v27, 2, v1
    s_mul_i32 s52, s2, 1536
    v_lshlrev_b32 v28, 3, v1
    buffer_store_dwordx4 v[32:35], v24, s[16:19], s52 offen sc1
    buffer_store_dwordx2 v[32:33], v28, s[16:19], s52 offen offset:1024 sc1
    v_mov_b32 v26, 1879048192
    v_mov_b32 v88, v24
    v_cmp_gt_u32 vcc, 40, v1
    v_lshlrev_b32 v27, 2, v1
    buffer_load_dwordx4 v[44:47], v24, s[32:35], 0 offen
    buffer_load_dword v48, v27, s[32:35], 0 offen offset:1024
    v_cndmask_b32 v28, v26, v27, vcc
    s_mul_i32 s52, s48, 160
    buffer_load_dword v86, v28, s[32:35], s52 offen
    s_mul_i32 s52, s48, 320
    s_add_u32 s52, s52, 131072
    s_and_b32 s53, s2, 0xc7
    s_cmp_eq_u32 s53, 0
    s_cselect_b32 s52, s52, 1879048192
    v_lshl_add_u32 v87, v1, 3, s52
    v_cndmask_b32 v87, v26, v87, vcc
    v_add_u32 v24, 0, v1
    v_mul_u32_u24 v36, 171, v24
    v_lshrrev_b32 v36, 12, v36
    v_mul_u32_u24 v37, 24, v36
    v_sub_u32 v37, v24, v37
    v_and_b32 v24, 2, v36
    v_xor_b32 v37, v37, v24
    v_mul_u32_u24 v36, 12288, v36
    v_lshl_add_u32 v38, v37, 4, v36
    v_add_u32 v24, 64, v1
    v_mul_u32_u24 v36, 171, v24
    v_lshrrev_b32 v36, 12, v36
    v_mul_u32_u24 v37, 24, v36
    v_sub_u32 v37, v24, v37
    v_and_b32 v24, 2, v36
    v_xor_b32 v37, v37, v24
    v_mul_u32_u24 v36, 12288, v36
    v_lshl_add_u32 v39, v37, 4, v36
    v_add_u32 v24, 128, v1
    v_mul_u32_u24 v36, 171, v24
    v_lshrrev_b32 v36, 12, v36
    v_mul_u32_u24 v37, 24, v36
    v_sub_u32 v37, v24, v37
    v_and_b32 v24, 2, v36
    v_xor_b32 v37, v37, v24
    v_mul_u32_u24 v36, 12288, v36
    v_lshl_add_u32 v40, v37, 4, v36
    s_mul_i32 s52, s48, 983040
    s_mul_i32 s54, s47, 384
    s_add_u32 s52, s52, s54
    s_mov_b32 s53, 65536
WQL:
    s_add_u32 m0, s53, 0
    s_nop 0
    buffer_load_dwordx4 v38, s[20:23], s52 offen nt lds
    v_xor_b32 v38, 64, v38
    s_add_u32 m0, s53, 1024
    s_nop 0
    buffer_load_dwordx4 v39, s[20:23], s52 offen nt lds
    v_xor_b32 v39, 64, v39
    s_add_u32 m0, s53, 2048
    s_nop 0
    buffer_load_dwordx4 v40, s[20:23], s52 offen nt lds
    v_xor_b32 v40, 64, v40
    s_add_u32 s52, s52, 98304
    s_add_u32 s53, s53, 3072
    s_cmp_lt_u32 s53, 96256
    s_cbranch_scc1 WQL
    v_mov_b32 v37, 0
    buffer_load_dword v89, v37, s[40:43], 0 offen sc1
    s_barrier
    s_waitcnt vmcnt(31)
    v_mov_b32 v36, 0x3f803f80
    v_mov_b32 v37, v36
    v_cndmask_b32 v36, 0, v36, vcc
    v_add_u32 v27, 96256, v27
    ds_write_b32 v27, v36 offset:1152
    ds_write_b32 v27, v37 offset:1408
    ds_write_b32 v27, v86
    v_mov_b64 v[36:37], 0
    ds_write_b32 v27, v36 offset:12800
    ds_write_b32 v27, v36 offset:13056
    v_mov_b32 v38, 0x3f803f80
    v_dot2_f32_bf16 v36, v44, v44, v36
    v_dot2_f32_bf16 v37, v44, v38, v37
    v_dot2_f32_bf16 v36, v45, v45, v36
    v_dot2_f32_bf16 v37, v45, v38, v37
    v_dot2_f32_bf16 v36, v46, v46, v36
    v_dot2_f32_bf16 v37, v46, v38, v37
    v_dot2_f32_bf16 v36, v47, v47, v36
    v_dot2_f32_bf16 v37, v47, v38, v37
    v_dot2_f32_bf16 v36, v48, v48, v36
    v_dot2_f32_bf16 v37, v48, v38, v37
    s_nop 2
    v_add_f32_dpp v36, v36, v36 quad_perm:[1,0,3,2] row_mask:0xf bank_mask:0xf
    v_add_f32_dpp v37, v37, v37 quad_perm:[1,0,3,2] row_mask:0xf bank_mask:0xf
    s_nop 0
    v_add_f32_dpp v36, v36, v36 quad_perm:[2,3,0,1] row_mask:0xf bank_mask:0xf
    v_add_f32_dpp v37, v37, v37 quad_perm:[2,3,0,1] row_mask:0xf bank_mask:0xf
    s_nop 0
    v_add_f32_dpp v36, v36, v36 row_half_mirror row_mask:0xf bank_mask:0xf
    v_add_f32_dpp v37, v37, v37 row_half_mirror row_mask:0xf bank_mask:0xf
    s_nop 0
    v_add_f32_dpp v36, v36, v36 row_mirror row_mask:0xf bank_mask:0xf
    v_add_f32_dpp v37, v37, v37 row_mirror row_mask:0xf bank_mask:0xf
    s_nop 0
    v_mov_b32 v39, v36
    s_nop 1
    v_permlane16_swap_b32 v36, v39
    v_add_f32 v36, v36, v39
    v_mov_b32 v39, v37
    s_nop 1
    v_permlane16_swap_b32 v37, v39
    v_add_f32 v37, v37, v39
    v_mov_b32 v39, v36
    s_nop 1
    v_permlane32_swap_b32 v36, v39
    v_add_f32 v36, v36, v39
    v_mov_b32 v39, v37
    s_nop 1
    v_permlane32_swap_b32 v37, v39
    v_add_f32 v37, v37, v39
    v_mov_b32 v39, 0x3727c5ac
    v_mul_f32 v37, 0x3acccccd, v37
    v_fmamk_f32 v36, v36, 0x3acccccd, v39
    v_fma_f32 v36, -v37, v37, v36
    v_rsq_f32 v36, abs(v36)
    v_mov_b32 v84, v37
    v_mul_f32 v85, 0x3dd53b94, v36
SETUP2:
    s_cmp_ge_u32 s46, 10
    s_cselect_b32 s56, 1, 0
    s_cmp_ge_u32 s46, 20
    s_cselect_b32 s52, 2, s56
    s_mul_i32 s52, s52, 10
    s_sub_u32 s57, s46, s52
    s_min_u32 s4, s46, 29
    s_cmp_ge_u32 s4, 15
    s_cselect_b32 s58, 1, 0
    s_mul_i32 s52, s58, 15
    s_sub_u32 s52, s4, s52
    s_mul_i32 s59, s52, 52
    s_lshr_b32 s59, s59, 8
    s_mul_i32 s53, s59, 5
    s_sub_u32 s3, s52, s53
    s_cmp_ge_u32 s46, 20
    s_cselect_b32 s24, s80, s72
    s_cselect_b32 s25, s81, s73
    s_mov_b32 s26, 7864320
    s_cselect_b32 s26, 1966080, s26
    s_and_b32 s25, s25, 0xffff
    s_mov_b32 s27, 0x20000
    s_cmp_eq_u32 s58, 1
    s_cselect_b32 s28, s78, s76
    s_cselect_b32 s29, s79, s77
    s_and_b32 s29, s29, 0xffff
    s_mov_b32 s30, 1966080
    s_mov_b32 s31, 0x20000
    s_mov_b32 s49, 0
    s_mul_i32 s63, s45, 45312
    s_add_u32 s63, s63, 529408
    s_mul_i32 s62, s45, 28160
    s_add_u32 s62, s62, 136192
    s_mov_b32 s50, 0
    s_mov_b32 s0, 0
    v_and_b32 v24, 15, v1
    v_cmp_eq_u32 vcc, 1, v24
    v_mov_b32 v25, 96256
    v_mov_b32 v26, 97408
    v_cndmask_b32 v2, v25, v26, vcc
    v_lshl_add_u32 v2, v19, 4, v2
    v_and_b32 v24, 3, v1
    v_lshlrev_b32 v24, 4, v24
    v_and_b32 v25, 1, v19
    v_lshl_add_u32 v24, v25, 6, v24
    v_add_u32 v24, 98304, v24
    v_bfe_u32 v25, v1, 2, 2
    v_lshrrev_b32 v27, 5, v1
    v_sub_u32 v25, v25, v27
    v_mov_b32 v26, 109184
    v_cmp_eq_u32 vcc, 0, v25
    s_nop 1
    v_cndmask_b32 v3, v26, v24, vcc
    v_cmp_eq_u32 vcc, 2, v25
    s_nop 1
    v_cndmask_b32 v4, v26, v24, vcc
    v_and_b32 v24, 3, v1
    v_cmp_eq_u32 vcc, 3, v24
    v_mov_b32 v25, 0xffff
    v_mov_b32 v26, 0xffff0000
    v_cndmask_b32 v25, v25, v26, vcc
    v_cndmask_b32 v24, v24, 0, vcc
    v_or_b32 v24, 12, v24
    v_mul_u32_u24 v24, 0x1111, v24
    v_bfe_u32 v26, v1, 1, 1
    v_mul_u32_u24 v26, 0xaaaa, v26
    v_add_u32 v26, 0x4444, v26
    v_lshl_add_u32 v7, v24, 16, v26
    v_and_b32 v24, 4, v1
    v_cmp_eq_u32 vcc, 0, v24
    s_nop 1
    v_cndmask_b32 v5, 0, v25, vcc
    v_cndmask_b32 v6, v25, 0, vcc
    v_mul_u32_u24 v82, s97, v27
    v_bfe_u32 v24, v1, 3, 1
    v_mul_u32_u24 v24, 1536, v24
    v_add_u32 v82, v82, v24
    v_and_b32 v24, 1, v19
    v_mul_u32_u24 v24, 768, v24
    v_add_u32 v82, v82, v24
    v_and_b32 v24, 7, v1
    v_lshl_add_u32 v82, v24, 4, v82
    s_mul_i32 s52, s7, 6144
    s_add_u32 s52, s52, 20480
    v_lshl_add_u32 v8, v0, 4, s52
    s_lshl_b32 s52, s7, 6
    s_add_u32 s52, s52, 45056
    v_lshl_add_u32 v9, v24, 3, s52
    v_and_b32 v10, 0xe1, v0
    v_lshlrev_b32 v10, 1, v10
    v_bfe_u32 v24, v0, 4, 1
    v_lshl_add_u32 v10, v24, 3, v10
    v_bfe_u32 v24, v0, 3, 1
    v_lshl_add_u32 v10, v24, 4, v10
    v_bfe_u32 v24, v0, 2, 1
    v_lshl_add_u32 v10, v24, 2, v10
    v_bfe_u32 v24, v0, 1, 1
    v_lshl_add_u32 v10, v24, 5, v10
    v_add_u32 v10, 98304, v10
    v_mov_b32 v11, 0x3727c5ac
    v_lshlrev_b32 v12, 4, v0
    v_add_u32 v12, 110336, v12
    s_cmp_lg_u32 s44, 3
    s_cbranch_scc1 KBAR
    s_lshr_b32 s53, s2, 4
    s_and_b32 s51, s2, 15
    s_lshl_b32 s52, s53, 14
    s_lshl_b32 s54, s51, 9
    s_add_u32 s52, s52, s54
    s_add_u32 s52, s52, 1835008
    s_and_b32 s53, s46, 1
    s_lshl_b32 s53, s53, 13
    s_add_u32 s52, s52, s53
    s_xor_b32 s53, s52, 8192
    s_memtime s[88:89]
    s_waitcnt lgkmcnt(0)
    s_buffer_load_dword s1, s[16:19], s52
    s_waitcnt lgkmcnt(0)
    s_memtime s[90:91]
    s_waitcnt lgkmcnt(0)
    s_buffer_load_dword s1, s[16:19], s53
    s_waitcnt lgkmcnt(0)
    s_memtime s[92:93]
    s_waitcnt lgkmcnt(0)
    s_sub_u32 s88, s90, s88
    s_sub_u32 s90, s92, s90
    s_cmp_lt_u32 s90, s88
    s_cselect_b32 s1, 1, 0
    s_xor_b32 s1, s1, s46
    s_getreg_b32 s52, hwreg(HW_REG_XCC_ID)
    s_lshr_b32 s52, s52, 2
    s_xor_b32 s1, s1, s52
    s_and_b32 s1, s1, 1
    s_lshl_b32 s1, s1, 4
    s_mov_b32 s51, 0
    v_mov_b32 v37, 0
NOP:
    s_waitcnt vmcnt(0)
    v_readfirstlane_b32 s5, v89
    s_cmp_lg_u32 s5, 0
    s_cbranch_scc1 NOOK
    buffer_load_dword v89, v37, s[40:43], 0 offen sc1
    s_add_u32 s51, s51, 1
    s_sleep 4
    s_cmp_lt_u32 s51, 0x8000
    s_cbranch_scc1 NOP
NOOK:
    s_getreg_b32 s52, hwreg(HW_REG_XCC_ID)
    s_and_b32 s52, s52, 15
    s_or_b32 s5, s5, s52
    s_or_b32 s1, s1, s5
    v_mov_b32 v36, s1
    s_lshl_b32 s52, s45, 7
    s_lshl_b32 s54, s46, 2
    s_add_u32 s52, s52, s54
    s_add_u32 s52, s52, 1376256
    s_mov_b64 exec, 1
    buffer_store_dword v36, v37, s[16:19], s52 offen sc1
    s_mov_b64 exec, -1
    s_mov_b32 s44, 0
    s_branch Q0L
KBAR:
    s_barrier
    s_waitcnt vmcnt(7)
    buffer_load_dwordx4 a[24:27], v80, s[8:11], s96 offen offset:0 nt
    s_waitcnt vmcnt(7)
    buffer_load_dwordx4 a[32:35], v80, s[8:11], s96 offen offset:128 nt
    s_waitcnt vmcnt(7)
    buffer_load_dwordx4 a[40:43], v80, s[8:11], s96 offen offset:256 nt
    s_add_u32 s96, s96, s97
    s_waitcnt vmcnt(7)
    buffer_load_dwordx4 a[28:31], v80, s[8:11], s96 offen offset:0 nt
    s_waitcnt vmcnt(7)
    buffer_load_dwordx4 a[36:39], v80, s[8:11], s96 offen offset:128 nt
    s_waitcnt vmcnt(7)
    buffer_load_dwordx4 a[44:47], v80, s[8:11], s96 offen offset:256 nt
    s_add_u32 s96, s96, s97
    s_waitcnt vmcnt(7)
    buffer_load_dwordx4 a[48:51], v80, s[8:11], s96 offen offset:0 nt
    s_waitcnt vmcnt(7)
    buffer_load_dwordx4 a[56:59], v80, s[8:11], s96 offen offset:128 nt
    s_waitcnt vmcnt(7)
    buffer_load_dwordx4 a[64:67], v80, s[8:11], s96 offen offset:256 nt
    s_add_u32 s96, s96, s97
    s_waitcnt vmcnt(7)
    buffer_load_dwordx4 a[52:55], v80, s[8:11], s96 offen offset:0 nt
    s_waitcnt vmcnt(7)
    buffer_load_dwordx4 a[60:63], v80, s[8:11], s96 offen offset:128 nt
    s_waitcnt vmcnt(7)
    buffer_load_dwordx4 a[68:71], v80, s[8:11], s96 offen offset:256 nt
    s_add_u32 s96, s96, s97
    s_waitcnt vmcnt(7)
    buffer_load_dwordx4 a[72:75], v80, s[8:11], s96 offen offset:0 nt
    s_waitcnt vmcnt(7)
    buffer_load_dwordx4 a[80:83], v80, s[8:11], s96 offen offset:128 nt
    s_waitcnt vmcnt(7)
    buffer_load_dwordx4 a[88:91], v80, s[8:11], s96 offen offset:256 nt
    s_add_u32 s96, s96, s97
    s_waitcnt vmcnt(7)
    buffer_load_dwordx4 a[76:79], v80, s[8:11], s96 offen offset:0 nt
    s_waitcnt vmcnt(7)
    buffer_load_dwordx4 a[84:87], v80, s[8:11], s96 offen offset:128 nt
    s_waitcnt vmcnt(7)
    buffer_load_dwordx4 a[92:95], v80, s[8:11], s96 offen offset:256 nt
    s_add_u32 s96, s96, s97
    s_waitcnt vmcnt(7)
    buffer_load_dwordx4 a[96:99], v80, s[8:11], s96 offen offset:0 nt
    s_waitcnt vmcnt(7)
    buffer_load_dwordx4 a[104:107], v80, s[8:11], s96 offen offset:128 nt
    s_waitcnt vmcnt(7)
    buffer_load_dwordx4 a[112:115], v80, s[8:11], s96 offen offset:256 nt
    s_add_u32 s96, s96, s97
    s_waitcnt vmcnt(7)
    buffer_load_dwordx4 a[100:103], v80, s[8:11], s96 offen offset:0 nt
    s_waitcnt vmcnt(7)
    buffer_load_dwordx4 a[108:111], v80, s[8:11], s96 offen offset:128 nt
    s_waitcnt vmcnt(7)
    buffer_load_dwordx4 a[116:119], v80, s[8:11], s96 offen offset:256 nt
    s_add_u32 s96, s96, s97
    s_waitcnt vmcnt(7)
    buffer_load_dwordx4 a[120:123], v80, s[8:11], s96 offen offset:0 nt
    s_waitcnt vmcnt(7)
    buffer_load_dwordx4 a[128:131], v80, s[8:11], s96 offen offset:128 nt
    s_waitcnt vmcnt(7)
    buffer_load_dwordx4 a[136:139], v80, s[8:11], s96 offen offset:256 nt
    s_add_u32 s96, s96, s97
    s_waitcnt vmcnt(7)
    buffer_load_dwordx4 a[124:127], v80, s[8:11], s96 offen offset:0 nt
    s_waitcnt vmcnt(7)
    buffer_load_dwordx4 a[132:135], v80, s[8:11], s96 offen offset:128 nt
    s_waitcnt vmcnt(7)
    buffer_load_dwordx4 a[140:143], v80, s[8:11], s96 offen offset:256 nt
    s_add_u32 s96, s96, s97
    s_waitcnt vmcnt(7)
    buffer_load_dwordx4 a[144:147], v80, s[8:11], s96 offen offset:0 nt
    s_waitcnt vmcnt(7)
    buffer_load_dwordx4 a[152:155], v80, s[8:11], s96 offen offset:128 nt
    s_waitcnt vmcnt(7)
    buffer_load_dwordx4 a[160:163], v80, s[8:11], s96 offen offset:256 nt
    s_add_u32 s96, s96, s97
    s_waitcnt vmcnt(7)
    buffer_load_dwordx4 a[148:151], v80, s[8:11], s96 offen offset:0 nt
    s_waitcnt vmcnt(7)
    buffer_load_dwordx4 a[156:159], v80, s[8:11], s96 offen offset:128 nt
    s_waitcnt vmcnt(7)
    buffer_load_dwordx4 a[164:167], v80, s[8:11], s96 offen offset:256 nt
    s_add_u32 s96, s96, s97
    s_waitcnt vmcnt(7)
    buffer_load_dwordx4 a[168:171], v80, s[8:11], s96 offen offset:0 nt
    s_waitcnt vmcnt(7)
    buffer_load_dwordx4 a[176:179], v80, s[8:11], s96 offen offset:128 nt
    s_waitcnt vmcnt(7)
    buffer_load_dwordx4 a[184:187], v80, s[8:11], s96 offen offset:256 nt
    s_add_u32 s96, s96, s97
    s_waitcnt vmcnt(7)
    buffer_load_dwordx4 a[172:175], v80, s[8:11], s96 offen offset:0 nt
    s_waitcnt vmcnt(7)
    buffer_load_dwordx4 a[180:183], v80, s[8:11], s96 offen offset:128 nt
    s_waitcnt vmcnt(7)
    buffer_load_dwordx4 a[188:191], v80, s[8:11], s96 offen offset:256 nt
    s_lshl_b32 s97, s97, 1
    s_waitcnt vmcnt(7)
    buffer_load_dwordx4 a[192:195], v82, s[12:15], s55 offen offset:0 nt
    s_waitcnt vmcnt(7)
    buffer_load_dwordx4 a[200:203], v82, s[12:15], s55 offen offset:128 nt
    s_waitcnt vmcnt(7)
    buffer_load_dwordx4 a[208:211], v82, s[12:15], s55 offen offset:256 nt
    s_waitcnt vmcnt(7)
    buffer_load_dwordx4 a[216:219], v82, s[12:15], s55 offen offset:384 nt
    s_waitcnt vmcnt(7)
    buffer_load_dwordx4 a[224:227], v82, s[12:15], s55 offen offset:512 nt
    s_waitcnt vmcnt(7)
    buffer_load_dwordx4 a[232:235], v82, s[12:15], s55 offen offset:640 nt
    s_add_u32 s55, s55, s97
    s_waitcnt vmcnt(7)
    buffer_load_dwordx4 a[196:199], v82, s[12:15], s55 offen offset:0 nt
    s_waitcnt vmcnt(7)
    buffer_load_dwordx4 a[204:207], v82, s[12:15], s55 offen offset:128 nt
    s_waitcnt vmcnt(7)
    buffer_load_dwordx4 a[212:215], v82, s[12:15], s55 offen offset:256 nt
    s_waitcnt vmcnt(7)
    buffer_load_dwordx4 a[220:223], v82, s[12:15], s55 offen offset:384 nt
    s_waitcnt vmcnt(7)
    buffer_load_dwordx4 a[228:231], v82, s[12:15], s55 offen offset:512 nt
    s_waitcnt vmcnt(7)
    buffer_load_dwordx4 a[236:239], v82, s[12:15], s55 offen offset:640 nt
    s_add_u32 s55, s55, s97
    s_waitcnt vmcnt(7)
    buffer_load_dwordx4 a[240:243], v82, s[12:15], s55 offen offset:0 nt
    s_waitcnt vmcnt(7)
    buffer_load_dwordx4 a[248:251], v82, s[12:15], s55 offen offset:128 nt
    s_waitcnt vmcnt(7)
    buffer_load_dwordx4 v[128:131], v82, s[12:15], s55 offen offset:256 nt
    s_waitcnt vmcnt(7)
    buffer_load_dwordx4 v[136:139], v82, s[12:15], s55 offen offset:384 nt
    s_waitcnt vmcnt(7)
    buffer_load_dwordx4 v[144:147], v82, s[12:15], s55 offen offset:512 nt
    s_waitcnt vmcnt(7)
    buffer_load_dwordx4 v[152:155], v82, s[12:15], s55 offen offset:640 nt
    s_add_u32 s55, s55, s97
    s_waitcnt vmcnt(7)
    buffer_load_dwordx4 a[244:247], v82, s[12:15], s55 offen offset:0 nt
    s_waitcnt vmcnt(7)
    buffer_load_dwordx4 a[252:255], v82, s[12:15], s55 offen offset:128 nt
    s_waitcnt vmcnt(7)
    buffer_load_dwordx4 v[132:135], v82, s[12:15], s55 offen offset:256 nt
    s_waitcnt vmcnt(7)
    buffer_load_dwordx4 v[140:143], v82, s[12:15], s55 offen offset:384 nt
    s_waitcnt vmcnt(7)
    buffer_load_dwordx4 v[148:151], v82, s[12:15], s55 offen offset:512 nt
    s_waitcnt vmcnt(7)
    buffer_load_dwordx4 v[156:159], v82, s[12:15], s55 offen offset:640 nt
    s_add_u32 s55, s55, s97
    s_waitcnt vmcnt(7)
    buffer_load_dwordx4 v[160:163], v82, s[12:15], s55 offen offset:0 nt
    s_waitcnt vmcnt(7)
    buffer_load_dwordx4 v[168:171], v82, s[12:15], s55 offen offset:128 nt
    s_waitcnt vmcnt(7)
    buffer_load_dwordx4 v[176:179], v82, s[12:15], s55 offen offset:256 nt
    s_waitcnt vmcnt(7)
    buffer_load_dwordx4 v[184:187], v82, s[12:15], s55 offen offset:384 nt
    s_waitcnt vmcnt(7)
    buffer_load_dwordx4 v[192:195], v82, s[12:15], s55 offen offset:512 nt
    s_waitcnt vmcnt(7)
    buffer_load_dwordx4 v[200:203], v82, s[12:15], s55 offen offset:640 nt
    s_add_u32 s55, s55, s97
    s_waitcnt vmcnt(7)
    buffer_load_dwordx4 v[164:167], v82, s[12:15], s55 offen offset:0 nt
    s_waitcnt vmcnt(7)
    buffer_load_dwordx4 v[172:175], v82, s[12:15], s55 offen offset:128 nt
    s_waitcnt vmcnt(7)
    buffer_load_dwordx4 v[180:183], v82, s[12:15], s55 offen offset:256 nt
    s_waitcnt vmcnt(7)
    buffer_load_dwordx4 v[188:191], v82, s[12:15], s55 offen offset:384 nt
    s_waitcnt vmcnt(7)
    buffer_load_dwordx4 v[196:199], v82, s[12:15], s55 offen offset:512 nt
    s_waitcnt vmcnt(7)
    buffer_load_dwordx4 v[204:207], v82, s[12:15], s55 offen offset:640 nt
    s_add_u32 s55, s55, s97
    s_waitcnt vmcnt(7)
    buffer_load_dwordx4 v[208:211], v82, s[12:15], s55 offen offset:0 nt
    s_waitcnt vmcnt(7)
    buffer_load_dwordx4 v[216:219], v82, s[12:15], s55 offen offset:128 nt
    s_waitcnt vmcnt(7)
    buffer_load_dwordx4 v[224:227], v82, s[12:15], s55 offen offset:256 nt
    s_waitcnt vmcnt(7)
    buffer_load_dwordx4 v[232:235], v82, s[12:15], s55 offen offset:384 nt
    s_waitcnt vmcnt(7)
    buffer_load_dwordx4 v[240:243], v82, s[12:15], s55 offen offset:512 nt
    s_waitcnt vmcnt(7)
    buffer_load_dwordx4 v[248:251], v82, s[12:15], s55 offen offset:640 nt
    s_add_u32 s55, s55, s97
    s_waitcnt vmcnt(7)
    buffer_load_dwordx4 v[212:215], v82, s[12:15], s55 offen offset:0 nt
    s_waitcnt vmcnt(7)
    buffer_load_dwordx4 v[220:223], v82, s[12:15], s55 offen offset:128 nt
    s_waitcnt vmcnt(7)
    buffer_load_dwordx4 v[228:231], v82, s[12:15], s55 offen offset:256 nt
    s_barrier
    s_waitcnt vmcnt(7)
    buffer_load_dwordx4 v[236:239], v82, s[12:15], s55 offen offset:384 nt
    s_waitcnt vmcnt(7)
    buffer_load_dwordx4 v[244:247], v82, s[12:15], s55 offen offset:512 nt
    s_waitcnt vmcnt(7)
    buffer_load_dwordx4 v[252:255], v82, s[12:15], s55 offen offset:640 nt
    s_branch TABLES
LOOP:
    ds_read_b128 v[14:17], v12 offset:24576
    ds_read_b128 v[18:21], v12 offset:28672
    s_mov_b32 s55, s99
    s_mov_b32 s51, 0
    s_cmp_lg_u32 s49, 0
    s_cbranch_scc1 FINAL
    s_waitcnt lgkmcnt(0)
QTR:
    ds_read_b64_tr_b16 v[44:45], v19 offset:0
    ds_read_b64_tr_b16 v[46:47], v19 offset:1536
    ds_read_b64_tr_b16 v[56:57], v19 offset:128
    ds_read_b64_tr_b16 v[58:59], v19 offset:1664
    ds_read_b64_tr_b16 v[68:69], v19 offset:256
    ds_read_b64_tr_b16 v[70:71], v19 offset:1792
    ds_read_b64_tr_b16 v[48:49], v19 offset:12288
    ds_read_b64_tr_b16 v[50:51], v19 offset:13824
    ds_read_b64_tr_b16 v[60:61], v19 offset:12416
    ds_read_b64_tr_b16 v[62:63], v19 offset:13952
    ds_read_b64_tr_b16 v[72:73], v19 offset:12544
    ds_read_b64_tr_b16 v[74:75], v19 offset:14080
    ds_read_b64_tr_b16 v[52:53], v20 offset:24576
    ds_read_b64_tr_b16 v[54:55], v20 offset:26112
    ds_read_b64_tr_b16 v[64:65], v20 offset:24704
    ds_read_b64_tr_b16 v[66:67], v20 offset:26240
    ds_read_b64_tr_b16 v[76:77], v20 offset:24832
    ds_read_b64_tr_b16 v[78:79], v20 offset:26368
    s_cmp_lg_u32 s6, 0
    s_cbranch_scc1 QA0
    s_mov_b32 s96, s62
    s_mov_b32 s49, 393216
    s_mov_b32 s62, s63
    s_cmp_lg_u32 s50, 0
    s_cselect_b32 s32, s62, 1610612736
    s_cselect_b32 s33, 1610612736, s62
    s_cmp_lg_u32 s50, 0
    s_cselect_b32 s34, s49, 1610612736
    s_cselect_b32 s35, 1610612736, s49
    s_add_u32 s99, s49, s0
    s_xor_b32 s1, s99, 8192
    s_cmp_eq_u32 s44, 3
    s_cbranch_scc1 QX
    s_sub_u32 s52, s46, 20
    s_cmp_ge_u32 s52, 10
    s_cbranch_scc1 HOOKL
    v_lshlrev_b32 v30, 3, v0
    s_mul_i32 s52, s47, 12288
    s_add_u32 s52, s52, 1441792
    s_add_u32 s53, s52, 0
    buffer_load_dwordx2 v[32:33], v30, s[16:19], s53 offen offset:0 sc1
    buffer_load_dwordx2 v[34:35], v30, s[16:19], s53 offen offset:1536 sc1
    s_add_u32 s53, s52, 3072
    buffer_load_dwordx2 v[36:37], v30, s[16:19], s53 offen offset:0 sc1
    buffer_load_dwordx2 v[38:39], v30, s[16:19], s53 offen offset:1536 sc1
    s_add_u32 s53, s52, 6144
    buffer_load_dwordx2 v[40:41], v30, s[16:19], s53 offen offset:0 sc1
    buffer_load_dwordx2 v[42:43], v30, s[16:19], s53 offen offset:1536 sc1
    s_add_u32 s53, s52, 9216
    buffer_load_dwordx2 v[26:27], v30, s[16:19], s53 offen offset:0 sc1
    buffer_load_dwordx2 v[28:29], v30, s[16:19], s53 offen offset:1536 sc1
    s_sleep 5
GYB:
    buffer_load_dword v22, v16, s[16:19], s55 offen offset:0 sc1
    buffer_load_dword v23, v16, s[16:19], s55 offen offset:128 sc1
    buffer_load_dword v24, v16, s[16:19], s55 offen offset:256 sc1
    buffer_load_dword v25, v16, s[16:19], s55 offen offset:384 sc1
    s_waitcnt vmcnt(4)
QCP:
    v_bitop3_b32 v33, v32, v33, s101 bitop3:0x96
    v_bitop3_b32 v35, v34, v35, s101 bitop3:0x96
    v_bitop3_b32 v37, v36, v37, s101 bitop3:0x96
    v_bitop3_b32 v39, v38, v39, s101 bitop3:0x96
    v_bitop3_b32 v41, v40, v41, s101 bitop3:0x96
    v_bitop3_b32 v43, v42, v43, s101 bitop3:0x96
    v_bitop3_b32 v27, v26, v27, s101 bitop3:0x96
    v_bitop3_b32 v29, v28, v29, s101 bitop3:0x96
    v_add_f32 v13, v32, v34
    v_add_f32 v13, v13, v36
    v_add_f32 v13, v13, v38
    v_add_f32 v13, v13, v40
    v_add_f32 v13, v13, v42
    v_add_f32 v13, v13, v26
    v_add_f32 v13, v13, v28
    v_or3_b32 v33, v33, v35, v37
    v_or3_b32 v33, v33, v39, v41
    v_or3_b32 v33, v33, v43, v27
    v_or_b32 v33, v33, v29
    v_cmp_ne_u32 vcc, 0, v33
    s_cbranch_vccnz QCA
Y2W:
    s_waitcnt vmcnt(0)
    v_pk_add_f32 v[22:23], v[22:23], v[24:25]
    v_add_f32 v30, v22, v23
    v_mov_b32 v31, v30
    s_nop 1
    v_permlane32_swap_b32 v30, v31
    v_add_f32 v30, v30, v31
    v_cmp_u_f32 vcc, v30, v30
    v_cvt_pk_bf16_f32 v30, v30, v30
    ds_write_b16 v17, v30
    s_cbranch_vccnz AGY2P
OKY2P:
    v_and_b32 v30, 0xffff0000, v30
    buffer_store_dword v30, v18, s[16:19], s34 offen offset:0
    s_cmp_eq_u32 s50, 0
    s_cbranch_scc1 SLOW1
PUBD1:
QX:
    s_waitcnt lgkmcnt(0)
    s_barrier
QA0:
    ds_read_b128 v[32:35], v2 offset:0
    ds_read_b128 v[36:39], v2 offset:64
    ds_read_b128 v[40:43], v2 offset:128
    s_cmp_lg_u32 s6, 0
    s_waitcnt lgkmcnt(2)
    v_mfma_f32_16x16x32_bf16 v[28:31], v[32:35], v[32:35], 0
    v_mfma_f32_16x16x32_bf16 v[16:19], v[32:35], v[44:47], 0
    v_mfma_f32_16x16x32_bf16 v[20:23], v[32:35], v[56:59], 0
    v_mfma_f32_16x16x32_bf16 v[24:27], v[32:35], v[68:71], 0
    s_waitcnt lgkmcnt(1)
    v_mfma_f32_16x16x32_bf16 v[28:31], v[36:39], v[36:39], v[28:31]
    v_mfma_f32_16x16x32_bf16 v[16:19], v[36:39], v[48:51], v[16:19]
    v_mfma_f32_16x16x32_bf16 v[20:23], v[36:39], v[60:63], v[20:23]
    v_mfma_f32_16x16x32_bf16 v[24:27], v[36:39], v[72:75], v[24:27]
    s_waitcnt lgkmcnt(0)
    v_mfma_f32_16x16x32_bf16 v[16:19], v[40:43], v[52:55], v[16:19]
    v_mfma_f32_16x16x32_bf16 v[20:23], v[40:43], v[64:67], v[20:23]
    v_mfma_f32_16x16x32_bf16 v[24:27], v[40:43], v[76:79], v[24:27]
    v_mfma_f32_16x16x32_bf16 v[28:31], v[40:43], v[40:43], v[28:31]
    s_cbranch_scc1 HOOKA
    v_mov_b64 v[64:65], 0
    v_mov_b64 v[66:67], 0
    v_mov_b64 v[68:69], 0
    v_mov_b64 v[70:71], 0
    buffer_store_dword v16, v14, s[16:19], s32 offen offset:0
    buffer_store_dword v20, v14, s[16:19], s32 offen offset:1024
    buffer_store_dword v24, v14, s[16:19], s32 offen offset:2048
    buffer_store_dwordx2 v[28:29], v15, s[16:19], s32 offen offset:0
    s_cmp_eq_u32 s50, 0
    s_cbranch_scc1 SLOW2
PUBD2:
    ds_read_b64 v[14:15], v12 offset:0
    ds_read_b64 v[60:61], v12 offset:8
    s_cmp_eq_u32 s44, 3
    s_cbranch_scc1 EN3
    v_mov_b32 v36, v36
    v_mov_b32 v36, v36
    v_mov_b32 v36, v36
    v_mov_b32 v36, v36
    v_mov_b32 v36, v36
    v_mov_b32 v36, v36
    v_mov_b32 v36, v36
    v_mov_b32 v36, v36
    v_mov_b32 v36, v36
    v_mov_b32 v36, v36
    v_mov_b32 v36, v36
    v_mov_b32 v36, v36
    v_mov_b32 v36, v36
    v_mov_b32 v36, v36
    v_mov_b32 v36, v36
    v_mov_b32 v36, v36
    v_mov_b32 v36, v36
    v_mov_b32 v36, v36
    v_mov_b32 v36, v36
    v_mov_b32 v36, v36
    v_mov_b32 v36, v36
    v_mov_b32 v36, v36
    v_mov_b32 v36, v36
    v_mov_b32 v36, v36
    v_mov_b32 v36, v36
    v_mov_b32 v36, v36
    v_mov_b32 v36, v36
    v_mov_b32 v36, v36
    v_mov_b32 v36, v36
    v_mov_b32 v36, v36
    v_mov_b32 v36, v36
    v_mov_b32 v36, v36
    buffer_load_dwordx2 v[62:63], v9, s[16:19], s62 offen sc1
    buffer_load_dwordx4 v[52:55], v8, s[16:19], s62 offen offset:0 sc1
    buffer_load_dwordx4 v[56:59], v8, s[16:19], s62 offen offset:3072 sc1
    v_mov_b64 v[72:73], 0
    v_mov_b64 v[74:75], 0
    v_mov_b64 v[76:77], 0
    v_mov_b64 v[78:79], 0
    v_mov_b64 v[40:41], 0
    v_mov_b64 v[42:43], 0
    v_mov_b64 v[44:45], 0
    v_mov_b64 v[46:47], 0
    v_mov_b64 v[48:49], 0
    v_mov_b64 v[50:51], 0
    s_mov_b32 s51, 0
    v_mov_b32 v36, v36
    v_mov_b32 v36, v36
    v_mov_b32 v36, v36
    v_mov_b32 v36, v36
    v_mov_b32 v36, v36
    v_mov_b32 v36, v36
    v_mov_b32 v36, v36
    v_mov_b32 v36, v36
    v_mov_b32 v36, v36
    v_mov_b32 v36, v36
ENP:
    buffer_load_dwordx2 v[62:63], v9, s[16:19], s62 offen sc1
    buffer_load_dwordx4 v[52:55], v8, s[16:19], s62 offen offset:0 sc1
    buffer_load_dwordx4 v[56:59], v8, s[16:19], s62 offen offset:3072 sc1
    s_waitcnt vmcnt(3)
    v_add_f32_dpp v32, v62, v62 quad_perm:[1,0,3,2] row_mask:0xf bank_mask:0xf
    v_add_f32_dpp v33, v63, v63 quad_perm:[1,0,3,2] row_mask:0xf bank_mask:0xf
    v_pk_add_f32 v[16:17], v[52:53], v[54:55]
    v_add_f32_dpp v32, v32, v32 quad_perm:[2,3,0,1] row_mask:0xf bank_mask:0xf
    v_add_f32_dpp v33, v33, v33 quad_perm:[2,3,0,1] row_mask:0xf bank_mask:0xf
    v_pk_add_f32 v[20:21], v[56:57], v[58:59]
    v_add_f32_dpp v32, v32, v32 row_half_mirror row_mask:0xf bank_mask:0xf
    v_add_f32_dpp v33, v33, v33 row_half_mirror row_mask:0xf bank_mask:0xf
    v_pk_add_f32 v[16:17], v[16:17], v[20:21]
    v_mul_f32 v33, 0x3acccccd, v33
    v_fmamk_f32 v32, v32, 0x3acccccd, v11
    v_fma_f32 v32, -v33, v33, v32
    v_rsq_f32 v32, abs(v32)
    v_add_f32 v16, v16, v17
    v_mul_f32 v32, 0x3dd53b94, v32
    v_fma_f32 v16, -v33, v13, v16
    v_mul_f32 v16, v16, v32
    v_cvt_pk_bf16_f32 v17, v16, v16
    ds_write_b16 v10, v17
    v_cmp_u_f32 vcc, v16, v16
    s_cbranch_vccnz AGENP
OKENP:
ENOK2:
    s_waitcnt lgkmcnt(0)
    s_barrier
QFRAG:
    ds_read_b128 v[16:19], v3 offset:0
    ds_read_b128 v[20:23], v3 offset:128
    ds_read_b128 v[24:27], v3 offset:256
    ds_read_b128 v[28:31], v4 offset:0
    ds_read_b128 v[32:35], v4 offset:128
    ds_read_b128 v[36:39], v4 offset:256
    s_cmp_eq_u32 s49, 0
    s_cbranch_scc1 HOOKF
    s_waitcnt vmcnt(0)
QK:
    s_waitcnt lgkmcnt(5)
    v_smfmac_f32_16x16x64_bf16 v[64:67], v[16:19], a[0:7], v7
    s_waitcnt lgkmcnt(4)
    v_smfmac_f32_16x16x64_bf16 v[64:67], v[20:23], a[8:15], v7
    s_waitcnt lgkmcnt(3)
    v_smfmac_f32_16x16x64_bf16 v[64:67], v[24:27], a[16:23], v7
    s_waitcnt lgkmcnt(2)
    v_smfmac_f32_16x16x64_bf16 v[64:67], v[28:31], a[24:31], v7
    s_waitcnt lgkmcnt(1)
    v_smfmac_f32_16x16x64_bf16 v[64:67], v[32:35], a[32:39], v7
    s_waitcnt lgkmcnt(0)
    v_smfmac_f32_16x16x64_bf16 v[64:67], v[36:39], a[40:47], v7
    v_smfmac_f32_16x16x64_bf16 v[68:71], v[16:19], a[48:55], v7
    v_smfmac_f32_16x16x64_bf16 v[68:71], v[20:23], a[56:63], v7
    v_smfmac_f32_16x16x64_bf16 v[68:71], v[24:27], a[64:71], v7
    v_smfmac_f32_16x16x64_bf16 v[68:71], v[28:31], a[72:79], v7
    v_smfmac_f32_16x16x64_bf16 v[68:71], v[32:35], a[80:87], v7
    v_smfmac_f32_16x16x64_bf16 v[68:71], v[36:39], a[88:95], v7
    v_smfmac_f32_16x16x64_bf16 v[72:75], v[16:19], a[96:103], v7
    v_smfmac_f32_16x16x64_bf16 v[72:75], v[20:23], a[104:111], v7
    v_smfmac_f32_16x16x64_bf16 v[72:75], v[24:27], a[112:119], v7
    v_pk_add_f32 v[64:65], v[64:65], v[66:67]
    v_smfmac_f32_16x16x64_bf16 v[72:75], v[28:31], a[120:127], v7
    v_smfmac_f32_16x16x64_bf16 v[72:75], v[32:35], a[128:135], v7
    v_add_f32_dpp v52, v65, v64 quad_perm:[1,1,3,3] row_mask:0xf bank_mask:0xf
    v_smfmac_f32_16x16x64_bf16 v[72:75], v[36:39], a[136:143], v7
    v_smfmac_f32_16x16x64_bf16 v[76:79], v[16:19], a[144:151], v7
    v_smfmac_f32_16x16x64_bf16 v[76:79], v[20:23], a[152:159], v7
    v_smfmac_f32_16x16x64_bf16 v[76:79], v[24:27], a[160:167], v7
    v_pk_add_f32 v[68:69], v[68:69], v[70:71]
    v_smfmac_f32_16x16x64_bf16 v[76:79], v[28:31], a[168:175], v7
    v_smfmac_f32_16x16x64_bf16 v[76:79], v[32:35], a[176:183], v7
    v_add_f32_dpp v53, v69, v68 quad_perm:[1,1,3,3] row_mask:0xf bank_mask:0xf
    v_smfmac_f32_16x16x64_bf16 v[76:79], v[36:39], a[184:191], v7
    v_pk_add_f32 v[72:73], v[72:73], v[74:75]
    v_max_f32 v62, v52, v53
    s_nop 0
    v_add_f32_dpp v54, v73, v72 quad_perm:[1,1,3,3] row_mask:0xf bank_mask:0xf
    v_mov_b32 v63, v63
    v_mov_b32 v63, v63
    v_mov_b32 v63, v63
    v_mov_b32 v63, v63
    v_pk_add_f32 v[76:77], v[76:77], v[78:79]
    s_nop 1
    v_add_f32_dpp v55, v77, v76 quad_perm:[1,1,3,3] row_mask:0xf bank_mask:0xf
    v_max3_f32 v62, v62, v54, v55
    s_nop 1
    v_max_f32_dpp v62, v62, v62 quad_perm:[2,3,0,1] row_mask:0xf bank_mask:0xf
    s_nop 1
    v_max_f32_dpp v62, v62, v62 row_ror:4 row_mask:0xf bank_mask:0xf
    s_nop 1
    v_max_f32_dpp v62, v62, v62 row_ror:8 row_mask:0xf bank_mask:0xf
    v_mov_b32 v63, v62
    s_nop 1
    v_permlane16_swap_b32 v62, v63
    v_max_f32 v62, v62, v63
    v_mov_b32 v63, v62
    s_nop 1
    v_permlane32_swap_b32 v62, v63
    v_max_f32 v62, v62, v63
    v_pk_add_f32 v[52:53], v[52:53], v[62:63] op_sel_hi:[1,0] neg_lo:[0,1] neg_hi:[0,1]
    v_exp_f32 v52, v52
    v_pk_add_f32 v[54:55], v[54:55], v[62:63] op_sel_hi:[1,0] neg_lo:[0,1] neg_hi:[0,1]
    v_cvt_pk_bf16_f32 v56, v52, v52
    v_exp_f32 v53, v53
    v_exp_f32 v54, v54
    v_and_b32_dpp v16, v56, v5 quad_perm:[0,0,0,0] row_mask:0xf bank_mask:0xf
    v_and_b32_dpp v19, v56, v6 quad_perm:[0,0,0,0] row_mask:0xf bank_mask:0xf
    v_exp_f32 v55, v55
    v_mov_b32_dpp v17, v16 row_shr:4 row_mask:0xf bank_mask:0xf bound_ctrl:0
    v_mov_b32_dpp v18, v19 row_shl:4 row_mask:0xf bank_mask:0xf bound_ctrl:0
    v_cvt_pk_bf16_f32 v57, v53, v53
    s_waitcnt vmcnt(36)
    v_smfmac_f32_16x16x64_bf16 v[40:43], v[16:19], a[192:199], v7 abid:1
    ds_read_b128 v[64:67], v12 offset:4096
    v_and_b32_dpp v20, v56, v5 quad_perm:[2,2,2,2] row_mask:0xf bank_mask:0xf
    v_and_b32_dpp v23, v56, v6 quad_perm:[2,2,2,2] row_mask:0xf bank_mask:0xf
    v_smfmac_f32_16x16x64_bf16 v[44:47], v[16:19], a[200:207], v7 abid:1
    v_mov_b32_dpp v21, v20 row_shr:4 row_mask:0xf bank_mask:0xf bound_ctrl:0
    v_mov_b32_dpp v22, v23 row_shl:4 row_mask:0xf bank_mask:0xf bound_ctrl:0
    v_cvt_pk_bf16_f32 v58, v54, v54
    v_pk_add_f32 v[24:25], v[52:53], v[54:55]
    v_smfmac_f32_16x16x64_bf16 v[48:51], v[16:19], a[208:215], v7 abid:1
    v_smfmac_f32_16x16x64_bf16 v[40:43], v[20:23], a[216:223], v7 abid:1
    ds_read_b128 v[68:71], v12 offset:8192
    v_and_b32_dpp v16, v57, v5 quad_perm:[0,0,0,0] row_mask:0xf bank_mask:0xf
    v_and_b32_dpp v19, v57, v6 quad_perm:[0,0,0,0] row_mask:0xf bank_mask:0xf
    v_smfmac_f32_16x16x64_bf16 v[44:47], v[20:23], a[224:231], v7 abid:1
    v_mov_b32_dpp v17, v16 row_shr:4 row_mask:0xf bank_mask:0xf bound_ctrl:0
    v_mov_b32_dpp v18, v19 row_shl:4 row_mask:0xf bank_mask:0xf bound_ctrl:0
    v_cvt_pk_bf16_f32 v59, v55, v55
    v_add_f32 v63, v24, v25
    v_smfmac_f32_16x16x64_bf16 v[48:51], v[20:23], a[232:239], v7 abid:1
    s_waitcnt vmcnt(24)
    v_smfmac_f32_16x16x64_bf16 v[40:43], v[16:19], a[240:247], v7 abid:1
    v_and_b32_dpp v20, v57, v5 quad_perm:[2,2,2,2] row_mask:0xf bank_mask:0xf
    v_and_b32_dpp v23, v57, v6 quad_perm:[2,2,2,2] row_mask:0xf bank_mask:0xf
    v_smfmac_f32_16x16x64_bf16 v[44:47], v[16:19], a[248:255], v7 abid:1
    v_mov_b32_dpp v21, v20 row_shr:4 row_mask:0xf bank_mask:0xf bound_ctrl:0
    v_mov_b32_dpp v22, v23 row_shl:4 row_mask:0xf bank_mask:0xf bound_ctrl:0
    v_add_f32_dpp v63, v63, v63 quad_perm:[2,3,0,1] row_mask:0xf bank_mask:0xf
    v_smfmac_f32_16x16x64_bf16 v[48:51], v[16:19], v[128:135], v7 abid:1
    v_smfmac_f32_16x16x64_bf16 v[40:43], v[20:23], v[136:143], v7 abid:1
    v_add_f32_dpp v63, v63, v63 row_ror:4 row_mask:0xf bank_mask:0xf
    v_and_b32_dpp v16, v58, v5 quad_perm:[0,0,0,0] row_mask:0xf bank_mask:0xf
    v_and_b32_dpp v19, v58, v6 quad_perm:[0,0,0,0] row_mask:0xf bank_mask:0xf
    v_smfmac_f32_16x16x64_bf16 v[44:47], v[20:23], v[144:151], v7 abid:1
    v_mov_b32_dpp v17, v16 row_shr:4 row_mask:0xf bank_mask:0xf bound_ctrl:0
    v_mov_b32_dpp v18, v19 row_shl:4 row_mask:0xf bank_mask:0xf bound_ctrl:0
    v_add_f32_dpp v63, v63, v63 row_ror:8 row_mask:0xf bank_mask:0xf
    v_mov_b32 v24, v63
    v_smfmac_f32_16x16x64_bf16 v[48:51], v[20:23], v[152:159], v7 abid:1
    s_waitcnt vmcnt(12)
    v_smfmac_f32_16x16x64_bf16 v[40:43], v[16:19], v[160:167], v7 abid:1
    v_permlane16_swap_b32 v63, v24
    v_add_f32 v63, v63, v24
    v_and_b32_dpp v20, v58, v5 quad_perm:[2,2,2,2] row_mask:0xf bank_mask:0xf
    v_and_b32_dpp v23, v58, v6 quad_perm:[2,2,2,2] row_mask:0xf bank_mask:0xf
    v_smfmac_f32_16x16x64_bf16 v[44:47], v[16:19], v[168:175], v7 abid:1
    v_mov_b32_dpp v21, v20 row_shr:4 row_mask:0xf bank_mask:0xf bound_ctrl:0
    v_mov_b32_dpp v22, v23 row_shl:4 row_mask:0xf bank_mask:0xf bound_ctrl:0
    v_mov_b32 v24, v63
    v_smfmac_f32_16x16x64_bf16 v[48:51], v[16:19], v[176:183], v7 abid:1
    v_smfmac_f32_16x16x64_bf16 v[40:43], v[20:23], v[184:191], v7 abid:1
    v_permlane32_swap_b32 v63, v24
    v_add_f32 v63, v63, v24
    v_and_b32_dpp v16, v59, v5 quad_perm:[0,0,0,0] row_mask:0xf bank_mask:0xf
    v_and_b32_dpp v19, v59, v6 quad_perm:[0,0,0,0] row_mask:0xf bank_mask:0xf
    v_smfmac_f32_16x16x64_bf16 v[44:47], v[20:23], v[192:199], v7 abid:1
    v_mov_b32_dpp v17, v16 row_shr:4 row_mask:0xf bank_mask:0xf bound_ctrl:0
    v_mov_b32_dpp v18, v19 row_shl:4 row_mask:0xf bank_mask:0xf bound_ctrl:0
    s_waitcnt lgkmcnt(0)
    ds_write2_b32 v71, v62, v63 offset0:0 offset1:4
    v_smfmac_f32_16x16x64_bf16 v[48:51], v[20:23], v[200:207], v7 abid:1
    s_waitcnt vmcnt(0)
    v_smfmac_f32_16x16x64_bf16 v[40:43], v[16:19], v[208:215], v7 abid:1
    v_and_b32_dpp v20, v59, v5 quad_perm:[2,2,2,2] row_mask:0xf bank_mask:0xf
    v_and_b32_dpp v23, v59, v6 quad_perm:[2,2,2,2] row_mask:0xf bank_mask:0xf
    v_smfmac_f32_16x16x64_bf16 v[44:47], v[16:19], v[216:223], v7 abid:1
    v_mov_b32_dpp v21, v20 row_shr:4 row_mask:0xf bank_mask:0xf bound_ctrl:0
    v_mov_b32_dpp v22, v23 row_shl:4 row_mask:0xf bank_mask:0xf bound_ctrl:0
    s_mov_b32 vcc_lo, 0x00ff00ff
    v_smfmac_f32_16x16x64_bf16 v[48:51], v[16:19], v[224:231], v7 abid:1
    v_smfmac_f32_16x16x64_bf16 v[40:43], v[20:23], v[232:239], v7 abid:1
    v_smfmac_f32_16x16x64_bf16 v[44:47], v[20:23], v[240:247], v7 abid:1
    v_smfmac_f32_16x16x64_bf16 v[48:51], v[20:23], v[248:255], v7 abid:1
    s_mov_b32 vcc_hi, 0xff00ff00
    v_cmp_eq_u32 s[60:61], 24, v1
    v_mov_b32 v24, v24
    v_mov_b32 v24, v24
    v_mov_b32 v24, v24
    v_mov_b32 v24, v24
    v_mov_b32 v24, v24
    v_cndmask_b32_dpp v40, v44, v40, vcc row_ror:8 row_mask:0xf bank_mask:0xf
    v_cndmask_b32_dpp v41, v45, v41, vcc row_ror:8 row_mask:0xf bank_mask:0xf
    v_cndmask_b32_dpp v42, v46, v42, vcc row_ror:8 row_mask:0xf bank_mask:0xf
    v_cndmask_b32_dpp v43, v47, v43, vcc row_ror:8 row_mask:0xf bank_mask:0xf
    ds_write_b128 v15, v[40:43]
    v_cndmask_b32_dpp v48, v50, v48, vcc row_ror:8 row_mask:0xf bank_mask:0xf
    v_cndmask_b32_dpp v49, v51, v49, vcc row_ror:8 row_mask:0xf bank_mask:0xf
    ds_write_b64 v61, v[48:49]
    s_cmp_eq_u32 s49, 0
    s_cbranch_scc1 HOOKC
EXB:
    s_waitcnt lgkmcnt(0)
    s_barrier
    ds_read_b128 v[16:19], v70
    ds_read_b128 v[20:23], v70 offset:16
    ds_read_b64 v[24:25], v60 offset:0
    v_mov_b32 v44, v44
    ds_read_b64 v[26:27], v60 offset:768
    ds_read_b64 v[28:29], v60 offset:1536
    v_mov_b32 v44, v44
    ds_read_b64 v[30:31], v60 offset:2304
    ds_read_b64 v[32:33], v60 offset:3072
    v_mov_b32 v44, v44
    ds_read_b64 v[34:35], v60 offset:3840
    ds_read_b64 v[36:37], v60 offset:4608
    v_mov_b32 v44, v44
    ds_read_b64 v[38:39], v60 offset:5376
    s_mov_b32 s51, 0
    s_cmp_eq_u32 s49, 0
    s_cselect_b32 s52, 20, s46
    s_waitcnt lgkmcnt(9)
    v_max3_f32 v40, v16, v17, v18
    v_max_f32 v40, v40, v19
    v_pk_add_f32 v[16:17], v[16:17], v[40:41] op_sel_hi:[1,0] neg_lo:[0,1] neg_hi:[0,1]
    v_pk_add_f32 v[18:19], v[18:19], v[40:41] op_sel_hi:[1,0] neg_lo:[0,1] neg_hi:[0,1]
    v_exp_f32 v16, v16
    v_exp_f32 v17, v17
    v_exp_f32 v18, v18
    v_exp_f32 v19, v19
    s_waitcnt lgkmcnt(0)
    v_pk_mul_f32 v[20:21], v[20:21], v[16:17]
    v_pk_fma_f32 v[20:21], v[22:23], v[18:19], v[20:21]
    v_add_f32 v41, v20, v21
    v_rcp_f32 v42, v41
    v_log_f32 v43, v41
    v_pk_add_f32 v[24:25], v[24:25], v[26:27]
    v_pk_add_f32 v[28:29], v[28:29], v[30:31]
    v_pk_add_f32 v[32:33], v[32:33], v[34:35]
    v_pk_add_f32 v[36:37], v[36:37], v[38:39]
    v_pk_mul_f32 v[24:25], v[24:25], v[16:17] op_sel_hi:[1,0]
    v_pk_fma_f32 v[24:25], v[28:29], v[16:17], v[24:25] op_sel:[0,1,0] op_sel_hi:[1,1,1]
    v_pk_fma_f32 v[24:25], v[32:33], v[18:19], v[24:25] op_sel:[0,0,0] op_sel_hi:[1,0,1]
    v_pk_fma_f32 v[24:25], v[36:37], v[18:19], v[24:25] op_sel:[0,1,0] op_sel_hi:[1,1,1]
    v_pk_mul_f32 v[24:25], v[24:25], v[42:43] op_sel_hi:[1,0]
    v_add_f32 v43, v43, v40
    v_cvt_pk_bf16_f32 v24, v24, v25
    v_cndmask_b32 v24, v24, v43, s[60:61]
    buffer_store_dword v24, v14, s[16:19], s32 offen offset:0
    s_cmp_eq_u32 s50, 0
    s_cbranch_scc1 SLOW3
PUBD3:
    s_cmp_ge_u32 s52, 20
    s_cbranch_scc1 HOOKG
    v_mov_b32 v40, v40
    v_mov_b32 v40, v40
    v_mov_b32 v40, v40
    v_mov_b32 v40, v40
    v_mov_b32 v40, v40
    v_mov_b32 v40, v40
    v_mov_b32 v40, v40
    v_mov_b32 v40, v40
    v_mov_b32 v40, v40
    v_mov_b32 v40, v40
    v_mov_b32 v40, v40
    v_mov_b32 v40, v40
    v_mov_b32 v40, v40
    v_mov_b32 v40, v40
    v_mov_b32 v40, v40
    v_mov_b32 v40, v40
    buffer_load_dword v56, v65, s[16:19], s62 offen sc1
    buffer_load_dwordx4 v[44:47], v64, s[16:19], s62 offen offset:0 sc1
    buffer_load_dwordx4 v[48:51], v64, s[16:19], s62 offen offset:512 sc1
    buffer_load_dwordx4 v[52:55], v64, s[16:19], s62 offen offset:1024 sc1
    buffer_load_dword v57, v66, s[16:19], s49 offen sc1
    v_mov_b32 v40, v40
    v_mov_b32 v40, v40
    v_mov_b32 v40, v40
    v_mov_b32 v40, v40
    v_mov_b32 v40, v40
    v_mov_b32 v40, v40
    v_mov_b32 v40, v40
    v_mov_b32 v40, v40
    v_mov_b32 v40, v40
    v_mov_b32 v40, v40
    v_mov_b32 v40, v40
    v_mov_b32 v40, v40
    v_mov_b32 v40, v40
    v_mov_b32 v40, v40
    v_mov_b32 v40, v40
    v_mov_b32 v40, v40
    v_mov_b32 v40, v40
    v_mov_b32 v40, v40
    v_mov_b32 v40, v40
    v_mov_b32 v40, v40
WOP:
    buffer_load_dword v56, v65, s[16:19], s62 offen sc1
    buffer_load_dwordx4 v[44:47], v64, s[16:19], s62 offen offset:0 sc1
    buffer_load_dwordx4 v[48:51], v64, s[16:19], s62 offen offset:512 sc1
    buffer_load_dwordx4 v[52:55], v64, s[16:19], s62 offen offset:1024 sc1
    buffer_load_dword v57, v66, s[16:19], s49 offen sc1
    v_mov_b32 v40, v40
    v_mov_b32 v40, v40
    v_mov_b32 v40, v40
    v_mov_b32 v40, v40
    s_waitcnt vmcnt(5)
WOC:
    v_max3_u32 v63, v44, v48, v52
    v_mov_b32 v32, v56
    v_max_u32 v63, v63, v32
    v_cmp_eq_u32 vcc, -1, v63
    s_cbranch_vccnz AGWOP
    v_mfma_f32_16x16x32_bf16 v[16:19], v[44:47], v[80:83], 0
    v_max_f32_dpp v33, v32, v32 quad_perm:[1,0,3,2] row_mask:0xf bank_mask:0xf
    s_nop 0
    v_mfma_f32_16x16x32_bf16 v[16:19], v[48:51], v[96:99], v[16:19]
    v_max_f32_dpp v33, v33, v33 quad_perm:[2,3,0,1] row_mask:0xf bank_mask:0xf
    s_nop 0
    v_mfma_f32_16x16x32_bf16 v[16:19], v[52:55], v[112:115], v[16:19]
    v_max_f32_dpp v33, v33, v33 row_half_mirror row_mask:0xf bank_mask:0xf
    v_sub_f32 v34, v32, v33
    v_mfma_f32_16x16x32_bf16 v[20:23], v[44:47], v[84:87], 0
    v_exp_f32 v34, v34
    s_nop 0
    v_mfma_f32_16x16x32_bf16 v[20:23], v[48:51], v[100:103], v[20:23]
    v_add_f32_dpp v33, v34, v34 quad_perm:[1,0,3,2] row_mask:0xf bank_mask:0xf
    s_nop 0
    v_mfma_f32_16x16x32_bf16 v[20:23], v[52:55], v[116:119], v[20:23]
    v_add_f32_dpp v33, v33, v33 quad_perm:[2,3,0,1] row_mask:0xf bank_mask:0xf
    s_nop 0
    v_mfma_f32_16x16x32_bf16 v[24:27], v[44:47], v[88:91], 0
    v_add_f32_dpp v33, v33, v33 row_half_mirror row_mask:0xf bank_mask:0xf
    v_rcp_f32 v33, v33
    v_mfma_f32_16x16x32_bf16 v[24:27], v[48:51], v[104:107], v[24:27]
    v_mul_f32 v34, v34, v33
    s_nop 0
    v_mfma_f32_16x16x32_bf16 v[24:27], v[52:55], v[120:123], v[24:27]
    v_mul_f32_dpp v36, v34, v16 row_newbcast:0 row_mask:0xf bank_mask:0xf
    v_fmac_f32_dpp v36, v34, v17 row_newbcast:1 row_mask:0xf bank_mask:0xf
    v_mfma_f32_16x16x32_bf16 v[28:31], v[44:47], v[92:95], 0
    v_fmac_f32_dpp v36, v34, v18 row_newbcast:2 row_mask:0xf bank_mask:0xf
    v_fmac_f32_dpp v36, v34, v19 row_newbcast:3 row_mask:0xf bank_mask:0xf
    v_mfma_f32_16x16x32_bf16 v[28:31], v[48:51], v[108:111], v[28:31]
    v_mul_f32_dpp v37, v34, v20 row_newbcast:0 row_mask:0xf bank_mask:0xf
    v_fmac_f32_dpp v37, v34, v21 row_newbcast:1 row_mask:0xf bank_mask:0xf
    v_mfma_f32_16x16x32_bf16 v[28:31], v[52:55], v[124:127], v[28:31]
    v_fmac_f32_dpp v37, v34, v22 row_newbcast:2 row_mask:0xf bank_mask:0xf
    v_fmac_f32_dpp v37, v34, v23 row_newbcast:3 row_mask:0xf bank_mask:0xf
    v_cmp_u_f32 vcc, v36, v57
    v_mul_f32_dpp v38, v34, v24 row_newbcast:0 row_mask:0xf bank_mask:0xf
    v_fmac_f32_dpp v38, v34, v25 row_newbcast:1 row_mask:0xf bank_mask:0xf
    v_fmac_f32_dpp v38, v34, v26 row_newbcast:2 row_mask:0xf bank_mask:0xf
    v_fmac_f32_dpp v38, v34, v27 row_newbcast:3 row_mask:0xf bank_mask:0xf
    s_mov_b32 exec_hi, 0
    v_mul_f32_dpp v39, v34, v28 row_newbcast:0 row_mask:0xf bank_mask:0xf
    v_fmac_f32_dpp v39, v34, v29 row_newbcast:1 row_mask:0xf bank_mask:0xf
    v_fmac_f32_dpp v39, v34, v30 row_newbcast:2 row_mask:0xf bank_mask:0xf
    v_fmac_f32_dpp v39, v34, v31 row_newbcast:3 row_mask:0xf bank_mask:0xf
    ds_write_b128 v68, v[36:39]
    s_mov_b64 exec, -1
    s_cbranch_vccnz AGWOP
OKWOP:
    s_cmp_lg_u32 s44, 3
    s_waitcnt lgkmcnt(0)
    s_barrier
    s_cbranch_scc1 WOX
    ds_read2st64_b32 v[16:17], v69 offset0:0 offset1:1
    ds_read2st64_b32 v[18:19], v69 offset0:2 offset1:3
    ds_read2st64_b32 v[20:21], v69 offset0:4 offset1:5
    ds_read2st64_b32 v[22:23], v69 offset0:6 offset1:7
    s_waitcnt lgkmcnt(2)
    v_pk_add_f32 v[16:17], v[16:17], v[18:19]
    v_add_f32 v16, v16, v57
    s_waitcnt lgkmcnt(0)
    v_pk_add_f32 v[20:21], v[20:21], v[22:23]
    v_pk_add_f32 v[16:17], v[16:17], v[20:21]
    v_add_f32 v16, v16, v17
    buffer_store_dword v16, v67, s[16:19], s1 offen sc1
    buffer_store_dword v16, v67, s[16:19], s99 offen sc1
WOX:
    s_cmp_ge_u32 s46, 30
    s_cbranch_scc1 STX
    s_cmp_eq_u32 s44, 3
    s_cbranch_scc1 F1W3
    s_waitcnt vmcnt(0)
F1W3:
    s_waitcnt vmcnt(2)
F1E:
    ds_read_b128 v[56:59], v12 offset:16384
    ds_read_b128 v[52:55], v12 offset:12288
    ds_read_b128 v[60:63], v12 offset:20480
    s_mov_b32 s100, 0
    s_mov_b32 s51, 0
    s_waitcnt lgkmcnt(0)
    ds_read_b64_tr_b16 v[64:65], v57 offset:49152
    ds_read_b64_tr_b16 v[66:67], v57 offset:49664
    ds_read_b64_tr_b16 v[68:69], v57 offset:53248
    ds_read_b64_tr_b16 v[70:71], v57 offset:53760
    ds_read_b64_tr_b16 v[72:73], v57 offset:57344
    ds_read_b64_tr_b16 v[74:75], v57 offset:57856
    ds_read_b64_tr_b16 v[76:77], v57 offset:61440
    ds_read_b64_tr_b16 v[78:79], v57 offset:61952
    s_cmp_eq_u32 s49, 0
    s_cbranch_scc1 HOOKD
    s_cmp_lt_u32 s46, 20
    s_cbranch_scc1 GFB
    s_sleep 11
GFB:
    s_sleep 11
F1W:
    buffer_load_dword v44, v52, s[16:19], s99 offen offset:0 sc1
    buffer_load_dword v45, v52, s[16:19], s99 offen offset:128 sc1
    buffer_load_dword v46, v52, s[16:19], s99 offen offset:256 sc1
    buffer_load_dword v47, v52, s[16:19], s99 offen offset:384 sc1
    buffer_load_dword v48, v52, s[16:19], s99 offen offset:512 sc1
    buffer_load_dword v49, v52, s[16:19], s99 offen offset:640 sc1
    buffer_load_dword v50, v52, s[16:19], s99 offen offset:768 sc1
    buffer_load_dword v51, v52, s[16:19], s99 offen offset:896 sc1
    s_waitcnt vmcnt(0)
    v_pk_add_f32 v[16:17], v[44:45], v[46:47]
    v_pk_add_f32 v[18:19], v[48:49], v[50:51]
    v_pk_add_f32 v[16:17], v[16:17], v[18:19]
    v_add_f32 v16, v16, v17
    v_mov_b32 v17, v16
    s_nop 1
    v_permlane32_swap_b32 v16, v17
    v_add_f32 v16, v16, v17
    v_cmp_u_f32 vcc, v16, v16
    v_cvt_pk_bf16_f32 v16, v16, v16
    ds_write_b16 v53, v16
    s_cbranch_vccnz AGF1P
OKF1P:
    v_and_b32 v16, 0xffff0000, v16
    buffer_store_dword v16, v54, s[16:19], s34 offen offset:0
    s_cmp_eq_u32 s50, 0
    s_cbranch_scc1 SLOW8
PUBD8:
    s_waitcnt lgkmcnt(0)
    s_barrier
    ds_read_b128 v[20:23], v2 offset:256
    ds_read_b128 v[24:27], v2 offset:320
    ds_read_b128 v[28:31], v2 offset:384
    ds_read_b128 v[32:35], v2 offset:448
    s_waitcnt lgkmcnt(3)
    v_mfma_f32_16x16x32_bf16 v[40:43], v[20:23], v[64:67], 0
    v_mfma_f32_16x16x32_bf16 v[36:39], v[20:23], v[20:23], 0
    s_waitcnt lgkmcnt(2)
    v_mfma_f32_16x16x32_bf16 v[40:43], v[24:27], v[68:71], v[40:43]
    v_mfma_f32_16x16x32_bf16 v[36:39], v[24:27], v[24:27], v[36:39]
    s_waitcnt lgkmcnt(1)
    v_mfma_f32_16x16x32_bf16 v[40:43], v[28:31], v[72:75], v[40:43]
    v_mfma_f32_16x16x32_bf16 v[36:39], v[28:31], v[28:31], v[36:39]
    s_waitcnt lgkmcnt(0)
    v_mfma_f32_16x16x32_bf16 v[40:43], v[32:35], v[76:79], v[40:43]
    v_mfma_f32_16x16x32_bf16 v[36:39], v[32:35], v[32:35], v[36:39]
    s_mov_b32 s51, 0
    s_nop 5
    buffer_store_dword v40, v55, s[16:19], s32 offen offset:0
    buffer_store_dwordx2 v[36:37], v56, s[16:19], s32 offen offset:0
    s_cmp_eq_u32 s50, 0
    s_cbranch_scc1 SLOW9
PUBD9:
    s_cmp_lt_u32 s46, 20
    s_cbranch_scc1 STX
    v_mov_b32 v44, v44
    v_mov_b32 v44, v44
    v_mov_b32 v44, v44
    v_mov_b32 v44, v44
    v_mov_b32 v44, v44
    v_mov_b32 v44, v44
    v_mov_b32 v44, v44
    v_mov_b32 v44, v44
    v_mov_b32 v44, v44
    v_mov_b32 v44, v44
    v_mov_b32 v44, v44
    v_mov_b32 v44, v44
    v_mov_b32 v44, v44
    v_mov_b32 v44, v44
    v_mov_b32 v44, v44
    v_mov_b32 v44, v44
    v_mov_b32 v44, v44
    v_mov_b32 v44, v44
    v_mov_b32 v44, v44
    v_mov_b32 v44, v44
    v_mov_b32 v44, v44
    v_mov_b32 v44, v44
    v_mov_b32 v44, v44
    v_mov_b32 v44, v44
    v_mov_b32 v44, v44
    v_mov_b32 v44, v44
    v_mov_b32 v44, v44
    v_mov_b32 v44, v44
    v_mov_b32 v44, v44
    v_mov_b32 v44, v44
    buffer_load_dwordx2 v[74:75], v60, s[16:19], s62 offen sc1
    buffer_load_dwordx4 v[64:67], v58, s[16:19], s62 offen offset:0 sc1
    buffer_load_dwordx4 v[68:71], v58, s[16:19], s62 offen offset:3072 sc1
    buffer_load_dwordx2 v[72:73], v59, s[16:19], s62 offen sc1
    buffer_load_dword v76, v61, s[16:19], s49 offen sc1
    s_cmp_eq_u32 s49, 0
    s_cbranch_scc1 HOOKI
    v_mov_b32 v44, v44
    v_mov_b32 v44, v44
    v_mov_b32 v44, v44
    v_mov_b32 v44, v44
    v_mov_b32 v44, v44
    v_mov_b32 v44, v44
    v_mov_b32 v44, v44
    v_mov_b32 v44, v44
    v_mov_b32 v44, v44
    v_mov_b32 v44, v44
    v_mov_b32 v44, v44
    v_mov_b32 v44, v44
    v_mov_b32 v44, v44
    v_mov_b32 v44, v44
    v_mov_b32 v44, v44
    v_mov_b32 v44, v44
    v_mov_b32 v44, v44
    v_mov_b32 v44, v44
    v_mov_b32 v44, v44
    v_mov_b32 v44, v44
W2P:
    buffer_load_dwordx2 v[74:75], v60, s[16:19], s62 offen sc1
    buffer_load_dwordx4 v[64:67], v58, s[16:19], s62 offen offset:0 sc1
    buffer_load_dwordx4 v[68:71], v58, s[16:19], s62 offen offset:3072 sc1
    buffer_load_dwordx2 v[72:73], v59, s[16:19], s62 offen sc1
    buffer_load_dword v76, v61, s[16:19], s49 offen sc1
    s_waitcnt vmcnt(5)
    v_add_f32_dpp v46, v74, v74 quad_perm:[1,0,3,2] row_mask:0xf bank_mask:0xf
    v_add_f32_dpp v47, v75, v75 quad_perm:[1,0,3,2] row_mask:0xf bank_mask:0xf
    v_pk_add_f32 v[18:19], v[64:65], v[66:67]
    v_add_f32_dpp v46, v46, v46 quad_perm:[2,3,0,1] row_mask:0xf bank_mask:0xf
    v_add_f32_dpp v47, v47, v47 quad_perm:[2,3,0,1] row_mask:0xf bank_mask:0xf
    v_pk_add_f32 v[20:21], v[68:69], v[70:71]
    v_add_f32_dpp v46, v46, v46 row_half_mirror row_mask:0xf bank_mask:0xf
    v_add_f32_dpp v47, v47, v47 row_half_mirror row_mask:0xf bank_mask:0xf
    v_add_f32 v16, v18, v19
    v_add_f32 v17, v20, v21
    v_mul_f32 v47, 0x3acccccd, v47
    v_fmamk_f32 v46, v46, 0x3acccccd, v11
    v_fma_f32 v46, -v47, v47, v46
    v_rsq_f32 v46, abs(v46)
    v_pk_add_f32 v[16:17], v[16:17], v[72:73]
    v_pk_fma_f32 v[16:17], v[46:47], v[126:127], v[16:17] op_sel:[1,0,0] op_sel_hi:[1,1,1] neg_lo:[1,0,0] neg_hi:[1,0,0]
    v_pk_mul_f32 v[16:17], v[16:17], v[46:47] op_sel_hi:[1,0]
    v_mul_f32 v18, 0xbfb8aa3b, v16
    v_exp_f32 v18, v18
    v_mul_f32 v16, v16, v17
    v_add_f32 v18, 1.0, v18
    v_rcp_f32 v18, v18
    v_cmp_u_f32 vcc, v16, v76
    v_mul_f32 v16, v16, v18
    v_cvt_pk_bf16_f32 v16, v16, v16
    ds_write_b16 v63, v16
    s_cbranch_vccnz AGW2P
OKW2P:
    s_waitcnt lgkmcnt(0)
    s_barrier
    ds_read_b128 v[16:19], v2 offset:512
    ds_read_b128 v[20:23], v2 offset:576
    ds_read_b128 v[24:27], v2 offset:640
    ds_read_b128 v[28:31], v2 offset:704
    ds_read_b128 v[32:35], v2 offset:768
    ds_read_b128 v[36:39], v2 offset:832
    v_mov_b32 v40, v76
    s_nop 0
    s_waitcnt lgkmcnt(5)
    v_mfma_f32_16x16x32_bf16 v[40:43], v[16:19], v[80:83], v[40:43]
    s_waitcnt lgkmcnt(4)
    v_mfma_f32_16x16x32_bf16 v[40:43], v[20:23], v[84:87], v[40:43]
    s_waitcnt lgkmcnt(3)
    v_mfma_f32_16x16x32_bf16 v[40:43], v[24:27], v[88:91], v[40:43]
    s_waitcnt lgkmcnt(2)
    v_mfma_f32_16x16x32_bf16 v[40:43], v[28:31], v[92:95], v[40:43]
    s_waitcnt lgkmcnt(1)
    v_mfma_f32_16x16x32_bf16 v[40:43], v[32:35], v[96:99], v[40:43]
    s_waitcnt lgkmcnt(0)
    v_mfma_f32_16x16x32_bf16 v[40:43], v[36:39], v[100:103], v[40:43]
    s_waitcnt vmcnt(0)
    s_nop 6
    buffer_store_dword v40, v62, s[16:19], s49 offen sc1
STX:
    s_cmp_lg_u32 s49, 0
    s_cbranch_scc1 LAST
    s_branch LOOP
LAST:
    s_and_b32 s52, s2, 0xc7
    s_cmp_eq_u32 s52, 0
    s_cbranch_scc1 LOOP
    s_endpgm
FINAL:
    s_cmp_eq_u32 s44, 3
    s_cbranch_scc1 FINX
    s_sleep 22
    s_waitcnt lgkmcnt(0)
Y3P:
    buffer_load_dword v22, v16, s[16:19], s55 offen offset:0 sc1
    buffer_load_dword v23, v16, s[16:19], s55 offen offset:128 sc1
    buffer_load_dword v24, v16, s[16:19], s55 offen offset:256 sc1
    buffer_load_dword v25, v16, s[16:19], s55 offen offset:384 sc1
    s_waitcnt vmcnt(0)
    v_pk_add_f32 v[22:23], v[22:23], v[24:25]
    v_add_f32 v30, v22, v23
    v_mov_b32 v31, v30
    s_nop 1
    v_permlane32_swap_b32 v30, v31
    v_add_f32 v30, v30, v31
    v_cmp_u_f32 vcc, v30, v30
    v_cvt_pk_bf16_f32 v30, v30, v30
    s_cbranch_vccnz AGY3P
OKY3P:
    buffer_store_short v30, v21, s[36:39], 0 offen
FINX:
DONE:
    s_endpgm
TABLES:
    v_mov_b32 v23, 1879048192
    v_and_b32 v24, 15, v1
    v_lshrrev_b32 v25, 4, v1
    v_and_b32 v26, 7, v1
    v_and_b32 v27, 31, v1
    v_lshrrev_b32 v28, 5, v1
    v_and_b32 v29, 31, v1
    v_lshl_add_u32 v29, s44, 5, v29
    v_lshrrev_b32 v16, 2, v1
    v_lshlrev_b32 v16, 7, v16
    v_and_b32 v20, 3, v1
    v_lshl_add_u32 v16, v20, 2, v16
    s_mul_i32 s52, s7, 3072
    s_mul_i32 s54, s44, 768
    s_add_u32 s52, s52, s54
    s_lshl_b32 s54, s48, 4
    s_add_u32 s52, s52, s54
    v_add_u32 v16, s52, v16
    v_cmp_gt_u32 vcc, 24, v1
    s_nop 1
    v_cndmask_b32 v16, v23, v16, vcc
    s_lshl_b32 s52, s7, 5
    s_lshl_b32 s54, s48, 2
    s_add_u32 s52, s52, s54
    s_add_u32 s52, s52, 19968
    s_cmp_eq_u32 s44, 3
    s_cselect_b32 s52, s52, 1879048192
    v_writelane_b32 v16, s52, 24
    v_lshlrev_b32 v17, 4, v26
    v_and_b32 v20, 1, v25
    v_lshl_add_u32 v17, v20, 7, v17
    v_mul_u32_u24 v20, 768, v28
    v_add_u32 v17, v17, v20
    s_mul_i32 s52, s44, 1536
    s_add_u32 s52, s52, 98816
    v_add_u32 v17, s52, v17
    v_bfe_u32 v20, v1, 3, 1
    v_xor_b32 v20, v20, v28
    v_lshl_add_u32 v19, v20, 3, v17
    v_add_u32 v19, 512, v19
    v_lshl_add_u32 v17, v20, 8, v17
    s_mul_i32 s52, s44, 24
    v_min_u32 v21, 23, v1
    v_add_u32 v21, s52, v21
    v_lshrrev_b32 v18, 5, v21
    v_lshlrev_b32 v18, 8, v18
    v_bfe_u32 v20, v21, 1, 1
    v_lshl_add_u32 v18, v20, 7, v18
    v_bfe_u32 v20, v21, 2, 3
    v_lshl_add_u32 v18, v20, 4, v18
    v_bfe_u32 v20, v21, 0, 1
    v_lshl_add_u32 v18, v20, 3, v18
    v_add_u32 v18, 98816, v18
    ds_write_b128 v12, v[16:19] offset:0
    v_lshlrev_b32 v16, 4, v26
    v_lshl_add_u32 v16, v25, 7, v16
    s_mul_i32 s52, s56, 6144
    s_mul_i32 s54, s44, 1536
    s_add_u32 s52, s52, s54
    v_add_u32 v16, s52, v16
    v_cmp_gt_u32 vcc, 8, v24
    s_nop 1
    v_cndmask_b32 v16, v23, v16, vcc
    s_lshr_b32 s53, s44, 1
    s_lshl_b32 s52, s56, 6
    s_lshl_b32 s54, s53, 5
    s_add_u32 s52, s52, s54
    s_add_u32 s52, s52, 19968
    v_lshl_add_u32 v17, v25, 2, v26
    v_and_b32 v17, 7, v17
    v_lshl_add_u32 v17, v17, 2, s52
    s_lshl_b32 s52, s57, 8
    s_add_u32 s52, s52, 131072
    s_or_b32 s53, s45, s56
    s_cmp_eq_u32 s53, 0
    s_cselect_b32 s52, s52, 1879048192
    v_lshl_add_u32 v18, v1, 2, s52
    v_lshlrev_b32 v19, 11, v28
    v_lshl_add_u32 v19, v27, 2, v19
    s_lshr_b32 s53, s57, 1
    s_lshl_b32 s52, s57, 12
    s_lshl_b32 s54, s53, 13
    s_add_u32 s52, s52, s54
    s_lshl_b32 s54, s45, 8
    s_add_u32 s52, s52, s54
    s_lshl_b32 s54, s56, 7
    s_add_u32 s52, s52, s54
    v_add_u32 v19, s52, v19
    ds_write_b128 v12, v[16:19] offset:4096
    s_lshl_b32 s52, s44, 9
    s_add_u32 s52, s52, 104960
    v_lshl_add_u32 v16, v27, 4, s52
    v_lshl_add_u32 v16, v28, 11, v16
    v_lshlrev_b32 v17, 4, v24
    v_lshl_add_u32 v17, v25, 2, v17
    v_add_u32 v17, 104960, v17
    v_mov_b32 v18, 98752
    s_lshl_b32 s52, s44, 2
    s_add_u32 s52, s52, 98752
    v_mov_b32 v19, 98792
    v_writelane_b32 v19, s52, 0
    ds_write_b128 v12, v[16:19] offset:8192
    v_lshlrev_b32 v16, 10, v28
    v_lshl_add_u32 v16, v27, 2, v16
    s_lshl_b32 s52, s3, 14
    s_lshl_b32 s54, s44, 11
    s_add_u32 s52, s52, s54
    v_add_u32 v16, s52, v16
    v_lshlrev_b32 v17, 1, v29
    v_add_u32 v17, 96512, v17
    s_lshl_b32 s52, s4, 9
    s_add_u32 s52, s52, 133632
    s_cmp_lt_u32 s4, 5
    s_cselect_b32 s52, s52, 1879048192
    s_cmp_eq_u32 s45, 0
    s_cselect_b32 s52, s52, 1879048192
    v_lshl_add_u32 v18, v29, 2, s52
    v_cmp_gt_u32 vcc, 32, v1
    s_nop 1
    v_cndmask_b32 v18, v23, v18, vcc
    s_lshl_b32 s52, s59, 6
    s_lshl_b32 s54, s44, 4
    s_add_u32 s52, s52, s54
    v_add_u32 v19, s52, v1
    s_mul_i32 s52, s58, 3072
    s_lshl_b32 s54, s3, 2
    s_add_u32 s52, s52, s54
    s_add_u32 s52, s52, 12288
    s_lshl_b32 s53, s58, 2
    s_add_u32 s53, s53, 18432
    s_cmp_eq_u32 s3, 4
    s_cselect_b32 s52, s53, s52
    s_cselect_b32 s53, 3, 4
    v_lshlrev_b32 v19, s53, v19
    v_add_u32 v19, s52, v19
    v_cmp_gt_u32 vcc, 16, v1
    s_nop 1
    v_cndmask_b32 v19, v23, v19, vcc
    ds_write_b128 v12, v[16:19] offset:12288
    s_lshl_b32 s52, s4, 3
    s_add_u32 s52, s52, 20224
    s_cmp_eq_u32 s44, 3
    s_cselect_b32 s52, s52, 1879048192
    s_cmp_lt_u32 s4, 5
    s_cselect_b32 s52, s52, 1879048192
    v_mov_b32 v16, v23
    v_writelane_b32 v16, s52, 0
    v_and_b32 v17, 3, v1
    v_lshlrev_b32 v17, 3, v17
    v_bfe_u32 v20, v1, 2, 2
    v_lshl_add_u32 v17, v20, 7, v17
    v_lshrrev_b32 v20, 4, v1
    v_lshl_add_u32 v17, v20, 10, v17
    v_bfe_u32 v20, v1, 3, 2
    v_lshl_add_u32 v17, v20, 5, v17
    s_lshl_b32 s52, s44, 5
    v_xor_b32 v17, s52, v17
    v_lshlrev_b32 v18, 4, v0
    v_add_u32 v18, 12288, v18
    v_lshlrev_b32 v19, 3, v0
    v_add_u32 v19, 18432, v19
    v_cmp_gt_u32 vcc, 192, v0
    s_nop 1
    v_cndmask_b32 v18, v23, v18, vcc
    v_cndmask_b32 v19, v23, v19, vcc
    ds_write_b128 v12, v[16:19] offset:16384
    v_lshlrev_b32 v16, 3, v26
    v_add_u32 v16, 20224, v16
    v_cmp_gt_u32 vcc, 5, v26
    s_nop 1
    v_cndmask_b32 v16, v23, v16, vcc
    v_cmp_gt_u32 vcc, 192, v0
    s_nop 1
    v_cndmask_b32 v16, v23, v16, vcc
    s_lshl_b32 s52, s57, 8
    s_lshl_b32 s54, s44, 6
    s_add_u32 s52, s52, s54
    s_add_u32 s52, s52, 133632
    s_cmp_eq_u32 s45, 0
    s_cselect_b32 s52, s52, 1879048192
    v_lshl_add_u32 v17, v24, 2, s52
    s_lshr_b32 s53, s57, 2
    s_lshr_b32 s51, s44, 1
    s_lshl_b32 s52, s57, 11
    s_lshl_b32 s54, s53, 13
    s_add_u32 s52, s52, s54
    s_mul_i32 s54, s51, 896
    s_add_u32 s52, s52, s54
    s_lshl_b32 s54, s44, 6
    s_add_u32 s52, s52, s54
    s_lshl_b32 s54, s45, 7
    s_add_u32 s52, s52, s54
    s_add_u32 s52, s52, 81920
    v_lshl_add_u32 v18, v24, 2, s52
    v_lshl_add_u32 v18, v25, 13, v18
    v_cmp_gt_u32 vcc, 32, v1
    s_nop 1
    v_cndmask_b32 v18, v23, v18, vcc
    v_lshlrev_b32 v19, 1, v0
    v_add_u32 v19, 96768, v19
    ds_write_b128 v12, v[16:19] offset:20480
    s_lshr_b32 s53, s48, 2
    s_mul_i32 s52, s7, 6144
    s_lshl_b32 s54, s44, 8
    s_add_u32 s52, s52, s54
    s_mul_i32 s54, s53, 3056
    s_add_u32 s52, s52, s54
    s_lshl_b32 s54, s48, 2
    s_add_u32 s52, s52, s54
    s_add_u32 s52, s52, 20480
    v_lshl_add_u32 v16, v1, 4, s52
    v_cmp_gt_u32 vcc, 16, v1
    s_nop 1
    v_cndmask_b32 v16, v23, v16, vcc
    s_lshl_b32 s52, s7, 6
    s_lshl_b32 s54, s48, 3
    s_add_u32 s52, s52, s54
    s_add_u32 s52, s52, 45056
    s_cmp_eq_u32 s44, 3
    s_cselect_b32 s52, s52, 1879048192
    v_mov_b32 v17, v23
    v_writelane_b32 v17, s52, 0
    s_mul_i32 s52, s48, 80
    v_add_u32 v20, s52, v29
    v_lshrrev_b32 v18, 5, v20
    v_lshlrev_b32 v18, 10, v18
    v_lshrrev_b32 v21, 8, v20
    v_lshl_add_u32 v18, v21, 13, v18
    v_and_b32 v21, 31, v20
    v_lshl_add_u32 v18, v21, 2, v18
    v_lshl_add_u32 v18, v28, 9, v18
    v_add_u32 v18, 81920, v18
    v_cmp_gt_u32 vcc, 80, v29
    s_nop 1
    v_cndmask_b32 v18, v23, v18, vcc
    v_lshlrev_b32 v19, 1, v29
    v_add_u32 v19, 96256, v19
    ds_write_b128 v12, v[16:19] offset:24576
    s_and_b32 s53, s2, 0xc7
    s_cmp_eq_u32 s53, 0
    s_mov_b32 s52, 131072
    s_cselect_b32 s52, s52, 1879048192
    v_lshl_add_u32 v16, v20, 2, s52
    v_lshlrev_b32 v19, 1, v20
    s_and_b32 vcc_hi, vcc_hi, 0
    s_nop 1
    v_cndmask_b32 v16, v23, v16, vcc
    v_cndmask_b32 v19, v23, v19, vcc
    v_and_b32 v21, 3, v1
    v_lshrrev_b32 v17, 4, v1
    v_bfe_u32 v18, v1, 2, 2
    v_lshlrev_b32 v21, 3, v21
    v_mul_u32_u24 v18, 384, v18
    v_add_u32 v21, v21, v18
    v_bfe_u32 v18, v1, 3, 2
    v_xor_b32 v18, s44, v18
    v_lshl_add_u32 v21, v18, 5, v21
    v_add_u32 v21, 65536, v21
    v_and_b32 v18, 1, v17
    v_mul_u32_u24 v17, 3072, v17
    v_mul_u32_u24 v18, 3072, v18
    v_add_u32 v17, v17, v21
    v_add_u32 v18, v18, v21
    ds_write_b128 v12, v[16:19] offset:28672
    s_branch ENTRY0
HOOKL:
    s_cmp_lt_u32 s46, 30
    s_cbranch_scc1 NOGSW
    v_mov_b32 v30, 20224
GSW:
    buffer_load_dword v31, v30, s[16:19], s96 offen sc1
    s_waitcnt vmcnt(0)
    v_cmp_u_f32 vcc, v31, v31
    s_cbranch_vccz NOGSW
    s_add_u32 s51, s51, 1
    s_sleep 2
    s_cmp_lt_u32 s51, 0x8000
    s_cbranch_scc1 GSW
NOGSW:
    s_cmp_ge_u32 s46, 30
    s_cselect_b32 s53, 10, 0
    s_sub_u32 s53, s46, s53
    v_min_u32 v31, 17, v1
    v_lshlrev_b32 v31, 7, v31
    s_mul_i32 s52, s45, 45312
    s_mul_i32 s54, s53, 2304
    s_add_u32 s52, s52, s54
    s_add_u32 s52, s52, 524288
    buffer_load_dword v31, v31, s[16:19], s52 offen sc1
    v_lshlrev_b32 v30, 3, v0
    s_mul_i32 s52, s47, 12288
    s_add_u32 s52, s52, 1441792
    s_add_u32 s53, s52, 0
    buffer_load_dwordx2 v[32:33], v30, s[16:19], s53 offen offset:0 sc1
    buffer_load_dwordx2 v[34:35], v30, s[16:19], s53 offen offset:1536 sc1
    s_add_u32 s53, s52, 3072
    buffer_load_dwordx2 v[36:37], v30, s[16:19], s53 offen offset:0 sc1
    buffer_load_dwordx2 v[38:39], v30, s[16:19], s53 offen offset:1536 sc1
    s_add_u32 s53, s52, 6144
    buffer_load_dwordx2 v[40:41], v30, s[16:19], s53 offen offset:0 sc1
    buffer_load_dwordx2 v[42:43], v30, s[16:19], s53 offen offset:1536 sc1
    s_add_u32 s53, s52, 9216
    buffer_load_dwordx2 v[26:27], v30, s[16:19], s53 offen offset:0 sc1
    buffer_load_dwordx2 v[28:29], v30, s[16:19], s53 offen offset:1536 sc1
    s_sleep 20
    s_mov_b32 s51, 0
    s_branch GYB
QCA:
    v_lshlrev_b32 v30, 3, v0
    s_mul_i32 s52, s47, 12288
    s_add_u32 s52, s52, 1441792
    s_add_u32 s53, s52, 0
    buffer_load_dwordx2 v[32:33], v30, s[16:19], s53 offen offset:0 sc1
    buffer_load_dwordx2 v[34:35], v30, s[16:19], s53 offen offset:1536 sc1
    s_add_u32 s53, s52, 3072
    buffer_load_dwordx2 v[36:37], v30, s[16:19], s53 offen offset:0 sc1
    buffer_load_dwordx2 v[38:39], v30, s[16:19], s53 offen offset:1536 sc1
    s_add_u32 s53, s52, 6144
    buffer_load_dwordx2 v[40:41], v30, s[16:19], s53 offen offset:0 sc1
    buffer_load_dwordx2 v[42:43], v30, s[16:19], s53 offen offset:1536 sc1
    s_add_u32 s53, s52, 9216
    buffer_load_dwordx2 v[26:27], v30, s[16:19], s53 offen offset:0 sc1
    buffer_load_dwordx2 v[28:29], v30, s[16:19], s53 offen offset:1536 sc1
    s_waitcnt vmcnt(0)
    s_add_u32 s51, s51, 1
    s_sleep 2
    s_cmp_lt_u32 s51, 0x8000
    s_cbranch_scc1 QCP
    s_branch Y2W
Y2P:
    buffer_load_dword v22, v16, s[16:19], s55 offen offset:0 sc1
    buffer_load_dword v23, v16, s[16:19], s55 offen offset:128 sc1
    buffer_load_dword v24, v16, s[16:19], s55 offen offset:256 sc1
    buffer_load_dword v25, v16, s[16:19], s55 offen offset:384 sc1
    s_branch Y2W
AGY2P:
    s_add_u32 s51, s51, 1
    s_sleep 1
    s_cmp_lt_u32 s51, 0x8000
    s_cbranch_scc1 Y2P
    s_branch OKY2P
Q0L:
    v_and_b32 v21, 3, v1
    v_lshrrev_b32 v19, 4, v1
    v_bfe_u32 v20, v1, 2, 2
    v_lshlrev_b32 v21, 3, v21
    v_mul_u32_u24 v20, 384, v20
    v_add_u32 v21, v21, v20
    v_bfe_u32 v20, v1, 3, 2
    v_xor_b32 v20, s44, v20
    v_lshl_add_u32 v21, v20, 5, v21
    v_add_u32 v21, 65536, v21
    v_and_b32 v20, 1, v19
    v_mul_u32_u24 v19, 3072, v19
    v_mul_u32_u24 v20, 3072, v20
    v_add_u32 v19, v19, v21
    v_add_u32 v20, v20, v21
    s_branch QTR
HOOKA:
    s_mov_b64 exec, 0xffff
    s_nop 3
    s_lshl_b32 s52, s44, 6
    s_add_u32 s52, s52, 98816
    v_lshl_add_u32 v14, v1, 2, s52
    ds_write_b32 v14, v17 offset:10752
    v_fma_f32 v16, -v84, v17, v16
    v_mul_f32 v16, v16, v85
    ds_write_b32 v14, v16 offset:0
    ds_write_b32 v14, v21 offset:11008
    v_fma_f32 v20, -v84, v21, v20
    v_mul_f32 v20, v20, v85
    ds_write_b32 v14, v20 offset:256
    ds_write_b32 v14, v25 offset:11264
    v_fma_f32 v24, -v84, v25, v24
    v_mul_f32 v24, v24, v85
    ds_write_b32 v14, v24 offset:512
    s_mov_b64 exec, -1
    s_add_u32 s44, s44, 1
    s_cmp_lt_u32 s44, 4
    s_cbranch_scc1 Q0L
    s_mov_b32 s44, 3
    v_lshlrev_b32 v14, 2, v1
    v_add_u32 v14, 98816, v14
    ds_read2st64_b32 v[16:17], v14 offset0:0 offset1:1
    ds_read_b32 v18, v14 offset:512
    s_lshl_b32 s52, s47, 13
    s_lshl_b32 s54, s48, 10
    s_add_u32 s52, s52, s54
    s_add_u32 s52, s52, 1114112
    s_waitcnt lgkmcnt(0)
    v_bitop3_b32 v19, v16, v17, v18 bitop3:0x96
    v_xor_b32 v19, v19, v89
    buffer_store_dwordx4 v[16:19], v88, s[16:19], s52 offen sc1
    s_sleep 24
    v_and_b32 v15, 0xe1, v1
    v_lshlrev_b32 v15, 1, v15
    v_bfe_u32 v14, v1, 4, 1
    v_lshl_add_u32 v15, v14, 3, v15
    v_bfe_u32 v14, v1, 3, 1
    v_lshl_add_u32 v15, v14, 4, v15
    v_bfe_u32 v14, v1, 2, 1
    v_lshl_add_u32 v15, v14, 2, v15
    v_bfe_u32 v14, v1, 1, 1
    v_lshl_add_u32 v15, v14, 5, v15
    v_add_u32 v15, 98304, v15
    s_lshl_b32 s52, s47, 13
    s_add_u32 s52, s52, 1114112
    s_add_u32 s53, s52, 4096
    s_mov_b32 s51, 0
Q0P:
    buffer_load_dwordx4 v[16:19], v88, s[16:19], s52 offen offset:0 sc1
    buffer_load_dwordx4 v[20:23], v88, s[16:19], s52 offen offset:1024 sc1
    buffer_load_dwordx4 v[24:27], v88, s[16:19], s52 offen offset:2048 sc1
    buffer_load_dwordx4 v[28:31], v88, s[16:19], s52 offen offset:3072 sc1
    buffer_load_dwordx4 v[32:35], v88, s[16:19], s53 offen offset:0 sc1
    buffer_load_dwordx4 v[36:39], v88, s[16:19], s53 offen offset:1024 sc1
    buffer_load_dwordx4 v[40:43], v88, s[16:19], s53 offen offset:2048 sc1
    buffer_load_dwordx4 v[44:47], v88, s[16:19], s53 offen offset:3072 sc1
    v_mov_b32 v48, 0
    s_waitcnt vmcnt(0)
    v_bitop3_b32 v49, v16, v17, v18 bitop3:0x96
    v_bitop3_b32 v49, v49, v19, v89 bitop3:0x96
    v_or_b32 v48, v48, v49
    v_bitop3_b32 v49, v20, v21, v22 bitop3:0x96
    v_bitop3_b32 v49, v49, v23, v89 bitop3:0x96
    v_or_b32 v48, v48, v49
    v_bitop3_b32 v49, v24, v25, v26 bitop3:0x96
    v_bitop3_b32 v49, v49, v27, v89 bitop3:0x96
    v_or_b32 v48, v48, v49
    v_bitop3_b32 v49, v28, v29, v30 bitop3:0x96
    v_bitop3_b32 v49, v49, v31, v89 bitop3:0x96
    v_or_b32 v48, v48, v49
    v_bitop3_b32 v49, v32, v33, v34 bitop3:0x96
    v_bitop3_b32 v49, v49, v35, v89 bitop3:0x96
    v_or_b32 v48, v48, v49
    v_bitop3_b32 v49, v36, v37, v38 bitop3:0x96
    v_bitop3_b32 v49, v49, v39, v89 bitop3:0x96
    v_or_b32 v48, v48, v49
    v_bitop3_b32 v49, v40, v41, v42 bitop3:0x96
    v_bitop3_b32 v49, v49, v43, v89 bitop3:0x96
    v_or_b32 v48, v48, v49
    v_bitop3_b32 v49, v44, v45, v46 bitop3:0x96
    v_bitop3_b32 v49, v49, v47, v89 bitop3:0x96
    v_or_b32 v48, v48, v49
    v_cmp_ne_u32 vcc, 0, v48
    s_cbranch_vccz Q0OK
    s_add_u32 s51, s51, 1
    s_sleep 4
    s_cmp_lt_u32 s51, 0x8000
    s_cbranch_scc1 Q0P
Q0OK:
    v_pk_add_f32 v[16:17], v[16:17], v[20:21]
    v_add_f32 v18, v18, v22
    v_pk_add_f32 v[16:17], v[16:17], v[24:25]
    v_add_f32 v18, v18, v26
    v_pk_add_f32 v[16:17], v[16:17], v[28:29]
    v_add_f32 v18, v18, v30
    v_pk_add_f32 v[16:17], v[16:17], v[32:33]
    v_add_f32 v18, v18, v34
    v_pk_add_f32 v[16:17], v[16:17], v[36:37]
    v_add_f32 v18, v18, v38
    v_pk_add_f32 v[16:17], v[16:17], v[40:41]
    v_add_f32 v18, v18, v42
    v_pk_add_f32 v[16:17], v[16:17], v[44:45]
    v_add_f32 v18, v18, v46
    v_cvt_pk_bf16_f32 v16, v16, v17
    v_cvt_pk_bf16_f32 v18, v18, v18
    ds_write_b16 v15, v16
    ds_write_b16_d16_hi v15, v16 offset:128
    ds_write_b16 v15, v18 offset:256
    s_mov_b32 s51, 0
HSP:
    s_mov_b32 s52, 1376256
    buffer_load_dwordx4 v[24:27], v88, s[16:19], s52 offen sc1
    s_waitcnt vmcnt(0)
    v_xor_b32 v20, s5, v24
    v_xor_b32 v21, s5, v25
    v_xor_b32 v22, s5, v26
    v_xor_b32 v23, s5, v27
    v_or3_b32 v20, v20, v21, v22
    v_or_b32 v20, v20, v23
    v_cmp_lt_u32 vcc, 31, v20
    s_cbranch_vccz HSOK
    s_add_u32 s51, s51, 1
    s_sleep 8
    s_cmp_lt_u32 s51, 0x8000
    s_cbranch_scc1 HSP
HSOK:
    s_mov_b32 s53, 0
    v_and_b32 v24, 16, v24
    v_cmp_ne_u32 vcc, 0, v24
    s_bcnt1_i32_b64 s52, vcc
    s_add_u32 s53, s53, s52
    v_and_b32 v25, 16, v25
    v_cmp_ne_u32 vcc, 0, v25
    s_bcnt1_i32_b64 s52, vcc
    s_add_u32 s53, s53, s52
    v_and_b32 v26, 16, v26
    v_cmp_ne_u32 vcc, 0, v26
    s_bcnt1_i32_b64 s52, vcc
    s_add_u32 s53, s53, s52
    v_and_b32 v27, 16, v27
    v_cmp_ne_u32 vcc, 0, v27
    s_bcnt1_i32_b64 s52, vcc
    s_add_u32 s53, s53, s52
    v_and_b32 v20, 15, v20
    s_cmp_gt_u32 s53, 128
    s_cselect_b32 s53, 2, 0
    s_lshr_b32 s52, s5, 1
    s_xor_b32 s53, s53, s52
    s_and_b32 s53, s53, 2
    s_lshl_b32 s52, s45, 3
    v_cmp_ne_u32 vcc, 0, v20
    s_lshr_b64 s[60:61], vcc, s52
    s_and_b32 s52, s60, 0xff
    s_cselect_b32 s50, 0, 1
    v_mov_b32 v38, 98784
    s_or_b32 s53, s53, s50
    v_or_b32 v39, s53, v89
    ds_write_b32 v38, v39
    v_and_b32 v21, 0xffff0000, v86
    v_lshlrev_b32 v20, 16, v86
    buffer_store_dwordx2 v[20:21], v87, s[16:19], 0 offen sc1
    s_branch TABLES
EN3:
    v_mov_b64 v[72:73], 0
    v_mov_b64 v[74:75], 0
    v_mov_b64 v[76:77], 0
    v_mov_b64 v[78:79], 0
    v_mov_b64 v[40:41], 0
    v_mov_b64 v[42:43], 0
    v_mov_b64 v[44:45], 0
    v_mov_b64 v[46:47], 0
    v_mov_b64 v[48:49], 0
    v_mov_b64 v[50:51], 0
    s_branch ENOK2
ENTRY0:
    ds_read_b64 v[14:15], v12 offset:0
    ds_read_b64 v[60:61], v12 offset:8
    v_mov_b64 v[64:65], 0
    v_mov_b64 v[66:67], 0
    v_mov_b64 v[68:69], 0
    v_mov_b64 v[70:71], 0
    v_mov_b64 v[72:73], 0
    v_mov_b64 v[74:75], 0
    v_mov_b64 v[76:77], 0
    v_mov_b64 v[78:79], 0
    v_mov_b64 v[40:41], 0
    v_mov_b64 v[42:43], 0
    v_mov_b64 v[44:45], 0
    v_mov_b64 v[46:47], 0
    v_mov_b64 v[48:49], 0
    v_mov_b64 v[50:51], 0
    s_cmp_lg_u32 s44, 3
    s_cbranch_scc1 QFRAG
    s_waitcnt lgkmcnt(0)
    s_barrier
    s_waitcnt vmcnt(23)
    buffer_load_dwordx4 a[0:3], v80, s[8:11], s96 offen offset:0 nt
    s_waitcnt vmcnt(23)
    buffer_load_dwordx4 a[8:11], v80, s[8:11], s96 offen offset:128 nt
    s_waitcnt vmcnt(23)
    buffer_load_dwordx4 a[16:19], v80, s[8:11], s96 offen offset:256 nt
    s_add_u32 s96, s96, s97
    s_waitcnt vmcnt(23)
    buffer_load_dwordx4 a[4:7], v80, s[8:11], s96 offen offset:0 nt
    s_waitcnt vmcnt(23)
    buffer_load_dwordx4 a[12:15], v80, s[8:11], s96 offen offset:128 nt
    s_waitcnt vmcnt(23)
    buffer_load_dwordx4 a[20:23], v80, s[8:11], s96 offen offset:256 nt
    s_add_u32 s96, s96, s97
    s_waitcnt vmcnt(23)
    buffer_load_dwordx4 a[24:27], v80, s[8:11], s96 offen offset:0 nt
    s_waitcnt vmcnt(23)
    buffer_load_dwordx4 a[32:35], v80, s[8:11], s96 offen offset:128 nt
    s_waitcnt vmcnt(23)
    buffer_load_dwordx4 a[40:43], v80, s[8:11], s96 offen offset:256 nt
    s_add_u32 s96, s96, s97
    s_waitcnt vmcnt(23)
    buffer_load_dwordx4 a[28:31], v80, s[8:11], s96 offen offset:0 nt
    s_waitcnt vmcnt(23)
    buffer_load_dwordx4 a[36:39], v80, s[8:11], s96 offen offset:128 nt
    s_waitcnt vmcnt(23)
    buffer_load_dwordx4 a[44:47], v80, s[8:11], s96 offen offset:256 nt
    s_add_u32 s96, s96, s97
    s_waitcnt vmcnt(23)
    buffer_load_dwordx4 a[48:51], v80, s[8:11], s96 offen offset:0 nt
    s_waitcnt vmcnt(23)
    buffer_load_dwordx4 a[56:59], v80, s[8:11], s96 offen offset:128 nt
    s_waitcnt vmcnt(23)
    buffer_load_dwordx4 a[64:67], v80, s[8:11], s96 offen offset:256 nt
    s_add_u32 s96, s96, s97
    s_waitcnt vmcnt(23)
    buffer_load_dwordx4 a[52:55], v80, s[8:11], s96 offen offset:0 nt
    s_waitcnt vmcnt(23)
    buffer_load_dwordx4 a[60:63], v80, s[8:11], s96 offen offset:128 nt
    s_waitcnt vmcnt(23)
    buffer_load_dwordx4 a[68:71], v80, s[8:11], s96 offen offset:256 nt
    s_add_u32 s96, s96, s97
    s_waitcnt vmcnt(23)
    buffer_load_dwordx4 a[72:75], v80, s[8:11], s96 offen offset:0 nt
    s_waitcnt vmcnt(23)
    buffer_load_dwordx4 a[80:83], v80, s[8:11], s96 offen offset:128 nt
    s_waitcnt vmcnt(23)
    buffer_load_dwordx4 a[88:91], v80, s[8:11], s96 offen offset:256 nt
    s_add_u32 s96, s96, s97
    s_waitcnt vmcnt(23)
    buffer_load_dwordx4 a[76:79], v80, s[8:11], s96 offen offset:0 nt
    s_waitcnt vmcnt(23)
    buffer_load_dwordx4 a[84:87], v80, s[8:11], s96 offen offset:128 nt
    s_waitcnt vmcnt(23)
    buffer_load_dwordx4 a[92:95], v80, s[8:11], s96 offen offset:256 nt
    s_add_u32 s96, s96, s97
    s_waitcnt vmcnt(23)
    buffer_load_dwordx4 a[96:99], v80, s[8:11], s96 offen offset:0 nt
    s_waitcnt vmcnt(23)
    buffer_load_dwordx4 a[104:107], v80, s[8:11], s96 offen offset:128 nt
    s_waitcnt vmcnt(23)
    buffer_load_dwordx4 a[112:115], v80, s[8:11], s96 offen offset:256 nt
    s_add_u32 s96, s96, s97
    s_waitcnt vmcnt(23)
    buffer_load_dwordx4 a[100:103], v80, s[8:11], s96 offen offset:0 nt
    s_waitcnt vmcnt(23)
    buffer_load_dwordx4 a[108:111], v80, s[8:11], s96 offen offset:128 nt
    s_waitcnt vmcnt(23)
    buffer_load_dwordx4 a[116:119], v80, s[8:11], s96 offen offset:256 nt
    s_add_u32 s96, s96, s97
    s_waitcnt vmcnt(23)
    buffer_load_dwordx4 a[120:123], v80, s[8:11], s96 offen offset:0 nt
    s_waitcnt vmcnt(23)
    buffer_load_dwordx4 a[128:131], v80, s[8:11], s96 offen offset:128 nt
    s_waitcnt vmcnt(23)
    buffer_load_dwordx4 a[136:139], v80, s[8:11], s96 offen offset:256 nt
    s_add_u32 s96, s96, s97
    s_waitcnt vmcnt(23)
    buffer_load_dwordx4 a[124:127], v80, s[8:11], s96 offen offset:0 nt
    s_waitcnt vmcnt(23)
    buffer_load_dwordx4 a[132:135], v80, s[8:11], s96 offen offset:128 nt
    s_waitcnt vmcnt(23)
    buffer_load_dwordx4 a[140:143], v80, s[8:11], s96 offen offset:256 nt
    s_add_u32 s96, s96, s97
    s_waitcnt vmcnt(23)
    buffer_load_dwordx4 a[144:147], v80, s[8:11], s96 offen offset:0 nt
    s_waitcnt vmcnt(23)
    buffer_load_dwordx4 a[152:155], v80, s[8:11], s96 offen offset:128 nt
    s_waitcnt vmcnt(23)
    buffer_load_dwordx4 a[160:163], v80, s[8:11], s96 offen offset:256 nt
    s_add_u32 s96, s96, s97
    s_waitcnt vmcnt(23)
    buffer_load_dwordx4 a[148:151], v80, s[8:11], s96 offen offset:0 nt
    s_waitcnt vmcnt(23)
    buffer_load_dwordx4 a[156:159], v80, s[8:11], s96 offen offset:128 nt
    s_waitcnt vmcnt(23)
    buffer_load_dwordx4 a[164:167], v80, s[8:11], s96 offen offset:256 nt
    s_add_u32 s96, s96, s97
    s_waitcnt vmcnt(23)
    buffer_load_dwordx4 a[168:171], v80, s[8:11], s96 offen offset:0 nt
    s_waitcnt vmcnt(23)
    buffer_load_dwordx4 a[176:179], v80, s[8:11], s96 offen offset:128 nt
    s_waitcnt vmcnt(23)
    buffer_load_dwordx4 a[184:187], v80, s[8:11], s96 offen offset:256 nt
    s_add_u32 s96, s96, s97
    s_waitcnt vmcnt(23)
    buffer_load_dwordx4 a[172:175], v80, s[8:11], s96 offen offset:0 nt
    s_waitcnt vmcnt(23)
    buffer_load_dwordx4 a[180:183], v80, s[8:11], s96 offen offset:128 nt
    s_waitcnt vmcnt(23)
    buffer_load_dwordx4 a[188:191], v80, s[8:11], s96 offen offset:256 nt
    s_lshl_b32 s97, s97, 1
    s_waitcnt vmcnt(23)
    buffer_load_dwordx4 a[192:195], v82, s[12:15], s55 offen offset:0 nt
    s_waitcnt vmcnt(23)
    buffer_load_dwordx4 a[200:203], v82, s[12:15], s55 offen offset:128 nt
    s_waitcnt vmcnt(23)
    buffer_load_dwordx4 a[208:211], v82, s[12:15], s55 offen offset:256 nt
    s_waitcnt vmcnt(23)
    buffer_load_dwordx4 a[216:219], v82, s[12:15], s55 offen offset:384 nt
    s_waitcnt vmcnt(23)
    buffer_load_dwordx4 a[224:227], v82, s[12:15], s55 offen offset:512 nt
    s_waitcnt vmcnt(23)
    buffer_load_dwordx4 a[232:235], v82, s[12:15], s55 offen offset:640 nt
    s_add_u32 s55, s55, s97
    s_waitcnt vmcnt(23)
    buffer_load_dwordx4 a[196:199], v82, s[12:15], s55 offen offset:0 nt
    s_waitcnt vmcnt(23)
    buffer_load_dwordx4 a[204:207], v82, s[12:15], s55 offen offset:128 nt
    s_waitcnt vmcnt(23)
    buffer_load_dwordx4 a[212:215], v82, s[12:15], s55 offen offset:256 nt
    s_waitcnt vmcnt(23)
    buffer_load_dwordx4 a[220:223], v82, s[12:15], s55 offen offset:384 nt
    s_waitcnt vmcnt(23)
    buffer_load_dwordx4 a[228:231], v82, s[12:15], s55 offen offset:512 nt
    s_waitcnt vmcnt(23)
    buffer_load_dwordx4 a[236:239], v82, s[12:15], s55 offen offset:640 nt
    s_add_u32 s55, s55, s97
    s_waitcnt vmcnt(23)
    buffer_load_dwordx4 a[240:243], v82, s[12:15], s55 offen offset:0 nt
    s_waitcnt vmcnt(23)
    buffer_load_dwordx4 a[248:251], v82, s[12:15], s55 offen offset:128 nt
    s_waitcnt vmcnt(23)
    buffer_load_dwordx4 v[128:131], v82, s[12:15], s55 offen offset:256 nt
    s_waitcnt vmcnt(23)
    buffer_load_dwordx4 v[136:139], v82, s[12:15], s55 offen offset:384 nt
    s_waitcnt vmcnt(23)
    buffer_load_dwordx4 v[144:147], v82, s[12:15], s55 offen offset:512 nt
    s_waitcnt vmcnt(23)
    buffer_load_dwordx4 v[152:155], v82, s[12:15], s55 offen offset:640 nt
    s_add_u32 s55, s55, s97
    s_waitcnt vmcnt(23)
    buffer_load_dwordx4 a[244:247], v82, s[12:15], s55 offen offset:0 nt
    s_waitcnt vmcnt(23)
    buffer_load_dwordx4 a[252:255], v82, s[12:15], s55 offen offset:128 nt
    s_waitcnt vmcnt(23)
    buffer_load_dwordx4 v[132:135], v82, s[12:15], s55 offen offset:256 nt
    s_waitcnt vmcnt(23)
    buffer_load_dwordx4 v[140:143], v82, s[12:15], s55 offen offset:384 nt
    s_waitcnt vmcnt(23)
    buffer_load_dwordx4 v[148:151], v82, s[12:15], s55 offen offset:512 nt
    s_waitcnt vmcnt(23)
    buffer_load_dwordx4 v[156:159], v82, s[12:15], s55 offen offset:640 nt
    s_add_u32 s55, s55, s97
    s_waitcnt vmcnt(23)
    buffer_load_dwordx4 v[160:163], v82, s[12:15], s55 offen offset:0 nt
    s_waitcnt vmcnt(23)
    buffer_load_dwordx4 v[168:171], v82, s[12:15], s55 offen offset:128 nt
    s_waitcnt vmcnt(23)
    buffer_load_dwordx4 v[176:179], v82, s[12:15], s55 offen offset:256 nt
    s_waitcnt vmcnt(23)
    buffer_load_dwordx4 v[184:187], v82, s[12:15], s55 offen offset:384 nt
    s_waitcnt vmcnt(23)
    buffer_load_dwordx4 v[192:195], v82, s[12:15], s55 offen offset:512 nt
    s_waitcnt vmcnt(23)
    buffer_load_dwordx4 v[200:203], v82, s[12:15], s55 offen offset:640 nt
    s_add_u32 s55, s55, s97
    s_waitcnt vmcnt(23)
    buffer_load_dwordx4 v[164:167], v82, s[12:15], s55 offen offset:0 nt
    s_waitcnt vmcnt(23)
    buffer_load_dwordx4 v[172:175], v82, s[12:15], s55 offen offset:128 nt
    s_waitcnt vmcnt(23)
    buffer_load_dwordx4 v[180:183], v82, s[12:15], s55 offen offset:256 nt
    s_waitcnt vmcnt(23)
    buffer_load_dwordx4 v[188:191], v82, s[12:15], s55 offen offset:384 nt
    s_waitcnt vmcnt(23)
    buffer_load_dwordx4 v[196:199], v82, s[12:15], s55 offen offset:512 nt
    s_waitcnt vmcnt(23)
    buffer_load_dwordx4 v[204:207], v82, s[12:15], s55 offen offset:640 nt
    s_add_u32 s55, s55, s97
    s_waitcnt vmcnt(23)
    buffer_load_dwordx4 v[208:211], v82, s[12:15], s55 offen offset:0 nt
    s_waitcnt vmcnt(23)
    buffer_load_dwordx4 v[216:219], v82, s[12:15], s55 offen offset:128 nt
    s_waitcnt vmcnt(23)
    buffer_load_dwordx4 v[224:227], v82, s[12:15], s55 offen offset:256 nt
    s_waitcnt vmcnt(23)
    buffer_load_dwordx4 v[232:235], v82, s[12:15], s55 offen offset:384 nt
    s_waitcnt vmcnt(23)
    buffer_load_dwordx4 v[240:243], v82, s[12:15], s55 offen offset:512 nt
    s_waitcnt vmcnt(23)
    buffer_load_dwordx4 v[248:251], v82, s[12:15], s55 offen offset:640 nt
    s_add_u32 s55, s55, s97
    s_barrier
    s_waitcnt vmcnt(23)
    buffer_load_dwordx4 v[212:215], v82, s[12:15], s55 offen offset:0 nt
    s_waitcnt vmcnt(23)
    buffer_load_dwordx4 v[220:223], v82, s[12:15], s55 offen offset:128 nt
    s_waitcnt vmcnt(23)
    buffer_load_dwordx4 v[228:231], v82, s[12:15], s55 offen offset:256 nt
    s_waitcnt vmcnt(23)
    buffer_load_dwordx4 v[236:239], v82, s[12:15], s55 offen offset:384 nt
    s_waitcnt vmcnt(23)
    buffer_load_dwordx4 v[244:247], v82, s[12:15], s55 offen offset:512 nt
    s_waitcnt vmcnt(23)
    buffer_load_dwordx4 v[252:255], v82, s[12:15], s55 offen offset:640 nt
    s_branch QFRAG
HOOKF:
    v_mov_b32 v52, 98784
    ds_read_b32 v52, v52
    s_mov_b32 s6, 0
    s_waitcnt lgkmcnt(0)
    v_readfirstlane_b32 s101, v52
    s_and_b32 s50, s101, 1
    s_and_b32 s0, s101, 2
    s_lshl_b32 s0, s0, 12
    s_and_b32 s101, s101, 0xffffffe0
    s_cmp_lg_u32 s50, 0
    s_cselect_b32 s32, s62, 1610612736
    s_cselect_b32 s33, 1610612736, s62
    s_cmp_lg_u32 s50, 0
    s_cselect_b32 s34, s49, 1610612736
    s_cselect_b32 s35, 1610612736, s49
    s_add_u32 s99, s49, s0
    s_xor_b32 s1, s99, 8192
    s_waitcnt vmcnt(48)
    s_branch QK
AGENP:
    s_add_u32 s51, s51, 1
    s_cmp_lt_u32 s51, 0x8000
    s_cbranch_scc1 ENP
    s_branch OKENP
HOOKC:
    s_cmp_eq_u32 s44, 3
    s_cbranch_scc1 EXB
    v_min_u32 v83, 8, v1
    v_lshlrev_b32 v83, 7, v83
    s_mul_i32 s52, s45, 28160
    s_mul_i32 s54, s46, 1152
    s_add_u32 s52, s52, s54
    s_add_u32 s52, s52, 131072
    buffer_load_dword v83, v83, s[16:19], s52 offen sc1
    v_lshrrev_b32 v58, 3, v1
    v_and_b32 v57, 7, v1
    v_and_b32 v56, 2, v58
    v_xor_b32 v57, v57, v56
    s_and_b32 s52, s44, 1
    s_lshl_b32 s52, s52, 2
    v_xor_b32 v57, s52, v57
    v_mul_u32_u24 v56, 3072, v58
    v_lshl_add_u32 v56, v57, 4, v56
    v_lshrrev_b32 v58, 3, v1
    v_and_b32 v57, 7, v1
    v_and_b32 v55, 2, v58
    v_xor_b32 v57, v57, v55
    s_and_b32 s52, s44, 1
    s_lshl_b32 s52, s52, 2
    v_xor_b32 v57, s52, v57
    v_mul_u32_u24 v55, 1280, v58
    v_lshl_add_u32 v55, v57, 4, v55
    s_barrier
    s_cmp_ge_u32 s46, 20
    s_cbranch_scc1 HC8
    s_mul_i32 s52, s45, 983040
    s_mul_i32 s54, s56, 491520
    s_add_u32 s52, s52, s54
    s_lshl_b32 s54, s57, 7
    s_add_u32 s52, s52, s54
    s_mul_i32 s54, s44, 10240
    s_add_u32 s52, s52, s54
    s_lshl_b32 s53, s44, 10
DMA1:
    s_mov_b32 m0, s53
    s_add_u32 s53, s53, 3072
    buffer_load_dwordx4 v55, s[24:27], s52 offen nt lds
    v_xor_b32 v55, 64, v55
    s_add_u32 s52, s52, 30720
    s_cmp_lt_u32 s53, 49152
    s_cbranch_scc1 DMA1
HC8:
    s_cmp_ge_u32 s46, 30
    s_cbranch_scc1 HC7
    s_mul_i32 s52, s3, 393216
    s_mul_i32 s54, s45, 384
    s_add_u32 s52, s52, s54
    s_lshl_b32 s54, s59, 7
    s_add_u32 s52, s52, s54
    s_mul_i32 s54, s44, 24576
    s_add_u32 s52, s52, s54
    s_lshl_b32 s53, s44, 10
    s_add_u32 s53, s53, 49152
DMA2:
    s_mov_b32 m0, s53
    s_add_u32 s53, s53, 3072
    buffer_load_dwordx4 v56, s[28:31], s52 offen nt lds
    v_xor_b32 v56, 64, v56
    s_add_u32 s52, s52, 73728
    s_cmp_lt_u32 s53, 65536
    s_cbranch_scc1 DMA2
HC7:
    s_branch EXB
HOOKG:
    s_cmp_lg_u32 s49, 0
    s_cbranch_scc1 WOX
    s_cmp_ge_u32 s46, 20
    s_cbranch_scc1 HOOKG3
    v_and_b32 v72, 3, v1
    v_lshlrev_b32 v72, 3, v72
    v_bfe_u32 v73, v1, 2, 2
    v_lshl_add_u32 v72, v73, 7, v72
    v_lshrrev_b32 v73, 4, v1
    v_lshl_add_u32 v72, v73, 10, v72
    v_bfe_u32 v73, v1, 3, 2
    v_lshl_add_u32 v72, v73, 5, v72
    s_mul_i32 s52, s44, 12288
    v_add_u32 v72, s52, v72
    v_xor_b32 v73, 32, v72
    v_xor_b32 v74, 64, v72
    v_xor_b32 v75, 96, v72
    s_cmp_lg_u32 s44, 3
    s_cbranch_scc1 QCNA
    v_lshlrev_b32 v38, 2, v1
    v_add_u32 v39, 109568, v38
    v_lshlrev_b32 v38, 1, v38
    ds_read_b32 v32, v39 offset:0
    ds_read_b32 v34, v39 offset:256
    ds_read_b32 v36, v39 offset:512
    s_mul_i32 s52, s47, 12288
    s_mul_i32 s54, s48, 1536
    s_add_u32 s52, s52, s54
    s_add_u32 s52, s52, 1441792
    s_cmp_lg_u32 s50, 0
    s_cselect_b32 s53, s52, 1610612736
    s_cselect_b32 s54, 1610612736, s52
    s_waitcnt lgkmcnt(0)
    v_xor_b32 v33, s101, v32
    v_xor_b32 v35, s101, v34
    v_xor_b32 v37, s101, v36
    buffer_store_dwordx2 v[32:33], v38, s[16:19], s53 offen offset:0
    buffer_store_dwordx2 v[34:35], v38, s[16:19], s53 offen offset:512
    buffer_store_dwordx2 v[36:37], v38, s[16:19], s53 offen offset:1024
    s_cmp_eq_u32 s50, 0
    s_cbranch_scc1 SLOW4
PUBD4:
    s_branch QCMA
QCNA:
    s_waitcnt vmcnt(1)
QCMA:
    s_barrier
    buffer_load_dword v56, v65, s[16:19], s62 offen sc1
    buffer_load_dwordx4 v[44:47], v64, s[16:19], s62 offen offset:0 sc1
    buffer_load_dwordx4 v[48:51], v64, s[16:19], s62 offen offset:512 sc1
    buffer_load_dwordx4 v[52:55], v64, s[16:19], s62 offen offset:1024 sc1
    buffer_load_dword v57, v66, s[16:19], s49 offen sc1
    ds_read_b64_tr_b16 v[80:81], v72 offset:0
    ds_read_b64_tr_b16 v[82:83], v72 offset:512
    ds_read_b64_tr_b16 v[96:97], v72 offset:4096
    ds_read_b64_tr_b16 v[98:99], v72 offset:4608
    ds_read_b64_tr_b16 v[112:113], v72 offset:8192
    ds_read_b64_tr_b16 v[114:115], v72 offset:8704
    ds_read_b64_tr_b16 v[84:85], v73 offset:0
    ds_read_b64_tr_b16 v[86:87], v73 offset:512
    ds_read_b64_tr_b16 v[100:101], v73 offset:4096
    ds_read_b64_tr_b16 v[102:103], v73 offset:4608
    ds_read_b64_tr_b16 v[116:117], v73 offset:8192
    ds_read_b64_tr_b16 v[118:119], v73 offset:8704
    ds_read_b64_tr_b16 v[88:89], v74 offset:0
    ds_read_b64_tr_b16 v[90:91], v74 offset:512
    ds_read_b64_tr_b16 v[104:105], v74 offset:4096
    ds_read_b64_tr_b16 v[106:107], v74 offset:4608
    ds_read_b64_tr_b16 v[120:121], v74 offset:8192
    ds_read_b64_tr_b16 v[122:123], v74 offset:8704
    ds_read_b64_tr_b16 v[92:93], v75 offset:0
    ds_read_b64_tr_b16 v[94:95], v75 offset:512
    ds_read_b64_tr_b16 v[108:109], v75 offset:4096
    ds_read_b64_tr_b16 v[110:111], v75 offset:4608
    ds_read_b64_tr_b16 v[124:125], v75 offset:8192
    ds_read_b64_tr_b16 v[126:127], v75 offset:8704
    s_waitcnt lgkmcnt(0) vmcnt(0)
    s_branch WOC
HOOKG3:
    s_cmp_lg_u32 s44, 3
    s_cbranch_scc1 QCNB
    v_lshlrev_b32 v38, 2, v1
    v_add_u32 v39, 109568, v38
    v_lshlrev_b32 v38, 1, v38
    ds_read_b32 v32, v39 offset:0
    ds_read_b32 v34, v39 offset:256
    ds_read_b32 v36, v39 offset:512
    s_mul_i32 s52, s47, 12288
    s_mul_i32 s54, s48, 1536
    s_add_u32 s52, s52, s54
    s_add_u32 s52, s52, 1441792
    s_cmp_lg_u32 s50, 0
    s_cselect_b32 s53, s52, 1610612736
    s_cselect_b32 s54, 1610612736, s52
    s_waitcnt lgkmcnt(0)
    v_xor_b32 v33, s101, v32
    v_xor_b32 v35, s101, v34
    v_xor_b32 v37, s101, v36
    buffer_store_dwordx2 v[32:33], v38, s[16:19], s53 offen offset:0
    buffer_store_dwordx2 v[34:35], v38, s[16:19], s53 offen offset:512
    buffer_store_dwordx2 v[36:37], v38, s[16:19], s53 offen offset:1024
    s_cmp_eq_u32 s50, 0
    s_cbranch_scc1 SLOW5
PUBD5:
    s_branch QCMB
QCNB:
    s_waitcnt vmcnt(1)
QCMB:
    s_barrier
    s_cmp_lg_u32 s46, 31
    s_cbranch_scc1 EW1
    s_cmp_lg_u32 s44, 0
    s_cbranch_scc1 WOX
    v_and_b32 v32, 31, v1
    v_lshlrev_b32 v32, 2, v32
    v_add_u32 v32, 19968, v32
    s_lshl_b32 s52, s45, 7
    s_add_u32 s52, s52, 118784
    v_lshlrev_b32 v34, 13, v1
EWP:
    buffer_load_dword v33, v32, s[16:19], s62 offen sc1
    s_waitcnt vmcnt(0)
    v_cmp_u_f32 vcc, v33, v33
    s_cbranch_vccz EWOK
    s_add_u32 s51, s51, 1
    s_cmp_lt_u32 s51, 0x8000
    s_cbranch_scc1 EWP
EWOK:
    s_mov_b64 exec, 3
    buffer_store_dword v34, v34, s[16:19], s52 offen sc1
    s_mov_b64 exec, -1
EW1:
    s_cmp_ge_u32 s46, 30
    s_cbranch_scc1 WOX
    s_cmp_eq_u32 s44, 3
    s_cbranch_scc1 HD0
    v_lshrrev_b32 v33, 3, v1
    v_and_b32 v32, 7, v1
    v_and_b32 v34, 2, v33
    v_xor_b32 v32, v32, v34
    s_and_b32 s52, s44, 1
    s_lshl_b32 s52, s52, 2
    v_xor_b32 v32, s52, v32
    v_mul_u32_u24 v34, 1280, v33
    v_lshl_add_u32 v34, v32, 4, v34
    s_mul_i32 s52, s45, 245760
    s_lshl_b32 s54, s57, 7
    s_add_u32 s52, s52, s54
    s_mul_i32 s54, s44, 10240
    s_add_u32 s52, s52, s54
    s_lshl_b32 s53, s44, 10
DMA3:
    s_mov_b32 m0, s53
    s_add_u32 s53, s53, 3072
    buffer_load_dwordx4 v34, s[24:27], s52 offen nt lds
    v_xor_b32 v34, 64, v34
    s_add_u32 s52, s52, 30720
    s_cmp_lt_u32 s53, 24576
    s_cbranch_scc1 DMA3
HD0:
    v_mov_b64 v[116:117], -1
    v_mov_b64 v[118:119], -1
    v_mov_b32 v23, 1879048192
    s_mul_i32 s52, s57, 5120
    s_mul_i32 s54, s44, 1280
    s_add_u32 s52, s52, s54
    v_lshl_add_u32 v120, v1, 4, s52
    s_add_u32 s52, s52, 1024
    v_lshl_add_u32 v121, v1, 2, s52
    s_lshl_b32 s52, s57, 14
    s_lshl_b32 s54, s45, 11
    s_add_u32 s52, s52, s54
    s_lshl_b32 s54, s44, 9
    s_add_u32 s52, s52, s54
    v_lshl_add_u32 v122, v1, 3, s52
    v_cmp_gt_u32 vcc, 45312, v120
    s_nop 1
    v_cndmask_b32 v120, v23, v120, vcc
    v_cmp_gt_u32 vcc, 45312, v121
    s_nop 1
    v_cndmask_b32 v121, v23, v121, vcc
    v_cmp_gt_u32 vcc, 136192, v122
    s_nop 1
    v_cndmask_b32 v122, v23, v122, vcc
    s_branch F1E
AGWOP:
    s_add_u32 s51, s51, 1
    s_cmp_lt_u32 s51, 0x8000
    s_cbranch_scc1 WOP
    s_branch OKWOP
HOOKD:
    ds_read_b128 v[20:23], v2 offset:256
    ds_read_b128 v[24:27], v2 offset:320
    ds_read_b128 v[28:31], v2 offset:384
    ds_read_b128 v[32:35], v2 offset:448
    s_waitcnt lgkmcnt(0)
    v_mfma_f32_16x16x32_bf16 v[40:43], v[20:23], v[64:67], 0
    v_mfma_f32_16x16x32_bf16 v[40:43], v[24:27], v[68:71], v[40:43]
    v_mfma_f32_16x16x32_bf16 v[40:43], v[28:31], v[72:75], v[40:43]
    v_mfma_f32_16x16x32_bf16 v[40:43], v[32:35], v[76:79], v[40:43]
    s_add_u32 s52, s62, 8192
    s_cmp_lg_u32 s50, 0
    s_cselect_b32 s53, s52, 1610612736
    s_cselect_b32 s54, 1610612736, s52
    s_nop 3
    buffer_store_dword v41, v55, s[16:19], s53 offen offset:0
    s_cmp_eq_u32 s50, 0
    s_cbranch_scc1 SLOW6
PUBD6:
    v_and_b32 v16, 7, v1
    v_lshlrev_b32 v16, 7, v16
    s_add_u32 s52, s0, 118784
EWQ:
    buffer_load_dword v17, v16, s[16:19], s52 offen sc1
    s_waitcnt vmcnt(0)
    v_cmp_u_f32 vcc, v17, v17
    s_cbranch_vccz EWQK
    s_add_u32 s51, s51, 1
    s_sleep 1
    s_cmp_lt_u32 s51, 0x8000
    s_cbranch_scc1 EWQ
EWQK:
    s_sleep 1
    s_mov_b32 s51, 0
    s_cmp_lt_u32 s46, 20
    s_cbranch_scc1 F1W
    s_mov_b32 s100, 3
    s_cmp_lg_u32 s50, 0
    s_cselect_b32 s53, s63, 1610612736
    s_cselect_b32 s54, 1610612736, s63
    buffer_store_dwordx4 v[116:119], v120, s[16:19], s53 offen offset:0
    buffer_store_dword v116, v121, s[16:19], s53 offen offset:0
    s_cmp_eq_u32 s50, 0
    s_cbranch_scc1 SLOW7
PUBD7:
    s_mov_b32 s52, 393216
    buffer_store_dwordx2 v[116:117], v122, s[16:19], s52 offen sc1
F1P:
    s_cmp_lg_u32 s100, 3
    s_cbranch_scc1 F1W
    s_add_u32 s52, s62, 8192
    buffer_load_dwordx4 v[104:107], v58, s[16:19], s52 offen offset:0 sc1
    buffer_load_dwordx4 v[108:111], v58, s[16:19], s52 offen offset:3072 sc1
    buffer_load_dwordx2 v[112:113], v59, s[16:19], s52 offen sc1
    s_branch F1W
GCP:
    s_add_u32 s52, s62, 8192
    buffer_load_dwordx4 v[104:107], v58, s[16:19], s52 offen offset:0 sc1
    buffer_load_dwordx4 v[108:111], v58, s[16:19], s52 offen offset:3072 sc1
    buffer_load_dwordx2 v[112:113], v59, s[16:19], s52 offen sc1
    s_waitcnt vmcnt(0)
HOOKI:
    v_pk_add_f32 v[104:105], v[104:105], v[106:107]
    v_pk_add_f32 v[108:109], v[108:109], v[110:111]
    v_add_f32 v126, v104, v105
    v_add_f32 v127, v108, v109
    v_pk_add_f32 v[126:127], v[126:127], v[112:113]
    v_cmp_u_f32 vcc, v126, v127
    s_cbranch_vccz GCOK
    s_add_u32 s51, s51, 1
    s_cmp_lt_u32 s51, 0x8000
    s_cbranch_scc1 GCP
GCOK:
    ds_read_b64_tr_b16 v[80:81], v57 offset:0
    ds_read_b64_tr_b16 v[82:83], v57 offset:512
    ds_read_b64_tr_b16 v[84:85], v57 offset:4096
    ds_read_b64_tr_b16 v[86:87], v57 offset:4608
    ds_read_b64_tr_b16 v[88:89], v57 offset:8192
    ds_read_b64_tr_b16 v[90:91], v57 offset:8704
    ds_read_b64_tr_b16 v[92:93], v57 offset:12288
    ds_read_b64_tr_b16 v[94:95], v57 offset:12800
    ds_read_b64_tr_b16 v[96:97], v57 offset:16384
    ds_read_b64_tr_b16 v[98:99], v57 offset:16896
    ds_read_b64_tr_b16 v[100:101], v57 offset:20480
    ds_read_b64_tr_b16 v[102:103], v57 offset:20992
    s_branch W2P
AGF1P:
    s_add_u32 s51, s51, 1
    s_sleep 1
    s_cmp_lt_u32 s51, 0x8000
    s_cbranch_scc1 F1P
    s_branch OKF1P
AGW2P:
    s_add_u32 s51, s51, 1
    s_cmp_lt_u32 s51, 0x8000
    s_cbranch_scc1 W2P
    s_branch OKW2P
AGY3P:
    s_add_u32 s51, s51, 1
    s_sleep 1
    s_cmp_lt_u32 s51, 0x8000
    s_cbranch_scc1 Y3P
    s_branch OKY3P
SLOW1:
    buffer_store_dword v30, v18, s[16:19], s35 offen offset:0 sc1
    s_branch PUBD1
SLOW2:
    buffer_store_dword v16, v14, s[16:19], s33 offen offset:0 sc1
    buffer_store_dword v20, v14, s[16:19], s33 offen offset:1024 sc1
    buffer_store_dword v24, v14, s[16:19], s33 offen offset:2048 sc1
    buffer_store_dwordx2 v[28:29], v15, s[16:19], s33 offen offset:0 sc1
    s_branch PUBD2
SLOW3:
    buffer_store_dword v24, v14, s[16:19], s33 offen offset:0 sc1
    s_branch PUBD3
SLOW4:
    buffer_store_dwordx2 v[32:33], v38, s[16:19], s54 offen offset:0 sc1
    buffer_store_dwordx2 v[34:35], v38, s[16:19], s54 offen offset:512 sc1
    buffer_store_dwordx2 v[36:37], v38, s[16:19], s54 offen offset:1024 sc1
    s_branch PUBD4
SLOW5:
    buffer_store_dwordx2 v[32:33], v38, s[16:19], s54 offen offset:0 sc1
    buffer_store_dwordx2 v[34:35], v38, s[16:19], s54 offen offset:512 sc1
    buffer_store_dwordx2 v[36:37], v38, s[16:19], s54 offen offset:1024 sc1
    s_branch PUBD5
SLOW6:
    buffer_store_dword v41, v55, s[16:19], s54 offen offset:0 sc1
    s_branch PUBD6
SLOW7:
    buffer_store_dwordx4 v[116:119], v120, s[16:19], s54 offen offset:0 sc1
    buffer_store_dword v116, v121, s[16:19], s54 offen offset:0 sc1
    s_branch PUBD7
SLOW8:
    buffer_store_dword v16, v54, s[16:19], s35 offen offset:0 sc1
    s_branch PUBD8
SLOW9:
    buffer_store_dword v40, v55, s[16:19], s33 offen offset:0 sc1
    buffer_store_dwordx2 v[36:37], v56, s[16:19], s33 offen offset:0 sc1
    s_branch PUBD9
CODEEND:
    s_endpgm
.section .rodata,"a"
.p2align 6
.amdhsa_kernel interleave_layers__sliding_block_cached__glu_gated_swiglu__decode_kernel
  .amdhsa_next_free_vgpr 512
  .amdhsa_next_free_sgpr 102
  .amdhsa_accum_offset 256
  .amdhsa_group_segment_fixed_size 0
  .amdhsa_kernarg_size 96
  .amdhsa_user_sgpr_count 2
  .amdhsa_user_sgpr_kernarg_segment_ptr 1
  .amdhsa_system_sgpr_workgroup_id_x 1
.end_amdhsa_kernel
```

```asm
; @launch grid=(256,1,1) block=(256,1,1) lds=143104
.amdgcn_target "amdgcn-amd-amdhsa--gfx950"
.text
.globl interleave_layers__sliding_block_cached__glu_gated_swiglu__decode_kernel
.p2align 8
.type interleave_layers__sliding_block_cached__glu_gated_swiglu__decode_kernel,@function
interleave_layers__sliding_block_cached__glu_gated_swiglu__decode_kernel:
    s_cmp_ge_u32 s2, 256
    s_cbranch_scc1 DONE
    s_load_dwordx16 s[64:79], s[0:1], 0
    s_load_dwordx8 s[80:87], s[0:1], 64
    s_memrealtime s[98:99]
    s_getpc_b64 s[60:61]
PCREF:
    v_lshlrev_b32 v14, 7, v0
    v_cmp_gt_u32 vcc, CODEEND-PCREF, v14
    v_mov_b32 v15, s61
    s_and_saveexec_b64 s[88:89], vcc
    s_cbranch_execz NOPF
    v_add_co_u32 v14, vcc, s60, v14
    s_nop 1
    v_addc_co_u32 v15, vcc, 0, v15, vcc
    global_load_dword v79, v[14:15], off
NOPF:
    s_mov_b64 exec, s[88:89]
    v_and_b32 v1, 63, v0
    v_lshrrev_b32 v13, 6, v0
    s_and_b32 s45, s2, 7
    v_readfirstlane_b32 s44, v13
    s_lshr_b32 s46, s2, 3
    s_lshr_b32 s7, s46, 3
    s_lshl_b32 s52, s45, 2
    s_add_u32 s47, s7, s52
    s_and_b32 s48, s46, 7
    v_lshrrev_b32 v19, 4, v1
    v_bfe_u32 v21, v1, 1, 3
    v_and_b32 v20, 1, v1
    v_mul_u32_u24 v80, 384, v21
    v_lshl_add_u32 v80, v20, 4, v80
    v_lshl_add_u32 v80, v19, 5, v80
    s_mul_i32 s52, s48, 3
    s_lshl_b32 s54, s44, 0
    s_add_u32 s52, s52, s54
    s_add_u32 s53, s48, 384
    s_cmp_eq_u32 s44, 3
    s_cselect_b32 s52, s53, s52
    s_cselect_b32 s97, 8, 24
    s_mulk_i32 s97, 3072
    s_mul_i32 s55, s47, 12582912
    s_mul_i32 s54, s52, 3072
    s_add_u32 s55, s55, s54
    s_add_u32 s55, s55, 11010048
    s_mov_b32 s96, s55
    s_waitcnt lgkmcnt(0)
    s_mov_b32 s8, s66
    s_and_b32 s9, s67, 0xffff
    s_mov_b32 s10, 402653184
    s_mov_b32 s11, 0x20000
    s_mov_b32 s6, 1
    s_mov_b32 s100, 0
    s_cmp_eq_u32 s44, 3
    s_cbranch_scc1 SETUP
    buffer_load_dwordx4 a[0:3], v80, s[8:11], s96 offen offset:0 nt
    buffer_load_dwordx4 a[8:11], v80, s[8:11], s96 offen offset:128 nt
    buffer_load_dwordx4 a[16:19], v80, s[8:11], s96 offen offset:256 nt
    s_add_u32 s96, s96, s97
    buffer_load_dwordx4 a[4:7], v80, s[8:11], s96 offen offset:0 nt
    buffer_load_dwordx4 a[12:15], v80, s[8:11], s96 offen offset:128 nt
    buffer_load_dwordx4 a[20:23], v80, s[8:11], s96 offen offset:256 nt
    s_add_u32 s96, s96, s97
SETUP:
    s_mov_b32 s16, s86
    s_and_b32 s17, s87, 0xffff
    s_mov_b32 s18, 1610612736
    s_mov_b32 s19, 0x20000
    s_mov_b32 s12, s68
    s_and_b32 s13, s69, 0xffff
    s_mov_b32 s14, 402653184
    s_mov_b32 s15, 0x20000
    s_mov_b32 s20, s70
    s_and_b32 s21, s71, 0xffff
    s_mov_b32 s22, 7864320
    s_mov_b32 s23, 0x20000
    s_mov_b32 s32, s64
    s_and_b32 s33, s65, 0xffff
    s_mov_b32 s34, 1280
    s_mov_b32 s35, 0x20000
    s_mov_b32 s36, s82
    s_and_b32 s37, s83, 0xffff
    s_mov_b32 s38, 1280
    s_mov_b32 s39, 0x20000
    s_mov_b32 s40, s84
    s_and_b32 s41, s85, 0xffff
    s_mov_b32 s42, 256
    s_mov_b32 s43, 0x20000
    v_mov_b32 v76, 1879048192
    v_mov_b32 v87, 1879048192
    v_mov_b32 v88, 1879048192
    v_mov_b32 v120, 1879048192
    v_mov_b32 v121, 1879048192
    v_mov_b32 v122, 1879048192
    s_cmp_lg_u32 s44, 3
    s_cbranch_scc1 SETUP2
    v_mov_b32 v32, -1
    v_mov_b32 v33, -1
    v_mov_b32 v34, -1
    v_mov_b32 v35, -1
    s_cmp_lg_u32 s2, 0
    s_cbranch_scc1 NONW
    s_or_b32 s101, s98, 0x20
    s_and_b32 s101, s101, 0xffffffe0
    v_mov_b32 v24, s101
    v_mov_b32 v25, 0
    s_mov_b64 exec, 1
    buffer_store_dword v24, v25, s[40:43], 0 offen sc1
    s_mov_b64 exec, -1
NONW:
    v_lshlrev_b32 v24, 4, v1
    v_lshlrev_b32 v27, 2, v1
    s_mul_i32 s52, s2, 1536
    v_lshlrev_b32 v28, 3, v1
    buffer_store_dwordx4 v[32:35], v24, s[16:19], s52 offen sc1
    buffer_store_dwordx2 v[32:33], v28, s[16:19], s52 offen offset:1024 sc1
    v_mov_b32 v26, 1879048192
    v_mov_b32 v88, v24
    v_cmp_gt_u32 vcc, 40, v1
    v_lshlrev_b32 v27, 2, v1
    buffer_load_dwordx4 v[44:47], v24, s[32:35], 0 offen
    buffer_load_dword v48, v27, s[32:35], 0 offen offset:1024
    v_cndmask_b32 v28, v26, v27, vcc
    s_mul_i32 s52, s48, 160
    buffer_load_dword v86, v28, s[32:35], s52 offen
    s_mul_i32 s52, s48, 320
    s_add_u32 s52, s52, 131072
    s_and_b32 s53, s2, 0xc7
    s_cmp_eq_u32 s53, 0
    s_cselect_b32 s52, s52, 1879048192
    v_lshl_add_u32 v87, v1, 3, s52
    v_cndmask_b32 v87, v26, v87, vcc
    v_add_u32 v24, 0, v1
    v_mul_u32_u24 v36, 171, v24
    v_lshrrev_b32 v36, 12, v36
    v_mul_u32_u24 v37, 24, v36
    v_sub_u32 v37, v24, v37
    v_and_b32 v24, 2, v36
    v_xor_b32 v37, v37, v24
    v_mul_u32_u24 v36, 12288, v36
    v_lshl_add_u32 v38, v37, 4, v36
    v_add_u32 v24, 64, v1
    v_mul_u32_u24 v36, 171, v24
    v_lshrrev_b32 v36, 12, v36
    v_mul_u32_u24 v37, 24, v36
    v_sub_u32 v37, v24, v37
    v_and_b32 v24, 2, v36
    v_xor_b32 v37, v37, v24
    v_mul_u32_u24 v36, 12288, v36
    v_lshl_add_u32 v39, v37, 4, v36
    v_add_u32 v24, 128, v1
    v_mul_u32_u24 v36, 171, v24
    v_lshrrev_b32 v36, 12, v36
    v_mul_u32_u24 v37, 24, v36
    v_sub_u32 v37, v24, v37
    v_and_b32 v24, 2, v36
    v_xor_b32 v37, v37, v24
    v_mul_u32_u24 v36, 12288, v36
    v_lshl_add_u32 v40, v37, 4, v36
    s_mul_i32 s52, s48, 983040
    s_mul_i32 s54, s47, 384
    s_add_u32 s52, s52, s54
    s_mov_b32 s53, 65536
WQL:
    s_add_u32 m0, s53, 0
    s_nop 0
    buffer_load_dwordx4 v38, s[20:23], s52 offen nt lds
    v_xor_b32 v38, 64, v38
    s_add_u32 m0, s53, 1024
    s_nop 0
    buffer_load_dwordx4 v39, s[20:23], s52 offen nt lds
    v_xor_b32 v39, 64, v39
    s_add_u32 m0, s53, 2048
    s_nop 0
    buffer_load_dwordx4 v40, s[20:23], s52 offen nt lds
    v_xor_b32 v40, 64, v40
    s_add_u32 s52, s52, 98304
    s_add_u32 s53, s53, 3072
    s_cmp_lt_u32 s53, 96256
    s_cbranch_scc1 WQL
    v_mov_b32 v37, 0
    buffer_load_dword v89, v37, s[40:43], 0 offen sc1
    s_barrier
    s_waitcnt vmcnt(31)
    v_mov_b32 v36, 0x3f803f80
    v_mov_b32 v37, v36
    v_cndmask_b32 v36, 0, v36, vcc
    v_add_u32 v27, 96256, v27
    ds_write_b32 v27, v36 offset:1152
    ds_write_b32 v27, v37 offset:1408
    ds_write_b32 v27, v86
    v_mov_b64 v[36:37], 0
    ds_write_b32 v27, v36 offset:12800
    ds_write_b32 v27, v36 offset:13056
    v_mov_b32 v38, 0x3f803f80
    v_dot2_f32_bf16 v36, v44, v44, v36
    v_dot2_f32_bf16 v37, v44, v38, v37
    v_dot2_f32_bf16 v36, v45, v45, v36
    v_dot2_f32_bf16 v37, v45, v38, v37
    v_dot2_f32_bf16 v36, v46, v46, v36
    v_dot2_f32_bf16 v37, v46, v38, v37
    v_dot2_f32_bf16 v36, v47, v47, v36
    v_dot2_f32_bf16 v37, v47, v38, v37
    v_dot2_f32_bf16 v36, v48, v48, v36
    v_dot2_f32_bf16 v37, v48, v38, v37
    s_nop 2
    v_add_f32_dpp v36, v36, v36 quad_perm:[1,0,3,2] row_mask:0xf bank_mask:0xf
    v_add_f32_dpp v37, v37, v37 quad_perm:[1,0,3,2] row_mask:0xf bank_mask:0xf
    s_nop 0
    v_add_f32_dpp v36, v36, v36 quad_perm:[2,3,0,1] row_mask:0xf bank_mask:0xf
    v_add_f32_dpp v37, v37, v37 quad_perm:[2,3,0,1] row_mask:0xf bank_mask:0xf
    s_nop 0
    v_add_f32_dpp v36, v36, v36 row_half_mirror row_mask:0xf bank_mask:0xf
    v_add_f32_dpp v37, v37, v37 row_half_mirror row_mask:0xf bank_mask:0xf
    s_nop 0
    v_add_f32_dpp v36, v36, v36 row_mirror row_mask:0xf bank_mask:0xf
    v_add_f32_dpp v37, v37, v37 row_mirror row_mask:0xf bank_mask:0xf
    s_nop 0
    v_mov_b32 v39, v36
    s_nop 1
    v_permlane16_swap_b32 v36, v39
    v_add_f32 v36, v36, v39
    v_mov_b32 v39, v37
    s_nop 1
    v_permlane16_swap_b32 v37, v39
    v_add_f32 v37, v37, v39
    v_mov_b32 v39, v36
    s_nop 1
    v_permlane32_swap_b32 v36, v39
    v_add_f32 v36, v36, v39
    v_mov_b32 v39, v37
    s_nop 1
    v_permlane32_swap_b32 v37, v39
    v_add_f32 v37, v37, v39
    v_mov_b32 v39, 0x3727c5ac
    v_mul_f32 v37, 0x3acccccd, v37
    v_fmamk_f32 v36, v36, 0x3acccccd, v39
    v_fma_f32 v36, -v37, v37, v36
    v_rsq_f32 v36, abs(v36)
    v_mov_b32 v84, v37
    v_mul_f32 v85, 0x3dd53b94, v36
SETUP2:
    s_cmp_ge_u32 s46, 10
    s_cselect_b32 s56, 1, 0
    s_cmp_ge_u32 s46, 20
    s_cselect_b32 s52, 2, s56
    s_mul_i32 s52, s52, 10
    s_sub_u32 s57, s46, s52
    s_min_u32 s4, s46, 29
    s_cmp_ge_u32 s4, 15
    s_cselect_b32 s58, 1, 0
    s_mul_i32 s52, s58, 15
    s_sub_u32 s52, s4, s52
    s_mul_i32 s59, s52, 52
    s_lshr_b32 s59, s59, 8
    s_mul_i32 s53, s59, 5
    s_sub_u32 s3, s52, s53
    s_cmp_ge_u32 s46, 20
    s_cselect_b32 s24, s80, s72
    s_cselect_b32 s25, s81, s73
    s_mov_b32 s26, 7864320
    s_cselect_b32 s26, 1966080, s26
    s_and_b32 s25, s25, 0xffff
    s_mov_b32 s27, 0x20000
    s_cmp_eq_u32 s58, 1
    s_cselect_b32 s28, s78, s76
    s_cselect_b32 s29, s79, s77
    s_and_b32 s29, s29, 0xffff
    s_mov_b32 s30, 1966080
    s_mov_b32 s31, 0x20000
    s_mov_b32 s49, 0
    s_mul_i32 s63, s45, 45312
    s_add_u32 s63, s63, 529408
    s_mul_i32 s62, s45, 28160
    s_add_u32 s62, s62, 136192
    s_mov_b32 s50, 0
    s_mov_b32 s0, 0
    v_and_b32 v24, 15, v1
    v_cmp_eq_u32 vcc, 1, v24
    v_mov_b32 v25, 96256
    v_mov_b32 v26, 97408
    v_cndmask_b32 v2, v25, v26, vcc
    v_lshl_add_u32 v2, v19, 4, v2
    v_and_b32 v24, 3, v1
    v_lshlrev_b32 v24, 4, v24
    v_and_b32 v25, 1, v19
    v_lshl_add_u32 v24, v25, 6, v24
    v_add_u32 v24, 98304, v24
    v_bfe_u32 v25, v1, 2, 2
    v_lshrrev_b32 v27, 5, v1
    v_sub_u32 v25, v25, v27
    v_mov_b32 v26, 109184
    v_cmp_eq_u32 vcc, 0, v25
    s_nop 1
    v_cndmask_b32 v3, v26, v24, vcc
    v_cmp_eq_u32 vcc, 2, v25
    s_nop 1
    v_cndmask_b32 v4, v26, v24, vcc
    v_and_b32 v24, 3, v1
    v_cmp_eq_u32 vcc, 3, v24
    v_mov_b32 v25, 0xffff
    v_mov_b32 v26, 0xffff0000
    v_cndmask_b32 v25, v25, v26, vcc
    v_cndmask_b32 v24, v24, 0, vcc
    v_or_b32 v24, 12, v24
    v_mul_u32_u24 v24, 0x1111, v24
    v_bfe_u32 v26, v1, 1, 1
    v_mul_u32_u24 v26, 0xaaaa, v26
    v_add_u32 v26, 0x4444, v26
    v_lshl_add_u32 v7, v24, 16, v26
    v_and_b32 v24, 4, v1
    v_cmp_eq_u32 vcc, 0, v24
    s_nop 1
    v_cndmask_b32 v5, 0, v25, vcc
    v_cndmask_b32 v6, v25, 0, vcc
    v_mul_u32_u24 v82, s97, v27
    v_bfe_u32 v24, v1, 3, 1
    v_mul_u32_u24 v24, 1536, v24
    v_add_u32 v82, v82, v24
    v_and_b32 v24, 1, v19
    v_mul_u32_u24 v24, 768, v24
    v_add_u32 v82, v82, v24
    v_and_b32 v24, 7, v1
    v_lshl_add_u32 v82, v24, 4, v82
    s_mul_i32 s52, s7, 6144
    s_add_u32 s52, s52, 20480
    v_lshl_add_u32 v8, v0, 4, s52
    s_lshl_b32 s52, s7, 6
    s_add_u32 s52, s52, 45056
    v_lshl_add_u32 v9, v24, 3, s52
    v_and_b32 v10, 0xe1, v0
    v_lshlrev_b32 v10, 1, v10
    v_bfe_u32 v24, v0, 4, 1
    v_lshl_add_u32 v10, v24, 3, v10
    v_bfe_u32 v24, v0, 3, 1
    v_lshl_add_u32 v10, v24, 4, v10
    v_bfe_u32 v24, v0, 2, 1
    v_lshl_add_u32 v10, v24, 2, v10
    v_bfe_u32 v24, v0, 1, 1
    v_lshl_add_u32 v10, v24, 5, v10
    v_add_u32 v10, 98304, v10
    v_mov_b32 v11, 0x3727c5ac
    v_lshlrev_b32 v12, 4, v0
    v_add_u32 v12, 110336, v12
    s_cmp_lg_u32 s44, 3
    s_cbranch_scc1 KBAR
    s_lshr_b32 s53, s2, 4
    s_and_b32 s51, s2, 15
    s_lshl_b32 s52, s53, 14
    s_lshl_b32 s54, s51, 9
    s_add_u32 s52, s52, s54
    s_add_u32 s52, s52, 1835008
    s_and_b32 s53, s46, 1
    s_lshl_b32 s53, s53, 13
    s_add_u32 s52, s52, s53
    s_xor_b32 s53, s52, 8192
    s_memtime s[88:89]
    s_waitcnt lgkmcnt(0)
    s_buffer_load_dword s1, s[16:19], s52
    s_waitcnt lgkmcnt(0)
    s_memtime s[90:91]
    s_waitcnt lgkmcnt(0)
    s_buffer_load_dword s1, s[16:19], s53
    s_waitcnt lgkmcnt(0)
    s_memtime s[92:93]
    s_waitcnt lgkmcnt(0)
    s_sub_u32 s88, s90, s88
    s_sub_u32 s90, s92, s90
    s_cmp_lt_u32 s90, s88
    s_cselect_b32 s1, 1, 0
    s_xor_b32 s1, s1, s46
    s_getreg_b32 s52, hwreg(HW_REG_XCC_ID)
    s_lshr_b32 s52, s52, 2
    s_xor_b32 s1, s1, s52
    s_and_b32 s1, s1, 1
    s_lshl_b32 s1, s1, 4
    s_mov_b32 s51, 0
    v_mov_b32 v37, 0
NOP:
    s_waitcnt vmcnt(0)
    v_readfirstlane_b32 s5, v89
    s_cmp_lg_u32 s5, 0
    s_cbranch_scc1 NOOK
    buffer_load_dword v89, v37, s[40:43], 0 offen sc1
    s_add_u32 s51, s51, 1
    s_sleep 4
    s_cmp_lt_u32 s51, 0x8000
    s_cbranch_scc1 NOP
NOOK:
    s_getreg_b32 s52, hwreg(HW_REG_XCC_ID)
    s_and_b32 s52, s52, 15
    s_or_b32 s5, s5, s52
    s_or_b32 s1, s1, s5
    v_mov_b32 v36, s1
    s_lshl_b32 s52, s45, 7
    s_lshl_b32 s54, s46, 2
    s_add_u32 s52, s52, s54
    s_add_u32 s52, s52, 1376256
    s_mov_b64 exec, 1
    buffer_store_dword v36, v37, s[16:19], s52 offen sc1
    s_mov_b64 exec, -1
    s_mov_b32 s44, 0
    s_branch Q0L
KBAR:
    s_barrier
    s_waitcnt vmcnt(7)
    buffer_load_dwordx4 a[24:27], v80, s[8:11], s96 offen offset:0 nt
    s_waitcnt vmcnt(7)
    buffer_load_dwordx4 a[32:35], v80, s[8:11], s96 offen offset:128 nt
    s_waitcnt vmcnt(7)
    buffer_load_dwordx4 a[40:43], v80, s[8:11], s96 offen offset:256 nt
    s_add_u32 s96, s96, s97
    s_waitcnt vmcnt(7)
    buffer_load_dwordx4 a[28:31], v80, s[8:11], s96 offen offset:0 nt
    s_waitcnt vmcnt(7)
    buffer_load_dwordx4 a[36:39], v80, s[8:11], s96 offen offset:128 nt
    s_waitcnt vmcnt(7)
    buffer_load_dwordx4 a[44:47], v80, s[8:11], s96 offen offset:256 nt
    s_add_u32 s96, s96, s97
    s_waitcnt vmcnt(7)
    buffer_load_dwordx4 a[48:51], v80, s[8:11], s96 offen offset:0 nt
    s_waitcnt vmcnt(7)
    buffer_load_dwordx4 a[56:59], v80, s[8:11], s96 offen offset:128 nt
    s_waitcnt vmcnt(7)
    buffer_load_dwordx4 a[64:67], v80, s[8:11], s96 offen offset:256 nt
    s_add_u32 s96, s96, s97
    s_waitcnt vmcnt(7)
    buffer_load_dwordx4 a[52:55], v80, s[8:11], s96 offen offset:0 nt
    s_waitcnt vmcnt(7)
    buffer_load_dwordx4 a[60:63], v80, s[8:11], s96 offen offset:128 nt
    s_waitcnt vmcnt(7)
    buffer_load_dwordx4 a[68:71], v80, s[8:11], s96 offen offset:256 nt
    s_add_u32 s96, s96, s97
    s_waitcnt vmcnt(7)
    buffer_load_dwordx4 a[72:75], v80, s[8:11], s96 offen offset:0 nt
    s_waitcnt vmcnt(7)
    buffer_load_dwordx4 a[80:83], v80, s[8:11], s96 offen offset:128 nt
    s_waitcnt vmcnt(7)
    buffer_load_dwordx4 a[88:91], v80, s[8:11], s96 offen offset:256 nt
    s_add_u32 s96, s96, s97
    s_waitcnt vmcnt(7)
    buffer_load_dwordx4 a[76:79], v80, s[8:11], s96 offen offset:0 nt
    s_waitcnt vmcnt(7)
    buffer_load_dwordx4 a[84:87], v80, s[8:11], s96 offen offset:128 nt
    s_waitcnt vmcnt(7)
    buffer_load_dwordx4 a[92:95], v80, s[8:11], s96 offen offset:256 nt
    s_add_u32 s96, s96, s97
    s_waitcnt vmcnt(7)
    buffer_load_dwordx4 a[96:99], v80, s[8:11], s96 offen offset:0 nt
    s_waitcnt vmcnt(7)
    buffer_load_dwordx4 a[104:107], v80, s[8:11], s96 offen offset:128 nt
    s_waitcnt vmcnt(7)
    buffer_load_dwordx4 a[112:115], v80, s[8:11], s96 offen offset:256 nt
    s_add_u32 s96, s96, s97
    s_waitcnt vmcnt(7)
    buffer_load_dwordx4 a[100:103], v80, s[8:11], s96 offen offset:0 nt
    s_waitcnt vmcnt(7)
    buffer_load_dwordx4 a[108:111], v80, s[8:11], s96 offen offset:128 nt
    s_waitcnt vmcnt(7)
    buffer_load_dwordx4 a[116:119], v80, s[8:11], s96 offen offset:256 nt
    s_add_u32 s96, s96, s97
    s_waitcnt vmcnt(7)
    buffer_load_dwordx4 a[120:123], v80, s[8:11], s96 offen offset:0 nt
    s_waitcnt vmcnt(7)
    buffer_load_dwordx4 a[128:131], v80, s[8:11], s96 offen offset:128 nt
    s_waitcnt vmcnt(7)
    buffer_load_dwordx4 a[136:139], v80, s[8:11], s96 offen offset:256 nt
    s_add_u32 s96, s96, s97
    s_waitcnt vmcnt(7)
    buffer_load_dwordx4 a[124:127], v80, s[8:11], s96 offen offset:0 nt
    s_waitcnt vmcnt(7)
    buffer_load_dwordx4 a[132:135], v80, s[8:11], s96 offen offset:128 nt
    s_waitcnt vmcnt(7)
    buffer_load_dwordx4 a[140:143], v80, s[8:11], s96 offen offset:256 nt
    s_add_u32 s96, s96, s97
    s_waitcnt vmcnt(7)
    buffer_load_dwordx4 a[144:147], v80, s[8:11], s96 offen offset:0 nt
    s_waitcnt vmcnt(7)
    buffer_load_dwordx4 a[152:155], v80, s[8:11], s96 offen offset:128 nt
    s_waitcnt vmcnt(7)
    buffer_load_dwordx4 a[160:163], v80, s[8:11], s96 offen offset:256 nt
    s_add_u32 s96, s96, s97
    s_waitcnt vmcnt(7)
    buffer_load_dwordx4 a[148:151], v80, s[8:11], s96 offen offset:0 nt
    s_waitcnt vmcnt(7)
    buffer_load_dwordx4 a[156:159], v80, s[8:11], s96 offen offset:128 nt
    s_waitcnt vmcnt(7)
    buffer_load_dwordx4 a[164:167], v80, s[8:11], s96 offen offset:256 nt
    s_add_u32 s96, s96, s97
    s_waitcnt vmcnt(7)
    buffer_load_dwordx4 a[168:171], v80, s[8:11], s96 offen offset:0 nt
    s_waitcnt vmcnt(7)
    buffer_load_dwordx4 a[176:179], v80, s[8:11], s96 offen offset:128 nt
    s_waitcnt vmcnt(7)
    buffer_load_dwordx4 a[184:187], v80, s[8:11], s96 offen offset:256 nt
    s_add_u32 s96, s96, s97
    s_waitcnt vmcnt(7)
    buffer_load_dwordx4 a[172:175], v80, s[8:11], s96 offen offset:0 nt
    s_waitcnt vmcnt(7)
    buffer_load_dwordx4 a[180:183], v80, s[8:11], s96 offen offset:128 nt
    s_waitcnt vmcnt(7)
    buffer_load_dwordx4 a[188:191], v80, s[8:11], s96 offen offset:256 nt
    s_lshl_b32 s97, s97, 1
    s_waitcnt vmcnt(7)
    buffer_load_dwordx4 a[192:195], v82, s[12:15], s55 offen offset:0 nt
    s_waitcnt vmcnt(7)
    buffer_load_dwordx4 a[200:203], v82, s[12:15], s55 offen offset:128 nt
    s_waitcnt vmcnt(7)
    buffer_load_dwordx4 a[208:211], v82, s[12:15], s55 offen offset:256 nt
    s_waitcnt vmcnt(7)
    buffer_load_dwordx4 a[216:219], v82, s[12:15], s55 offen offset:384 nt
    s_waitcnt vmcnt(7)
    buffer_load_dwordx4 a[224:227], v82, s[12:15], s55 offen offset:512 nt
    s_waitcnt vmcnt(7)
    buffer_load_dwordx4 a[232:235], v82, s[12:15], s55 offen offset:640 nt
    s_add_u32 s55, s55, s97
    s_waitcnt vmcnt(7)
    buffer_load_dwordx4 a[196:199], v82, s[12:15], s55 offen offset:0 nt
    s_waitcnt vmcnt(7)
    buffer_load_dwordx4 a[204:207], v82, s[12:15], s55 offen offset:128 nt
    s_waitcnt vmcnt(7)
    buffer_load_dwordx4 a[212:215], v82, s[12:15], s55 offen offset:256 nt
    s_waitcnt vmcnt(7)
    buffer_load_dwordx4 a[220:223], v82, s[12:15], s55 offen offset:384 nt
    s_waitcnt vmcnt(7)
    buffer_load_dwordx4 a[228:231], v82, s[12:15], s55 offen offset:512 nt
    s_waitcnt vmcnt(7)
    buffer_load_dwordx4 a[236:239], v82, s[12:15], s55 offen offset:640 nt
    s_add_u32 s55, s55, s97
    s_waitcnt vmcnt(7)
    buffer_load_dwordx4 a[240:243], v82, s[12:15], s55 offen offset:0 nt
    s_waitcnt vmcnt(7)
    buffer_load_dwordx4 a[248:251], v82, s[12:15], s55 offen offset:128 nt
    s_waitcnt vmcnt(7)
    buffer_load_dwordx4 v[128:131], v82, s[12:15], s55 offen offset:256 nt
    s_waitcnt vmcnt(7)
    buffer_load_dwordx4 v[136:139], v82, s[12:15], s55 offen offset:384 nt
    s_waitcnt vmcnt(7)
    buffer_load_dwordx4 v[144:147], v82, s[12:15], s55 offen offset:512 nt
    s_waitcnt vmcnt(7)
    buffer_load_dwordx4 v[152:155], v82, s[12:15], s55 offen offset:640 nt
    s_add_u32 s55, s55, s97
    s_waitcnt vmcnt(7)
    buffer_load_dwordx4 a[244:247], v82, s[12:15], s55 offen offset:0 nt
    s_waitcnt vmcnt(7)
    buffer_load_dwordx4 a[252:255], v82, s[12:15], s55 offen offset:128 nt
    s_waitcnt vmcnt(7)
    buffer_load_dwordx4 v[132:135], v82, s[12:15], s55 offen offset:256 nt
    s_waitcnt vmcnt(7)
    buffer_load_dwordx4 v[140:143], v82, s[12:15], s55 offen offset:384 nt
    s_waitcnt vmcnt(7)
    buffer_load_dwordx4 v[148:151], v82, s[12:15], s55 offen offset:512 nt
    s_waitcnt vmcnt(7)
    buffer_load_dwordx4 v[156:159], v82, s[12:15], s55 offen offset:640 nt
    s_add_u32 s55, s55, s97
    s_waitcnt vmcnt(7)
    buffer_load_dwordx4 v[160:163], v82, s[12:15], s55 offen offset:0 nt
    s_waitcnt vmcnt(7)
    buffer_load_dwordx4 v[168:171], v82, s[12:15], s55 offen offset:128 nt
    s_waitcnt vmcnt(7)
    buffer_load_dwordx4 v[176:179], v82, s[12:15], s55 offen offset:256 nt
    s_waitcnt vmcnt(7)
    buffer_load_dwordx4 v[184:187], v82, s[12:15], s55 offen offset:384 nt
    s_waitcnt vmcnt(7)
    buffer_load_dwordx4 v[192:195], v82, s[12:15], s55 offen offset:512 nt
    s_waitcnt vmcnt(7)
    buffer_load_dwordx4 v[200:203], v82, s[12:15], s55 offen offset:640 nt
    s_add_u32 s55, s55, s97
    s_waitcnt vmcnt(7)
    buffer_load_dwordx4 v[164:167], v82, s[12:15], s55 offen offset:0 nt
    s_waitcnt vmcnt(7)
    buffer_load_dwordx4 v[172:175], v82, s[12:15], s55 offen offset:128 nt
    s_waitcnt vmcnt(7)
    buffer_load_dwordx4 v[180:183], v82, s[12:15], s55 offen offset:256 nt
    s_waitcnt vmcnt(7)
    buffer_load_dwordx4 v[188:191], v82, s[12:15], s55 offen offset:384 nt
    s_waitcnt vmcnt(7)
    buffer_load_dwordx4 v[196:199], v82, s[12:15], s55 offen offset:512 nt
    s_waitcnt vmcnt(7)
    buffer_load_dwordx4 v[204:207], v82, s[12:15], s55 offen offset:640 nt
    s_add_u32 s55, s55, s97
    s_waitcnt vmcnt(7)
    buffer_load_dwordx4 v[208:211], v82, s[12:15], s55 offen offset:0 nt
    s_waitcnt vmcnt(7)
    buffer_load_dwordx4 v[216:219], v82, s[12:15], s55 offen offset:128 nt
    s_waitcnt vmcnt(7)
    buffer_load_dwordx4 v[224:227], v82, s[12:15], s55 offen offset:256 nt
    s_waitcnt vmcnt(7)
    buffer_load_dwordx4 v[232:235], v82, s[12:15], s55 offen offset:384 nt
    s_waitcnt vmcnt(7)
    buffer_load_dwordx4 v[240:243], v82, s[12:15], s55 offen offset:512 nt
    s_waitcnt vmcnt(7)
    buffer_load_dwordx4 v[248:251], v82, s[12:15], s55 offen offset:640 nt
    s_add_u32 s55, s55, s97
    s_waitcnt vmcnt(7)
    buffer_load_dwordx4 v[212:215], v82, s[12:15], s55 offen offset:0 nt
    s_waitcnt vmcnt(7)
    buffer_load_dwordx4 v[220:223], v82, s[12:15], s55 offen offset:128 nt
    s_waitcnt vmcnt(7)
    buffer_load_dwordx4 v[228:231], v82, s[12:15], s55 offen offset:256 nt
    s_barrier
    s_waitcnt vmcnt(7)
    buffer_load_dwordx4 v[236:239], v82, s[12:15], s55 offen offset:384 nt
    s_waitcnt vmcnt(7)
    buffer_load_dwordx4 v[244:247], v82, s[12:15], s55 offen offset:512 nt
    s_waitcnt vmcnt(7)
    buffer_load_dwordx4 v[252:255], v82, s[12:15], s55 offen offset:640 nt
    s_branch TABLES
LOOP:
    ds_read_b128 v[14:17], v12 offset:24576
    ds_read_b128 v[18:21], v12 offset:28672
    s_mov_b32 s55, s99
    s_mov_b32 s51, 0
    s_cmp_lg_u32 s49, 0
    s_cbranch_scc1 FINAL
    s_waitcnt lgkmcnt(0)
QTR:
    ds_read_b64_tr_b16 v[44:45], v19 offset:0
    ds_read_b64_tr_b16 v[46:47], v19 offset:1536
    ds_read_b64_tr_b16 v[56:57], v19 offset:128
    ds_read_b64_tr_b16 v[58:59], v19 offset:1664
    ds_read_b64_tr_b16 v[68:69], v19 offset:256
    ds_read_b64_tr_b16 v[70:71], v19 offset:1792
    ds_read_b64_tr_b16 v[48:49], v19 offset:12288
    ds_read_b64_tr_b16 v[50:51], v19 offset:13824
    ds_read_b64_tr_b16 v[60:61], v19 offset:12416
    ds_read_b64_tr_b16 v[62:63], v19 offset:13952
    ds_read_b64_tr_b16 v[72:73], v19 offset:12544
    ds_read_b64_tr_b16 v[74:75], v19 offset:14080
    ds_read_b64_tr_b16 v[52:53], v20 offset:24576
    ds_read_b64_tr_b16 v[54:55], v20 offset:26112
    ds_read_b64_tr_b16 v[64:65], v20 offset:24704
    ds_read_b64_tr_b16 v[66:67], v20 offset:26240
    ds_read_b64_tr_b16 v[76:77], v20 offset:24832
    ds_read_b64_tr_b16 v[78:79], v20 offset:26368
    s_cmp_lg_u32 s6, 0
    s_cbranch_scc1 QA0
    s_mov_b32 s96, s62
    s_mov_b32 s49, 393216
    s_mov_b32 s62, s63
    s_cmp_lg_u32 s50, 0
    s_cselect_b32 s32, s62, 1610612736
    s_cselect_b32 s33, 1610612736, s62
    s_cmp_lg_u32 s50, 0
    s_cselect_b32 s34, s49, 1610612736
    s_cselect_b32 s35, 1610612736, s49
    s_add_u32 s99, s49, s0
    s_xor_b32 s1, s99, 8192
    s_cmp_eq_u32 s44, 3
    s_cbranch_scc1 QX
    s_sub_u32 s52, s46, 20
    s_cmp_ge_u32 s52, 10
    s_cbranch_scc1 HOOKL
    v_lshlrev_b32 v30, 3, v0
    s_mul_i32 s52, s47, 12288
    s_add_u32 s52, s52, 1441792
    s_add_u32 s53, s52, 0
    buffer_load_dwordx2 v[32:33], v30, s[16:19], s53 offen offset:0 sc1
    buffer_load_dwordx2 v[34:35], v30, s[16:19], s53 offen offset:1536 sc1
    s_add_u32 s53, s52, 3072
    buffer_load_dwordx2 v[36:37], v30, s[16:19], s53 offen offset:0 sc1
    buffer_load_dwordx2 v[38:39], v30, s[16:19], s53 offen offset:1536 sc1
    s_add_u32 s53, s52, 6144
    buffer_load_dwordx2 v[40:41], v30, s[16:19], s53 offen offset:0 sc1
    buffer_load_dwordx2 v[42:43], v30, s[16:19], s53 offen offset:1536 sc1
    s_add_u32 s53, s52, 9216
    buffer_load_dwordx2 v[26:27], v30, s[16:19], s53 offen offset:0 sc1
    buffer_load_dwordx2 v[28:29], v30, s[16:19], s53 offen offset:1536 sc1
    s_sleep 5
GYB:
    buffer_load_dword v22, v16, s[16:19], s55 offen offset:0 sc1
    buffer_load_dword v23, v16, s[16:19], s55 offen offset:128 sc1
    buffer_load_dword v24, v16, s[16:19], s55 offen offset:256 sc1
    buffer_load_dword v25, v16, s[16:19], s55 offen offset:384 sc1
    s_waitcnt vmcnt(4)
QCP:
    v_bitop3_b32 v33, v32, v33, s101 bitop3:0x96
    v_bitop3_b32 v35, v34, v35, s101 bitop3:0x96
    v_bitop3_b32 v37, v36, v37, s101 bitop3:0x96
    v_bitop3_b32 v39, v38, v39, s101 bitop3:0x96
    v_bitop3_b32 v41, v40, v41, s101 bitop3:0x96
    v_bitop3_b32 v43, v42, v43, s101 bitop3:0x96
    v_bitop3_b32 v27, v26, v27, s101 bitop3:0x96
    v_bitop3_b32 v29, v28, v29, s101 bitop3:0x96
    v_add_f32 v13, v32, v34
    v_add_f32 v13, v13, v36
    v_add_f32 v13, v13, v38
    v_add_f32 v13, v13, v40
    v_add_f32 v13, v13, v42
    v_add_f32 v13, v13, v26
    v_add_f32 v13, v13, v28
    v_or3_b32 v33, v33, v35, v37
    v_or3_b32 v33, v33, v39, v41
    v_or3_b32 v33, v33, v43, v27
    v_or_b32 v33, v33, v29
    v_cmp_ne_u32 vcc, 0, v33
    s_cbranch_vccnz QCA
Y2W:
    s_waitcnt vmcnt(0)
    v_pk_add_f32 v[22:23], v[22:23], v[24:25]
    v_add_f32 v30, v22, v23
    v_mov_b32 v31, v30
    s_nop 1
    v_permlane32_swap_b32 v30, v31
    v_add_f32 v30, v30, v31
    v_cmp_u_f32 vcc, v30, v30
    v_cvt_pk_bf16_f32 v30, v30, v30
    ds_write_b16 v17, v30
    s_cbranch_vccnz AGY2P
OKY2P:
    v_and_b32 v30, 0xffff0000, v30
    buffer_store_dword v30, v18, s[16:19], s34 offen offset:0
    s_cmp_eq_u32 s50, 0
    s_cbranch_scc1 SLOW1
PUBD1:
QX:
    s_waitcnt lgkmcnt(0)
    s_barrier
QA0:
    ds_read_b128 v[32:35], v2 offset:0
    ds_read_b128 v[36:39], v2 offset:64
    ds_read_b128 v[40:43], v2 offset:128
    s_cmp_lg_u32 s6, 0
    s_waitcnt lgkmcnt(2)
    v_mfma_f32_16x16x32_bf16 v[28:31], v[32:35], v[32:35], 0
    v_mfma_f32_16x16x32_bf16 v[16:19], v[32:35], v[44:47], 0
    v_mfma_f32_16x16x32_bf16 v[20:23], v[32:35], v[56:59], 0
    v_mfma_f32_16x16x32_bf16 v[24:27], v[32:35], v[68:71], 0
    s_waitcnt lgkmcnt(1)
    v_mfma_f32_16x16x32_bf16 v[28:31], v[36:39], v[36:39], v[28:31]
    v_mfma_f32_16x16x32_bf16 v[16:19], v[36:39], v[48:51], v[16:19]
    v_mfma_f32_16x16x32_bf16 v[20:23], v[36:39], v[60:63], v[20:23]
    v_mfma_f32_16x16x32_bf16 v[24:27], v[36:39], v[72:75], v[24:27]
    s_waitcnt lgkmcnt(0)
    v_mfma_f32_16x16x32_bf16 v[16:19], v[40:43], v[52:55], v[16:19]
    v_mfma_f32_16x16x32_bf16 v[20:23], v[40:43], v[64:67], v[20:23]
    v_mfma_f32_16x16x32_bf16 v[24:27], v[40:43], v[76:79], v[24:27]
    v_mfma_f32_16x16x32_bf16 v[28:31], v[40:43], v[40:43], v[28:31]
    s_cbranch_scc1 HOOKA
    v_mov_b64 v[64:65], 0
    v_mov_b64 v[66:67], 0
    v_mov_b64 v[68:69], 0
    v_mov_b64 v[70:71], 0
    buffer_store_dword v16, v14, s[16:19], s32 offen offset:0
    buffer_store_dword v20, v14, s[16:19], s32 offen offset:1024
    buffer_store_dword v24, v14, s[16:19], s32 offen offset:2048
    buffer_store_dwordx2 v[28:29], v15, s[16:19], s32 offen offset:0
    s_cmp_eq_u32 s50, 0
    s_cbranch_scc1 SLOW2
PUBD2:
    ds_read_b64 v[14:15], v12 offset:0
    ds_read_b64 v[60:61], v12 offset:8
    s_cmp_eq_u32 s44, 3
    s_cbranch_scc1 EN3
    v_mov_b32 v36, v36
    v_mov_b32 v36, v36
    v_mov_b32 v36, v36
    v_mov_b32 v36, v36
    v_mov_b32 v36, v36
    v_mov_b32 v36, v36
    v_mov_b32 v36, v36
    v_mov_b32 v36, v36
    v_mov_b32 v36, v36
    v_mov_b32 v36, v36
    v_mov_b32 v36, v36
    v_mov_b32 v36, v36
    v_mov_b32 v36, v36
    v_mov_b32 v36, v36
    v_mov_b32 v36, v36
    v_mov_b32 v36, v36
    v_mov_b32 v36, v36
    v_mov_b32 v36, v36
    v_mov_b32 v36, v36
    v_mov_b32 v36, v36
    v_mov_b32 v36, v36
    v_mov_b32 v36, v36
    v_mov_b32 v36, v36
    v_mov_b32 v36, v36
    v_mov_b32 v36, v36
    v_mov_b32 v36, v36
    v_mov_b32 v36, v36
    v_mov_b32 v36, v36
    v_mov_b32 v36, v36
    v_mov_b32 v36, v36
    v_mov_b32 v36, v36
    v_mov_b32 v36, v36
    buffer_load_dwordx2 v[62:63], v9, s[16:19], s62 offen sc1
    buffer_load_dwordx4 v[52:55], v8, s[16:19], s62 offen offset:0 sc1
    buffer_load_dwordx4 v[56:59], v8, s[16:19], s62 offen offset:3072 sc1
    v_mov_b64 v[72:73], 0
    v_mov_b64 v[74:75], 0
    v_mov_b64 v[76:77], 0
    v_mov_b64 v[78:79], 0
    v_mov_b64 v[40:41], 0
    v_mov_b64 v[42:43], 0
    v_mov_b64 v[44:45], 0
    v_mov_b64 v[46:47], 0
    v_mov_b64 v[48:49], 0
    v_mov_b64 v[50:51], 0
    s_mov_b32 s51, 0
    v_mov_b32 v36, v36
    v_mov_b32 v36, v36
    v_mov_b32 v36, v36
    v_mov_b32 v36, v36
    v_mov_b32 v36, v36
    v_mov_b32 v36, v36
    v_mov_b32 v36, v36
    v_mov_b32 v36, v36
    v_mov_b32 v36, v36
    v_mov_b32 v36, v36
ENP:
    buffer_load_dwordx2 v[62:63], v9, s[16:19], s62 offen sc1
    buffer_load_dwordx4 v[52:55], v8, s[16:19], s62 offen offset:0 sc1
    buffer_load_dwordx4 v[56:59], v8, s[16:19], s62 offen offset:3072 sc1
    s_waitcnt vmcnt(3)
    v_add_f32_dpp v32, v62, v62 quad_perm:[1,0,3,2] row_mask:0xf bank_mask:0xf
    v_add_f32_dpp v33, v63, v63 quad_perm:[1,0,3,2] row_mask:0xf bank_mask:0xf
    v_pk_add_f32 v[16:17], v[52:53], v[54:55]
    v_add_f32_dpp v32, v32, v32 quad_perm:[2,3,0,1] row_mask:0xf bank_mask:0xf
    v_add_f32_dpp v33, v33, v33 quad_perm:[2,3,0,1] row_mask:0xf bank_mask:0xf
    v_pk_add_f32 v[20:21], v[56:57], v[58:59]
    v_add_f32_dpp v32, v32, v32 row_half_mirror row_mask:0xf bank_mask:0xf
    v_add_f32_dpp v33, v33, v33 row_half_mirror row_mask:0xf bank_mask:0xf
    v_pk_add_f32 v[16:17], v[16:17], v[20:21]
    v_mul_f32 v33, 0x3acccccd, v33
    v_fmamk_f32 v32, v32, 0x3acccccd, v11
    v_fma_f32 v32, -v33, v33, v32
    v_rsq_f32 v32, abs(v32)
    v_add_f32 v16, v16, v17
    v_mul_f32 v32, 0x3dd53b94, v32
    v_fma_f32 v16, -v33, v13, v16
    v_mul_f32 v16, v16, v32
    v_cvt_pk_bf16_f32 v17, v16, v16
    ds_write_b16 v10, v17
    v_cmp_u_f32 vcc, v16, v16
    s_cbranch_vccnz AGENP
OKENP:
ENOK2:
    s_waitcnt lgkmcnt(0)
    s_barrier
QFRAG:
    ds_read_b128 v[16:19], v3 offset:0
    ds_read_b128 v[20:23], v3 offset:128
    ds_read_b128 v[24:27], v3 offset:256
    ds_read_b128 v[28:31], v4 offset:0
    ds_read_b128 v[32:35], v4 offset:128
    ds_read_b128 v[36:39], v4 offset:256
    s_cmp_eq_u32 s49, 0
    s_cbranch_scc1 HOOKF
    s_waitcnt vmcnt(0)
QK:
    s_waitcnt lgkmcnt(5)
    v_smfmac_f32_16x16x64_bf16 v[64:67], v[16:19], a[0:7], v7
    s_waitcnt lgkmcnt(4)
    v_smfmac_f32_16x16x64_bf16 v[64:67], v[20:23], a[8:15], v7
    s_waitcnt lgkmcnt(3)
    v_smfmac_f32_16x16x64_bf16 v[64:67], v[24:27], a[16:23], v7
    s_waitcnt lgkmcnt(2)
    v_smfmac_f32_16x16x64_bf16 v[64:67], v[28:31], a[24:31], v7
    s_waitcnt lgkmcnt(1)
    v_smfmac_f32_16x16x64_bf16 v[64:67], v[32:35], a[32:39], v7
    s_waitcnt lgkmcnt(0)
    v_smfmac_f32_16x16x64_bf16 v[64:67], v[36:39], a[40:47], v7
    v_smfmac_f32_16x16x64_bf16 v[68:71], v[16:19], a[48:55], v7
    v_smfmac_f32_16x16x64_bf16 v[68:71], v[20:23], a[56:63], v7
    v_smfmac_f32_16x16x64_bf16 v[68:71], v[24:27], a[64:71], v7
    v_smfmac_f32_16x16x64_bf16 v[68:71], v[28:31], a[72:79], v7
    v_smfmac_f32_16x16x64_bf16 v[68:71], v[32:35], a[80:87], v7
    v_smfmac_f32_16x16x64_bf16 v[68:71], v[36:39], a[88:95], v7
    v_smfmac_f32_16x16x64_bf16 v[72:75], v[16:19], a[96:103], v7
    v_smfmac_f32_16x16x64_bf16 v[72:75], v[20:23], a[104:111], v7
    v_smfmac_f32_16x16x64_bf16 v[72:75], v[24:27], a[112:119], v7
    v_pk_add_f32 v[64:65], v[64:65], v[66:67]
    v_smfmac_f32_16x16x64_bf16 v[72:75], v[28:31], a[120:127], v7
    v_smfmac_f32_16x16x64_bf16 v[72:75], v[32:35], a[128:135], v7
    v_add_f32_dpp v52, v65, v64 quad_perm:[1,1,3,3] row_mask:0xf bank_mask:0xf
    v_smfmac_f32_16x16x64_bf16 v[72:75], v[36:39], a[136:143], v7
    v_smfmac_f32_16x16x64_bf16 v[76:79], v[16:19], a[144:151], v7
    v_smfmac_f32_16x16x64_bf16 v[76:79], v[20:23], a[152:159], v7
    v_smfmac_f32_16x16x64_bf16 v[76:79], v[24:27], a[160:167], v7
    v_pk_add_f32 v[68:69], v[68:69], v[70:71]
    v_smfmac_f32_16x16x64_bf16 v[76:79], v[28:31], a[168:175], v7
    v_smfmac_f32_16x16x64_bf16 v[76:79], v[32:35], a[176:183], v7
    v_add_f32_dpp v53, v69, v68 quad_perm:[1,1,3,3] row_mask:0xf bank_mask:0xf
    v_smfmac_f32_16x16x64_bf16 v[76:79], v[36:39], a[184:191], v7
    v_pk_add_f32 v[72:73], v[72:73], v[74:75]
    v_max_f32 v62, v52, v53
    s_nop 0
    v_add_f32_dpp v54, v73, v72 quad_perm:[1,1,3,3] row_mask:0xf bank_mask:0xf
    v_mov_b32 v63, v63
    v_mov_b32 v63, v63
    v_mov_b32 v63, v63
    v_mov_b32 v63, v63
    v_pk_add_f32 v[76:77], v[76:77], v[78:79]
    s_nop 1
    v_add_f32_dpp v55, v77, v76 quad_perm:[1,1,3,3] row_mask:0xf bank_mask:0xf
    v_max3_f32 v62, v62, v54, v55
    s_nop 1
    v_max_f32_dpp v62, v62, v62 quad_perm:[2,3,0,1] row_mask:0xf bank_mask:0xf
    s_nop 1
    v_max_f32_dpp v62, v62, v62 row_ror:4 row_mask:0xf bank_mask:0xf
    s_nop 1
    v_max_f32_dpp v62, v62, v62 row_ror:8 row_mask:0xf bank_mask:0xf
    v_mov_b32 v63, v62
    s_nop 1
    v_permlane16_swap_b32 v62, v63
    v_max_f32 v62, v62, v63
    v_mov_b32 v63, v62
    s_nop 1
    v_permlane32_swap_b32 v62, v63
    v_max_f32 v62, v62, v63
    v_pk_add_f32 v[52:53], v[52:53], v[62:63] op_sel_hi:[1,0] neg_lo:[0,1] neg_hi:[0,1]
    v_exp_f32 v52, v52
    v_pk_add_f32 v[54:55], v[54:55], v[62:63] op_sel_hi:[1,0] neg_lo:[0,1] neg_hi:[0,1]
    v_cvt_pk_bf16_f32 v56, v52, v52
    v_exp_f32 v53, v53
    v_exp_f32 v54, v54
    v_and_b32_dpp v16, v56, v5 quad_perm:[0,0,0,0] row_mask:0xf bank_mask:0xf
    v_and_b32_dpp v19, v56, v6 quad_perm:[0,0,0,0] row_mask:0xf bank_mask:0xf
    v_exp_f32 v55, v55
    v_mov_b32_dpp v17, v16 row_shr:4 row_mask:0xf bank_mask:0xf bound_ctrl:0
    v_mov_b32_dpp v18, v19 row_shl:4 row_mask:0xf bank_mask:0xf bound_ctrl:0
    v_cvt_pk_bf16_f32 v57, v53, v53
    s_waitcnt vmcnt(36)
    v_smfmac_f32_16x16x64_bf16 v[40:43], v[16:19], a[192:199], v7 abid:1
    ds_read_b128 v[64:67], v12 offset:4096
    v_and_b32_dpp v20, v56, v5 quad_perm:[2,2,2,2] row_mask:0xf bank_mask:0xf
    v_and_b32_dpp v23, v56, v6 quad_perm:[2,2,2,2] row_mask:0xf bank_mask:0xf
    v_smfmac_f32_16x16x64_bf16 v[44:47], v[16:19], a[200:207], v7 abid:1
    v_mov_b32_dpp v21, v20 row_shr:4 row_mask:0xf bank_mask:0xf bound_ctrl:0
    v_mov_b32_dpp v22, v23 row_shl:4 row_mask:0xf bank_mask:0xf bound_ctrl:0
    v_cvt_pk_bf16_f32 v58, v54, v54
    v_pk_add_f32 v[24:25], v[52:53], v[54:55]
    v_smfmac_f32_16x16x64_bf16 v[48:51], v[16:19], a[208:215], v7 abid:1
    v_smfmac_f32_16x16x64_bf16 v[40:43], v[20:23], a[216:223], v7 abid:1
    ds_read_b128 v[68:71], v12 offset:8192
    v_and_b32_dpp v16, v57, v5 quad_perm:[0,0,0,0] row_mask:0xf bank_mask:0xf
    v_and_b32_dpp v19, v57, v6 quad_perm:[0,0,0,0] row_mask:0xf bank_mask:0xf
    v_smfmac_f32_16x16x64_bf16 v[44:47], v[20:23], a[224:231], v7 abid:1
    v_mov_b32_dpp v17, v16 row_shr:4 row_mask:0xf bank_mask:0xf bound_ctrl:0
    v_mov_b32_dpp v18, v19 row_shl:4 row_mask:0xf bank_mask:0xf bound_ctrl:0
    v_cvt_pk_bf16_f32 v59, v55, v55
    v_add_f32 v63, v24, v25
    v_smfmac_f32_16x16x64_bf16 v[48:51], v[20:23], a[232:239], v7 abid:1
    s_waitcnt vmcnt(24)
    v_smfmac_f32_16x16x64_bf16 v[40:43], v[16:19], a[240:247], v7 abid:1
    v_and_b32_dpp v20, v57, v5 quad_perm:[2,2,2,2] row_mask:0xf bank_mask:0xf
    v_and_b32_dpp v23, v57, v6 quad_perm:[2,2,2,2] row_mask:0xf bank_mask:0xf
    v_smfmac_f32_16x16x64_bf16 v[44:47], v[16:19], a[248:255], v7 abid:1
    v_mov_b32_dpp v21, v20 row_shr:4 row_mask:0xf bank_mask:0xf bound_ctrl:0
    v_mov_b32_dpp v22, v23 row_shl:4 row_mask:0xf bank_mask:0xf bound_ctrl:0
    v_add_f32_dpp v63, v63, v63 quad_perm:[2,3,0,1] row_mask:0xf bank_mask:0xf
    v_smfmac_f32_16x16x64_bf16 v[48:51], v[16:19], v[128:135], v7 abid:1
    v_smfmac_f32_16x16x64_bf16 v[40:43], v[20:23], v[136:143], v7 abid:1
    v_add_f32_dpp v63, v63, v63 row_ror:4 row_mask:0xf bank_mask:0xf
    v_and_b32_dpp v16, v58, v5 quad_perm:[0,0,0,0] row_mask:0xf bank_mask:0xf
    v_and_b32_dpp v19, v58, v6 quad_perm:[0,0,0,0] row_mask:0xf bank_mask:0xf
    v_smfmac_f32_16x16x64_bf16 v[44:47], v[20:23], v[144:151], v7 abid:1
    v_mov_b32_dpp v17, v16 row_shr:4 row_mask:0xf bank_mask:0xf bound_ctrl:0
    v_mov_b32_dpp v18, v19 row_shl:4 row_mask:0xf bank_mask:0xf bound_ctrl:0
    v_add_f32_dpp v63, v63, v63 row_ror:8 row_mask:0xf bank_mask:0xf
    v_mov_b32 v24, v63
    v_smfmac_f32_16x16x64_bf16 v[48:51], v[20:23], v[152:159], v7 abid:1
    s_waitcnt vmcnt(12)
    v_smfmac_f32_16x16x64_bf16 v[40:43], v[16:19], v[160:167], v7 abid:1
    v_permlane16_swap_b32 v63, v24
    v_add_f32 v63, v63, v24
    v_and_b32_dpp v20, v58, v5 quad_perm:[2,2,2,2] row_mask:0xf bank_mask:0xf
    v_and_b32_dpp v23, v58, v6 quad_perm:[2,2,2,2] row_mask:0xf bank_mask:0xf
    v_smfmac_f32_16x16x64_bf16 v[44:47], v[16:19], v[168:175], v7 abid:1
    v_mov_b32_dpp v21, v20 row_shr:4 row_mask:0xf bank_mask:0xf bound_ctrl:0
    v_mov_b32_dpp v22, v23 row_shl:4 row_mask:0xf bank_mask:0xf bound_ctrl:0
    v_mov_b32 v24, v63
    v_smfmac_f32_16x16x64_bf16 v[48:51], v[16:19], v[176:183], v7 abid:1
    v_smfmac_f32_16x16x64_bf16 v[40:43], v[20:23], v[184:191], v7 abid:1
    v_permlane32_swap_b32 v63, v24
    v_add_f32 v63, v63, v24
    v_and_b32_dpp v16, v59, v5 quad_perm:[0,0,0,0] row_mask:0xf bank_mask:0xf
    v_and_b32_dpp v19, v59, v6 quad_perm:[0,0,0,0] row_mask:0xf bank_mask:0xf
    v_smfmac_f32_16x16x64_bf16 v[44:47], v[20:23], v[192:199], v7 abid:1
    v_mov_b32_dpp v17, v16 row_shr:4 row_mask:0xf bank_mask:0xf bound_ctrl:0
    v_mov_b32_dpp v18, v19 row_shl:4 row_mask:0xf bank_mask:0xf bound_ctrl:0
    s_waitcnt lgkmcnt(0)
    ds_write2_b32 v71, v62, v63 offset0:0 offset1:4
    v_smfmac_f32_16x16x64_bf16 v[48:51], v[20:23], v[200:207], v7 abid:1
    s_waitcnt vmcnt(0)
    v_smfmac_f32_16x16x64_bf16 v[40:43], v[16:19], v[208:215], v7 abid:1
    v_and_b32_dpp v20, v59, v5 quad_perm:[2,2,2,2] row_mask:0xf bank_mask:0xf
    v_and_b32_dpp v23, v59, v6 quad_perm:[2,2,2,2] row_mask:0xf bank_mask:0xf
    v_smfmac_f32_16x16x64_bf16 v[44:47], v[16:19], v[216:223], v7 abid:1
    v_mov_b32_dpp v21, v20 row_shr:4 row_mask:0xf bank_mask:0xf bound_ctrl:0
    v_mov_b32_dpp v22, v23 row_shl:4 row_mask:0xf bank_mask:0xf bound_ctrl:0
    s_mov_b32 vcc_lo, 0x00ff00ff
    v_smfmac_f32_16x16x64_bf16 v[48:51], v[16:19], v[224:231], v7 abid:1
    v_smfmac_f32_16x16x64_bf16 v[40:43], v[20:23], v[232:239], v7 abid:1
    v_smfmac_f32_16x16x64_bf16 v[44:47], v[20:23], v[240:247], v7 abid:1
    v_smfmac_f32_16x16x64_bf16 v[48:51], v[20:23], v[248:255], v7 abid:1
    s_mov_b32 vcc_hi, 0xff00ff00
    v_cmp_eq_u32 s[60:61], 24, v1
    v_mov_b32 v24, v24
    v_mov_b32 v24, v24
    v_mov_b32 v24, v24
    v_mov_b32 v24, v24
    v_mov_b32 v24, v24
    v_cndmask_b32_dpp v40, v44, v40, vcc row_ror:8 row_mask:0xf bank_mask:0xf
    v_cndmask_b32_dpp v41, v45, v41, vcc row_ror:8 row_mask:0xf bank_mask:0xf
    v_cndmask_b32_dpp v42, v46, v42, vcc row_ror:8 row_mask:0xf bank_mask:0xf
    v_cndmask_b32_dpp v43, v47, v43, vcc row_ror:8 row_mask:0xf bank_mask:0xf
    ds_write_b128 v15, v[40:43]
    v_cndmask_b32_dpp v48, v50, v48, vcc row_ror:8 row_mask:0xf bank_mask:0xf
    v_cndmask_b32_dpp v49, v51, v49, vcc row_ror:8 row_mask:0xf bank_mask:0xf
    ds_write_b64 v61, v[48:49]
    s_cmp_eq_u32 s49, 0
    s_cbranch_scc1 HOOKC
EXB:
    s_waitcnt lgkmcnt(0)
    s_barrier
    ds_read_b128 v[16:19], v70
    ds_read_b128 v[20:23], v70 offset:16
    ds_read_b64 v[24:25], v60 offset:0
    v_mov_b32 v44, v44
    ds_read_b64 v[26:27], v60 offset:768
    ds_read_b64 v[28:29], v60 offset:1536
    v_mov_b32 v44, v44
    ds_read_b64 v[30:31], v60 offset:2304
    ds_read_b64 v[32:33], v60 offset:3072
    v_mov_b32 v44, v44
    ds_read_b64 v[34:35], v60 offset:3840
    ds_read_b64 v[36:37], v60 offset:4608
    v_mov_b32 v44, v44
    ds_read_b64 v[38:39], v60 offset:5376
    s_mov_b32 s51, 0
    s_cmp_eq_u32 s49, 0
    s_cselect_b32 s52, 20, s46
    s_waitcnt lgkmcnt(9)
    v_max3_f32 v40, v16, v17, v18
    v_max_f32 v40, v40, v19
    v_pk_add_f32 v[16:17], v[16:17], v[40:41] op_sel_hi:[1,0] neg_lo:[0,1] neg_hi:[0,1]
    v_pk_add_f32 v[18:19], v[18:19], v[40:41] op_sel_hi:[1,0] neg_lo:[0,1] neg_hi:[0,1]
    v_exp_f32 v16, v16
    v_exp_f32 v17, v17
    v_exp_f32 v18, v18
    v_exp_f32 v19, v19
    s_waitcnt lgkmcnt(0)
    v_pk_mul_f32 v[20:21], v[20:21], v[16:17]
    v_pk_fma_f32 v[20:21], v[22:23], v[18:19], v[20:21]
    v_add_f32 v41, v20, v21
    v_rcp_f32 v42, v41
    v_log_f32 v43, v41
    v_pk_add_f32 v[24:25], v[24:25], v[26:27]
    v_pk_add_f32 v[28:29], v[28:29], v[30:31]
    v_pk_add_f32 v[32:33], v[32:33], v[34:35]
    v_pk_add_f32 v[36:37], v[36:37], v[38:39]
    v_pk_mul_f32 v[24:25], v[24:25], v[16:17] op_sel_hi:[1,0]
    v_pk_fma_f32 v[24:25], v[28:29], v[16:17], v[24:25] op_sel:[0,1,0] op_sel_hi:[1,1,1]
    v_pk_fma_f32 v[24:25], v[32:33], v[18:19], v[24:25] op_sel:[0,0,0] op_sel_hi:[1,0,1]
    v_pk_fma_f32 v[24:25], v[36:37], v[18:19], v[24:25] op_sel:[0,1,0] op_sel_hi:[1,1,1]
    v_pk_mul_f32 v[24:25], v[24:25], v[42:43] op_sel_hi:[1,0]
    v_add_f32 v43, v43, v40
    v_cvt_pk_bf16_f32 v24, v24, v25
    v_cndmask_b32 v24, v24, v43, s[60:61]
    buffer_store_dword v24, v14, s[16:19], s32 offen offset:0
    s_cmp_eq_u32 s50, 0
    s_cbranch_scc1 SLOW3
PUBD3:
    s_cmp_ge_u32 s52, 20
    s_cbranch_scc1 HOOKG
    v_mov_b32 v40, v40
    v_mov_b32 v40, v40
    v_mov_b32 v40, v40
    v_mov_b32 v40, v40
    v_mov_b32 v40, v40
    v_mov_b32 v40, v40
    v_mov_b32 v40, v40
    v_mov_b32 v40, v40
    v_mov_b32 v40, v40
    v_mov_b32 v40, v40
    v_mov_b32 v40, v40
    v_mov_b32 v40, v40
    v_mov_b32 v40, v40
    v_mov_b32 v40, v40
    v_mov_b32 v40, v40
    v_mov_b32 v40, v40
    buffer_load_dword v56, v65, s[16:19], s62 offen sc1
    buffer_load_dwordx4 v[44:47], v64, s[16:19], s62 offen offset:0 sc1
    buffer_load_dwordx4 v[48:51], v64, s[16:19], s62 offen offset:512 sc1
    buffer_load_dwordx4 v[52:55], v64, s[16:19], s62 offen offset:1024 sc1
    buffer_load_dword v57, v66, s[16:19], s49 offen sc1
    v_mov_b32 v40, v40
    v_mov_b32 v40, v40
    v_mov_b32 v40, v40
    v_mov_b32 v40, v40
    v_mov_b32 v40, v40
    v_mov_b32 v40, v40
    v_mov_b32 v40, v40
    v_mov_b32 v40, v40
    v_mov_b32 v40, v40
    v_mov_b32 v40, v40
    v_mov_b32 v40, v40
    v_mov_b32 v40, v40
    v_mov_b32 v40, v40
    v_mov_b32 v40, v40
    v_mov_b32 v40, v40
    v_mov_b32 v40, v40
    v_mov_b32 v40, v40
    v_mov_b32 v40, v40
    v_mov_b32 v40, v40
    v_mov_b32 v40, v40
WOP:
    buffer_load_dword v56, v65, s[16:19], s62 offen sc1
    buffer_load_dwordx4 v[44:47], v64, s[16:19], s62 offen offset:0 sc1
    buffer_load_dwordx4 v[48:51], v64, s[16:19], s62 offen offset:512 sc1
    buffer_load_dwordx4 v[52:55], v64, s[16:19], s62 offen offset:1024 sc1
    buffer_load_dword v57, v66, s[16:19], s49 offen sc1
    v_mov_b32 v40, v40
    v_mov_b32 v40, v40
    v_mov_b32 v40, v40
    v_mov_b32 v40, v40
    s_waitcnt vmcnt(5)
WOC:
    v_max3_u32 v63, v44, v48, v52
    v_mov_b32 v32, v56
    v_max_u32 v63, v63, v32
    v_cmp_eq_u32 vcc, -1, v63
    s_cbranch_vccnz AGWOP
    v_mfma_f32_16x16x32_bf16 v[16:19], v[44:47], v[80:83], 0
    v_max_f32_dpp v33, v32, v32 quad_perm:[1,0,3,2] row_mask:0xf bank_mask:0xf
    s_nop 0
    v_mfma_f32_16x16x32_bf16 v[16:19], v[48:51], v[96:99], v[16:19]
    v_max_f32_dpp v33, v33, v33 quad_perm:[2,3,0,1] row_mask:0xf bank_mask:0xf
    s_nop 0
    v_mfma_f32_16x16x32_bf16 v[16:19], v[52:55], v[112:115], v[16:19]
    v_max_f32_dpp v33, v33, v33 row_half_mirror row_mask:0xf bank_mask:0xf
    v_sub_f32 v34, v32, v33
    v_mfma_f32_16x16x32_bf16 v[20:23], v[44:47], v[84:87], 0
    v_exp_f32 v34, v34
    s_nop 0
    v_mfma_f32_16x16x32_bf16 v[20:23], v[48:51], v[100:103], v[20:23]
    v_add_f32_dpp v33, v34, v34 quad_perm:[1,0,3,2] row_mask:0xf bank_mask:0xf
    s_nop 0
    v_mfma_f32_16x16x32_bf16 v[20:23], v[52:55], v[116:119], v[20:23]
    v_add_f32_dpp v33, v33, v33 quad_perm:[2,3,0,1] row_mask:0xf bank_mask:0xf
    s_nop 0
    v_mfma_f32_16x16x32_bf16 v[24:27], v[44:47], v[88:91], 0
    v_add_f32_dpp v33, v33, v33 row_half_mirror row_mask:0xf bank_mask:0xf
    v_rcp_f32 v33, v33
    v_mfma_f32_16x16x32_bf16 v[24:27], v[48:51], v[104:107], v[24:27]
    v_mul_f32 v34, v34, v33
    s_nop 0
    v_mfma_f32_16x16x32_bf16 v[24:27], v[52:55], v[120:123], v[24:27]
    v_mul_f32_dpp v36, v34, v16 row_newbcast:0 row_mask:0xf bank_mask:0xf
    v_fmac_f32_dpp v36, v34, v17 row_newbcast:1 row_mask:0xf bank_mask:0xf
    v_mfma_f32_16x16x32_bf16 v[28:31], v[44:47], v[92:95], 0
    v_fmac_f32_dpp v36, v34, v18 row_newbcast:2 row_mask:0xf bank_mask:0xf
    v_fmac_f32_dpp v36, v34, v19 row_newbcast:3 row_mask:0xf bank_mask:0xf
    v_mfma_f32_16x16x32_bf16 v[28:31], v[48:51], v[108:111], v[28:31]
    v_mul_f32_dpp v37, v34, v20 row_newbcast:0 row_mask:0xf bank_mask:0xf
    v_fmac_f32_dpp v37, v34, v21 row_newbcast:1 row_mask:0xf bank_mask:0xf
    v_mfma_f32_16x16x32_bf16 v[28:31], v[52:55], v[124:127], v[28:31]
    v_fmac_f32_dpp v37, v34, v22 row_newbcast:2 row_mask:0xf bank_mask:0xf
    v_fmac_f32_dpp v37, v34, v23 row_newbcast:3 row_mask:0xf bank_mask:0xf
    v_cmp_u_f32 vcc, v36, v57
    v_mul_f32_dpp v38, v34, v24 row_newbcast:0 row_mask:0xf bank_mask:0xf
    v_fmac_f32_dpp v38, v34, v25 row_newbcast:1 row_mask:0xf bank_mask:0xf
    v_fmac_f32_dpp v38, v34, v26 row_newbcast:2 row_mask:0xf bank_mask:0xf
    v_fmac_f32_dpp v38, v34, v27 row_newbcast:3 row_mask:0xf bank_mask:0xf
    s_mov_b32 exec_hi, 0
    v_mul_f32_dpp v39, v34, v28 row_newbcast:0 row_mask:0xf bank_mask:0xf
    v_fmac_f32_dpp v39, v34, v29 row_newbcast:1 row_mask:0xf bank_mask:0xf
    v_fmac_f32_dpp v39, v34, v30 row_newbcast:2 row_mask:0xf bank_mask:0xf
    v_fmac_f32_dpp v39, v34, v31 row_newbcast:3 row_mask:0xf bank_mask:0xf
    ds_write_b128 v68, v[36:39]
    s_mov_b64 exec, -1
    s_cbranch_vccnz AGWOP
OKWOP:
    s_cmp_lg_u32 s44, 3
    s_waitcnt lgkmcnt(0)
    s_barrier
    s_cbranch_scc1 WOX
    ds_read2st64_b32 v[16:17], v69 offset0:0 offset1:1
    ds_read2st64_b32 v[18:19], v69 offset0:2 offset1:3
    ds_read2st64_b32 v[20:21], v69 offset0:4 offset1:5
    ds_read2st64_b32 v[22:23], v69 offset0:6 offset1:7
    s_waitcnt lgkmcnt(2)
    v_pk_add_f32 v[16:17], v[16:17], v[18:19]
    v_add_f32 v16, v16, v57
    s_waitcnt lgkmcnt(0)
    v_pk_add_f32 v[20:21], v[20:21], v[22:23]
    v_pk_add_f32 v[16:17], v[16:17], v[20:21]
    v_add_f32 v16, v16, v17
    buffer_store_dword v16, v67, s[16:19], s1 offen sc1
    buffer_store_dword v16, v67, s[16:19], s99 offen sc1
WOX:
    s_cmp_ge_u32 s46, 30
    s_cbranch_scc1 STX
    s_cmp_eq_u32 s44, 3
    s_cbranch_scc1 F1W3
    s_waitcnt vmcnt(0)
F1W3:
    s_waitcnt vmcnt(2)
F1E:
    ds_read_b128 v[56:59], v12 offset:16384
    ds_read_b128 v[52:55], v12 offset:12288
    ds_read_b128 v[60:63], v12 offset:20480
    s_mov_b32 s100, 0
    s_mov_b32 s51, 0
    s_waitcnt lgkmcnt(0)
    ds_read_b64_tr_b16 v[64:65], v57 offset:49152
    ds_read_b64_tr_b16 v[66:67], v57 offset:49664
    ds_read_b64_tr_b16 v[68:69], v57 offset:53248
    ds_read_b64_tr_b16 v[70:71], v57 offset:53760
    ds_read_b64_tr_b16 v[72:73], v57 offset:57344
    ds_read_b64_tr_b16 v[74:75], v57 offset:57856
    ds_read_b64_tr_b16 v[76:77], v57 offset:61440
    ds_read_b64_tr_b16 v[78:79], v57 offset:61952
    s_cmp_eq_u32 s49, 0
    s_cbranch_scc1 HOOKD
    s_cmp_lt_u32 s46, 20
    s_cbranch_scc1 GFB
    s_sleep 11
GFB:
    s_sleep 11
F1P:
F1W:
    buffer_load_dword v44, v52, s[16:19], s99 offen offset:0 sc1
    buffer_load_dword v45, v52, s[16:19], s99 offen offset:128 sc1
    buffer_load_dword v46, v52, s[16:19], s99 offen offset:256 sc1
    buffer_load_dword v47, v52, s[16:19], s99 offen offset:384 sc1
    buffer_load_dword v48, v52, s[16:19], s99 offen offset:512 sc1
    buffer_load_dword v49, v52, s[16:19], s99 offen offset:640 sc1
    buffer_load_dword v50, v52, s[16:19], s99 offen offset:768 sc1
    buffer_load_dword v51, v52, s[16:19], s99 offen offset:896 sc1
    s_waitcnt vmcnt(0)
    v_pk_add_f32 v[16:17], v[44:45], v[46:47]
    v_pk_add_f32 v[18:19], v[48:49], v[50:51]
    v_pk_add_f32 v[16:17], v[16:17], v[18:19]
    v_add_f32 v16, v16, v17
    v_mov_b32 v17, v16
    s_nop 1
    v_permlane32_swap_b32 v16, v17
    v_add_f32 v16, v16, v17
    v_cmp_u_f32 vcc, v16, v16
    v_cvt_pk_bf16_f32 v16, v16, v16
    ds_write_b16 v53, v16
    s_cbranch_vccnz AGF1P
OKF1P:
    v_and_b32 v16, 0xffff0000, v16
    buffer_store_dword v16, v54, s[16:19], s34 offen offset:0
    s_cmp_eq_u32 s50, 0
    s_cbranch_scc1 SLOW8
PUBD8:
    s_waitcnt lgkmcnt(0)
    s_barrier
    ds_read_b128 v[20:23], v2 offset:256
    ds_read_b128 v[24:27], v2 offset:320
    ds_read_b128 v[28:31], v2 offset:384
    ds_read_b128 v[32:35], v2 offset:448
    s_waitcnt lgkmcnt(3)
    v_mfma_f32_16x16x32_bf16 v[40:43], v[20:23], v[64:67], 0
    v_mfma_f32_16x16x32_bf16 v[36:39], v[20:23], v[20:23], 0
    s_waitcnt lgkmcnt(2)
    v_mfma_f32_16x16x32_bf16 v[40:43], v[24:27], v[68:71], v[40:43]
    v_mfma_f32_16x16x32_bf16 v[36:39], v[24:27], v[24:27], v[36:39]
    s_waitcnt lgkmcnt(1)
    v_mfma_f32_16x16x32_bf16 v[40:43], v[28:31], v[72:75], v[40:43]
    v_mfma_f32_16x16x32_bf16 v[36:39], v[28:31], v[28:31], v[36:39]
    s_waitcnt lgkmcnt(0)
    v_mfma_f32_16x16x32_bf16 v[40:43], v[32:35], v[76:79], v[40:43]
    v_mfma_f32_16x16x32_bf16 v[36:39], v[32:35], v[32:35], v[36:39]
    s_mov_b32 s51, 0
    s_nop 5
    buffer_store_dword v40, v55, s[16:19], s32 offen offset:0
    buffer_store_dwordx2 v[36:37], v56, s[16:19], s32 offen offset:0
    s_cmp_eq_u32 s50, 0
    s_cbranch_scc1 SLOW9
PUBD9:
    s_cmp_lt_u32 s46, 20
    s_cbranch_scc1 STX
    s_cmp_eq_u32 s49, 0
    s_cbranch_scc1 HOOKI
    v_mov_b32 v44, v44
    v_mov_b32 v44, v44
    v_mov_b32 v44, v44
    v_mov_b32 v44, v44
    v_mov_b32 v44, v44
    v_mov_b32 v44, v44
    v_mov_b32 v44, v44
    v_mov_b32 v44, v44
    v_mov_b32 v44, v44
    v_mov_b32 v44, v44
    v_mov_b32 v44, v44
    v_mov_b32 v44, v44
    v_mov_b32 v44, v44
    v_mov_b32 v44, v44
    v_mov_b32 v44, v44
    v_mov_b32 v44, v44
    v_mov_b32 v44, v44
    v_mov_b32 v44, v44
    v_mov_b32 v44, v44
    v_mov_b32 v44, v44
    v_mov_b32 v44, v44
    v_mov_b32 v44, v44
    v_mov_b32 v44, v44
    v_mov_b32 v44, v44
    v_mov_b32 v44, v44
    v_mov_b32 v44, v44
    v_mov_b32 v44, v44
    v_mov_b32 v44, v44
    buffer_load_dwordx2 v[74:75], v60, s[16:19], s62 offen sc1
    buffer_load_dwordx4 v[64:67], v58, s[16:19], s62 offen offset:0 sc1
    buffer_load_dwordx4 v[68:71], v58, s[16:19], s62 offen offset:3072 sc1
    buffer_load_dwordx2 v[72:73], v59, s[16:19], s62 offen sc1
    buffer_load_dword v76, v61, s[16:19], s49 offen sc1
    v_mov_b32 v44, v44
    v_mov_b32 v44, v44
    v_mov_b32 v44, v44
    v_mov_b32 v44, v44
    v_mov_b32 v44, v44
    v_mov_b32 v44, v44
    v_mov_b32 v44, v44
    v_mov_b32 v44, v44
    v_mov_b32 v44, v44
    v_mov_b32 v44, v44
    v_mov_b32 v44, v44
    v_mov_b32 v44, v44
    v_mov_b32 v44, v44
    v_mov_b32 v44, v44
    v_mov_b32 v44, v44
    v_mov_b32 v44, v44
    v_mov_b32 v44, v44
    v_mov_b32 v44, v44
    v_mov_b32 v44, v44
    v_mov_b32 v44, v44
W2P:
    buffer_load_dwordx2 v[74:75], v60, s[16:19], s62 offen sc1
    buffer_load_dwordx4 v[64:67], v58, s[16:19], s62 offen offset:0 sc1
    buffer_load_dwordx4 v[68:71], v58, s[16:19], s62 offen offset:3072 sc1
    buffer_load_dwordx2 v[72:73], v59, s[16:19], s62 offen sc1
    buffer_load_dword v76, v61, s[16:19], s49 offen sc1
    s_waitcnt vmcnt(5)
    v_add_f32_dpp v46, v74, v74 quad_perm:[1,0,3,2] row_mask:0xf bank_mask:0xf
    v_add_f32_dpp v47, v75, v75 quad_perm:[1,0,3,2] row_mask:0xf bank_mask:0xf
    v_pk_add_f32 v[18:19], v[64:65], v[66:67]
    v_add_f32_dpp v46, v46, v46 quad_perm:[2,3,0,1] row_mask:0xf bank_mask:0xf
    v_add_f32_dpp v47, v47, v47 quad_perm:[2,3,0,1] row_mask:0xf bank_mask:0xf
    v_pk_add_f32 v[20:21], v[68:69], v[70:71]
    v_add_f32_dpp v46, v46, v46 row_half_mirror row_mask:0xf bank_mask:0xf
    v_add_f32_dpp v47, v47, v47 row_half_mirror row_mask:0xf bank_mask:0xf
    v_add_f32 v16, v18, v19
    v_add_f32 v17, v20, v21
    v_mul_f32 v47, 0x3acccccd, v47
    v_fmamk_f32 v46, v46, 0x3acccccd, v11
    v_fma_f32 v46, -v47, v47, v46
    v_rsq_f32 v46, abs(v46)
    v_pk_add_f32 v[16:17], v[16:17], v[72:73]
    v_pk_fma_f32 v[16:17], v[46:47], v[126:127], v[16:17] op_sel:[1,0,0] op_sel_hi:[1,1,1] neg_lo:[1,0,0] neg_hi:[1,0,0]
    v_pk_mul_f32 v[16:17], v[16:17], v[46:47] op_sel_hi:[1,0]
    v_mul_f32 v18, 0xbfb8aa3b, v16
    v_exp_f32 v18, v18
    v_mul_f32 v16, v16, v17
    v_add_f32 v18, 1.0, v18
    v_rcp_f32 v18, v18
    v_cmp_u_f32 vcc, v16, v76
    v_mul_f32 v16, v16, v18
    v_cvt_pk_bf16_f32 v16, v16, v16
    ds_write_b16 v63, v16
    s_cbranch_vccnz AGW2P
OKW2P:
    s_waitcnt lgkmcnt(0)
    s_barrier
    ds_read_b128 v[16:19], v2 offset:512
    ds_read_b128 v[20:23], v2 offset:576
    ds_read_b128 v[24:27], v2 offset:640
    ds_read_b128 v[28:31], v2 offset:704
    ds_read_b128 v[32:35], v2 offset:768
    ds_read_b128 v[36:39], v2 offset:832
    v_mov_b32 v40, v76
    s_nop 0
    s_waitcnt lgkmcnt(5)
    v_mfma_f32_16x16x32_bf16 v[40:43], v[16:19], v[80:83], v[40:43]
    s_waitcnt lgkmcnt(4)
    v_mfma_f32_16x16x32_bf16 v[40:43], v[20:23], v[84:87], v[40:43]
    s_waitcnt lgkmcnt(3)
    v_mfma_f32_16x16x32_bf16 v[40:43], v[24:27], v[88:91], v[40:43]
    s_waitcnt lgkmcnt(2)
    v_mfma_f32_16x16x32_bf16 v[40:43], v[28:31], v[92:95], v[40:43]
    s_waitcnt lgkmcnt(1)
    v_mfma_f32_16x16x32_bf16 v[40:43], v[32:35], v[96:99], v[40:43]
    s_waitcnt lgkmcnt(0)
    v_mfma_f32_16x16x32_bf16 v[40:43], v[36:39], v[100:103], v[40:43]
    s_waitcnt vmcnt(0)
    s_nop 6
    buffer_store_dword v40, v62, s[16:19], s49 offen sc1
STX:
    s_cmp_lg_u32 s49, 0
    s_cbranch_scc1 LAST
    s_branch LOOP
LAST:
    s_and_b32 s52, s2, 0xc7
    s_cmp_eq_u32 s52, 0
    s_cbranch_scc1 LOOP
    s_endpgm
FINAL:
    s_cmp_eq_u32 s44, 3
    s_cbranch_scc1 FINX
    s_sleep 22
    s_waitcnt lgkmcnt(0)
Y3P:
    buffer_load_dword v22, v16, s[16:19], s55 offen offset:0 sc1
    buffer_load_dword v23, v16, s[16:19], s55 offen offset:128 sc1
    buffer_load_dword v24, v16, s[16:19], s55 offen offset:256 sc1
    buffer_load_dword v25, v16, s[16:19], s55 offen offset:384 sc1
    s_waitcnt vmcnt(0)
    v_pk_add_f32 v[22:23], v[22:23], v[24:25]
    v_add_f32 v30, v22, v23
    v_mov_b32 v31, v30
    s_nop 1
    v_permlane32_swap_b32 v30, v31
    v_add_f32 v30, v30, v31
    v_cmp_u_f32 vcc, v30, v30
    v_cvt_pk_bf16_f32 v30, v30, v30
    s_cbranch_vccnz AGY3P
OKY3P:
    buffer_store_short v30, v21, s[36:39], 0 offen
FINX:
DONE:
    s_endpgm
TABLES:
    v_mov_b32 v23, 1879048192
    v_and_b32 v24, 15, v1
    v_lshrrev_b32 v25, 4, v1
    v_and_b32 v26, 7, v1
    v_and_b32 v27, 31, v1
    v_lshrrev_b32 v28, 5, v1
    v_and_b32 v29, 31, v1
    v_lshl_add_u32 v29, s44, 5, v29
    v_lshrrev_b32 v16, 2, v1
    v_lshlrev_b32 v16, 7, v16
    v_and_b32 v20, 3, v1
    v_lshl_add_u32 v16, v20, 2, v16
    s_mul_i32 s52, s7, 3072
    s_mul_i32 s54, s44, 768
    s_add_u32 s52, s52, s54
    s_lshl_b32 s54, s48, 4
    s_add_u32 s52, s52, s54
    v_add_u32 v16, s52, v16
    v_cmp_gt_u32 vcc, 24, v1
    s_nop 1
    v_cndmask_b32 v16, v23, v16, vcc
    s_lshl_b32 s52, s7, 5
    s_lshl_b32 s54, s48, 2
    s_add_u32 s52, s52, s54
    s_add_u32 s52, s52, 19968
    s_cmp_eq_u32 s44, 3
    s_cselect_b32 s52, s52, 1879048192
    v_writelane_b32 v16, s52, 24
    v_lshlrev_b32 v17, 4, v26
    v_and_b32 v20, 1, v25
    v_lshl_add_u32 v17, v20, 7, v17
    v_mul_u32_u24 v20, 768, v28
    v_add_u32 v17, v17, v20
    s_mul_i32 s52, s44, 1536
    s_add_u32 s52, s52, 98816
    v_add_u32 v17, s52, v17
    v_bfe_u32 v20, v1, 3, 1
    v_xor_b32 v20, v20, v28
    v_lshl_add_u32 v19, v20, 3, v17
    v_add_u32 v19, 512, v19
    v_lshl_add_u32 v17, v20, 8, v17
    s_mul_i32 s52, s44, 24
    v_min_u32 v21, 23, v1
    v_add_u32 v21, s52, v21
    v_lshrrev_b32 v18, 5, v21
    v_lshlrev_b32 v18, 8, v18
    v_bfe_u32 v20, v21, 1, 1
    v_lshl_add_u32 v18, v20, 7, v18
    v_bfe_u32 v20, v21, 2, 3
    v_lshl_add_u32 v18, v20, 4, v18
    v_bfe_u32 v20, v21, 0, 1
    v_lshl_add_u32 v18, v20, 3, v18
    v_add_u32 v18, 98816, v18
    ds_write_b128 v12, v[16:19] offset:0
    v_lshlrev_b32 v16, 4, v26
    v_lshl_add_u32 v16, v25, 7, v16
    s_mul_i32 s52, s56, 6144
    s_mul_i32 s54, s44, 1536
    s_add_u32 s52, s52, s54
    v_add_u32 v16, s52, v16
    v_cmp_gt_u32 vcc, 8, v24
    s_nop 1
    v_cndmask_b32 v16, v23, v16, vcc
    s_lshr_b32 s53, s44, 1
    s_lshl_b32 s52, s56, 6
    s_lshl_b32 s54, s53, 5
    s_add_u32 s52, s52, s54
    s_add_u32 s52, s52, 19968
    v_lshl_add_u32 v17, v25, 2, v26
    v_and_b32 v17, 7, v17
    v_lshl_add_u32 v17, v17, 2, s52
    s_lshl_b32 s52, s57, 8
    s_add_u32 s52, s52, 131072
    s_or_b32 s53, s45, s56
    s_cmp_eq_u32 s53, 0
    s_cselect_b32 s52, s52, 1879048192
    v_lshl_add_u32 v18, v1, 2, s52
    v_lshlrev_b32 v19, 11, v28
    v_lshl_add_u32 v19, v27, 2, v19
    s_lshr_b32 s53, s57, 1
    s_lshl_b32 s52, s57, 12
    s_lshl_b32 s54, s53, 13
    s_add_u32 s52, s52, s54
    s_lshl_b32 s54, s45, 8
    s_add_u32 s52, s52, s54
    s_lshl_b32 s54, s56, 7
    s_add_u32 s52, s52, s54
    v_add_u32 v19, s52, v19
    ds_write_b128 v12, v[16:19] offset:4096
    s_lshl_b32 s52, s44, 9
    s_add_u32 s52, s52, 104960
    v_lshl_add_u32 v16, v27, 4, s52
    v_lshl_add_u32 v16, v28, 11, v16
    v_lshlrev_b32 v17, 4, v24
    v_lshl_add_u32 v17, v25, 2, v17
    v_add_u32 v17, 104960, v17
    v_mov_b32 v18, 98752
    s_lshl_b32 s52, s44, 2
    s_add_u32 s52, s52, 98752
    v_mov_b32 v19, 98792
    v_writelane_b32 v19, s52, 0
    ds_write_b128 v12, v[16:19] offset:8192
    v_lshlrev_b32 v16, 10, v28
    v_lshl_add_u32 v16, v27, 2, v16
    s_lshl_b32 s52, s3, 14
    s_lshl_b32 s54, s44, 11
    s_add_u32 s52, s52, s54
    v_add_u32 v16, s52, v16
    v_lshlrev_b32 v17, 1, v29
    v_add_u32 v17, 96512, v17
    s_lshl_b32 s52, s4, 9
    s_add_u32 s52, s52, 133632
    s_cmp_lt_u32 s4, 5
    s_cselect_b32 s52, s52, 1879048192
    s_cmp_eq_u32 s45, 0
    s_cselect_b32 s52, s52, 1879048192
    v_lshl_add_u32 v18, v29, 2, s52
    v_cmp_gt_u32 vcc, 32, v1
    s_nop 1
    v_cndmask_b32 v18, v23, v18, vcc
    s_lshl_b32 s52, s59, 6
    s_lshl_b32 s54, s44, 4
    s_add_u32 s52, s52, s54
    v_add_u32 v19, s52, v1
    s_mul_i32 s52, s58, 3072
    s_lshl_b32 s54, s3, 2
    s_add_u32 s52, s52, s54
    s_add_u32 s52, s52, 12288
    s_lshl_b32 s53, s58, 2
    s_add_u32 s53, s53, 18432
    s_cmp_eq_u32 s3, 4
    s_cselect_b32 s52, s53, s52
    s_cselect_b32 s53, 3, 4
    v_lshlrev_b32 v19, s53, v19
    v_add_u32 v19, s52, v19
    v_cmp_gt_u32 vcc, 16, v1
    s_nop 1
    v_cndmask_b32 v19, v23, v19, vcc
    ds_write_b128 v12, v[16:19] offset:12288
    s_lshl_b32 s52, s4, 3
    s_add_u32 s52, s52, 20224
    s_cmp_eq_u32 s44, 3
    s_cselect_b32 s52, s52, 1879048192
    s_cmp_lt_u32 s4, 5
    s_cselect_b32 s52, s52, 1879048192
    v_mov_b32 v16, v23
    v_writelane_b32 v16, s52, 0
    v_and_b32 v17, 3, v1
    v_lshlrev_b32 v17, 3, v17
    v_bfe_u32 v20, v1, 2, 2
    v_lshl_add_u32 v17, v20, 7, v17
    v_lshrrev_b32 v20, 4, v1
    v_lshl_add_u32 v17, v20, 10, v17
    v_bfe_u32 v20, v1, 3, 2
    v_lshl_add_u32 v17, v20, 5, v17
    s_lshl_b32 s52, s44, 5
    v_xor_b32 v17, s52, v17
    v_lshlrev_b32 v18, 4, v0
    v_add_u32 v18, 12288, v18
    v_lshlrev_b32 v19, 3, v0
    v_add_u32 v19, 18432, v19
    v_cmp_gt_u32 vcc, 192, v0
    s_nop 1
    v_cndmask_b32 v18, v23, v18, vcc
    v_cndmask_b32 v19, v23, v19, vcc
    ds_write_b128 v12, v[16:19] offset:16384
    v_lshlrev_b32 v16, 3, v26
    v_add_u32 v16, 20224, v16
    v_cmp_gt_u32 vcc, 5, v26
    s_nop 1
    v_cndmask_b32 v16, v23, v16, vcc
    v_cmp_gt_u32 vcc, 192, v0
    s_nop 1
    v_cndmask_b32 v16, v23, v16, vcc
    s_lshl_b32 s52, s57, 8
    s_lshl_b32 s54, s44, 6
    s_add_u32 s52, s52, s54
    s_add_u32 s52, s52, 133632
    s_cmp_eq_u32 s45, 0
    s_cselect_b32 s52, s52, 1879048192
    v_lshl_add_u32 v17, v24, 2, s52
    s_lshr_b32 s53, s57, 2
    s_lshr_b32 s51, s44, 1
    s_lshl_b32 s52, s57, 11
    s_lshl_b32 s54, s53, 13
    s_add_u32 s52, s52, s54
    s_mul_i32 s54, s51, 896
    s_add_u32 s52, s52, s54
    s_lshl_b32 s54, s44, 6
    s_add_u32 s52, s52, s54
    s_lshl_b32 s54, s45, 7
    s_add_u32 s52, s52, s54
    s_add_u32 s52, s52, 81920
    v_lshl_add_u32 v18, v24, 2, s52
    v_lshl_add_u32 v18, v25, 13, v18
    v_cmp_gt_u32 vcc, 32, v1
    s_nop 1
    v_cndmask_b32 v18, v23, v18, vcc
    v_lshlrev_b32 v19, 1, v0
    v_add_u32 v19, 96768, v19
    ds_write_b128 v12, v[16:19] offset:20480
    s_lshr_b32 s53, s48, 2
    s_mul_i32 s52, s7, 6144
    s_lshl_b32 s54, s44, 8
    s_add_u32 s52, s52, s54
    s_mul_i32 s54, s53, 3056
    s_add_u32 s52, s52, s54
    s_lshl_b32 s54, s48, 2
    s_add_u32 s52, s52, s54
    s_add_u32 s52, s52, 20480
    v_lshl_add_u32 v16, v1, 4, s52
    v_cmp_gt_u32 vcc, 16, v1
    s_nop 1
    v_cndmask_b32 v16, v23, v16, vcc
    s_lshl_b32 s52, s7, 6
    s_lshl_b32 s54, s48, 3
    s_add_u32 s52, s52, s54
    s_add_u32 s52, s52, 45056
    s_cmp_eq_u32 s44, 3
    s_cselect_b32 s52, s52, 1879048192
    v_mov_b32 v17, v23
    v_writelane_b32 v17, s52, 0
    s_mul_i32 s52, s48, 80
    v_add_u32 v20, s52, v29
    v_lshrrev_b32 v18, 5, v20
    v_lshlrev_b32 v18, 10, v18
    v_lshrrev_b32 v21, 8, v20
    v_lshl_add_u32 v18, v21, 13, v18
    v_and_b32 v21, 31, v20
    v_lshl_add_u32 v18, v21, 2, v18
    v_lshl_add_u32 v18, v28, 9, v18
    v_add_u32 v18, 81920, v18
    v_cmp_gt_u32 vcc, 80, v29
    s_nop 1
    v_cndmask_b32 v18, v23, v18, vcc
    v_lshlrev_b32 v19, 1, v29
    v_add_u32 v19, 96256, v19
    ds_write_b128 v12, v[16:19] offset:24576
    s_and_b32 s53, s2, 0xc7
    s_cmp_eq_u32 s53, 0
    s_mov_b32 s52, 131072
    s_cselect_b32 s52, s52, 1879048192
    v_lshl_add_u32 v16, v20, 2, s52
    v_lshlrev_b32 v19, 1, v20
    s_and_b32 vcc_hi, vcc_hi, 0
    s_nop 1
    v_cndmask_b32 v16, v23, v16, vcc
    v_cndmask_b32 v19, v23, v19, vcc
    v_and_b32 v21, 3, v1
    v_lshrrev_b32 v17, 4, v1
    v_bfe_u32 v18, v1, 2, 2
    v_lshlrev_b32 v21, 3, v21
    v_mul_u32_u24 v18, 384, v18
    v_add_u32 v21, v21, v18
    v_bfe_u32 v18, v1, 3, 2
    v_xor_b32 v18, s44, v18
    v_lshl_add_u32 v21, v18, 5, v21
    v_add_u32 v21, 65536, v21
    v_and_b32 v18, 1, v17
    v_mul_u32_u24 v17, 3072, v17
    v_mul_u32_u24 v18, 3072, v18
    v_add_u32 v17, v17, v21
    v_add_u32 v18, v18, v21
    ds_write_b128 v12, v[16:19] offset:28672
    s_branch ENTRY0
HOOKL:
    s_cmp_lt_u32 s46, 30
    s_cbranch_scc1 NOGSW
    v_mov_b32 v30, 20224
GSW:
    buffer_load_dword v31, v30, s[16:19], s96 offen sc1
    s_waitcnt vmcnt(0)
    v_cmp_u_f32 vcc, v31, v31
    s_cbranch_vccz NOGSW
    s_add_u32 s51, s51, 1
    s_sleep 2
    s_cmp_lt_u32 s51, 0x8000
    s_cbranch_scc1 GSW
NOGSW:
    s_cmp_ge_u32 s46, 30
    s_cselect_b32 s53, 10, 0
    s_sub_u32 s53, s46, s53
    v_min_u32 v31, 17, v1
    v_lshlrev_b32 v31, 7, v31
    s_mul_i32 s52, s45, 45312
    s_mul_i32 s54, s53, 2304
    s_add_u32 s52, s52, s54
    s_add_u32 s52, s52, 524288
    buffer_load_dword v31, v31, s[16:19], s52 offen sc1
    v_lshlrev_b32 v30, 3, v0
    s_mul_i32 s52, s47, 12288
    s_add_u32 s52, s52, 1441792
    s_add_u32 s53, s52, 0
    buffer_load_dwordx2 v[32:33], v30, s[16:19], s53 offen offset:0 sc1
    buffer_load_dwordx2 v[34:35], v30, s[16:19], s53 offen offset:1536 sc1
    s_add_u32 s53, s52, 3072
    buffer_load_dwordx2 v[36:37], v30, s[16:19], s53 offen offset:0 sc1
    buffer_load_dwordx2 v[38:39], v30, s[16:19], s53 offen offset:1536 sc1
    s_add_u32 s53, s52, 6144
    buffer_load_dwordx2 v[40:41], v30, s[16:19], s53 offen offset:0 sc1
    buffer_load_dwordx2 v[42:43], v30, s[16:19], s53 offen offset:1536 sc1
    s_add_u32 s53, s52, 9216
    buffer_load_dwordx2 v[26:27], v30, s[16:19], s53 offen offset:0 sc1
    buffer_load_dwordx2 v[28:29], v30, s[16:19], s53 offen offset:1536 sc1
    s_sleep 23
    s_mov_b32 s51, 0
    s_branch GYB
QCA:
    v_lshlrev_b32 v30, 3, v0
    s_mul_i32 s52, s47, 12288
    s_add_u32 s52, s52, 1441792
    s_add_u32 s53, s52, 0
    buffer_load_dwordx2 v[32:33], v30, s[16:19], s53 offen offset:0 sc1
    buffer_load_dwordx2 v[34:35], v30, s[16:19], s53 offen offset:1536 sc1
    s_add_u32 s53, s52, 3072
    buffer_load_dwordx2 v[36:37], v30, s[16:19], s53 offen offset:0 sc1
    buffer_load_dwordx2 v[38:39], v30, s[16:19], s53 offen offset:1536 sc1
    s_add_u32 s53, s52, 6144
    buffer_load_dwordx2 v[40:41], v30, s[16:19], s53 offen offset:0 sc1
    buffer_load_dwordx2 v[42:43], v30, s[16:19], s53 offen offset:1536 sc1
    s_add_u32 s53, s52, 9216
    buffer_load_dwordx2 v[26:27], v30, s[16:19], s53 offen offset:0 sc1
    buffer_load_dwordx2 v[28:29], v30, s[16:19], s53 offen offset:1536 sc1
    s_waitcnt vmcnt(0)
    s_add_u32 s51, s51, 1
    s_sleep 2
    s_cmp_lt_u32 s51, 0x8000
    s_cbranch_scc1 QCP
    s_branch Y2W
Y2P:
    buffer_load_dword v22, v16, s[16:19], s55 offen offset:0 sc1
    buffer_load_dword v23, v16, s[16:19], s55 offen offset:128 sc1
    buffer_load_dword v24, v16, s[16:19], s55 offen offset:256 sc1
    buffer_load_dword v25, v16, s[16:19], s55 offen offset:384 sc1
    s_branch Y2W
AGY2P:
    s_add_u32 s51, s51, 1
    s_sleep 1
    s_cmp_lt_u32 s51, 0x8000
    s_cbranch_scc1 Y2P
    s_branch OKY2P
Q0L:
    v_and_b32 v21, 3, v1
    v_lshrrev_b32 v19, 4, v1
    v_bfe_u32 v20, v1, 2, 2
    v_lshlrev_b32 v21, 3, v21
    v_mul_u32_u24 v20, 384, v20
    v_add_u32 v21, v21, v20
    v_bfe_u32 v20, v1, 3, 2
    v_xor_b32 v20, s44, v20
    v_lshl_add_u32 v21, v20, 5, v21
    v_add_u32 v21, 65536, v21
    v_and_b32 v20, 1, v19
    v_mul_u32_u24 v19, 3072, v19
    v_mul_u32_u24 v20, 3072, v20
    v_add_u32 v19, v19, v21
    v_add_u32 v20, v20, v21
    s_branch QTR
HOOKA:
    s_mov_b64 exec, 0xffff
    s_nop 3
    s_lshl_b32 s52, s44, 6
    s_add_u32 s52, s52, 98816
    v_lshl_add_u32 v14, v1, 2, s52
    ds_write_b32 v14, v17 offset:10752
    v_fma_f32 v16, -v84, v17, v16
    v_mul_f32 v16, v16, v85
    ds_write_b32 v14, v16 offset:0
    ds_write_b32 v14, v21 offset:11008
    v_fma_f32 v20, -v84, v21, v20
    v_mul_f32 v20, v20, v85
    ds_write_b32 v14, v20 offset:256
    ds_write_b32 v14, v25 offset:11264
    v_fma_f32 v24, -v84, v25, v24
    v_mul_f32 v24, v24, v85
    ds_write_b32 v14, v24 offset:512
    s_mov_b64 exec, -1
    s_add_u32 s44, s44, 1
    s_cmp_lt_u32 s44, 4
    s_cbranch_scc1 Q0L
    s_mov_b32 s44, 3
    v_lshlrev_b32 v14, 2, v1
    v_add_u32 v14, 98816, v14
    ds_read2st64_b32 v[16:17], v14 offset0:0 offset1:1
    ds_read_b32 v18, v14 offset:512
    s_lshl_b32 s52, s47, 13
    s_lshl_b32 s54, s48, 10
    s_add_u32 s52, s52, s54
    s_add_u32 s52, s52, 1114112
    s_waitcnt lgkmcnt(0)
    v_bitop3_b32 v19, v16, v17, v18 bitop3:0x96
    v_xor_b32 v19, v19, v89
    buffer_store_dwordx4 v[16:19], v88, s[16:19], s52 offen sc1
    s_sleep 24
    v_and_b32 v15, 0xe1, v1
    v_lshlrev_b32 v15, 1, v15
    v_bfe_u32 v14, v1, 4, 1
    v_lshl_add_u32 v15, v14, 3, v15
    v_bfe_u32 v14, v1, 3, 1
    v_lshl_add_u32 v15, v14, 4, v15
    v_bfe_u32 v14, v1, 2, 1
    v_lshl_add_u32 v15, v14, 2, v15
    v_bfe_u32 v14, v1, 1, 1
    v_lshl_add_u32 v15, v14, 5, v15
    v_add_u32 v15, 98304, v15
    s_lshl_b32 s52, s47, 13
    s_add_u32 s52, s52, 1114112
    s_add_u32 s53, s52, 4096
    s_mov_b32 s51, 0
Q0P:
    buffer_load_dwordx4 v[16:19], v88, s[16:19], s52 offen offset:0 sc1
    buffer_load_dwordx4 v[20:23], v88, s[16:19], s52 offen offset:1024 sc1
    buffer_load_dwordx4 v[24:27], v88, s[16:19], s52 offen offset:2048 sc1
    buffer_load_dwordx4 v[28:31], v88, s[16:19], s52 offen offset:3072 sc1
    buffer_load_dwordx4 v[32:35], v88, s[16:19], s53 offen offset:0 sc1
    buffer_load_dwordx4 v[36:39], v88, s[16:19], s53 offen offset:1024 sc1
    buffer_load_dwordx4 v[40:43], v88, s[16:19], s53 offen offset:2048 sc1
    buffer_load_dwordx4 v[44:47], v88, s[16:19], s53 offen offset:3072 sc1
    v_mov_b32 v48, 0
    s_waitcnt vmcnt(0)
    v_bitop3_b32 v49, v16, v17, v18 bitop3:0x96
    v_bitop3_b32 v49, v49, v19, v89 bitop3:0x96
    v_or_b32 v48, v48, v49
    v_bitop3_b32 v49, v20, v21, v22 bitop3:0x96
    v_bitop3_b32 v49, v49, v23, v89 bitop3:0x96
    v_or_b32 v48, v48, v49
    v_bitop3_b32 v49, v24, v25, v26 bitop3:0x96
    v_bitop3_b32 v49, v49, v27, v89 bitop3:0x96
    v_or_b32 v48, v48, v49
    v_bitop3_b32 v49, v28, v29, v30 bitop3:0x96
    v_bitop3_b32 v49, v49, v31, v89 bitop3:0x96
    v_or_b32 v48, v48, v49
    v_bitop3_b32 v49, v32, v33, v34 bitop3:0x96
    v_bitop3_b32 v49, v49, v35, v89 bitop3:0x96
    v_or_b32 v48, v48, v49
    v_bitop3_b32 v49, v36, v37, v38 bitop3:0x96
    v_bitop3_b32 v49, v49, v39, v89 bitop3:0x96
    v_or_b32 v48, v48, v49
    v_bitop3_b32 v49, v40, v41, v42 bitop3:0x96
    v_bitop3_b32 v49, v49, v43, v89 bitop3:0x96
    v_or_b32 v48, v48, v49
    v_bitop3_b32 v49, v44, v45, v46 bitop3:0x96
    v_bitop3_b32 v49, v49, v47, v89 bitop3:0x96
    v_or_b32 v48, v48, v49
    v_cmp_ne_u32 vcc, 0, v48
    s_cbranch_vccz Q0OK
    s_add_u32 s51, s51, 1
    s_sleep 4
    s_cmp_lt_u32 s51, 0x8000
    s_cbranch_scc1 Q0P
Q0OK:
    v_pk_add_f32 v[16:17], v[16:17], v[20:21]
    v_add_f32 v18, v18, v22
    v_pk_add_f32 v[16:17], v[16:17], v[24:25]
    v_add_f32 v18, v18, v26
    v_pk_add_f32 v[16:17], v[16:17], v[28:29]
    v_add_f32 v18, v18, v30
    v_pk_add_f32 v[16:17], v[16:17], v[32:33]
    v_add_f32 v18, v18, v34
    v_pk_add_f32 v[16:17], v[16:17], v[36:37]
    v_add_f32 v18, v18, v38
    v_pk_add_f32 v[16:17], v[16:17], v[40:41]
    v_add_f32 v18, v18, v42
    v_pk_add_f32 v[16:17], v[16:17], v[44:45]
    v_add_f32 v18, v18, v46
    v_cvt_pk_bf16_f32 v16, v16, v17
    v_cvt_pk_bf16_f32 v18, v18, v18
    ds_write_b16 v15, v16
    ds_write_b16_d16_hi v15, v16 offset:128
    ds_write_b16 v15, v18 offset:256
    s_mov_b32 s51, 0
HSP:
    s_mov_b32 s52, 1376256
    buffer_load_dwordx4 v[24:27], v88, s[16:19], s52 offen sc1
    s_waitcnt vmcnt(0)
    v_xor_b32 v20, s5, v24
    v_xor_b32 v21, s5, v25
    v_xor_b32 v22, s5, v26
    v_xor_b32 v23, s5, v27
    v_or3_b32 v20, v20, v21, v22
    v_or_b32 v20, v20, v23
    v_cmp_lt_u32 vcc, 31, v20
    s_cbranch_vccz HSOK
    s_add_u32 s51, s51, 1
    s_sleep 8
    s_cmp_lt_u32 s51, 0x8000
    s_cbranch_scc1 HSP
HSOK:
    s_mov_b32 s53, 0
    v_and_b32 v24, 16, v24
    v_cmp_ne_u32 vcc, 0, v24
    s_bcnt1_i32_b64 s52, vcc
    s_add_u32 s53, s53, s52
    v_and_b32 v25, 16, v25
    v_cmp_ne_u32 vcc, 0, v25
    s_bcnt1_i32_b64 s52, vcc
    s_add_u32 s53, s53, s52
    v_and_b32 v26, 16, v26
    v_cmp_ne_u32 vcc, 0, v26
    s_bcnt1_i32_b64 s52, vcc
    s_add_u32 s53, s53, s52
    v_and_b32 v27, 16, v27
    v_cmp_ne_u32 vcc, 0, v27
    s_bcnt1_i32_b64 s52, vcc
    s_add_u32 s53, s53, s52
    v_and_b32 v20, 15, v20
    s_cmp_gt_u32 s53, 128
    s_cselect_b32 s53, 2, 0
    s_lshr_b32 s52, s5, 1
    s_xor_b32 s53, s53, s52
    s_and_b32 s53, s53, 2
    s_lshl_b32 s52, s45, 3
    v_cmp_ne_u32 vcc, 0, v20
    s_lshr_b64 s[60:61], vcc, s52
    s_and_b32 s52, s60, 0xff
    s_cselect_b32 s50, 0, 1
    v_mov_b32 v38, 98784
    s_or_b32 s53, s53, s50
    v_or_b32 v39, s53, v89
    ds_write_b32 v38, v39
    v_and_b32 v21, 0xffff0000, v86
    v_lshlrev_b32 v20, 16, v86
    buffer_store_dwordx2 v[20:21], v87, s[16:19], 0 offen sc1
    s_branch TABLES
EN3:
    v_mov_b64 v[72:73], 0
    v_mov_b64 v[74:75], 0
    v_mov_b64 v[76:77], 0
    v_mov_b64 v[78:79], 0
    v_mov_b64 v[40:41], 0
    v_mov_b64 v[42:43], 0
    v_mov_b64 v[44:45], 0
    v_mov_b64 v[46:47], 0
    v_mov_b64 v[48:49], 0
    v_mov_b64 v[50:51], 0
    s_branch ENOK2
ENTRY0:
    ds_read_b64 v[14:15], v12 offset:0
    ds_read_b64 v[60:61], v12 offset:8
    v_mov_b64 v[64:65], 0
    v_mov_b64 v[66:67], 0
    v_mov_b64 v[68:69], 0
    v_mov_b64 v[70:71], 0
    v_mov_b64 v[72:73], 0
    v_mov_b64 v[74:75], 0
    v_mov_b64 v[76:77], 0
    v_mov_b64 v[78:79], 0
    v_mov_b64 v[40:41], 0
    v_mov_b64 v[42:43], 0
    v_mov_b64 v[44:45], 0
    v_mov_b64 v[46:47], 0
    v_mov_b64 v[48:49], 0
    v_mov_b64 v[50:51], 0
    s_cmp_lg_u32 s44, 3
    s_cbranch_scc1 QFRAG
    s_waitcnt lgkmcnt(0)
    s_barrier
    s_waitcnt vmcnt(23)
    buffer_load_dwordx4 a[0:3], v80, s[8:11], s96 offen offset:0 nt
    s_waitcnt vmcnt(23)
    buffer_load_dwordx4 a[8:11], v80, s[8:11], s96 offen offset:128 nt
    s_waitcnt vmcnt(23)
    buffer_load_dwordx4 a[16:19], v80, s[8:11], s96 offen offset:256 nt
    s_add_u32 s96, s96, s97
    s_waitcnt vmcnt(23)
    buffer_load_dwordx4 a[4:7], v80, s[8:11], s96 offen offset:0 nt
    s_waitcnt vmcnt(23)
    buffer_load_dwordx4 a[12:15], v80, s[8:11], s96 offen offset:128 nt
    s_waitcnt vmcnt(23)
    buffer_load_dwordx4 a[20:23], v80, s[8:11], s96 offen offset:256 nt
    s_add_u32 s96, s96, s97
    s_waitcnt vmcnt(23)
    buffer_load_dwordx4 a[24:27], v80, s[8:11], s96 offen offset:0 nt
    s_waitcnt vmcnt(23)
    buffer_load_dwordx4 a[32:35], v80, s[8:11], s96 offen offset:128 nt
    s_waitcnt vmcnt(23)
    buffer_load_dwordx4 a[40:43], v80, s[8:11], s96 offen offset:256 nt
    s_add_u32 s96, s96, s97
    s_waitcnt vmcnt(23)
    buffer_load_dwordx4 a[28:31], v80, s[8:11], s96 offen offset:0 nt
    s_waitcnt vmcnt(23)
    buffer_load_dwordx4 a[36:39], v80, s[8:11], s96 offen offset:128 nt
    s_waitcnt vmcnt(23)
    buffer_load_dwordx4 a[44:47], v80, s[8:11], s96 offen offset:256 nt
    s_add_u32 s96, s96, s97
    s_waitcnt vmcnt(23)
    buffer_load_dwordx4 a[48:51], v80, s[8:11], s96 offen offset:0 nt
    s_waitcnt vmcnt(23)
    buffer_load_dwordx4 a[56:59], v80, s[8:11], s96 offen offset:128 nt
    s_waitcnt vmcnt(23)
    buffer_load_dwordx4 a[64:67], v80, s[8:11], s96 offen offset:256 nt
    s_add_u32 s96, s96, s97
    s_waitcnt vmcnt(23)
    buffer_load_dwordx4 a[52:55], v80, s[8:11], s96 offen offset:0 nt
    s_waitcnt vmcnt(23)
    buffer_load_dwordx4 a[60:63], v80, s[8:11], s96 offen offset:128 nt
    s_waitcnt vmcnt(23)
    buffer_load_dwordx4 a[68:71], v80, s[8:11], s96 offen offset:256 nt
    s_add_u32 s96, s96, s97
    s_waitcnt vmcnt(23)
    buffer_load_dwordx4 a[72:75], v80, s[8:11], s96 offen offset:0 nt
    s_waitcnt vmcnt(23)
    buffer_load_dwordx4 a[80:83], v80, s[8:11], s96 offen offset:128 nt
    s_waitcnt vmcnt(23)
    buffer_load_dwordx4 a[88:91], v80, s[8:11], s96 offen offset:256 nt
    s_add_u32 s96, s96, s97
    s_waitcnt vmcnt(23)
    buffer_load_dwordx4 a[76:79], v80, s[8:11], s96 offen offset:0 nt
    s_waitcnt vmcnt(23)
    buffer_load_dwordx4 a[84:87], v80, s[8:11], s96 offen offset:128 nt
    s_waitcnt vmcnt(23)
    buffer_load_dwordx4 a[92:95], v80, s[8:11], s96 offen offset:256 nt
    s_add_u32 s96, s96, s97
    s_waitcnt vmcnt(23)
    buffer_load_dwordx4 a[96:99], v80, s[8:11], s96 offen offset:0 nt
    s_waitcnt vmcnt(23)
    buffer_load_dwordx4 a[104:107], v80, s[8:11], s96 offen offset:128 nt
    s_waitcnt vmcnt(23)
    buffer_load_dwordx4 a[112:115], v80, s[8:11], s96 offen offset:256 nt
    s_add_u32 s96, s96, s97
    s_waitcnt vmcnt(23)
    buffer_load_dwordx4 a[100:103], v80, s[8:11], s96 offen offset:0 nt
    s_waitcnt vmcnt(23)
    buffer_load_dwordx4 a[108:111], v80, s[8:11], s96 offen offset:128 nt
    s_waitcnt vmcnt(23)
    buffer_load_dwordx4 a[116:119], v80, s[8:11], s96 offen offset:256 nt
    s_add_u32 s96, s96, s97
    s_waitcnt vmcnt(23)
    buffer_load_dwordx4 a[120:123], v80, s[8:11], s96 offen offset:0 nt
    s_waitcnt vmcnt(23)
    buffer_load_dwordx4 a[128:131], v80, s[8:11], s96 offen offset:128 nt
    s_waitcnt vmcnt(23)
    buffer_load_dwordx4 a[136:139], v80, s[8:11], s96 offen offset:256 nt
    s_add_u32 s96, s96, s97
    s_waitcnt vmcnt(23)
    buffer_load_dwordx4 a[124:127], v80, s[8:11], s96 offen offset:0 nt
    s_waitcnt vmcnt(23)
    buffer_load_dwordx4 a[132:135], v80, s[8:11], s96 offen offset:128 nt
    s_waitcnt vmcnt(23)
    buffer_load_dwordx4 a[140:143], v80, s[8:11], s96 offen offset:256 nt
    s_add_u32 s96, s96, s97
    s_waitcnt vmcnt(23)
    buffer_load_dwordx4 a[144:147], v80, s[8:11], s96 offen offset:0 nt
    s_waitcnt vmcnt(23)
    buffer_load_dwordx4 a[152:155], v80, s[8:11], s96 offen offset:128 nt
    s_waitcnt vmcnt(23)
    buffer_load_dwordx4 a[160:163], v80, s[8:11], s96 offen offset:256 nt
    s_add_u32 s96, s96, s97
    s_waitcnt vmcnt(23)
    buffer_load_dwordx4 a[148:151], v80, s[8:11], s96 offen offset:0 nt
    s_waitcnt vmcnt(23)
    buffer_load_dwordx4 a[156:159], v80, s[8:11], s96 offen offset:128 nt
    s_waitcnt vmcnt(23)
    buffer_load_dwordx4 a[164:167], v80, s[8:11], s96 offen offset:256 nt
    s_add_u32 s96, s96, s97
    s_waitcnt vmcnt(23)
    buffer_load_dwordx4 a[168:171], v80, s[8:11], s96 offen offset:0 nt
    s_waitcnt vmcnt(23)
    buffer_load_dwordx4 a[176:179], v80, s[8:11], s96 offen offset:128 nt
    s_waitcnt vmcnt(23)
    buffer_load_dwordx4 a[184:187], v80, s[8:11], s96 offen offset:256 nt
    s_add_u32 s96, s96, s97
    s_waitcnt vmcnt(23)
    buffer_load_dwordx4 a[172:175], v80, s[8:11], s96 offen offset:0 nt
    s_waitcnt vmcnt(23)
    buffer_load_dwordx4 a[180:183], v80, s[8:11], s96 offen offset:128 nt
    s_waitcnt vmcnt(23)
    buffer_load_dwordx4 a[188:191], v80, s[8:11], s96 offen offset:256 nt
    s_lshl_b32 s97, s97, 1
    s_waitcnt vmcnt(23)
    buffer_load_dwordx4 a[192:195], v82, s[12:15], s55 offen offset:0 nt
    s_waitcnt vmcnt(23)
    buffer_load_dwordx4 a[200:203], v82, s[12:15], s55 offen offset:128 nt
    s_waitcnt vmcnt(23)
    buffer_load_dwordx4 a[208:211], v82, s[12:15], s55 offen offset:256 nt
    s_waitcnt vmcnt(23)
    buffer_load_dwordx4 a[216:219], v82, s[12:15], s55 offen offset:384 nt
    s_waitcnt vmcnt(23)
    buffer_load_dwordx4 a[224:227], v82, s[12:15], s55 offen offset:512 nt
    s_waitcnt vmcnt(23)
    buffer_load_dwordx4 a[232:235], v82, s[12:15], s55 offen offset:640 nt
    s_add_u32 s55, s55, s97
    s_waitcnt vmcnt(23)
    buffer_load_dwordx4 a[196:199], v82, s[12:15], s55 offen offset:0 nt
    s_waitcnt vmcnt(23)
    buffer_load_dwordx4 a[204:207], v82, s[12:15], s55 offen offset:128 nt
    s_waitcnt vmcnt(23)
    buffer_load_dwordx4 a[212:215], v82, s[12:15], s55 offen offset:256 nt
    s_waitcnt vmcnt(23)
    buffer_load_dwordx4 a[220:223], v82, s[12:15], s55 offen offset:384 nt
    s_waitcnt vmcnt(23)
    buffer_load_dwordx4 a[228:231], v82, s[12:15], s55 offen offset:512 nt
    s_waitcnt vmcnt(23)
    buffer_load_dwordx4 a[236:239], v82, s[12:15], s55 offen offset:640 nt
    s_add_u32 s55, s55, s97
    s_waitcnt vmcnt(23)
    buffer_load_dwordx4 a[240:243], v82, s[12:15], s55 offen offset:0 nt
    s_waitcnt vmcnt(23)
    buffer_load_dwordx4 a[248:251], v82, s[12:15], s55 offen offset:128 nt
    s_waitcnt vmcnt(23)
    buffer_load_dwordx4 v[128:131], v82, s[12:15], s55 offen offset:256 nt
    s_waitcnt vmcnt(23)
    buffer_load_dwordx4 v[136:139], v82, s[12:15], s55 offen offset:384 nt
    s_waitcnt vmcnt(23)
    buffer_load_dwordx4 v[144:147], v82, s[12:15], s55 offen offset:512 nt
    s_waitcnt vmcnt(23)
    buffer_load_dwordx4 v[152:155], v82, s[12:15], s55 offen offset:640 nt
    s_add_u32 s55, s55, s97
    s_waitcnt vmcnt(23)
    buffer_load_dwordx4 a[244:247], v82, s[12:15], s55 offen offset:0 nt
    s_waitcnt vmcnt(23)
    buffer_load_dwordx4 a[252:255], v82, s[12:15], s55 offen offset:128 nt
    s_waitcnt vmcnt(23)
    buffer_load_dwordx4 v[132:135], v82, s[12:15], s55 offen offset:256 nt
    s_waitcnt vmcnt(23)
    buffer_load_dwordx4 v[140:143], v82, s[12:15], s55 offen offset:384 nt
    s_waitcnt vmcnt(23)
    buffer_load_dwordx4 v[148:151], v82, s[12:15], s55 offen offset:512 nt
    s_waitcnt vmcnt(23)
    buffer_load_dwordx4 v[156:159], v82, s[12:15], s55 offen offset:640 nt
    s_add_u32 s55, s55, s97
    s_waitcnt vmcnt(23)
    buffer_load_dwordx4 v[160:163], v82, s[12:15], s55 offen offset:0 nt
    s_waitcnt vmcnt(23)
    buffer_load_dwordx4 v[168:171], v82, s[12:15], s55 offen offset:128 nt
    s_waitcnt vmcnt(23)
    buffer_load_dwordx4 v[176:179], v82, s[12:15], s55 offen offset:256 nt
    s_waitcnt vmcnt(23)
    buffer_load_dwordx4 v[184:187], v82, s[12:15], s55 offen offset:384 nt
    s_waitcnt vmcnt(23)
    buffer_load_dwordx4 v[192:195], v82, s[12:15], s55 offen offset:512 nt
    s_waitcnt vmcnt(23)
    buffer_load_dwordx4 v[200:203], v82, s[12:15], s55 offen offset:640 nt
    s_add_u32 s55, s55, s97
    s_waitcnt vmcnt(23)
    buffer_load_dwordx4 v[164:167], v82, s[12:15], s55 offen offset:0 nt
    s_waitcnt vmcnt(23)
    buffer_load_dwordx4 v[172:175], v82, s[12:15], s55 offen offset:128 nt
    s_waitcnt vmcnt(23)
    buffer_load_dwordx4 v[180:183], v82, s[12:15], s55 offen offset:256 nt
    s_waitcnt vmcnt(23)
    buffer_load_dwordx4 v[188:191], v82, s[12:15], s55 offen offset:384 nt
    s_waitcnt vmcnt(23)
    buffer_load_dwordx4 v[196:199], v82, s[12:15], s55 offen offset:512 nt
    s_waitcnt vmcnt(23)
    buffer_load_dwordx4 v[204:207], v82, s[12:15], s55 offen offset:640 nt
    s_add_u32 s55, s55, s97
    s_waitcnt vmcnt(23)
    buffer_load_dwordx4 v[208:211], v82, s[12:15], s55 offen offset:0 nt
    s_waitcnt vmcnt(23)
    buffer_load_dwordx4 v[216:219], v82, s[12:15], s55 offen offset:128 nt
    s_waitcnt vmcnt(23)
    buffer_load_dwordx4 v[224:227], v82, s[12:15], s55 offen offset:256 nt
    s_waitcnt vmcnt(23)
    buffer_load_dwordx4 v[232:235], v82, s[12:15], s55 offen offset:384 nt
    s_waitcnt vmcnt(23)
    buffer_load_dwordx4 v[240:243], v82, s[12:15], s55 offen offset:512 nt
    s_waitcnt vmcnt(23)
    buffer_load_dwordx4 v[248:251], v82, s[12:15], s55 offen offset:640 nt
    s_add_u32 s55, s55, s97
    s_barrier
    s_waitcnt vmcnt(23)
    buffer_load_dwordx4 v[212:215], v82, s[12:15], s55 offen offset:0 nt
    s_waitcnt vmcnt(23)
    buffer_load_dwordx4 v[220:223], v82, s[12:15], s55 offen offset:128 nt
    s_waitcnt vmcnt(23)
    buffer_load_dwordx4 v[228:231], v82, s[12:15], s55 offen offset:256 nt
    s_waitcnt vmcnt(23)
    buffer_load_dwordx4 v[236:239], v82, s[12:15], s55 offen offset:384 nt
    s_waitcnt vmcnt(23)
    buffer_load_dwordx4 v[244:247], v82, s[12:15], s55 offen offset:512 nt
    s_waitcnt vmcnt(23)
    buffer_load_dwordx4 v[252:255], v82, s[12:15], s55 offen offset:640 nt
    s_branch QFRAG
HOOKF:
    v_mov_b32 v52, 98784
    ds_read_b32 v52, v52
    s_mov_b32 s6, 0
    s_waitcnt lgkmcnt(0)
    v_readfirstlane_b32 s101, v52
    s_and_b32 s50, s101, 1
    s_and_b32 s0, s101, 2
    s_lshl_b32 s0, s0, 12
    s_and_b32 s101, s101, 0xffffffe0
    s_cmp_lg_u32 s50, 0
    s_cselect_b32 s32, s62, 1610612736
    s_cselect_b32 s33, 1610612736, s62
    s_cmp_lg_u32 s50, 0
    s_cselect_b32 s34, s49, 1610612736
    s_cselect_b32 s35, 1610612736, s49
    s_add_u32 s99, s49, s0
    s_xor_b32 s1, s99, 8192
    s_waitcnt vmcnt(48)
    s_branch QK
AGENP:
    s_add_u32 s51, s51, 1
    s_cmp_lt_u32 s51, 0x8000
    s_cbranch_scc1 ENP
    s_branch OKENP
HOOKC:
    s_cmp_eq_u32 s44, 3
    s_cbranch_scc1 EXB
    s_cmp_eq_u32 s44, 1
    s_cbranch_scc1 WM1
    s_cmp_eq_u32 s44, 2
    s_cbranch_scc1 WM2
    v_min_u32 v83, 8, v1
    v_lshlrev_b32 v83, 7, v83
    s_mul_i32 s52, s45, 28160
    s_mul_i32 s54, s46, 1152
    s_add_u32 s52, s52, s54
    s_add_u32 s52, s52, 131072
    buffer_load_dword v83, v83, s[16:19], s52 offen sc1
    s_branch WM3
WM1:
    v_min_u32 v83, 11, v1
    v_lshlrev_b32 v83, 7, v83
    s_mul_i32 s52, s45, 45312
    s_mul_i32 s54, s46, 1536
    s_add_u32 s52, s52, s54
    s_add_u32 s52, s52, 529408
    buffer_load_dword v83, v83, s[16:19], s52 offen sc1
    s_branch WM3
WM2:
    v_min_u32 v83, 11, v1
    v_lshlrev_b32 v83, 7, v83
    s_mul_i32 s52, s45, 49152
    s_mul_i32 s54, s46, 1536
    s_add_u32 s52, s52, s54
    s_add_u32 s52, s52, 1441792
    buffer_load_dword v83, v83, s[16:19], s52 offen sc1
WM3:
    v_lshrrev_b32 v58, 3, v1
    v_and_b32 v57, 7, v1
    v_and_b32 v56, 2, v58
    v_xor_b32 v57, v57, v56
    s_and_b32 s52, s44, 1
    s_lshl_b32 s52, s52, 2
    v_xor_b32 v57, s52, v57
    v_mul_u32_u24 v56, 3072, v58
    v_lshl_add_u32 v56, v57, 4, v56
    v_lshrrev_b32 v58, 3, v1
    v_and_b32 v57, 7, v1
    v_and_b32 v55, 2, v58
    v_xor_b32 v57, v57, v55
    s_and_b32 s52, s44, 1
    s_lshl_b32 s52, s52, 2
    v_xor_b32 v57, s52, v57
    v_mul_u32_u24 v55, 1280, v58
    v_lshl_add_u32 v55, v57, 4, v55
    s_barrier
    s_cmp_ge_u32 s46, 20
    s_cbranch_scc1 HC8
    s_mul_i32 s52, s45, 983040
    s_mul_i32 s54, s56, 491520
    s_add_u32 s52, s52, s54
    s_lshl_b32 s54, s57, 7
    s_add_u32 s52, s52, s54
    s_mul_i32 s54, s44, 10240
    s_add_u32 s52, s52, s54
    s_lshl_b32 s53, s44, 10
DMA1:
    s_mov_b32 m0, s53
    s_add_u32 s53, s53, 3072
    buffer_load_dwordx4 v55, s[24:27], s52 offen nt lds
    v_xor_b32 v55, 64, v55
    s_add_u32 s52, s52, 30720
    s_cmp_lt_u32 s53, 49152
    s_cbranch_scc1 DMA1
HC8:
    s_cmp_ge_u32 s46, 30
    s_cbranch_scc1 HC7
    s_mul_i32 s52, s3, 393216
    s_mul_i32 s54, s45, 384
    s_add_u32 s52, s52, s54
    s_lshl_b32 s54, s59, 7
    s_add_u32 s52, s52, s54
    s_mul_i32 s54, s44, 24576
    s_add_u32 s52, s52, s54
    s_lshl_b32 s53, s44, 10
    s_add_u32 s53, s53, 49152
DMA2:
    s_mov_b32 m0, s53
    s_add_u32 s53, s53, 3072
    buffer_load_dwordx4 v56, s[28:31], s52 offen nt lds
    v_xor_b32 v56, 64, v56
    s_add_u32 s52, s52, 73728
    s_cmp_lt_u32 s53, 65536
    s_cbranch_scc1 DMA2
HC7:
    s_branch EXB
HOOKG:
    s_cmp_lg_u32 s49, 0
    s_cbranch_scc1 WOX
    s_cmp_ge_u32 s46, 20
    s_cbranch_scc1 HOOKG3
    v_and_b32 v72, 3, v1
    v_lshlrev_b32 v72, 3, v72
    v_bfe_u32 v73, v1, 2, 2
    v_lshl_add_u32 v72, v73, 7, v72
    v_lshrrev_b32 v73, 4, v1
    v_lshl_add_u32 v72, v73, 10, v72
    v_bfe_u32 v73, v1, 3, 2
    v_lshl_add_u32 v72, v73, 5, v72
    s_mul_i32 s52, s44, 12288
    v_add_u32 v72, s52, v72
    v_xor_b32 v73, 32, v72
    v_xor_b32 v74, 64, v72
    v_xor_b32 v75, 96, v72
    s_cmp_lg_u32 s44, 3
    s_cbranch_scc1 QCNA
    v_lshlrev_b32 v38, 2, v1
    v_add_u32 v39, 109568, v38
    v_lshlrev_b32 v38, 1, v38
    ds_read_b32 v32, v39 offset:0
    ds_read_b32 v34, v39 offset:256
    ds_read_b32 v36, v39 offset:512
    s_mul_i32 s52, s47, 12288
    s_mul_i32 s54, s48, 1536
    s_add_u32 s52, s52, s54
    s_add_u32 s52, s52, 1441792
    s_cmp_lg_u32 s50, 0
    s_cselect_b32 s53, s52, 1610612736
    s_cselect_b32 s54, 1610612736, s52
    s_waitcnt lgkmcnt(0)
    v_xor_b32 v33, s101, v32
    v_xor_b32 v35, s101, v34
    v_xor_b32 v37, s101, v36
    buffer_store_dwordx2 v[32:33], v38, s[16:19], s53 offen offset:0
    buffer_store_dwordx2 v[34:35], v38, s[16:19], s53 offen offset:512
    buffer_store_dwordx2 v[36:37], v38, s[16:19], s53 offen offset:1024
    s_cmp_eq_u32 s50, 0
    s_cbranch_scc1 SLOW4
PUBD4:
    s_branch QCMA
QCNA:
    s_waitcnt vmcnt(1)
QCMA:
    s_barrier
    buffer_load_dword v56, v65, s[16:19], s62 offen sc1
    buffer_load_dwordx4 v[44:47], v64, s[16:19], s62 offen offset:0 sc1
    buffer_load_dwordx4 v[48:51], v64, s[16:19], s62 offen offset:512 sc1
    buffer_load_dwordx4 v[52:55], v64, s[16:19], s62 offen offset:1024 sc1
    buffer_load_dword v57, v66, s[16:19], s49 offen sc1
    ds_read_b64_tr_b16 v[80:81], v72 offset:0
    ds_read_b64_tr_b16 v[82:83], v72 offset:512
    ds_read_b64_tr_b16 v[96:97], v72 offset:4096
    ds_read_b64_tr_b16 v[98:99], v72 offset:4608
    ds_read_b64_tr_b16 v[112:113], v72 offset:8192
    ds_read_b64_tr_b16 v[114:115], v72 offset:8704
    ds_read_b64_tr_b16 v[84:85], v73 offset:0
    ds_read_b64_tr_b16 v[86:87], v73 offset:512
    ds_read_b64_tr_b16 v[100:101], v73 offset:4096
    ds_read_b64_tr_b16 v[102:103], v73 offset:4608
    ds_read_b64_tr_b16 v[116:117], v73 offset:8192
    ds_read_b64_tr_b16 v[118:119], v73 offset:8704
    ds_read_b64_tr_b16 v[88:89], v74 offset:0
    ds_read_b64_tr_b16 v[90:91], v74 offset:512
    ds_read_b64_tr_b16 v[104:105], v74 offset:4096
    ds_read_b64_tr_b16 v[106:107], v74 offset:4608
    ds_read_b64_tr_b16 v[120:121], v74 offset:8192
    ds_read_b64_tr_b16 v[122:123], v74 offset:8704
    ds_read_b64_tr_b16 v[92:93], v75 offset:0
    ds_read_b64_tr_b16 v[94:95], v75 offset:512
    ds_read_b64_tr_b16 v[108:109], v75 offset:4096
    ds_read_b64_tr_b16 v[110:111], v75 offset:4608
    ds_read_b64_tr_b16 v[124:125], v75 offset:8192
    ds_read_b64_tr_b16 v[126:127], v75 offset:8704
    s_waitcnt lgkmcnt(0) vmcnt(0)
    s_branch WOC
HOOKG3:
    s_cmp_lg_u32 s44, 3
    s_cbranch_scc1 QCNB
    v_lshlrev_b32 v38, 2, v1
    v_add_u32 v39, 109568, v38
    v_lshlrev_b32 v38, 1, v38
    ds_read_b32 v32, v39 offset:0
    ds_read_b32 v34, v39 offset:256
    ds_read_b32 v36, v39 offset:512
    s_mul_i32 s52, s47, 12288
    s_mul_i32 s54, s48, 1536
    s_add_u32 s52, s52, s54
    s_add_u32 s52, s52, 1441792
    s_cmp_lg_u32 s50, 0
    s_cselect_b32 s53, s52, 1610612736
    s_cselect_b32 s54, 1610612736, s52
    s_waitcnt lgkmcnt(0)
    v_xor_b32 v33, s101, v32
    v_xor_b32 v35, s101, v34
    v_xor_b32 v37, s101, v36
    buffer_store_dwordx2 v[32:33], v38, s[16:19], s53 offen offset:0
    buffer_store_dwordx2 v[34:35], v38, s[16:19], s53 offen offset:512
    buffer_store_dwordx2 v[36:37], v38, s[16:19], s53 offen offset:1024
    s_cmp_eq_u32 s50, 0
    s_cbranch_scc1 SLOW5
PUBD5:
    s_branch QCMB
QCNB:
    s_waitcnt vmcnt(1)
QCMB:
    s_barrier
    s_cmp_lg_u32 s46, 31
    s_cbranch_scc1 EW1
    s_cmp_lg_u32 s44, 0
    s_cbranch_scc1 WOX
    v_and_b32 v32, 31, v1
    v_lshlrev_b32 v32, 2, v32
    v_add_u32 v32, 19968, v32
    s_lshl_b32 s52, s45, 7
    s_add_u32 s52, s52, 118784
    v_lshlrev_b32 v34, 13, v1
EWP:
    buffer_load_dword v33, v32, s[16:19], s62 offen sc1
    s_waitcnt vmcnt(0)
    v_cmp_u_f32 vcc, v33, v33
    s_cbranch_vccz EWOK
    s_add_u32 s51, s51, 1
    s_cmp_lt_u32 s51, 0x8000
    s_cbranch_scc1 EWP
EWOK:
    s_mov_b64 exec, 3
    buffer_store_dword v34, v34, s[16:19], s52 offen sc1
    s_mov_b64 exec, -1
EW1:
    s_cmp_ge_u32 s46, 30
    s_cbranch_scc1 WOX
    s_cmp_eq_u32 s44, 3
    s_cbranch_scc1 HD0
    v_lshrrev_b32 v33, 3, v1
    v_and_b32 v32, 7, v1
    v_and_b32 v34, 2, v33
    v_xor_b32 v32, v32, v34
    s_and_b32 s52, s44, 1
    s_lshl_b32 s52, s52, 2
    v_xor_b32 v32, s52, v32
    v_mul_u32_u24 v34, 1280, v33
    v_lshl_add_u32 v34, v32, 4, v34
    s_mul_i32 s52, s45, 245760
    s_lshl_b32 s54, s57, 7
    s_add_u32 s52, s52, s54
    s_mul_i32 s54, s44, 10240
    s_add_u32 s52, s52, s54
    s_lshl_b32 s53, s44, 10
DMA3:
    s_mov_b32 m0, s53
    s_add_u32 s53, s53, 3072
    buffer_load_dwordx4 v34, s[24:27], s52 offen nt lds
    v_xor_b32 v34, 64, v34
    s_add_u32 s52, s52, 30720
    s_cmp_lt_u32 s53, 24576
    s_cbranch_scc1 DMA3
HD0:
    v_mov_b64 v[116:117], -1
    v_mov_b64 v[118:119], -1
    v_mov_b32 v23, 1879048192
    s_mul_i32 s52, s57, 5120
    s_mul_i32 s54, s44, 1280
    s_add_u32 s52, s52, s54
    v_lshl_add_u32 v120, v1, 4, s52
    s_add_u32 s52, s52, 1024
    v_lshl_add_u32 v121, v1, 2, s52
    s_lshl_b32 s52, s57, 14
    s_lshl_b32 s54, s45, 11
    s_add_u32 s52, s52, s54
    s_lshl_b32 s54, s44, 9
    s_add_u32 s52, s52, s54
    v_lshl_add_u32 v122, v1, 3, s52
    v_cmp_gt_u32 vcc, 45312, v120
    s_nop 1
    v_cndmask_b32 v120, v23, v120, vcc
    v_cmp_gt_u32 vcc, 45312, v121
    s_nop 1
    v_cndmask_b32 v121, v23, v121, vcc
    v_cmp_gt_u32 vcc, 136192, v122
    s_nop 1
    v_cndmask_b32 v122, v23, v122, vcc
    s_branch F1E
AGWOP:
    s_add_u32 s51, s51, 1
    s_cmp_lt_u32 s51, 0x8000
    s_cbranch_scc1 WOP
    s_branch OKWOP
HOOKD:
    ds_read_b128 v[20:23], v2 offset:256
    ds_read_b128 v[24:27], v2 offset:320
    ds_read_b128 v[28:31], v2 offset:384
    ds_read_b128 v[32:35], v2 offset:448
    s_waitcnt lgkmcnt(0)
    v_mfma_f32_16x16x32_bf16 v[40:43], v[20:23], v[64:67], 0
    v_mfma_f32_16x16x32_bf16 v[40:43], v[24:27], v[68:71], v[40:43]
    v_mfma_f32_16x16x32_bf16 v[40:43], v[28:31], v[72:75], v[40:43]
    v_mfma_f32_16x16x32_bf16 v[40:43], v[32:35], v[76:79], v[40:43]
    s_add_u32 s52, s62, 8192
    s_cmp_lg_u32 s50, 0
    s_cselect_b32 s53, s52, 1610612736
    s_cselect_b32 s54, 1610612736, s52
    s_nop 3
    buffer_store_dword v41, v55, s[16:19], s53 offen offset:0
    s_cmp_eq_u32 s50, 0
    s_cbranch_scc1 SLOW6
PUBD6:
    v_and_b32 v16, 7, v1
    v_lshlrev_b32 v16, 7, v16
    s_add_u32 s52, s0, 118784
EWQ:
    buffer_load_dword v17, v16, s[16:19], s52 offen sc1
    s_waitcnt vmcnt(0)
    v_cmp_u_f32 vcc, v17, v17
    s_cbranch_vccz EWQK
    s_add_u32 s51, s51, 1
    s_sleep 1
    s_cmp_lt_u32 s51, 0x8000
    s_cbranch_scc1 EWQ
EWQK:
    s_sleep 1
    s_mov_b32 s51, 0
    s_cmp_lt_u32 s46, 20
    s_cbranch_scc1 F1W
    s_mov_b32 s100, 3
    s_cmp_lg_u32 s50, 0
    s_cselect_b32 s53, s63, 1610612736
    s_cselect_b32 s54, 1610612736, s63
    buffer_store_dwordx4 v[116:119], v120, s[16:19], s53 offen offset:0
    buffer_store_dword v116, v121, s[16:19], s53 offen offset:0
    s_cmp_eq_u32 s50, 0
    s_cbranch_scc1 SLOW7
PUBD7:
    s_mov_b32 s52, 393216
    buffer_store_dwordx2 v[116:117], v122, s[16:19], s52 offen sc1
    s_branch F1P
AGF1P:
    s_add_u32 s51, s51, 1
    s_sleep 1
    s_cmp_lt_u32 s51, 0x8000
    s_cbranch_scc1 F1P
    s_branch OKF1P
HOOKI:
    s_add_u32 s52, s62, 8192
    buffer_load_dwordx4 v[104:107], v58, s[16:19], s52 offen offset:0 sc1
    buffer_load_dwordx4 v[108:111], v58, s[16:19], s52 offen offset:3072 sc1
    buffer_load_dwordx2 v[112:113], v59, s[16:19], s52 offen sc1
    ds_read_b64_tr_b16 v[80:81], v57 offset:0
    ds_read_b64_tr_b16 v[82:83], v57 offset:512
    ds_read_b64_tr_b16 v[84:85], v57 offset:4096
    ds_read_b64_tr_b16 v[86:87], v57 offset:4608
    ds_read_b64_tr_b16 v[88:89], v57 offset:8192
    ds_read_b64_tr_b16 v[90:91], v57 offset:8704
    ds_read_b64_tr_b16 v[92:93], v57 offset:12288
    ds_read_b64_tr_b16 v[94:95], v57 offset:12800
    ds_read_b64_tr_b16 v[96:97], v57 offset:16384
    ds_read_b64_tr_b16 v[98:99], v57 offset:16896
    ds_read_b64_tr_b16 v[100:101], v57 offset:20480
    ds_read_b64_tr_b16 v[102:103], v57 offset:20992
    v_mov_b32 v44, v44
    v_mov_b32 v44, v44
    v_mov_b32 v44, v44
    v_mov_b32 v44, v44
    v_mov_b32 v44, v44
    v_mov_b32 v44, v44
    buffer_load_dwordx2 v[74:75], v60, s[16:19], s62 offen sc1
    buffer_load_dwordx4 v[64:67], v58, s[16:19], s62 offen offset:0 sc1
    buffer_load_dwordx4 v[68:71], v58, s[16:19], s62 offen offset:3072 sc1
    buffer_load_dwordx2 v[72:73], v59, s[16:19], s62 offen sc1
    buffer_load_dword v76, v61, s[16:19], s49 offen sc1
    v_mov_b32 v44, v44
    v_mov_b32 v44, v44
    v_mov_b32 v44, v44
    v_mov_b32 v44, v44
    v_mov_b32 v44, v44
    v_mov_b32 v44, v44
    v_mov_b32 v44, v44
    v_mov_b32 v44, v44
    v_mov_b32 v44, v44
    v_mov_b32 v44, v44
    v_mov_b32 v44, v44
    v_mov_b32 v44, v44
    v_mov_b32 v44, v44
    v_mov_b32 v44, v44
    v_mov_b32 v44, v44
    v_mov_b32 v44, v44
    s_waitcnt vmcnt(5)
GCC:
    v_pk_add_f32 v[114:115], v[104:105], v[106:107]
    v_pk_add_f32 v[116:117], v[108:109], v[110:111]
    v_add_f32 v126, v114, v115
    v_add_f32 v127, v116, v117
    v_pk_add_f32 v[126:127], v[126:127], v[112:113]
    v_cmp_u_f32 vcc, v126, v127
    s_cbranch_vccz W2P
    s_add_u32 s52, s62, 8192
    buffer_load_dwordx4 v[104:107], v58, s[16:19], s52 offen offset:0 sc1
    buffer_load_dwordx4 v[108:111], v58, s[16:19], s52 offen offset:3072 sc1
    buffer_load_dwordx2 v[112:113], v59, s[16:19], s52 offen sc1
    s_waitcnt vmcnt(0)
    s_add_u32 s51, s51, 1
    s_cmp_lt_u32 s51, 0x8000
    s_cbranch_scc1 GCC
    s_branch W2P
AGW2P:
    s_add_u32 s51, s51, 1
    s_cmp_lt_u32 s51, 0x8000
    s_cbranch_scc1 W2P
    s_branch OKW2P
AGY3P:
    s_add_u32 s51, s51, 1
    s_sleep 1
    s_cmp_lt_u32 s51, 0x8000
    s_cbranch_scc1 Y3P
    s_branch OKY3P
SLOW1:
    buffer_store_dword v30, v18, s[16:19], s35 offen offset:0 sc1
    s_branch PUBD1
SLOW2:
    buffer_store_dword v16, v14, s[16:19], s33 offen offset:0 sc1
    buffer_store_dword v20, v14, s[16:19], s33 offen offset:1024 sc1
    buffer_store_dword v24, v14, s[16:19], s33 offen offset:2048 sc1
    buffer_store_dwordx2 v[28:29], v15, s[16:19], s33 offen offset:0 sc1
    s_branch PUBD2
SLOW3:
    buffer_store_dword v24, v14, s[16:19], s33 offen offset:0 sc1
    s_branch PUBD3
SLOW4:
    buffer_store_dwordx2 v[32:33], v38, s[16:19], s54 offen offset:0 sc1
    buffer_store_dwordx2 v[34:35], v38, s[16:19], s54 offen offset:512 sc1
    buffer_store_dwordx2 v[36:37], v38, s[16:19], s54 offen offset:1024 sc1
    s_branch PUBD4
SLOW5:
    buffer_store_dwordx2 v[32:33], v38, s[16:19], s54 offen offset:0 sc1
    buffer_store_dwordx2 v[34:35], v38, s[16:19], s54 offen offset:512 sc1
    buffer_store_dwordx2 v[36:37], v38, s[16:19], s54 offen offset:1024 sc1
    s_branch PUBD5
SLOW6:
    buffer_store_dword v41, v55, s[16:19], s54 offen offset:0 sc1
    s_branch PUBD6
SLOW7:
    buffer_store_dwordx4 v[116:119], v120, s[16:19], s54 offen offset:0 sc1
    buffer_store_dword v116, v121, s[16:19], s54 offen offset:0 sc1
    s_branch PUBD7
SLOW8:
    buffer_store_dword v16, v54, s[16:19], s35 offen offset:0 sc1
    s_branch PUBD8
SLOW9:
    buffer_store_dword v40, v55, s[16:19], s33 offen offset:0 sc1
    buffer_store_dwordx2 v[36:37], v56, s[16:19], s33 offen offset:0 sc1
    s_branch PUBD9
CODEEND:
    s_endpgm
.section .rodata,"a"
.p2align 6
.amdhsa_kernel interleave_layers__sliding_block_cached__glu_gated_swiglu__decode_kernel
  .amdhsa_next_free_vgpr 512
  .amdhsa_next_free_sgpr 102
  .amdhsa_accum_offset 256
  .amdhsa_group_segment_fixed_size 0
  .amdhsa_kernarg_size 96
  .amdhsa_user_sgpr_count 2
  .amdhsa_user_sgpr_kernarg_segment_ptr 1
  .amdhsa_system_sgpr_workgroup_id_x 1
.end_amdhsa_kernel
```

```asm
; @launch grid=(256,1,1) block=(256,1,1) lds=143104
.amdgcn_target "amdgcn-amd-amdhsa--gfx950"
.text
.globl interleave_layers__sliding_block_cached__glu_gated_swiglu__decode_kernel
.p2align 8
.type interleave_layers__sliding_block_cached__glu_gated_swiglu__decode_kernel,@function
interleave_layers__sliding_block_cached__glu_gated_swiglu__decode_kernel:
    s_cmp_ge_u32 s2, 256
    s_cbranch_scc1 DONE
    s_load_dwordx16 s[64:79], s[0:1], 0
    s_load_dwordx8 s[80:87], s[0:1], 64
    s_memrealtime s[98:99]
    s_getpc_b64 s[60:61]
PCREF:
    v_lshlrev_b32 v14, 7, v0
    v_cmp_gt_u32 vcc, CODEEND-PCREF, v14
    v_mov_b32 v15, s61
    s_and_saveexec_b64 s[88:89], vcc
    s_cbranch_execz NOPF
    v_add_co_u32 v14, vcc, s60, v14
    s_nop 1
    v_addc_co_u32 v15, vcc, 0, v15, vcc
    global_load_dword v79, v[14:15], off
NOPF:
    s_mov_b64 exec, s[88:89]
    v_and_b32 v1, 63, v0
    v_lshrrev_b32 v13, 6, v0
    s_and_b32 s45, s2, 7
    v_readfirstlane_b32 s44, v13
    s_lshr_b32 s46, s2, 3
    s_lshr_b32 s7, s46, 3
    s_lshl_b32 s52, s45, 2
    s_add_u32 s47, s7, s52
    s_and_b32 s48, s46, 7
    v_lshrrev_b32 v19, 4, v1
    v_bfe_u32 v21, v1, 1, 3
    v_and_b32 v20, 1, v1
    v_mul_u32_u24 v80, 384, v21
    v_lshl_add_u32 v80, v20, 4, v80
    v_lshl_add_u32 v80, v19, 5, v80
    s_mul_i32 s52, s48, 3
    s_lshl_b32 s54, s44, 0
    s_add_u32 s52, s52, s54
    s_add_u32 s53, s48, 384
    s_cmp_eq_u32 s44, 3
    s_cselect_b32 s52, s53, s52
    s_cselect_b32 s97, 8, 24
    s_mulk_i32 s97, 3072
    s_mul_i32 s55, s47, 12582912
    s_mul_i32 s54, s52, 3072
    s_add_u32 s55, s55, s54
    s_add_u32 s55, s55, 11010048
    s_mov_b32 s96, s55
    s_waitcnt lgkmcnt(0)
    s_mov_b32 s8, s66
    s_and_b32 s9, s67, 0xffff
    s_mov_b32 s10, 402653184
    s_mov_b32 s11, 0x20000
    s_mov_b32 s6, 1
    s_mov_b32 s100, 0
    s_cmp_eq_u32 s44, 3
    s_cbranch_scc1 SETUP
    buffer_load_dwordx4 a[0:3], v80, s[8:11], s96 offen offset:0 nt
    buffer_load_dwordx4 a[8:11], v80, s[8:11], s96 offen offset:128 nt
    buffer_load_dwordx4 a[16:19], v80, s[8:11], s96 offen offset:256 nt
    s_add_u32 s96, s96, s97
    buffer_load_dwordx4 a[4:7], v80, s[8:11], s96 offen offset:0 nt
    buffer_load_dwordx4 a[12:15], v80, s[8:11], s96 offen offset:128 nt
    buffer_load_dwordx4 a[20:23], v80, s[8:11], s96 offen offset:256 nt
    s_add_u32 s96, s96, s97
SETUP:
    s_mov_b32 s16, s86
    s_and_b32 s17, s87, 0xffff
    s_mov_b32 s18, 1610612736
    s_mov_b32 s19, 0x20000
    s_mov_b32 s12, s68
    s_and_b32 s13, s69, 0xffff
    s_mov_b32 s14, 402653184
    s_mov_b32 s15, 0x20000
    s_mov_b32 s20, s70
    s_and_b32 s21, s71, 0xffff
    s_mov_b32 s22, 7864320
    s_mov_b32 s23, 0x20000
    s_mov_b32 s32, s64
    s_and_b32 s33, s65, 0xffff
    s_mov_b32 s34, 1280
    s_mov_b32 s35, 0x20000
    s_mov_b32 s36, s82
    s_and_b32 s37, s83, 0xffff
    s_mov_b32 s38, 1280
    s_mov_b32 s39, 0x20000
    s_mov_b32 s40, s84
    s_and_b32 s41, s85, 0xffff
    s_mov_b32 s42, 256
    s_mov_b32 s43, 0x20000
    v_mov_b32 v76, 1879048192
    v_mov_b32 v87, 1879048192
    v_mov_b32 v88, 1879048192
    v_mov_b32 v120, 1879048192
    v_mov_b32 v121, 1879048192
    v_mov_b32 v122, 1879048192
    s_cmp_lg_u32 s44, 3
    s_cbranch_scc1 SETUP2
    v_mov_b32 v32, -1
    v_mov_b32 v33, -1
    v_mov_b32 v34, -1
    v_mov_b32 v35, -1
    s_cmp_lg_u32 s2, 0
    s_cbranch_scc1 NONW
    s_or_b32 s101, s98, 0x20
    s_and_b32 s101, s101, 0xffffffe0
    v_mov_b32 v24, s101
    v_mov_b32 v25, 0
    s_mov_b64 exec, 1
    buffer_store_dword v24, v25, s[40:43], 0 offen sc1
    s_mov_b64 exec, -1
NONW:
    v_lshlrev_b32 v24, 4, v1
    v_lshlrev_b32 v27, 2, v1
    s_mul_i32 s52, s2, 1536
    v_lshlrev_b32 v28, 3, v1
    buffer_store_dwordx4 v[32:35], v24, s[16:19], s52 offen sc1
    buffer_store_dwordx2 v[32:33], v28, s[16:19], s52 offen offset:1024 sc1
    v_mov_b32 v26, 1879048192
    v_mov_b32 v88, v24
    v_cmp_gt_u32 vcc, 40, v1
    v_lshlrev_b32 v27, 2, v1
    buffer_load_dwordx4 v[44:47], v24, s[32:35], 0 offen
    buffer_load_dword v48, v27, s[32:35], 0 offen offset:1024
    v_cndmask_b32 v28, v26, v27, vcc
    s_mul_i32 s52, s48, 160
    buffer_load_dword v86, v28, s[32:35], s52 offen
    s_mul_i32 s52, s48, 320
    s_add_u32 s52, s52, 131072
    s_and_b32 s53, s2, 0xc7
    s_cmp_eq_u32 s53, 0
    s_cselect_b32 s52, s52, 1879048192
    v_lshl_add_u32 v87, v1, 3, s52
    v_cndmask_b32 v87, v26, v87, vcc
    v_add_u32 v24, 0, v1
    v_mul_u32_u24 v36, 171, v24
    v_lshrrev_b32 v36, 12, v36
    v_mul_u32_u24 v37, 24, v36
    v_sub_u32 v37, v24, v37
    v_and_b32 v24, 2, v36
    v_xor_b32 v37, v37, v24
    v_mul_u32_u24 v36, 12288, v36
    v_lshl_add_u32 v38, v37, 4, v36
    v_add_u32 v24, 64, v1
    v_mul_u32_u24 v36, 171, v24
    v_lshrrev_b32 v36, 12, v36
    v_mul_u32_u24 v37, 24, v36
    v_sub_u32 v37, v24, v37
    v_and_b32 v24, 2, v36
    v_xor_b32 v37, v37, v24
    v_mul_u32_u24 v36, 12288, v36
    v_lshl_add_u32 v39, v37, 4, v36
    v_add_u32 v24, 128, v1
    v_mul_u32_u24 v36, 171, v24
    v_lshrrev_b32 v36, 12, v36
    v_mul_u32_u24 v37, 24, v36
    v_sub_u32 v37, v24, v37
    v_and_b32 v24, 2, v36
    v_xor_b32 v37, v37, v24
    v_mul_u32_u24 v36, 12288, v36
    v_lshl_add_u32 v40, v37, 4, v36
    s_mul_i32 s52, s48, 983040
    s_mul_i32 s54, s47, 384
    s_add_u32 s52, s52, s54
    s_mov_b32 s53, 65536
WQL:
    s_add_u32 m0, s53, 0
    s_nop 0
    buffer_load_dwordx4 v38, s[20:23], s52 offen nt lds
    v_xor_b32 v38, 64, v38
    s_add_u32 m0, s53, 1024
    s_nop 0
    buffer_load_dwordx4 v39, s[20:23], s52 offen nt lds
    v_xor_b32 v39, 64, v39
    s_add_u32 m0, s53, 2048
    s_nop 0
    buffer_load_dwordx4 v40, s[20:23], s52 offen nt lds
    v_xor_b32 v40, 64, v40
    s_add_u32 s52, s52, 98304
    s_add_u32 s53, s53, 3072
    s_cmp_lt_u32 s53, 96256
    s_cbranch_scc1 WQL
    v_mov_b32 v37, 0
    buffer_load_dword v89, v37, s[40:43], 0 offen sc1
    s_barrier
    s_waitcnt vmcnt(31)
    v_mov_b32 v36, 0x3f803f80
    v_mov_b32 v37, v36
    v_cndmask_b32 v36, 0, v36, vcc
    v_add_u32 v27, 96256, v27
    ds_write_b32 v27, v36 offset:1152
    ds_write_b32 v27, v37 offset:1408
    ds_write_b32 v27, v86
    v_mov_b64 v[36:37], 0
    ds_write_b32 v27, v36 offset:12800
    ds_write_b32 v27, v36 offset:13056
    v_mov_b32 v38, 0x3f803f80
    v_dot2_f32_bf16 v36, v44, v44, v36
    v_dot2_f32_bf16 v37, v44, v38, v37
    v_dot2_f32_bf16 v36, v45, v45, v36
    v_dot2_f32_bf16 v37, v45, v38, v37
    v_dot2_f32_bf16 v36, v46, v46, v36
    v_dot2_f32_bf16 v37, v46, v38, v37
    v_dot2_f32_bf16 v36, v47, v47, v36
    v_dot2_f32_bf16 v37, v47, v38, v37
    v_dot2_f32_bf16 v36, v48, v48, v36
    v_dot2_f32_bf16 v37, v48, v38, v37
    s_nop 2
    v_add_f32_dpp v36, v36, v36 quad_perm:[1,0,3,2] row_mask:0xf bank_mask:0xf
    v_add_f32_dpp v37, v37, v37 quad_perm:[1,0,3,2] row_mask:0xf bank_mask:0xf
    s_nop 0
    v_add_f32_dpp v36, v36, v36 quad_perm:[2,3,0,1] row_mask:0xf bank_mask:0xf
    v_add_f32_dpp v37, v37, v37 quad_perm:[2,3,0,1] row_mask:0xf bank_mask:0xf
    s_nop 0
    v_add_f32_dpp v36, v36, v36 row_half_mirror row_mask:0xf bank_mask:0xf
    v_add_f32_dpp v37, v37, v37 row_half_mirror row_mask:0xf bank_mask:0xf
    s_nop 0
    v_add_f32_dpp v36, v36, v36 row_mirror row_mask:0xf bank_mask:0xf
    v_add_f32_dpp v37, v37, v37 row_mirror row_mask:0xf bank_mask:0xf
    s_nop 0
    v_mov_b32 v39, v36
    s_nop 1
    v_permlane16_swap_b32 v36, v39
    v_add_f32 v36, v36, v39
    v_mov_b32 v39, v37
    s_nop 1
    v_permlane16_swap_b32 v37, v39
    v_add_f32 v37, v37, v39
    v_mov_b32 v39, v36
    s_nop 1
    v_permlane32_swap_b32 v36, v39
    v_add_f32 v36, v36, v39
    v_mov_b32 v39, v37
    s_nop 1
    v_permlane32_swap_b32 v37, v39
    v_add_f32 v37, v37, v39
    v_mov_b32 v39, 0x3727c5ac
    v_mul_f32 v37, 0x3acccccd, v37
    v_fmamk_f32 v36, v36, 0x3acccccd, v39
    v_fma_f32 v36, -v37, v37, v36
    v_rsq_f32 v36, abs(v36)
    v_mov_b32 v84, v37
    v_mul_f32 v85, 0x3dd53b94, v36
SETUP2:
    s_cmp_ge_u32 s46, 10
    s_cselect_b32 s56, 1, 0
    s_cmp_ge_u32 s46, 20
    s_cselect_b32 s52, 2, s56
    s_mul_i32 s52, s52, 10
    s_sub_u32 s57, s46, s52
    s_min_u32 s4, s46, 29
    s_cmp_ge_u32 s4, 15
    s_cselect_b32 s58, 1, 0
    s_mul_i32 s52, s58, 15
    s_sub_u32 s52, s4, s52
    s_mul_i32 s59, s52, 52
    s_lshr_b32 s59, s59, 8
    s_mul_i32 s53, s59, 5
    s_sub_u32 s3, s52, s53
    s_cmp_ge_u32 s46, 20
    s_cselect_b32 s24, s80, s72
    s_cselect_b32 s25, s81, s73
    s_mov_b32 s26, 7864320
    s_cselect_b32 s26, 1966080, s26
    s_and_b32 s25, s25, 0xffff
    s_mov_b32 s27, 0x20000
    s_cmp_eq_u32 s58, 1
    s_cselect_b32 s28, s78, s76
    s_cselect_b32 s29, s79, s77
    s_and_b32 s29, s29, 0xffff
    s_mov_b32 s30, 1966080
    s_mov_b32 s31, 0x20000
    s_mov_b32 s49, 0
    s_mul_i32 s63, s45, 45312
    s_add_u32 s63, s63, 529408
    s_mul_i32 s62, s45, 28160
    s_add_u32 s62, s62, 136192
    s_mov_b32 s50, 0
    s_mov_b32 s0, 0
    v_and_b32 v24, 15, v1
    v_cmp_eq_u32 vcc, 1, v24
    v_mov_b32 v25, 96256
    v_mov_b32 v26, 97408
    v_cndmask_b32 v2, v25, v26, vcc
    v_lshl_add_u32 v2, v19, 4, v2
    v_and_b32 v24, 3, v1
    v_lshlrev_b32 v24, 4, v24
    v_and_b32 v25, 1, v19
    v_lshl_add_u32 v24, v25, 6, v24
    v_add_u32 v24, 98304, v24
    v_bfe_u32 v25, v1, 2, 2
    v_lshrrev_b32 v27, 5, v1
    v_sub_u32 v25, v25, v27
    v_mov_b32 v26, 109184
    v_cmp_eq_u32 vcc, 0, v25
    s_nop 1
    v_cndmask_b32 v3, v26, v24, vcc
    v_cmp_eq_u32 vcc, 2, v25
    s_nop 1
    v_cndmask_b32 v4, v26, v24, vcc
    v_and_b32 v24, 3, v1
    v_cmp_eq_u32 vcc, 3, v24
    v_mov_b32 v25, 0xffff
    v_mov_b32 v26, 0xffff0000
    v_cndmask_b32 v25, v25, v26, vcc
    v_cndmask_b32 v24, v24, 0, vcc
    v_or_b32 v24, 12, v24
    v_mul_u32_u24 v24, 0x1111, v24
    v_bfe_u32 v26, v1, 1, 1
    v_mul_u32_u24 v26, 0xaaaa, v26
    v_add_u32 v26, 0x4444, v26
    v_lshl_add_u32 v7, v24, 16, v26
    v_and_b32 v24, 4, v1
    v_cmp_eq_u32 vcc, 0, v24
    s_nop 1
    v_cndmask_b32 v5, 0, v25, vcc
    v_cndmask_b32 v6, v25, 0, vcc
    v_mul_u32_u24 v82, s97, v27
    v_bfe_u32 v24, v1, 3, 1
    v_mul_u32_u24 v24, 1536, v24
    v_add_u32 v82, v82, v24
    v_and_b32 v24, 1, v19
    v_mul_u32_u24 v24, 768, v24
    v_add_u32 v82, v82, v24
    v_and_b32 v24, 7, v1
    v_lshl_add_u32 v82, v24, 4, v82
    s_mul_i32 s52, s7, 6144
    s_add_u32 s52, s52, 20480
    v_lshl_add_u32 v8, v0, 4, s52
    s_lshl_b32 s52, s7, 6
    s_add_u32 s52, s52, 45056
    v_lshl_add_u32 v9, v24, 3, s52
    v_and_b32 v10, 0xe1, v0
    v_lshlrev_b32 v10, 1, v10
    v_bfe_u32 v24, v0, 4, 1
    v_lshl_add_u32 v10, v24, 3, v10
    v_bfe_u32 v24, v0, 3, 1
    v_lshl_add_u32 v10, v24, 4, v10
    v_bfe_u32 v24, v0, 2, 1
    v_lshl_add_u32 v10, v24, 2, v10
    v_bfe_u32 v24, v0, 1, 1
    v_lshl_add_u32 v10, v24, 5, v10
    v_add_u32 v10, 98304, v10
    v_mov_b32 v11, 0x3727c5ac
    v_lshlrev_b32 v12, 4, v0
    v_add_u32 v12, 110336, v12
    s_cmp_lg_u32 s44, 3
    s_cbranch_scc1 KBAR
    s_lshr_b32 s53, s2, 4
    s_and_b32 s51, s2, 15
    s_lshl_b32 s52, s53, 14
    s_lshl_b32 s54, s51, 9
    s_add_u32 s52, s52, s54
    s_add_u32 s52, s52, 1835008
    s_and_b32 s53, s46, 1
    s_lshl_b32 s53, s53, 13
    s_add_u32 s52, s52, s53
    s_xor_b32 s53, s52, 8192
    s_memtime s[88:89]
    s_waitcnt lgkmcnt(0)
    s_buffer_load_dword s1, s[16:19], s52
    s_waitcnt lgkmcnt(0)
    s_memtime s[90:91]
    s_waitcnt lgkmcnt(0)
    s_buffer_load_dword s1, s[16:19], s53
    s_waitcnt lgkmcnt(0)
    s_memtime s[92:93]
    s_waitcnt lgkmcnt(0)
    s_sub_u32 s88, s90, s88
    s_sub_u32 s90, s92, s90
    s_cmp_lt_u32 s90, s88
    s_cselect_b32 s1, 1, 0
    s_xor_b32 s1, s1, s46
    s_getreg_b32 s52, hwreg(HW_REG_XCC_ID)
    s_lshr_b32 s52, s52, 2
    s_xor_b32 s1, s1, s52
    s_and_b32 s1, s1, 1
    s_lshl_b32 s1, s1, 4
    s_mov_b32 s51, 0
    v_mov_b32 v37, 0
NOP:
    s_waitcnt vmcnt(0)
    v_readfirstlane_b32 s5, v89
    s_cmp_lg_u32 s5, 0
    s_cbranch_scc1 NOOK
    buffer_load_dword v89, v37, s[40:43], 0 offen sc1
    s_add_u32 s51, s51, 1
    s_sleep 4
    s_cmp_lt_u32 s51, 0x40000
    s_cbranch_scc1 NOP
NOOK:
    s_getreg_b32 s52, hwreg(HW_REG_XCC_ID)
    s_and_b32 s52, s52, 15
    s_or_b32 s5, s5, s52
    s_or_b32 s1, s1, s5
    v_mov_b32 v36, s1
    s_lshl_b32 s52, s45, 7
    s_lshl_b32 s54, s46, 2
    s_add_u32 s52, s52, s54
    s_add_u32 s52, s52, 1376256
    s_mov_b64 exec, 1
    buffer_store_dword v36, v37, s[16:19], s52 offen sc1
    s_mov_b64 exec, -1
    s_mov_b32 s44, 0
    s_branch Q0L
KBAR:
    s_barrier
    s_waitcnt vmcnt(7)
    buffer_load_dwordx4 a[24:27], v80, s[8:11], s96 offen offset:0 nt
    s_waitcnt vmcnt(7)
    buffer_load_dwordx4 a[32:35], v80, s[8:11], s96 offen offset:128 nt
    s_waitcnt vmcnt(7)
    buffer_load_dwordx4 a[40:43], v80, s[8:11], s96 offen offset:256 nt
    s_add_u32 s96, s96, s97
    s_waitcnt vmcnt(7)
    buffer_load_dwordx4 a[28:31], v80, s[8:11], s96 offen offset:0 nt
    s_waitcnt vmcnt(7)
    buffer_load_dwordx4 a[36:39], v80, s[8:11], s96 offen offset:128 nt
    s_waitcnt vmcnt(7)
    buffer_load_dwordx4 a[44:47], v80, s[8:11], s96 offen offset:256 nt
    s_add_u32 s96, s96, s97
    s_waitcnt vmcnt(7)
    buffer_load_dwordx4 a[48:51], v80, s[8:11], s96 offen offset:0 nt
    s_waitcnt vmcnt(7)
    buffer_load_dwordx4 a[56:59], v80, s[8:11], s96 offen offset:128 nt
    s_waitcnt vmcnt(7)
    buffer_load_dwordx4 a[64:67], v80, s[8:11], s96 offen offset:256 nt
    s_add_u32 s96, s96, s97
    s_waitcnt vmcnt(7)
    buffer_load_dwordx4 a[52:55], v80, s[8:11], s96 offen offset:0 nt
    s_waitcnt vmcnt(7)
    buffer_load_dwordx4 a[60:63], v80, s[8:11], s96 offen offset:128 nt
    s_waitcnt vmcnt(7)
    buffer_load_dwordx4 a[68:71], v80, s[8:11], s96 offen offset:256 nt
    s_add_u32 s96, s96, s97
    s_waitcnt vmcnt(7)
    buffer_load_dwordx4 a[72:75], v80, s[8:11], s96 offen offset:0 nt
    s_waitcnt vmcnt(7)
    buffer_load_dwordx4 a[80:83], v80, s[8:11], s96 offen offset:128 nt
    s_waitcnt vmcnt(7)
    buffer_load_dwordx4 a[88:91], v80, s[8:11], s96 offen offset:256 nt
    s_add_u32 s96, s96, s97
    s_waitcnt vmcnt(7)
    buffer_load_dwordx4 a[76:79], v80, s[8:11], s96 offen offset:0 nt
    s_waitcnt vmcnt(7)
    buffer_load_dwordx4 a[84:87], v80, s[8:11], s96 offen offset:128 nt
    s_waitcnt vmcnt(7)
    buffer_load_dwordx4 a[92:95], v80, s[8:11], s96 offen offset:256 nt
    s_add_u32 s96, s96, s97
    s_waitcnt vmcnt(7)
    buffer_load_dwordx4 a[96:99], v80, s[8:11], s96 offen offset:0 nt
    s_waitcnt vmcnt(7)
    buffer_load_dwordx4 a[104:107], v80, s[8:11], s96 offen offset:128 nt
    s_waitcnt vmcnt(7)
    buffer_load_dwordx4 a[112:115], v80, s[8:11], s96 offen offset:256 nt
    s_add_u32 s96, s96, s97
    s_waitcnt vmcnt(7)
    buffer_load_dwordx4 a[100:103], v80, s[8:11], s96 offen offset:0 nt
    s_waitcnt vmcnt(7)
    buffer_load_dwordx4 a[108:111], v80, s[8:11], s96 offen offset:128 nt
    s_waitcnt vmcnt(7)
    buffer_load_dwordx4 a[116:119], v80, s[8:11], s96 offen offset:256 nt
    s_add_u32 s96, s96, s97
    s_waitcnt vmcnt(7)
    buffer_load_dwordx4 a[120:123], v80, s[8:11], s96 offen offset:0 nt
    s_waitcnt vmcnt(7)
    buffer_load_dwordx4 a[128:131], v80, s[8:11], s96 offen offset:128 nt
    s_waitcnt vmcnt(7)
    buffer_load_dwordx4 a[136:139], v80, s[8:11], s96 offen offset:256 nt
    s_add_u32 s96, s96, s97
    s_waitcnt vmcnt(7)
    buffer_load_dwordx4 a[124:127], v80, s[8:11], s96 offen offset:0 nt
    s_waitcnt vmcnt(7)
    buffer_load_dwordx4 a[132:135], v80, s[8:11], s96 offen offset:128 nt
    s_waitcnt vmcnt(7)
    buffer_load_dwordx4 a[140:143], v80, s[8:11], s96 offen offset:256 nt
    s_add_u32 s96, s96, s97
    s_waitcnt vmcnt(7)
    buffer_load_dwordx4 a[144:147], v80, s[8:11], s96 offen offset:0 nt
    s_waitcnt vmcnt(7)
    buffer_load_dwordx4 a[152:155], v80, s[8:11], s96 offen offset:128 nt
    s_waitcnt vmcnt(7)
    buffer_load_dwordx4 a[160:163], v80, s[8:11], s96 offen offset:256 nt
    s_add_u32 s96, s96, s97
    s_waitcnt vmcnt(7)
    buffer_load_dwordx4 a[148:151], v80, s[8:11], s96 offen offset:0 nt
    s_waitcnt vmcnt(7)
    buffer_load_dwordx4 a[156:159], v80, s[8:11], s96 offen offset:128 nt
    s_waitcnt vmcnt(7)
    buffer_load_dwordx4 a[164:167], v80, s[8:11], s96 offen offset:256 nt
    s_add_u32 s96, s96, s97
    s_waitcnt vmcnt(7)
    buffer_load_dwordx4 a[168:171], v80, s[8:11], s96 offen offset:0 nt
    s_waitcnt vmcnt(7)
    buffer_load_dwordx4 a[176:179], v80, s[8:11], s96 offen offset:128 nt
    s_waitcnt vmcnt(7)
    buffer_load_dwordx4 a[184:187], v80, s[8:11], s96 offen offset:256 nt
    s_add_u32 s96, s96, s97
    s_waitcnt vmcnt(7)
    buffer_load_dwordx4 a[172:175], v80, s[8:11], s96 offen offset:0 nt
    s_waitcnt vmcnt(7)
    buffer_load_dwordx4 a[180:183], v80, s[8:11], s96 offen offset:128 nt
    s_waitcnt vmcnt(7)
    buffer_load_dwordx4 a[188:191], v80, s[8:11], s96 offen offset:256 nt
    s_lshl_b32 s97, s97, 1
    s_waitcnt vmcnt(7)
    buffer_load_dwordx4 a[192:195], v82, s[12:15], s55 offen offset:0 nt
    s_waitcnt vmcnt(7)
    buffer_load_dwordx4 a[200:203], v82, s[12:15], s55 offen offset:128 nt
    s_waitcnt vmcnt(7)
    buffer_load_dwordx4 a[208:211], v82, s[12:15], s55 offen offset:256 nt
    s_waitcnt vmcnt(7)
    buffer_load_dwordx4 a[216:219], v82, s[12:15], s55 offen offset:384 nt
    s_waitcnt vmcnt(7)
    buffer_load_dwordx4 a[224:227], v82, s[12:15], s55 offen offset:512 nt
    s_waitcnt vmcnt(7)
    buffer_load_dwordx4 a[232:235], v82, s[12:15], s55 offen offset:640 nt
    s_add_u32 s55, s55, s97
    s_waitcnt vmcnt(7)
    buffer_load_dwordx4 a[196:199], v82, s[12:15], s55 offen offset:0 nt
    s_waitcnt vmcnt(7)
    buffer_load_dwordx4 a[204:207], v82, s[12:15], s55 offen offset:128 nt
    s_waitcnt vmcnt(7)
    buffer_load_dwordx4 a[212:215], v82, s[12:15], s55 offen offset:256 nt
    s_waitcnt vmcnt(7)
    buffer_load_dwordx4 a[220:223], v82, s[12:15], s55 offen offset:384 nt
    s_waitcnt vmcnt(7)
    buffer_load_dwordx4 a[228:231], v82, s[12:15], s55 offen offset:512 nt
    s_waitcnt vmcnt(7)
    buffer_load_dwordx4 a[236:239], v82, s[12:15], s55 offen offset:640 nt
    s_add_u32 s55, s55, s97
    s_waitcnt vmcnt(7)
    buffer_load_dwordx4 a[240:243], v82, s[12:15], s55 offen offset:0 nt
    s_waitcnt vmcnt(7)
    buffer_load_dwordx4 a[248:251], v82, s[12:15], s55 offen offset:128 nt
    s_waitcnt vmcnt(7)
    buffer_load_dwordx4 v[128:131], v82, s[12:15], s55 offen offset:256 nt
    s_waitcnt vmcnt(7)
    buffer_load_dwordx4 v[136:139], v82, s[12:15], s55 offen offset:384 nt
    s_waitcnt vmcnt(7)
    buffer_load_dwordx4 v[144:147], v82, s[12:15], s55 offen offset:512 nt
    s_waitcnt vmcnt(7)
    buffer_load_dwordx4 v[152:155], v82, s[12:15], s55 offen offset:640 nt
    s_add_u32 s55, s55, s97
    s_waitcnt vmcnt(7)
    buffer_load_dwordx4 a[244:247], v82, s[12:15], s55 offen offset:0 nt
    s_waitcnt vmcnt(7)
    buffer_load_dwordx4 a[252:255], v82, s[12:15], s55 offen offset:128 nt
    s_waitcnt vmcnt(7)
    buffer_load_dwordx4 v[132:135], v82, s[12:15], s55 offen offset:256 nt
    s_waitcnt vmcnt(7)
    buffer_load_dwordx4 v[140:143], v82, s[12:15], s55 offen offset:384 nt
    s_waitcnt vmcnt(7)
    buffer_load_dwordx4 v[148:151], v82, s[12:15], s55 offen offset:512 nt
    s_waitcnt vmcnt(7)
    buffer_load_dwordx4 v[156:159], v82, s[12:15], s55 offen offset:640 nt
    s_add_u32 s55, s55, s97
    s_waitcnt vmcnt(7)
    buffer_load_dwordx4 v[160:163], v82, s[12:15], s55 offen offset:0 nt
    s_waitcnt vmcnt(7)
    buffer_load_dwordx4 v[168:171], v82, s[12:15], s55 offen offset:128 nt
    s_waitcnt vmcnt(7)
    buffer_load_dwordx4 v[176:179], v82, s[12:15], s55 offen offset:256 nt
    s_waitcnt vmcnt(7)
    buffer_load_dwordx4 v[184:187], v82, s[12:15], s55 offen offset:384 nt
    s_waitcnt vmcnt(7)
    buffer_load_dwordx4 v[192:195], v82, s[12:15], s55 offen offset:512 nt
    s_waitcnt vmcnt(7)
    buffer_load_dwordx4 v[200:203], v82, s[12:15], s55 offen offset:640 nt
    s_add_u32 s55, s55, s97
    s_waitcnt vmcnt(7)
    buffer_load_dwordx4 v[164:167], v82, s[12:15], s55 offen offset:0 nt
    s_waitcnt vmcnt(7)
    buffer_load_dwordx4 v[172:175], v82, s[12:15], s55 offen offset:128 nt
    s_waitcnt vmcnt(7)
    buffer_load_dwordx4 v[180:183], v82, s[12:15], s55 offen offset:256 nt
    s_waitcnt vmcnt(7)
    buffer_load_dwordx4 v[188:191], v82, s[12:15], s55 offen offset:384 nt
    s_waitcnt vmcnt(7)
    buffer_load_dwordx4 v[196:199], v82, s[12:15], s55 offen offset:512 nt
    s_waitcnt vmcnt(7)
    buffer_load_dwordx4 v[204:207], v82, s[12:15], s55 offen offset:640 nt
    s_add_u32 s55, s55, s97
    s_waitcnt vmcnt(7)
    buffer_load_dwordx4 v[208:211], v82, s[12:15], s55 offen offset:0 nt
    s_waitcnt vmcnt(7)
    buffer_load_dwordx4 v[216:219], v82, s[12:15], s55 offen offset:128 nt
    s_waitcnt vmcnt(7)
    buffer_load_dwordx4 v[224:227], v82, s[12:15], s55 offen offset:256 nt
    s_waitcnt vmcnt(7)
    buffer_load_dwordx4 v[232:235], v82, s[12:15], s55 offen offset:384 nt
    s_waitcnt vmcnt(7)
    buffer_load_dwordx4 v[240:243], v82, s[12:15], s55 offen offset:512 nt
    s_waitcnt vmcnt(7)
    buffer_load_dwordx4 v[248:251], v82, s[12:15], s55 offen offset:640 nt
    s_add_u32 s55, s55, s97
    s_waitcnt vmcnt(7)
    buffer_load_dwordx4 v[212:215], v82, s[12:15], s55 offen offset:0 nt
    s_waitcnt vmcnt(7)
    buffer_load_dwordx4 v[220:223], v82, s[12:15], s55 offen offset:128 nt
    s_waitcnt vmcnt(7)
    buffer_load_dwordx4 v[228:231], v82, s[12:15], s55 offen offset:256 nt
    s_barrier
    s_waitcnt vmcnt(7)
    buffer_load_dwordx4 v[236:239], v82, s[12:15], s55 offen offset:384 nt
    s_waitcnt vmcnt(7)
    buffer_load_dwordx4 v[244:247], v82, s[12:15], s55 offen offset:512 nt
    s_waitcnt vmcnt(7)
    buffer_load_dwordx4 v[252:255], v82, s[12:15], s55 offen offset:640 nt
    s_branch TABLES
LOOP:
    ds_read_b128 v[14:17], v12 offset:24576
    ds_read_b128 v[18:21], v12 offset:28672
    s_mov_b32 s55, s99
    s_mov_b32 s51, 0
    s_cmp_lg_u32 s49, 0
    s_cbranch_scc1 FINAL
    s_waitcnt lgkmcnt(0)
QTR:
    ds_read_b64_tr_b16 v[44:45], v19 offset:0
    ds_read_b64_tr_b16 v[46:47], v19 offset:1536
    ds_read_b64_tr_b16 v[56:57], v19 offset:128
    ds_read_b64_tr_b16 v[58:59], v19 offset:1664
    ds_read_b64_tr_b16 v[68:69], v19 offset:256
    ds_read_b64_tr_b16 v[70:71], v19 offset:1792
    ds_read_b64_tr_b16 v[48:49], v19 offset:12288
    ds_read_b64_tr_b16 v[50:51], v19 offset:13824
    ds_read_b64_tr_b16 v[60:61], v19 offset:12416
    ds_read_b64_tr_b16 v[62:63], v19 offset:13952
    ds_read_b64_tr_b16 v[72:73], v19 offset:12544
    ds_read_b64_tr_b16 v[74:75], v19 offset:14080
    ds_read_b64_tr_b16 v[52:53], v20 offset:24576
    ds_read_b64_tr_b16 v[54:55], v20 offset:26112
    ds_read_b64_tr_b16 v[64:65], v20 offset:24704
    ds_read_b64_tr_b16 v[66:67], v20 offset:26240
    ds_read_b64_tr_b16 v[76:77], v20 offset:24832
    ds_read_b64_tr_b16 v[78:79], v20 offset:26368
    s_cmp_lg_u32 s6, 0
    s_cbranch_scc1 QA0
    s_mov_b32 s96, s62
    s_mov_b32 s49, 393216
    s_mov_b32 s62, s63
    s_cmp_lg_u32 s50, 0
    s_cselect_b32 s32, s62, 1610612736
    s_cselect_b32 s33, 1610612736, s62
    s_cmp_lg_u32 s50, 0
    s_cselect_b32 s34, s49, 1610612736
    s_cselect_b32 s35, 1610612736, s49
    s_add_u32 s99, s49, s0
    s_xor_b32 s1, s99, 8192
    s_cmp_eq_u32 s44, 3
    s_cbranch_scc1 QX
    s_sub_u32 s52, s46, 20
    s_cmp_ge_u32 s52, 10
    s_cbranch_scc1 HOOKL
    v_lshlrev_b32 v30, 3, v0
    s_mul_i32 s52, s47, 12288
    s_add_u32 s52, s52, 1441792
    s_add_u32 s53, s52, 0
    buffer_load_dwordx2 v[32:33], v30, s[16:19], s53 offen offset:0 sc1
    buffer_load_dwordx2 v[34:35], v30, s[16:19], s53 offen offset:1536 sc1
    s_add_u32 s53, s52, 3072
    buffer_load_dwordx2 v[36:37], v30, s[16:19], s53 offen offset:0 sc1
    buffer_load_dwordx2 v[38:39], v30, s[16:19], s53 offen offset:1536 sc1
    s_add_u32 s53, s52, 6144
    buffer_load_dwordx2 v[40:41], v30, s[16:19], s53 offen offset:0 sc1
    buffer_load_dwordx2 v[42:43], v30, s[16:19], s53 offen offset:1536 sc1
    s_add_u32 s53, s52, 9216
    buffer_load_dwordx2 v[26:27], v30, s[16:19], s53 offen offset:0 sc1
    buffer_load_dwordx2 v[28:29], v30, s[16:19], s53 offen offset:1536 sc1
    s_sleep 5
GYB:
    buffer_load_dword v22, v16, s[16:19], s55 offen offset:0 sc1
    buffer_load_dword v23, v16, s[16:19], s55 offen offset:128 sc1
    buffer_load_dword v24, v16, s[16:19], s55 offen offset:256 sc1
    buffer_load_dword v25, v16, s[16:19], s55 offen offset:384 sc1
    s_waitcnt vmcnt(4)
QCP:
    v_bitop3_b32 v33, v32, v33, s101 bitop3:0x96
    v_bitop3_b32 v35, v34, v35, s101 bitop3:0x96
    v_bitop3_b32 v37, v36, v37, s101 bitop3:0x96
    v_bitop3_b32 v39, v38, v39, s101 bitop3:0x96
    v_bitop3_b32 v41, v40, v41, s101 bitop3:0x96
    v_bitop3_b32 v43, v42, v43, s101 bitop3:0x96
    v_bitop3_b32 v27, v26, v27, s101 bitop3:0x96
    v_bitop3_b32 v29, v28, v29, s101 bitop3:0x96
    v_add_f32 v13, v32, v34
    v_add_f32 v13, v13, v36
    v_add_f32 v13, v13, v38
    v_add_f32 v13, v13, v40
    v_add_f32 v13, v13, v42
    v_add_f32 v13, v13, v26
    v_add_f32 v13, v13, v28
    v_or3_b32 v33, v33, v35, v37
    v_or3_b32 v33, v33, v39, v41
    v_or3_b32 v33, v33, v43, v27
    v_or_b32 v33, v33, v29
    v_cmp_ne_u32 vcc, 0, v33
    s_cbranch_vccnz QCA
Y2W:
    s_waitcnt vmcnt(0)
    v_pk_add_f32 v[22:23], v[22:23], v[24:25]
    v_add_f32 v30, v22, v23
    v_mov_b32 v31, v30
    s_nop 1
    v_permlane32_swap_b32 v30, v31
    v_add_f32 v30, v30, v31
    v_cmp_u_f32 vcc, v30, v30
    v_cvt_pk_bf16_f32 v30, v30, v30
    ds_write_b16 v17, v30
    s_cbranch_vccnz AGY2P
OKY2P:
    v_and_b32 v30, 0xffff0000, v30
    buffer_store_dword v30, v18, s[16:19], s34 offen offset:0
    s_cmp_eq_u32 s50, 0
    s_cbranch_scc1 SLOW1
PUBD1:
QX:
    s_waitcnt lgkmcnt(0)
    s_barrier
QA0:
    ds_read_b128 v[32:35], v2 offset:0
    ds_read_b128 v[36:39], v2 offset:64
    ds_read_b128 v[40:43], v2 offset:128
    s_cmp_lg_u32 s6, 0
    s_waitcnt lgkmcnt(2)
    v_mfma_f32_16x16x32_bf16 v[28:31], v[32:35], v[32:35], 0
    v_mfma_f32_16x16x32_bf16 v[16:19], v[32:35], v[44:47], 0
    v_mfma_f32_16x16x32_bf16 v[20:23], v[32:35], v[56:59], 0
    v_mfma_f32_16x16x32_bf16 v[24:27], v[32:35], v[68:71], 0
    s_waitcnt lgkmcnt(1)
    v_mfma_f32_16x16x32_bf16 v[28:31], v[36:39], v[36:39], v[28:31]
    v_mfma_f32_16x16x32_bf16 v[16:19], v[36:39], v[48:51], v[16:19]
    v_mfma_f32_16x16x32_bf16 v[20:23], v[36:39], v[60:63], v[20:23]
    v_mfma_f32_16x16x32_bf16 v[24:27], v[36:39], v[72:75], v[24:27]
    s_waitcnt lgkmcnt(0)
    v_mfma_f32_16x16x32_bf16 v[16:19], v[40:43], v[52:55], v[16:19]
    v_mfma_f32_16x16x32_bf16 v[20:23], v[40:43], v[64:67], v[20:23]
    v_mfma_f32_16x16x32_bf16 v[24:27], v[40:43], v[76:79], v[24:27]
    v_mfma_f32_16x16x32_bf16 v[28:31], v[40:43], v[40:43], v[28:31]
    s_cbranch_scc1 HOOKA
    v_mov_b64 v[64:65], 0
    v_mov_b64 v[66:67], 0
    v_mov_b64 v[68:69], 0
    v_mov_b64 v[70:71], 0
    buffer_store_dword v16, v14, s[16:19], s32 offen offset:0
    buffer_store_dword v20, v14, s[16:19], s32 offen offset:1024
    buffer_store_dword v24, v14, s[16:19], s32 offen offset:2048
    buffer_store_dwordx2 v[28:29], v15, s[16:19], s32 offen offset:0
    s_cmp_eq_u32 s50, 0
    s_cbranch_scc1 SLOW2
PUBD2:
    ds_read_b64 v[14:15], v12 offset:0
    ds_read_b64 v[60:61], v12 offset:8
    s_cmp_eq_u32 s44, 3
    s_cbranch_scc1 EN3
    v_mov_b32 v36, v36
    v_mov_b32 v36, v36
    v_mov_b32 v36, v36
    v_mov_b32 v36, v36
    v_mov_b32 v36, v36
    v_mov_b32 v36, v36
    v_mov_b32 v36, v36
    v_mov_b32 v36, v36
    v_mov_b32 v36, v36
    v_mov_b32 v36, v36
    v_mov_b32 v36, v36
    v_mov_b32 v36, v36
    v_mov_b32 v36, v36
    v_mov_b32 v36, v36
    v_mov_b32 v36, v36
    v_mov_b32 v36, v36
    v_mov_b32 v36, v36
    v_mov_b32 v36, v36
    v_mov_b32 v36, v36
    v_mov_b32 v36, v36
    v_mov_b32 v36, v36
    v_mov_b32 v36, v36
    v_mov_b32 v36, v36
    v_mov_b32 v36, v36
    v_mov_b32 v36, v36
    v_mov_b32 v36, v36
    v_mov_b32 v36, v36
    v_mov_b32 v36, v36
    v_mov_b32 v36, v36
    v_mov_b32 v36, v36
    v_mov_b32 v36, v36
    v_mov_b32 v36, v36
    buffer_load_dwordx2 v[62:63], v9, s[16:19], s62 offen sc1
    buffer_load_dwordx4 v[52:55], v8, s[16:19], s62 offen offset:0 sc1
    buffer_load_dwordx4 v[56:59], v8, s[16:19], s62 offen offset:3072 sc1
    v_mov_b64 v[72:73], 0
    v_mov_b64 v[74:75], 0
    v_mov_b64 v[76:77], 0
    v_mov_b64 v[78:79], 0
    v_mov_b64 v[40:41], 0
    v_mov_b64 v[42:43], 0
    v_mov_b64 v[44:45], 0
    v_mov_b64 v[46:47], 0
    v_mov_b64 v[48:49], 0
    v_mov_b64 v[50:51], 0
    s_mov_b32 s51, 0
    v_mov_b32 v36, v36
    v_mov_b32 v36, v36
    v_mov_b32 v36, v36
    v_mov_b32 v36, v36
    v_mov_b32 v36, v36
    v_mov_b32 v36, v36
    v_mov_b32 v36, v36
    v_mov_b32 v36, v36
    v_mov_b32 v36, v36
    v_mov_b32 v36, v36
ENP:
    buffer_load_dwordx2 v[62:63], v9, s[16:19], s62 offen sc1
    buffer_load_dwordx4 v[52:55], v8, s[16:19], s62 offen offset:0 sc1
    buffer_load_dwordx4 v[56:59], v8, s[16:19], s62 offen offset:3072 sc1
    s_waitcnt vmcnt(3)
    v_add_f32_dpp v32, v62, v62 quad_perm:[1,0,3,2] row_mask:0xf bank_mask:0xf
    v_add_f32_dpp v33, v63, v63 quad_perm:[1,0,3,2] row_mask:0xf bank_mask:0xf
    v_pk_add_f32 v[16:17], v[52:53], v[54:55]
    v_add_f32_dpp v32, v32, v32 quad_perm:[2,3,0,1] row_mask:0xf bank_mask:0xf
    v_add_f32_dpp v33, v33, v33 quad_perm:[2,3,0,1] row_mask:0xf bank_mask:0xf
    v_pk_add_f32 v[20:21], v[56:57], v[58:59]
    v_add_f32_dpp v32, v32, v32 row_half_mirror row_mask:0xf bank_mask:0xf
    v_add_f32_dpp v33, v33, v33 row_half_mirror row_mask:0xf bank_mask:0xf
    v_pk_add_f32 v[16:17], v[16:17], v[20:21]
    v_mul_f32 v33, 0x3acccccd, v33
    v_fmamk_f32 v32, v32, 0x3acccccd, v11
    v_fma_f32 v32, -v33, v33, v32
    v_rsq_f32 v32, abs(v32)
    v_add_f32 v16, v16, v17
    v_mul_f32 v32, 0x3dd53b94, v32
    v_fma_f32 v16, -v33, v13, v16
    v_mul_f32 v16, v16, v32
    v_cvt_pk_bf16_f32 v17, v16, v16
    ds_write_b16 v10, v17
    v_cmp_u_f32 vcc, v16, v16
    s_cbranch_vccnz AGENP
OKENP:
ENOK2:
    s_waitcnt lgkmcnt(0)
    s_barrier
QFRAG:
    ds_read_b128 v[16:19], v3 offset:0
    ds_read_b128 v[20:23], v3 offset:128
    ds_read_b128 v[24:27], v3 offset:256
    ds_read_b128 v[28:31], v4 offset:0
    ds_read_b128 v[32:35], v4 offset:128
    ds_read_b128 v[36:39], v4 offset:256
    s_cmp_eq_u32 s49, 0
    s_cbranch_scc1 HOOKF
    s_waitcnt vmcnt(0)
QK:
    s_waitcnt lgkmcnt(5)
    v_smfmac_f32_16x16x64_bf16 v[64:67], v[16:19], a[0:7], v7
    s_waitcnt lgkmcnt(4)
    v_smfmac_f32_16x16x64_bf16 v[64:67], v[20:23], a[8:15], v7
    s_waitcnt lgkmcnt(3)
    v_smfmac_f32_16x16x64_bf16 v[64:67], v[24:27], a[16:23], v7
    s_waitcnt lgkmcnt(2)
    v_smfmac_f32_16x16x64_bf16 v[64:67], v[28:31], a[24:31], v7
    s_waitcnt lgkmcnt(1)
    v_smfmac_f32_16x16x64_bf16 v[64:67], v[32:35], a[32:39], v7
    s_waitcnt lgkmcnt(0)
    v_smfmac_f32_16x16x64_bf16 v[64:67], v[36:39], a[40:47], v7
    v_smfmac_f32_16x16x64_bf16 v[68:71], v[16:19], a[48:55], v7
    v_smfmac_f32_16x16x64_bf16 v[68:71], v[20:23], a[56:63], v7
    v_smfmac_f32_16x16x64_bf16 v[68:71], v[24:27], a[64:71], v7
    v_smfmac_f32_16x16x64_bf16 v[68:71], v[28:31], a[72:79], v7
    v_smfmac_f32_16x16x64_bf16 v[68:71], v[32:35], a[80:87], v7
    v_smfmac_f32_16x16x64_bf16 v[68:71], v[36:39], a[88:95], v7
    v_smfmac_f32_16x16x64_bf16 v[72:75], v[16:19], a[96:103], v7
    v_smfmac_f32_16x16x64_bf16 v[72:75], v[20:23], a[104:111], v7
    v_smfmac_f32_16x16x64_bf16 v[72:75], v[24:27], a[112:119], v7
    v_pk_add_f32 v[64:65], v[64:65], v[66:67]
    v_smfmac_f32_16x16x64_bf16 v[72:75], v[28:31], a[120:127], v7
    v_smfmac_f32_16x16x64_bf16 v[72:75], v[32:35], a[128:135], v7
    v_add_f32_dpp v52, v65, v64 quad_perm:[1,1,3,3] row_mask:0xf bank_mask:0xf
    v_smfmac_f32_16x16x64_bf16 v[72:75], v[36:39], a[136:143], v7
    v_smfmac_f32_16x16x64_bf16 v[76:79], v[16:19], a[144:151], v7
    v_smfmac_f32_16x16x64_bf16 v[76:79], v[20:23], a[152:159], v7
    v_smfmac_f32_16x16x64_bf16 v[76:79], v[24:27], a[160:167], v7
    v_pk_add_f32 v[68:69], v[68:69], v[70:71]
    v_smfmac_f32_16x16x64_bf16 v[76:79], v[28:31], a[168:175], v7
    v_smfmac_f32_16x16x64_bf16 v[76:79], v[32:35], a[176:183], v7
    v_add_f32_dpp v53, v69, v68 quad_perm:[1,1,3,3] row_mask:0xf bank_mask:0xf
    v_smfmac_f32_16x16x64_bf16 v[76:79], v[36:39], a[184:191], v7
    v_pk_add_f32 v[72:73], v[72:73], v[74:75]
    v_max_f32 v62, v52, v53
    s_nop 0
    v_add_f32_dpp v54, v73, v72 quad_perm:[1,1,3,3] row_mask:0xf bank_mask:0xf
    v_mov_b32 v63, v63
    v_mov_b32 v63, v63
    v_mov_b32 v63, v63
    v_mov_b32 v63, v63
    v_pk_add_f32 v[76:77], v[76:77], v[78:79]
    s_nop 1
    v_add_f32_dpp v55, v77, v76 quad_perm:[1,1,3,3] row_mask:0xf bank_mask:0xf
    v_max3_f32 v62, v62, v54, v55
    s_nop 1
    v_max_f32_dpp v62, v62, v62 quad_perm:[2,3,0,1] row_mask:0xf bank_mask:0xf
    s_nop 1
    v_max_f32_dpp v62, v62, v62 row_ror:4 row_mask:0xf bank_mask:0xf
    s_nop 1
    v_max_f32_dpp v62, v62, v62 row_ror:8 row_mask:0xf bank_mask:0xf
    v_mov_b32 v63, v62
    s_nop 1
    v_permlane16_swap_b32 v62, v63
    v_max_f32 v62, v62, v63
    v_mov_b32 v63, v62
    s_nop 1
    v_permlane32_swap_b32 v62, v63
    v_max_f32 v62, v62, v63
    v_pk_add_f32 v[52:53], v[52:53], v[62:63] op_sel_hi:[1,0] neg_lo:[0,1] neg_hi:[0,1]
    v_exp_f32 v52, v52
    v_pk_add_f32 v[54:55], v[54:55], v[62:63] op_sel_hi:[1,0] neg_lo:[0,1] neg_hi:[0,1]
    v_cvt_pk_bf16_f32 v56, v52, v52
    v_exp_f32 v53, v53
    v_exp_f32 v54, v54
    v_and_b32_dpp v16, v56, v5 quad_perm:[0,0,0,0] row_mask:0xf bank_mask:0xf
    v_and_b32_dpp v19, v56, v6 quad_perm:[0,0,0,0] row_mask:0xf bank_mask:0xf
    v_exp_f32 v55, v55
    v_mov_b32_dpp v17, v16 row_shr:4 row_mask:0xf bank_mask:0xf bound_ctrl:0
    v_mov_b32_dpp v18, v19 row_shl:4 row_mask:0xf bank_mask:0xf bound_ctrl:0
    v_cvt_pk_bf16_f32 v57, v53, v53
    s_waitcnt vmcnt(36)
    v_smfmac_f32_16x16x64_bf16 v[40:43], v[16:19], a[192:199], v7 abid:1
    ds_read_b128 v[64:67], v12 offset:4096
    v_and_b32_dpp v20, v56, v5 quad_perm:[2,2,2,2] row_mask:0xf bank_mask:0xf
    v_and_b32_dpp v23, v56, v6 quad_perm:[2,2,2,2] row_mask:0xf bank_mask:0xf
    v_smfmac_f32_16x16x64_bf16 v[44:47], v[16:19], a[200:207], v7 abid:1
    v_mov_b32_dpp v21, v20 row_shr:4 row_mask:0xf bank_mask:0xf bound_ctrl:0
    v_mov_b32_dpp v22, v23 row_shl:4 row_mask:0xf bank_mask:0xf bound_ctrl:0
    v_cvt_pk_bf16_f32 v58, v54, v54
    v_pk_add_f32 v[24:25], v[52:53], v[54:55]
    v_smfmac_f32_16x16x64_bf16 v[48:51], v[16:19], a[208:215], v7 abid:1
    v_smfmac_f32_16x16x64_bf16 v[40:43], v[20:23], a[216:223], v7 abid:1
    ds_read_b128 v[68:71], v12 offset:8192
    v_and_b32_dpp v16, v57, v5 quad_perm:[0,0,0,0] row_mask:0xf bank_mask:0xf
    v_and_b32_dpp v19, v57, v6 quad_perm:[0,0,0,0] row_mask:0xf bank_mask:0xf
    v_smfmac_f32_16x16x64_bf16 v[44:47], v[20:23], a[224:231], v7 abid:1
    v_mov_b32_dpp v17, v16 row_shr:4 row_mask:0xf bank_mask:0xf bound_ctrl:0
    v_mov_b32_dpp v18, v19 row_shl:4 row_mask:0xf bank_mask:0xf bound_ctrl:0
    v_cvt_pk_bf16_f32 v59, v55, v55
    v_add_f32 v63, v24, v25
    v_smfmac_f32_16x16x64_bf16 v[48:51], v[20:23], a[232:239], v7 abid:1
    s_waitcnt vmcnt(24)
    v_smfmac_f32_16x16x64_bf16 v[40:43], v[16:19], a[240:247], v7 abid:1
    v_and_b32_dpp v20, v57, v5 quad_perm:[2,2,2,2] row_mask:0xf bank_mask:0xf
    v_and_b32_dpp v23, v57, v6 quad_perm:[2,2,2,2] row_mask:0xf bank_mask:0xf
    v_smfmac_f32_16x16x64_bf16 v[44:47], v[16:19], a[248:255], v7 abid:1
    v_mov_b32_dpp v21, v20 row_shr:4 row_mask:0xf bank_mask:0xf bound_ctrl:0
    v_mov_b32_dpp v22, v23 row_shl:4 row_mask:0xf bank_mask:0xf bound_ctrl:0
    v_add_f32_dpp v63, v63, v63 quad_perm:[2,3,0,1] row_mask:0xf bank_mask:0xf
    v_smfmac_f32_16x16x64_bf16 v[48:51], v[16:19], v[128:135], v7 abid:1
    v_smfmac_f32_16x16x64_bf16 v[40:43], v[20:23], v[136:143], v7 abid:1
    v_add_f32_dpp v63, v63, v63 row_ror:4 row_mask:0xf bank_mask:0xf
    v_and_b32_dpp v16, v58, v5 quad_perm:[0,0,0,0] row_mask:0xf bank_mask:0xf
    v_and_b32_dpp v19, v58, v6 quad_perm:[0,0,0,0] row_mask:0xf bank_mask:0xf
    v_smfmac_f32_16x16x64_bf16 v[44:47], v[20:23], v[144:151], v7 abid:1
    v_mov_b32_dpp v17, v16 row_shr:4 row_mask:0xf bank_mask:0xf bound_ctrl:0
    v_mov_b32_dpp v18, v19 row_shl:4 row_mask:0xf bank_mask:0xf bound_ctrl:0
    v_add_f32_dpp v63, v63, v63 row_ror:8 row_mask:0xf bank_mask:0xf
    v_mov_b32 v24, v63
    v_smfmac_f32_16x16x64_bf16 v[48:51], v[20:23], v[152:159], v7 abid:1
    s_waitcnt vmcnt(12)
    v_smfmac_f32_16x16x64_bf16 v[40:43], v[16:19], v[160:167], v7 abid:1
    v_permlane16_swap_b32 v63, v24
    v_add_f32 v63, v63, v24
    v_and_b32_dpp v20, v58, v5 quad_perm:[2,2,2,2] row_mask:0xf bank_mask:0xf
    v_and_b32_dpp v23, v58, v6 quad_perm:[2,2,2,2] row_mask:0xf bank_mask:0xf
    v_smfmac_f32_16x16x64_bf16 v[44:47], v[16:19], v[168:175], v7 abid:1
    v_mov_b32_dpp v21, v20 row_shr:4 row_mask:0xf bank_mask:0xf bound_ctrl:0
    v_mov_b32_dpp v22, v23 row_shl:4 row_mask:0xf bank_mask:0xf bound_ctrl:0
    v_mov_b32 v24, v63
    v_smfmac_f32_16x16x64_bf16 v[48:51], v[16:19], v[176:183], v7 abid:1
    v_smfmac_f32_16x16x64_bf16 v[40:43], v[20:23], v[184:191], v7 abid:1
    v_permlane32_swap_b32 v63, v24
    v_add_f32 v63, v63, v24
    v_and_b32_dpp v16, v59, v5 quad_perm:[0,0,0,0] row_mask:0xf bank_mask:0xf
    v_and_b32_dpp v19, v59, v6 quad_perm:[0,0,0,0] row_mask:0xf bank_mask:0xf
    v_smfmac_f32_16x16x64_bf16 v[44:47], v[20:23], v[192:199], v7 abid:1
    v_mov_b32_dpp v17, v16 row_shr:4 row_mask:0xf bank_mask:0xf bound_ctrl:0
    v_mov_b32_dpp v18, v19 row_shl:4 row_mask:0xf bank_mask:0xf bound_ctrl:0
    s_waitcnt lgkmcnt(0)
    ds_write2_b32 v71, v62, v63 offset0:0 offset1:4
    v_smfmac_f32_16x16x64_bf16 v[48:51], v[20:23], v[200:207], v7 abid:1
    s_waitcnt vmcnt(0)
    v_smfmac_f32_16x16x64_bf16 v[40:43], v[16:19], v[208:215], v7 abid:1
    v_and_b32_dpp v20, v59, v5 quad_perm:[2,2,2,2] row_mask:0xf bank_mask:0xf
    v_and_b32_dpp v23, v59, v6 quad_perm:[2,2,2,2] row_mask:0xf bank_mask:0xf
    v_smfmac_f32_16x16x64_bf16 v[44:47], v[16:19], v[216:223], v7 abid:1
    v_mov_b32_dpp v21, v20 row_shr:4 row_mask:0xf bank_mask:0xf bound_ctrl:0
    v_mov_b32_dpp v22, v23 row_shl:4 row_mask:0xf bank_mask:0xf bound_ctrl:0
    s_mov_b32 vcc_lo, 0x00ff00ff
    v_smfmac_f32_16x16x64_bf16 v[48:51], v[16:19], v[224:231], v7 abid:1
    v_smfmac_f32_16x16x64_bf16 v[40:43], v[20:23], v[232:239], v7 abid:1
    v_smfmac_f32_16x16x64_bf16 v[44:47], v[20:23], v[240:247], v7 abid:1
    v_smfmac_f32_16x16x64_bf16 v[48:51], v[20:23], v[248:255], v7 abid:1
    s_mov_b32 vcc_hi, 0xff00ff00
    v_cmp_eq_u32 s[60:61], 24, v1
    v_mov_b32 v24, v24
    v_mov_b32 v24, v24
    v_mov_b32 v24, v24
    v_mov_b32 v24, v24
    v_mov_b32 v24, v24
    v_cndmask_b32_dpp v40, v44, v40, vcc row_ror:8 row_mask:0xf bank_mask:0xf
    v_cndmask_b32_dpp v41, v45, v41, vcc row_ror:8 row_mask:0xf bank_mask:0xf
    v_cndmask_b32_dpp v42, v46, v42, vcc row_ror:8 row_mask:0xf bank_mask:0xf
    v_cndmask_b32_dpp v43, v47, v43, vcc row_ror:8 row_mask:0xf bank_mask:0xf
    ds_write_b128 v15, v[40:43]
    v_cndmask_b32_dpp v48, v50, v48, vcc row_ror:8 row_mask:0xf bank_mask:0xf
    v_cndmask_b32_dpp v49, v51, v49, vcc row_ror:8 row_mask:0xf bank_mask:0xf
    ds_write_b64 v61, v[48:49]
    s_cmp_eq_u32 s49, 0
    s_cbranch_scc1 HOOKC
EXB:
    s_waitcnt lgkmcnt(0)
    s_barrier
    ds_read_b128 v[16:19], v70
    ds_read_b128 v[20:23], v70 offset:16
    ds_read_b64 v[24:25], v60 offset:0
    v_mov_b32 v44, v44
    ds_read_b64 v[26:27], v60 offset:768
    ds_read_b64 v[28:29], v60 offset:1536
    v_mov_b32 v44, v44
    ds_read_b64 v[30:31], v60 offset:2304
    ds_read_b64 v[32:33], v60 offset:3072
    v_mov_b32 v44, v44
    ds_read_b64 v[34:35], v60 offset:3840
    ds_read_b64 v[36:37], v60 offset:4608
    v_mov_b32 v44, v44
    ds_read_b64 v[38:39], v60 offset:5376
    s_mov_b32 s51, 0
    s_cmp_eq_u32 s49, 0
    s_cselect_b32 s52, 20, s46
    s_waitcnt lgkmcnt(9)
    v_max3_f32 v40, v16, v17, v18
    v_max_f32 v40, v40, v19
    v_pk_add_f32 v[16:17], v[16:17], v[40:41] op_sel_hi:[1,0] neg_lo:[0,1] neg_hi:[0,1]
    v_pk_add_f32 v[18:19], v[18:19], v[40:41] op_sel_hi:[1,0] neg_lo:[0,1] neg_hi:[0,1]
    v_exp_f32 v16, v16
    v_exp_f32 v17, v17
    v_exp_f32 v18, v18
    v_exp_f32 v19, v19
    s_waitcnt lgkmcnt(0)
    v_pk_mul_f32 v[20:21], v[20:21], v[16:17]
    v_pk_fma_f32 v[20:21], v[22:23], v[18:19], v[20:21]
    v_add_f32 v41, v20, v21
    v_rcp_f32 v42, v41
    v_log_f32 v43, v41
    v_pk_add_f32 v[24:25], v[24:25], v[26:27]
    v_pk_add_f32 v[28:29], v[28:29], v[30:31]
    v_pk_add_f32 v[32:33], v[32:33], v[34:35]
    v_pk_add_f32 v[36:37], v[36:37], v[38:39]
    v_pk_mul_f32 v[24:25], v[24:25], v[16:17] op_sel_hi:[1,0]
    v_pk_fma_f32 v[24:25], v[28:29], v[16:17], v[24:25] op_sel:[0,1,0] op_sel_hi:[1,1,1]
    v_pk_fma_f32 v[24:25], v[32:33], v[18:19], v[24:25] op_sel:[0,0,0] op_sel_hi:[1,0,1]
    v_pk_fma_f32 v[24:25], v[36:37], v[18:19], v[24:25] op_sel:[0,1,0] op_sel_hi:[1,1,1]
    v_pk_mul_f32 v[24:25], v[24:25], v[42:43] op_sel_hi:[1,0]
    v_add_f32 v43, v43, v40
    v_cvt_pk_bf16_f32 v24, v24, v25
    v_cndmask_b32 v24, v24, v43, s[60:61]
    buffer_store_dword v24, v14, s[16:19], s32 offen offset:0
    s_cmp_eq_u32 s50, 0
    s_cbranch_scc1 SLOW3
PUBD3:
    s_cmp_ge_u32 s52, 20
    s_cbranch_scc1 HOOKG
    v_mov_b32 v40, v40
    v_mov_b32 v40, v40
    v_mov_b32 v40, v40
    v_mov_b32 v40, v40
    v_mov_b32 v40, v40
    v_mov_b32 v40, v40
    v_mov_b32 v40, v40
    v_mov_b32 v40, v40
    v_mov_b32 v40, v40
    v_mov_b32 v40, v40
    v_mov_b32 v40, v40
    v_mov_b32 v40, v40
    v_mov_b32 v40, v40
    v_mov_b32 v40, v40
    v_mov_b32 v40, v40
    v_mov_b32 v40, v40
    buffer_load_dword v56, v65, s[16:19], s62 offen sc1
    buffer_load_dwordx4 v[44:47], v64, s[16:19], s62 offen offset:0 sc1
    buffer_load_dwordx4 v[48:51], v64, s[16:19], s62 offen offset:512 sc1
    buffer_load_dwordx4 v[52:55], v64, s[16:19], s62 offen offset:1024 sc1
    buffer_load_dword v57, v66, s[16:19], s49 offen sc1
    v_mov_b32 v40, v40
    v_mov_b32 v40, v40
    v_mov_b32 v40, v40
    v_mov_b32 v40, v40
    v_mov_b32 v40, v40
    v_mov_b32 v40, v40
    v_mov_b32 v40, v40
    v_mov_b32 v40, v40
    v_mov_b32 v40, v40
    v_mov_b32 v40, v40
    v_mov_b32 v40, v40
    v_mov_b32 v40, v40
    v_mov_b32 v40, v40
    v_mov_b32 v40, v40
    v_mov_b32 v40, v40
    v_mov_b32 v40, v40
    v_mov_b32 v40, v40
    v_mov_b32 v40, v40
    v_mov_b32 v40, v40
    v_mov_b32 v40, v40
WOP:
    buffer_load_dword v56, v65, s[16:19], s62 offen sc1
    buffer_load_dwordx4 v[44:47], v64, s[16:19], s62 offen offset:0 sc1
    buffer_load_dwordx4 v[48:51], v64, s[16:19], s62 offen offset:512 sc1
    buffer_load_dwordx4 v[52:55], v64, s[16:19], s62 offen offset:1024 sc1
    buffer_load_dword v57, v66, s[16:19], s49 offen sc1
    v_mov_b32 v40, v40
    v_mov_b32 v40, v40
    v_mov_b32 v40, v40
    v_mov_b32 v40, v40
    s_waitcnt vmcnt(5)
WOC:
    v_max3_u32 v63, v44, v48, v52
    v_mov_b32 v32, v56
    v_max_u32 v63, v63, v32
    v_cmp_eq_u32 vcc, -1, v63
    s_cbranch_vccnz AGWOP
    v_mfma_f32_16x16x32_bf16 v[16:19], v[44:47], v[80:83], 0
    v_max_f32_dpp v33, v32, v32 quad_perm:[1,0,3,2] row_mask:0xf bank_mask:0xf
    s_nop 0
    v_mfma_f32_16x16x32_bf16 v[16:19], v[48:51], v[96:99], v[16:19]
    v_max_f32_dpp v33, v33, v33 quad_perm:[2,3,0,1] row_mask:0xf bank_mask:0xf
    s_nop 0
    v_mfma_f32_16x16x32_bf16 v[16:19], v[52:55], v[112:115], v[16:19]
    v_max_f32_dpp v33, v33, v33 row_half_mirror row_mask:0xf bank_mask:0xf
    v_sub_f32 v34, v32, v33
    v_mfma_f32_16x16x32_bf16 v[20:23], v[44:47], v[84:87], 0
    v_exp_f32 v34, v34
    s_nop 0
    v_mfma_f32_16x16x32_bf16 v[20:23], v[48:51], v[100:103], v[20:23]
    v_add_f32_dpp v33, v34, v34 quad_perm:[1,0,3,2] row_mask:0xf bank_mask:0xf
    s_nop 0
    v_mfma_f32_16x16x32_bf16 v[20:23], v[52:55], v[116:119], v[20:23]
    v_add_f32_dpp v33, v33, v33 quad_perm:[2,3,0,1] row_mask:0xf bank_mask:0xf
    s_nop 0
    v_mfma_f32_16x16x32_bf16 v[24:27], v[44:47], v[88:91], 0
    v_add_f32_dpp v33, v33, v33 row_half_mirror row_mask:0xf bank_mask:0xf
    v_rcp_f32 v33, v33
    v_mfma_f32_16x16x32_bf16 v[24:27], v[48:51], v[104:107], v[24:27]
    v_mul_f32 v34, v34, v33
    s_nop 0
    v_mfma_f32_16x16x32_bf16 v[24:27], v[52:55], v[120:123], v[24:27]
    v_mul_f32_dpp v36, v34, v16 row_newbcast:0 row_mask:0xf bank_mask:0xf
    v_fmac_f32_dpp v36, v34, v17 row_newbcast:1 row_mask:0xf bank_mask:0xf
    v_mfma_f32_16x16x32_bf16 v[28:31], v[44:47], v[92:95], 0
    v_fmac_f32_dpp v36, v34, v18 row_newbcast:2 row_mask:0xf bank_mask:0xf
    v_fmac_f32_dpp v36, v34, v19 row_newbcast:3 row_mask:0xf bank_mask:0xf
    v_mfma_f32_16x16x32_bf16 v[28:31], v[48:51], v[108:111], v[28:31]
    v_mul_f32_dpp v37, v34, v20 row_newbcast:0 row_mask:0xf bank_mask:0xf
    v_fmac_f32_dpp v37, v34, v21 row_newbcast:1 row_mask:0xf bank_mask:0xf
    v_mfma_f32_16x16x32_bf16 v[28:31], v[52:55], v[124:127], v[28:31]
    v_fmac_f32_dpp v37, v34, v22 row_newbcast:2 row_mask:0xf bank_mask:0xf
    v_fmac_f32_dpp v37, v34, v23 row_newbcast:3 row_mask:0xf bank_mask:0xf
    v_cmp_u_f32 vcc, v36, v57
    v_mul_f32_dpp v38, v34, v24 row_newbcast:0 row_mask:0xf bank_mask:0xf
    v_fmac_f32_dpp v38, v34, v25 row_newbcast:1 row_mask:0xf bank_mask:0xf
    v_fmac_f32_dpp v38, v34, v26 row_newbcast:2 row_mask:0xf bank_mask:0xf
    v_fmac_f32_dpp v38, v34, v27 row_newbcast:3 row_mask:0xf bank_mask:0xf
    s_mov_b32 exec_hi, 0
    v_mul_f32_dpp v39, v34, v28 row_newbcast:0 row_mask:0xf bank_mask:0xf
    v_fmac_f32_dpp v39, v34, v29 row_newbcast:1 row_mask:0xf bank_mask:0xf
    v_fmac_f32_dpp v39, v34, v30 row_newbcast:2 row_mask:0xf bank_mask:0xf
    v_fmac_f32_dpp v39, v34, v31 row_newbcast:3 row_mask:0xf bank_mask:0xf
    ds_write_b128 v68, v[36:39]
    s_mov_b64 exec, -1
    s_cbranch_vccnz AGWOP
OKWOP:
    s_cmp_lg_u32 s44, 3
    s_waitcnt lgkmcnt(0)
    s_barrier
    s_cbranch_scc1 WOX
    ds_read2st64_b32 v[16:17], v69 offset0:0 offset1:1
    ds_read2st64_b32 v[18:19], v69 offset0:2 offset1:3
    ds_read2st64_b32 v[20:21], v69 offset0:4 offset1:5
    ds_read2st64_b32 v[22:23], v69 offset0:6 offset1:7
    s_waitcnt lgkmcnt(2)
    v_pk_add_f32 v[16:17], v[16:17], v[18:19]
    v_add_f32 v16, v16, v57
    s_waitcnt lgkmcnt(0)
    v_pk_add_f32 v[20:21], v[20:21], v[22:23]
    v_pk_add_f32 v[16:17], v[16:17], v[20:21]
    v_add_f32 v16, v16, v17
    buffer_store_dword v16, v67, s[16:19], s1 offen sc1
    buffer_store_dword v16, v67, s[16:19], s99 offen sc1
WOX:
    s_cmp_ge_u32 s46, 30
    s_cbranch_scc1 STX
    s_cmp_eq_u32 s44, 3
    s_cbranch_scc1 F1W3
    s_waitcnt vmcnt(0)
F1W3:
    s_waitcnt vmcnt(2)
F1E:
    ds_read_b128 v[56:59], v12 offset:16384
    ds_read_b128 v[52:55], v12 offset:12288
    ds_read_b128 v[60:63], v12 offset:20480
    s_mov_b32 s100, 0
    s_mov_b32 s51, 0
    s_waitcnt lgkmcnt(0)
    ds_read_b64_tr_b16 v[64:65], v57 offset:49152
    ds_read_b64_tr_b16 v[66:67], v57 offset:49664
    ds_read_b64_tr_b16 v[68:69], v57 offset:53248
    ds_read_b64_tr_b16 v[70:71], v57 offset:53760
    ds_read_b64_tr_b16 v[72:73], v57 offset:57344
    ds_read_b64_tr_b16 v[74:75], v57 offset:57856
    ds_read_b64_tr_b16 v[76:77], v57 offset:61440
    ds_read_b64_tr_b16 v[78:79], v57 offset:61952
    s_cmp_eq_u32 s49, 0
    s_cbranch_scc1 HOOKD
    s_cmp_lt_u32 s46, 20
    s_cbranch_scc1 GFB
    s_sleep 11
GFB:
    s_sleep 11
F1P:
F1W:
    buffer_load_dword v44, v52, s[16:19], s99 offen offset:0 sc1
    buffer_load_dword v45, v52, s[16:19], s99 offen offset:128 sc1
    buffer_load_dword v46, v52, s[16:19], s99 offen offset:256 sc1
    buffer_load_dword v47, v52, s[16:19], s99 offen offset:384 sc1
    buffer_load_dword v48, v52, s[16:19], s99 offen offset:512 sc1
    buffer_load_dword v49, v52, s[16:19], s99 offen offset:640 sc1
    buffer_load_dword v50, v52, s[16:19], s99 offen offset:768 sc1
    buffer_load_dword v51, v52, s[16:19], s99 offen offset:896 sc1
    s_waitcnt vmcnt(0)
    v_pk_add_f32 v[16:17], v[44:45], v[46:47]
    v_pk_add_f32 v[18:19], v[48:49], v[50:51]
    v_pk_add_f32 v[16:17], v[16:17], v[18:19]
    v_add_f32 v16, v16, v17
    v_mov_b32 v17, v16
    s_nop 1
    v_permlane32_swap_b32 v16, v17
    v_add_f32 v16, v16, v17
    v_cmp_u_f32 vcc, v16, v16
    v_cvt_pk_bf16_f32 v16, v16, v16
    ds_write_b16 v53, v16
    s_cbranch_vccnz AGF1P
OKF1P:
    v_and_b32 v16, 0xffff0000, v16
    buffer_store_dword v16, v54, s[16:19], s34 offen offset:0
    s_cmp_eq_u32 s50, 0
    s_cbranch_scc1 SLOW8
PUBD8:
    s_waitcnt lgkmcnt(0)
    s_barrier
    ds_read_b128 v[20:23], v2 offset:256
    ds_read_b128 v[24:27], v2 offset:320
    ds_read_b128 v[28:31], v2 offset:384
    ds_read_b128 v[32:35], v2 offset:448
    s_waitcnt lgkmcnt(3)
    v_mfma_f32_16x16x32_bf16 v[40:43], v[20:23], v[64:67], 0
    v_mfma_f32_16x16x32_bf16 v[36:39], v[20:23], v[20:23], 0
    s_waitcnt lgkmcnt(2)
    v_mfma_f32_16x16x32_bf16 v[40:43], v[24:27], v[68:71], v[40:43]
    v_mfma_f32_16x16x32_bf16 v[36:39], v[24:27], v[24:27], v[36:39]
    s_waitcnt lgkmcnt(1)
    v_mfma_f32_16x16x32_bf16 v[40:43], v[28:31], v[72:75], v[40:43]
    v_mfma_f32_16x16x32_bf16 v[36:39], v[28:31], v[28:31], v[36:39]
    s_waitcnt lgkmcnt(0)
    v_mfma_f32_16x16x32_bf16 v[40:43], v[32:35], v[76:79], v[40:43]
    v_mfma_f32_16x16x32_bf16 v[36:39], v[32:35], v[32:35], v[36:39]
    s_mov_b32 s51, 0
    s_nop 5
    buffer_store_dword v40, v55, s[16:19], s32 offen offset:0
    buffer_store_dwordx2 v[36:37], v56, s[16:19], s32 offen offset:0
    s_cmp_eq_u32 s50, 0
    s_cbranch_scc1 SLOW9
PUBD9:
    s_cmp_lt_u32 s46, 20
    s_cbranch_scc1 STX
    s_cmp_eq_u32 s49, 0
    s_cbranch_scc1 HOOKI
    v_mov_b32 v44, v44
    v_mov_b32 v44, v44
    v_mov_b32 v44, v44
    v_mov_b32 v44, v44
    v_mov_b32 v44, v44
    v_mov_b32 v44, v44
    v_mov_b32 v44, v44
    v_mov_b32 v44, v44
    v_mov_b32 v44, v44
    v_mov_b32 v44, v44
    v_mov_b32 v44, v44
    v_mov_b32 v44, v44
    v_mov_b32 v44, v44
    v_mov_b32 v44, v44
    v_mov_b32 v44, v44
    v_mov_b32 v44, v44
    v_mov_b32 v44, v44
    v_mov_b32 v44, v44
    v_mov_b32 v44, v44
    v_mov_b32 v44, v44
    v_mov_b32 v44, v44
    v_mov_b32 v44, v44
    v_mov_b32 v44, v44
    v_mov_b32 v44, v44
    v_mov_b32 v44, v44
    v_mov_b32 v44, v44
    v_mov_b32 v44, v44
    v_mov_b32 v44, v44
    buffer_load_dwordx2 v[74:75], v60, s[16:19], s62 offen sc1
    buffer_load_dwordx4 v[64:67], v58, s[16:19], s62 offen offset:0 sc1
    buffer_load_dwordx4 v[68:71], v58, s[16:19], s62 offen offset:3072 sc1
    buffer_load_dwordx2 v[72:73], v59, s[16:19], s62 offen sc1
    buffer_load_dword v76, v61, s[16:19], s49 offen sc1
    v_mov_b32 v44, v44
    v_mov_b32 v44, v44
    v_mov_b32 v44, v44
    v_mov_b32 v44, v44
    v_mov_b32 v44, v44
    v_mov_b32 v44, v44
    v_mov_b32 v44, v44
    v_mov_b32 v44, v44
    v_mov_b32 v44, v44
    v_mov_b32 v44, v44
    v_mov_b32 v44, v44
    v_mov_b32 v44, v44
    v_mov_b32 v44, v44
    v_mov_b32 v44, v44
    v_mov_b32 v44, v44
    v_mov_b32 v44, v44
    v_mov_b32 v44, v44
    v_mov_b32 v44, v44
    v_mov_b32 v44, v44
    v_mov_b32 v44, v44
W2P:
    buffer_load_dwordx2 v[74:75], v60, s[16:19], s62 offen sc1
    buffer_load_dwordx4 v[64:67], v58, s[16:19], s62 offen offset:0 sc1
    buffer_load_dwordx4 v[68:71], v58, s[16:19], s62 offen offset:3072 sc1
    buffer_load_dwordx2 v[72:73], v59, s[16:19], s62 offen sc1
    buffer_load_dword v76, v61, s[16:19], s49 offen sc1
    s_waitcnt vmcnt(5)
    v_add_f32_dpp v46, v74, v74 quad_perm:[1,0,3,2] row_mask:0xf bank_mask:0xf
    v_add_f32_dpp v47, v75, v75 quad_perm:[1,0,3,2] row_mask:0xf bank_mask:0xf
    v_pk_add_f32 v[18:19], v[64:65], v[66:67]
    v_add_f32_dpp v46, v46, v46 quad_perm:[2,3,0,1] row_mask:0xf bank_mask:0xf
    v_add_f32_dpp v47, v47, v47 quad_perm:[2,3,0,1] row_mask:0xf bank_mask:0xf
    v_pk_add_f32 v[20:21], v[68:69], v[70:71]
    v_add_f32_dpp v46, v46, v46 row_half_mirror row_mask:0xf bank_mask:0xf
    v_add_f32_dpp v47, v47, v47 row_half_mirror row_mask:0xf bank_mask:0xf
    v_add_f32 v16, v18, v19
    v_add_f32 v17, v20, v21
    v_mul_f32 v47, 0x3acccccd, v47
    v_fmamk_f32 v46, v46, 0x3acccccd, v11
    v_fma_f32 v46, -v47, v47, v46
    v_rsq_f32 v46, abs(v46)
    v_pk_add_f32 v[16:17], v[16:17], v[72:73]
    v_pk_fma_f32 v[16:17], v[46:47], v[126:127], v[16:17] op_sel:[1,0,0] op_sel_hi:[1,1,1] neg_lo:[1,0,0] neg_hi:[1,0,0]
    v_pk_mul_f32 v[16:17], v[16:17], v[46:47] op_sel_hi:[1,0]
    v_mul_f32 v18, 0xbfb8aa3b, v16
    v_exp_f32 v18, v18
    v_mul_f32 v16, v16, v17
    v_add_f32 v18, 1.0, v18
    v_rcp_f32 v18, v18
    v_cmp_u_f32 vcc, v16, v76
    v_mul_f32 v16, v16, v18
    v_cvt_pk_bf16_f32 v16, v16, v16
    ds_write_b16 v63, v16
    s_cbranch_vccnz AGW2P
OKW2P:
    s_waitcnt lgkmcnt(0)
    s_barrier
    ds_read_b128 v[16:19], v2 offset:512
    ds_read_b128 v[20:23], v2 offset:576
    ds_read_b128 v[24:27], v2 offset:640
    ds_read_b128 v[28:31], v2 offset:704
    ds_read_b128 v[32:35], v2 offset:768
    ds_read_b128 v[36:39], v2 offset:832
    v_mov_b32 v40, v76
    s_nop 0
    s_waitcnt lgkmcnt(5)
    v_mfma_f32_16x16x32_bf16 v[40:43], v[16:19], v[80:83], v[40:43]
    s_waitcnt lgkmcnt(4)
    v_mfma_f32_16x16x32_bf16 v[40:43], v[20:23], v[84:87], v[40:43]
    s_waitcnt lgkmcnt(3)
    v_mfma_f32_16x16x32_bf16 v[40:43], v[24:27], v[88:91], v[40:43]
    s_waitcnt lgkmcnt(2)
    v_mfma_f32_16x16x32_bf16 v[40:43], v[28:31], v[92:95], v[40:43]
    s_waitcnt lgkmcnt(1)
    v_mfma_f32_16x16x32_bf16 v[40:43], v[32:35], v[96:99], v[40:43]
    s_waitcnt lgkmcnt(0)
    v_mfma_f32_16x16x32_bf16 v[40:43], v[36:39], v[100:103], v[40:43]
    s_waitcnt vmcnt(0)
    s_nop 6
    buffer_store_dword v40, v62, s[16:19], s49 offen sc1
STX:
    s_cmp_lg_u32 s49, 0
    s_cbranch_scc1 LAST
    s_branch LOOP
LAST:
    s_and_b32 s52, s2, 0xc7
    s_cmp_eq_u32 s52, 0
    s_cbranch_scc1 LOOP
    s_endpgm
FINAL:
    s_cmp_eq_u32 s44, 3
    s_cbranch_scc1 FINX
    s_sleep 22
    s_waitcnt lgkmcnt(0)
Y3P:
    buffer_load_dword v22, v16, s[16:19], s55 offen offset:0 sc1
    buffer_load_dword v23, v16, s[16:19], s55 offen offset:128 sc1
    buffer_load_dword v24, v16, s[16:19], s55 offen offset:256 sc1
    buffer_load_dword v25, v16, s[16:19], s55 offen offset:384 sc1
    s_waitcnt vmcnt(0)
    v_pk_add_f32 v[22:23], v[22:23], v[24:25]
    v_add_f32 v30, v22, v23
    v_mov_b32 v31, v30
    s_nop 1
    v_permlane32_swap_b32 v30, v31
    v_add_f32 v30, v30, v31
    v_cmp_u_f32 vcc, v30, v30
    v_cvt_pk_bf16_f32 v30, v30, v30
    s_cbranch_vccnz AGY3P
OKY3P:
    buffer_store_short v30, v21, s[36:39], 0 offen
FINX:
DONE:
    s_endpgm
TABLES:
    v_mov_b32 v23, 1879048192
    v_and_b32 v24, 15, v1
    v_lshrrev_b32 v25, 4, v1
    v_and_b32 v26, 7, v1
    v_and_b32 v27, 31, v1
    v_lshrrev_b32 v28, 5, v1
    v_and_b32 v29, 31, v1
    v_lshl_add_u32 v29, s44, 5, v29
    v_lshrrev_b32 v16, 2, v1
    v_lshlrev_b32 v16, 7, v16
    v_and_b32 v20, 3, v1
    v_lshl_add_u32 v16, v20, 2, v16
    s_mul_i32 s52, s7, 3072
    s_mul_i32 s54, s44, 768
    s_add_u32 s52, s52, s54
    s_lshl_b32 s54, s48, 4
    s_add_u32 s52, s52, s54
    v_add_u32 v16, s52, v16
    v_cmp_gt_u32 vcc, 24, v1
    s_nop 1
    v_cndmask_b32 v16, v23, v16, vcc
    s_lshl_b32 s52, s7, 5
    s_lshl_b32 s54, s48, 2
    s_add_u32 s52, s52, s54
    s_add_u32 s52, s52, 19968
    s_cmp_eq_u32 s44, 3
    s_cselect_b32 s52, s52, 1879048192
    v_writelane_b32 v16, s52, 24
    v_lshlrev_b32 v17, 4, v26
    v_and_b32 v20, 1, v25
    v_lshl_add_u32 v17, v20, 7, v17
    v_mul_u32_u24 v20, 768, v28
    v_add_u32 v17, v17, v20
    s_mul_i32 s52, s44, 1536
    s_add_u32 s52, s52, 98816
    v_add_u32 v17, s52, v17
    v_bfe_u32 v20, v1, 3, 1
    v_xor_b32 v20, v20, v28
    v_lshl_add_u32 v19, v20, 3, v17
    v_add_u32 v19, 512, v19
    v_lshl_add_u32 v17, v20, 8, v17
    s_mul_i32 s52, s44, 24
    v_min_u32 v21, 23, v1
    v_add_u32 v21, s52, v21
    v_lshrrev_b32 v18, 5, v21
    v_lshlrev_b32 v18, 8, v18
    v_bfe_u32 v20, v21, 1, 1
    v_lshl_add_u32 v18, v20, 7, v18
    v_bfe_u32 v20, v21, 2, 3
    v_lshl_add_u32 v18, v20, 4, v18
    v_bfe_u32 v20, v21, 0, 1
    v_lshl_add_u32 v18, v20, 3, v18
    v_add_u32 v18, 98816, v18
    ds_write_b128 v12, v[16:19] offset:0
    v_lshlrev_b32 v16, 4, v26
    v_lshl_add_u32 v16, v25, 7, v16
    s_mul_i32 s52, s56, 6144
    s_mul_i32 s54, s44, 1536
    s_add_u32 s52, s52, s54
    v_add_u32 v16, s52, v16
    v_cmp_gt_u32 vcc, 8, v24
    s_nop 1
    v_cndmask_b32 v16, v23, v16, vcc
    s_lshr_b32 s53, s44, 1
    s_lshl_b32 s52, s56, 6
    s_lshl_b32 s54, s53, 5
    s_add_u32 s52, s52, s54
    s_add_u32 s52, s52, 19968
    v_lshl_add_u32 v17, v25, 2, v26
    v_and_b32 v17, 7, v17
    v_lshl_add_u32 v17, v17, 2, s52
    s_lshl_b32 s52, s57, 8
    s_add_u32 s52, s52, 131072
    s_or_b32 s53, s45, s56
    s_cmp_eq_u32 s53, 0
    s_cselect_b32 s52, s52, 1879048192
    v_lshl_add_u32 v18, v1, 2, s52
    v_lshlrev_b32 v19, 11, v28
    v_lshl_add_u32 v19, v27, 2, v19
    s_lshr_b32 s53, s57, 1
    s_lshl_b32 s52, s57, 12
    s_lshl_b32 s54, s53, 13
    s_add_u32 s52, s52, s54
    s_lshl_b32 s54, s45, 8
    s_add_u32 s52, s52, s54
    s_lshl_b32 s54, s56, 7
    s_add_u32 s52, s52, s54
    v_add_u32 v19, s52, v19
    ds_write_b128 v12, v[16:19] offset:4096
    s_lshl_b32 s52, s44, 9
    s_add_u32 s52, s52, 104960
    v_lshl_add_u32 v16, v27, 4, s52
    v_lshl_add_u32 v16, v28, 11, v16
    v_lshlrev_b32 v17, 4, v24
    v_lshl_add_u32 v17, v25, 2, v17
    v_add_u32 v17, 104960, v17
    v_mov_b32 v18, 98752
    s_lshl_b32 s52, s44, 2
    s_add_u32 s52, s52, 98752
    v_mov_b32 v19, 98792
    v_writelane_b32 v19, s52, 0
    ds_write_b128 v12, v[16:19] offset:8192
    v_lshlrev_b32 v16, 10, v28
    v_lshl_add_u32 v16, v27, 2, v16
    s_lshl_b32 s52, s3, 14
    s_lshl_b32 s54, s44, 11
    s_add_u32 s52, s52, s54
    v_add_u32 v16, s52, v16
    v_lshlrev_b32 v17, 1, v29
    v_add_u32 v17, 96512, v17
    s_lshl_b32 s52, s4, 9
    s_add_u32 s52, s52, 133632
    s_cmp_lt_u32 s4, 5
    s_cselect_b32 s52, s52, 1879048192
    s_cmp_eq_u32 s45, 0
    s_cselect_b32 s52, s52, 1879048192
    v_lshl_add_u32 v18, v29, 2, s52
    v_cmp_gt_u32 vcc, 32, v1
    s_nop 1
    v_cndmask_b32 v18, v23, v18, vcc
    s_lshl_b32 s52, s59, 6
    s_lshl_b32 s54, s44, 4
    s_add_u32 s52, s52, s54
    v_add_u32 v19, s52, v1
    s_mul_i32 s52, s58, 3072
    s_lshl_b32 s54, s3, 2
    s_add_u32 s52, s52, s54
    s_add_u32 s52, s52, 12288
    s_lshl_b32 s53, s58, 2
    s_add_u32 s53, s53, 18432
    s_cmp_eq_u32 s3, 4
    s_cselect_b32 s52, s53, s52
    s_cselect_b32 s53, 3, 4
    v_lshlrev_b32 v19, s53, v19
    v_add_u32 v19, s52, v19
    v_cmp_gt_u32 vcc, 16, v1
    s_nop 1
    v_cndmask_b32 v19, v23, v19, vcc
    ds_write_b128 v12, v[16:19] offset:12288
    s_lshl_b32 s52, s4, 3
    s_add_u32 s52, s52, 20224
    s_cmp_eq_u32 s44, 3
    s_cselect_b32 s52, s52, 1879048192
    s_cmp_lt_u32 s4, 5
    s_cselect_b32 s52, s52, 1879048192
    v_mov_b32 v16, v23
    v_writelane_b32 v16, s52, 0
    v_and_b32 v17, 3, v1
    v_lshlrev_b32 v17, 3, v17
    v_bfe_u32 v20, v1, 2, 2
    v_lshl_add_u32 v17, v20, 7, v17
    v_lshrrev_b32 v20, 4, v1
    v_lshl_add_u32 v17, v20, 10, v17
    v_bfe_u32 v20, v1, 3, 2
    v_lshl_add_u32 v17, v20, 5, v17
    s_lshl_b32 s52, s44, 5
    v_xor_b32 v17, s52, v17
    v_lshlrev_b32 v18, 4, v0
    v_add_u32 v18, 12288, v18
    v_lshlrev_b32 v19, 3, v0
    v_add_u32 v19, 18432, v19
    v_cmp_gt_u32 vcc, 192, v0
    s_nop 1
    v_cndmask_b32 v18, v23, v18, vcc
    v_cndmask_b32 v19, v23, v19, vcc
    ds_write_b128 v12, v[16:19] offset:16384
    v_lshlrev_b32 v16, 3, v26
    v_add_u32 v16, 20224, v16
    v_cmp_gt_u32 vcc, 5, v26
    s_nop 1
    v_cndmask_b32 v16, v23, v16, vcc
    v_cmp_gt_u32 vcc, 192, v0
    s_nop 1
    v_cndmask_b32 v16, v23, v16, vcc
    s_lshl_b32 s52, s57, 8
    s_lshl_b32 s54, s44, 6
    s_add_u32 s52, s52, s54
    s_add_u32 s52, s52, 133632
    s_cmp_eq_u32 s45, 0
    s_cselect_b32 s52, s52, 1879048192
    v_lshl_add_u32 v17, v24, 2, s52
    s_lshr_b32 s53, s57, 2
    s_lshr_b32 s51, s44, 1
    s_lshl_b32 s52, s57, 11
    s_lshl_b32 s54, s53, 13
    s_add_u32 s52, s52, s54
    s_mul_i32 s54, s51, 896
    s_add_u32 s52, s52, s54
    s_lshl_b32 s54, s44, 6
    s_add_u32 s52, s52, s54
    s_lshl_b32 s54, s45, 7
    s_add_u32 s52, s52, s54
    s_add_u32 s52, s52, 81920
    v_lshl_add_u32 v18, v24, 2, s52
    v_lshl_add_u32 v18, v25, 13, v18
    v_cmp_gt_u32 vcc, 32, v1
    s_nop 1
    v_cndmask_b32 v18, v23, v18, vcc
    v_lshlrev_b32 v19, 1, v0
    v_add_u32 v19, 96768, v19
    ds_write_b128 v12, v[16:19] offset:20480
    s_lshr_b32 s53, s48, 2
    s_mul_i32 s52, s7, 6144
    s_lshl_b32 s54, s44, 8
    s_add_u32 s52, s52, s54
    s_mul_i32 s54, s53, 3056
    s_add_u32 s52, s52, s54
    s_lshl_b32 s54, s48, 2
    s_add_u32 s52, s52, s54
    s_add_u32 s52, s52, 20480
    v_lshl_add_u32 v16, v1, 4, s52
    v_cmp_gt_u32 vcc, 16, v1
    s_nop 1
    v_cndmask_b32 v16, v23, v16, vcc
    s_lshl_b32 s52, s7, 6
    s_lshl_b32 s54, s48, 3
    s_add_u32 s52, s52, s54
    s_add_u32 s52, s52, 45056
    s_cmp_eq_u32 s44, 3
    s_cselect_b32 s52, s52, 1879048192
    v_mov_b32 v17, v23
    v_writelane_b32 v17, s52, 0
    s_mul_i32 s52, s48, 80
    v_add_u32 v20, s52, v29
    v_lshrrev_b32 v18, 5, v20
    v_lshlrev_b32 v18, 10, v18
    v_lshrrev_b32 v21, 8, v20
    v_lshl_add_u32 v18, v21, 13, v18
    v_and_b32 v21, 31, v20
    v_lshl_add_u32 v18, v21, 2, v18
    v_lshl_add_u32 v18, v28, 9, v18
    v_add_u32 v18, 81920, v18
    v_cmp_gt_u32 vcc, 80, v29
    s_nop 1
    v_cndmask_b32 v18, v23, v18, vcc
    v_lshlrev_b32 v19, 1, v29
    v_add_u32 v19, 96256, v19
    ds_write_b128 v12, v[16:19] offset:24576
    s_and_b32 s53, s2, 0xc7
    s_cmp_eq_u32 s53, 0
    s_mov_b32 s52, 131072
    s_cselect_b32 s52, s52, 1879048192
    v_lshl_add_u32 v16, v20, 2, s52
    v_lshlrev_b32 v19, 1, v20
    s_and_b32 vcc_hi, vcc_hi, 0
    s_nop 1
    v_cndmask_b32 v16, v23, v16, vcc
    v_cndmask_b32 v19, v23, v19, vcc
    v_and_b32 v21, 3, v1
    v_lshrrev_b32 v17, 4, v1
    v_bfe_u32 v18, v1, 2, 2
    v_lshlrev_b32 v21, 3, v21
    v_mul_u32_u24 v18, 384, v18
    v_add_u32 v21, v21, v18
    v_bfe_u32 v18, v1, 3, 2
    v_xor_b32 v18, s44, v18
    v_lshl_add_u32 v21, v18, 5, v21
    v_add_u32 v21, 65536, v21
    v_and_b32 v18, 1, v17
    v_mul_u32_u24 v17, 3072, v17
    v_mul_u32_u24 v18, 3072, v18
    v_add_u32 v17, v17, v21
    v_add_u32 v18, v18, v21
    ds_write_b128 v12, v[16:19] offset:28672
    s_branch ENTRY0
HOOKL:
    s_cmp_lt_u32 s46, 30
    s_cbranch_scc1 NOGSW
    v_mov_b32 v30, 20224
GSW:
    buffer_load_dword v31, v30, s[16:19], s96 offen sc1
    s_waitcnt vmcnt(0)
    v_cmp_u_f32 vcc, v31, v31
    s_cbranch_vccz NOGSW
    s_add_u32 s51, s51, 1
    s_sleep 2
    s_cmp_lt_u32 s51, 0x40000
    s_cbranch_scc1 GSW
NOGSW:
    s_cmp_ge_u32 s46, 30
    s_cselect_b32 s53, 10, 0
    s_sub_u32 s53, s46, s53
    v_min_u32 v31, 17, v1
    v_lshlrev_b32 v31, 7, v31
    s_mul_i32 s52, s45, 45312
    s_mul_i32 s54, s53, 2304
    s_add_u32 s52, s52, s54
    s_add_u32 s52, s52, 524288
    buffer_load_dword v31, v31, s[16:19], s52 offen sc1
    v_lshlrev_b32 v30, 3, v0
    s_mul_i32 s52, s47, 12288
    s_add_u32 s52, s52, 1441792
    s_add_u32 s53, s52, 0
    buffer_load_dwordx2 v[32:33], v30, s[16:19], s53 offen offset:0 sc1
    buffer_load_dwordx2 v[34:35], v30, s[16:19], s53 offen offset:1536 sc1
    s_add_u32 s53, s52, 3072
    buffer_load_dwordx2 v[36:37], v30, s[16:19], s53 offen offset:0 sc1
    buffer_load_dwordx2 v[38:39], v30, s[16:19], s53 offen offset:1536 sc1
    s_add_u32 s53, s52, 6144
    buffer_load_dwordx2 v[40:41], v30, s[16:19], s53 offen offset:0 sc1
    buffer_load_dwordx2 v[42:43], v30, s[16:19], s53 offen offset:1536 sc1
    s_add_u32 s53, s52, 9216
    buffer_load_dwordx2 v[26:27], v30, s[16:19], s53 offen offset:0 sc1
    buffer_load_dwordx2 v[28:29], v30, s[16:19], s53 offen offset:1536 sc1
    s_sleep 23
    s_mov_b32 s51, 0
    s_branch GYB
QCA:
    v_lshlrev_b32 v30, 3, v0
    s_mul_i32 s52, s47, 12288
    s_add_u32 s52, s52, 1441792
    s_add_u32 s53, s52, 0
    buffer_load_dwordx2 v[32:33], v30, s[16:19], s53 offen offset:0 sc1
    buffer_load_dwordx2 v[34:35], v30, s[16:19], s53 offen offset:1536 sc1
    s_add_u32 s53, s52, 3072
    buffer_load_dwordx2 v[36:37], v30, s[16:19], s53 offen offset:0 sc1
    buffer_load_dwordx2 v[38:39], v30, s[16:19], s53 offen offset:1536 sc1
    s_add_u32 s53, s52, 6144
    buffer_load_dwordx2 v[40:41], v30, s[16:19], s53 offen offset:0 sc1
    buffer_load_dwordx2 v[42:43], v30, s[16:19], s53 offen offset:1536 sc1
    s_add_u32 s53, s52, 9216
    buffer_load_dwordx2 v[26:27], v30, s[16:19], s53 offen offset:0 sc1
    buffer_load_dwordx2 v[28:29], v30, s[16:19], s53 offen offset:1536 sc1
    s_waitcnt vmcnt(0)
    s_add_u32 s51, s51, 1
    s_sleep 2
    s_cmp_lt_u32 s51, 0x40000
    s_cbranch_scc1 QCP
    s_branch Y2W
Y2P:
    buffer_load_dword v22, v16, s[16:19], s55 offen offset:0 sc1
    buffer_load_dword v23, v16, s[16:19], s55 offen offset:128 sc1
    buffer_load_dword v24, v16, s[16:19], s55 offen offset:256 sc1
    buffer_load_dword v25, v16, s[16:19], s55 offen offset:384 sc1
    s_branch Y2W
AGY2P:
    s_add_u32 s51, s51, 1
    s_sleep 1
    s_cmp_lt_u32 s51, 0x40000
    s_cbranch_scc1 Y2P
    s_branch OKY2P
Q0L:
    v_and_b32 v21, 3, v1
    v_lshrrev_b32 v19, 4, v1
    v_bfe_u32 v20, v1, 2, 2
    v_lshlrev_b32 v21, 3, v21
    v_mul_u32_u24 v20, 384, v20
    v_add_u32 v21, v21, v20
    v_bfe_u32 v20, v1, 3, 2
    v_xor_b32 v20, s44, v20
    v_lshl_add_u32 v21, v20, 5, v21
    v_add_u32 v21, 65536, v21
    v_and_b32 v20, 1, v19
    v_mul_u32_u24 v19, 3072, v19
    v_mul_u32_u24 v20, 3072, v20
    v_add_u32 v19, v19, v21
    v_add_u32 v20, v20, v21
    s_branch QTR
HOOKA:
    s_mov_b64 exec, 0xffff
    s_nop 3
    s_lshl_b32 s52, s44, 6
    s_add_u32 s52, s52, 98816
    v_lshl_add_u32 v14, v1, 2, s52
    ds_write_b32 v14, v17 offset:10752
    v_fma_f32 v16, -v84, v17, v16
    v_mul_f32 v16, v16, v85
    ds_write_b32 v14, v16 offset:0
    ds_write_b32 v14, v21 offset:11008
    v_fma_f32 v20, -v84, v21, v20
    v_mul_f32 v20, v20, v85
    ds_write_b32 v14, v20 offset:256
    ds_write_b32 v14, v25 offset:11264
    v_fma_f32 v24, -v84, v25, v24
    v_mul_f32 v24, v24, v85
    ds_write_b32 v14, v24 offset:512
    s_mov_b64 exec, -1
    s_add_u32 s44, s44, 1
    s_cmp_lt_u32 s44, 4
    s_cbranch_scc1 Q0L
    s_mov_b32 s44, 3
    v_lshlrev_b32 v14, 2, v1
    v_add_u32 v14, 98816, v14
    ds_read2st64_b32 v[16:17], v14 offset0:0 offset1:1
    ds_read_b32 v18, v14 offset:512
    s_lshl_b32 s52, s47, 13
    s_lshl_b32 s54, s48, 10
    s_add_u32 s52, s52, s54
    s_add_u32 s52, s52, 1114112
    s_waitcnt lgkmcnt(0)
    v_bitop3_b32 v19, v16, v17, v18 bitop3:0x96
    v_xor_b32 v19, v19, v89
    buffer_store_dwordx4 v[16:19], v88, s[16:19], s52 offen sc1
    s_sleep 40
    v_and_b32 v15, 0xe1, v1
    v_lshlrev_b32 v15, 1, v15
    v_bfe_u32 v14, v1, 4, 1
    v_lshl_add_u32 v15, v14, 3, v15
    v_bfe_u32 v14, v1, 3, 1
    v_lshl_add_u32 v15, v14, 4, v15
    v_bfe_u32 v14, v1, 2, 1
    v_lshl_add_u32 v15, v14, 2, v15
    v_bfe_u32 v14, v1, 1, 1
    v_lshl_add_u32 v15, v14, 5, v15
    v_add_u32 v15, 98304, v15
    s_lshl_b32 s52, s47, 13
    s_add_u32 s52, s52, 1114112
    s_add_u32 s53, s52, 4096
    s_mov_b32 s51, 0
Q0P:
    buffer_load_dwordx4 v[16:19], v88, s[16:19], s52 offen offset:0 sc1
    buffer_load_dwordx4 v[20:23], v88, s[16:19], s52 offen offset:1024 sc1
    buffer_load_dwordx4 v[24:27], v88, s[16:19], s52 offen offset:2048 sc1
    buffer_load_dwordx4 v[28:31], v88, s[16:19], s52 offen offset:3072 sc1
    buffer_load_dwordx4 v[32:35], v88, s[16:19], s53 offen offset:0 sc1
    buffer_load_dwordx4 v[36:39], v88, s[16:19], s53 offen offset:1024 sc1
    buffer_load_dwordx4 v[40:43], v88, s[16:19], s53 offen offset:2048 sc1
    buffer_load_dwordx4 v[44:47], v88, s[16:19], s53 offen offset:3072 sc1
    v_mov_b32 v48, 0
    s_waitcnt vmcnt(0)
    v_bitop3_b32 v49, v16, v17, v18 bitop3:0x96
    v_bitop3_b32 v49, v49, v19, v89 bitop3:0x96
    v_or_b32 v48, v48, v49
    v_bitop3_b32 v49, v20, v21, v22 bitop3:0x96
    v_bitop3_b32 v49, v49, v23, v89 bitop3:0x96
    v_or_b32 v48, v48, v49
    v_bitop3_b32 v49, v24, v25, v26 bitop3:0x96
    v_bitop3_b32 v49, v49, v27, v89 bitop3:0x96
    v_or_b32 v48, v48, v49
    v_bitop3_b32 v49, v28, v29, v30 bitop3:0x96
    v_bitop3_b32 v49, v49, v31, v89 bitop3:0x96
    v_or_b32 v48, v48, v49
    v_bitop3_b32 v49, v32, v33, v34 bitop3:0x96
    v_bitop3_b32 v49, v49, v35, v89 bitop3:0x96
    v_or_b32 v48, v48, v49
    v_bitop3_b32 v49, v36, v37, v38 bitop3:0x96
    v_bitop3_b32 v49, v49, v39, v89 bitop3:0x96
    v_or_b32 v48, v48, v49
    v_bitop3_b32 v49, v40, v41, v42 bitop3:0x96
    v_bitop3_b32 v49, v49, v43, v89 bitop3:0x96
    v_or_b32 v48, v48, v49
    v_bitop3_b32 v49, v44, v45, v46 bitop3:0x96
    v_bitop3_b32 v49, v49, v47, v89 bitop3:0x96
    v_or_b32 v48, v48, v49
    v_cmp_ne_u32 vcc, 0, v48
    s_cbranch_vccz Q0OK
    s_add_u32 s51, s51, 1
    s_sleep 16
    s_cmp_lt_u32 s51, 0x40000
    s_cbranch_scc1 Q0P
Q0OK:
    v_pk_add_f32 v[16:17], v[16:17], v[20:21]
    v_add_f32 v18, v18, v22
    v_pk_add_f32 v[16:17], v[16:17], v[24:25]
    v_add_f32 v18, v18, v26
    v_pk_add_f32 v[16:17], v[16:17], v[28:29]
    v_add_f32 v18, v18, v30
    v_pk_add_f32 v[16:17], v[16:17], v[32:33]
    v_add_f32 v18, v18, v34
    v_pk_add_f32 v[16:17], v[16:17], v[36:37]
    v_add_f32 v18, v18, v38
    v_pk_add_f32 v[16:17], v[16:17], v[40:41]
    v_add_f32 v18, v18, v42
    v_pk_add_f32 v[16:17], v[16:17], v[44:45]
    v_add_f32 v18, v18, v46
    v_cvt_pk_bf16_f32 v16, v16, v17
    v_cvt_pk_bf16_f32 v18, v18, v18
    ds_write_b16 v15, v16
    ds_write_b16_d16_hi v15, v16 offset:128
    ds_write_b16 v15, v18 offset:256
    s_mov_b32 s51, 0
HSP:
    s_mov_b32 s52, 1376256
    buffer_load_dwordx4 v[24:27], v88, s[16:19], s52 offen sc1
    s_waitcnt vmcnt(0)
    v_xor_b32 v20, s5, v24
    v_xor_b32 v21, s5, v25
    v_xor_b32 v22, s5, v26
    v_xor_b32 v23, s5, v27
    v_or3_b32 v20, v20, v21, v22
    v_or_b32 v20, v20, v23
    v_cmp_lt_u32 vcc, 31, v20
    s_cbranch_vccz HSOK
    s_add_u32 s51, s51, 1
    s_sleep 8
    s_cmp_lt_u32 s51, 0x40000
    s_cbranch_scc1 HSP
HSOK:
    s_mov_b32 s53, 0
    v_and_b32 v24, 16, v24
    v_cmp_ne_u32 vcc, 0, v24
    s_bcnt1_i32_b64 s52, vcc
    s_add_u32 s53, s53, s52
    v_and_b32 v25, 16, v25
    v_cmp_ne_u32 vcc, 0, v25
    s_bcnt1_i32_b64 s52, vcc
    s_add_u32 s53, s53, s52
    v_and_b32 v26, 16, v26
    v_cmp_ne_u32 vcc, 0, v26
    s_bcnt1_i32_b64 s52, vcc
    s_add_u32 s53, s53, s52
    v_and_b32 v27, 16, v27
    v_cmp_ne_u32 vcc, 0, v27
    s_bcnt1_i32_b64 s52, vcc
    s_add_u32 s53, s53, s52
    v_and_b32 v20, 15, v20
    s_cmp_gt_u32 s53, 128
    s_cselect_b32 s53, 2, 0
    s_lshr_b32 s52, s5, 1
    s_xor_b32 s53, s53, s52
    s_and_b32 s53, s53, 2
    s_lshl_b32 s52, s45, 3
    v_cmp_ne_u32 vcc, 0, v20
    s_lshr_b64 s[60:61], vcc, s52
    s_and_b32 s52, s60, 0xff
    s_cselect_b32 s50, 0, 1
    v_mov_b32 v38, 98784
    s_or_b32 s53, s53, s50
    v_or_b32 v39, s53, v89
    ds_write_b32 v38, v39
    v_and_b32 v21, 0xffff0000, v86
    v_lshlrev_b32 v20, 16, v86
    buffer_store_dwordx2 v[20:21], v87, s[16:19], 0 offen sc1
    s_branch TABLES
EN3:
    v_mov_b64 v[72:73], 0
    v_mov_b64 v[74:75], 0
    v_mov_b64 v[76:77], 0
    v_mov_b64 v[78:79], 0
    v_mov_b64 v[40:41], 0
    v_mov_b64 v[42:43], 0
    v_mov_b64 v[44:45], 0
    v_mov_b64 v[46:47], 0
    v_mov_b64 v[48:49], 0
    v_mov_b64 v[50:51], 0
    s_branch ENOK2
ENTRY0:
    ds_read_b64 v[14:15], v12 offset:0
    ds_read_b64 v[60:61], v12 offset:8
    v_mov_b64 v[64:65], 0
    v_mov_b64 v[66:67], 0
    v_mov_b64 v[68:69], 0
    v_mov_b64 v[70:71], 0
    v_mov_b64 v[72:73], 0
    v_mov_b64 v[74:75], 0
    v_mov_b64 v[76:77], 0
    v_mov_b64 v[78:79], 0
    v_mov_b64 v[40:41], 0
    v_mov_b64 v[42:43], 0
    v_mov_b64 v[44:45], 0
    v_mov_b64 v[46:47], 0
    v_mov_b64 v[48:49], 0
    v_mov_b64 v[50:51], 0
    s_cmp_lg_u32 s44, 3
    s_cbranch_scc1 QFRAG
    s_waitcnt lgkmcnt(0)
    s_barrier
    s_waitcnt vmcnt(23)
    buffer_load_dwordx4 a[0:3], v80, s[8:11], s96 offen offset:0 nt
    s_waitcnt vmcnt(23)
    buffer_load_dwordx4 a[8:11], v80, s[8:11], s96 offen offset:128 nt
    s_waitcnt vmcnt(23)
    buffer_load_dwordx4 a[16:19], v80, s[8:11], s96 offen offset:256 nt
    s_add_u32 s96, s96, s97
    s_waitcnt vmcnt(23)
    buffer_load_dwordx4 a[4:7], v80, s[8:11], s96 offen offset:0 nt
    s_waitcnt vmcnt(23)
    buffer_load_dwordx4 a[12:15], v80, s[8:11], s96 offen offset:128 nt
    s_waitcnt vmcnt(23)
    buffer_load_dwordx4 a[20:23], v80, s[8:11], s96 offen offset:256 nt
    s_add_u32 s96, s96, s97
    s_waitcnt vmcnt(23)
    buffer_load_dwordx4 a[24:27], v80, s[8:11], s96 offen offset:0 nt
    s_waitcnt vmcnt(23)
    buffer_load_dwordx4 a[32:35], v80, s[8:11], s96 offen offset:128 nt
    s_waitcnt vmcnt(23)
    buffer_load_dwordx4 a[40:43], v80, s[8:11], s96 offen offset:256 nt
    s_add_u32 s96, s96, s97
    s_waitcnt vmcnt(23)
    buffer_load_dwordx4 a[28:31], v80, s[8:11], s96 offen offset:0 nt
    s_waitcnt vmcnt(23)
    buffer_load_dwordx4 a[36:39], v80, s[8:11], s96 offen offset:128 nt
    s_waitcnt vmcnt(23)
    buffer_load_dwordx4 a[44:47], v80, s[8:11], s96 offen offset:256 nt
    s_add_u32 s96, s96, s97
    s_waitcnt vmcnt(23)
    buffer_load_dwordx4 a[48:51], v80, s[8:11], s96 offen offset:0 nt
    s_waitcnt vmcnt(23)
    buffer_load_dwordx4 a[56:59], v80, s[8:11], s96 offen offset:128 nt
    s_waitcnt vmcnt(23)
    buffer_load_dwordx4 a[64:67], v80, s[8:11], s96 offen offset:256 nt
    s_add_u32 s96, s96, s97
    s_waitcnt vmcnt(23)
    buffer_load_dwordx4 a[52:55], v80, s[8:11], s96 offen offset:0 nt
    s_waitcnt vmcnt(23)
    buffer_load_dwordx4 a[60:63], v80, s[8:11], s96 offen offset:128 nt
    s_waitcnt vmcnt(23)
    buffer_load_dwordx4 a[68:71], v80, s[8:11], s96 offen offset:256 nt
    s_add_u32 s96, s96, s97
    s_waitcnt vmcnt(23)
    buffer_load_dwordx4 a[72:75], v80, s[8:11], s96 offen offset:0 nt
    s_waitcnt vmcnt(23)
    buffer_load_dwordx4 a[80:83], v80, s[8:11], s96 offen offset:128 nt
    s_waitcnt vmcnt(23)
    buffer_load_dwordx4 a[88:91], v80, s[8:11], s96 offen offset:256 nt
    s_add_u32 s96, s96, s97
    s_waitcnt vmcnt(23)
    buffer_load_dwordx4 a[76:79], v80, s[8:11], s96 offen offset:0 nt
    s_waitcnt vmcnt(23)
    buffer_load_dwordx4 a[84:87], v80, s[8:11], s96 offen offset:128 nt
    s_waitcnt vmcnt(23)
    buffer_load_dwordx4 a[92:95], v80, s[8:11], s96 offen offset:256 nt
    s_add_u32 s96, s96, s97
    s_waitcnt vmcnt(23)
    buffer_load_dwordx4 a[96:99], v80, s[8:11], s96 offen offset:0 nt
    s_waitcnt vmcnt(23)
    buffer_load_dwordx4 a[104:107], v80, s[8:11], s96 offen offset:128 nt
    s_waitcnt vmcnt(23)
    buffer_load_dwordx4 a[112:115], v80, s[8:11], s96 offen offset:256 nt
    s_add_u32 s96, s96, s97
    s_waitcnt vmcnt(23)
    buffer_load_dwordx4 a[100:103], v80, s[8:11], s96 offen offset:0 nt
    s_waitcnt vmcnt(23)
    buffer_load_dwordx4 a[108:111], v80, s[8:11], s96 offen offset:128 nt
    s_waitcnt vmcnt(23)
    buffer_load_dwordx4 a[116:119], v80, s[8:11], s96 offen offset:256 nt
    s_add_u32 s96, s96, s97
    s_waitcnt vmcnt(23)
    buffer_load_dwordx4 a[120:123], v80, s[8:11], s96 offen offset:0 nt
    s_waitcnt vmcnt(23)
    buffer_load_dwordx4 a[128:131], v80, s[8:11], s96 offen offset:128 nt
    s_waitcnt vmcnt(23)
    buffer_load_dwordx4 a[136:139], v80, s[8:11], s96 offen offset:256 nt
    s_add_u32 s96, s96, s97
    s_waitcnt vmcnt(23)
    buffer_load_dwordx4 a[124:127], v80, s[8:11], s96 offen offset:0 nt
    s_waitcnt vmcnt(23)
    buffer_load_dwordx4 a[132:135], v80, s[8:11], s96 offen offset:128 nt
    s_waitcnt vmcnt(23)
    buffer_load_dwordx4 a[140:143], v80, s[8:11], s96 offen offset:256 nt
    s_add_u32 s96, s96, s97
    s_waitcnt vmcnt(23)
    buffer_load_dwordx4 a[144:147], v80, s[8:11], s96 offen offset:0 nt
    s_waitcnt vmcnt(23)
    buffer_load_dwordx4 a[152:155], v80, s[8:11], s96 offen offset:128 nt
    s_waitcnt vmcnt(23)
    buffer_load_dwordx4 a[160:163], v80, s[8:11], s96 offen offset:256 nt
    s_add_u32 s96, s96, s97
    s_waitcnt vmcnt(23)
    buffer_load_dwordx4 a[148:151], v80, s[8:11], s96 offen offset:0 nt
    s_waitcnt vmcnt(23)
    buffer_load_dwordx4 a[156:159], v80, s[8:11], s96 offen offset:128 nt
    s_waitcnt vmcnt(23)
    buffer_load_dwordx4 a[164:167], v80, s[8:11], s96 offen offset:256 nt
    s_add_u32 s96, s96, s97
    s_waitcnt vmcnt(23)
    buffer_load_dwordx4 a[168:171], v80, s[8:11], s96 offen offset:0 nt
    s_waitcnt vmcnt(23)
    buffer_load_dwordx4 a[176:179], v80, s[8:11], s96 offen offset:128 nt
    s_waitcnt vmcnt(23)
    buffer_load_dwordx4 a[184:187], v80, s[8:11], s96 offen offset:256 nt
    s_add_u32 s96, s96, s97
    s_waitcnt vmcnt(23)
    buffer_load_dwordx4 a[172:175], v80, s[8:11], s96 offen offset:0 nt
    s_waitcnt vmcnt(23)
    buffer_load_dwordx4 a[180:183], v80, s[8:11], s96 offen offset:128 nt
    s_waitcnt vmcnt(23)
    buffer_load_dwordx4 a[188:191], v80, s[8:11], s96 offen offset:256 nt
    s_lshl_b32 s97, s97, 1
    s_waitcnt vmcnt(23)
    buffer_load_dwordx4 a[192:195], v82, s[12:15], s55 offen offset:0 nt
    s_waitcnt vmcnt(23)
    buffer_load_dwordx4 a[200:203], v82, s[12:15], s55 offen offset:128 nt
    s_waitcnt vmcnt(23)
    buffer_load_dwordx4 a[208:211], v82, s[12:15], s55 offen offset:256 nt
    s_waitcnt vmcnt(23)
    buffer_load_dwordx4 a[216:219], v82, s[12:15], s55 offen offset:384 nt
    s_waitcnt vmcnt(23)
    buffer_load_dwordx4 a[224:227], v82, s[12:15], s55 offen offset:512 nt
    s_waitcnt vmcnt(23)
    buffer_load_dwordx4 a[232:235], v82, s[12:15], s55 offen offset:640 nt
    s_add_u32 s55, s55, s97
    s_waitcnt vmcnt(23)
    buffer_load_dwordx4 a[196:199], v82, s[12:15], s55 offen offset:0 nt
    s_waitcnt vmcnt(23)
    buffer_load_dwordx4 a[204:207], v82, s[12:15], s55 offen offset:128 nt
    s_waitcnt vmcnt(23)
    buffer_load_dwordx4 a[212:215], v82, s[12:15], s55 offen offset:256 nt
    s_waitcnt vmcnt(23)
    buffer_load_dwordx4 a[220:223], v82, s[12:15], s55 offen offset:384 nt
    s_waitcnt vmcnt(23)
    buffer_load_dwordx4 a[228:231], v82, s[12:15], s55 offen offset:512 nt
    s_waitcnt vmcnt(23)
    buffer_load_dwordx4 a[236:239], v82, s[12:15], s55 offen offset:640 nt
    s_add_u32 s55, s55, s97
    s_waitcnt vmcnt(23)
    buffer_load_dwordx4 a[240:243], v82, s[12:15], s55 offen offset:0 nt
    s_waitcnt vmcnt(23)
    buffer_load_dwordx4 a[248:251], v82, s[12:15], s55 offen offset:128 nt
    s_waitcnt vmcnt(23)
    buffer_load_dwordx4 v[128:131], v82, s[12:15], s55 offen offset:256 nt
    s_waitcnt vmcnt(23)
    buffer_load_dwordx4 v[136:139], v82, s[12:15], s55 offen offset:384 nt
    s_waitcnt vmcnt(23)
    buffer_load_dwordx4 v[144:147], v82, s[12:15], s55 offen offset:512 nt
    s_waitcnt vmcnt(23)
    buffer_load_dwordx4 v[152:155], v82, s[12:15], s55 offen offset:640 nt
    s_add_u32 s55, s55, s97
    s_waitcnt vmcnt(23)
    buffer_load_dwordx4 a[244:247], v82, s[12:15], s55 offen offset:0 nt
    s_waitcnt vmcnt(23)
    buffer_load_dwordx4 a[252:255], v82, s[12:15], s55 offen offset:128 nt
    s_waitcnt vmcnt(23)
    buffer_load_dwordx4 v[132:135], v82, s[12:15], s55 offen offset:256 nt
    s_waitcnt vmcnt(23)
    buffer_load_dwordx4 v[140:143], v82, s[12:15], s55 offen offset:384 nt
    s_waitcnt vmcnt(23)
    buffer_load_dwordx4 v[148:151], v82, s[12:15], s55 offen offset:512 nt
    s_waitcnt vmcnt(23)
    buffer_load_dwordx4 v[156:159], v82, s[12:15], s55 offen offset:640 nt
    s_add_u32 s55, s55, s97
    s_waitcnt vmcnt(23)
    buffer_load_dwordx4 v[160:163], v82, s[12:15], s55 offen offset:0 nt
    s_waitcnt vmcnt(23)
    buffer_load_dwordx4 v[168:171], v82, s[12:15], s55 offen offset:128 nt
    s_waitcnt vmcnt(23)
    buffer_load_dwordx4 v[176:179], v82, s[12:15], s55 offen offset:256 nt
    s_waitcnt vmcnt(23)
    buffer_load_dwordx4 v[184:187], v82, s[12:15], s55 offen offset:384 nt
    s_waitcnt vmcnt(23)
    buffer_load_dwordx4 v[192:195], v82, s[12:15], s55 offen offset:512 nt
    s_waitcnt vmcnt(23)
    buffer_load_dwordx4 v[200:203], v82, s[12:15], s55 offen offset:640 nt
    s_add_u32 s55, s55, s97
    s_waitcnt vmcnt(23)
    buffer_load_dwordx4 v[164:167], v82, s[12:15], s55 offen offset:0 nt
    s_waitcnt vmcnt(23)
    buffer_load_dwordx4 v[172:175], v82, s[12:15], s55 offen offset:128 nt
    s_waitcnt vmcnt(23)
    buffer_load_dwordx4 v[180:183], v82, s[12:15], s55 offen offset:256 nt
    s_waitcnt vmcnt(23)
    buffer_load_dwordx4 v[188:191], v82, s[12:15], s55 offen offset:384 nt
    s_waitcnt vmcnt(23)
    buffer_load_dwordx4 v[196:199], v82, s[12:15], s55 offen offset:512 nt
    s_waitcnt vmcnt(23)
    buffer_load_dwordx4 v[204:207], v82, s[12:15], s55 offen offset:640 nt
    s_add_u32 s55, s55, s97
    s_waitcnt vmcnt(23)
    buffer_load_dwordx4 v[208:211], v82, s[12:15], s55 offen offset:0 nt
    s_waitcnt vmcnt(23)
    buffer_load_dwordx4 v[216:219], v82, s[12:15], s55 offen offset:128 nt
    s_waitcnt vmcnt(23)
    buffer_load_dwordx4 v[224:227], v82, s[12:15], s55 offen offset:256 nt
    s_waitcnt vmcnt(23)
    buffer_load_dwordx4 v[232:235], v82, s[12:15], s55 offen offset:384 nt
    s_waitcnt vmcnt(23)
    buffer_load_dwordx4 v[240:243], v82, s[12:15], s55 offen offset:512 nt
    s_waitcnt vmcnt(23)
    buffer_load_dwordx4 v[248:251], v82, s[12:15], s55 offen offset:640 nt
    s_add_u32 s55, s55, s97
    s_barrier
    s_waitcnt vmcnt(23)
    buffer_load_dwordx4 v[212:215], v82, s[12:15], s55 offen offset:0 nt
    s_waitcnt vmcnt(23)
    buffer_load_dwordx4 v[220:223], v82, s[12:15], s55 offen offset:128 nt
    s_waitcnt vmcnt(23)
    buffer_load_dwordx4 v[228:231], v82, s[12:15], s55 offen offset:256 nt
    s_waitcnt vmcnt(23)
    buffer_load_dwordx4 v[236:239], v82, s[12:15], s55 offen offset:384 nt
    s_waitcnt vmcnt(23)
    buffer_load_dwordx4 v[244:247], v82, s[12:15], s55 offen offset:512 nt
    s_waitcnt vmcnt(23)
    buffer_load_dwordx4 v[252:255], v82, s[12:15], s55 offen offset:640 nt
    s_branch QFRAG
HOOKF:
    v_mov_b32 v52, 98784
    ds_read_b32 v52, v52
    s_mov_b32 s6, 0
    s_waitcnt lgkmcnt(0)
    v_readfirstlane_b32 s101, v52
    s_and_b32 s50, s101, 1
    s_and_b32 s0, s101, 2
    s_lshl_b32 s0, s0, 12
    s_and_b32 s101, s101, 0xffffffe0
    s_cmp_lg_u32 s50, 0
    s_cselect_b32 s32, s62, 1610612736
    s_cselect_b32 s33, 1610612736, s62
    s_cmp_lg_u32 s50, 0
    s_cselect_b32 s34, s49, 1610612736
    s_cselect_b32 s35, 1610612736, s49
    s_add_u32 s99, s49, s0
    s_xor_b32 s1, s99, 8192
    s_waitcnt vmcnt(48)
    s_branch QK
AGENP:
    s_add_u32 s51, s51, 1
    s_cmp_lt_u32 s51, 0x40000
    s_cbranch_scc1 ENP
    s_branch OKENP
HOOKC:
    s_cmp_eq_u32 s44, 3
    s_cbranch_scc1 EXB
    s_cmp_eq_u32 s44, 1
    s_cbranch_scc1 WM1
    s_cmp_eq_u32 s44, 2
    s_cbranch_scc1 WM2
    v_min_u32 v83, 8, v1
    v_lshlrev_b32 v83, 7, v83
    s_mul_i32 s52, s45, 28160
    s_mul_i32 s54, s46, 1152
    s_add_u32 s52, s52, s54
    s_add_u32 s52, s52, 131072
    buffer_load_dword v83, v83, s[16:19], s52 offen sc1
    s_branch WM3
WM1:
    v_min_u32 v83, 11, v1
    v_lshlrev_b32 v83, 7, v83
    s_mul_i32 s52, s45, 45312
    s_mul_i32 s54, s46, 1536
    s_add_u32 s52, s52, s54
    s_add_u32 s52, s52, 529408
    buffer_load_dword v83, v83, s[16:19], s52 offen sc1
    s_branch WM3
WM2:
    v_min_u32 v83, 11, v1
    v_lshlrev_b32 v83, 7, v83
    s_mul_i32 s52, s45, 49152
    s_mul_i32 s54, s46, 1536
    s_add_u32 s52, s52, s54
    s_add_u32 s52, s52, 1441792
    buffer_load_dword v83, v83, s[16:19], s52 offen sc1
WM3:
    v_lshrrev_b32 v58, 3, v1
    v_and_b32 v57, 7, v1
    v_and_b32 v56, 2, v58
    v_xor_b32 v57, v57, v56
    s_and_b32 s52, s44, 1
    s_lshl_b32 s52, s52, 2
    v_xor_b32 v57, s52, v57
    v_mul_u32_u24 v56, 3072, v58
    v_lshl_add_u32 v56, v57, 4, v56
    v_lshrrev_b32 v58, 3, v1
    v_and_b32 v57, 7, v1
    v_and_b32 v55, 2, v58
    v_xor_b32 v57, v57, v55
    s_and_b32 s52, s44, 1
    s_lshl_b32 s52, s52, 2
    v_xor_b32 v57, s52, v57
    v_mul_u32_u24 v55, 1280, v58
    v_lshl_add_u32 v55, v57, 4, v55
    s_barrier
    s_cmp_ge_u32 s46, 20
    s_cbranch_scc1 HC8
    s_mul_i32 s52, s45, 983040
    s_mul_i32 s54, s56, 491520
    s_add_u32 s52, s52, s54
    s_lshl_b32 s54, s57, 7
    s_add_u32 s52, s52, s54
    s_mul_i32 s54, s44, 10240
    s_add_u32 s52, s52, s54
    s_lshl_b32 s53, s44, 10
DMA1:
    s_mov_b32 m0, s53
    s_add_u32 s53, s53, 3072
    buffer_load_dwordx4 v55, s[24:27], s52 offen nt lds
    v_xor_b32 v55, 64, v55
    s_add_u32 s52, s52, 30720
    s_cmp_lt_u32 s53, 49152
    s_cbranch_scc1 DMA1
HC8:
    s_cmp_ge_u32 s46, 30
    s_cbranch_scc1 HC7
    s_mul_i32 s52, s3, 393216
    s_mul_i32 s54, s45, 384
    s_add_u32 s52, s52, s54
    s_lshl_b32 s54, s59, 7
    s_add_u32 s52, s52, s54
    s_mul_i32 s54, s44, 24576
    s_add_u32 s52, s52, s54
    s_lshl_b32 s53, s44, 10
    s_add_u32 s53, s53, 49152
DMA2:
    s_mov_b32 m0, s53
    s_add_u32 s53, s53, 3072
    buffer_load_dwordx4 v56, s[28:31], s52 offen nt lds
    v_xor_b32 v56, 64, v56
    s_add_u32 s52, s52, 73728
    s_cmp_lt_u32 s53, 65536
    s_cbranch_scc1 DMA2
HC7:
    s_branch EXB
HOOKG:
    s_cmp_lg_u32 s49, 0
    s_cbranch_scc1 WOX
    s_cmp_ge_u32 s46, 20
    s_cbranch_scc1 HOOKG3
    v_and_b32 v72, 3, v1
    v_lshlrev_b32 v72, 3, v72
    v_bfe_u32 v73, v1, 2, 2
    v_lshl_add_u32 v72, v73, 7, v72
    v_lshrrev_b32 v73, 4, v1
    v_lshl_add_u32 v72, v73, 10, v72
    v_bfe_u32 v73, v1, 3, 2
    v_lshl_add_u32 v72, v73, 5, v72
    s_mul_i32 s52, s44, 12288
    v_add_u32 v72, s52, v72
    v_xor_b32 v73, 32, v72
    v_xor_b32 v74, 64, v72
    v_xor_b32 v75, 96, v72
    s_cmp_lg_u32 s44, 3
    s_cbranch_scc1 QCNA
    v_lshlrev_b32 v38, 2, v1
    v_add_u32 v39, 109568, v38
    v_lshlrev_b32 v38, 1, v38
    ds_read_b32 v32, v39 offset:0
    ds_read_b32 v34, v39 offset:256
    ds_read_b32 v36, v39 offset:512
    s_mul_i32 s52, s47, 12288
    s_mul_i32 s54, s48, 1536
    s_add_u32 s52, s52, s54
    s_add_u32 s52, s52, 1441792
    s_cmp_lg_u32 s50, 0
    s_cselect_b32 s53, s52, 1610612736
    s_cselect_b32 s54, 1610612736, s52
    s_waitcnt lgkmcnt(0)
    v_xor_b32 v33, s101, v32
    v_xor_b32 v35, s101, v34
    v_xor_b32 v37, s101, v36
    buffer_store_dwordx2 v[32:33], v38, s[16:19], s53 offen offset:0
    buffer_store_dwordx2 v[34:35], v38, s[16:19], s53 offen offset:512
    buffer_store_dwordx2 v[36:37], v38, s[16:19], s53 offen offset:1024
    s_cmp_eq_u32 s50, 0
    s_cbranch_scc1 SLOW4
PUBD4:
    s_branch QCMA
QCNA:
    s_waitcnt vmcnt(1)
QCMA:
    s_barrier
    buffer_load_dword v56, v65, s[16:19], s62 offen sc1
    buffer_load_dwordx4 v[44:47], v64, s[16:19], s62 offen offset:0 sc1
    buffer_load_dwordx4 v[48:51], v64, s[16:19], s62 offen offset:512 sc1
    buffer_load_dwordx4 v[52:55], v64, s[16:19], s62 offen offset:1024 sc1
    buffer_load_dword v57, v66, s[16:19], s49 offen sc1
    ds_read_b64_tr_b16 v[80:81], v72 offset:0
    ds_read_b64_tr_b16 v[82:83], v72 offset:512
    ds_read_b64_tr_b16 v[96:97], v72 offset:4096
    ds_read_b64_tr_b16 v[98:99], v72 offset:4608
    ds_read_b64_tr_b16 v[112:113], v72 offset:8192
    ds_read_b64_tr_b16 v[114:115], v72 offset:8704
    ds_read_b64_tr_b16 v[84:85], v73 offset:0
    ds_read_b64_tr_b16 v[86:87], v73 offset:512
    ds_read_b64_tr_b16 v[100:101], v73 offset:4096
    ds_read_b64_tr_b16 v[102:103], v73 offset:4608
    ds_read_b64_tr_b16 v[116:117], v73 offset:8192
    ds_read_b64_tr_b16 v[118:119], v73 offset:8704
    ds_read_b64_tr_b16 v[88:89], v74 offset:0
    ds_read_b64_tr_b16 v[90:91], v74 offset:512
    ds_read_b64_tr_b16 v[104:105], v74 offset:4096
    ds_read_b64_tr_b16 v[106:107], v74 offset:4608
    ds_read_b64_tr_b16 v[120:121], v74 offset:8192
    ds_read_b64_tr_b16 v[122:123], v74 offset:8704
    ds_read_b64_tr_b16 v[92:93], v75 offset:0
    ds_read_b64_tr_b16 v[94:95], v75 offset:512
    ds_read_b64_tr_b16 v[108:109], v75 offset:4096
    ds_read_b64_tr_b16 v[110:111], v75 offset:4608
    ds_read_b64_tr_b16 v[124:125], v75 offset:8192
    ds_read_b64_tr_b16 v[126:127], v75 offset:8704
    s_waitcnt lgkmcnt(0) vmcnt(0)
    s_branch WOC
HOOKG3:
    s_cmp_lg_u32 s44, 3
    s_cbranch_scc1 QCNB
    v_lshlrev_b32 v38, 2, v1
    v_add_u32 v39, 109568, v38
    v_lshlrev_b32 v38, 1, v38
    ds_read_b32 v32, v39 offset:0
    ds_read_b32 v34, v39 offset:256
    ds_read_b32 v36, v39 offset:512
    s_mul_i32 s52, s47, 12288
    s_mul_i32 s54, s48, 1536
    s_add_u32 s52, s52, s54
    s_add_u32 s52, s52, 1441792
    s_cmp_lg_u32 s50, 0
    s_cselect_b32 s53, s52, 1610612736
    s_cselect_b32 s54, 1610612736, s52
    s_waitcnt lgkmcnt(0)
    v_xor_b32 v33, s101, v32
    v_xor_b32 v35, s101, v34
    v_xor_b32 v37, s101, v36
    buffer_store_dwordx2 v[32:33], v38, s[16:19], s53 offen offset:0
    buffer_store_dwordx2 v[34:35], v38, s[16:19], s53 offen offset:512
    buffer_store_dwordx2 v[36:37], v38, s[16:19], s53 offen offset:1024
    s_cmp_eq_u32 s50, 0
    s_cbranch_scc1 SLOW5
PUBD5:
    s_branch QCMB
QCNB:
    s_waitcnt vmcnt(1)
QCMB:
    s_barrier
    s_cmp_lg_u32 s46, 31
    s_cbranch_scc1 EW1
    s_cmp_lg_u32 s44, 0
    s_cbranch_scc1 WOX
    v_and_b32 v32, 31, v1
    v_lshlrev_b32 v32, 2, v32
    v_add_u32 v32, 19968, v32
    s_lshl_b32 s52, s45, 7
    s_add_u32 s52, s52, 118784
    v_lshlrev_b32 v34, 13, v1
EWP:
    buffer_load_dword v33, v32, s[16:19], s62 offen sc1
    s_waitcnt vmcnt(0)
    v_cmp_u_f32 vcc, v33, v33
    s_cbranch_vccz EWOK
    s_add_u32 s51, s51, 1
    s_cmp_lt_u32 s51, 0x40000
    s_cbranch_scc1 EWP
EWOK:
    s_mov_b64 exec, 3
    buffer_store_dword v34, v34, s[16:19], s52 offen sc1
    s_mov_b64 exec, -1
EW1:
    s_cmp_ge_u32 s46, 30
    s_cbranch_scc1 WOX
    s_cmp_eq_u32 s44, 3
    s_cbranch_scc1 HD0
    v_lshrrev_b32 v33, 3, v1
    v_and_b32 v32, 7, v1
    v_and_b32 v34, 2, v33
    v_xor_b32 v32, v32, v34
    s_and_b32 s52, s44, 1
    s_lshl_b32 s52, s52, 2
    v_xor_b32 v32, s52, v32
    v_mul_u32_u24 v34, 1280, v33
    v_lshl_add_u32 v34, v32, 4, v34
    s_mul_i32 s52, s45, 245760
    s_lshl_b32 s54, s57, 7
    s_add_u32 s52, s52, s54
    s_mul_i32 s54, s44, 10240
    s_add_u32 s52, s52, s54
    s_lshl_b32 s53, s44, 10
DMA3:
    s_mov_b32 m0, s53
    s_add_u32 s53, s53, 3072
    buffer_load_dwordx4 v34, s[24:27], s52 offen nt lds
    v_xor_b32 v34, 64, v34
    s_add_u32 s52, s52, 30720
    s_cmp_lt_u32 s53, 24576
    s_cbranch_scc1 DMA3
HD0:
    v_mov_b64 v[116:117], -1
    v_mov_b64 v[118:119], -1
    v_mov_b32 v23, 1879048192
    s_mul_i32 s52, s57, 5120
    s_mul_i32 s54, s44, 1280
    s_add_u32 s52, s52, s54
    v_lshl_add_u32 v120, v1, 4, s52
    s_add_u32 s52, s52, 1024
    v_lshl_add_u32 v121, v1, 2, s52
    s_lshl_b32 s52, s57, 14
    s_lshl_b32 s54, s45, 11
    s_add_u32 s52, s52, s54
    s_lshl_b32 s54, s44, 9
    s_add_u32 s52, s52, s54
    v_lshl_add_u32 v122, v1, 3, s52
    v_cmp_gt_u32 vcc, 45312, v120
    s_nop 1
    v_cndmask_b32 v120, v23, v120, vcc
    v_cmp_gt_u32 vcc, 45312, v121
    s_nop 1
    v_cndmask_b32 v121, v23, v121, vcc
    v_cmp_gt_u32 vcc, 136192, v122
    s_nop 1
    v_cndmask_b32 v122, v23, v122, vcc
    s_branch F1E
AGWOP:
    s_add_u32 s51, s51, 1
    s_cmp_lt_u32 s51, 0x40000
    s_cbranch_scc1 WOP
    s_branch OKWOP
HOOKD:
    ds_read_b128 v[20:23], v2 offset:256
    ds_read_b128 v[24:27], v2 offset:320
    ds_read_b128 v[28:31], v2 offset:384
    ds_read_b128 v[32:35], v2 offset:448
    s_waitcnt lgkmcnt(0)
    v_mfma_f32_16x16x32_bf16 v[40:43], v[20:23], v[64:67], 0
    v_mfma_f32_16x16x32_bf16 v[40:43], v[24:27], v[68:71], v[40:43]
    v_mfma_f32_16x16x32_bf16 v[40:43], v[28:31], v[72:75], v[40:43]
    v_mfma_f32_16x16x32_bf16 v[40:43], v[32:35], v[76:79], v[40:43]
    s_add_u32 s52, s62, 8192
    s_cmp_lg_u32 s50, 0
    s_cselect_b32 s53, s52, 1610612736
    s_cselect_b32 s54, 1610612736, s52
    s_nop 3
    buffer_store_dword v41, v55, s[16:19], s53 offen offset:0
    s_cmp_eq_u32 s50, 0
    s_cbranch_scc1 SLOW6
PUBD6:
    v_and_b32 v16, 7, v1
    v_lshlrev_b32 v16, 7, v16
    s_add_u32 s52, s0, 118784
EWQ:
    buffer_load_dword v17, v16, s[16:19], s52 offen sc1
    s_waitcnt vmcnt(0)
    v_cmp_u_f32 vcc, v17, v17
    s_cbranch_vccz EWQK
    s_add_u32 s51, s51, 1
    s_sleep 1
    s_cmp_lt_u32 s51, 0x40000
    s_cbranch_scc1 EWQ
EWQK:
    s_sleep 1
    s_mov_b32 s51, 0
    s_cmp_lt_u32 s46, 20
    s_cbranch_scc1 F1W
    s_mov_b32 s100, 3
    s_cmp_lg_u32 s50, 0
    s_cselect_b32 s53, s63, 1610612736
    s_cselect_b32 s54, 1610612736, s63
    buffer_store_dwordx4 v[116:119], v120, s[16:19], s53 offen offset:0
    buffer_store_dword v116, v121, s[16:19], s53 offen offset:0
    s_cmp_eq_u32 s50, 0
    s_cbranch_scc1 SLOW7
PUBD7:
    s_mov_b32 s52, 393216
    buffer_store_dwordx2 v[116:117], v122, s[16:19], s52 offen sc1
    s_branch F1P
AGF1P:
    s_add_u32 s51, s51, 1
    s_sleep 1
    s_cmp_lt_u32 s51, 0x40000
    s_cbranch_scc1 F1P
    s_branch OKF1P
HOOKI:
    s_add_u32 s52, s62, 8192
    buffer_load_dwordx4 v[104:107], v58, s[16:19], s52 offen offset:0 sc1
    buffer_load_dwordx4 v[108:111], v58, s[16:19], s52 offen offset:3072 sc1
    buffer_load_dwordx2 v[112:113], v59, s[16:19], s52 offen sc1
    ds_read_b64_tr_b16 v[80:81], v57 offset:0
    ds_read_b64_tr_b16 v[82:83], v57 offset:512
    ds_read_b64_tr_b16 v[84:85], v57 offset:4096
    ds_read_b64_tr_b16 v[86:87], v57 offset:4608
    ds_read_b64_tr_b16 v[88:89], v57 offset:8192
    ds_read_b64_tr_b16 v[90:91], v57 offset:8704
    ds_read_b64_tr_b16 v[92:93], v57 offset:12288
    ds_read_b64_tr_b16 v[94:95], v57 offset:12800
    ds_read_b64_tr_b16 v[96:97], v57 offset:16384
    ds_read_b64_tr_b16 v[98:99], v57 offset:16896
    ds_read_b64_tr_b16 v[100:101], v57 offset:20480
    ds_read_b64_tr_b16 v[102:103], v57 offset:20992
    v_mov_b32 v44, v44
    v_mov_b32 v44, v44
    v_mov_b32 v44, v44
    v_mov_b32 v44, v44
    v_mov_b32 v44, v44
    v_mov_b32 v44, v44
    buffer_load_dwordx2 v[74:75], v60, s[16:19], s62 offen sc1
    buffer_load_dwordx4 v[64:67], v58, s[16:19], s62 offen offset:0 sc1
    buffer_load_dwordx4 v[68:71], v58, s[16:19], s62 offen offset:3072 sc1
    buffer_load_dwordx2 v[72:73], v59, s[16:19], s62 offen sc1
    buffer_load_dword v76, v61, s[16:19], s49 offen sc1
    v_mov_b32 v44, v44
    v_mov_b32 v44, v44
    v_mov_b32 v44, v44
    v_mov_b32 v44, v44
    v_mov_b32 v44, v44
    v_mov_b32 v44, v44
    v_mov_b32 v44, v44
    v_mov_b32 v44, v44
    v_mov_b32 v44, v44
    v_mov_b32 v44, v44
    v_mov_b32 v44, v44
    v_mov_b32 v44, v44
    v_mov_b32 v44, v44
    v_mov_b32 v44, v44
    v_mov_b32 v44, v44
    v_mov_b32 v44, v44
    s_waitcnt vmcnt(5)
GCC:
    v_pk_add_f32 v[114:115], v[104:105], v[106:107]
    v_pk_add_f32 v[116:117], v[108:109], v[110:111]
    v_add_f32 v126, v114, v115
    v_add_f32 v127, v116, v117
    v_pk_add_f32 v[126:127], v[126:127], v[112:113]
    v_cmp_u_f32 vcc, v126, v127
    s_cbranch_vccz W2P
    s_add_u32 s52, s62, 8192
    buffer_load_dwordx4 v[104:107], v58, s[16:19], s52 offen offset:0 sc1
    buffer_load_dwordx4 v[108:111], v58, s[16:19], s52 offen offset:3072 sc1
    buffer_load_dwordx2 v[112:113], v59, s[16:19], s52 offen sc1
    s_waitcnt vmcnt(0)
    s_add_u32 s51, s51, 1
    s_cmp_lt_u32 s51, 0x40000
    s_cbranch_scc1 GCC
    s_branch W2P
AGW2P:
    s_add_u32 s51, s51, 1
    s_cmp_lt_u32 s51, 0x40000
    s_cbranch_scc1 W2P
    s_branch OKW2P
AGY3P:
    s_add_u32 s51, s51, 1
    s_sleep 1
    s_cmp_lt_u32 s51, 0x40000
    s_cbranch_scc1 Y3P
    s_branch OKY3P
SLOW1:
    buffer_store_dword v30, v18, s[16:19], s35 offen offset:0 sc1
    s_branch PUBD1
SLOW2:
    buffer_store_dword v16, v14, s[16:19], s33 offen offset:0 sc1
    buffer_store_dword v20, v14, s[16:19], s33 offen offset:1024 sc1
    buffer_store_dword v24, v14, s[16:19], s33 offen offset:2048 sc1
    buffer_store_dwordx2 v[28:29], v15, s[16:19], s33 offen offset:0 sc1
    s_branch PUBD2
SLOW3:
    buffer_store_dword v24, v14, s[16:19], s33 offen offset:0 sc1
    s_branch PUBD3
SLOW4:
    buffer_store_dwordx2 v[32:33], v38, s[16:19], s54 offen offset:0 sc1
    buffer_store_dwordx2 v[34:35], v38, s[16:19], s54 offen offset:512 sc1
    buffer_store_dwordx2 v[36:37], v38, s[16:19], s54 offen offset:1024 sc1
    s_branch PUBD4
SLOW5:
    buffer_store_dwordx2 v[32:33], v38, s[16:19], s54 offen offset:0 sc1
    buffer_store_dwordx2 v[34:35], v38, s[16:19], s54 offen offset:512 sc1
    buffer_store_dwordx2 v[36:37], v38, s[16:19], s54 offen offset:1024 sc1
    s_branch PUBD5
SLOW6:
    buffer_store_dword v41, v55, s[16:19], s54 offen offset:0 sc1
    s_branch PUBD6
SLOW7:
    buffer_store_dwordx4 v[116:119], v120, s[16:19], s54 offen offset:0 sc1
    buffer_store_dword v116, v121, s[16:19], s54 offen offset:0 sc1
    s_branch PUBD7
SLOW8:
    buffer_store_dword v16, v54, s[16:19], s35 offen offset:0 sc1
    s_branch PUBD8
SLOW9:
    buffer_store_dword v40, v55, s[16:19], s33 offen offset:0 sc1
    buffer_store_dwordx2 v[36:37], v56, s[16:19], s33 offen offset:0 sc1
    s_branch PUBD9
CODEEND:
    s_endpgm
.section .rodata,"a"
.p2align 6
.amdhsa_kernel interleave_layers__sliding_block_cached__glu_gated_swiglu__decode_kernel
  .amdhsa_next_free_vgpr 512
  .amdhsa_next_free_sgpr 102
  .amdhsa_accum_offset 256
  .amdhsa_group_segment_fixed_size 0
  .amdhsa_kernarg_size 96
  .amdhsa_user_sgpr_count 2
  .amdhsa_user_sgpr_kernarg_segment_ptr 1
  .amdhsa_system_sgpr_workgroup_id_x 1
.end_amdhsa_kernel
```

```asm
; @launch grid=(256,1,1) block=(256,1,1) lds=143104
.amdgcn_target "amdgcn-amd-amdhsa--gfx950"
.text
.globl interleave_layers__sliding_block_cached__glu_gated_swiglu__decode_kernel
.p2align 8
.type interleave_layers__sliding_block_cached__glu_gated_swiglu__decode_kernel,@function
interleave_layers__sliding_block_cached__glu_gated_swiglu__decode_kernel:
    s_cmp_ge_u32 s2, 256
    s_cbranch_scc1 DONE
    s_load_dwordx16 s[64:79], s[0:1], 0
    s_load_dwordx8 s[80:87], s[0:1], 64
    s_memrealtime s[98:99]
    s_getpc_b64 s[60:61]
PCREF:
    v_lshlrev_b32 v14, 7, v0
    v_cmp_gt_u32 vcc, CODEEND-PCREF, v14
    v_mov_b32 v15, s61
    s_and_saveexec_b64 s[88:89], vcc
    s_cbranch_execz NOPF
    v_add_co_u32 v14, vcc, s60, v14
    s_nop 1
    v_addc_co_u32 v15, vcc, 0, v15, vcc
    global_load_dword v79, v[14:15], off
NOPF:
    s_mov_b64 exec, s[88:89]
    v_and_b32 v1, 63, v0
    v_lshrrev_b32 v13, 6, v0
    s_and_b32 s45, s2, 7
    v_readfirstlane_b32 s44, v13
    s_lshr_b32 s46, s2, 3
    s_lshr_b32 s7, s46, 3
    s_lshl_b32 s52, s45, 2
    s_add_u32 s47, s7, s52
    s_and_b32 s48, s46, 7
    v_lshrrev_b32 v19, 4, v1
    v_bfe_u32 v21, v1, 1, 3
    v_and_b32 v20, 1, v1
    v_mul_u32_u24 v80, 384, v21
    v_lshl_add_u32 v80, v20, 4, v80
    v_lshl_add_u32 v80, v19, 5, v80
    s_mul_i32 s52, s48, 3
    s_lshl_b32 s54, s44, 0
    s_add_u32 s52, s52, s54
    s_add_u32 s53, s48, 384
    s_cmp_eq_u32 s44, 3
    s_cselect_b32 s52, s53, s52
    s_cselect_b32 s97, 8, 24
    s_mulk_i32 s97, 3072
    s_mul_i32 s55, s47, 12582912
    s_mul_i32 s54, s52, 3072
    s_add_u32 s55, s55, s54
    s_add_u32 s55, s55, 11010048
    s_mov_b32 s96, s55
    s_waitcnt lgkmcnt(0)
    s_mov_b32 s8, s66
    s_and_b32 s9, s67, 0xffff
    s_mov_b32 s10, 402653184
    s_mov_b32 s11, 0x20000
    s_mov_b32 s6, 1
    s_mov_b32 s100, 0
    s_cmp_eq_u32 s44, 3
    s_cbranch_scc1 SETUP
    buffer_load_dwordx4 a[0:3], v80, s[8:11], s96 offen offset:0 nt
    buffer_load_dwordx4 a[8:11], v80, s[8:11], s96 offen offset:128 nt
    buffer_load_dwordx4 a[16:19], v80, s[8:11], s96 offen offset:256 nt
    s_add_u32 s96, s96, s97
    buffer_load_dwordx4 a[4:7], v80, s[8:11], s96 offen offset:0 nt
    buffer_load_dwordx4 a[12:15], v80, s[8:11], s96 offen offset:128 nt
    buffer_load_dwordx4 a[20:23], v80, s[8:11], s96 offen offset:256 nt
    s_add_u32 s96, s96, s97
SETUP:
    s_mov_b32 s16, s86
    s_and_b32 s17, s87, 0xffff
    s_mov_b32 s18, 1610612736
    s_mov_b32 s19, 0x20000
    s_mov_b32 s12, s68
    s_and_b32 s13, s69, 0xffff
    s_mov_b32 s14, 402653184
    s_mov_b32 s15, 0x20000
    s_mov_b32 s20, s70
    s_and_b32 s21, s71, 0xffff
    s_mov_b32 s22, 7864320
    s_mov_b32 s23, 0x20000
    s_mov_b32 s32, s64
    s_and_b32 s33, s65, 0xffff
    s_mov_b32 s34, 1280
    s_mov_b32 s35, 0x20000
    s_mov_b32 s36, s82
    s_and_b32 s37, s83, 0xffff
    s_mov_b32 s38, 1280
    s_mov_b32 s39, 0x20000
    s_mov_b32 s40, s84
    s_and_b32 s41, s85, 0xffff
    s_mov_b32 s42, 256
    s_mov_b32 s43, 0x20000
    v_mov_b32 v87, 1879048192
    v_mov_b32 v88, 1879048192
    v_mov_b32 v120, 1879048192
    v_mov_b32 v121, 1879048192
    v_mov_b32 v122, 1879048192
    s_cmp_lg_u32 s44, 3
    s_cbranch_scc1 SETUP2
    v_mov_b32 v32, -1
    v_mov_b32 v33, -1
    v_mov_b32 v34, -1
    v_mov_b32 v35, -1
    s_cmp_lg_u32 s2, 0
    s_cbranch_scc1 NONW
    s_or_b32 s101, s98, 0x20
    s_and_b32 s101, s101, 0xffffffe0
    v_mov_b32 v24, s101
    v_mov_b32 v25, 0
    s_mov_b64 exec, 1
    buffer_store_dword v24, v25, s[40:43], 0 offen sc1
    s_mov_b64 exec, -1
NONW:
    v_lshlrev_b32 v24, 4, v1
    v_lshlrev_b32 v27, 2, v1
    s_mul_i32 s52, s2, 1536
    v_lshlrev_b32 v28, 3, v1
    buffer_store_dwordx4 v[32:35], v24, s[16:19], s52 offen sc1
    buffer_store_dwordx2 v[32:33], v28, s[16:19], s52 offen offset:1024 sc1
    v_mov_b32 v26, 1879048192
    v_mov_b32 v88, v24
    v_cmp_gt_u32 vcc, 40, v1
    v_lshlrev_b32 v27, 2, v1
    buffer_load_dwordx4 v[44:47], v24, s[32:35], 0 offen
    buffer_load_dword v48, v27, s[32:35], 0 offen offset:1024
    v_cndmask_b32 v28, v26, v27, vcc
    s_mul_i32 s52, s48, 160
    buffer_load_dword v86, v28, s[32:35], s52 offen
    s_mul_i32 s52, s48, 320
    s_add_u32 s52, s52, 131072
    s_and_b32 s53, s2, 0xc7
    s_cmp_eq_u32 s53, 0
    s_cselect_b32 s52, s52, 1879048192
    v_lshl_add_u32 v87, v1, 3, s52
    v_cndmask_b32 v87, v26, v87, vcc
    v_add_u32 v24, 0, v1
    v_mul_u32_u24 v36, 171, v24
    v_lshrrev_b32 v36, 12, v36
    v_mul_u32_u24 v37, 24, v36
    v_sub_u32 v37, v24, v37
    v_and_b32 v24, 2, v36
    v_xor_b32 v37, v37, v24
    v_mul_u32_u24 v36, 12288, v36
    v_lshl_add_u32 v38, v37, 4, v36
    v_add_u32 v24, 64, v1
    v_mul_u32_u24 v36, 171, v24
    v_lshrrev_b32 v36, 12, v36
    v_mul_u32_u24 v37, 24, v36
    v_sub_u32 v37, v24, v37
    v_and_b32 v24, 2, v36
    v_xor_b32 v37, v37, v24
    v_mul_u32_u24 v36, 12288, v36
    v_lshl_add_u32 v39, v37, 4, v36
    v_add_u32 v24, 128, v1
    v_mul_u32_u24 v36, 171, v24
    v_lshrrev_b32 v36, 12, v36
    v_mul_u32_u24 v37, 24, v36
    v_sub_u32 v37, v24, v37
    v_and_b32 v24, 2, v36
    v_xor_b32 v37, v37, v24
    v_mul_u32_u24 v36, 12288, v36
    v_lshl_add_u32 v40, v37, 4, v36
    s_mul_i32 s52, s48, 983040
    s_mul_i32 s54, s47, 384
    s_add_u32 s52, s52, s54
    s_mov_b32 s53, 65536
WQL:
    s_add_u32 m0, s53, 0
    s_nop 0
    buffer_load_dwordx4 v38, s[20:23], s52 offen nt lds
    v_xor_b32 v38, 64, v38
    s_add_u32 m0, s53, 1024
    s_nop 0
    buffer_load_dwordx4 v39, s[20:23], s52 offen nt lds
    v_xor_b32 v39, 64, v39
    s_add_u32 m0, s53, 2048
    s_nop 0
    buffer_load_dwordx4 v40, s[20:23], s52 offen nt lds
    v_xor_b32 v40, 64, v40
    s_add_u32 s52, s52, 98304
    s_add_u32 s53, s53, 3072
    s_cmp_lt_u32 s53, 96256
    s_cbranch_scc1 WQL
    v_mov_b32 v37, 0
    buffer_load_dword v89, v37, s[40:43], 0 offen sc1
    s_barrier
    s_waitcnt vmcnt(31)
    v_mov_b32 v36, 0x3f803f80
    v_mov_b32 v37, v36
    v_cndmask_b32 v36, 0, v36, vcc
    v_add_u32 v27, 96256, v27
    ds_write_b32 v27, v36 offset:1152
    ds_write_b32 v27, v37 offset:1408
    ds_write_b32 v27, v86
    v_mov_b64 v[36:37], 0
    ds_write_b32 v27, v36 offset:12800
    ds_write_b32 v27, v36 offset:13056
    v_mov_b32 v38, 0x3f803f80
    v_dot2_f32_bf16 v36, v44, v44, v36
    v_dot2_f32_bf16 v37, v44, v38, v37
    v_dot2_f32_bf16 v36, v45, v45, v36
    v_dot2_f32_bf16 v37, v45, v38, v37
    v_dot2_f32_bf16 v36, v46, v46, v36
    v_dot2_f32_bf16 v37, v46, v38, v37
    v_dot2_f32_bf16 v36, v47, v47, v36
    v_dot2_f32_bf16 v37, v47, v38, v37
    v_dot2_f32_bf16 v36, v48, v48, v36
    v_dot2_f32_bf16 v37, v48, v38, v37
    s_nop 2
    v_add_f32_dpp v36, v36, v36 quad_perm:[1,0,3,2] row_mask:0xf bank_mask:0xf
    v_add_f32_dpp v37, v37, v37 quad_perm:[1,0,3,2] row_mask:0xf bank_mask:0xf
    s_nop 0
    v_add_f32_dpp v36, v36, v36 quad_perm:[2,3,0,1] row_mask:0xf bank_mask:0xf
    v_add_f32_dpp v37, v37, v37 quad_perm:[2,3,0,1] row_mask:0xf bank_mask:0xf
    s_nop 0
    v_add_f32_dpp v36, v36, v36 row_half_mirror row_mask:0xf bank_mask:0xf
    v_add_f32_dpp v37, v37, v37 row_half_mirror row_mask:0xf bank_mask:0xf
    s_nop 0
    v_add_f32_dpp v36, v36, v36 row_mirror row_mask:0xf bank_mask:0xf
    v_add_f32_dpp v37, v37, v37 row_mirror row_mask:0xf bank_mask:0xf
    s_nop 0
    v_mov_b32 v39, v36
    s_nop 1
    v_permlane16_swap_b32 v36, v39
    v_add_f32 v36, v36, v39
    v_mov_b32 v39, v37
    s_nop 1
    v_permlane16_swap_b32 v37, v39
    v_add_f32 v37, v37, v39
    v_mov_b32 v39, v36
    s_nop 1
    v_permlane32_swap_b32 v36, v39
    v_add_f32 v36, v36, v39
    v_mov_b32 v39, v37
    s_nop 1
    v_permlane32_swap_b32 v37, v39
    v_add_f32 v37, v37, v39
    v_mov_b32 v39, 0x3727c5ac
    v_mul_f32 v37, 0x3acccccd, v37
    v_fmamk_f32 v36, v36, 0x3acccccd, v39
    v_fma_f32 v36, -v37, v37, v36
    v_rsq_f32 v36, abs(v36)
    v_mov_b32 v84, v37
    v_mul_f32 v85, 0x3dd53b94, v36
SETUP2:
    s_cmp_ge_u32 s46, 10
    s_cselect_b32 s56, 1, 0
    s_cmp_ge_u32 s46, 20
    s_cselect_b32 s52, 2, s56
    s_mul_i32 s52, s52, 10
    s_sub_u32 s57, s46, s52
    s_min_u32 s4, s46, 29
    s_cmp_ge_u32 s4, 15
    s_cselect_b32 s58, 1, 0
    s_mul_i32 s52, s58, 15
    s_sub_u32 s52, s4, s52
    s_mul_i32 s59, s52, 52
    s_lshr_b32 s59, s59, 8
    s_mul_i32 s53, s59, 5
    s_sub_u32 s3, s52, s53
    s_cmp_ge_u32 s46, 20
    s_cselect_b32 s24, s80, s72
    s_cselect_b32 s25, s81, s73
    s_mov_b32 s26, 7864320
    s_cselect_b32 s26, 1966080, s26
    s_and_b32 s25, s25, 0xffff
    s_mov_b32 s27, 0x20000
    s_cmp_eq_u32 s58, 1
    s_cselect_b32 s28, s78, s76
    s_cselect_b32 s29, s79, s77
    s_and_b32 s29, s29, 0xffff
    s_mov_b32 s30, 1966080
    s_mov_b32 s31, 0x20000
    s_mov_b32 s49, 0
    s_mul_i32 s63, s45, 45312
    s_add_u32 s63, s63, 529408
    s_mul_i32 s62, s45, 28160
    s_add_u32 s62, s62, 136192
    s_mov_b32 s50, 0
    s_mov_b32 s0, 0
    v_and_b32 v24, 15, v1
    v_cmp_eq_u32 vcc, 1, v24
    v_mov_b32 v25, 96256
    v_mov_b32 v26, 97408
    v_cndmask_b32 v2, v25, v26, vcc
    v_lshl_add_u32 v2, v19, 4, v2
    v_and_b32 v24, 3, v1
    v_lshlrev_b32 v24, 4, v24
    v_and_b32 v25, 1, v19
    v_lshl_add_u32 v24, v25, 6, v24
    v_add_u32 v24, 98304, v24
    v_bfe_u32 v25, v1, 2, 2
    v_lshrrev_b32 v27, 5, v1
    v_sub_u32 v25, v25, v27
    v_mov_b32 v26, 109184
    v_cmp_eq_u32 vcc, 0, v25
    s_nop 1
    v_cndmask_b32 v3, v26, v24, vcc
    v_cmp_eq_u32 vcc, 2, v25
    s_nop 1
    v_cndmask_b32 v4, v26, v24, vcc
    v_and_b32 v24, 3, v1
    v_cmp_eq_u32 vcc, 3, v24
    v_mov_b32 v25, 0xffff
    v_mov_b32 v26, 0xffff0000
    v_cndmask_b32 v25, v25, v26, vcc
    v_cndmask_b32 v24, v24, 0, vcc
    v_or_b32 v24, 12, v24
    v_mul_u32_u24 v24, 0x1111, v24
    v_bfe_u32 v26, v1, 1, 1
    v_mul_u32_u24 v26, 0xaaaa, v26
    v_add_u32 v26, 0x4444, v26
    v_lshl_add_u32 v7, v24, 16, v26
    v_and_b32 v24, 4, v1
    v_cmp_eq_u32 vcc, 0, v24
    s_nop 1
    v_cndmask_b32 v5, 0, v25, vcc
    v_cndmask_b32 v6, v25, 0, vcc
    v_mul_u32_u24 v82, s97, v27
    v_bfe_u32 v24, v1, 3, 1
    v_mul_u32_u24 v24, 1536, v24
    v_add_u32 v82, v82, v24
    v_and_b32 v24, 1, v19
    v_mul_u32_u24 v24, 768, v24
    v_add_u32 v82, v82, v24
    v_and_b32 v24, 7, v1
    v_lshl_add_u32 v82, v24, 4, v82
    s_mul_i32 s52, s7, 6144
    s_add_u32 s52, s52, 20480
    v_lshl_add_u32 v8, v0, 4, s52
    s_lshl_b32 s52, s7, 6
    s_add_u32 s52, s52, 45056
    v_lshl_add_u32 v9, v24, 3, s52
    v_bfe_u32 v25, v1, 3, 1
    v_lshl_add_u32 v9, v25, 2, v9
    v_and_b32 v10, 0xe1, v0
    v_lshlrev_b32 v10, 1, v10
    v_bfe_u32 v24, v0, 4, 1
    v_lshl_add_u32 v10, v24, 3, v10
    v_bfe_u32 v24, v0, 3, 1
    v_lshl_add_u32 v10, v24, 4, v10
    v_bfe_u32 v24, v0, 2, 1
    v_lshl_add_u32 v10, v24, 2, v10
    v_bfe_u32 v24, v0, 1, 1
    v_lshl_add_u32 v10, v24, 5, v10
    v_add_u32 v10, 98304, v10
    v_mov_b32 v11, 0x3acccccd
    v_lshlrev_b32 v12, 4, v0
    v_add_u32 v12, 110336, v12
    s_cmp_lg_u32 s44, 3
    s_cbranch_scc1 KBAR
    s_lshr_b32 s53, s2, 4
    s_and_b32 s51, s2, 15
    s_lshl_b32 s52, s53, 14
    s_lshl_b32 s54, s51, 9
    s_add_u32 s52, s52, s54
    s_add_u32 s52, s52, 1835008
    s_and_b32 s53, s46, 1
    s_lshl_b32 s53, s53, 13
    s_add_u32 s52, s52, s53
    s_xor_b32 s53, s52, 8192
    s_memtime s[88:89]
    s_waitcnt lgkmcnt(0)
    s_buffer_load_dword s1, s[16:19], s52
    s_waitcnt lgkmcnt(0)
    s_memtime s[90:91]
    s_waitcnt lgkmcnt(0)
    s_buffer_load_dword s1, s[16:19], s53
    s_waitcnt lgkmcnt(0)
    s_memtime s[92:93]
    s_waitcnt lgkmcnt(0)
    s_sub_u32 s88, s90, s88
    s_sub_u32 s90, s92, s90
    s_cmp_lt_u32 s90, s88
    s_cselect_b32 s1, 1, 0
    s_xor_b32 s1, s1, s46
    s_getreg_b32 s52, hwreg(HW_REG_XCC_ID)
    s_lshr_b32 s52, s52, 2
    s_xor_b32 s1, s1, s52
    s_and_b32 s1, s1, 1
    s_lshl_b32 s1, s1, 4
    s_mov_b32 s51, 0
    v_mov_b32 v37, 0
NOP:
    s_waitcnt vmcnt(0)
    v_readfirstlane_b32 s5, v89
    s_cmp_lg_u32 s5, 0
    s_cbranch_scc1 NOOK
    buffer_load_dword v89, v37, s[40:43], 0 offen sc1
    s_add_u32 s51, s51, 1
    s_sleep 4
    s_cmp_lt_u32 s51, 0x40000
    s_cbranch_scc1 NOP
NOOK:
    s_getreg_b32 s52, hwreg(HW_REG_XCC_ID)
    s_and_b32 s52, s52, 15
    s_or_b32 s5, s5, s52
    s_or_b32 s1, s1, s5
    v_mov_b32 v36, s1
    s_lshl_b32 s52, s45, 7
    s_lshl_b32 s54, s46, 2
    s_add_u32 s52, s52, s54
    s_add_u32 s52, s52, 1376256
    s_mov_b64 exec, 1
    buffer_store_dword v36, v37, s[16:19], s52 offen sc1
    s_mov_b64 exec, -1
    s_mov_b32 s44, 0
    s_branch Q0L
KBAR:
    s_barrier
    s_waitcnt vmcnt(7)
    buffer_load_dwordx4 a[24:27], v80, s[8:11], s96 offen offset:0 nt
    s_waitcnt vmcnt(7)
    buffer_load_dwordx4 a[32:35], v80, s[8:11], s96 offen offset:128 nt
    s_waitcnt vmcnt(7)
    buffer_load_dwordx4 a[40:43], v80, s[8:11], s96 offen offset:256 nt
    s_add_u32 s96, s96, s97
    s_waitcnt vmcnt(7)
    buffer_load_dwordx4 a[28:31], v80, s[8:11], s96 offen offset:0 nt
    s_waitcnt vmcnt(7)
    buffer_load_dwordx4 a[36:39], v80, s[8:11], s96 offen offset:128 nt
    s_waitcnt vmcnt(7)
    buffer_load_dwordx4 a[44:47], v80, s[8:11], s96 offen offset:256 nt
    s_add_u32 s96, s96, s97
    s_waitcnt vmcnt(7)
    buffer_load_dwordx4 a[48:51], v80, s[8:11], s96 offen offset:0 nt
    s_waitcnt vmcnt(7)
    buffer_load_dwordx4 a[56:59], v80, s[8:11], s96 offen offset:128 nt
    s_waitcnt vmcnt(7)
    buffer_load_dwordx4 a[64:67], v80, s[8:11], s96 offen offset:256 nt
    s_add_u32 s96, s96, s97
    s_waitcnt vmcnt(7)
    buffer_load_dwordx4 a[52:55], v80, s[8:11], s96 offen offset:0 nt
    s_waitcnt vmcnt(7)
    buffer_load_dwordx4 a[60:63], v80, s[8:11], s96 offen offset:128 nt
    s_waitcnt vmcnt(7)
    buffer_load_dwordx4 a[68:71], v80, s[8:11], s96 offen offset:256 nt
    s_add_u32 s96, s96, s97
    s_waitcnt vmcnt(7)
    buffer_load_dwordx4 a[72:75], v80, s[8:11], s96 offen offset:0 nt
    s_waitcnt vmcnt(7)
    buffer_load_dwordx4 a[80:83], v80, s[8:11], s96 offen offset:128 nt
    s_waitcnt vmcnt(7)
    buffer_load_dwordx4 a[88:91], v80, s[8:11], s96 offen offset:256 nt
    s_add_u32 s96, s96, s97
    s_waitcnt vmcnt(7)
    buffer_load_dwordx4 a[76:79], v80, s[8:11], s96 offen offset:0 nt
    s_waitcnt vmcnt(7)
    buffer_load_dwordx4 a[84:87], v80, s[8:11], s96 offen offset:128 nt
    s_waitcnt vmcnt(7)
    buffer_load_dwordx4 a[92:95], v80, s[8:11], s96 offen offset:256 nt
    s_add_u32 s96, s96, s97
    s_waitcnt vmcnt(7)
    buffer_load_dwordx4 a[96:99], v80, s[8:11], s96 offen offset:0 nt
    s_waitcnt vmcnt(7)
    buffer_load_dwordx4 a[104:107], v80, s[8:11], s96 offen offset:128 nt
    s_waitcnt vmcnt(7)
    buffer_load_dwordx4 a[112:115], v80, s[8:11], s96 offen offset:256 nt
    s_add_u32 s96, s96, s97
    s_waitcnt vmcnt(7)
    buffer_load_dwordx4 a[100:103], v80, s[8:11], s96 offen offset:0 nt
    s_waitcnt vmcnt(7)
    buffer_load_dwordx4 a[108:111], v80, s[8:11], s96 offen offset:128 nt
    s_waitcnt vmcnt(7)
    buffer_load_dwordx4 a[116:119], v80, s[8:11], s96 offen offset:256 nt
    s_add_u32 s96, s96, s97
    s_waitcnt vmcnt(7)
    buffer_load_dwordx4 a[120:123], v80, s[8:11], s96 offen offset:0 nt
    s_waitcnt vmcnt(7)
    buffer_load_dwordx4 a[128:131], v80, s[8:11], s96 offen offset:128 nt
    s_waitcnt vmcnt(7)
    buffer_load_dwordx4 a[136:139], v80, s[8:11], s96 offen offset:256 nt
    s_add_u32 s96, s96, s97
    s_waitcnt vmcnt(7)
    buffer_load_dwordx4 a[124:127], v80, s[8:11], s96 offen offset:0 nt
    s_waitcnt vmcnt(7)
    buffer_load_dwordx4 a[132:135], v80, s[8:11], s96 offen offset:128 nt
    s_waitcnt vmcnt(7)
    buffer_load_dwordx4 a[140:143], v80, s[8:11], s96 offen offset:256 nt
    s_add_u32 s96, s96, s97
    s_waitcnt vmcnt(7)
    buffer_load_dwordx4 a[144:147], v80, s[8:11], s96 offen offset:0 nt
    s_waitcnt vmcnt(7)
    buffer_load_dwordx4 a[152:155], v80, s[8:11], s96 offen offset:128 nt
    s_waitcnt vmcnt(7)
    buffer_load_dwordx4 a[160:163], v80, s[8:11], s96 offen offset:256 nt
    s_add_u32 s96, s96, s97
    s_waitcnt vmcnt(7)
    buffer_load_dwordx4 a[148:151], v80, s[8:11], s96 offen offset:0 nt
    s_waitcnt vmcnt(7)
    buffer_load_dwordx4 a[156:159], v80, s[8:11], s96 offen offset:128 nt
    s_waitcnt vmcnt(7)
    buffer_load_dwordx4 a[164:167], v80, s[8:11], s96 offen offset:256 nt
    s_add_u32 s96, s96, s97
    s_waitcnt vmcnt(7)
    buffer_load_dwordx4 a[168:171], v80, s[8:11], s96 offen offset:0 nt
    s_waitcnt vmcnt(7)
    buffer_load_dwordx4 a[176:179], v80, s[8:11], s96 offen offset:128 nt
    s_waitcnt vmcnt(7)
    buffer_load_dwordx4 a[184:187], v80, s[8:11], s96 offen offset:256 nt
    s_add_u32 s96, s96, s97
    s_waitcnt vmcnt(7)
    buffer_load_dwordx4 a[172:175], v80, s[8:11], s96 offen offset:0 nt
    s_waitcnt vmcnt(7)
    buffer_load_dwordx4 a[180:183], v80, s[8:11], s96 offen offset:128 nt
    s_waitcnt vmcnt(7)
    buffer_load_dwordx4 a[188:191], v80, s[8:11], s96 offen offset:256 nt
    s_lshl_b32 s97, s97, 1
    s_waitcnt vmcnt(7)
    buffer_load_dwordx4 a[192:195], v82, s[12:15], s55 offen offset:0 nt
    s_waitcnt vmcnt(7)
    buffer_load_dwordx4 a[200:203], v82, s[12:15], s55 offen offset:128 nt
    s_waitcnt vmcnt(7)
    buffer_load_dwordx4 a[208:211], v82, s[12:15], s55 offen offset:256 nt
    s_waitcnt vmcnt(7)
    buffer_load_dwordx4 a[216:219], v82, s[12:15], s55 offen offset:384 nt
    s_waitcnt vmcnt(7)
    buffer_load_dwordx4 a[224:227], v82, s[12:15], s55 offen offset:512 nt
    s_waitcnt vmcnt(7)
    buffer_load_dwordx4 a[232:235], v82, s[12:15], s55 offen offset:640 nt
    s_add_u32 s55, s55, s97
    s_waitcnt vmcnt(7)
    buffer_load_dwordx4 a[196:199], v82, s[12:15], s55 offen offset:0 nt
    s_waitcnt vmcnt(7)
    buffer_load_dwordx4 a[204:207], v82, s[12:15], s55 offen offset:128 nt
    s_waitcnt vmcnt(7)
    buffer_load_dwordx4 a[212:215], v82, s[12:15], s55 offen offset:256 nt
    s_waitcnt vmcnt(7)
    buffer_load_dwordx4 a[220:223], v82, s[12:15], s55 offen offset:384 nt
    s_waitcnt vmcnt(7)
    buffer_load_dwordx4 a[228:231], v82, s[12:15], s55 offen offset:512 nt
    s_waitcnt vmcnt(7)
    buffer_load_dwordx4 a[236:239], v82, s[12:15], s55 offen offset:640 nt
    s_add_u32 s55, s55, s97
    s_waitcnt vmcnt(7)
    buffer_load_dwordx4 a[240:243], v82, s[12:15], s55 offen offset:0 nt
    s_waitcnt vmcnt(7)
    buffer_load_dwordx4 a[248:251], v82, s[12:15], s55 offen offset:128 nt
    s_waitcnt vmcnt(7)
    buffer_load_dwordx4 v[128:131], v82, s[12:15], s55 offen offset:256 nt
    s_waitcnt vmcnt(7)
    buffer_load_dwordx4 v[136:139], v82, s[12:15], s55 offen offset:384 nt
    s_waitcnt vmcnt(7)
    buffer_load_dwordx4 v[144:147], v82, s[12:15], s55 offen offset:512 nt
    s_waitcnt vmcnt(7)
    buffer_load_dwordx4 v[152:155], v82, s[12:15], s55 offen offset:640 nt
    s_add_u32 s55, s55, s97
    s_waitcnt vmcnt(7)
    buffer_load_dwordx4 a[244:247], v82, s[12:15], s55 offen offset:0 nt
    s_waitcnt vmcnt(7)
    buffer_load_dwordx4 a[252:255], v82, s[12:15], s55 offen offset:128 nt
    s_waitcnt vmcnt(7)
    buffer_load_dwordx4 v[132:135], v82, s[12:15], s55 offen offset:256 nt
    s_waitcnt vmcnt(7)
    buffer_load_dwordx4 v[140:143], v82, s[12:15], s55 offen offset:384 nt
    s_waitcnt vmcnt(7)
    buffer_load_dwordx4 v[148:151], v82, s[12:15], s55 offen offset:512 nt
    s_waitcnt vmcnt(7)
    buffer_load_dwordx4 v[156:159], v82, s[12:15], s55 offen offset:640 nt
    s_add_u32 s55, s55, s97
    s_waitcnt vmcnt(7)
    buffer_load_dwordx4 v[160:163], v82, s[12:15], s55 offen offset:0 nt
    s_waitcnt vmcnt(7)
    buffer_load_dwordx4 v[168:171], v82, s[12:15], s55 offen offset:128 nt
    s_waitcnt vmcnt(7)
    buffer_load_dwordx4 v[176:179], v82, s[12:15], s55 offen offset:256 nt
    s_waitcnt vmcnt(7)
    buffer_load_dwordx4 v[184:187], v82, s[12:15], s55 offen offset:384 nt
    s_waitcnt vmcnt(7)
    buffer_load_dwordx4 v[192:195], v82, s[12:15], s55 offen offset:512 nt
    s_waitcnt vmcnt(7)
    buffer_load_dwordx4 v[200:203], v82, s[12:15], s55 offen offset:640 nt
    s_add_u32 s55, s55, s97
    s_waitcnt vmcnt(7)
    buffer_load_dwordx4 v[164:167], v82, s[12:15], s55 offen offset:0 nt
    s_waitcnt vmcnt(7)
    buffer_load_dwordx4 v[172:175], v82, s[12:15], s55 offen offset:128 nt
    s_waitcnt vmcnt(7)
    buffer_load_dwordx4 v[180:183], v82, s[12:15], s55 offen offset:256 nt
    s_waitcnt vmcnt(7)
    buffer_load_dwordx4 v[188:191], v82, s[12:15], s55 offen offset:384 nt
    s_waitcnt vmcnt(7)
    buffer_load_dwordx4 v[196:199], v82, s[12:15], s55 offen offset:512 nt
    s_waitcnt vmcnt(7)
    buffer_load_dwordx4 v[204:207], v82, s[12:15], s55 offen offset:640 nt
    s_add_u32 s55, s55, s97
    s_waitcnt vmcnt(7)
    buffer_load_dwordx4 v[208:211], v82, s[12:15], s55 offen offset:0 nt
    s_waitcnt vmcnt(7)
    buffer_load_dwordx4 v[216:219], v82, s[12:15], s55 offen offset:128 nt
    s_waitcnt vmcnt(7)
    buffer_load_dwordx4 v[224:227], v82, s[12:15], s55 offen offset:256 nt
    s_waitcnt vmcnt(7)
    buffer_load_dwordx4 v[232:235], v82, s[12:15], s55 offen offset:384 nt
    s_waitcnt vmcnt(7)
    buffer_load_dwordx4 v[240:243], v82, s[12:15], s55 offen offset:512 nt
    s_waitcnt vmcnt(7)
    buffer_load_dwordx4 v[248:251], v82, s[12:15], s55 offen offset:640 nt
    s_add_u32 s55, s55, s97
    s_waitcnt vmcnt(7)
    buffer_load_dwordx4 v[212:215], v82, s[12:15], s55 offen offset:0 nt
    s_waitcnt vmcnt(7)
    buffer_load_dwordx4 v[220:223], v82, s[12:15], s55 offen offset:128 nt
    s_waitcnt vmcnt(7)
    buffer_load_dwordx4 v[228:231], v82, s[12:15], s55 offen offset:256 nt
    s_barrier
    s_waitcnt vmcnt(7)
    buffer_load_dwordx4 v[236:239], v82, s[12:15], s55 offen offset:384 nt
    s_waitcnt vmcnt(7)
    buffer_load_dwordx4 v[244:247], v82, s[12:15], s55 offen offset:512 nt
    s_waitcnt vmcnt(7)
    buffer_load_dwordx4 v[252:255], v82, s[12:15], s55 offen offset:640 nt
    s_branch TABLES
LOOP:
    ds_read_b128 v[14:17], v12 offset:24576
    ds_read_b128 v[18:21], v12 offset:28672
    s_mov_b32 s55, s99
    s_mov_b32 s51, 0
    s_cmp_lg_u32 s49, 0
    s_cbranch_scc1 FINAL
    s_waitcnt lgkmcnt(0)
QTR:
    ds_read_b64_tr_b16 v[44:45], v19 offset:0
    ds_read_b64_tr_b16 v[46:47], v19 offset:1536
    ds_read_b64_tr_b16 v[56:57], v19 offset:128
    ds_read_b64_tr_b16 v[58:59], v19 offset:1664
    ds_read_b64_tr_b16 v[68:69], v19 offset:256
    ds_read_b64_tr_b16 v[70:71], v19 offset:1792
    ds_read_b64_tr_b16 v[48:49], v19 offset:12288
    ds_read_b64_tr_b16 v[50:51], v19 offset:13824
    ds_read_b64_tr_b16 v[60:61], v19 offset:12416
    ds_read_b64_tr_b16 v[62:63], v19 offset:13952
    ds_read_b64_tr_b16 v[72:73], v19 offset:12544
    ds_read_b64_tr_b16 v[74:75], v19 offset:14080
    ds_read_b64_tr_b16 v[52:53], v20 offset:24576
    ds_read_b64_tr_b16 v[54:55], v20 offset:26112
    ds_read_b64_tr_b16 v[64:65], v20 offset:24704
    ds_read_b64_tr_b16 v[66:67], v20 offset:26240
    ds_read_b64_tr_b16 v[76:77], v20 offset:24832
    ds_read_b64_tr_b16 v[78:79], v20 offset:26368
    s_cmp_lg_u32 s6, 0
    s_cbranch_scc1 QA0
    s_mov_b32 s96, s62
    s_mov_b32 s49, 393216
    s_mov_b32 s62, s63
    s_cmp_lg_u32 s50, 0
    s_cselect_b32 s32, s62, 1610612736
    s_cselect_b32 s33, 1610612736, s62
    s_cmp_lg_u32 s50, 0
    s_cselect_b32 s34, s49, 1610612736
    s_cselect_b32 s35, 1610612736, s49
    s_add_u32 s99, s49, s0
    s_xor_b32 s1, s99, 8192
    s_cmp_eq_u32 s44, 3
    s_cbranch_scc1 QX
    s_sub_u32 s52, s46, 20
    s_cmp_ge_u32 s52, 10
    s_cbranch_scc1 HOOKL
    v_lshlrev_b32 v30, 3, v0
    s_mul_i32 s52, s47, 12288
    s_add_u32 s52, s52, 1441792
    s_add_u32 s53, s52, 0
    buffer_load_dwordx2 v[32:33], v30, s[16:19], s53 offen offset:0 sc1
    buffer_load_dwordx2 v[34:35], v30, s[16:19], s53 offen offset:1536 sc1
    s_add_u32 s53, s52, 3072
    buffer_load_dwordx2 v[36:37], v30, s[16:19], s53 offen offset:0 sc1
    buffer_load_dwordx2 v[38:39], v30, s[16:19], s53 offen offset:1536 sc1
    s_add_u32 s53, s52, 6144
    buffer_load_dwordx2 v[40:41], v30, s[16:19], s53 offen offset:0 sc1
    buffer_load_dwordx2 v[42:43], v30, s[16:19], s53 offen offset:1536 sc1
    s_add_u32 s53, s52, 9216
    buffer_load_dwordx2 v[26:27], v30, s[16:19], s53 offen offset:0 sc1
    buffer_load_dwordx2 v[28:29], v30, s[16:19], s53 offen offset:1536 sc1
    s_sleep 5
GYB:
    buffer_load_dword v22, v16, s[16:19], s55 offen offset:0 sc1
    buffer_load_dword v23, v16, s[16:19], s55 offen offset:128 sc1
    buffer_load_dword v24, v16, s[16:19], s55 offen offset:256 sc1
    buffer_load_dword v25, v16, s[16:19], s55 offen offset:384 sc1
    s_waitcnt vmcnt(4)
QCP:
    v_bitop3_b32 v33, v32, v33, s101 bitop3:0x96
    v_bitop3_b32 v35, v34, v35, s101 bitop3:0x96
    v_bitop3_b32 v37, v36, v37, s101 bitop3:0x96
    v_bitop3_b32 v39, v38, v39, s101 bitop3:0x96
    v_bitop3_b32 v41, v40, v41, s101 bitop3:0x96
    v_bitop3_b32 v43, v42, v43, s101 bitop3:0x96
    v_bitop3_b32 v27, v26, v27, s101 bitop3:0x96
    v_bitop3_b32 v29, v28, v29, s101 bitop3:0x96
    v_add_f32 v13, v32, v34
    v_add_f32 v13, v13, v36
    v_add_f32 v13, v13, v38
    v_add_f32 v13, v13, v40
    v_add_f32 v13, v13, v42
    v_add_f32 v13, v13, v26
    v_add_f32 v13, v13, v28
    v_or3_b32 v33, v33, v35, v37
    v_or3_b32 v33, v33, v39, v41
    v_or3_b32 v33, v33, v43, v27
    v_or_b32 v33, v33, v29
    v_cmp_ne_u32 vcc, 0, v33
    s_cbranch_vccnz QCA
Y2W:
    s_waitcnt vmcnt(0)
    v_pk_add_f32 v[22:23], v[22:23], v[24:25]
    v_add_f32 v30, v22, v23
    v_mov_b32 v31, v30
    s_nop 1
    v_permlane32_swap_b32 v30, v31
    v_add_f32 v30, v30, v31
    v_cmp_u_f32 vcc, v30, v30
    v_cvt_pk_bf16_f32 v30, v30, v30
    ds_write_b16 v17, v30
    s_cbranch_vccnz AGY2P
OKY2P:
    v_and_b32 v30, 0xffff0000, v30
    buffer_store_dword v30, v18, s[16:19], s34 offen offset:0
    s_cmp_eq_u32 s50, 0
    s_cbranch_scc1 SLOW1
PUBD1:
QX:
    s_waitcnt lgkmcnt(0)
    s_barrier
QA0:
    ds_read_b128 v[32:35], v2 offset:0
    ds_read_b128 v[36:39], v2 offset:64
    ds_read_b128 v[40:43], v2 offset:128
    s_cmp_lg_u32 s6, 0
    s_waitcnt lgkmcnt(2)
    v_mfma_f32_16x16x32_bf16 v[28:31], v[32:35], v[32:35], 0
    v_mfma_f32_16x16x32_bf16 v[16:19], v[32:35], v[44:47], 0
    v_mfma_f32_16x16x32_bf16 v[20:23], v[32:35], v[56:59], 0
    v_mfma_f32_16x16x32_bf16 v[24:27], v[32:35], v[68:71], 0
    s_waitcnt lgkmcnt(1)
    v_mfma_f32_16x16x32_bf16 v[28:31], v[36:39], v[36:39], v[28:31]
    v_mfma_f32_16x16x32_bf16 v[16:19], v[36:39], v[48:51], v[16:19]
    v_mfma_f32_16x16x32_bf16 v[20:23], v[36:39], v[60:63], v[20:23]
    v_mfma_f32_16x16x32_bf16 v[24:27], v[36:39], v[72:75], v[24:27]
    s_waitcnt lgkmcnt(0)
    v_mfma_f32_16x16x32_bf16 v[16:19], v[40:43], v[52:55], v[16:19]
    v_mfma_f32_16x16x32_bf16 v[20:23], v[40:43], v[64:67], v[20:23]
    v_mfma_f32_16x16x32_bf16 v[24:27], v[40:43], v[76:79], v[24:27]
    v_mfma_f32_16x16x32_bf16 v[28:31], v[40:43], v[40:43], v[28:31]
    s_cbranch_scc1 HOOKA
    v_mov_b64 v[64:65], 0
    v_mov_b64 v[66:67], 0
    v_mov_b64 v[68:69], 0
    v_mov_b64 v[70:71], 0
    buffer_store_dword v16, v14, s[16:19], s32 offen offset:0
    buffer_store_dword v20, v14, s[16:19], s32 offen offset:1024
    buffer_store_dword v24, v14, s[16:19], s32 offen offset:2048
    buffer_store_dwordx2 v[28:29], v15, s[16:19], s32 offen offset:0
    s_cmp_eq_u32 s50, 0
    s_cbranch_scc1 SLOW2
PUBD2:
    ds_read_b64 v[14:15], v12 offset:0
    ds_read_b64 v[60:61], v12 offset:8
    s_cmp_eq_u32 s44, 3
    s_cbranch_scc1 EN3
    v_mov_b32 v36, v36
    v_mov_b32 v36, v36
    v_mov_b32 v36, v36
    v_mov_b32 v36, v36
    v_mov_b32 v36, v36
    v_mov_b32 v36, v36
    v_mov_b32 v36, v36
    v_mov_b32 v36, v36
    v_mov_b32 v36, v36
    v_mov_b32 v36, v36
    v_mov_b32 v36, v36
    v_mov_b32 v36, v36
    v_mov_b32 v36, v36
    v_mov_b32 v36, v36
    v_mov_b32 v36, v36
    v_mov_b32 v36, v36
    v_mov_b32 v36, v36
    v_mov_b32 v36, v36
    v_mov_b32 v36, v36
    v_mov_b32 v36, v36
    v_mov_b32 v36, v36
    v_mov_b32 v36, v36
    v_mov_b32 v36, v36
    v_mov_b32 v36, v36
    v_mov_b32 v36, v36
    v_mov_b32 v36, v36
    v_mov_b32 v36, v36
    v_mov_b32 v36, v36
    v_mov_b32 v36, v36
    v_mov_b32 v36, v36
    v_mov_b32 v36, v36
    v_mov_b32 v36, v36
    buffer_load_dword v62, v9, s[16:19], s62 offen sc1
    buffer_load_dwordx4 v[52:55], v8, s[16:19], s62 offen offset:0 sc1
    buffer_load_dwordx4 v[56:59], v8, s[16:19], s62 offen offset:3072 sc1
    v_mov_b64 v[72:73], 0
    v_mov_b64 v[74:75], 0
    v_mov_b64 v[76:77], 0
    v_mov_b64 v[78:79], 0
    v_mov_b64 v[40:41], 0
    v_mov_b64 v[42:43], 0
    v_mov_b64 v[44:45], 0
    v_mov_b64 v[46:47], 0
    v_mov_b64 v[48:49], 0
    v_mov_b64 v[50:51], 0
    s_mov_b32 s51, 0
    v_mov_b32 v37, 0x3c75e03e
    v_mov_b32 v38, 0x3a71d1e6
    v_mov_b32 v39, 0x3e13985d
    v_mul_f32 v13, 0x3dd53b95, v13
    v_mov_b32 v36, v36
    v_mov_b32 v36, v36
    v_mov_b32 v36, v36
    v_mov_b32 v36, v36
    v_mov_b32 v36, v36
    v_mov_b32 v36, v36
ENP:
    buffer_load_dword v62, v9, s[16:19], s62 offen sc1
    buffer_load_dwordx4 v[52:55], v8, s[16:19], s62 offen offset:0 sc1
    buffer_load_dwordx4 v[56:59], v8, s[16:19], s62 offen offset:3072 sc1
    s_waitcnt vmcnt(3)
    v_add_f32_dpp v32, v62, v62 quad_perm:[1,0,3,2] row_mask:0xf bank_mask:0xf
    v_pk_add_f32 v[16:17], v[52:53], v[54:55]
    v_pk_add_f32 v[20:21], v[56:57], v[58:59]
    v_add_f32_dpp v32, v32, v32 quad_perm:[2,3,0,1] row_mask:0xf bank_mask:0xf
    v_pk_add_f32 v[16:17], v[16:17], v[20:21]
    v_mov_b32 v34, v38
    v_add_f32_dpp v32, v32, v32 row_half_mirror row_mask:0xf bank_mask:0xf
    v_add_f32 v16, v16, v17
    s_nop 0
    v_mul_f32_dpp v33, v32, v37 row_newbcast:8 row_mask:0xf bank_mask:0xf
    v_fmac_f32_dpp v34, v32, v39 row_newbcast:0 row_mask:0xf bank_mask:0xf
    v_fma_f32 v34, -v33, v33, v34
    v_rsq_f32 v34, abs(v34)
    v_fma_f32 v16, -v33, v13, v16
    v_mul_f32 v16, v16, v34
    v_cvt_pk_bf16_f32 v17, v16, v16
    ds_write_b16 v10, v17
    v_cmp_u_f32 vcc, v16, v16
    s_cbranch_vccnz AGENP
OKENP:
ENOK2:
    s_waitcnt lgkmcnt(0)
    s_barrier
QFRAG:
    ds_read_b128 v[16:19], v3 offset:0
    ds_read_b128 v[20:23], v3 offset:128
    ds_read_b128 v[24:27], v3 offset:256
    ds_read_b128 v[28:31], v4 offset:0
    ds_read_b128 v[32:35], v4 offset:128
    ds_read_b128 v[36:39], v4 offset:256
    s_cmp_eq_u32 s49, 0
    s_cbranch_scc1 HOOKF
    s_waitcnt vmcnt(0)
QK:
    s_waitcnt lgkmcnt(5)
    v_smfmac_f32_16x16x64_bf16 v[64:67], v[16:19], a[0:7], v7
    s_waitcnt lgkmcnt(4)
    v_smfmac_f32_16x16x64_bf16 v[64:67], v[20:23], a[8:15], v7
    s_waitcnt lgkmcnt(3)
    v_smfmac_f32_16x16x64_bf16 v[64:67], v[24:27], a[16:23], v7
    s_waitcnt lgkmcnt(2)
    v_smfmac_f32_16x16x64_bf16 v[64:67], v[28:31], a[24:31], v7
    s_waitcnt lgkmcnt(1)
    v_smfmac_f32_16x16x64_bf16 v[64:67], v[32:35], a[32:39], v7
    s_waitcnt lgkmcnt(0)
    v_smfmac_f32_16x16x64_bf16 v[64:67], v[36:39], a[40:47], v7
    v_smfmac_f32_16x16x64_bf16 v[68:71], v[16:19], a[48:55], v7
    v_smfmac_f32_16x16x64_bf16 v[68:71], v[20:23], a[56:63], v7
    v_smfmac_f32_16x16x64_bf16 v[68:71], v[24:27], a[64:71], v7
    v_smfmac_f32_16x16x64_bf16 v[68:71], v[28:31], a[72:79], v7
    v_smfmac_f32_16x16x64_bf16 v[68:71], v[32:35], a[80:87], v7
    v_smfmac_f32_16x16x64_bf16 v[68:71], v[36:39], a[88:95], v7
    v_smfmac_f32_16x16x64_bf16 v[72:75], v[16:19], a[96:103], v7
    v_smfmac_f32_16x16x64_bf16 v[72:75], v[20:23], a[104:111], v7
    v_smfmac_f32_16x16x64_bf16 v[72:75], v[24:27], a[112:119], v7
    v_pk_add_f32 v[64:65], v[64:65], v[66:67]
    v_smfmac_f32_16x16x64_bf16 v[72:75], v[28:31], a[120:127], v7
    v_smfmac_f32_16x16x64_bf16 v[72:75], v[32:35], a[128:135], v7
    v_add_f32_dpp v52, v65, v64 quad_perm:[1,1,3,3] row_mask:0xf bank_mask:0xf
    v_smfmac_f32_16x16x64_bf16 v[72:75], v[36:39], a[136:143], v7
    v_smfmac_f32_16x16x64_bf16 v[76:79], v[16:19], a[144:151], v7
    v_smfmac_f32_16x16x64_bf16 v[76:79], v[20:23], a[152:159], v7
    v_smfmac_f32_16x16x64_bf16 v[76:79], v[24:27], a[160:167], v7
    v_pk_add_f32 v[68:69], v[68:69], v[70:71]
    v_smfmac_f32_16x16x64_bf16 v[76:79], v[28:31], a[168:175], v7
    v_smfmac_f32_16x16x64_bf16 v[76:79], v[32:35], a[176:183], v7
    v_add_f32_dpp v53, v69, v68 quad_perm:[1,1,3,3] row_mask:0xf bank_mask:0xf
    v_smfmac_f32_16x16x64_bf16 v[76:79], v[36:39], a[184:191], v7
    v_pk_add_f32 v[72:73], v[72:73], v[74:75]
    v_max_f32 v62, v52, v53
    s_nop 0
    v_add_f32_dpp v54, v73, v72 quad_perm:[1,1,3,3] row_mask:0xf bank_mask:0xf
    v_mov_b32 v63, v63
    v_mov_b32 v63, v63
    v_mov_b32 v63, v63
    v_mov_b32 v63, v63
    v_pk_add_f32 v[76:77], v[76:77], v[78:79]
    s_nop 1
    v_add_f32_dpp v55, v77, v76 quad_perm:[1,1,3,3] row_mask:0xf bank_mask:0xf
    v_max3_f32 v62, v62, v54, v55
    s_nop 1
    v_max_f32_dpp v62, v62, v62 quad_perm:[2,3,0,1] row_mask:0xf bank_mask:0xf
    s_nop 1
    v_max_f32_dpp v62, v62, v62 row_ror:4 row_mask:0xf bank_mask:0xf
    s_nop 1
    v_max_f32_dpp v62, v62, v62 row_ror:8 row_mask:0xf bank_mask:0xf
    v_mov_b32 v63, v62
    s_nop 1
    v_permlane16_swap_b32 v62, v63
    v_max_f32 v62, v62, v63
    v_mov_b32 v63, v62
    s_nop 1
    v_permlane32_swap_b32 v62, v63
    v_max_f32 v62, v62, v63
    v_pk_add_f32 v[52:53], v[52:53], v[62:63] op_sel_hi:[1,0] neg_lo:[0,1] neg_hi:[0,1]
    v_exp_f32 v52, v52
    v_pk_add_f32 v[54:55], v[54:55], v[62:63] op_sel_hi:[1,0] neg_lo:[0,1] neg_hi:[0,1]
    v_cvt_pk_bf16_f32 v56, v52, v52
    v_exp_f32 v53, v53
    v_exp_f32 v54, v54
    v_and_b32_dpp v16, v56, v5 quad_perm:[0,0,0,0] row_mask:0xf bank_mask:0xf
    v_and_b32_dpp v19, v56, v6 quad_perm:[0,0,0,0] row_mask:0xf bank_mask:0xf
    v_exp_f32 v55, v55
    v_mov_b32_dpp v17, v16 row_shr:4 row_mask:0xf bank_mask:0xf bound_ctrl:0
    v_mov_b32_dpp v18, v19 row_shl:4 row_mask:0xf bank_mask:0xf bound_ctrl:0
    v_cvt_pk_bf16_f32 v57, v53, v53
    s_waitcnt vmcnt(36)
    v_smfmac_f32_16x16x64_bf16 v[40:43], v[16:19], a[192:199], v7 abid:1
    ds_read_b128 v[64:67], v12 offset:4096
    v_and_b32_dpp v20, v56, v5 quad_perm:[2,2,2,2] row_mask:0xf bank_mask:0xf
    v_and_b32_dpp v23, v56, v6 quad_perm:[2,2,2,2] row_mask:0xf bank_mask:0xf
    v_smfmac_f32_16x16x64_bf16 v[44:47], v[16:19], a[200:207], v7 abid:1
    v_mov_b32_dpp v21, v20 row_shr:4 row_mask:0xf bank_mask:0xf bound_ctrl:0
    v_mov_b32_dpp v22, v23 row_shl:4 row_mask:0xf bank_mask:0xf bound_ctrl:0
    v_cvt_pk_bf16_f32 v58, v54, v54
    v_pk_add_f32 v[24:25], v[52:53], v[54:55]
    v_smfmac_f32_16x16x64_bf16 v[48:51], v[16:19], a[208:215], v7 abid:1
    v_smfmac_f32_16x16x64_bf16 v[40:43], v[20:23], a[216:223], v7 abid:1
    ds_read_b128 v[68:71], v12 offset:8192
    v_and_b32_dpp v16, v57, v5 quad_perm:[0,0,0,0] row_mask:0xf bank_mask:0xf
    v_and_b32_dpp v19, v57, v6 quad_perm:[0,0,0,0] row_mask:0xf bank_mask:0xf
    v_smfmac_f32_16x16x64_bf16 v[44:47], v[20:23], a[224:231], v7 abid:1
    v_mov_b32_dpp v17, v16 row_shr:4 row_mask:0xf bank_mask:0xf bound_ctrl:0
    v_mov_b32_dpp v18, v19 row_shl:4 row_mask:0xf bank_mask:0xf bound_ctrl:0
    v_cvt_pk_bf16_f32 v59, v55, v55
    v_add_f32 v63, v24, v25
    v_smfmac_f32_16x16x64_bf16 v[48:51], v[20:23], a[232:239], v7 abid:1
    s_waitcnt vmcnt(24)
    v_smfmac_f32_16x16x64_bf16 v[40:43], v[16:19], a[240:247], v7 abid:1
    v_and_b32_dpp v20, v57, v5 quad_perm:[2,2,2,2] row_mask:0xf bank_mask:0xf
    v_and_b32_dpp v23, v57, v6 quad_perm:[2,2,2,2] row_mask:0xf bank_mask:0xf
    v_smfmac_f32_16x16x64_bf16 v[44:47], v[16:19], a[248:255], v7 abid:1
    v_mov_b32_dpp v21, v20 row_shr:4 row_mask:0xf bank_mask:0xf bound_ctrl:0
    v_mov_b32_dpp v22, v23 row_shl:4 row_mask:0xf bank_mask:0xf bound_ctrl:0
    v_add_f32_dpp v63, v63, v63 quad_perm:[2,3,0,1] row_mask:0xf bank_mask:0xf
    v_smfmac_f32_16x16x64_bf16 v[48:51], v[16:19], v[128:135], v7 abid:1
    v_smfmac_f32_16x16x64_bf16 v[40:43], v[20:23], v[136:143], v7 abid:1
    v_add_f32_dpp v63, v63, v63 row_ror:4 row_mask:0xf bank_mask:0xf
    v_and_b32_dpp v16, v58, v5 quad_perm:[0,0,0,0] row_mask:0xf bank_mask:0xf
    v_and_b32_dpp v19, v58, v6 quad_perm:[0,0,0,0] row_mask:0xf bank_mask:0xf
    v_smfmac_f32_16x16x64_bf16 v[44:47], v[20:23], v[144:151], v7 abid:1
    v_mov_b32_dpp v17, v16 row_shr:4 row_mask:0xf bank_mask:0xf bound_ctrl:0
    v_mov_b32_dpp v18, v19 row_shl:4 row_mask:0xf bank_mask:0xf bound_ctrl:0
    v_add_f32_dpp v63, v63, v63 row_ror:8 row_mask:0xf bank_mask:0xf
    v_mov_b32 v24, v63
    v_smfmac_f32_16x16x64_bf16 v[48:51], v[20:23], v[152:159], v7 abid:1
    s_waitcnt vmcnt(12)
    v_smfmac_f32_16x16x64_bf16 v[40:43], v[16:19], v[160:167], v7 abid:1
    v_permlane16_swap_b32 v63, v24
    v_add_f32 v63, v63, v24
    v_and_b32_dpp v20, v58, v5 quad_perm:[2,2,2,2] row_mask:0xf bank_mask:0xf
    v_and_b32_dpp v23, v58, v6 quad_perm:[2,2,2,2] row_mask:0xf bank_mask:0xf
    v_smfmac_f32_16x16x64_bf16 v[44:47], v[16:19], v[168:175], v7 abid:1
    v_mov_b32_dpp v21, v20 row_shr:4 row_mask:0xf bank_mask:0xf bound_ctrl:0
    v_mov_b32_dpp v22, v23 row_shl:4 row_mask:0xf bank_mask:0xf bound_ctrl:0
    v_mov_b32 v24, v63
    v_smfmac_f32_16x16x64_bf16 v[48:51], v[16:19], v[176:183], v7 abid:1
    v_smfmac_f32_16x16x64_bf16 v[40:43], v[20:23], v[184:191], v7 abid:1
    v_permlane32_swap_b32 v63, v24
    v_add_f32 v63, v63, v24
    v_and_b32_dpp v16, v59, v5 quad_perm:[0,0,0,0] row_mask:0xf bank_mask:0xf
    v_and_b32_dpp v19, v59, v6 quad_perm:[0,0,0,0] row_mask:0xf bank_mask:0xf
    v_smfmac_f32_16x16x64_bf16 v[44:47], v[20:23], v[192:199], v7 abid:1
    v_mov_b32_dpp v17, v16 row_shr:4 row_mask:0xf bank_mask:0xf bound_ctrl:0
    v_mov_b32_dpp v18, v19 row_shl:4 row_mask:0xf bank_mask:0xf bound_ctrl:0
    s_waitcnt lgkmcnt(0)
    ds_write2_b32 v71, v62, v63 offset0:0 offset1:4
    v_smfmac_f32_16x16x64_bf16 v[48:51], v[20:23], v[200:207], v7 abid:1
    s_waitcnt vmcnt(0)
    v_smfmac_f32_16x16x64_bf16 v[40:43], v[16:19], v[208:215], v7 abid:1
    v_and_b32_dpp v20, v59, v5 quad_perm:[2,2,2,2] row_mask:0xf bank_mask:0xf
    v_and_b32_dpp v23, v59, v6 quad_perm:[2,2,2,2] row_mask:0xf bank_mask:0xf
    v_smfmac_f32_16x16x64_bf16 v[44:47], v[16:19], v[216:223], v7 abid:1
    v_mov_b32_dpp v21, v20 row_shr:4 row_mask:0xf bank_mask:0xf bound_ctrl:0
    v_mov_b32_dpp v22, v23 row_shl:4 row_mask:0xf bank_mask:0xf bound_ctrl:0
    s_mov_b32 vcc_lo, 0x00ff00ff
    v_smfmac_f32_16x16x64_bf16 v[48:51], v[16:19], v[224:231], v7 abid:1
    v_smfmac_f32_16x16x64_bf16 v[40:43], v[20:23], v[232:239], v7 abid:1
    v_smfmac_f32_16x16x64_bf16 v[44:47], v[20:23], v[240:247], v7 abid:1
    v_smfmac_f32_16x16x64_bf16 v[48:51], v[20:23], v[248:255], v7 abid:1
    s_mov_b32 vcc_hi, 0xff00ff00
    v_cmp_eq_u32 s[60:61], 24, v1
    v_mov_b32 v24, v24
    v_mov_b32 v24, v24
    v_mov_b32 v24, v24
    v_mov_b32 v24, v24
    v_mov_b32 v24, v24
    v_cndmask_b32_dpp v40, v44, v40, vcc row_ror:8 row_mask:0xf bank_mask:0xf
    v_cndmask_b32_dpp v41, v45, v41, vcc row_ror:8 row_mask:0xf bank_mask:0xf
    v_cndmask_b32_dpp v42, v46, v42, vcc row_ror:8 row_mask:0xf bank_mask:0xf
    v_cndmask_b32_dpp v43, v47, v43, vcc row_ror:8 row_mask:0xf bank_mask:0xf
    ds_write_b128 v15, v[40:43]
    v_cndmask_b32_dpp v48, v50, v48, vcc row_ror:8 row_mask:0xf bank_mask:0xf
    v_cndmask_b32_dpp v49, v51, v49, vcc row_ror:8 row_mask:0xf bank_mask:0xf
    ds_write_b64 v61, v[48:49]
    s_cmp_eq_u32 s49, 0
    s_cbranch_scc1 HOOKC
EXB:
    s_waitcnt lgkmcnt(0)
    s_barrier
    ds_read_b128 v[16:19], v70
    ds_read_b128 v[20:23], v70 offset:16
    ds_read_b64 v[24:25], v60 offset:0
    v_mov_b32 v44, v44
    ds_read_b64 v[26:27], v60 offset:768
    ds_read_b64 v[28:29], v60 offset:1536
    v_mov_b32 v44, v44
    ds_read_b64 v[30:31], v60 offset:2304
    ds_read_b64 v[32:33], v60 offset:3072
    v_mov_b32 v44, v44
    ds_read_b64 v[34:35], v60 offset:3840
    ds_read_b64 v[36:37], v60 offset:4608
    v_mov_b32 v44, v44
    ds_read_b64 v[38:39], v60 offset:5376
    s_mov_b32 s51, 0
    s_cmp_eq_u32 s49, 0
    s_cselect_b32 s52, 20, s46
    s_waitcnt lgkmcnt(9)
    v_max3_f32 v40, v16, v17, v18
    v_max_f32 v40, v40, v19
    v_pk_add_f32 v[16:17], v[16:17], v[40:41] op_sel_hi:[1,0] neg_lo:[0,1] neg_hi:[0,1]
    v_pk_add_f32 v[18:19], v[18:19], v[40:41] op_sel_hi:[1,0] neg_lo:[0,1] neg_hi:[0,1]
    v_exp_f32 v16, v16
    v_exp_f32 v17, v17
    v_exp_f32 v18, v18
    v_exp_f32 v19, v19
    s_waitcnt lgkmcnt(0)
    v_pk_mul_f32 v[20:21], v[20:21], v[16:17]
    v_pk_fma_f32 v[20:21], v[22:23], v[18:19], v[20:21]
    v_add_f32 v41, v20, v21
    v_rcp_f32 v42, v41
    v_log_f32 v43, v41
    v_pk_add_f32 v[24:25], v[24:25], v[26:27]
    v_pk_add_f32 v[28:29], v[28:29], v[30:31]
    v_pk_add_f32 v[32:33], v[32:33], v[34:35]
    v_pk_add_f32 v[36:37], v[36:37], v[38:39]
    v_pk_mul_f32 v[24:25], v[24:25], v[16:17] op_sel_hi:[1,0]
    v_pk_fma_f32 v[24:25], v[28:29], v[16:17], v[24:25] op_sel:[0,1,0] op_sel_hi:[1,1,1]
    v_pk_fma_f32 v[24:25], v[32:33], v[18:19], v[24:25] op_sel:[0,0,0] op_sel_hi:[1,0,1]
    v_pk_fma_f32 v[24:25], v[36:37], v[18:19], v[24:25] op_sel:[0,1,0] op_sel_hi:[1,1,1]
    v_pk_mul_f32 v[24:25], v[24:25], v[42:43] op_sel_hi:[1,0]
    v_add_f32 v43, v43, v40
    v_cvt_pk_bf16_f32 v24, v24, v25
    v_cndmask_b32 v24, v24, v43, s[60:61]
    buffer_store_dword v24, v14, s[16:19], s32 offen offset:0
    s_cmp_eq_u32 s50, 0
    s_cbranch_scc1 SLOW3
PUBD3:
    s_cmp_ge_u32 s52, 20
    s_cbranch_scc1 HOOKG
    v_mov_b32 v40, v40
    v_mov_b32 v40, v40
    v_mov_b32 v40, v40
    v_mov_b32 v40, v40
    v_mov_b32 v40, v40
    v_mov_b32 v40, v40
    v_mov_b32 v40, v40
    v_mov_b32 v40, v40
    v_mov_b32 v40, v40
    v_mov_b32 v40, v40
    v_mov_b32 v40, v40
    v_mov_b32 v40, v40
    v_mov_b32 v40, v40
    v_mov_b32 v40, v40
    v_mov_b32 v40, v40
    v_mov_b32 v40, v40
    buffer_load_dword v56, v65, s[16:19], s62 offen sc1
    buffer_load_dwordx4 v[44:47], v64, s[16:19], s62 offen offset:0 sc1
    buffer_load_dwordx4 v[48:51], v64, s[16:19], s62 offen offset:512 sc1
    buffer_load_dwordx4 v[52:55], v64, s[16:19], s62 offen offset:1024 sc1
    buffer_load_dword v57, v66, s[16:19], s49 offen sc1
    v_mov_b32 v40, v40
    v_mov_b32 v40, v40
    v_mov_b32 v40, v40
    v_mov_b32 v40, v40
    v_mov_b32 v40, v40
    v_mov_b32 v40, v40
    v_mov_b32 v40, v40
    v_mov_b32 v40, v40
    v_mov_b32 v40, v40
    v_mov_b32 v40, v40
    v_mov_b32 v40, v40
    v_mov_b32 v40, v40
    v_mov_b32 v40, v40
    v_mov_b32 v40, v40
    v_mov_b32 v40, v40
    v_mov_b32 v40, v40
    v_mov_b32 v40, v40
    v_mov_b32 v40, v40
    v_mov_b32 v40, v40
    v_mov_b32 v40, v40
WOP:
    buffer_load_dword v56, v65, s[16:19], s62 offen sc1
    buffer_load_dwordx4 v[44:47], v64, s[16:19], s62 offen offset:0 sc1
    buffer_load_dwordx4 v[48:51], v64, s[16:19], s62 offen offset:512 sc1
    buffer_load_dwordx4 v[52:55], v64, s[16:19], s62 offen offset:1024 sc1
    buffer_load_dword v57, v66, s[16:19], s49 offen sc1
    v_mov_b32 v40, v40
    v_mov_b32 v40, v40
    v_mov_b32 v40, v40
    v_mov_b32 v40, v40
    s_waitcnt vmcnt(5)
WOC:
    v_mfma_f32_16x16x32_bf16 v[16:19], v[44:47], v[80:83], 0
    v_mov_b32 v32, v56
    v_max3_u32 v63, v44, v48, v52
    v_mfma_f32_16x16x32_bf16 v[16:19], v[48:51], v[96:99], v[16:19]
    v_max_u32 v63, v63, v32
    v_max_f32_dpp v33, v32, v32 quad_perm:[1,0,3,2] row_mask:0xf bank_mask:0xf
    v_mfma_f32_16x16x32_bf16 v[16:19], v[52:55], v[112:115], v[16:19]
    v_cmp_eq_u32 vcc, -1, v63
    v_max_f32_dpp v33, v33, v33 quad_perm:[2,3,0,1] row_mask:0xf bank_mask:0xf
    v_mfma_f32_16x16x32_bf16 v[20:23], v[44:47], v[84:87], 0
    s_cbranch_vccnz AGWOP
    v_max_f32_dpp v33, v33, v33 row_half_mirror row_mask:0xf bank_mask:0xf
    v_sub_f32 v34, v32, v33
    v_mfma_f32_16x16x32_bf16 v[20:23], v[48:51], v[100:103], v[20:23]
    v_exp_f32 v34, v34
    s_nop 0
    v_mfma_f32_16x16x32_bf16 v[20:23], v[52:55], v[116:119], v[20:23]
    v_add_f32_dpp v33, v34, v34 quad_perm:[1,0,3,2] row_mask:0xf bank_mask:0xf
    s_nop 0
    v_mfma_f32_16x16x32_bf16 v[24:27], v[44:47], v[88:91], 0
    v_add_f32_dpp v33, v33, v33 quad_perm:[2,3,0,1] row_mask:0xf bank_mask:0xf
    s_nop 0
    v_mfma_f32_16x16x32_bf16 v[24:27], v[48:51], v[104:107], v[24:27]
    v_add_f32_dpp v33, v33, v33 row_half_mirror row_mask:0xf bank_mask:0xf
    v_rcp_f32 v33, v33
    v_mfma_f32_16x16x32_bf16 v[24:27], v[52:55], v[120:123], v[24:27]
    v_mul_f32 v34, v34, v33
    s_nop 0
    v_mfma_f32_16x16x32_bf16 v[28:31], v[44:47], v[92:95], 0
    v_mul_f32_dpp v36, v34, v16 row_newbcast:0 row_mask:0xf bank_mask:0xf
    v_fmac_f32_dpp v36, v34, v17 row_newbcast:1 row_mask:0xf bank_mask:0xf
    v_mfma_f32_16x16x32_bf16 v[28:31], v[48:51], v[108:111], v[28:31]
    v_fmac_f32_dpp v36, v34, v18 row_newbcast:2 row_mask:0xf bank_mask:0xf
    v_fmac_f32_dpp v36, v34, v19 row_newbcast:3 row_mask:0xf bank_mask:0xf
    v_mfma_f32_16x16x32_bf16 v[28:31], v[52:55], v[124:127], v[28:31]
    v_mul_f32_dpp v37, v34, v20 row_newbcast:0 row_mask:0xf bank_mask:0xf
    v_fmac_f32_dpp v37, v34, v21 row_newbcast:1 row_mask:0xf bank_mask:0xf
    v_fmac_f32_dpp v37, v34, v22 row_newbcast:2 row_mask:0xf bank_mask:0xf
    v_fmac_f32_dpp v37, v34, v23 row_newbcast:3 row_mask:0xf bank_mask:0xf
    v_mul_f32_dpp v38, v34, v24 row_newbcast:0 row_mask:0xf bank_mask:0xf
    v_fmac_f32_dpp v38, v34, v25 row_newbcast:1 row_mask:0xf bank_mask:0xf
    v_fmac_f32_dpp v38, v34, v26 row_newbcast:2 row_mask:0xf bank_mask:0xf
    v_fmac_f32_dpp v38, v34, v27 row_newbcast:3 row_mask:0xf bank_mask:0xf
    v_cmp_u_f32 vcc, v36, v57
    s_mov_b32 exec_hi, 0
    v_mul_f32_dpp v39, v34, v28 row_newbcast:0 row_mask:0xf bank_mask:0xf
    v_fmac_f32_dpp v39, v34, v29 row_newbcast:1 row_mask:0xf bank_mask:0xf
    v_fmac_f32_dpp v39, v34, v30 row_newbcast:2 row_mask:0xf bank_mask:0xf
    v_fmac_f32_dpp v39, v34, v31 row_newbcast:3 row_mask:0xf bank_mask:0xf
    ds_write_b128 v68, v[36:39]
    s_mov_b64 exec, -1
    s_cbranch_vccnz AGWOP
OKWOP:
    s_cmp_lg_u32 s44, 3
    s_waitcnt lgkmcnt(0)
    s_barrier
    s_cbranch_scc1 WOX
    ds_read2st64_b32 v[16:17], v69 offset0:0 offset1:1
    ds_read2st64_b32 v[18:19], v69 offset0:2 offset1:3
    ds_read2st64_b32 v[20:21], v69 offset0:4 offset1:5
    ds_read2st64_b32 v[22:23], v69 offset0:6 offset1:7
    s_waitcnt lgkmcnt(2)
    v_pk_add_f32 v[16:17], v[16:17], v[18:19]
    v_add_f32 v16, v16, v57
    s_waitcnt lgkmcnt(0)
    v_pk_add_f32 v[20:21], v[20:21], v[22:23]
    v_pk_add_f32 v[16:17], v[16:17], v[20:21]
    v_add_f32 v16, v16, v17
    buffer_store_dword v16, v67, s[16:19], s1 offen sc1
    buffer_store_dword v16, v67, s[16:19], s99 offen sc1
WOX:
    s_cmp_ge_u32 s46, 30
    s_cbranch_scc1 STX
    s_cmp_eq_u32 s44, 3
    s_cbranch_scc1 F1W3
    s_waitcnt vmcnt(0)
F1W3:
    s_waitcnt vmcnt(2)
F1E:
    ds_read_b128 v[56:59], v12 offset:16384
    ds_read_b128 v[52:55], v12 offset:12288
    ds_read_b128 v[60:63], v12 offset:20480
    s_mov_b32 s100, 0
    s_mov_b32 s51, 0
    s_waitcnt lgkmcnt(0)
    ds_read_b64_tr_b16 v[64:65], v57 offset:49152
    ds_read_b64_tr_b16 v[66:67], v57 offset:49664
    ds_read_b64_tr_b16 v[68:69], v57 offset:53248
    ds_read_b64_tr_b16 v[70:71], v57 offset:53760
    ds_read_b64_tr_b16 v[72:73], v57 offset:57344
    ds_read_b64_tr_b16 v[74:75], v57 offset:57856
    ds_read_b64_tr_b16 v[76:77], v57 offset:61440
    ds_read_b64_tr_b16 v[78:79], v57 offset:61952
    s_cmp_eq_u32 s49, 0
    s_cbranch_scc1 HOOKD
    s_cmp_lt_u32 s46, 20
    s_cbranch_scc1 GFB
    s_sleep 11
GFB:
    s_sleep 11
F1P:
F1W:
    buffer_load_dword v44, v52, s[16:19], s99 offen offset:0 sc1
    buffer_load_dword v45, v52, s[16:19], s99 offen offset:128 sc1
    buffer_load_dword v46, v52, s[16:19], s99 offen offset:256 sc1
    buffer_load_dword v47, v52, s[16:19], s99 offen offset:384 sc1
    buffer_load_dword v48, v52, s[16:19], s99 offen offset:512 sc1
    buffer_load_dword v49, v52, s[16:19], s99 offen offset:640 sc1
    buffer_load_dword v50, v52, s[16:19], s99 offen offset:768 sc1
    buffer_load_dword v51, v52, s[16:19], s99 offen offset:896 sc1
    s_waitcnt vmcnt(0)
    v_pk_add_f32 v[16:17], v[44:45], v[46:47]
    v_pk_add_f32 v[18:19], v[48:49], v[50:51]
    v_pk_add_f32 v[16:17], v[16:17], v[18:19]
    v_add_f32 v16, v16, v17
    v_mov_b32 v17, v16
    s_nop 1
    v_permlane32_swap_b32 v16, v17
    v_add_f32 v16, v16, v17
    v_cmp_u_f32 vcc, v16, v16
    v_cvt_pk_bf16_f32 v16, v16, v16
    ds_write_b16 v53, v16
    s_cbranch_vccnz AGF1P
OKF1P:
    v_and_b32 v16, 0xffff0000, v16
    buffer_store_dword v16, v54, s[16:19], s34 offen offset:0
    s_cmp_eq_u32 s50, 0
    s_cbranch_scc1 SLOW8
PUBD8:
    s_waitcnt lgkmcnt(0)
    s_barrier
    ds_read_b128 v[20:23], v2 offset:256
    ds_read_b128 v[24:27], v2 offset:320
    ds_read_b128 v[28:31], v2 offset:384
    ds_read_b128 v[32:35], v2 offset:448
    s_waitcnt lgkmcnt(3)
    v_mfma_f32_16x16x32_bf16 v[40:43], v[20:23], v[64:67], 0
    v_mfma_f32_16x16x32_bf16 v[36:39], v[20:23], v[20:23], 0
    s_waitcnt lgkmcnt(2)
    v_mfma_f32_16x16x32_bf16 v[40:43], v[24:27], v[68:71], v[40:43]
    v_mfma_f32_16x16x32_bf16 v[36:39], v[24:27], v[24:27], v[36:39]
    s_waitcnt lgkmcnt(1)
    v_mfma_f32_16x16x32_bf16 v[40:43], v[28:31], v[72:75], v[40:43]
    v_mfma_f32_16x16x32_bf16 v[36:39], v[28:31], v[28:31], v[36:39]
    s_waitcnt lgkmcnt(0)
    v_mfma_f32_16x16x32_bf16 v[40:43], v[32:35], v[76:79], v[40:43]
    v_mfma_f32_16x16x32_bf16 v[36:39], v[32:35], v[32:35], v[36:39]
    s_mov_b32 s51, 0
    s_nop 5
    buffer_store_dword v40, v55, s[16:19], s32 offen offset:0
    buffer_store_dwordx2 v[36:37], v56, s[16:19], s32 offen offset:0
    s_cmp_eq_u32 s50, 0
    s_cbranch_scc1 SLOW9
PUBD9:
    s_cmp_lt_u32 s46, 20
    s_cbranch_scc1 STX
    s_cmp_eq_u32 s49, 0
    s_cbranch_scc1 HOOKI
    v_mov_b32 v44, v44
    v_mov_b32 v44, v44
    v_mov_b32 v44, v44
    v_mov_b32 v44, v44
    v_mov_b32 v44, v44
    v_mov_b32 v44, v44
    v_mov_b32 v44, v44
    v_mov_b32 v44, v44
    v_mov_b32 v44, v44
    v_mov_b32 v44, v44
    v_mov_b32 v44, v44
    v_mov_b32 v44, v44
    v_mov_b32 v44, v44
    v_mov_b32 v44, v44
    v_mov_b32 v44, v44
    v_mov_b32 v44, v44
    v_mov_b32 v44, v44
    v_mov_b32 v44, v44
    v_mov_b32 v44, v44
    v_mov_b32 v44, v44
    v_mov_b32 v44, v44
    v_mov_b32 v44, v44
    v_mov_b32 v44, v44
    v_mov_b32 v44, v44
    v_mov_b32 v44, v44
    v_mov_b32 v44, v44
    v_mov_b32 v44, v44
    v_mov_b32 v44, v44
    buffer_load_dword v74, v60, s[16:19], s62 offen sc1
    buffer_load_dwordx4 v[64:67], v58, s[16:19], s62 offen offset:0 sc1
    buffer_load_dwordx4 v[68:71], v58, s[16:19], s62 offen offset:3072 sc1
    buffer_load_dwordx2 v[72:73], v59, s[16:19], s62 offen sc1
    buffer_load_dword v76, v61, s[16:19], s49 offen sc1
    v_mov_b32 v44, v44
    v_mov_b32 v44, v44
    v_mov_b32 v44, v44
    v_mov_b32 v44, v44
    v_mov_b32 v44, v44
    v_mov_b32 v44, v44
    v_mov_b32 v44, v44
    v_mov_b32 v44, v44
    v_mov_b32 v44, v44
    v_mov_b32 v44, v44
    v_mov_b32 v44, v44
    v_mov_b32 v44, v44
    v_mov_b32 v44, v44
    v_mov_b32 v44, v44
    v_mov_b32 v44, v44
    v_mov_b32 v44, v44
    v_mov_b32 v44, v44
    v_mov_b32 v44, v44
    v_mov_b32 v44, v44
    v_mov_b32 v44, v44
W2P:
    buffer_load_dword v74, v60, s[16:19], s62 offen sc1
    buffer_load_dwordx4 v[64:67], v58, s[16:19], s62 offen offset:0 sc1
    buffer_load_dwordx4 v[68:71], v58, s[16:19], s62 offen offset:3072 sc1
    buffer_load_dwordx2 v[72:73], v59, s[16:19], s62 offen sc1
    buffer_load_dword v76, v61, s[16:19], s49 offen sc1
    s_waitcnt vmcnt(5)
    v_add_f32_dpp v48, v74, v74 quad_perm:[1,0,3,2] row_mask:0xf bank_mask:0xf
    v_pk_add_f32 v[18:19], v[64:65], v[66:67]
    v_pk_add_f32 v[20:21], v[68:69], v[70:71]
    v_add_f32_dpp v48, v48, v48 quad_perm:[2,3,0,1] row_mask:0xf bank_mask:0xf
    v_add_f32 v16, v18, v19
    v_add_f32 v17, v20, v21
    v_add_f32_dpp v48, v48, v48 row_half_mirror row_mask:0xf bank_mask:0xf
    v_pk_add_f32 v[16:17], v[16:17], v[72:73]
    v_mov_b32 v46, 0x3727c5ac
    v_mul_f32_dpp v47, v48, v11 row_newbcast:8 row_mask:0xf bank_mask:0xf
    v_fmac_f32_dpp v46, v48, v11 row_newbcast:0 row_mask:0xf bank_mask:0xf
    v_fma_f32 v46, -v47, v47, v46
    v_rsq_f32 v48, abs(v46)
    v_pk_fma_f32 v[16:17], v[46:47], v[126:127], v[16:17] op_sel:[1,0,0] op_sel_hi:[1,1,1] neg_lo:[1,0,0] neg_hi:[1,0,0]
    v_pk_mul_f32 v[16:17], v[16:17], v[48:49] op_sel_hi:[1,0]
    v_mul_f32 v18, 0xbfb8aa3b, v16
    v_exp_f32 v18, v18
    v_mul_f32 v16, v16, v17
    v_add_f32 v18, 1.0, v18
    v_rcp_f32 v18, v18
    v_cmp_u_f32 vcc, v16, v76
    v_mul_f32 v16, v16, v18
    v_cvt_pk_bf16_f32 v16, v16, v16
    ds_write_b16 v63, v16
    s_cbranch_vccnz AGW2P
OKW2P:
    s_waitcnt lgkmcnt(0)
    s_barrier
    ds_read_b128 v[16:19], v2 offset:512
    ds_read_b128 v[20:23], v2 offset:576
    ds_read_b128 v[24:27], v2 offset:640
    ds_read_b128 v[28:31], v2 offset:704
    ds_read_b128 v[32:35], v2 offset:768
    ds_read_b128 v[36:39], v2 offset:832
    v_mov_b32 v40, v76
    s_nop 0
    s_waitcnt lgkmcnt(5)
    v_mfma_f32_16x16x32_bf16 v[40:43], v[16:19], v[80:83], v[40:43]
    s_waitcnt lgkmcnt(4)
    v_mfma_f32_16x16x32_bf16 v[40:43], v[20:23], v[84:87], v[40:43]
    s_waitcnt lgkmcnt(3)
    v_mfma_f32_16x16x32_bf16 v[40:43], v[24:27], v[88:91], v[40:43]
    s_waitcnt lgkmcnt(2)
    v_mfma_f32_16x16x32_bf16 v[40:43], v[28:31], v[92:95], v[40:43]
    s_waitcnt lgkmcnt(1)
    v_mfma_f32_16x16x32_bf16 v[40:43], v[32:35], v[96:99], v[40:43]
    s_waitcnt lgkmcnt(0)
    v_mfma_f32_16x16x32_bf16 v[40:43], v[36:39], v[100:103], v[40:43]
    s_waitcnt vmcnt(0)
    s_nop 6
    buffer_store_dword v40, v62, s[16:19], s49 offen sc1
STX:
    s_cmp_lg_u32 s49, 0
    s_cbranch_scc1 LAST
    s_branch LOOP
LAST:
    s_and_b32 s52, s2, 0xc7
    s_cmp_eq_u32 s52, 0
    s_cbranch_scc1 LOOP
    s_endpgm
FINAL:
    s_cmp_eq_u32 s44, 3
    s_cbranch_scc1 FINX
    s_sleep 22
    s_waitcnt lgkmcnt(0)
Y3P:
    buffer_load_dword v22, v16, s[16:19], s55 offen offset:0 sc1
    buffer_load_dword v23, v16, s[16:19], s55 offen offset:128 sc1
    buffer_load_dword v24, v16, s[16:19], s55 offen offset:256 sc1
    buffer_load_dword v25, v16, s[16:19], s55 offen offset:384 sc1
    s_waitcnt vmcnt(0)
    v_pk_add_f32 v[22:23], v[22:23], v[24:25]
    v_add_f32 v30, v22, v23
    v_mov_b32 v31, v30
    s_nop 1
    v_permlane32_swap_b32 v30, v31
    v_add_f32 v30, v30, v31
    v_cmp_u_f32 vcc, v30, v30
    v_cvt_pk_bf16_f32 v30, v30, v30
    s_cbranch_vccnz AGY3P
OKY3P:
    buffer_store_short v30, v21, s[36:39], 0 offen
FINX:
DONE:
    s_endpgm
TABLES:
    v_mov_b32 v23, 1879048192
    v_and_b32 v24, 15, v1
    v_lshrrev_b32 v25, 4, v1
    v_and_b32 v26, 7, v1
    v_and_b32 v27, 31, v1
    v_lshrrev_b32 v28, 5, v1
    v_and_b32 v29, 31, v1
    v_lshl_add_u32 v29, s44, 5, v29
    v_lshrrev_b32 v16, 2, v1
    v_lshlrev_b32 v16, 7, v16
    v_and_b32 v20, 3, v1
    v_lshl_add_u32 v16, v20, 2, v16
    s_mul_i32 s52, s7, 3072
    s_mul_i32 s54, s44, 768
    s_add_u32 s52, s52, s54
    s_lshl_b32 s54, s48, 4
    s_add_u32 s52, s52, s54
    v_add_u32 v16, s52, v16
    v_cmp_gt_u32 vcc, 24, v1
    s_nop 1
    v_cndmask_b32 v16, v23, v16, vcc
    s_lshl_b32 s52, s7, 5
    s_lshl_b32 s54, s48, 2
    s_add_u32 s52, s52, s54
    s_add_u32 s52, s52, 19968
    s_cmp_eq_u32 s44, 3
    s_cselect_b32 s52, s52, 1879048192
    v_writelane_b32 v16, s52, 24
    v_lshlrev_b32 v17, 4, v26
    v_and_b32 v20, 1, v25
    v_lshl_add_u32 v17, v20, 7, v17
    v_mul_u32_u24 v20, 768, v28
    v_add_u32 v17, v17, v20
    s_mul_i32 s52, s44, 1536
    s_add_u32 s52, s52, 98816
    v_add_u32 v17, s52, v17
    v_bfe_u32 v20, v1, 3, 1
    v_xor_b32 v20, v20, v28
    v_lshl_add_u32 v19, v20, 3, v17
    v_add_u32 v19, 512, v19
    v_lshl_add_u32 v17, v20, 8, v17
    s_mul_i32 s52, s44, 24
    v_min_u32 v21, 23, v1
    v_add_u32 v21, s52, v21
    v_lshrrev_b32 v18, 5, v21
    v_lshlrev_b32 v18, 8, v18
    v_bfe_u32 v20, v21, 1, 1
    v_lshl_add_u32 v18, v20, 7, v18
    v_bfe_u32 v20, v21, 2, 3
    v_lshl_add_u32 v18, v20, 4, v18
    v_bfe_u32 v20, v21, 0, 1
    v_lshl_add_u32 v18, v20, 3, v18
    v_add_u32 v18, 98816, v18
    ds_write_b128 v12, v[16:19] offset:0
    v_lshlrev_b32 v16, 4, v26
    v_lshl_add_u32 v16, v25, 7, v16
    s_mul_i32 s52, s56, 6144
    s_mul_i32 s54, s44, 1536
    s_add_u32 s52, s52, s54
    v_add_u32 v16, s52, v16
    v_cmp_gt_u32 vcc, 8, v24
    s_nop 1
    v_cndmask_b32 v16, v23, v16, vcc
    s_lshr_b32 s53, s44, 1
    s_lshl_b32 s52, s56, 6
    s_lshl_b32 s54, s53, 5
    s_add_u32 s52, s52, s54
    s_add_u32 s52, s52, 19968
    v_lshl_add_u32 v17, v25, 2, v26
    v_and_b32 v17, 7, v17
    v_lshl_add_u32 v17, v17, 2, s52
    s_lshl_b32 s52, s57, 8
    s_add_u32 s52, s52, 131072
    s_or_b32 s53, s45, s56
    s_cmp_eq_u32 s53, 0
    s_cselect_b32 s52, s52, 1879048192
    v_lshl_add_u32 v18, v1, 2, s52
    v_lshlrev_b32 v19, 11, v28
    v_lshl_add_u32 v19, v27, 2, v19
    s_lshr_b32 s53, s57, 1
    s_lshl_b32 s52, s57, 12
    s_lshl_b32 s54, s53, 13
    s_add_u32 s52, s52, s54
    s_lshl_b32 s54, s45, 8
    s_add_u32 s52, s52, s54
    s_lshl_b32 s54, s56, 7
    s_add_u32 s52, s52, s54
    v_add_u32 v19, s52, v19
    ds_write_b128 v12, v[16:19] offset:4096
    s_lshl_b32 s52, s44, 9
    s_add_u32 s52, s52, 104960
    v_lshl_add_u32 v16, v27, 4, s52
    v_lshl_add_u32 v16, v28, 11, v16
    v_lshlrev_b32 v17, 4, v24
    v_lshl_add_u32 v17, v25, 2, v17
    v_add_u32 v17, 104960, v17
    v_mov_b32 v18, 98752
    s_lshl_b32 s52, s44, 2
    s_add_u32 s52, s52, 98752
    v_mov_b32 v19, 98792
    v_writelane_b32 v19, s52, 0
    ds_write_b128 v12, v[16:19] offset:8192
    v_lshlrev_b32 v16, 10, v28
    v_lshl_add_u32 v16, v27, 2, v16
    s_lshl_b32 s52, s3, 14
    s_lshl_b32 s54, s44, 11
    s_add_u32 s52, s52, s54
    v_add_u32 v16, s52, v16
    v_lshlrev_b32 v17, 1, v29
    v_add_u32 v17, 96512, v17
    s_lshl_b32 s52, s4, 9
    s_add_u32 s52, s52, 133632
    s_cmp_lt_u32 s4, 5
    s_cselect_b32 s52, s52, 1879048192
    s_cmp_eq_u32 s45, 0
    s_cselect_b32 s52, s52, 1879048192
    v_lshl_add_u32 v18, v29, 2, s52
    v_cmp_gt_u32 vcc, 32, v1
    s_nop 1
    v_cndmask_b32 v18, v23, v18, vcc
    s_lshl_b32 s52, s59, 6
    s_lshl_b32 s54, s44, 4
    s_add_u32 s52, s52, s54
    v_add_u32 v19, s52, v1
    s_mul_i32 s52, s58, 3072
    s_lshl_b32 s54, s3, 2
    s_add_u32 s52, s52, s54
    s_add_u32 s52, s52, 12288
    s_lshl_b32 s53, s58, 2
    s_add_u32 s53, s53, 18432
    s_cmp_eq_u32 s3, 4
    s_cselect_b32 s52, s53, s52
    s_cselect_b32 s53, 3, 4
    v_lshlrev_b32 v19, s53, v19
    v_add_u32 v19, s52, v19
    v_cmp_gt_u32 vcc, 16, v1
    s_nop 1
    v_cndmask_b32 v19, v23, v19, vcc
    ds_write_b128 v12, v[16:19] offset:12288
    s_lshl_b32 s52, s4, 3
    s_add_u32 s52, s52, 20224
    s_cmp_eq_u32 s44, 3
    s_cselect_b32 s52, s52, 1879048192
    s_cmp_lt_u32 s4, 5
    s_cselect_b32 s52, s52, 1879048192
    v_mov_b32 v16, v23
    v_writelane_b32 v16, s52, 0
    v_and_b32 v17, 3, v1
    v_lshlrev_b32 v17, 3, v17
    v_bfe_u32 v20, v1, 2, 2
    v_lshl_add_u32 v17, v20, 7, v17
    v_lshrrev_b32 v20, 4, v1
    v_lshl_add_u32 v17, v20, 10, v17
    v_bfe_u32 v20, v1, 3, 2
    v_lshl_add_u32 v17, v20, 5, v17
    s_lshl_b32 s52, s44, 5
    v_xor_b32 v17, s52, v17
    v_lshlrev_b32 v18, 4, v0
    v_add_u32 v18, 12288, v18
    v_lshlrev_b32 v19, 3, v0
    v_add_u32 v19, 18432, v19
    v_cmp_gt_u32 vcc, 192, v0
    s_nop 1
    v_cndmask_b32 v18, v23, v18, vcc
    v_cndmask_b32 v19, v23, v19, vcc
    ds_write_b128 v12, v[16:19] offset:16384
    v_lshlrev_b32 v16, 3, v26
    v_add_u32 v16, 20224, v16
    v_bfe_u32 v20, v1, 3, 1
    v_lshl_add_u32 v16, v20, 2, v16
    v_cmp_gt_u32 vcc, 5, v26
    s_nop 1
    v_cndmask_b32 v16, v23, v16, vcc
    v_cmp_gt_u32 vcc, 192, v0
    s_nop 1
    v_cndmask_b32 v16, v23, v16, vcc
    s_lshl_b32 s52, s57, 8
    s_lshl_b32 s54, s44, 6
    s_add_u32 s52, s52, s54
    s_add_u32 s52, s52, 133632
    s_cmp_eq_u32 s45, 0
    s_cselect_b32 s52, s52, 1879048192
    v_lshl_add_u32 v17, v24, 2, s52
    s_lshr_b32 s53, s57, 2
    s_lshr_b32 s51, s44, 1
    s_lshl_b32 s52, s57, 11
    s_lshl_b32 s54, s53, 13
    s_add_u32 s52, s52, s54
    s_mul_i32 s54, s51, 896
    s_add_u32 s52, s52, s54
    s_lshl_b32 s54, s44, 6
    s_add_u32 s52, s52, s54
    s_lshl_b32 s54, s45, 7
    s_add_u32 s52, s52, s54
    s_add_u32 s52, s52, 81920
    v_lshl_add_u32 v18, v24, 2, s52
    v_lshl_add_u32 v18, v25, 13, v18
    v_cmp_gt_u32 vcc, 32, v1
    s_nop 1
    v_cndmask_b32 v18, v23, v18, vcc
    v_lshlrev_b32 v19, 1, v0
    v_add_u32 v19, 96768, v19
    ds_write_b128 v12, v[16:19] offset:20480
    s_lshr_b32 s53, s48, 2
    s_mul_i32 s52, s7, 6144
    s_lshl_b32 s54, s44, 8
    s_add_u32 s52, s52, s54
    s_mul_i32 s54, s53, 3056
    s_add_u32 s52, s52, s54
    s_lshl_b32 s54, s48, 2
    s_add_u32 s52, s52, s54
    s_add_u32 s52, s52, 20480
    v_lshl_add_u32 v16, v1, 4, s52
    v_cmp_gt_u32 vcc, 16, v1
    s_nop 1
    v_cndmask_b32 v16, v23, v16, vcc
    s_lshl_b32 s52, s7, 6
    s_lshl_b32 s54, s48, 3
    s_add_u32 s52, s52, s54
    s_add_u32 s52, s52, 45056
    s_cmp_eq_u32 s44, 3
    s_cselect_b32 s52, s52, 1879048192
    v_mov_b32 v17, v23
    v_writelane_b32 v17, s52, 0
    s_mul_i32 s52, s48, 80
    v_add_u32 v20, s52, v29
    v_lshrrev_b32 v18, 5, v20
    v_lshlrev_b32 v18, 10, v18
    v_lshrrev_b32 v21, 8, v20
    v_lshl_add_u32 v18, v21, 13, v18
    v_and_b32 v21, 31, v20
    v_lshl_add_u32 v18, v21, 2, v18
    v_lshl_add_u32 v18, v28, 9, v18
    v_add_u32 v18, 81920, v18
    v_cmp_gt_u32 vcc, 80, v29
    s_nop 1
    v_cndmask_b32 v18, v23, v18, vcc
    v_lshlrev_b32 v19, 1, v29
    v_add_u32 v19, 96256, v19
    ds_write_b128 v12, v[16:19] offset:24576
    s_and_b32 s53, s2, 0xc7
    s_cmp_eq_u32 s53, 0
    s_mov_b32 s52, 131072
    s_cselect_b32 s52, s52, 1879048192
    v_lshl_add_u32 v16, v20, 2, s52
    v_lshlrev_b32 v19, 1, v20
    s_and_b32 vcc_hi, vcc_hi, 0
    s_nop 1
    v_cndmask_b32 v16, v23, v16, vcc
    v_cndmask_b32 v19, v23, v19, vcc
    v_and_b32 v21, 3, v1
    v_lshrrev_b32 v17, 4, v1
    v_bfe_u32 v18, v1, 2, 2
    v_lshlrev_b32 v21, 3, v21
    v_mul_u32_u24 v18, 384, v18
    v_add_u32 v21, v21, v18
    v_bfe_u32 v18, v1, 3, 2
    v_xor_b32 v18, s44, v18
    v_lshl_add_u32 v21, v18, 5, v21
    v_add_u32 v21, 65536, v21
    v_and_b32 v18, 1, v17
    v_mul_u32_u24 v17, 3072, v17
    v_mul_u32_u24 v18, 3072, v18
    v_add_u32 v17, v17, v21
    v_add_u32 v18, v18, v21
    ds_write_b128 v12, v[16:19] offset:28672
    s_branch ENTRY0
HOOKL:
    s_cmp_lt_u32 s46, 30
    s_cbranch_scc1 NOGSW
    v_mov_b32 v30, 20224
GSW:
    buffer_load_dword v31, v30, s[16:19], s96 offen sc1
    s_waitcnt vmcnt(0)
    v_cmp_u_f32 vcc, v31, v31
    s_cbranch_vccz NOGSW
    s_add_u32 s51, s51, 1
    s_sleep 2
    s_cmp_lt_u32 s51, 0x40000
    s_cbranch_scc1 GSW
NOGSW:
    s_cmp_ge_u32 s46, 30
    s_cselect_b32 s53, 10, 0
    s_sub_u32 s53, s46, s53
    v_min_u32 v31, 17, v1
    v_lshlrev_b32 v31, 7, v31
    s_mul_i32 s52, s45, 45312
    s_mul_i32 s54, s53, 2304
    s_add_u32 s52, s52, s54
    s_add_u32 s52, s52, 524288
    buffer_load_dword v31, v31, s[16:19], s52 offen sc1
    v_lshlrev_b32 v30, 3, v0
    s_mul_i32 s52, s47, 12288
    s_add_u32 s52, s52, 1441792
    s_add_u32 s53, s52, 0
    buffer_load_dwordx2 v[32:33], v30, s[16:19], s53 offen offset:0 sc1
    buffer_load_dwordx2 v[34:35], v30, s[16:19], s53 offen offset:1536 sc1
    s_add_u32 s53, s52, 3072
    buffer_load_dwordx2 v[36:37], v30, s[16:19], s53 offen offset:0 sc1
    buffer_load_dwordx2 v[38:39], v30, s[16:19], s53 offen offset:1536 sc1
    s_add_u32 s53, s52, 6144
    buffer_load_dwordx2 v[40:41], v30, s[16:19], s53 offen offset:0 sc1
    buffer_load_dwordx2 v[42:43], v30, s[16:19], s53 offen offset:1536 sc1
    s_add_u32 s53, s52, 9216
    buffer_load_dwordx2 v[26:27], v30, s[16:19], s53 offen offset:0 sc1
    buffer_load_dwordx2 v[28:29], v30, s[16:19], s53 offen offset:1536 sc1
    s_sleep 23
    s_mov_b32 s51, 0
    s_branch GYB
QCA:
    v_lshlrev_b32 v30, 3, v0
    s_mul_i32 s52, s47, 12288
    s_add_u32 s52, s52, 1441792
    s_add_u32 s53, s52, 0
    buffer_load_dwordx2 v[32:33], v30, s[16:19], s53 offen offset:0 sc1
    buffer_load_dwordx2 v[34:35], v30, s[16:19], s53 offen offset:1536 sc1
    s_add_u32 s53, s52, 3072
    buffer_load_dwordx2 v[36:37], v30, s[16:19], s53 offen offset:0 sc1
    buffer_load_dwordx2 v[38:39], v30, s[16:19], s53 offen offset:1536 sc1
    s_add_u32 s53, s52, 6144
    buffer_load_dwordx2 v[40:41], v30, s[16:19], s53 offen offset:0 sc1
    buffer_load_dwordx2 v[42:43], v30, s[16:19], s53 offen offset:1536 sc1
    s_add_u32 s53, s52, 9216
    buffer_load_dwordx2 v[26:27], v30, s[16:19], s53 offen offset:0 sc1
    buffer_load_dwordx2 v[28:29], v30, s[16:19], s53 offen offset:1536 sc1
    s_waitcnt vmcnt(0)
    s_add_u32 s51, s51, 1
    s_sleep 2
    s_cmp_lt_u32 s51, 0x40000
    s_cbranch_scc1 QCP
    s_branch Y2W
Y2P:
    buffer_load_dword v22, v16, s[16:19], s55 offen offset:0 sc1
    buffer_load_dword v23, v16, s[16:19], s55 offen offset:128 sc1
    buffer_load_dword v24, v16, s[16:19], s55 offen offset:256 sc1
    buffer_load_dword v25, v16, s[16:19], s55 offen offset:384 sc1
    s_branch Y2W
AGY2P:
    s_add_u32 s51, s51, 1
    s_sleep 1
    s_cmp_lt_u32 s51, 0x40000
    s_cbranch_scc1 Y2P
    s_branch OKY2P
Q0L:
    v_and_b32 v21, 3, v1
    v_lshrrev_b32 v19, 4, v1
    v_bfe_u32 v20, v1, 2, 2
    v_lshlrev_b32 v21, 3, v21
    v_mul_u32_u24 v20, 384, v20
    v_add_u32 v21, v21, v20
    v_bfe_u32 v20, v1, 3, 2
    v_xor_b32 v20, s44, v20
    v_lshl_add_u32 v21, v20, 5, v21
    v_add_u32 v21, 65536, v21
    v_and_b32 v20, 1, v19
    v_mul_u32_u24 v19, 3072, v19
    v_mul_u32_u24 v20, 3072, v20
    v_add_u32 v19, v19, v21
    v_add_u32 v20, v20, v21
    s_branch QTR
HOOKA:
    s_mov_b64 exec, 0xffff
    s_nop 3
    s_lshl_b32 s52, s44, 6
    s_add_u32 s52, s52, 98816
    v_lshl_add_u32 v14, v1, 2, s52
    ds_write_b32 v14, v17 offset:10752
    v_fma_f32 v16, -v84, v17, v16
    v_mul_f32 v16, v16, v85
    ds_write_b32 v14, v16 offset:0
    ds_write_b32 v14, v21 offset:11008
    v_fma_f32 v20, -v84, v21, v20
    v_mul_f32 v20, v20, v85
    ds_write_b32 v14, v20 offset:256
    ds_write_b32 v14, v25 offset:11264
    v_fma_f32 v24, -v84, v25, v24
    v_mul_f32 v24, v24, v85
    ds_write_b32 v14, v24 offset:512
    s_mov_b64 exec, -1
    s_add_u32 s44, s44, 1
    s_cmp_lt_u32 s44, 4
    s_cbranch_scc1 Q0L
    s_mov_b32 s44, 3
    v_lshlrev_b32 v14, 2, v1
    v_add_u32 v14, 98816, v14
    ds_read2st64_b32 v[16:17], v14 offset0:0 offset1:1
    ds_read_b32 v18, v14 offset:512
    s_lshl_b32 s52, s47, 13
    s_lshl_b32 s54, s48, 10
    s_add_u32 s52, s52, s54
    s_add_u32 s52, s52, 1114112
    s_waitcnt lgkmcnt(0)
    v_bitop3_b32 v19, v16, v17, v18 bitop3:0x96
    v_xor_b32 v19, v19, v89
    buffer_store_dwordx4 v[16:19], v88, s[16:19], s52 offen sc1
    s_sleep 40
    v_and_b32 v15, 0xe1, v1
    v_lshlrev_b32 v15, 1, v15
    v_bfe_u32 v14, v1, 4, 1
    v_lshl_add_u32 v15, v14, 3, v15
    v_bfe_u32 v14, v1, 3, 1
    v_lshl_add_u32 v15, v14, 4, v15
    v_bfe_u32 v14, v1, 2, 1
    v_lshl_add_u32 v15, v14, 2, v15
    v_bfe_u32 v14, v1, 1, 1
    v_lshl_add_u32 v15, v14, 5, v15
    v_add_u32 v15, 98304, v15
    s_lshl_b32 s52, s47, 13
    s_add_u32 s52, s52, 1114112
    s_add_u32 s53, s52, 4096
    s_mov_b32 s51, 0
Q0P:
    buffer_load_dwordx4 v[16:19], v88, s[16:19], s52 offen offset:0 sc1
    buffer_load_dwordx4 v[20:23], v88, s[16:19], s52 offen offset:1024 sc1
    buffer_load_dwordx4 v[24:27], v88, s[16:19], s52 offen offset:2048 sc1
    buffer_load_dwordx4 v[28:31], v88, s[16:19], s52 offen offset:3072 sc1
    buffer_load_dwordx4 v[32:35], v88, s[16:19], s53 offen offset:0 sc1
    buffer_load_dwordx4 v[36:39], v88, s[16:19], s53 offen offset:1024 sc1
    buffer_load_dwordx4 v[40:43], v88, s[16:19], s53 offen offset:2048 sc1
    buffer_load_dwordx4 v[44:47], v88, s[16:19], s53 offen offset:3072 sc1
    v_mov_b32 v48, 0
    s_waitcnt vmcnt(0)
    v_bitop3_b32 v49, v16, v17, v18 bitop3:0x96
    v_bitop3_b32 v49, v49, v19, v89 bitop3:0x96
    v_or_b32 v48, v48, v49
    v_bitop3_b32 v49, v20, v21, v22 bitop3:0x96
    v_bitop3_b32 v49, v49, v23, v89 bitop3:0x96
    v_or_b32 v48, v48, v49
    v_bitop3_b32 v49, v24, v25, v26 bitop3:0x96
    v_bitop3_b32 v49, v49, v27, v89 bitop3:0x96
    v_or_b32 v48, v48, v49
    v_bitop3_b32 v49, v28, v29, v30 bitop3:0x96
    v_bitop3_b32 v49, v49, v31, v89 bitop3:0x96
    v_or_b32 v48, v48, v49
    v_bitop3_b32 v49, v32, v33, v34 bitop3:0x96
    v_bitop3_b32 v49, v49, v35, v89 bitop3:0x96
    v_or_b32 v48, v48, v49
    v_bitop3_b32 v49, v36, v37, v38 bitop3:0x96
    v_bitop3_b32 v49, v49, v39, v89 bitop3:0x96
    v_or_b32 v48, v48, v49
    v_bitop3_b32 v49, v40, v41, v42 bitop3:0x96
    v_bitop3_b32 v49, v49, v43, v89 bitop3:0x96
    v_or_b32 v48, v48, v49
    v_bitop3_b32 v49, v44, v45, v46 bitop3:0x96
    v_bitop3_b32 v49, v49, v47, v89 bitop3:0x96
    v_or_b32 v48, v48, v49
    v_cmp_ne_u32 vcc, 0, v48
    s_cbranch_vccz Q0OK
    s_add_u32 s51, s51, 1
    s_sleep 16
    s_cmp_lt_u32 s51, 0x40000
    s_cbranch_scc1 Q0P
Q0OK:
    v_pk_add_f32 v[16:17], v[16:17], v[20:21]
    v_add_f32 v18, v18, v22
    v_pk_add_f32 v[16:17], v[16:17], v[24:25]
    v_add_f32 v18, v18, v26
    v_pk_add_f32 v[16:17], v[16:17], v[28:29]
    v_add_f32 v18, v18, v30
    v_pk_add_f32 v[16:17], v[16:17], v[32:33]
    v_add_f32 v18, v18, v34
    v_pk_add_f32 v[16:17], v[16:17], v[36:37]
    v_add_f32 v18, v18, v38
    v_pk_add_f32 v[16:17], v[16:17], v[40:41]
    v_add_f32 v18, v18, v42
    v_pk_add_f32 v[16:17], v[16:17], v[44:45]
    v_add_f32 v18, v18, v46
    v_cvt_pk_bf16_f32 v16, v16, v17
    v_cvt_pk_bf16_f32 v18, v18, v18
    ds_write_b16 v15, v16
    ds_write_b16_d16_hi v15, v16 offset:128
    ds_write_b16 v15, v18 offset:256
    s_mov_b32 s51, 0
HSP:
    s_mov_b32 s52, 1376256
    buffer_load_dwordx4 v[24:27], v88, s[16:19], s52 offen sc1
    s_waitcnt vmcnt(0)
    v_xor_b32 v20, s5, v24
    v_xor_b32 v21, s5, v25
    v_xor_b32 v22, s5, v26
    v_xor_b32 v23, s5, v27
    v_or3_b32 v20, v20, v21, v22
    v_or_b32 v20, v20, v23
    v_cmp_lt_u32 vcc, 31, v20
    s_cbranch_vccz HSOK
    s_add_u32 s51, s51, 1
    s_sleep 8
    s_cmp_lt_u32 s51, 0x40000
    s_cbranch_scc1 HSP
HSOK:
    s_mov_b32 s53, 0
    v_and_b32 v24, 16, v24
    v_cmp_ne_u32 vcc, 0, v24
    s_bcnt1_i32_b64 s52, vcc
    s_add_u32 s53, s53, s52
    v_and_b32 v25, 16, v25
    v_cmp_ne_u32 vcc, 0, v25
    s_bcnt1_i32_b64 s52, vcc
    s_add_u32 s53, s53, s52
    v_and_b32 v26, 16, v26
    v_cmp_ne_u32 vcc, 0, v26
    s_bcnt1_i32_b64 s52, vcc
    s_add_u32 s53, s53, s52
    v_and_b32 v27, 16, v27
    v_cmp_ne_u32 vcc, 0, v27
    s_bcnt1_i32_b64 s52, vcc
    s_add_u32 s53, s53, s52
    v_and_b32 v20, 15, v20
    s_cmp_gt_u32 s53, 128
    s_cselect_b32 s53, 2, 0
    s_lshr_b32 s52, s5, 1
    s_xor_b32 s53, s53, s52
    s_and_b32 s53, s53, 2
    s_lshl_b32 s52, s45, 3
    v_cmp_ne_u32 vcc, 0, v20
    s_lshr_b64 s[60:61], vcc, s52
    s_and_b32 s52, s60, 0xff
    s_cselect_b32 s50, 0, 1
    v_mov_b32 v38, 98784
    s_or_b32 s53, s53, s50
    v_or_b32 v39, s53, v89
    ds_write_b32 v38, v39
    v_and_b32 v21, 0xffff0000, v86
    v_lshlrev_b32 v20, 16, v86
    buffer_store_dwordx2 v[20:21], v87, s[16:19], 0 offen sc1
    s_branch TABLES
EN3:
    v_mov_b64 v[72:73], 0
    v_mov_b64 v[74:75], 0
    v_mov_b64 v[76:77], 0
    v_mov_b64 v[78:79], 0
    v_mov_b64 v[40:41], 0
    v_mov_b64 v[42:43], 0
    v_mov_b64 v[44:45], 0
    v_mov_b64 v[46:47], 0
    v_mov_b64 v[48:49], 0
    v_mov_b64 v[50:51], 0
    s_branch ENOK2
ENTRY0:
    ds_read_b64 v[14:15], v12 offset:0
    ds_read_b64 v[60:61], v12 offset:8
    v_mov_b64 v[64:65], 0
    v_mov_b64 v[66:67], 0
    v_mov_b64 v[68:69], 0
    v_mov_b64 v[70:71], 0
    v_mov_b64 v[72:73], 0
    v_mov_b64 v[74:75], 0
    v_mov_b64 v[76:77], 0
    v_mov_b64 v[78:79], 0
    v_mov_b64 v[40:41], 0
    v_mov_b64 v[42:43], 0
    v_mov_b64 v[44:45], 0
    v_mov_b64 v[46:47], 0
    v_mov_b64 v[48:49], 0
    v_mov_b64 v[50:51], 0
    s_cmp_lg_u32 s44, 3
    s_cbranch_scc1 QFRAG
    s_waitcnt lgkmcnt(0)
    s_barrier
    s_waitcnt vmcnt(23)
    buffer_load_dwordx4 a[0:3], v80, s[8:11], s96 offen offset:0 nt
    s_waitcnt vmcnt(23)
    buffer_load_dwordx4 a[8:11], v80, s[8:11], s96 offen offset:128 nt
    s_waitcnt vmcnt(23)
    buffer_load_dwordx4 a[16:19], v80, s[8:11], s96 offen offset:256 nt
    s_add_u32 s96, s96, s97
    s_waitcnt vmcnt(23)
    buffer_load_dwordx4 a[4:7], v80, s[8:11], s96 offen offset:0 nt
    s_waitcnt vmcnt(23)
    buffer_load_dwordx4 a[12:15], v80, s[8:11], s96 offen offset:128 nt
    s_waitcnt vmcnt(23)
    buffer_load_dwordx4 a[20:23], v80, s[8:11], s96 offen offset:256 nt
    s_add_u32 s96, s96, s97
    s_waitcnt vmcnt(23)
    buffer_load_dwordx4 a[24:27], v80, s[8:11], s96 offen offset:0 nt
    s_waitcnt vmcnt(23)
    buffer_load_dwordx4 a[32:35], v80, s[8:11], s96 offen offset:128 nt
    s_waitcnt vmcnt(23)
    buffer_load_dwordx4 a[40:43], v80, s[8:11], s96 offen offset:256 nt
    s_add_u32 s96, s96, s97
    s_waitcnt vmcnt(23)
    buffer_load_dwordx4 a[28:31], v80, s[8:11], s96 offen offset:0 nt
    s_waitcnt vmcnt(23)
    buffer_load_dwordx4 a[36:39], v80, s[8:11], s96 offen offset:128 nt
    s_waitcnt vmcnt(23)
    buffer_load_dwordx4 a[44:47], v80, s[8:11], s96 offen offset:256 nt
    s_add_u32 s96, s96, s97
    s_waitcnt vmcnt(23)
    buffer_load_dwordx4 a[48:51], v80, s[8:11], s96 offen offset:0 nt
    s_waitcnt vmcnt(23)
    buffer_load_dwordx4 a[56:59], v80, s[8:11], s96 offen offset:128 nt
    s_waitcnt vmcnt(23)
    buffer_load_dwordx4 a[64:67], v80, s[8:11], s96 offen offset:256 nt
    s_add_u32 s96, s96, s97
    s_waitcnt vmcnt(23)
    buffer_load_dwordx4 a[52:55], v80, s[8:11], s96 offen offset:0 nt
    s_waitcnt vmcnt(23)
    buffer_load_dwordx4 a[60:63], v80, s[8:11], s96 offen offset:128 nt
    s_waitcnt vmcnt(23)
    buffer_load_dwordx4 a[68:71], v80, s[8:11], s96 offen offset:256 nt
    s_add_u32 s96, s96, s97
    s_waitcnt vmcnt(23)
    buffer_load_dwordx4 a[72:75], v80, s[8:11], s96 offen offset:0 nt
    s_waitcnt vmcnt(23)
    buffer_load_dwordx4 a[80:83], v80, s[8:11], s96 offen offset:128 nt
    s_waitcnt vmcnt(23)
    buffer_load_dwordx4 a[88:91], v80, s[8:11], s96 offen offset:256 nt
    s_add_u32 s96, s96, s97
    s_waitcnt vmcnt(23)
    buffer_load_dwordx4 a[76:79], v80, s[8:11], s96 offen offset:0 nt
    s_waitcnt vmcnt(23)
    buffer_load_dwordx4 a[84:87], v80, s[8:11], s96 offen offset:128 nt
    s_waitcnt vmcnt(23)
    buffer_load_dwordx4 a[92:95], v80, s[8:11], s96 offen offset:256 nt
    s_add_u32 s96, s96, s97
    s_waitcnt vmcnt(23)
    buffer_load_dwordx4 a[96:99], v80, s[8:11], s96 offen offset:0 nt
    s_waitcnt vmcnt(23)
    buffer_load_dwordx4 a[104:107], v80, s[8:11], s96 offen offset:128 nt
    s_waitcnt vmcnt(23)
    buffer_load_dwordx4 a[112:115], v80, s[8:11], s96 offen offset:256 nt
    s_add_u32 s96, s96, s97
    s_waitcnt vmcnt(23)
    buffer_load_dwordx4 a[100:103], v80, s[8:11], s96 offen offset:0 nt
    s_waitcnt vmcnt(23)
    buffer_load_dwordx4 a[108:111], v80, s[8:11], s96 offen offset:128 nt
    s_waitcnt vmcnt(23)
    buffer_load_dwordx4 a[116:119], v80, s[8:11], s96 offen offset:256 nt
    s_add_u32 s96, s96, s97
    s_waitcnt vmcnt(23)
    buffer_load_dwordx4 a[120:123], v80, s[8:11], s96 offen offset:0 nt
    s_waitcnt vmcnt(23)
    buffer_load_dwordx4 a[128:131], v80, s[8:11], s96 offen offset:128 nt
    s_waitcnt vmcnt(23)
    buffer_load_dwordx4 a[136:139], v80, s[8:11], s96 offen offset:256 nt
    s_add_u32 s96, s96, s97
    s_waitcnt vmcnt(23)
    buffer_load_dwordx4 a[124:127], v80, s[8:11], s96 offen offset:0 nt
    s_waitcnt vmcnt(23)
    buffer_load_dwordx4 a[132:135], v80, s[8:11], s96 offen offset:128 nt
    s_waitcnt vmcnt(23)
    buffer_load_dwordx4 a[140:143], v80, s[8:11], s96 offen offset:256 nt
    s_add_u32 s96, s96, s97
    s_waitcnt vmcnt(23)
    buffer_load_dwordx4 a[144:147], v80, s[8:11], s96 offen offset:0 nt
    s_waitcnt vmcnt(23)
    buffer_load_dwordx4 a[152:155], v80, s[8:11], s96 offen offset:128 nt
    s_waitcnt vmcnt(23)
    buffer_load_dwordx4 a[160:163], v80, s[8:11], s96 offen offset:256 nt
    s_add_u32 s96, s96, s97
    s_waitcnt vmcnt(23)
    buffer_load_dwordx4 a[148:151], v80, s[8:11], s96 offen offset:0 nt
    s_waitcnt vmcnt(23)
    buffer_load_dwordx4 a[156:159], v80, s[8:11], s96 offen offset:128 nt
    s_waitcnt vmcnt(23)
    buffer_load_dwordx4 a[164:167], v80, s[8:11], s96 offen offset:256 nt
    s_add_u32 s96, s96, s97
    s_waitcnt vmcnt(23)
    buffer_load_dwordx4 a[168:171], v80, s[8:11], s96 offen offset:0 nt
    s_waitcnt vmcnt(23)
    buffer_load_dwordx4 a[176:179], v80, s[8:11], s96 offen offset:128 nt
    s_waitcnt vmcnt(23)
    buffer_load_dwordx4 a[184:187], v80, s[8:11], s96 offen offset:256 nt
    s_add_u32 s96, s96, s97
    s_waitcnt vmcnt(23)
    buffer_load_dwordx4 a[172:175], v80, s[8:11], s96 offen offset:0 nt
    s_waitcnt vmcnt(23)
    buffer_load_dwordx4 a[180:183], v80, s[8:11], s96 offen offset:128 nt
    s_waitcnt vmcnt(23)
    buffer_load_dwordx4 a[188:191], v80, s[8:11], s96 offen offset:256 nt
    s_lshl_b32 s97, s97, 1
    s_waitcnt vmcnt(23)
    buffer_load_dwordx4 a[192:195], v82, s[12:15], s55 offen offset:0 nt
    s_waitcnt vmcnt(23)
    buffer_load_dwordx4 a[200:203], v82, s[12:15], s55 offen offset:128 nt
    s_waitcnt vmcnt(23)
    buffer_load_dwordx4 a[208:211], v82, s[12:15], s55 offen offset:256 nt
    s_waitcnt vmcnt(23)
    buffer_load_dwordx4 a[216:219], v82, s[12:15], s55 offen offset:384 nt
    s_waitcnt vmcnt(23)
    buffer_load_dwordx4 a[224:227], v82, s[12:15], s55 offen offset:512 nt
    s_waitcnt vmcnt(23)
    buffer_load_dwordx4 a[232:235], v82, s[12:15], s55 offen offset:640 nt
    s_add_u32 s55, s55, s97
    s_waitcnt vmcnt(23)
    buffer_load_dwordx4 a[196:199], v82, s[12:15], s55 offen offset:0 nt
    s_waitcnt vmcnt(23)
    buffer_load_dwordx4 a[204:207], v82, s[12:15], s55 offen offset:128 nt
    s_waitcnt vmcnt(23)
    buffer_load_dwordx4 a[212:215], v82, s[12:15], s55 offen offset:256 nt
    s_waitcnt vmcnt(23)
    buffer_load_dwordx4 a[220:223], v82, s[12:15], s55 offen offset:384 nt
    s_waitcnt vmcnt(23)
    buffer_load_dwordx4 a[228:231], v82, s[12:15], s55 offen offset:512 nt
    s_waitcnt vmcnt(23)
    buffer_load_dwordx4 a[236:239], v82, s[12:15], s55 offen offset:640 nt
    s_add_u32 s55, s55, s97
    s_waitcnt vmcnt(23)
    buffer_load_dwordx4 a[240:243], v82, s[12:15], s55 offen offset:0 nt
    s_waitcnt vmcnt(23)
    buffer_load_dwordx4 a[248:251], v82, s[12:15], s55 offen offset:128 nt
    s_waitcnt vmcnt(23)
    buffer_load_dwordx4 v[128:131], v82, s[12:15], s55 offen offset:256 nt
    s_waitcnt vmcnt(23)
    buffer_load_dwordx4 v[136:139], v82, s[12:15], s55 offen offset:384 nt
    s_waitcnt vmcnt(23)
    buffer_load_dwordx4 v[144:147], v82, s[12:15], s55 offen offset:512 nt
    s_waitcnt vmcnt(23)
    buffer_load_dwordx4 v[152:155], v82, s[12:15], s55 offen offset:640 nt
    s_add_u32 s55, s55, s97
    s_waitcnt vmcnt(23)
    buffer_load_dwordx4 a[244:247], v82, s[12:15], s55 offen offset:0 nt
    s_waitcnt vmcnt(23)
    buffer_load_dwordx4 a[252:255], v82, s[12:15], s55 offen offset:128 nt
    s_waitcnt vmcnt(23)
    buffer_load_dwordx4 v[132:135], v82, s[12:15], s55 offen offset:256 nt
    s_waitcnt vmcnt(23)
    buffer_load_dwordx4 v[140:143], v82, s[12:15], s55 offen offset:384 nt
    s_waitcnt vmcnt(23)
    buffer_load_dwordx4 v[148:151], v82, s[12:15], s55 offen offset:512 nt
    s_waitcnt vmcnt(23)
    buffer_load_dwordx4 v[156:159], v82, s[12:15], s55 offen offset:640 nt
    s_add_u32 s55, s55, s97
    s_waitcnt vmcnt(23)
    buffer_load_dwordx4 v[160:163], v82, s[12:15], s55 offen offset:0 nt
    s_waitcnt vmcnt(23)
    buffer_load_dwordx4 v[168:171], v82, s[12:15], s55 offen offset:128 nt
    s_waitcnt vmcnt(23)
    buffer_load_dwordx4 v[176:179], v82, s[12:15], s55 offen offset:256 nt
    s_waitcnt vmcnt(23)
    buffer_load_dwordx4 v[184:187], v82, s[12:15], s55 offen offset:384 nt
    s_waitcnt vmcnt(23)
    buffer_load_dwordx4 v[192:195], v82, s[12:15], s55 offen offset:512 nt
    s_waitcnt vmcnt(23)
    buffer_load_dwordx4 v[200:203], v82, s[12:15], s55 offen offset:640 nt
    s_add_u32 s55, s55, s97
    s_waitcnt vmcnt(23)
    buffer_load_dwordx4 v[164:167], v82, s[12:15], s55 offen offset:0 nt
    s_waitcnt vmcnt(23)
    buffer_load_dwordx4 v[172:175], v82, s[12:15], s55 offen offset:128 nt
    s_waitcnt vmcnt(23)
    buffer_load_dwordx4 v[180:183], v82, s[12:15], s55 offen offset:256 nt
    s_waitcnt vmcnt(23)
    buffer_load_dwordx4 v[188:191], v82, s[12:15], s55 offen offset:384 nt
    s_waitcnt vmcnt(23)
    buffer_load_dwordx4 v[196:199], v82, s[12:15], s55 offen offset:512 nt
    s_waitcnt vmcnt(23)
    buffer_load_dwordx4 v[204:207], v82, s[12:15], s55 offen offset:640 nt
    s_add_u32 s55, s55, s97
    s_waitcnt vmcnt(23)
    buffer_load_dwordx4 v[208:211], v82, s[12:15], s55 offen offset:0 nt
    s_waitcnt vmcnt(23)
    buffer_load_dwordx4 v[216:219], v82, s[12:15], s55 offen offset:128 nt
    s_waitcnt vmcnt(23)
    buffer_load_dwordx4 v[224:227], v82, s[12:15], s55 offen offset:256 nt
    s_waitcnt vmcnt(23)
    buffer_load_dwordx4 v[232:235], v82, s[12:15], s55 offen offset:384 nt
    s_waitcnt vmcnt(23)
    buffer_load_dwordx4 v[240:243], v82, s[12:15], s55 offen offset:512 nt
    s_waitcnt vmcnt(23)
    buffer_load_dwordx4 v[248:251], v82, s[12:15], s55 offen offset:640 nt
    s_add_u32 s55, s55, s97
    s_barrier
    s_waitcnt vmcnt(23)
    buffer_load_dwordx4 v[212:215], v82, s[12:15], s55 offen offset:0 nt
    s_waitcnt vmcnt(23)
    buffer_load_dwordx4 v[220:223], v82, s[12:15], s55 offen offset:128 nt
    s_waitcnt vmcnt(23)
    buffer_load_dwordx4 v[228:231], v82, s[12:15], s55 offen offset:256 nt
    s_waitcnt vmcnt(23)
    buffer_load_dwordx4 v[236:239], v82, s[12:15], s55 offen offset:384 nt
    s_waitcnt vmcnt(23)
    buffer_load_dwordx4 v[244:247], v82, s[12:15], s55 offen offset:512 nt
    s_waitcnt vmcnt(23)
    buffer_load_dwordx4 v[252:255], v82, s[12:15], s55 offen offset:640 nt
    s_branch QFRAG
HOOKF:
    v_mov_b32 v52, 98784
    ds_read_b32 v52, v52
    s_mov_b32 s6, 0
    s_waitcnt lgkmcnt(0)
    v_readfirstlane_b32 s101, v52
    s_and_b32 s50, s101, 1
    s_and_b32 s0, s101, 2
    s_lshl_b32 s0, s0, 12
    s_and_b32 s101, s101, 0xffffffe0
    s_cmp_lg_u32 s50, 0
    s_cselect_b32 s32, s62, 1610612736
    s_cselect_b32 s33, 1610612736, s62
    s_cmp_lg_u32 s50, 0
    s_cselect_b32 s34, s49, 1610612736
    s_cselect_b32 s35, 1610612736, s49
    s_add_u32 s99, s49, s0
    s_xor_b32 s1, s99, 8192
    s_waitcnt vmcnt(48)
    s_branch QK
AGENP:
    s_add_u32 s51, s51, 1
    s_cmp_lt_u32 s51, 0x40000
    s_cbranch_scc1 ENP
    s_branch OKENP
HOOKC:
    s_cmp_eq_u32 s44, 3
    s_cbranch_scc1 EXB
    s_cmp_eq_u32 s44, 1
    s_cbranch_scc1 WM1
    s_cmp_eq_u32 s44, 2
    s_cbranch_scc1 WM2
    v_min_u32 v83, 8, v1
    v_lshlrev_b32 v83, 7, v83
    s_mul_i32 s52, s45, 28160
    s_mul_i32 s54, s46, 1152
    s_add_u32 s52, s52, s54
    s_add_u32 s52, s52, 131072
    buffer_load_dword v83, v83, s[16:19], s52 offen sc1
    s_branch WM3
WM1:
    v_min_u32 v83, 11, v1
    v_lshlrev_b32 v83, 7, v83
    s_mul_i32 s52, s45, 45312
    s_mul_i32 s54, s46, 1536
    s_add_u32 s52, s52, s54
    s_add_u32 s52, s52, 529408
    buffer_load_dword v83, v83, s[16:19], s52 offen sc1
    s_branch WM3
WM2:
    v_min_u32 v83, 11, v1
    v_lshlrev_b32 v83, 7, v83
    s_mul_i32 s52, s45, 49152
    s_mul_i32 s54, s46, 1536
    s_add_u32 s52, s52, s54
    s_add_u32 s52, s52, 1441792
    buffer_load_dword v83, v83, s[16:19], s52 offen sc1
WM3:
    v_lshrrev_b32 v58, 3, v1
    v_and_b32 v57, 7, v1
    v_and_b32 v56, 2, v58
    v_xor_b32 v57, v57, v56
    s_and_b32 s52, s44, 1
    s_lshl_b32 s52, s52, 2
    v_xor_b32 v57, s52, v57
    v_mul_u32_u24 v56, 3072, v58
    v_lshl_add_u32 v56, v57, 4, v56
    v_lshrrev_b32 v58, 3, v1
    v_and_b32 v57, 7, v1
    v_and_b32 v55, 2, v58
    v_xor_b32 v57, v57, v55
    s_and_b32 s52, s44, 1
    s_lshl_b32 s52, s52, 2
    v_xor_b32 v57, s52, v57
    v_mul_u32_u24 v55, 1280, v58
    v_lshl_add_u32 v55, v57, 4, v55
    s_barrier
    s_cmp_ge_u32 s46, 20
    s_cbranch_scc1 HC8
    s_mul_i32 s52, s45, 983040
    s_mul_i32 s54, s56, 491520
    s_add_u32 s52, s52, s54
    s_lshl_b32 s54, s57, 7
    s_add_u32 s52, s52, s54
    s_mul_i32 s54, s44, 10240
    s_add_u32 s52, s52, s54
    s_lshl_b32 s53, s44, 10
DMA1:
    s_mov_b32 m0, s53
    s_add_u32 s53, s53, 3072
    buffer_load_dwordx4 v55, s[24:27], s52 offen nt lds
    v_xor_b32 v55, 64, v55
    s_add_u32 s52, s52, 30720
    s_cmp_lt_u32 s53, 49152
    s_cbranch_scc1 DMA1
HC8:
    s_cmp_ge_u32 s46, 30
    s_cbranch_scc1 HC7
    s_mul_i32 s52, s3, 393216
    s_mul_i32 s54, s45, 384
    s_add_u32 s52, s52, s54
    s_lshl_b32 s54, s59, 7
    s_add_u32 s52, s52, s54
    s_mul_i32 s54, s44, 24576
    s_add_u32 s52, s52, s54
    s_lshl_b32 s53, s44, 10
    s_add_u32 s53, s53, 49152
DMA2:
    s_mov_b32 m0, s53
    s_add_u32 s53, s53, 3072
    buffer_load_dwordx4 v56, s[28:31], s52 offen nt lds
    v_xor_b32 v56, 64, v56
    s_add_u32 s52, s52, 73728
    s_cmp_lt_u32 s53, 65536
    s_cbranch_scc1 DMA2
HC7:
    s_branch EXB
HOOKG:
    s_cmp_lg_u32 s49, 0
    s_cbranch_scc1 WOX
    s_cmp_ge_u32 s46, 20
    s_cbranch_scc1 HOOKG3
    v_and_b32 v72, 3, v1
    v_lshlrev_b32 v72, 3, v72
    v_bfe_u32 v73, v1, 2, 2
    v_lshl_add_u32 v72, v73, 7, v72
    v_lshrrev_b32 v73, 4, v1
    v_lshl_add_u32 v72, v73, 10, v72
    v_bfe_u32 v73, v1, 3, 2
    v_lshl_add_u32 v72, v73, 5, v72
    s_mul_i32 s52, s44, 12288
    v_add_u32 v72, s52, v72
    v_xor_b32 v73, 32, v72
    v_xor_b32 v74, 64, v72
    v_xor_b32 v75, 96, v72
    s_cmp_lg_u32 s44, 3
    s_cbranch_scc1 QCNA
    v_lshlrev_b32 v38, 2, v1
    v_add_u32 v39, 109568, v38
    v_lshlrev_b32 v38, 1, v38
    ds_read_b32 v32, v39 offset:0
    ds_read_b32 v34, v39 offset:256
    ds_read_b32 v36, v39 offset:512
    s_mul_i32 s52, s47, 12288
    s_mul_i32 s54, s48, 1536
    s_add_u32 s52, s52, s54
    s_add_u32 s52, s52, 1441792
    s_cmp_lg_u32 s50, 0
    s_cselect_b32 s53, s52, 1610612736
    s_cselect_b32 s54, 1610612736, s52
    s_waitcnt lgkmcnt(0)
    v_xor_b32 v33, s101, v32
    v_xor_b32 v35, s101, v34
    v_xor_b32 v37, s101, v36
    buffer_store_dwordx2 v[32:33], v38, s[16:19], s53 offen offset:0
    buffer_store_dwordx2 v[34:35], v38, s[16:19], s53 offen offset:512
    buffer_store_dwordx2 v[36:37], v38, s[16:19], s53 offen offset:1024
    s_cmp_eq_u32 s50, 0
    s_cbranch_scc1 SLOW4
PUBD4:
    s_branch QCMA
QCNA:
    s_waitcnt vmcnt(1)
QCMA:
    s_barrier
    buffer_load_dword v56, v65, s[16:19], s62 offen sc1
    buffer_load_dwordx4 v[44:47], v64, s[16:19], s62 offen offset:0 sc1
    buffer_load_dwordx4 v[48:51], v64, s[16:19], s62 offen offset:512 sc1
    buffer_load_dwordx4 v[52:55], v64, s[16:19], s62 offen offset:1024 sc1
    buffer_load_dword v57, v66, s[16:19], s49 offen sc1
    ds_read_b64_tr_b16 v[80:81], v72 offset:0
    ds_read_b64_tr_b16 v[82:83], v72 offset:512
    ds_read_b64_tr_b16 v[96:97], v72 offset:4096
    ds_read_b64_tr_b16 v[98:99], v72 offset:4608
    ds_read_b64_tr_b16 v[112:113], v72 offset:8192
    ds_read_b64_tr_b16 v[114:115], v72 offset:8704
    ds_read_b64_tr_b16 v[84:85], v73 offset:0
    ds_read_b64_tr_b16 v[86:87], v73 offset:512
    ds_read_b64_tr_b16 v[100:101], v73 offset:4096
    ds_read_b64_tr_b16 v[102:103], v73 offset:4608
    ds_read_b64_tr_b16 v[116:117], v73 offset:8192
    ds_read_b64_tr_b16 v[118:119], v73 offset:8704
    ds_read_b64_tr_b16 v[88:89], v74 offset:0
    ds_read_b64_tr_b16 v[90:91], v74 offset:512
    ds_read_b64_tr_b16 v[104:105], v74 offset:4096
    ds_read_b64_tr_b16 v[106:107], v74 offset:4608
    ds_read_b64_tr_b16 v[120:121], v74 offset:8192
    ds_read_b64_tr_b16 v[122:123], v74 offset:8704
    ds_read_b64_tr_b16 v[92:93], v75 offset:0
    ds_read_b64_tr_b16 v[94:95], v75 offset:512
    ds_read_b64_tr_b16 v[108:109], v75 offset:4096
    ds_read_b64_tr_b16 v[110:111], v75 offset:4608
    ds_read_b64_tr_b16 v[124:125], v75 offset:8192
    ds_read_b64_tr_b16 v[126:127], v75 offset:8704
    s_waitcnt lgkmcnt(0) vmcnt(0)
    s_branch WOC
HOOKG3:
    s_cmp_lg_u32 s44, 3
    s_cbranch_scc1 QCNB
    v_lshlrev_b32 v38, 2, v1
    v_add_u32 v39, 109568, v38
    v_lshlrev_b32 v38, 1, v38
    ds_read_b32 v32, v39 offset:0
    ds_read_b32 v34, v39 offset:256
    ds_read_b32 v36, v39 offset:512
    s_mul_i32 s52, s47, 12288
    s_mul_i32 s54, s48, 1536
    s_add_u32 s52, s52, s54
    s_add_u32 s52, s52, 1441792
    s_cmp_lg_u32 s50, 0
    s_cselect_b32 s53, s52, 1610612736
    s_cselect_b32 s54, 1610612736, s52
    s_waitcnt lgkmcnt(0)
    v_xor_b32 v33, s101, v32
    v_xor_b32 v35, s101, v34
    v_xor_b32 v37, s101, v36
    buffer_store_dwordx2 v[32:33], v38, s[16:19], s53 offen offset:0
    buffer_store_dwordx2 v[34:35], v38, s[16:19], s53 offen offset:512
    buffer_store_dwordx2 v[36:37], v38, s[16:19], s53 offen offset:1024
    s_cmp_eq_u32 s50, 0
    s_cbranch_scc1 SLOW5
PUBD5:
    s_branch QCMB
QCNB:
    s_waitcnt vmcnt(1)
QCMB:
    s_barrier
    s_cmp_lg_u32 s46, 31
    s_cbranch_scc1 EW1
    s_cmp_lg_u32 s44, 0
    s_cbranch_scc1 WOX
    v_and_b32 v32, 31, v1
    v_lshlrev_b32 v32, 2, v32
    v_add_u32 v32, 19968, v32
    s_lshl_b32 s52, s45, 7
    s_add_u32 s52, s52, 118784
    v_lshlrev_b32 v34, 13, v1
EWP:
    buffer_load_dword v33, v32, s[16:19], s62 offen sc1
    s_waitcnt vmcnt(0)
    v_cmp_u_f32 vcc, v33, v33
    s_cbranch_vccz EWOK
    s_add_u32 s51, s51, 1
    s_cmp_lt_u32 s51, 0x40000
    s_cbranch_scc1 EWP
EWOK:
    s_mov_b64 exec, 3
    buffer_store_dword v34, v34, s[16:19], s52 offen sc1
    s_mov_b64 exec, -1
EW1:
    s_cmp_ge_u32 s46, 30
    s_cbranch_scc1 WOX
    s_cmp_eq_u32 s44, 3
    s_cbranch_scc1 HD0
    v_lshrrev_b32 v33, 3, v1
    v_and_b32 v32, 7, v1
    v_and_b32 v34, 2, v33
    v_xor_b32 v32, v32, v34
    s_and_b32 s52, s44, 1
    s_lshl_b32 s52, s52, 2
    v_xor_b32 v32, s52, v32
    v_mul_u32_u24 v34, 1280, v33
    v_lshl_add_u32 v34, v32, 4, v34
    s_mul_i32 s52, s45, 245760
    s_lshl_b32 s54, s57, 7
    s_add_u32 s52, s52, s54
    s_mul_i32 s54, s44, 10240
    s_add_u32 s52, s52, s54
    s_lshl_b32 s53, s44, 10
DMA3:
    s_mov_b32 m0, s53
    s_add_u32 s53, s53, 3072
    buffer_load_dwordx4 v34, s[24:27], s52 offen nt lds
    v_xor_b32 v34, 64, v34
    s_add_u32 s52, s52, 30720
    s_cmp_lt_u32 s53, 24576
    s_cbranch_scc1 DMA3
HD0:
    v_mov_b64 v[116:117], -1
    v_mov_b64 v[118:119], -1
    v_mov_b32 v23, 1879048192
    s_mul_i32 s52, s57, 5120
    s_mul_i32 s54, s44, 1280
    s_add_u32 s52, s52, s54
    v_lshl_add_u32 v120, v1, 4, s52
    s_add_u32 s52, s52, 1024
    v_lshl_add_u32 v121, v1, 2, s52
    s_lshl_b32 s52, s57, 14
    s_lshl_b32 s54, s45, 11
    s_add_u32 s52, s52, s54
    s_lshl_b32 s54, s44, 9
    s_add_u32 s52, s52, s54
    v_lshl_add_u32 v122, v1, 3, s52
    v_cmp_gt_u32 vcc, 45312, v120
    s_nop 1
    v_cndmask_b32 v120, v23, v120, vcc
    v_cmp_gt_u32 vcc, 45312, v121
    s_nop 1
    v_cndmask_b32 v121, v23, v121, vcc
    v_cmp_gt_u32 vcc, 136192, v122
    s_nop 1
    v_cndmask_b32 v122, v23, v122, vcc
    s_branch F1E
AGWOP:
    s_add_u32 s51, s51, 1
    s_cmp_lt_u32 s51, 0x40000
    s_cbranch_scc1 WOP
    s_branch OKWOP
HOOKD:
    ds_read_b128 v[20:23], v2 offset:256
    ds_read_b128 v[24:27], v2 offset:320
    ds_read_b128 v[28:31], v2 offset:384
    ds_read_b128 v[32:35], v2 offset:448
    s_waitcnt lgkmcnt(0)
    v_mfma_f32_16x16x32_bf16 v[40:43], v[20:23], v[64:67], 0
    v_mfma_f32_16x16x32_bf16 v[40:43], v[24:27], v[68:71], v[40:43]
    v_mfma_f32_16x16x32_bf16 v[40:43], v[28:31], v[72:75], v[40:43]
    v_mfma_f32_16x16x32_bf16 v[40:43], v[32:35], v[76:79], v[40:43]
    s_add_u32 s52, s62, 8192
    s_cmp_lg_u32 s50, 0
    s_cselect_b32 s53, s52, 1610612736
    s_cselect_b32 s54, 1610612736, s52
    s_nop 3
    buffer_store_dword v41, v55, s[16:19], s53 offen offset:0
    s_cmp_eq_u32 s50, 0
    s_cbranch_scc1 SLOW6
PUBD6:
    v_and_b32 v16, 7, v1
    v_lshlrev_b32 v16, 7, v16
    s_add_u32 s52, s0, 118784
EWQ:
    buffer_load_dword v17, v16, s[16:19], s52 offen sc1
    s_waitcnt vmcnt(0)
    v_cmp_u_f32 vcc, v17, v17
    s_cbranch_vccz EWQK
    s_add_u32 s51, s51, 1
    s_sleep 1
    s_cmp_lt_u32 s51, 0x40000
    s_cbranch_scc1 EWQ
EWQK:
    s_sleep 1
    s_mov_b32 s51, 0
    s_cmp_lt_u32 s46, 20
    s_cbranch_scc1 F1W
    s_mov_b32 s100, 3
    s_cmp_lg_u32 s50, 0
    s_cselect_b32 s53, s63, 1610612736
    s_cselect_b32 s54, 1610612736, s63
    buffer_store_dwordx4 v[116:119], v120, s[16:19], s53 offen offset:0
    buffer_store_dword v116, v121, s[16:19], s53 offen offset:0
    s_cmp_eq_u32 s50, 0
    s_cbranch_scc1 SLOW7
PUBD7:
    s_mov_b32 s52, 393216
    buffer_store_dwordx2 v[116:117], v122, s[16:19], s52 offen sc1
    s_branch F1P
AGF1P:
    s_add_u32 s51, s51, 1
    s_sleep 1
    s_cmp_lt_u32 s51, 0x40000
    s_cbranch_scc1 F1P
    s_branch OKF1P
HOOKI:
    s_add_u32 s52, s62, 8192
    buffer_load_dwordx4 v[104:107], v58, s[16:19], s52 offen offset:0 sc1
    buffer_load_dwordx4 v[108:111], v58, s[16:19], s52 offen offset:3072 sc1
    buffer_load_dwordx2 v[112:113], v59, s[16:19], s52 offen sc1
    ds_read_b64_tr_b16 v[80:81], v57 offset:0
    ds_read_b64_tr_b16 v[82:83], v57 offset:512
    ds_read_b64_tr_b16 v[84:85], v57 offset:4096
    ds_read_b64_tr_b16 v[86:87], v57 offset:4608
    ds_read_b64_tr_b16 v[88:89], v57 offset:8192
    ds_read_b64_tr_b16 v[90:91], v57 offset:8704
    ds_read_b64_tr_b16 v[92:93], v57 offset:12288
    ds_read_b64_tr_b16 v[94:95], v57 offset:12800
    ds_read_b64_tr_b16 v[96:97], v57 offset:16384
    ds_read_b64_tr_b16 v[98:99], v57 offset:16896
    ds_read_b64_tr_b16 v[100:101], v57 offset:20480
    ds_read_b64_tr_b16 v[102:103], v57 offset:20992
    v_mov_b32 v44, v44
    v_mov_b32 v44, v44
    v_mov_b32 v44, v44
    v_mov_b32 v44, v44
    v_mov_b32 v44, v44
    v_mov_b32 v44, v44
    buffer_load_dword v74, v60, s[16:19], s62 offen sc1
    buffer_load_dwordx4 v[64:67], v58, s[16:19], s62 offen offset:0 sc1
    buffer_load_dwordx4 v[68:71], v58, s[16:19], s62 offen offset:3072 sc1
    buffer_load_dwordx2 v[72:73], v59, s[16:19], s62 offen sc1
    buffer_load_dword v76, v61, s[16:19], s49 offen sc1
    v_mov_b32 v44, v44
    v_mov_b32 v44, v44
    v_mov_b32 v44, v44
    v_mov_b32 v44, v44
    v_mov_b32 v44, v44
    v_mov_b32 v44, v44
    v_mov_b32 v44, v44
    v_mov_b32 v44, v44
    v_mov_b32 v44, v44
    v_mov_b32 v44, v44
    v_mov_b32 v44, v44
    v_mov_b32 v44, v44
    v_mov_b32 v44, v44
    v_mov_b32 v44, v44
    v_mov_b32 v44, v44
    v_mov_b32 v44, v44
    s_waitcnt vmcnt(5)
GCC:
    v_pk_add_f32 v[114:115], v[104:105], v[106:107]
    v_pk_add_f32 v[116:117], v[108:109], v[110:111]
    v_add_f32 v126, v114, v115
    v_add_f32 v127, v116, v117
    v_pk_add_f32 v[126:127], v[126:127], v[112:113]
    v_cmp_u_f32 vcc, v126, v127
    s_cbranch_vccz W2P
    s_add_u32 s52, s62, 8192
    buffer_load_dwordx4 v[104:107], v58, s[16:19], s52 offen offset:0 sc1
    buffer_load_dwordx4 v[108:111], v58, s[16:19], s52 offen offset:3072 sc1
    buffer_load_dwordx2 v[112:113], v59, s[16:19], s52 offen sc1
    s_waitcnt vmcnt(0)
    s_add_u32 s51, s51, 1
    s_cmp_lt_u32 s51, 0x40000
    s_cbranch_scc1 GCC
    s_branch W2P
AGW2P:
    s_add_u32 s51, s51, 1
    s_cmp_lt_u32 s51, 0x40000
    s_cbranch_scc1 W2P
    s_branch OKW2P
AGY3P:
    s_add_u32 s51, s51, 1
    s_sleep 1
    s_cmp_lt_u32 s51, 0x40000
    s_cbranch_scc1 Y3P
    s_branch OKY3P
SLOW1:
    buffer_store_dword v30, v18, s[16:19], s35 offen offset:0 sc1
    s_branch PUBD1
SLOW2:
    buffer_store_dword v16, v14, s[16:19], s33 offen offset:0 sc1
    buffer_store_dword v20, v14, s[16:19], s33 offen offset:1024 sc1
    buffer_store_dword v24, v14, s[16:19], s33 offen offset:2048 sc1
    buffer_store_dwordx2 v[28:29], v15, s[16:19], s33 offen offset:0 sc1
    s_branch PUBD2
SLOW3:
    buffer_store_dword v24, v14, s[16:19], s33 offen offset:0 sc1
    s_branch PUBD3
SLOW4:
    buffer_store_dwordx2 v[32:33], v38, s[16:19], s54 offen offset:0 sc1
    buffer_store_dwordx2 v[34:35], v38, s[16:19], s54 offen offset:512 sc1
    buffer_store_dwordx2 v[36:37], v38, s[16:19], s54 offen offset:1024 sc1
    s_branch PUBD4
SLOW5:
    buffer_store_dwordx2 v[32:33], v38, s[16:19], s54 offen offset:0 sc1
    buffer_store_dwordx2 v[34:35], v38, s[16:19], s54 offen offset:512 sc1
    buffer_store_dwordx2 v[36:37], v38, s[16:19], s54 offen offset:1024 sc1
    s_branch PUBD5
SLOW6:
    buffer_store_dword v41, v55, s[16:19], s54 offen offset:0 sc1
    s_branch PUBD6
SLOW7:
    buffer_store_dwordx4 v[116:119], v120, s[16:19], s54 offen offset:0 sc1
    buffer_store_dword v116, v121, s[16:19], s54 offen offset:0 sc1
    s_branch PUBD7
SLOW8:
    buffer_store_dword v16, v54, s[16:19], s35 offen offset:0 sc1
    s_branch PUBD8
SLOW9:
    buffer_store_dword v40, v55, s[16:19], s33 offen offset:0 sc1
    buffer_store_dwordx2 v[36:37], v56, s[16:19], s33 offen offset:0 sc1
    s_branch PUBD9
CODEEND:
    s_endpgm
.section .rodata,"a"
.p2align 6
.amdhsa_kernel interleave_layers__sliding_block_cached__glu_gated_swiglu__decode_kernel
  .amdhsa_next_free_vgpr 512
  .amdhsa_next_free_sgpr 102
  .amdhsa_accum_offset 256
  .amdhsa_group_segment_fixed_size 0
  .amdhsa_kernarg_size 96
  .amdhsa_user_sgpr_count 2
  .amdhsa_user_sgpr_kernarg_segment_ptr 1
  .amdhsa_system_sgpr_workgroup_id_x 1
.end_amdhsa_kernel
```

```asm
; @launch grid=(256,1,1) block=(256,1,1) lds=143104
.amdgcn_target "amdgcn-amd-amdhsa--gfx950"
.text
.globl interleave_layers__sliding_block_cached__glu_gated_swiglu__decode_kernel
.p2align 8
.type interleave_layers__sliding_block_cached__glu_gated_swiglu__decode_kernel,@function
interleave_layers__sliding_block_cached__glu_gated_swiglu__decode_kernel:
    s_cmp_ge_u32 s2, 256
    s_cbranch_scc1 DONE
    s_load_dwordx16 s[64:79], s[0:1], 0
    s_load_dwordx8 s[80:87], s[0:1], 64
    s_memrealtime s[98:99]
    s_getpc_b64 s[60:61]
PCREF:
    v_lshlrev_b32 v14, 7, v0
    v_cmp_gt_u32 vcc, CODEEND-PCREF, v14
    v_mov_b32 v15, s61
    s_and_saveexec_b64 s[88:89], vcc
    s_cbranch_execz NOPF
    v_add_co_u32 v14, vcc, s60, v14
    s_nop 1
    v_addc_co_u32 v15, vcc, 0, v15, vcc
    global_load_dword v79, v[14:15], off
NOPF:
    s_mov_b64 exec, s[88:89]
    v_and_b32 v1, 63, v0
    v_lshrrev_b32 v13, 6, v0
    s_and_b32 s45, s2, 7
    v_readfirstlane_b32 s44, v13
    s_lshr_b32 s46, s2, 3
    s_lshr_b32 s7, s46, 3
    s_lshl_b32 s52, s45, 2
    s_add_u32 s47, s7, s52
    s_and_b32 s48, s46, 7
    v_lshrrev_b32 v19, 4, v1
    v_bfe_u32 v21, v1, 1, 3
    v_and_b32 v20, 1, v1
    v_mul_u32_u24 v80, 384, v21
    v_lshl_add_u32 v80, v20, 4, v80
    v_lshl_add_u32 v80, v19, 5, v80
    s_mul_i32 s52, s48, 3
    s_lshl_b32 s54, s44, 0
    s_add_u32 s52, s52, s54
    s_add_u32 s53, s48, 384
    s_cmp_eq_u32 s44, 3
    s_cselect_b32 s52, s53, s52
    s_cselect_b32 s97, 8, 24
    s_mulk_i32 s97, 3072
    s_mul_i32 s55, s47, 12582912
    s_mul_i32 s54, s52, 3072
    s_add_u32 s55, s55, s54
    s_add_u32 s55, s55, 11010048
    s_mov_b32 s96, s55
    s_waitcnt lgkmcnt(0)
    s_mov_b32 s8, s66
    s_and_b32 s9, s67, 0xffff
    s_mov_b32 s10, 402653184
    s_mov_b32 s11, 0x20000
    s_mov_b32 s6, 1
    s_mov_b32 s100, 0
    s_cmp_eq_u32 s44, 3
    s_cbranch_scc1 SETUP
    buffer_load_dwordx4 a[0:3], v80, s[8:11], s96 offen offset:0 nt
    buffer_load_dwordx4 a[8:11], v80, s[8:11], s96 offen offset:128 nt
    buffer_load_dwordx4 a[16:19], v80, s[8:11], s96 offen offset:256 nt
    s_add_u32 s96, s96, s97
    buffer_load_dwordx4 a[4:7], v80, s[8:11], s96 offen offset:0 nt
    buffer_load_dwordx4 a[12:15], v80, s[8:11], s96 offen offset:128 nt
    buffer_load_dwordx4 a[20:23], v80, s[8:11], s96 offen offset:256 nt
    s_add_u32 s96, s96, s97
SETUP:
    s_mov_b32 s16, s86
    s_and_b32 s17, s87, 0xffff
    s_mov_b32 s18, 1610612736
    s_mov_b32 s19, 0x20000
    s_mov_b32 s12, s68
    s_and_b32 s13, s69, 0xffff
    s_mov_b32 s14, 402653184
    s_mov_b32 s15, 0x20000
    s_mov_b32 s20, s70
    s_and_b32 s21, s71, 0xffff
    s_mov_b32 s22, 7864320
    s_mov_b32 s23, 0x20000
    s_mov_b32 s32, s64
    s_and_b32 s33, s65, 0xffff
    s_mov_b32 s34, 1280
    s_mov_b32 s35, 0x20000
    s_mov_b32 s36, s82
    s_and_b32 s37, s83, 0xffff
    s_mov_b32 s38, 1280
    s_mov_b32 s39, 0x20000
    s_mov_b32 s40, s84
    s_and_b32 s41, s85, 0xffff
    s_mov_b32 s42, 256
    s_mov_b32 s43, 0x20000
    v_mov_b32 v87, 1879048192
    v_mov_b32 v88, 1879048192
    v_mov_b32 v120, 1879048192
    v_mov_b32 v121, 1879048192
    v_mov_b32 v122, 1879048192
    s_cmp_lg_u32 s44, 3
    s_cbranch_scc1 SETUP2
    v_mov_b32 v32, -1
    v_mov_b32 v33, -1
    v_mov_b32 v34, -1
    v_mov_b32 v35, -1
    s_cmp_lg_u32 s2, 0
    s_cbranch_scc1 NONW
    s_or_b32 s101, s98, 0x20
    s_and_b32 s101, s101, 0xffffffe0
    v_mov_b32 v24, s101
    v_mov_b32 v25, 0
    s_mov_b64 exec, 1
    buffer_store_dword v24, v25, s[40:43], 0 offen sc1
    s_mov_b64 exec, -1
NONW:
    v_lshlrev_b32 v24, 4, v1
    v_lshlrev_b32 v27, 2, v1
    s_mul_i32 s52, s2, 1536
    v_lshlrev_b32 v28, 3, v1
    buffer_store_dwordx4 v[32:35], v24, s[16:19], s52 offen sc1
    buffer_store_dwordx2 v[32:33], v28, s[16:19], s52 offen offset:1024 sc1
    v_mov_b32 v26, 1879048192
    v_mov_b32 v88, v24
    v_cmp_gt_u32 vcc, 40, v1
    v_lshlrev_b32 v27, 2, v1
    buffer_load_dwordx4 v[44:47], v24, s[32:35], 0 offen
    buffer_load_dword v48, v27, s[32:35], 0 offen offset:1024
    v_cndmask_b32 v28, v26, v27, vcc
    s_mul_i32 s52, s48, 160
    buffer_load_dword v86, v28, s[32:35], s52 offen
    s_mul_i32 s52, s48, 320
    s_add_u32 s52, s52, 131072
    s_and_b32 s53, s2, 0xc7
    s_cmp_eq_u32 s53, 0
    s_cselect_b32 s52, s52, 1879048192
    v_lshl_add_u32 v87, v1, 3, s52
    v_cndmask_b32 v87, v26, v87, vcc
    v_add_u32 v24, 0, v1
    v_mul_u32_u24 v36, 171, v24
    v_lshrrev_b32 v36, 12, v36
    v_mul_u32_u24 v37, 24, v36
    v_sub_u32 v37, v24, v37
    v_and_b32 v24, 2, v36
    v_xor_b32 v37, v37, v24
    v_mul_u32_u24 v36, 12288, v36
    v_lshl_add_u32 v38, v37, 4, v36
    v_add_u32 v24, 64, v1
    v_mul_u32_u24 v36, 171, v24
    v_lshrrev_b32 v36, 12, v36
    v_mul_u32_u24 v37, 24, v36
    v_sub_u32 v37, v24, v37
    v_and_b32 v24, 2, v36
    v_xor_b32 v37, v37, v24
    v_mul_u32_u24 v36, 12288, v36
    v_lshl_add_u32 v39, v37, 4, v36
    v_add_u32 v24, 128, v1
    v_mul_u32_u24 v36, 171, v24
    v_lshrrev_b32 v36, 12, v36
    v_mul_u32_u24 v37, 24, v36
    v_sub_u32 v37, v24, v37
    v_and_b32 v24, 2, v36
    v_xor_b32 v37, v37, v24
    v_mul_u32_u24 v36, 12288, v36
    v_lshl_add_u32 v40, v37, 4, v36
    s_mul_i32 s52, s48, 983040
    s_mul_i32 s54, s47, 384
    s_add_u32 s52, s52, s54
    s_mov_b32 s53, 65536
WQL:
    s_add_u32 m0, s53, 0
    s_nop 0
    buffer_load_dwordx4 v38, s[20:23], s52 offen nt lds
    v_xor_b32 v38, 64, v38
    s_add_u32 m0, s53, 1024
    s_nop 0
    buffer_load_dwordx4 v39, s[20:23], s52 offen nt lds
    v_xor_b32 v39, 64, v39
    s_add_u32 m0, s53, 2048
    s_nop 0
    buffer_load_dwordx4 v40, s[20:23], s52 offen nt lds
    v_xor_b32 v40, 64, v40
    s_add_u32 s52, s52, 98304
    s_add_u32 s53, s53, 3072
    s_cmp_lt_u32 s53, 96256
    s_cbranch_scc1 WQL
    v_mov_b32 v37, 0
    buffer_load_dword v89, v37, s[40:43], 0 offen sc1
    s_barrier
    s_waitcnt vmcnt(31)
    v_mov_b32 v36, 0x3f803f80
    v_mov_b32 v37, v36
    v_cndmask_b32 v36, 0, v36, vcc
    v_add_u32 v27, 96256, v27
    ds_write_b32 v27, v36 offset:1152
    ds_write_b32 v27, v37 offset:1408
    ds_write_b32 v27, v86
    v_mov_b64 v[36:37], 0
    ds_write_b32 v27, v36 offset:12800
    ds_write_b32 v27, v36 offset:13056
    v_mov_b32 v38, 0x3f803f80
    v_dot2_f32_bf16 v36, v44, v44, v36
    v_dot2_f32_bf16 v37, v44, v38, v37
    v_dot2_f32_bf16 v36, v45, v45, v36
    v_dot2_f32_bf16 v37, v45, v38, v37
    v_dot2_f32_bf16 v36, v46, v46, v36
    v_dot2_f32_bf16 v37, v46, v38, v37
    v_dot2_f32_bf16 v36, v47, v47, v36
    v_dot2_f32_bf16 v37, v47, v38, v37
    v_dot2_f32_bf16 v36, v48, v48, v36
    v_dot2_f32_bf16 v37, v48, v38, v37
    s_nop 2
    v_add_f32_dpp v36, v36, v36 quad_perm:[1,0,3,2] row_mask:0xf bank_mask:0xf
    v_add_f32_dpp v37, v37, v37 quad_perm:[1,0,3,2] row_mask:0xf bank_mask:0xf
    s_nop 0
    v_add_f32_dpp v36, v36, v36 quad_perm:[2,3,0,1] row_mask:0xf bank_mask:0xf
    v_add_f32_dpp v37, v37, v37 quad_perm:[2,3,0,1] row_mask:0xf bank_mask:0xf
    s_nop 0
    v_add_f32_dpp v36, v36, v36 row_half_mirror row_mask:0xf bank_mask:0xf
    v_add_f32_dpp v37, v37, v37 row_half_mirror row_mask:0xf bank_mask:0xf
    s_nop 0
    v_add_f32_dpp v36, v36, v36 row_mirror row_mask:0xf bank_mask:0xf
    v_add_f32_dpp v37, v37, v37 row_mirror row_mask:0xf bank_mask:0xf
    s_nop 0
    v_mov_b32 v39, v36
    s_nop 1
    v_permlane16_swap_b32 v36, v39
    v_add_f32 v36, v36, v39
    v_mov_b32 v39, v37
    s_nop 1
    v_permlane16_swap_b32 v37, v39
    v_add_f32 v37, v37, v39
    v_mov_b32 v39, v36
    s_nop 1
    v_permlane32_swap_b32 v36, v39
    v_add_f32 v36, v36, v39
    v_mov_b32 v39, v37
    s_nop 1
    v_permlane32_swap_b32 v37, v39
    v_add_f32 v37, v37, v39
    v_mov_b32 v39, 0x3727c5ac
    v_mul_f32 v37, 0x3acccccd, v37
    v_fmamk_f32 v36, v36, 0x3acccccd, v39
    v_fma_f32 v36, -v37, v37, v36
    v_rsq_f32 v36, abs(v36)
    v_mov_b32 v84, v37
    v_mul_f32 v85, 0x3dd53b94, v36
SETUP2:
    s_cmp_ge_u32 s46, 10
    s_cselect_b32 s56, 1, 0
    s_cmp_ge_u32 s46, 20
    s_cselect_b32 s52, 2, s56
    s_mul_i32 s52, s52, 10
    s_sub_u32 s57, s46, s52
    s_min_u32 s4, s46, 29
    s_cmp_ge_u32 s4, 15
    s_cselect_b32 s58, 1, 0
    s_mul_i32 s52, s58, 15
    s_sub_u32 s52, s4, s52
    s_mul_i32 s59, s52, 52
    s_lshr_b32 s59, s59, 8
    s_mul_i32 s53, s59, 5
    s_sub_u32 s3, s52, s53
    s_cmp_ge_u32 s46, 20
    s_cselect_b32 s24, s80, s72
    s_cselect_b32 s25, s81, s73
    s_mov_b32 s26, 7864320
    s_cselect_b32 s26, 1966080, s26
    s_and_b32 s25, s25, 0xffff
    s_mov_b32 s27, 0x20000
    s_cmp_eq_u32 s58, 1
    s_cselect_b32 s28, s78, s76
    s_cselect_b32 s29, s79, s77
    s_and_b32 s29, s29, 0xffff
    s_mov_b32 s30, 1966080
    s_mov_b32 s31, 0x20000
    s_mov_b32 s49, 0
    s_mul_i32 s63, s45, 45312
    s_add_u32 s63, s63, 529408
    s_mul_i32 s62, s45, 28160
    s_add_u32 s62, s62, 136192
    s_mov_b32 s50, 0
    s_mov_b32 s0, 0
    v_and_b32 v24, 15, v1
    v_cmp_eq_u32 vcc, 1, v24
    v_mov_b32 v25, 96256
    v_mov_b32 v26, 97408
    v_cndmask_b32 v2, v25, v26, vcc
    v_lshl_add_u32 v2, v19, 4, v2
    v_and_b32 v24, 3, v1
    v_lshlrev_b32 v24, 4, v24
    v_and_b32 v25, 1, v19
    v_lshl_add_u32 v24, v25, 6, v24
    v_add_u32 v24, 98304, v24
    v_bfe_u32 v25, v1, 2, 2
    v_lshrrev_b32 v27, 5, v1
    v_sub_u32 v25, v25, v27
    v_mov_b32 v26, 109184
    v_cmp_eq_u32 vcc, 0, v25
    s_nop 1
    v_cndmask_b32 v3, v26, v24, vcc
    v_cmp_eq_u32 vcc, 2, v25
    s_nop 1
    v_cndmask_b32 v4, v26, v24, vcc
    v_and_b32 v24, 3, v1
    v_cmp_eq_u32 vcc, 3, v24
    v_mov_b32 v25, 0xffff
    v_mov_b32 v26, 0xffff0000
    v_cndmask_b32 v25, v25, v26, vcc
    v_cndmask_b32 v24, v24, 0, vcc
    v_or_b32 v24, 12, v24
    v_mul_u32_u24 v24, 0x1111, v24
    v_bfe_u32 v26, v1, 1, 1
    v_mul_u32_u24 v26, 0xaaaa, v26
    v_add_u32 v26, 0x4444, v26
    v_lshl_add_u32 v7, v24, 16, v26
    v_and_b32 v24, 4, v1
    v_cmp_eq_u32 vcc, 0, v24
    s_nop 1
    v_cndmask_b32 v5, 0, v25, vcc
    v_cndmask_b32 v6, v25, 0, vcc
    v_mul_u32_u24 v82, s97, v27
    v_bfe_u32 v24, v1, 3, 1
    v_mul_u32_u24 v24, 1536, v24
    v_add_u32 v82, v82, v24
    v_and_b32 v24, 1, v19
    v_mul_u32_u24 v24, 768, v24
    v_add_u32 v82, v82, v24
    v_and_b32 v24, 7, v1
    v_lshl_add_u32 v82, v24, 4, v82
    s_mul_i32 s52, s7, 6144
    s_add_u32 s52, s52, 20480
    v_lshl_add_u32 v8, v0, 4, s52
    s_lshl_b32 s52, s7, 6
    s_add_u32 s52, s52, 45056
    v_lshl_add_u32 v9, v24, 3, s52
    v_bfe_u32 v25, v1, 3, 1
    v_lshl_add_u32 v9, v25, 2, v9
    v_and_b32 v10, 0xe1, v0
    v_lshlrev_b32 v10, 1, v10
    v_bfe_u32 v24, v0, 4, 1
    v_lshl_add_u32 v10, v24, 3, v10
    v_bfe_u32 v24, v0, 3, 1
    v_lshl_add_u32 v10, v24, 4, v10
    v_bfe_u32 v24, v0, 2, 1
    v_lshl_add_u32 v10, v24, 2, v10
    v_bfe_u32 v24, v0, 1, 1
    v_lshl_add_u32 v10, v24, 5, v10
    v_add_u32 v10, 98304, v10
    v_mov_b32 v11, 0x3acccccd
    v_lshlrev_b32 v12, 4, v0
    v_add_u32 v12, 110336, v12
    s_cmp_lg_u32 s44, 3
    s_cbranch_scc1 KBAR
    s_lshr_b32 s53, s2, 4
    s_and_b32 s51, s2, 15
    s_lshl_b32 s52, s53, 14
    s_lshl_b32 s54, s51, 9
    s_add_u32 s52, s52, s54
    s_add_u32 s52, s52, 1835008
    s_and_b32 s53, s46, 1
    s_lshl_b32 s53, s53, 13
    s_add_u32 s52, s52, s53
    s_xor_b32 s53, s52, 8192
    s_memtime s[88:89]
    s_waitcnt lgkmcnt(0)
    s_buffer_load_dword s1, s[16:19], s52
    s_waitcnt lgkmcnt(0)
    s_memtime s[90:91]
    s_waitcnt lgkmcnt(0)
    s_buffer_load_dword s1, s[16:19], s53
    s_waitcnt lgkmcnt(0)
    s_memtime s[92:93]
    s_waitcnt lgkmcnt(0)
    s_sub_u32 s88, s90, s88
    s_sub_u32 s90, s92, s90
    s_cmp_lt_u32 s90, s88
    s_cselect_b32 s1, 1, 0
    s_xor_b32 s1, s1, s46
    s_getreg_b32 s52, hwreg(HW_REG_XCC_ID)
    s_lshr_b32 s52, s52, 2
    s_xor_b32 s1, s1, s52
    s_and_b32 s1, s1, 1
    s_lshl_b32 s1, s1, 4
    s_mov_b32 s51, 0
    v_mov_b32 v37, 0
NOP:
    s_waitcnt vmcnt(0)
    v_readfirstlane_b32 s5, v89
    s_cmp_lg_u32 s5, 0
    s_cbranch_scc1 NOOK
    buffer_load_dword v89, v37, s[40:43], 0 offen sc1
    s_add_u32 s51, s51, 1
    s_sleep 4
    s_cmp_lt_u32 s51, 0x40000
    s_cbranch_scc1 NOP
NOOK:
    s_getreg_b32 s52, hwreg(HW_REG_XCC_ID)
    s_and_b32 s52, s52, 15
    s_or_b32 s5, s5, s52
    s_or_b32 s1, s1, s5
    v_mov_b32 v36, s1
    s_lshl_b32 s52, s45, 7
    s_lshl_b32 s54, s46, 2
    s_add_u32 s52, s52, s54
    s_add_u32 s52, s52, 1376256
    s_mov_b64 exec, 1
    buffer_store_dword v36, v37, s[16:19], s52 offen sc1
    s_mov_b64 exec, -1
    s_mov_b32 s44, 0
    s_branch Q0L
KBAR:
    s_barrier
    s_waitcnt vmcnt(7)
    buffer_load_dwordx4 a[24:27], v80, s[8:11], s96 offen offset:0 nt
    s_waitcnt vmcnt(7)
    buffer_load_dwordx4 a[32:35], v80, s[8:11], s96 offen offset:128 nt
    s_waitcnt vmcnt(7)
    buffer_load_dwordx4 a[40:43], v80, s[8:11], s96 offen offset:256 nt
    s_add_u32 s96, s96, s97
    s_waitcnt vmcnt(7)
    buffer_load_dwordx4 a[28:31], v80, s[8:11], s96 offen offset:0 nt
    s_waitcnt vmcnt(7)
    buffer_load_dwordx4 a[36:39], v80, s[8:11], s96 offen offset:128 nt
    s_waitcnt vmcnt(7)
    buffer_load_dwordx4 a[44:47], v80, s[8:11], s96 offen offset:256 nt
    s_add_u32 s96, s96, s97
    s_waitcnt vmcnt(7)
    buffer_load_dwordx4 a[48:51], v80, s[8:11], s96 offen offset:0 nt
    s_waitcnt vmcnt(7)
    buffer_load_dwordx4 a[56:59], v80, s[8:11], s96 offen offset:128 nt
    s_waitcnt vmcnt(7)
    buffer_load_dwordx4 a[64:67], v80, s[8:11], s96 offen offset:256 nt
    s_add_u32 s96, s96, s97
    s_waitcnt vmcnt(7)
    buffer_load_dwordx4 a[52:55], v80, s[8:11], s96 offen offset:0 nt
    s_waitcnt vmcnt(7)
    buffer_load_dwordx4 a[60:63], v80, s[8:11], s96 offen offset:128 nt
    s_waitcnt vmcnt(7)
    buffer_load_dwordx4 a[68:71], v80, s[8:11], s96 offen offset:256 nt
    s_add_u32 s96, s96, s97
    s_waitcnt vmcnt(7)
    buffer_load_dwordx4 a[72:75], v80, s[8:11], s96 offen offset:0 nt
    s_waitcnt vmcnt(7)
    buffer_load_dwordx4 a[80:83], v80, s[8:11], s96 offen offset:128 nt
    s_waitcnt vmcnt(7)
    buffer_load_dwordx4 a[88:91], v80, s[8:11], s96 offen offset:256 nt
    s_add_u32 s96, s96, s97
    s_waitcnt vmcnt(7)
    buffer_load_dwordx4 a[76:79], v80, s[8:11], s96 offen offset:0 nt
    s_waitcnt vmcnt(7)
    buffer_load_dwordx4 a[84:87], v80, s[8:11], s96 offen offset:128 nt
    s_waitcnt vmcnt(7)
    buffer_load_dwordx4 a[92:95], v80, s[8:11], s96 offen offset:256 nt
    s_add_u32 s96, s96, s97
    s_waitcnt vmcnt(7)
    buffer_load_dwordx4 a[96:99], v80, s[8:11], s96 offen offset:0 nt
    s_waitcnt vmcnt(7)
    buffer_load_dwordx4 a[104:107], v80, s[8:11], s96 offen offset:128 nt
    s_waitcnt vmcnt(7)
    buffer_load_dwordx4 a[112:115], v80, s[8:11], s96 offen offset:256 nt
    s_add_u32 s96, s96, s97
    s_waitcnt vmcnt(7)
    buffer_load_dwordx4 a[100:103], v80, s[8:11], s96 offen offset:0 nt
    s_waitcnt vmcnt(7)
    buffer_load_dwordx4 a[108:111], v80, s[8:11], s96 offen offset:128 nt
    s_waitcnt vmcnt(7)
    buffer_load_dwordx4 a[116:119], v80, s[8:11], s96 offen offset:256 nt
    s_add_u32 s96, s96, s97
    s_waitcnt vmcnt(7)
    buffer_load_dwordx4 a[120:123], v80, s[8:11], s96 offen offset:0 nt
    s_waitcnt vmcnt(7)
    buffer_load_dwordx4 a[128:131], v80, s[8:11], s96 offen offset:128 nt
    s_waitcnt vmcnt(7)
    buffer_load_dwordx4 a[136:139], v80, s[8:11], s96 offen offset:256 nt
    s_add_u32 s96, s96, s97
    s_waitcnt vmcnt(7)
    buffer_load_dwordx4 a[124:127], v80, s[8:11], s96 offen offset:0 nt
    s_waitcnt vmcnt(7)
    buffer_load_dwordx4 a[132:135], v80, s[8:11], s96 offen offset:128 nt
    s_waitcnt vmcnt(7)
    buffer_load_dwordx4 a[140:143], v80, s[8:11], s96 offen offset:256 nt
    s_add_u32 s96, s96, s97
    s_waitcnt vmcnt(7)
    buffer_load_dwordx4 a[144:147], v80, s[8:11], s96 offen offset:0 nt
    s_waitcnt vmcnt(7)
    buffer_load_dwordx4 a[152:155], v80, s[8:11], s96 offen offset:128 nt
    s_waitcnt vmcnt(7)
    buffer_load_dwordx4 a[160:163], v80, s[8:11], s96 offen offset:256 nt
    s_add_u32 s96, s96, s97
    s_waitcnt vmcnt(7)
    buffer_load_dwordx4 a[148:151], v80, s[8:11], s96 offen offset:0 nt
    s_waitcnt vmcnt(7)
    buffer_load_dwordx4 a[156:159], v80, s[8:11], s96 offen offset:128 nt
    s_waitcnt vmcnt(7)
    buffer_load_dwordx4 a[164:167], v80, s[8:11], s96 offen offset:256 nt
    s_add_u32 s96, s96, s97
    s_waitcnt vmcnt(7)
    buffer_load_dwordx4 a[168:171], v80, s[8:11], s96 offen offset:0 nt
    s_waitcnt vmcnt(7)
    buffer_load_dwordx4 a[176:179], v80, s[8:11], s96 offen offset:128 nt
    s_waitcnt vmcnt(7)
    buffer_load_dwordx4 a[184:187], v80, s[8:11], s96 offen offset:256 nt
    s_add_u32 s96, s96, s97
    s_waitcnt vmcnt(7)
    buffer_load_dwordx4 a[172:175], v80, s[8:11], s96 offen offset:0 nt
    s_waitcnt vmcnt(7)
    buffer_load_dwordx4 a[180:183], v80, s[8:11], s96 offen offset:128 nt
    s_waitcnt vmcnt(7)
    buffer_load_dwordx4 a[188:191], v80, s[8:11], s96 offen offset:256 nt
    s_lshl_b32 s97, s97, 1
    s_waitcnt vmcnt(7)
    buffer_load_dwordx4 a[192:195], v82, s[12:15], s55 offen offset:0 nt
    s_waitcnt vmcnt(7)
    buffer_load_dwordx4 a[200:203], v82, s[12:15], s55 offen offset:128 nt
    s_waitcnt vmcnt(7)
    buffer_load_dwordx4 a[208:211], v82, s[12:15], s55 offen offset:256 nt
    s_waitcnt vmcnt(7)
    buffer_load_dwordx4 a[216:219], v82, s[12:15], s55 offen offset:384 nt
    s_waitcnt vmcnt(7)
    buffer_load_dwordx4 a[224:227], v82, s[12:15], s55 offen offset:512 nt
    s_waitcnt vmcnt(7)
    buffer_load_dwordx4 a[232:235], v82, s[12:15], s55 offen offset:640 nt
    s_add_u32 s55, s55, s97
    s_waitcnt vmcnt(7)
    buffer_load_dwordx4 a[196:199], v82, s[12:15], s55 offen offset:0 nt
    s_waitcnt vmcnt(7)
    buffer_load_dwordx4 a[204:207], v82, s[12:15], s55 offen offset:128 nt
    s_waitcnt vmcnt(7)
    buffer_load_dwordx4 a[212:215], v82, s[12:15], s55 offen offset:256 nt
    s_waitcnt vmcnt(7)
    buffer_load_dwordx4 a[220:223], v82, s[12:15], s55 offen offset:384 nt
    s_waitcnt vmcnt(7)
    buffer_load_dwordx4 a[228:231], v82, s[12:15], s55 offen offset:512 nt
    s_waitcnt vmcnt(7)
    buffer_load_dwordx4 a[236:239], v82, s[12:15], s55 offen offset:640 nt
    s_add_u32 s55, s55, s97
    s_waitcnt vmcnt(7)
    buffer_load_dwordx4 a[240:243], v82, s[12:15], s55 offen offset:0 nt
    s_waitcnt vmcnt(7)
    buffer_load_dwordx4 a[248:251], v82, s[12:15], s55 offen offset:128 nt
    s_waitcnt vmcnt(7)
    buffer_load_dwordx4 v[128:131], v82, s[12:15], s55 offen offset:256 nt
    s_waitcnt vmcnt(7)
    buffer_load_dwordx4 v[136:139], v82, s[12:15], s55 offen offset:384 nt
    s_waitcnt vmcnt(7)
    buffer_load_dwordx4 v[144:147], v82, s[12:15], s55 offen offset:512 nt
    s_waitcnt vmcnt(7)
    buffer_load_dwordx4 v[152:155], v82, s[12:15], s55 offen offset:640 nt
    s_add_u32 s55, s55, s97
    s_waitcnt vmcnt(7)
    buffer_load_dwordx4 a[244:247], v82, s[12:15], s55 offen offset:0 nt
    s_waitcnt vmcnt(7)
    buffer_load_dwordx4 a[252:255], v82, s[12:15], s55 offen offset:128 nt
    s_waitcnt vmcnt(7)
    buffer_load_dwordx4 v[132:135], v82, s[12:15], s55 offen offset:256 nt
    s_waitcnt vmcnt(7)
    buffer_load_dwordx4 v[140:143], v82, s[12:15], s55 offen offset:384 nt
    s_waitcnt vmcnt(7)
    buffer_load_dwordx4 v[148:151], v82, s[12:15], s55 offen offset:512 nt
    s_waitcnt vmcnt(7)
    buffer_load_dwordx4 v[156:159], v82, s[12:15], s55 offen offset:640 nt
    s_add_u32 s55, s55, s97
    s_waitcnt vmcnt(7)
    buffer_load_dwordx4 v[160:163], v82, s[12:15], s55 offen offset:0 nt
    s_waitcnt vmcnt(7)
    buffer_load_dwordx4 v[168:171], v82, s[12:15], s55 offen offset:128 nt
    s_waitcnt vmcnt(7)
    buffer_load_dwordx4 v[176:179], v82, s[12:15], s55 offen offset:256 nt
    s_waitcnt vmcnt(7)
    buffer_load_dwordx4 v[184:187], v82, s[12:15], s55 offen offset:384 nt
    s_waitcnt vmcnt(7)
    buffer_load_dwordx4 v[192:195], v82, s[12:15], s55 offen offset:512 nt
    s_waitcnt vmcnt(7)
    buffer_load_dwordx4 v[200:203], v82, s[12:15], s55 offen offset:640 nt
    s_add_u32 s55, s55, s97
    s_waitcnt vmcnt(7)
    buffer_load_dwordx4 v[164:167], v82, s[12:15], s55 offen offset:0 nt
    s_waitcnt vmcnt(7)
    buffer_load_dwordx4 v[172:175], v82, s[12:15], s55 offen offset:128 nt
    s_waitcnt vmcnt(7)
    buffer_load_dwordx4 v[180:183], v82, s[12:15], s55 offen offset:256 nt
    s_waitcnt vmcnt(7)
    buffer_load_dwordx4 v[188:191], v82, s[12:15], s55 offen offset:384 nt
    s_waitcnt vmcnt(7)
    buffer_load_dwordx4 v[196:199], v82, s[12:15], s55 offen offset:512 nt
    s_waitcnt vmcnt(7)
    buffer_load_dwordx4 v[204:207], v82, s[12:15], s55 offen offset:640 nt
    s_add_u32 s55, s55, s97
    s_waitcnt vmcnt(7)
    buffer_load_dwordx4 v[208:211], v82, s[12:15], s55 offen offset:0 nt
    s_waitcnt vmcnt(7)
    buffer_load_dwordx4 v[216:219], v82, s[12:15], s55 offen offset:128 nt
    s_waitcnt vmcnt(7)
    buffer_load_dwordx4 v[224:227], v82, s[12:15], s55 offen offset:256 nt
    s_waitcnt vmcnt(7)
    buffer_load_dwordx4 v[232:235], v82, s[12:15], s55 offen offset:384 nt
    s_waitcnt vmcnt(7)
    buffer_load_dwordx4 v[240:243], v82, s[12:15], s55 offen offset:512 nt
    s_waitcnt vmcnt(7)
    buffer_load_dwordx4 v[248:251], v82, s[12:15], s55 offen offset:640 nt
    s_add_u32 s55, s55, s97
    s_waitcnt vmcnt(7)
    buffer_load_dwordx4 v[212:215], v82, s[12:15], s55 offen offset:0 nt
    s_waitcnt vmcnt(7)
    buffer_load_dwordx4 v[220:223], v82, s[12:15], s55 offen offset:128 nt
    s_waitcnt vmcnt(7)
    buffer_load_dwordx4 v[228:231], v82, s[12:15], s55 offen offset:256 nt
    s_barrier
    s_waitcnt vmcnt(7)
    buffer_load_dwordx4 v[236:239], v82, s[12:15], s55 offen offset:384 nt
    s_waitcnt vmcnt(7)
    buffer_load_dwordx4 v[244:247], v82, s[12:15], s55 offen offset:512 nt
    s_waitcnt vmcnt(7)
    buffer_load_dwordx4 v[252:255], v82, s[12:15], s55 offen offset:640 nt
    s_branch TABLES
LOOP:
    ds_read_b128 v[14:17], v12 offset:24576
    ds_read_b128 v[18:21], v12 offset:28672
    s_mov_b32 s55, s99
    s_mov_b32 s51, 0
    s_cmp_lg_u32 s49, 0
    s_cbranch_scc1 FINAL
    s_waitcnt lgkmcnt(0)
QTR:
    ds_read_b64_tr_b16 v[44:45], v19 offset:0
    ds_read_b64_tr_b16 v[46:47], v19 offset:1536
    ds_read_b64_tr_b16 v[56:57], v19 offset:128
    ds_read_b64_tr_b16 v[58:59], v19 offset:1664
    ds_read_b64_tr_b16 v[68:69], v19 offset:256
    ds_read_b64_tr_b16 v[70:71], v19 offset:1792
    ds_read_b64_tr_b16 v[48:49], v19 offset:12288
    ds_read_b64_tr_b16 v[50:51], v19 offset:13824
    ds_read_b64_tr_b16 v[60:61], v19 offset:12416
    ds_read_b64_tr_b16 v[62:63], v19 offset:13952
    ds_read_b64_tr_b16 v[72:73], v19 offset:12544
    ds_read_b64_tr_b16 v[74:75], v19 offset:14080
    ds_read_b64_tr_b16 v[52:53], v20 offset:24576
    ds_read_b64_tr_b16 v[54:55], v20 offset:26112
    ds_read_b64_tr_b16 v[64:65], v20 offset:24704
    ds_read_b64_tr_b16 v[66:67], v20 offset:26240
    ds_read_b64_tr_b16 v[76:77], v20 offset:24832
    ds_read_b64_tr_b16 v[78:79], v20 offset:26368
    s_cmp_lg_u32 s6, 0
    s_cbranch_scc1 QA0
    s_mov_b32 s96, s62
    s_mov_b32 s49, 393216
    s_mov_b32 s62, s63
    s_cmp_lg_u32 s50, 0
    s_cselect_b32 s32, s62, 1610612736
    s_cselect_b32 s33, 1610612736, s62
    s_cmp_lg_u32 s50, 0
    s_cselect_b32 s34, s49, 1610612736
    s_cselect_b32 s35, 1610612736, s49
    s_add_u32 s99, s49, s0
    s_xor_b32 s1, s99, 8192
    s_cmp_eq_u32 s44, 3
    s_cbranch_scc1 QX
    s_sub_u32 s52, s46, 20
    s_cmp_ge_u32 s52, 10
    s_cbranch_scc1 HOOKL
    v_lshlrev_b32 v30, 3, v0
    s_mul_i32 s52, s47, 12288
    s_add_u32 s52, s52, 1441792
    s_add_u32 s53, s52, 0
    buffer_load_dwordx2 v[32:33], v30, s[16:19], s53 offen offset:0 sc1
    buffer_load_dwordx2 v[34:35], v30, s[16:19], s53 offen offset:1536 sc1
    s_add_u32 s53, s52, 3072
    buffer_load_dwordx2 v[36:37], v30, s[16:19], s53 offen offset:0 sc1
    buffer_load_dwordx2 v[38:39], v30, s[16:19], s53 offen offset:1536 sc1
    s_add_u32 s53, s52, 6144
    buffer_load_dwordx2 v[40:41], v30, s[16:19], s53 offen offset:0 sc1
    buffer_load_dwordx2 v[42:43], v30, s[16:19], s53 offen offset:1536 sc1
    s_add_u32 s53, s52, 9216
    buffer_load_dwordx2 v[26:27], v30, s[16:19], s53 offen offset:0 sc1
    buffer_load_dwordx2 v[28:29], v30, s[16:19], s53 offen offset:1536 sc1
    s_sleep 5
GYB:
    buffer_load_dword v22, v16, s[16:19], s55 offen offset:0 sc1
    buffer_load_dword v23, v16, s[16:19], s55 offen offset:128 sc1
    buffer_load_dword v24, v16, s[16:19], s55 offen offset:256 sc1
    buffer_load_dword v25, v16, s[16:19], s55 offen offset:384 sc1
    s_waitcnt vmcnt(4)
QCP:
    v_bitop3_b32 v33, v32, v33, s101 bitop3:0x96
    v_bitop3_b32 v35, v34, v35, s101 bitop3:0x96
    v_bitop3_b32 v37, v36, v37, s101 bitop3:0x96
    v_bitop3_b32 v39, v38, v39, s101 bitop3:0x96
    v_bitop3_b32 v41, v40, v41, s101 bitop3:0x96
    v_bitop3_b32 v43, v42, v43, s101 bitop3:0x96
    v_bitop3_b32 v27, v26, v27, s101 bitop3:0x96
    v_bitop3_b32 v29, v28, v29, s101 bitop3:0x96
    v_add_f32 v13, v32, v34
    v_add_f32 v13, v13, v36
    v_add_f32 v13, v13, v38
    v_add_f32 v13, v13, v40
    v_add_f32 v13, v13, v42
    v_add_f32 v13, v13, v26
    v_add_f32 v13, v13, v28
    v_or3_b32 v33, v33, v35, v37
    v_or3_b32 v33, v33, v39, v41
    v_or3_b32 v33, v33, v43, v27
    v_or_b32 v33, v33, v29
    v_cmp_ne_u32 vcc, 0, v33
    s_cbranch_vccnz QCA
Y2W:
    s_waitcnt vmcnt(0)
    v_pk_add_f32 v[22:23], v[22:23], v[24:25]
    v_add_f32 v30, v22, v23
    v_mov_b32 v31, v30
    s_nop 1
    v_permlane32_swap_b32 v30, v31
    v_add_f32 v30, v30, v31
    v_cmp_u_f32 vcc, v30, v30
    v_cvt_pk_bf16_f32 v30, v30, v30
    ds_write_b16 v17, v30
    s_cbranch_vccnz AGY2P
OKY2P:
    v_and_b32 v30, 0xffff0000, v30
    buffer_store_dword v30, v18, s[16:19], s34 offen offset:0
    s_cmp_eq_u32 s50, 0
    s_cbranch_scc1 SLOW1
PUBD1:
QX:
    s_waitcnt lgkmcnt(0)
    s_barrier
QA0:
    ds_read_b128 v[32:35], v2 offset:0
    ds_read_b128 v[36:39], v2 offset:64
    ds_read_b128 v[40:43], v2 offset:128
    s_cmp_lg_u32 s6, 0
    s_waitcnt lgkmcnt(2)
    v_mfma_f32_16x16x32_bf16 v[28:31], v[32:35], v[32:35], 0
    v_mfma_f32_16x16x32_bf16 v[16:19], v[32:35], v[44:47], 0
    v_mfma_f32_16x16x32_bf16 v[20:23], v[32:35], v[56:59], 0
    v_mfma_f32_16x16x32_bf16 v[24:27], v[32:35], v[68:71], 0
    s_waitcnt lgkmcnt(1)
    v_mfma_f32_16x16x32_bf16 v[28:31], v[36:39], v[36:39], v[28:31]
    v_mfma_f32_16x16x32_bf16 v[16:19], v[36:39], v[48:51], v[16:19]
    v_mfma_f32_16x16x32_bf16 v[20:23], v[36:39], v[60:63], v[20:23]
    v_mfma_f32_16x16x32_bf16 v[24:27], v[36:39], v[72:75], v[24:27]
    s_waitcnt lgkmcnt(0)
    v_mfma_f32_16x16x32_bf16 v[16:19], v[40:43], v[52:55], v[16:19]
    v_mfma_f32_16x16x32_bf16 v[20:23], v[40:43], v[64:67], v[20:23]
    v_mfma_f32_16x16x32_bf16 v[24:27], v[40:43], v[76:79], v[24:27]
    v_mfma_f32_16x16x32_bf16 v[28:31], v[40:43], v[40:43], v[28:31]
    s_cbranch_scc1 HOOKA
    v_mov_b64 v[64:65], 0
    v_mov_b64 v[66:67], 0
    v_mov_b64 v[68:69], 0
    v_mov_b64 v[70:71], 0
    buffer_store_dword v16, v14, s[16:19], s32 offen offset:0
    buffer_store_dword v20, v14, s[16:19], s32 offen offset:1024
    buffer_store_dword v24, v14, s[16:19], s32 offen offset:2048
    buffer_store_dwordx2 v[28:29], v15, s[16:19], s32 offen offset:0
    s_cmp_eq_u32 s50, 0
    s_cbranch_scc1 SLOW2
PUBD2:
    ds_read_b64 v[14:15], v12 offset:0
    ds_read_b64 v[60:61], v12 offset:8
    s_cmp_eq_u32 s44, 3
    s_cbranch_scc1 EN3
    s_sleep 3
    buffer_load_dword v62, v9, s[16:19], s62 offen sc1
    buffer_load_dwordx4 v[52:55], v8, s[16:19], s62 offen offset:0 sc1
    buffer_load_dwordx4 v[56:59], v8, s[16:19], s62 offen offset:3072 sc1
    v_mov_b64 v[72:73], 0
    v_mov_b64 v[74:75], 0
    v_mov_b64 v[76:77], 0
    v_mov_b64 v[78:79], 0
    v_mov_b64 v[40:41], 0
    v_mov_b64 v[42:43], 0
    v_mov_b64 v[44:45], 0
    v_mov_b64 v[46:47], 0
    v_mov_b64 v[48:49], 0
    v_mov_b64 v[50:51], 0
    s_mov_b32 s51, 0
    v_mov_b32 v37, 0x3c75e03e
    v_mov_b32 v38, 0x3a71d1e6
    v_mov_b32 v39, 0x3e13985d
    v_mul_f32 v13, 0x3dd53b95, v13
    s_sleep 1
ENP:
    buffer_load_dword v62, v9, s[16:19], s62 offen sc1
    buffer_load_dwordx4 v[52:55], v8, s[16:19], s62 offen offset:0 sc1
    buffer_load_dwordx4 v[56:59], v8, s[16:19], s62 offen offset:3072 sc1
    s_waitcnt vmcnt(3)
    v_add_f32_dpp v32, v62, v62 quad_perm:[1,0,3,2] row_mask:0xf bank_mask:0xf
    v_pk_add_f32 v[16:17], v[52:53], v[54:55]
    v_pk_add_f32 v[20:21], v[56:57], v[58:59]
    v_add_f32_dpp v32, v32, v32 quad_perm:[2,3,0,1] row_mask:0xf bank_mask:0xf
    v_pk_add_f32 v[16:17], v[16:17], v[20:21]
    v_mov_b32 v34, v38
    v_add_f32_dpp v32, v32, v32 row_half_mirror row_mask:0xf bank_mask:0xf
    v_add_f32 v16, v16, v17
    s_nop 0
    v_mul_f32_dpp v33, v32, v37 row_newbcast:8 row_mask:0xf bank_mask:0xf
    v_fmac_f32_dpp v34, v32, v39 row_newbcast:0 row_mask:0xf bank_mask:0xf
    v_fma_f32 v34, -v33, v33, v34
    v_rsq_f32 v34, abs(v34)
    v_fma_f32 v16, -v33, v13, v16
    v_mul_f32 v16, v16, v34
    v_cvt_pk_bf16_f32 v17, v16, v16
    ds_write_b16 v10, v17
    v_cmp_u_f32 vcc, v16, v16
    s_cbranch_vccnz AGENP
OKENP:
ENOK2:
    s_waitcnt lgkmcnt(0)
    s_barrier
QFRAG:
    ds_read_b128 v[16:19], v3 offset:0
    ds_read_b128 v[20:23], v3 offset:128
    ds_read_b128 v[24:27], v3 offset:256
    ds_read_b128 v[28:31], v4 offset:0
    ds_read_b128 v[32:35], v4 offset:128
    ds_read_b128 v[36:39], v4 offset:256
    s_cmp_eq_u32 s49, 0
    s_cbranch_scc1 HOOKF
    s_waitcnt vmcnt(0)
QK:
    s_waitcnt lgkmcnt(5)
    v_smfmac_f32_16x16x64_bf16 v[64:67], v[16:19], a[0:7], v7
    s_waitcnt lgkmcnt(4)
    v_smfmac_f32_16x16x64_bf16 v[64:67], v[20:23], a[8:15], v7
    s_waitcnt lgkmcnt(3)
    v_smfmac_f32_16x16x64_bf16 v[64:67], v[24:27], a[16:23], v7
    s_waitcnt lgkmcnt(2)
    v_smfmac_f32_16x16x64_bf16 v[64:67], v[28:31], a[24:31], v7
    s_waitcnt lgkmcnt(1)
    v_smfmac_f32_16x16x64_bf16 v[64:67], v[32:35], a[32:39], v7
    s_waitcnt lgkmcnt(0)
    v_smfmac_f32_16x16x64_bf16 v[64:67], v[36:39], a[40:47], v7
    v_smfmac_f32_16x16x64_bf16 v[68:71], v[16:19], a[48:55], v7
    v_smfmac_f32_16x16x64_bf16 v[68:71], v[20:23], a[56:63], v7
    v_smfmac_f32_16x16x64_bf16 v[68:71], v[24:27], a[64:71], v7
    v_smfmac_f32_16x16x64_bf16 v[68:71], v[28:31], a[72:79], v7
    v_smfmac_f32_16x16x64_bf16 v[68:71], v[32:35], a[80:87], v7
    v_smfmac_f32_16x16x64_bf16 v[68:71], v[36:39], a[88:95], v7
    v_smfmac_f32_16x16x64_bf16 v[72:75], v[16:19], a[96:103], v7
    v_smfmac_f32_16x16x64_bf16 v[72:75], v[20:23], a[104:111], v7
    v_smfmac_f32_16x16x64_bf16 v[72:75], v[24:27], a[112:119], v7
    v_pk_add_f32 v[64:65], v[64:65], v[66:67]
    v_smfmac_f32_16x16x64_bf16 v[72:75], v[28:31], a[120:127], v7
    v_smfmac_f32_16x16x64_bf16 v[72:75], v[32:35], a[128:135], v7
    v_add_f32_dpp v52, v65, v64 quad_perm:[1,1,3,3] row_mask:0xf bank_mask:0xf
    v_smfmac_f32_16x16x64_bf16 v[72:75], v[36:39], a[136:143], v7
    v_smfmac_f32_16x16x64_bf16 v[76:79], v[16:19], a[144:151], v7
    v_smfmac_f32_16x16x64_bf16 v[76:79], v[20:23], a[152:159], v7
    v_smfmac_f32_16x16x64_bf16 v[76:79], v[24:27], a[160:167], v7
    v_pk_add_f32 v[68:69], v[68:69], v[70:71]
    v_smfmac_f32_16x16x64_bf16 v[76:79], v[28:31], a[168:175], v7
    v_smfmac_f32_16x16x64_bf16 v[76:79], v[32:35], a[176:183], v7
    v_add_f32_dpp v53, v69, v68 quad_perm:[1,1,3,3] row_mask:0xf bank_mask:0xf
    v_smfmac_f32_16x16x64_bf16 v[76:79], v[36:39], a[184:191], v7
    v_pk_add_f32 v[72:73], v[72:73], v[74:75]
    v_max_f32 v62, v52, v53
    s_nop 0
    v_add_f32_dpp v54, v73, v72 quad_perm:[1,1,3,3] row_mask:0xf bank_mask:0xf
    s_nop 3
    v_pk_add_f32 v[76:77], v[76:77], v[78:79]
    s_nop 1
    v_add_f32_dpp v55, v77, v76 quad_perm:[1,1,3,3] row_mask:0xf bank_mask:0xf
    v_max3_f32 v62, v62, v54, v55
    s_nop 1
    v_max_f32_dpp v62, v62, v62 quad_perm:[2,3,0,1] row_mask:0xf bank_mask:0xf
    s_nop 1
    v_max_f32_dpp v62, v62, v62 row_ror:4 row_mask:0xf bank_mask:0xf
    s_nop 1
    v_max_f32_dpp v62, v62, v62 row_ror:8 row_mask:0xf bank_mask:0xf
    v_mov_b32 v63, v62
    s_nop 1
    v_permlane16_swap_b32 v62, v63
    v_max_f32 v62, v62, v63
    v_mov_b32 v63, v62
    s_nop 1
    v_permlane32_swap_b32 v62, v63
    v_max_f32 v62, v62, v63
    v_pk_add_f32 v[52:53], v[52:53], v[62:63] op_sel_hi:[1,0] neg_lo:[0,1] neg_hi:[0,1]
    v_exp_f32 v52, v52
    v_pk_add_f32 v[54:55], v[54:55], v[62:63] op_sel_hi:[1,0] neg_lo:[0,1] neg_hi:[0,1]
    v_cvt_pk_bf16_f32 v56, v52, v52
    v_exp_f32 v53, v53
    v_exp_f32 v54, v54
    v_and_b32_dpp v16, v56, v5 quad_perm:[0,0,0,0] row_mask:0xf bank_mask:0xf
    v_and_b32_dpp v19, v56, v6 quad_perm:[0,0,0,0] row_mask:0xf bank_mask:0xf
    v_exp_f32 v55, v55
    v_mov_b32_dpp v17, v16 row_shr:4 row_mask:0xf bank_mask:0xf bound_ctrl:0
    v_mov_b32_dpp v18, v19 row_shl:4 row_mask:0xf bank_mask:0xf bound_ctrl:0
    v_cvt_pk_bf16_f32 v57, v53, v53
    s_waitcnt vmcnt(36)
    v_smfmac_f32_16x16x64_bf16 v[40:43], v[16:19], a[192:199], v7 abid:1
    ds_read_b128 v[64:67], v12 offset:4096
    v_and_b32_dpp v20, v56, v5 quad_perm:[2,2,2,2] row_mask:0xf bank_mask:0xf
    v_and_b32_dpp v23, v56, v6 quad_perm:[2,2,2,2] row_mask:0xf bank_mask:0xf
    v_smfmac_f32_16x16x64_bf16 v[44:47], v[16:19], a[200:207], v7 abid:1
    v_mov_b32_dpp v21, v20 row_shr:4 row_mask:0xf bank_mask:0xf bound_ctrl:0
    v_mov_b32_dpp v22, v23 row_shl:4 row_mask:0xf bank_mask:0xf bound_ctrl:0
    v_cvt_pk_bf16_f32 v58, v54, v54
    v_pk_add_f32 v[24:25], v[52:53], v[54:55]
    v_smfmac_f32_16x16x64_bf16 v[48:51], v[16:19], a[208:215], v7 abid:1
    v_smfmac_f32_16x16x64_bf16 v[40:43], v[20:23], a[216:223], v7 abid:1
    ds_read_b128 v[68:71], v12 offset:8192
    v_and_b32_dpp v16, v57, v5 quad_perm:[0,0,0,0] row_mask:0xf bank_mask:0xf
    v_and_b32_dpp v19, v57, v6 quad_perm:[0,0,0,0] row_mask:0xf bank_mask:0xf
    v_smfmac_f32_16x16x64_bf16 v[44:47], v[20:23], a[224:231], v7 abid:1
    v_mov_b32_dpp v17, v16 row_shr:4 row_mask:0xf bank_mask:0xf bound_ctrl:0
    v_mov_b32_dpp v18, v19 row_shl:4 row_mask:0xf bank_mask:0xf bound_ctrl:0
    v_cvt_pk_bf16_f32 v59, v55, v55
    v_add_f32 v63, v24, v25
    v_smfmac_f32_16x16x64_bf16 v[48:51], v[20:23], a[232:239], v7 abid:1
    s_waitcnt vmcnt(24)
    v_smfmac_f32_16x16x64_bf16 v[40:43], v[16:19], a[240:247], v7 abid:1
    v_and_b32_dpp v20, v57, v5 quad_perm:[2,2,2,2] row_mask:0xf bank_mask:0xf
    v_and_b32_dpp v23, v57, v6 quad_perm:[2,2,2,2] row_mask:0xf bank_mask:0xf
    v_smfmac_f32_16x16x64_bf16 v[44:47], v[16:19], a[248:255], v7 abid:1
    v_mov_b32_dpp v21, v20 row_shr:4 row_mask:0xf bank_mask:0xf bound_ctrl:0
    v_mov_b32_dpp v22, v23 row_shl:4 row_mask:0xf bank_mask:0xf bound_ctrl:0
    v_add_f32_dpp v63, v63, v63 quad_perm:[2,3,0,1] row_mask:0xf bank_mask:0xf
    v_smfmac_f32_16x16x64_bf16 v[48:51], v[16:19], v[128:135], v7 abid:1
    v_smfmac_f32_16x16x64_bf16 v[40:43], v[20:23], v[136:143], v7 abid:1
    v_add_f32_dpp v63, v63, v63 row_ror:4 row_mask:0xf bank_mask:0xf
    v_and_b32_dpp v16, v58, v5 quad_perm:[0,0,0,0] row_mask:0xf bank_mask:0xf
    v_and_b32_dpp v19, v58, v6 quad_perm:[0,0,0,0] row_mask:0xf bank_mask:0xf
    v_smfmac_f32_16x16x64_bf16 v[44:47], v[20:23], v[144:151], v7 abid:1
    v_mov_b32_dpp v17, v16 row_shr:4 row_mask:0xf bank_mask:0xf bound_ctrl:0
    v_mov_b32_dpp v18, v19 row_shl:4 row_mask:0xf bank_mask:0xf bound_ctrl:0
    v_add_f32_dpp v63, v63, v63 row_ror:8 row_mask:0xf bank_mask:0xf
    v_mov_b32 v24, v63
    v_smfmac_f32_16x16x64_bf16 v[48:51], v[20:23], v[152:159], v7 abid:1
    s_waitcnt vmcnt(12)
    v_smfmac_f32_16x16x64_bf16 v[40:43], v[16:19], v[160:167], v7 abid:1
    v_permlane16_swap_b32 v63, v24
    v_add_f32 v63, v63, v24
    v_and_b32_dpp v20, v58, v5 quad_perm:[2,2,2,2] row_mask:0xf bank_mask:0xf
    v_and_b32_dpp v23, v58, v6 quad_perm:[2,2,2,2] row_mask:0xf bank_mask:0xf
    v_smfmac_f32_16x16x64_bf16 v[44:47], v[16:19], v[168:175], v7 abid:1
    v_mov_b32_dpp v21, v20 row_shr:4 row_mask:0xf bank_mask:0xf bound_ctrl:0
    v_mov_b32_dpp v22, v23 row_shl:4 row_mask:0xf bank_mask:0xf bound_ctrl:0
    v_mov_b32 v24, v63
    v_smfmac_f32_16x16x64_bf16 v[48:51], v[16:19], v[176:183], v7 abid:1
    v_smfmac_f32_16x16x64_bf16 v[40:43], v[20:23], v[184:191], v7 abid:1
    v_permlane32_swap_b32 v63, v24
    v_add_f32 v63, v63, v24
    v_and_b32_dpp v16, v59, v5 quad_perm:[0,0,0,0] row_mask:0xf bank_mask:0xf
    v_and_b32_dpp v19, v59, v6 quad_perm:[0,0,0,0] row_mask:0xf bank_mask:0xf
    v_smfmac_f32_16x16x64_bf16 v[44:47], v[20:23], v[192:199], v7 abid:1
    v_mov_b32_dpp v17, v16 row_shr:4 row_mask:0xf bank_mask:0xf bound_ctrl:0
    v_mov_b32_dpp v18, v19 row_shl:4 row_mask:0xf bank_mask:0xf bound_ctrl:0
    s_waitcnt lgkmcnt(0)
    ds_write2_b32 v71, v62, v63 offset0:0 offset1:4
    v_smfmac_f32_16x16x64_bf16 v[48:51], v[20:23], v[200:207], v7 abid:1
    s_waitcnt vmcnt(0)
    v_smfmac_f32_16x16x64_bf16 v[40:43], v[16:19], v[208:215], v7 abid:1
    v_and_b32_dpp v20, v59, v5 quad_perm:[2,2,2,2] row_mask:0xf bank_mask:0xf
    v_and_b32_dpp v23, v59, v6 quad_perm:[2,2,2,2] row_mask:0xf bank_mask:0xf
    v_smfmac_f32_16x16x64_bf16 v[44:47], v[16:19], v[216:223], v7 abid:1
    v_mov_b32_dpp v21, v20 row_shr:4 row_mask:0xf bank_mask:0xf bound_ctrl:0
    v_mov_b32_dpp v22, v23 row_shl:4 row_mask:0xf bank_mask:0xf bound_ctrl:0
    s_mov_b32 vcc_lo, 0x00ff00ff
    v_smfmac_f32_16x16x64_bf16 v[48:51], v[16:19], v[224:231], v7 abid:1
    v_smfmac_f32_16x16x64_bf16 v[40:43], v[20:23], v[232:239], v7 abid:1
    v_smfmac_f32_16x16x64_bf16 v[44:47], v[20:23], v[240:247], v7 abid:1
    v_smfmac_f32_16x16x64_bf16 v[48:51], v[20:23], v[248:255], v7 abid:1
    s_mov_b32 vcc_hi, 0xff00ff00
    v_cmp_eq_u32 s[60:61], 24, v1
    s_nop 4
    v_cndmask_b32_dpp v40, v44, v40, vcc row_ror:8 row_mask:0xf bank_mask:0xf
    v_cndmask_b32_dpp v41, v45, v41, vcc row_ror:8 row_mask:0xf bank_mask:0xf
    v_cndmask_b32_dpp v42, v46, v42, vcc row_ror:8 row_mask:0xf bank_mask:0xf
    v_cndmask_b32_dpp v43, v47, v43, vcc row_ror:8 row_mask:0xf bank_mask:0xf
    ds_write_b128 v15, v[40:43]
    v_cndmask_b32_dpp v48, v50, v48, vcc row_ror:8 row_mask:0xf bank_mask:0xf
    v_cndmask_b32_dpp v49, v51, v49, vcc row_ror:8 row_mask:0xf bank_mask:0xf
    ds_write_b64 v61, v[48:49]
    s_cmp_eq_u32 s49, 0
    s_cbranch_scc1 HOOKC
EXB:
    s_waitcnt lgkmcnt(0)
    s_barrier
    ds_read_b128 v[16:19], v70
    ds_read_b128 v[20:23], v70 offset:16
    ds_read_b64 v[24:25], v60 offset:0
    ds_read_b64 v[26:27], v60 offset:768
    ds_read_b64 v[28:29], v60 offset:1536
    ds_read_b64 v[30:31], v60 offset:2304
    ds_read_b64 v[32:33], v60 offset:3072
    ds_read_b64 v[34:35], v60 offset:3840
    ds_read_b64 v[36:37], v60 offset:4608
    ds_read_b64 v[38:39], v60 offset:5376
    s_mov_b32 s51, 0
    s_cmp_eq_u32 s49, 0
    s_cselect_b32 s52, 20, s46
    s_waitcnt lgkmcnt(9)
    v_max3_f32 v40, v16, v17, v18
    v_max_f32 v40, v40, v19
    v_pk_add_f32 v[16:17], v[16:17], v[40:41] op_sel_hi:[1,0] neg_lo:[0,1] neg_hi:[0,1]
    v_pk_add_f32 v[18:19], v[18:19], v[40:41] op_sel_hi:[1,0] neg_lo:[0,1] neg_hi:[0,1]
    v_exp_f32 v16, v16
    v_exp_f32 v17, v17
    v_exp_f32 v18, v18
    v_exp_f32 v19, v19
    s_waitcnt lgkmcnt(0)
    v_pk_mul_f32 v[20:21], v[20:21], v[16:17]
    v_pk_fma_f32 v[20:21], v[22:23], v[18:19], v[20:21]
    v_add_f32 v41, v20, v21
    v_rcp_f32 v42, v41
    v_log_f32 v43, v41
    v_pk_add_f32 v[24:25], v[24:25], v[26:27]
    v_pk_add_f32 v[28:29], v[28:29], v[30:31]
    v_pk_add_f32 v[32:33], v[32:33], v[34:35]
    v_pk_add_f32 v[36:37], v[36:37], v[38:39]
    v_pk_mul_f32 v[24:25], v[24:25], v[16:17] op_sel_hi:[1,0]
    v_pk_fma_f32 v[24:25], v[28:29], v[16:17], v[24:25] op_sel:[0,1,0] op_sel_hi:[1,1,1]
    v_pk_fma_f32 v[24:25], v[32:33], v[18:19], v[24:25] op_sel:[0,0,0] op_sel_hi:[1,0,1]
    v_pk_fma_f32 v[24:25], v[36:37], v[18:19], v[24:25] op_sel:[0,1,0] op_sel_hi:[1,1,1]
    v_pk_mul_f32 v[24:25], v[24:25], v[42:43] op_sel_hi:[1,0]
    v_add_f32 v43, v43, v40
    v_cvt_pk_bf16_f32 v24, v24, v25
    v_cndmask_b32 v24, v24, v43, s[60:61]
    buffer_store_dword v24, v14, s[16:19], s32 offen offset:0
    s_cmp_eq_u32 s50, 0
    s_cbranch_scc1 SLOW3
PUBD3:
    s_cmp_ge_u32 s52, 20
    s_cbranch_scc1 HOOKG
    s_sleep 2
    buffer_load_dword v56, v65, s[16:19], s62 offen sc1
    buffer_load_dwordx4 v[44:47], v64, s[16:19], s62 offen offset:0 sc1
    buffer_load_dwordx4 v[48:51], v64, s[16:19], s62 offen offset:512 sc1
    buffer_load_dwordx4 v[52:55], v64, s[16:19], s62 offen offset:1024 sc1
    buffer_load_dword v57, v66, s[16:19], s49 offen sc1
    s_sleep 2
WOP:
    buffer_load_dword v56, v65, s[16:19], s62 offen sc1
    buffer_load_dwordx4 v[44:47], v64, s[16:19], s62 offen offset:0 sc1
    buffer_load_dwordx4 v[48:51], v64, s[16:19], s62 offen offset:512 sc1
    buffer_load_dwordx4 v[52:55], v64, s[16:19], s62 offen offset:1024 sc1
    buffer_load_dword v57, v66, s[16:19], s49 offen sc1
    s_waitcnt vmcnt(5)
WOC:
    v_mfma_f32_16x16x32_bf16 v[16:19], v[44:47], v[80:83], 0
    v_mov_b32 v32, v56
    v_max3_u32 v63, v44, v48, v52
    v_mfma_f32_16x16x32_bf16 v[16:19], v[48:51], v[96:99], v[16:19]
    v_max_u32 v63, v63, v32
    v_max_f32_dpp v33, v32, v32 quad_perm:[1,0,3,2] row_mask:0xf bank_mask:0xf
    v_mfma_f32_16x16x32_bf16 v[16:19], v[52:55], v[112:115], v[16:19]
    v_cmp_eq_u32 vcc, -1, v63
    v_max_f32_dpp v33, v33, v33 quad_perm:[2,3,0,1] row_mask:0xf bank_mask:0xf
    v_mfma_f32_16x16x32_bf16 v[20:23], v[44:47], v[84:87], 0
    s_cbranch_vccnz AGWOP
    v_max_f32_dpp v33, v33, v33 row_half_mirror row_mask:0xf bank_mask:0xf
    v_sub_f32 v34, v32, v33
    v_mfma_f32_16x16x32_bf16 v[20:23], v[48:51], v[100:103], v[20:23]
    v_exp_f32 v34, v34
    s_nop 0
    v_mfma_f32_16x16x32_bf16 v[20:23], v[52:55], v[116:119], v[20:23]
    v_add_f32_dpp v33, v34, v34 quad_perm:[1,0,3,2] row_mask:0xf bank_mask:0xf
    s_nop 0
    v_mfma_f32_16x16x32_bf16 v[24:27], v[44:47], v[88:91], 0
    v_add_f32_dpp v33, v33, v33 quad_perm:[2,3,0,1] row_mask:0xf bank_mask:0xf
    s_nop 0
    v_mfma_f32_16x16x32_bf16 v[24:27], v[48:51], v[104:107], v[24:27]
    v_add_f32_dpp v33, v33, v33 row_half_mirror row_mask:0xf bank_mask:0xf
    v_rcp_f32 v33, v33
    v_mfma_f32_16x16x32_bf16 v[24:27], v[52:55], v[120:123], v[24:27]
    v_mul_f32 v34, v34, v33
    s_nop 0
    v_mfma_f32_16x16x32_bf16 v[28:31], v[44:47], v[92:95], 0
    v_mul_f32_dpp v36, v34, v16 row_newbcast:0 row_mask:0xf bank_mask:0xf
    v_fmac_f32_dpp v36, v34, v17 row_newbcast:1 row_mask:0xf bank_mask:0xf
    v_mfma_f32_16x16x32_bf16 v[28:31], v[48:51], v[108:111], v[28:31]
    v_fmac_f32_dpp v36, v34, v18 row_newbcast:2 row_mask:0xf bank_mask:0xf
    v_fmac_f32_dpp v36, v34, v19 row_newbcast:3 row_mask:0xf bank_mask:0xf
    v_mfma_f32_16x16x32_bf16 v[28:31], v[52:55], v[124:127], v[28:31]
    v_mul_f32_dpp v37, v34, v20 row_newbcast:0 row_mask:0xf bank_mask:0xf
    v_fmac_f32_dpp v37, v34, v21 row_newbcast:1 row_mask:0xf bank_mask:0xf
    v_fmac_f32_dpp v37, v34, v22 row_newbcast:2 row_mask:0xf bank_mask:0xf
    v_fmac_f32_dpp v37, v34, v23 row_newbcast:3 row_mask:0xf bank_mask:0xf
    v_mul_f32_dpp v38, v34, v24 row_newbcast:0 row_mask:0xf bank_mask:0xf
    v_fmac_f32_dpp v38, v34, v25 row_newbcast:1 row_mask:0xf bank_mask:0xf
    v_fmac_f32_dpp v38, v34, v26 row_newbcast:2 row_mask:0xf bank_mask:0xf
    v_fmac_f32_dpp v38, v34, v27 row_newbcast:3 row_mask:0xf bank_mask:0xf
    v_cmp_u_f32 vcc, v36, v57
    s_mov_b32 exec_hi, 0
    v_mul_f32_dpp v39, v34, v28 row_newbcast:0 row_mask:0xf bank_mask:0xf
    v_fmac_f32_dpp v39, v34, v29 row_newbcast:1 row_mask:0xf bank_mask:0xf
    v_fmac_f32_dpp v39, v34, v30 row_newbcast:2 row_mask:0xf bank_mask:0xf
    v_fmac_f32_dpp v39, v34, v31 row_newbcast:3 row_mask:0xf bank_mask:0xf
    ds_write_b128 v68, v[36:39]
    s_mov_b64 exec, -1
    s_cbranch_vccnz AGWOP
OKWOP:
    s_cmp_lg_u32 s44, 3
    s_waitcnt lgkmcnt(0)
    s_barrier
    s_cbranch_scc1 WOX
    ds_read2st64_b32 v[16:17], v69 offset0:0 offset1:1
    ds_read2st64_b32 v[18:19], v69 offset0:2 offset1:3
    ds_read2st64_b32 v[20:21], v69 offset0:4 offset1:5
    ds_read2st64_b32 v[22:23], v69 offset0:6 offset1:7
    s_waitcnt lgkmcnt(2)
    v_pk_add_f32 v[16:17], v[16:17], v[18:19]
    v_add_f32 v16, v16, v57
    s_waitcnt lgkmcnt(0)
    v_pk_add_f32 v[20:21], v[20:21], v[22:23]
    v_pk_add_f32 v[16:17], v[16:17], v[20:21]
    v_add_f32 v16, v16, v17
    buffer_store_dword v16, v67, s[16:19], s1 offen sc1
    buffer_store_dword v16, v67, s[16:19], s99 offen sc1
WOX:
    s_cmp_ge_u32 s46, 30
    s_cbranch_scc1 STX
    s_cmp_eq_u32 s44, 3
    s_cbranch_scc1 F1W3
    s_waitcnt vmcnt(0)
F1W3:
    s_waitcnt vmcnt(2)
F1E:
    ds_read_b128 v[56:59], v12 offset:16384
    ds_read_b128 v[52:55], v12 offset:12288
    ds_read_b128 v[60:63], v12 offset:20480
    s_mov_b32 s100, 0
    s_mov_b32 s51, 0
    s_waitcnt lgkmcnt(0)
    ds_read_b64_tr_b16 v[64:65], v57 offset:49152
    ds_read_b64_tr_b16 v[66:67], v57 offset:49664
    ds_read_b64_tr_b16 v[68:69], v57 offset:53248
    ds_read_b64_tr_b16 v[70:71], v57 offset:53760
    ds_read_b64_tr_b16 v[72:73], v57 offset:57344
    ds_read_b64_tr_b16 v[74:75], v57 offset:57856
    ds_read_b64_tr_b16 v[76:77], v57 offset:61440
    ds_read_b64_tr_b16 v[78:79], v57 offset:61952
    s_cmp_eq_u32 s49, 0
    s_cbranch_scc1 HOOKD
    s_cmp_lt_u32 s46, 20
    s_cbranch_scc1 GFB
    s_sleep 11
GFB:
    s_sleep 11
F1P:
F1W:
    buffer_load_dword v44, v52, s[16:19], s99 offen offset:0 sc1
    buffer_load_dword v45, v52, s[16:19], s99 offen offset:128 sc1
    buffer_load_dword v46, v52, s[16:19], s99 offen offset:256 sc1
    buffer_load_dword v47, v52, s[16:19], s99 offen offset:384 sc1
    buffer_load_dword v48, v52, s[16:19], s99 offen offset:512 sc1
    buffer_load_dword v49, v52, s[16:19], s99 offen offset:640 sc1
    buffer_load_dword v50, v52, s[16:19], s99 offen offset:768 sc1
    buffer_load_dword v51, v52, s[16:19], s99 offen offset:896 sc1
    s_waitcnt vmcnt(0)
    v_pk_add_f32 v[16:17], v[44:45], v[46:47]
    v_pk_add_f32 v[18:19], v[48:49], v[50:51]
    v_pk_add_f32 v[16:17], v[16:17], v[18:19]
    v_add_f32 v16, v16, v17
    v_mov_b32 v17, v16
    s_nop 1
    v_permlane32_swap_b32 v16, v17
    v_add_f32 v16, v16, v17
    v_cmp_u_f32 vcc, v16, v16
    v_cvt_pk_bf16_f32 v16, v16, v16
    ds_write_b16 v53, v16
    s_cbranch_vccnz AGF1P
OKF1P:
    v_and_b32 v16, 0xffff0000, v16
    buffer_store_dword v16, v54, s[16:19], s34 offen offset:0
    s_cmp_eq_u32 s50, 0
    s_cbranch_scc1 SLOW8
PUBD8:
    s_waitcnt lgkmcnt(0)
    s_barrier
    ds_read_b128 v[20:23], v2 offset:256
    ds_read_b128 v[24:27], v2 offset:320
    ds_read_b128 v[28:31], v2 offset:384
    ds_read_b128 v[32:35], v2 offset:448
    s_waitcnt lgkmcnt(3)
    v_mfma_f32_16x16x32_bf16 v[40:43], v[20:23], v[64:67], 0
    v_mfma_f32_16x16x32_bf16 v[36:39], v[20:23], v[20:23], 0
    s_waitcnt lgkmcnt(2)
    v_mfma_f32_16x16x32_bf16 v[40:43], v[24:27], v[68:71], v[40:43]
    v_mfma_f32_16x16x32_bf16 v[36:39], v[24:27], v[24:27], v[36:39]
    s_waitcnt lgkmcnt(1)
    v_mfma_f32_16x16x32_bf16 v[40:43], v[28:31], v[72:75], v[40:43]
    v_mfma_f32_16x16x32_bf16 v[36:39], v[28:31], v[28:31], v[36:39]
    s_waitcnt lgkmcnt(0)
    v_mfma_f32_16x16x32_bf16 v[40:43], v[32:35], v[76:79], v[40:43]
    v_mfma_f32_16x16x32_bf16 v[36:39], v[32:35], v[32:35], v[36:39]
    s_mov_b32 s51, 0
    s_nop 5
    buffer_store_dword v40, v55, s[16:19], s32 offen offset:0
    buffer_store_dwordx2 v[36:37], v56, s[16:19], s32 offen offset:0
    s_cmp_eq_u32 s50, 0
    s_cbranch_scc1 SLOW9
PUBD9:
    s_cmp_lt_u32 s46, 20
    s_cbranch_scc1 STX
    s_cmp_eq_u32 s49, 0
    s_cbranch_scc1 HOOKI
    s_sleep 2
    buffer_load_dword v74, v60, s[16:19], s62 offen sc1
    buffer_load_dwordx4 v[64:67], v58, s[16:19], s62 offen offset:0 sc1
    buffer_load_dwordx4 v[68:71], v58, s[16:19], s62 offen offset:3072 sc1
    buffer_load_dwordx2 v[72:73], v59, s[16:19], s62 offen sc1
    buffer_load_dword v76, v61, s[16:19], s49 offen sc1
    s_sleep 2
W2P:
    buffer_load_dword v74, v60, s[16:19], s62 offen sc1
    buffer_load_dwordx4 v[64:67], v58, s[16:19], s62 offen offset:0 sc1
    buffer_load_dwordx4 v[68:71], v58, s[16:19], s62 offen offset:3072 sc1
    buffer_load_dwordx2 v[72:73], v59, s[16:19], s62 offen sc1
    buffer_load_dword v76, v61, s[16:19], s49 offen sc1
    s_waitcnt vmcnt(5)
    v_add_f32_dpp v48, v74, v74 quad_perm:[1,0,3,2] row_mask:0xf bank_mask:0xf
    v_pk_add_f32 v[18:19], v[64:65], v[66:67]
    v_pk_add_f32 v[20:21], v[68:69], v[70:71]
    v_add_f32_dpp v48, v48, v48 quad_perm:[2,3,0,1] row_mask:0xf bank_mask:0xf
    v_add_f32 v16, v18, v19
    v_add_f32 v17, v20, v21
    v_add_f32_dpp v48, v48, v48 row_half_mirror row_mask:0xf bank_mask:0xf
    v_pk_add_f32 v[16:17], v[16:17], v[72:73]
    v_mov_b32 v46, 0x3727c5ac
    v_mul_f32_dpp v47, v48, v11 row_newbcast:8 row_mask:0xf bank_mask:0xf
    v_fmac_f32_dpp v46, v48, v11 row_newbcast:0 row_mask:0xf bank_mask:0xf
    v_fma_f32 v46, -v47, v47, v46
    v_rsq_f32 v48, abs(v46)
    v_pk_fma_f32 v[16:17], v[46:47], v[126:127], v[16:17] op_sel:[1,0,0] op_sel_hi:[1,1,1] neg_lo:[1,0,0] neg_hi:[1,0,0]
    v_pk_mul_f32 v[16:17], v[16:17], v[48:49] op_sel_hi:[1,0]
    v_mul_f32 v18, 0xbfb8aa3b, v16
    v_exp_f32 v18, v18
    v_mul_f32 v16, v16, v17
    v_add_f32 v18, 1.0, v18
    v_rcp_f32 v18, v18
    v_cmp_u_f32 vcc, v16, v76
    v_mul_f32 v16, v16, v18
    v_cvt_pk_bf16_f32 v16, v16, v16
    ds_write_b16 v63, v16
    s_cbranch_vccnz AGW2P
OKW2P:
    s_waitcnt lgkmcnt(0)
    s_barrier
    ds_read_b128 v[16:19], v2 offset:512
    ds_read_b128 v[20:23], v2 offset:576
    ds_read_b128 v[24:27], v2 offset:640
    ds_read_b128 v[28:31], v2 offset:704
    ds_read_b128 v[32:35], v2 offset:768
    ds_read_b128 v[36:39], v2 offset:832
    v_mov_b32 v40, v76
    s_nop 0
    s_waitcnt lgkmcnt(5)
    v_mfma_f32_16x16x32_bf16 v[40:43], v[16:19], v[80:83], v[40:43]
    s_waitcnt lgkmcnt(4)
    v_mfma_f32_16x16x32_bf16 v[40:43], v[20:23], v[84:87], v[40:43]
    s_waitcnt lgkmcnt(3)
    v_mfma_f32_16x16x32_bf16 v[40:43], v[24:27], v[88:91], v[40:43]
    s_waitcnt lgkmcnt(2)
    v_mfma_f32_16x16x32_bf16 v[40:43], v[28:31], v[92:95], v[40:43]
    s_waitcnt lgkmcnt(1)
    v_mfma_f32_16x16x32_bf16 v[40:43], v[32:35], v[96:99], v[40:43]
    s_waitcnt lgkmcnt(0)
    v_mfma_f32_16x16x32_bf16 v[40:43], v[36:39], v[100:103], v[40:43]
    s_waitcnt vmcnt(0)
    s_nop 6
    buffer_store_dword v40, v62, s[16:19], s49 offen sc1
STX:
    s_cmp_lg_u32 s49, 0
    s_cbranch_scc1 LAST
    s_branch LOOP
LAST:
    s_and_b32 s52, s2, 0xc7
    s_cmp_eq_u32 s52, 0
    s_cbranch_scc1 LOOP
    s_endpgm
FINAL:
    s_cmp_eq_u32 s44, 3
    s_cbranch_scc1 FINX
    s_sleep 22
    s_waitcnt lgkmcnt(0)
Y3P:
    buffer_load_dword v22, v16, s[16:19], s55 offen offset:0 sc1
    buffer_load_dword v23, v16, s[16:19], s55 offen offset:128 sc1
    buffer_load_dword v24, v16, s[16:19], s55 offen offset:256 sc1
    buffer_load_dword v25, v16, s[16:19], s55 offen offset:384 sc1
    s_waitcnt vmcnt(0)
    v_pk_add_f32 v[22:23], v[22:23], v[24:25]
    v_add_f32 v30, v22, v23
    v_mov_b32 v31, v30
    s_nop 1
    v_permlane32_swap_b32 v30, v31
    v_add_f32 v30, v30, v31
    v_cmp_u_f32 vcc, v30, v30
    v_cvt_pk_bf16_f32 v30, v30, v30
    s_cbranch_vccnz AGY3P
OKY3P:
    buffer_store_short v30, v21, s[36:39], 0 offen
FINX:
DONE:
    s_endpgm
TABLES:
    v_mov_b32 v23, 1879048192
    v_and_b32 v24, 15, v1
    v_lshrrev_b32 v25, 4, v1
    v_and_b32 v26, 7, v1
    v_and_b32 v27, 31, v1
    v_lshrrev_b32 v28, 5, v1
    v_and_b32 v29, 31, v1
    v_lshl_add_u32 v29, s44, 5, v29
    v_lshrrev_b32 v16, 2, v1
    v_lshlrev_b32 v16, 7, v16
    v_and_b32 v20, 3, v1
    v_lshl_add_u32 v16, v20, 2, v16
    s_mul_i32 s52, s7, 3072
    s_mul_i32 s54, s44, 768
    s_add_u32 s52, s52, s54
    s_lshl_b32 s54, s48, 4
    s_add_u32 s52, s52, s54
    v_add_u32 v16, s52, v16
    v_cmp_gt_u32 vcc, 24, v1
    s_nop 1
    v_cndmask_b32 v16, v23, v16, vcc
    s_lshl_b32 s52, s7, 5
    s_lshl_b32 s54, s48, 2
    s_add_u32 s52, s52, s54
    s_add_u32 s52, s52, 19968
    s_cmp_eq_u32 s44, 3
    s_cselect_b32 s52, s52, 1879048192
    v_writelane_b32 v16, s52, 24
    v_lshlrev_b32 v17, 4, v26
    v_and_b32 v20, 1, v25
    v_lshl_add_u32 v17, v20, 7, v17
    v_mul_u32_u24 v20, 768, v28
    v_add_u32 v17, v17, v20
    s_mul_i32 s52, s44, 1536
    s_add_u32 s52, s52, 98816
    v_add_u32 v17, s52, v17
    v_bfe_u32 v20, v1, 3, 1
    v_xor_b32 v20, v20, v28
    v_lshl_add_u32 v19, v20, 3, v17
    v_add_u32 v19, 512, v19
    v_lshl_add_u32 v17, v20, 8, v17
    s_mul_i32 s52, s44, 24
    v_min_u32 v21, 23, v1
    v_add_u32 v21, s52, v21
    v_lshrrev_b32 v18, 5, v21
    v_lshlrev_b32 v18, 8, v18
    v_bfe_u32 v20, v21, 1, 1
    v_lshl_add_u32 v18, v20, 7, v18
    v_bfe_u32 v20, v21, 2, 3
    v_lshl_add_u32 v18, v20, 4, v18
    v_bfe_u32 v20, v21, 0, 1
    v_lshl_add_u32 v18, v20, 3, v18
    v_add_u32 v18, 98816, v18
    ds_write_b128 v12, v[16:19] offset:0
    v_lshlrev_b32 v16, 4, v26
    v_lshl_add_u32 v16, v25, 7, v16
    s_mul_i32 s52, s56, 6144
    s_mul_i32 s54, s44, 1536
    s_add_u32 s52, s52, s54
    v_add_u32 v16, s52, v16
    v_cmp_gt_u32 vcc, 8, v24
    s_nop 1
    v_cndmask_b32 v16, v23, v16, vcc
    s_lshr_b32 s53, s44, 1
    s_lshl_b32 s52, s56, 6
    s_lshl_b32 s54, s53, 5
    s_add_u32 s52, s52, s54
    s_add_u32 s52, s52, 19968
    v_lshl_add_u32 v17, v25, 2, v26
    v_and_b32 v17, 7, v17
    v_lshl_add_u32 v17, v17, 2, s52
    s_lshl_b32 s52, s57, 8
    s_add_u32 s52, s52, 131072
    s_or_b32 s53, s45, s56
    s_cmp_eq_u32 s53, 0
    s_cselect_b32 s52, s52, 1879048192
    v_lshl_add_u32 v18, v1, 2, s52
    v_lshlrev_b32 v19, 11, v28
    v_lshl_add_u32 v19, v27, 2, v19
    s_lshr_b32 s53, s57, 1
    s_lshl_b32 s52, s57, 12
    s_lshl_b32 s54, s53, 13
    s_add_u32 s52, s52, s54
    s_lshl_b32 s54, s45, 8
    s_add_u32 s52, s52, s54
    s_lshl_b32 s54, s56, 7
    s_add_u32 s52, s52, s54
    v_add_u32 v19, s52, v19
    ds_write_b128 v12, v[16:19] offset:4096
    s_lshl_b32 s52, s44, 9
    s_add_u32 s52, s52, 104960
    v_lshl_add_u32 v16, v27, 4, s52
    v_lshl_add_u32 v16, v28, 11, v16
    v_lshlrev_b32 v17, 4, v24
    v_lshl_add_u32 v17, v25, 2, v17
    v_add_u32 v17, 104960, v17
    v_mov_b32 v18, 98752
    s_lshl_b32 s52, s44, 2
    s_add_u32 s52, s52, 98752
    v_mov_b32 v19, 98792
    v_writelane_b32 v19, s52, 0
    ds_write_b128 v12, v[16:19] offset:8192
    v_lshlrev_b32 v16, 10, v28
    v_lshl_add_u32 v16, v27, 2, v16
    s_lshl_b32 s52, s3, 14
    s_lshl_b32 s54, s44, 11
    s_add_u32 s52, s52, s54
    v_add_u32 v16, s52, v16
    v_lshlrev_b32 v17, 1, v29
    v_add_u32 v17, 96512, v17
    s_lshl_b32 s52, s4, 9
    s_add_u32 s52, s52, 133632
    s_cmp_lt_u32 s4, 5
    s_cselect_b32 s52, s52, 1879048192
    s_cmp_eq_u32 s45, 0
    s_cselect_b32 s52, s52, 1879048192
    v_lshl_add_u32 v18, v29, 2, s52
    v_cmp_gt_u32 vcc, 32, v1
    s_nop 1
    v_cndmask_b32 v18, v23, v18, vcc
    s_lshl_b32 s52, s59, 6
    s_lshl_b32 s54, s44, 4
    s_add_u32 s52, s52, s54
    v_add_u32 v19, s52, v1
    s_mul_i32 s52, s58, 3072
    s_lshl_b32 s54, s3, 2
    s_add_u32 s52, s52, s54
    s_add_u32 s52, s52, 12288
    s_lshl_b32 s53, s58, 2
    s_add_u32 s53, s53, 18432
    s_cmp_eq_u32 s3, 4
    s_cselect_b32 s52, s53, s52
    s_cselect_b32 s53, 3, 4
    v_lshlrev_b32 v19, s53, v19
    v_add_u32 v19, s52, v19
    v_cmp_gt_u32 vcc, 16, v1
    s_nop 1
    v_cndmask_b32 v19, v23, v19, vcc
    ds_write_b128 v12, v[16:19] offset:12288
    s_lshl_b32 s52, s4, 3
    s_add_u32 s52, s52, 20224
    s_cmp_eq_u32 s44, 3
    s_cselect_b32 s52, s52, 1879048192
    s_cmp_lt_u32 s4, 5
    s_cselect_b32 s52, s52, 1879048192
    v_mov_b32 v16, v23
    v_writelane_b32 v16, s52, 0
    v_and_b32 v17, 3, v1
    v_lshlrev_b32 v17, 3, v17
    v_bfe_u32 v20, v1, 2, 2
    v_lshl_add_u32 v17, v20, 7, v17
    v_lshrrev_b32 v20, 4, v1
    v_lshl_add_u32 v17, v20, 10, v17
    v_bfe_u32 v20, v1, 3, 2
    v_lshl_add_u32 v17, v20, 5, v17
    s_lshl_b32 s52, s44, 5
    v_xor_b32 v17, s52, v17
    v_lshlrev_b32 v18, 4, v0
    v_add_u32 v18, 12288, v18
    v_lshlrev_b32 v19, 3, v0
    v_add_u32 v19, 18432, v19
    v_cmp_gt_u32 vcc, 192, v0
    s_nop 1
    v_cndmask_b32 v18, v23, v18, vcc
    v_cndmask_b32 v19, v23, v19, vcc
    ds_write_b128 v12, v[16:19] offset:16384
    v_lshlrev_b32 v16, 3, v26
    v_add_u32 v16, 20224, v16
    v_bfe_u32 v20, v1, 3, 1
    v_lshl_add_u32 v16, v20, 2, v16
    v_cmp_gt_u32 vcc, 5, v26
    s_nop 1
    v_cndmask_b32 v16, v23, v16, vcc
    v_cmp_gt_u32 vcc, 192, v0
    s_nop 1
    v_cndmask_b32 v16, v23, v16, vcc
    s_lshl_b32 s52, s57, 8
    s_lshl_b32 s54, s44, 6
    s_add_u32 s52, s52, s54
    s_add_u32 s52, s52, 133632
    s_cmp_eq_u32 s45, 0
    s_cselect_b32 s52, s52, 1879048192
    v_lshl_add_u32 v17, v24, 2, s52
    s_lshr_b32 s53, s57, 2
    s_lshr_b32 s51, s44, 1
    s_lshl_b32 s52, s57, 11
    s_lshl_b32 s54, s53, 13
    s_add_u32 s52, s52, s54
    s_mul_i32 s54, s51, 896
    s_add_u32 s52, s52, s54
    s_lshl_b32 s54, s44, 6
    s_add_u32 s52, s52, s54
    s_lshl_b32 s54, s45, 7
    s_add_u32 s52, s52, s54
    s_add_u32 s52, s52, 81920
    v_lshl_add_u32 v18, v24, 2, s52
    v_lshl_add_u32 v18, v25, 13, v18
    v_cmp_gt_u32 vcc, 32, v1
    s_nop 1
    v_cndmask_b32 v18, v23, v18, vcc
    v_lshlrev_b32 v19, 1, v0
    v_add_u32 v19, 96768, v19
    ds_write_b128 v12, v[16:19] offset:20480
    s_lshr_b32 s53, s48, 2
    s_mul_i32 s52, s7, 6144
    s_lshl_b32 s54, s44, 8
    s_add_u32 s52, s52, s54
    s_mul_i32 s54, s53, 3056
    s_add_u32 s52, s52, s54
    s_lshl_b32 s54, s48, 2
    s_add_u32 s52, s52, s54
    s_add_u32 s52, s52, 20480
    v_lshl_add_u32 v16, v1, 4, s52
    v_cmp_gt_u32 vcc, 16, v1
    s_nop 1
    v_cndmask_b32 v16, v23, v16, vcc
    s_lshl_b32 s52, s7, 6
    s_lshl_b32 s54, s48, 3
    s_add_u32 s52, s52, s54
    s_add_u32 s52, s52, 45056
    s_cmp_eq_u32 s44, 3
    s_cselect_b32 s52, s52, 1879048192
    v_mov_b32 v17, v23
    v_writelane_b32 v17, s52, 0
    s_mul_i32 s52, s48, 80
    v_add_u32 v20, s52, v29
    v_lshrrev_b32 v18, 5, v20
    v_lshlrev_b32 v18, 10, v18
    v_lshrrev_b32 v21, 8, v20
    v_lshl_add_u32 v18, v21, 13, v18
    v_and_b32 v21, 31, v20
    v_lshl_add_u32 v18, v21, 2, v18
    v_lshl_add_u32 v18, v28, 9, v18
    v_add_u32 v18, 81920, v18
    v_cmp_gt_u32 vcc, 80, v29
    s_nop 1
    v_cndmask_b32 v18, v23, v18, vcc
    v_lshlrev_b32 v19, 1, v29
    v_add_u32 v19, 96256, v19
    ds_write_b128 v12, v[16:19] offset:24576
    s_and_b32 s53, s2, 0xc7
    s_cmp_eq_u32 s53, 0
    s_mov_b32 s52, 131072
    s_cselect_b32 s52, s52, 1879048192
    v_lshl_add_u32 v16, v20, 2, s52
    v_lshlrev_b32 v19, 1, v20
    s_and_b32 vcc_hi, vcc_hi, 0
    s_nop 1
    v_cndmask_b32 v16, v23, v16, vcc
    v_cndmask_b32 v19, v23, v19, vcc
    v_and_b32 v21, 3, v1
    v_lshrrev_b32 v17, 4, v1
    v_bfe_u32 v18, v1, 2, 2
    v_lshlrev_b32 v21, 3, v21
    v_mul_u32_u24 v18, 384, v18
    v_add_u32 v21, v21, v18
    v_bfe_u32 v18, v1, 3, 2
    v_xor_b32 v18, s44, v18
    v_lshl_add_u32 v21, v18, 5, v21
    v_add_u32 v21, 65536, v21
    v_and_b32 v18, 1, v17
    v_mul_u32_u24 v17, 3072, v17
    v_mul_u32_u24 v18, 3072, v18
    v_add_u32 v17, v17, v21
    v_add_u32 v18, v18, v21
    ds_write_b128 v12, v[16:19] offset:28672
    s_branch ENTRY0
HOOKL:
    s_cmp_lt_u32 s46, 30
    s_cbranch_scc1 NOGSW
    v_mov_b32 v30, 20224
GSW:
    buffer_load_dword v31, v30, s[16:19], s96 offen sc1
    s_waitcnt vmcnt(0)
    v_cmp_u_f32 vcc, v31, v31
    s_cbranch_vccz NOGSW
    s_add_u32 s51, s51, 1
    s_sleep 2
    s_cmp_lt_u32 s51, 0x40000
    s_cbranch_scc1 GSW
NOGSW:
    s_cmp_ge_u32 s46, 30
    s_cselect_b32 s53, 10, 0
    s_sub_u32 s53, s46, s53
    v_min_u32 v31, 17, v1
    v_lshlrev_b32 v31, 7, v31
    s_mul_i32 s52, s45, 45312
    s_mul_i32 s54, s53, 2304
    s_add_u32 s52, s52, s54
    s_add_u32 s52, s52, 524288
    buffer_load_dword v31, v31, s[16:19], s52 offen sc1
    v_lshlrev_b32 v30, 3, v0
    s_mul_i32 s52, s47, 12288
    s_add_u32 s52, s52, 1441792
    s_add_u32 s53, s52, 0
    buffer_load_dwordx2 v[32:33], v30, s[16:19], s53 offen offset:0 sc1
    buffer_load_dwordx2 v[34:35], v30, s[16:19], s53 offen offset:1536 sc1
    s_add_u32 s53, s52, 3072
    buffer_load_dwordx2 v[36:37], v30, s[16:19], s53 offen offset:0 sc1
    buffer_load_dwordx2 v[38:39], v30, s[16:19], s53 offen offset:1536 sc1
    s_add_u32 s53, s52, 6144
    buffer_load_dwordx2 v[40:41], v30, s[16:19], s53 offen offset:0 sc1
    buffer_load_dwordx2 v[42:43], v30, s[16:19], s53 offen offset:1536 sc1
    s_add_u32 s53, s52, 9216
    buffer_load_dwordx2 v[26:27], v30, s[16:19], s53 offen offset:0 sc1
    buffer_load_dwordx2 v[28:29], v30, s[16:19], s53 offen offset:1536 sc1
    s_sleep 23
    s_mov_b32 s51, 0
    s_branch GYB
QCA:
    v_lshlrev_b32 v30, 3, v0
    s_mul_i32 s52, s47, 12288
    s_add_u32 s52, s52, 1441792
    s_add_u32 s53, s52, 0
    buffer_load_dwordx2 v[32:33], v30, s[16:19], s53 offen offset:0 sc1
    buffer_load_dwordx2 v[34:35], v30, s[16:19], s53 offen offset:1536 sc1
    s_add_u32 s53, s52, 3072
    buffer_load_dwordx2 v[36:37], v30, s[16:19], s53 offen offset:0 sc1
    buffer_load_dwordx2 v[38:39], v30, s[16:19], s53 offen offset:1536 sc1
    s_add_u32 s53, s52, 6144
    buffer_load_dwordx2 v[40:41], v30, s[16:19], s53 offen offset:0 sc1
    buffer_load_dwordx2 v[42:43], v30, s[16:19], s53 offen offset:1536 sc1
    s_add_u32 s53, s52, 9216
    buffer_load_dwordx2 v[26:27], v30, s[16:19], s53 offen offset:0 sc1
    buffer_load_dwordx2 v[28:29], v30, s[16:19], s53 offen offset:1536 sc1
    s_waitcnt vmcnt(0)
    s_add_u32 s51, s51, 1
    s_sleep 2
    s_cmp_lt_u32 s51, 0x40000
    s_cbranch_scc1 QCP
    s_branch Y2W
Y2P:
    buffer_load_dword v22, v16, s[16:19], s55 offen offset:0 sc1
    buffer_load_dword v23, v16, s[16:19], s55 offen offset:128 sc1
    buffer_load_dword v24, v16, s[16:19], s55 offen offset:256 sc1
    buffer_load_dword v25, v16, s[16:19], s55 offen offset:384 sc1
    s_branch Y2W
AGY2P:
    s_add_u32 s51, s51, 1
    s_sleep 1
    s_cmp_lt_u32 s51, 0x40000
    s_cbranch_scc1 Y2P
    s_branch OKY2P
Q0L:
    v_and_b32 v21, 3, v1
    v_lshrrev_b32 v19, 4, v1
    v_bfe_u32 v20, v1, 2, 2
    v_lshlrev_b32 v21, 3, v21
    v_mul_u32_u24 v20, 384, v20
    v_add_u32 v21, v21, v20
    v_bfe_u32 v20, v1, 3, 2
    v_xor_b32 v20, s44, v20
    v_lshl_add_u32 v21, v20, 5, v21
    v_add_u32 v21, 65536, v21
    v_and_b32 v20, 1, v19
    v_mul_u32_u24 v19, 3072, v19
    v_mul_u32_u24 v20, 3072, v20
    v_add_u32 v19, v19, v21
    v_add_u32 v20, v20, v21
    s_branch QTR
HOOKA:
    s_mov_b64 exec, 0xffff
    s_nop 3
    s_lshl_b32 s52, s44, 6
    s_add_u32 s52, s52, 98816
    v_lshl_add_u32 v14, v1, 2, s52
    ds_write_b32 v14, v17 offset:10752
    v_fma_f32 v16, -v84, v17, v16
    v_mul_f32 v16, v16, v85
    ds_write_b32 v14, v16 offset:0
    ds_write_b32 v14, v21 offset:11008
    v_fma_f32 v20, -v84, v21, v20
    v_mul_f32 v20, v20, v85
    ds_write_b32 v14, v20 offset:256
    ds_write_b32 v14, v25 offset:11264
    v_fma_f32 v24, -v84, v25, v24
    v_mul_f32 v24, v24, v85
    ds_write_b32 v14, v24 offset:512
    s_mov_b64 exec, -1
    s_add_u32 s44, s44, 1
    s_cmp_lt_u32 s44, 4
    s_cbranch_scc1 Q0L
    s_mov_b32 s44, 3
    v_lshlrev_b32 v14, 2, v1
    v_add_u32 v14, 98816, v14
    ds_read2st64_b32 v[16:17], v14 offset0:0 offset1:1
    ds_read_b32 v18, v14 offset:512
    s_lshl_b32 s52, s47, 13
    s_lshl_b32 s54, s48, 10
    s_add_u32 s52, s52, s54
    s_add_u32 s52, s52, 1114112
    s_waitcnt lgkmcnt(0)
    v_bitop3_b32 v19, v16, v17, v18 bitop3:0x96
    v_xor_b32 v19, v19, v89
    buffer_store_dwordx4 v[16:19], v88, s[16:19], s52 offen sc1
    s_sleep 40
    v_and_b32 v15, 0xe1, v1
    v_lshlrev_b32 v15, 1, v15
    v_bfe_u32 v14, v1, 4, 1
    v_lshl_add_u32 v15, v14, 3, v15
    v_bfe_u32 v14, v1, 3, 1
    v_lshl_add_u32 v15, v14, 4, v15
    v_bfe_u32 v14, v1, 2, 1
    v_lshl_add_u32 v15, v14, 2, v15
    v_bfe_u32 v14, v1, 1, 1
    v_lshl_add_u32 v15, v14, 5, v15
    v_add_u32 v15, 98304, v15
    s_lshl_b32 s52, s47, 13
    s_add_u32 s52, s52, 1114112
    s_add_u32 s53, s52, 4096
    s_mov_b32 s51, 0
Q0P:
    buffer_load_dwordx4 v[16:19], v88, s[16:19], s52 offen offset:0 sc1
    buffer_load_dwordx4 v[20:23], v88, s[16:19], s52 offen offset:1024 sc1
    buffer_load_dwordx4 v[24:27], v88, s[16:19], s52 offen offset:2048 sc1
    buffer_load_dwordx4 v[28:31], v88, s[16:19], s52 offen offset:3072 sc1
    buffer_load_dwordx4 v[32:35], v88, s[16:19], s53 offen offset:0 sc1
    buffer_load_dwordx4 v[36:39], v88, s[16:19], s53 offen offset:1024 sc1
    buffer_load_dwordx4 v[40:43], v88, s[16:19], s53 offen offset:2048 sc1
    buffer_load_dwordx4 v[44:47], v88, s[16:19], s53 offen offset:3072 sc1
    v_mov_b32 v48, 0
    s_waitcnt vmcnt(0)
    v_bitop3_b32 v49, v16, v17, v18 bitop3:0x96
    v_bitop3_b32 v49, v49, v19, v89 bitop3:0x96
    v_or_b32 v48, v48, v49
    v_bitop3_b32 v49, v20, v21, v22 bitop3:0x96
    v_bitop3_b32 v49, v49, v23, v89 bitop3:0x96
    v_or_b32 v48, v48, v49
    v_bitop3_b32 v49, v24, v25, v26 bitop3:0x96
    v_bitop3_b32 v49, v49, v27, v89 bitop3:0x96
    v_or_b32 v48, v48, v49
    v_bitop3_b32 v49, v28, v29, v30 bitop3:0x96
    v_bitop3_b32 v49, v49, v31, v89 bitop3:0x96
    v_or_b32 v48, v48, v49
    v_bitop3_b32 v49, v32, v33, v34 bitop3:0x96
    v_bitop3_b32 v49, v49, v35, v89 bitop3:0x96
    v_or_b32 v48, v48, v49
    v_bitop3_b32 v49, v36, v37, v38 bitop3:0x96
    v_bitop3_b32 v49, v49, v39, v89 bitop3:0x96
    v_or_b32 v48, v48, v49
    v_bitop3_b32 v49, v40, v41, v42 bitop3:0x96
    v_bitop3_b32 v49, v49, v43, v89 bitop3:0x96
    v_or_b32 v48, v48, v49
    v_bitop3_b32 v49, v44, v45, v46 bitop3:0x96
    v_bitop3_b32 v49, v49, v47, v89 bitop3:0x96
    v_or_b32 v48, v48, v49
    v_cmp_ne_u32 vcc, 0, v48
    s_cbranch_vccz Q0OK
    s_add_u32 s51, s51, 1
    s_sleep 16
    s_cmp_lt_u32 s51, 0x40000
    s_cbranch_scc1 Q0P
Q0OK:
    v_pk_add_f32 v[16:17], v[16:17], v[20:21]
    v_add_f32 v18, v18, v22
    v_pk_add_f32 v[16:17], v[16:17], v[24:25]
    v_add_f32 v18, v18, v26
    v_pk_add_f32 v[16:17], v[16:17], v[28:29]
    v_add_f32 v18, v18, v30
    v_pk_add_f32 v[16:17], v[16:17], v[32:33]
    v_add_f32 v18, v18, v34
    v_pk_add_f32 v[16:17], v[16:17], v[36:37]
    v_add_f32 v18, v18, v38
    v_pk_add_f32 v[16:17], v[16:17], v[40:41]
    v_add_f32 v18, v18, v42
    v_pk_add_f32 v[16:17], v[16:17], v[44:45]
    v_add_f32 v18, v18, v46
    v_cvt_pk_bf16_f32 v16, v16, v17
    v_cvt_pk_bf16_f32 v18, v18, v18
    ds_write_b16 v15, v16
    ds_write_b16_d16_hi v15, v16 offset:128
    ds_write_b16 v15, v18 offset:256
    s_mov_b32 s51, 0
HSP:
    s_mov_b32 s52, 1376256
    buffer_load_dwordx4 v[24:27], v88, s[16:19], s52 offen sc1
    s_waitcnt vmcnt(0)
    v_xor_b32 v20, s5, v24
    v_xor_b32 v21, s5, v25
    v_xor_b32 v22, s5, v26
    v_xor_b32 v23, s5, v27
    v_or3_b32 v20, v20, v21, v22
    v_or_b32 v20, v20, v23
    v_cmp_lt_u32 vcc, 31, v20
    s_cbranch_vccz HSOK
    s_add_u32 s51, s51, 1
    s_sleep 8
    s_cmp_lt_u32 s51, 0x40000
    s_cbranch_scc1 HSP
HSOK:
    s_mov_b32 s53, 0
    v_and_b32 v24, 16, v24
    v_cmp_ne_u32 vcc, 0, v24
    s_bcnt1_i32_b64 s52, vcc
    s_add_u32 s53, s53, s52
    v_and_b32 v25, 16, v25
    v_cmp_ne_u32 vcc, 0, v25
    s_bcnt1_i32_b64 s52, vcc
    s_add_u32 s53, s53, s52
    v_and_b32 v26, 16, v26
    v_cmp_ne_u32 vcc, 0, v26
    s_bcnt1_i32_b64 s52, vcc
    s_add_u32 s53, s53, s52
    v_and_b32 v27, 16, v27
    v_cmp_ne_u32 vcc, 0, v27
    s_bcnt1_i32_b64 s52, vcc
    s_add_u32 s53, s53, s52
    v_and_b32 v20, 15, v20
    s_cmp_gt_u32 s53, 128
    s_cselect_b32 s53, 2, 0
    s_lshr_b32 s52, s5, 1
    s_xor_b32 s53, s53, s52
    s_and_b32 s53, s53, 2
    s_lshl_b32 s52, s45, 3
    v_cmp_ne_u32 vcc, 0, v20
    s_lshr_b64 s[60:61], vcc, s52
    s_and_b32 s52, s60, 0xff
    s_cselect_b32 s50, 0, 1
    v_mov_b32 v38, 98784
    s_or_b32 s53, s53, s50
    v_or_b32 v39, s53, v89
    ds_write_b32 v38, v39
    v_and_b32 v21, 0xffff0000, v86
    v_lshlrev_b32 v20, 16, v86
    buffer_store_dwordx2 v[20:21], v87, s[16:19], 0 offen sc1
    s_branch TABLES
EN3:
    v_mov_b64 v[72:73], 0
    v_mov_b64 v[74:75], 0
    v_mov_b64 v[76:77], 0
    v_mov_b64 v[78:79], 0
    v_mov_b64 v[40:41], 0
    v_mov_b64 v[42:43], 0
    v_mov_b64 v[44:45], 0
    v_mov_b64 v[46:47], 0
    v_mov_b64 v[48:49], 0
    v_mov_b64 v[50:51], 0
    s_branch ENOK2
ENTRY0:
    ds_read_b64 v[14:15], v12 offset:0
    ds_read_b64 v[60:61], v12 offset:8
    v_mov_b64 v[64:65], 0
    v_mov_b64 v[66:67], 0
    v_mov_b64 v[68:69], 0
    v_mov_b64 v[70:71], 0
    v_mov_b64 v[72:73], 0
    v_mov_b64 v[74:75], 0
    v_mov_b64 v[76:77], 0
    v_mov_b64 v[78:79], 0
    v_mov_b64 v[40:41], 0
    v_mov_b64 v[42:43], 0
    v_mov_b64 v[44:45], 0
    v_mov_b64 v[46:47], 0
    v_mov_b64 v[48:49], 0
    v_mov_b64 v[50:51], 0
    s_cmp_lg_u32 s44, 3
    s_cbranch_scc1 QFRAG
    s_waitcnt lgkmcnt(0)
    s_barrier
    s_waitcnt vmcnt(23)
    buffer_load_dwordx4 a[0:3], v80, s[8:11], s96 offen offset:0 nt
    s_waitcnt vmcnt(23)
    buffer_load_dwordx4 a[8:11], v80, s[8:11], s96 offen offset:128 nt
    s_waitcnt vmcnt(23)
    buffer_load_dwordx4 a[16:19], v80, s[8:11], s96 offen offset:256 nt
    s_add_u32 s96, s96, s97
    s_waitcnt vmcnt(23)
    buffer_load_dwordx4 a[4:7], v80, s[8:11], s96 offen offset:0 nt
    s_waitcnt vmcnt(23)
    buffer_load_dwordx4 a[12:15], v80, s[8:11], s96 offen offset:128 nt
    s_waitcnt vmcnt(23)
    buffer_load_dwordx4 a[20:23], v80, s[8:11], s96 offen offset:256 nt
    s_add_u32 s96, s96, s97
    s_waitcnt vmcnt(23)
    buffer_load_dwordx4 a[24:27], v80, s[8:11], s96 offen offset:0 nt
    s_waitcnt vmcnt(23)
    buffer_load_dwordx4 a[32:35], v80, s[8:11], s96 offen offset:128 nt
    s_waitcnt vmcnt(23)
    buffer_load_dwordx4 a[40:43], v80, s[8:11], s96 offen offset:256 nt
    s_add_u32 s96, s96, s97
    s_waitcnt vmcnt(23)
    buffer_load_dwordx4 a[28:31], v80, s[8:11], s96 offen offset:0 nt
    s_waitcnt vmcnt(23)
    buffer_load_dwordx4 a[36:39], v80, s[8:11], s96 offen offset:128 nt
    s_waitcnt vmcnt(23)
    buffer_load_dwordx4 a[44:47], v80, s[8:11], s96 offen offset:256 nt
    s_add_u32 s96, s96, s97
    s_waitcnt vmcnt(23)
    buffer_load_dwordx4 a[48:51], v80, s[8:11], s96 offen offset:0 nt
    s_waitcnt vmcnt(23)
    buffer_load_dwordx4 a[56:59], v80, s[8:11], s96 offen offset:128 nt
    s_waitcnt vmcnt(23)
    buffer_load_dwordx4 a[64:67], v80, s[8:11], s96 offen offset:256 nt
    s_add_u32 s96, s96, s97
    s_waitcnt vmcnt(23)
    buffer_load_dwordx4 a[52:55], v80, s[8:11], s96 offen offset:0 nt
    s_waitcnt vmcnt(23)
    buffer_load_dwordx4 a[60:63], v80, s[8:11], s96 offen offset:128 nt
    s_waitcnt vmcnt(23)
    buffer_load_dwordx4 a[68:71], v80, s[8:11], s96 offen offset:256 nt
    s_add_u32 s96, s96, s97
    s_waitcnt vmcnt(23)
    buffer_load_dwordx4 a[72:75], v80, s[8:11], s96 offen offset:0 nt
    s_waitcnt vmcnt(23)
    buffer_load_dwordx4 a[80:83], v80, s[8:11], s96 offen offset:128 nt
    s_waitcnt vmcnt(23)
    buffer_load_dwordx4 a[88:91], v80, s[8:11], s96 offen offset:256 nt
    s_add_u32 s96, s96, s97
    s_waitcnt vmcnt(23)
    buffer_load_dwordx4 a[76:79], v80, s[8:11], s96 offen offset:0 nt
    s_waitcnt vmcnt(23)
    buffer_load_dwordx4 a[84:87], v80, s[8:11], s96 offen offset:128 nt
    s_waitcnt vmcnt(23)
    buffer_load_dwordx4 a[92:95], v80, s[8:11], s96 offen offset:256 nt
    s_add_u32 s96, s96, s97
    s_waitcnt vmcnt(23)
    buffer_load_dwordx4 a[96:99], v80, s[8:11], s96 offen offset:0 nt
    s_waitcnt vmcnt(23)
    buffer_load_dwordx4 a[104:107], v80, s[8:11], s96 offen offset:128 nt
    s_waitcnt vmcnt(23)
    buffer_load_dwordx4 a[112:115], v80, s[8:11], s96 offen offset:256 nt
    s_add_u32 s96, s96, s97
    s_waitcnt vmcnt(23)
    buffer_load_dwordx4 a[100:103], v80, s[8:11], s96 offen offset:0 nt
    s_waitcnt vmcnt(23)
    buffer_load_dwordx4 a[108:111], v80, s[8:11], s96 offen offset:128 nt
    s_waitcnt vmcnt(23)
    buffer_load_dwordx4 a[116:119], v80, s[8:11], s96 offen offset:256 nt
    s_add_u32 s96, s96, s97
    s_waitcnt vmcnt(23)
    buffer_load_dwordx4 a[120:123], v80, s[8:11], s96 offen offset:0 nt
    s_waitcnt vmcnt(23)
    buffer_load_dwordx4 a[128:131], v80, s[8:11], s96 offen offset:128 nt
    s_waitcnt vmcnt(23)
    buffer_load_dwordx4 a[136:139], v80, s[8:11], s96 offen offset:256 nt
    s_add_u32 s96, s96, s97
    s_waitcnt vmcnt(23)
    buffer_load_dwordx4 a[124:127], v80, s[8:11], s96 offen offset:0 nt
    s_waitcnt vmcnt(23)
    buffer_load_dwordx4 a[132:135], v80, s[8:11], s96 offen offset:128 nt
    s_waitcnt vmcnt(23)
    buffer_load_dwordx4 a[140:143], v80, s[8:11], s96 offen offset:256 nt
    s_add_u32 s96, s96, s97
    s_waitcnt vmcnt(23)
    buffer_load_dwordx4 a[144:147], v80, s[8:11], s96 offen offset:0 nt
    s_waitcnt vmcnt(23)
    buffer_load_dwordx4 a[152:155], v80, s[8:11], s96 offen offset:128 nt
    s_waitcnt vmcnt(23)
    buffer_load_dwordx4 a[160:163], v80, s[8:11], s96 offen offset:256 nt
    s_add_u32 s96, s96, s97
    s_waitcnt vmcnt(23)
    buffer_load_dwordx4 a[148:151], v80, s[8:11], s96 offen offset:0 nt
    s_waitcnt vmcnt(23)
    buffer_load_dwordx4 a[156:159], v80, s[8:11], s96 offen offset:128 nt
    s_waitcnt vmcnt(23)
    buffer_load_dwordx4 a[164:167], v80, s[8:11], s96 offen offset:256 nt
    s_add_u32 s96, s96, s97
    s_waitcnt vmcnt(23)
    buffer_load_dwordx4 a[168:171], v80, s[8:11], s96 offen offset:0 nt
    s_waitcnt vmcnt(23)
    buffer_load_dwordx4 a[176:179], v80, s[8:11], s96 offen offset:128 nt
    s_waitcnt vmcnt(23)
    buffer_load_dwordx4 a[184:187], v80, s[8:11], s96 offen offset:256 nt
    s_add_u32 s96, s96, s97
    s_waitcnt vmcnt(23)
    buffer_load_dwordx4 a[172:175], v80, s[8:11], s96 offen offset:0 nt
    s_waitcnt vmcnt(23)
    buffer_load_dwordx4 a[180:183], v80, s[8:11], s96 offen offset:128 nt
    s_waitcnt vmcnt(23)
    buffer_load_dwordx4 a[188:191], v80, s[8:11], s96 offen offset:256 nt
    s_lshl_b32 s97, s97, 1
    s_waitcnt vmcnt(23)
    buffer_load_dwordx4 a[192:195], v82, s[12:15], s55 offen offset:0 nt
    s_waitcnt vmcnt(23)
    buffer_load_dwordx4 a[200:203], v82, s[12:15], s55 offen offset:128 nt
    s_waitcnt vmcnt(23)
    buffer_load_dwordx4 a[208:211], v82, s[12:15], s55 offen offset:256 nt
    s_waitcnt vmcnt(23)
    buffer_load_dwordx4 a[216:219], v82, s[12:15], s55 offen offset:384 nt
    s_waitcnt vmcnt(23)
    buffer_load_dwordx4 a[224:227], v82, s[12:15], s55 offen offset:512 nt
    s_waitcnt vmcnt(23)
    buffer_load_dwordx4 a[232:235], v82, s[12:15], s55 offen offset:640 nt
    s_add_u32 s55, s55, s97
    s_waitcnt vmcnt(23)
    buffer_load_dwordx4 a[196:199], v82, s[12:15], s55 offen offset:0 nt
    s_waitcnt vmcnt(23)
    buffer_load_dwordx4 a[204:207], v82, s[12:15], s55 offen offset:128 nt
    s_waitcnt vmcnt(23)
    buffer_load_dwordx4 a[212:215], v82, s[12:15], s55 offen offset:256 nt
    s_waitcnt vmcnt(23)
    buffer_load_dwordx4 a[220:223], v82, s[12:15], s55 offen offset:384 nt
    s_waitcnt vmcnt(23)
    buffer_load_dwordx4 a[228:231], v82, s[12:15], s55 offen offset:512 nt
    s_waitcnt vmcnt(23)
    buffer_load_dwordx4 a[236:239], v82, s[12:15], s55 offen offset:640 nt
    s_add_u32 s55, s55, s97
    s_waitcnt vmcnt(23)
    buffer_load_dwordx4 a[240:243], v82, s[12:15], s55 offen offset:0 nt
    s_waitcnt vmcnt(23)
    buffer_load_dwordx4 a[248:251], v82, s[12:15], s55 offen offset:128 nt
    s_waitcnt vmcnt(23)
    buffer_load_dwordx4 v[128:131], v82, s[12:15], s55 offen offset:256 nt
    s_waitcnt vmcnt(23)
    buffer_load_dwordx4 v[136:139], v82, s[12:15], s55 offen offset:384 nt
    s_waitcnt vmcnt(23)
    buffer_load_dwordx4 v[144:147], v82, s[12:15], s55 offen offset:512 nt
    s_waitcnt vmcnt(23)
    buffer_load_dwordx4 v[152:155], v82, s[12:15], s55 offen offset:640 nt
    s_add_u32 s55, s55, s97
    s_waitcnt vmcnt(23)
    buffer_load_dwordx4 a[244:247], v82, s[12:15], s55 offen offset:0 nt
    s_waitcnt vmcnt(23)
    buffer_load_dwordx4 a[252:255], v82, s[12:15], s55 offen offset:128 nt
    s_waitcnt vmcnt(23)
    buffer_load_dwordx4 v[132:135], v82, s[12:15], s55 offen offset:256 nt
    s_waitcnt vmcnt(23)
    buffer_load_dwordx4 v[140:143], v82, s[12:15], s55 offen offset:384 nt
    s_waitcnt vmcnt(23)
    buffer_load_dwordx4 v[148:151], v82, s[12:15], s55 offen offset:512 nt
    s_waitcnt vmcnt(23)
    buffer_load_dwordx4 v[156:159], v82, s[12:15], s55 offen offset:640 nt
    s_add_u32 s55, s55, s97
    s_waitcnt vmcnt(23)
    buffer_load_dwordx4 v[160:163], v82, s[12:15], s55 offen offset:0 nt
    s_waitcnt vmcnt(23)
    buffer_load_dwordx4 v[168:171], v82, s[12:15], s55 offen offset:128 nt
    s_waitcnt vmcnt(23)
    buffer_load_dwordx4 v[176:179], v82, s[12:15], s55 offen offset:256 nt
    s_waitcnt vmcnt(23)
    buffer_load_dwordx4 v[184:187], v82, s[12:15], s55 offen offset:384 nt
    s_waitcnt vmcnt(23)
    buffer_load_dwordx4 v[192:195], v82, s[12:15], s55 offen offset:512 nt
    s_waitcnt vmcnt(23)
    buffer_load_dwordx4 v[200:203], v82, s[12:15], s55 offen offset:640 nt
    s_add_u32 s55, s55, s97
    s_waitcnt vmcnt(23)
    buffer_load_dwordx4 v[164:167], v82, s[12:15], s55 offen offset:0 nt
    s_waitcnt vmcnt(23)
    buffer_load_dwordx4 v[172:175], v82, s[12:15], s55 offen offset:128 nt
    s_waitcnt vmcnt(23)
    buffer_load_dwordx4 v[180:183], v82, s[12:15], s55 offen offset:256 nt
    s_waitcnt vmcnt(23)
    buffer_load_dwordx4 v[188:191], v82, s[12:15], s55 offen offset:384 nt
    s_waitcnt vmcnt(23)
    buffer_load_dwordx4 v[196:199], v82, s[12:15], s55 offen offset:512 nt
    s_waitcnt vmcnt(23)
    buffer_load_dwordx4 v[204:207], v82, s[12:15], s55 offen offset:640 nt
    s_add_u32 s55, s55, s97
    s_waitcnt vmcnt(23)
    buffer_load_dwordx4 v[208:211], v82, s[12:15], s55 offen offset:0 nt
    s_waitcnt vmcnt(23)
    buffer_load_dwordx4 v[216:219], v82, s[12:15], s55 offen offset:128 nt
    s_waitcnt vmcnt(23)
    buffer_load_dwordx4 v[224:227], v82, s[12:15], s55 offen offset:256 nt
    s_waitcnt vmcnt(23)
    buffer_load_dwordx4 v[232:235], v82, s[12:15], s55 offen offset:384 nt
    s_waitcnt vmcnt(23)
    buffer_load_dwordx4 v[240:243], v82, s[12:15], s55 offen offset:512 nt
    s_waitcnt vmcnt(23)
    buffer_load_dwordx4 v[248:251], v82, s[12:15], s55 offen offset:640 nt
    s_add_u32 s55, s55, s97
    s_barrier
    s_waitcnt vmcnt(23)
    buffer_load_dwordx4 v[212:215], v82, s[12:15], s55 offen offset:0 nt
    s_waitcnt vmcnt(23)
    buffer_load_dwordx4 v[220:223], v82, s[12:15], s55 offen offset:128 nt
    s_waitcnt vmcnt(23)
    buffer_load_dwordx4 v[228:231], v82, s[12:15], s55 offen offset:256 nt
    s_waitcnt vmcnt(23)
    buffer_load_dwordx4 v[236:239], v82, s[12:15], s55 offen offset:384 nt
    s_waitcnt vmcnt(23)
    buffer_load_dwordx4 v[244:247], v82, s[12:15], s55 offen offset:512 nt
    s_waitcnt vmcnt(23)
    buffer_load_dwordx4 v[252:255], v82, s[12:15], s55 offen offset:640 nt
    s_branch QFRAG
HOOKF:
    v_mov_b32 v52, 98784
    ds_read_b32 v52, v52
    s_mov_b32 s6, 0
    s_waitcnt lgkmcnt(0)
    v_readfirstlane_b32 s101, v52
    s_and_b32 s50, s101, 1
    s_and_b32 s0, s101, 2
    s_lshl_b32 s0, s0, 12
    s_and_b32 s101, s101, 0xffffffe0
    s_cmp_lg_u32 s50, 0
    s_cselect_b32 s32, s62, 1610612736
    s_cselect_b32 s33, 1610612736, s62
    s_cmp_lg_u32 s50, 0
    s_cselect_b32 s34, s49, 1610612736
    s_cselect_b32 s35, 1610612736, s49
    s_add_u32 s99, s49, s0
    s_xor_b32 s1, s99, 8192
    s_waitcnt vmcnt(48)
    s_branch QK
AGENP:
    s_add_u32 s51, s51, 1
    s_cmp_lt_u32 s51, 0x40000
    s_cbranch_scc1 ENP
    s_branch OKENP
HOOKC:
    s_cmp_eq_u32 s44, 3
    s_cbranch_scc1 EXB
    s_cmp_eq_u32 s44, 1
    s_cbranch_scc1 WM1
    s_cmp_eq_u32 s44, 2
    s_cbranch_scc1 WM2
    v_min_u32 v83, 8, v1
    v_lshlrev_b32 v83, 7, v83
    s_mul_i32 s52, s45, 28160
    s_mul_i32 s54, s46, 1152
    s_add_u32 s52, s52, s54
    s_add_u32 s52, s52, 131072
    buffer_load_dword v83, v83, s[16:19], s52 offen sc1
    s_branch WM3
WM1:
    v_min_u32 v83, 11, v1
    v_lshlrev_b32 v83, 7, v83
    s_mul_i32 s52, s45, 45312
    s_mul_i32 s54, s46, 1536
    s_add_u32 s52, s52, s54
    s_add_u32 s52, s52, 529408
    buffer_load_dword v83, v83, s[16:19], s52 offen sc1
    s_branch WM3
WM2:
    v_min_u32 v83, 11, v1
    v_lshlrev_b32 v83, 7, v83
    s_mul_i32 s52, s45, 49152
    s_mul_i32 s54, s46, 1536
    s_add_u32 s52, s52, s54
    s_add_u32 s52, s52, 1441792
    buffer_load_dword v83, v83, s[16:19], s52 offen sc1
WM3:
    v_lshrrev_b32 v58, 3, v1
    v_and_b32 v57, 7, v1
    v_and_b32 v56, 2, v58
    v_xor_b32 v57, v57, v56
    s_and_b32 s52, s44, 1
    s_lshl_b32 s52, s52, 2
    v_xor_b32 v57, s52, v57
    v_mul_u32_u24 v56, 3072, v58
    v_lshl_add_u32 v56, v57, 4, v56
    v_lshrrev_b32 v58, 3, v1
    v_and_b32 v57, 7, v1
    v_and_b32 v55, 2, v58
    v_xor_b32 v57, v57, v55
    s_and_b32 s52, s44, 1
    s_lshl_b32 s52, s52, 2
    v_xor_b32 v57, s52, v57
    v_mul_u32_u24 v55, 1280, v58
    v_lshl_add_u32 v55, v57, 4, v55
    s_barrier
    s_cmp_ge_u32 s46, 20
    s_cbranch_scc1 HC8
    s_mul_i32 s52, s45, 983040
    s_mul_i32 s54, s56, 491520
    s_add_u32 s52, s52, s54
    s_lshl_b32 s54, s57, 7
    s_add_u32 s52, s52, s54
    s_mul_i32 s54, s44, 10240
    s_add_u32 s52, s52, s54
    s_lshl_b32 s53, s44, 10
DMA1:
    s_mov_b32 m0, s53
    s_add_u32 s53, s53, 3072
    buffer_load_dwordx4 v55, s[24:27], s52 offen nt lds
    v_xor_b32 v55, 64, v55
    s_add_u32 s52, s52, 30720
    s_cmp_lt_u32 s53, 49152
    s_cbranch_scc1 DMA1
HC8:
    s_cmp_ge_u32 s46, 30
    s_cbranch_scc1 HC7
    s_mul_i32 s52, s3, 393216
    s_mul_i32 s54, s45, 384
    s_add_u32 s52, s52, s54
    s_lshl_b32 s54, s59, 7
    s_add_u32 s52, s52, s54
    s_mul_i32 s54, s44, 24576
    s_add_u32 s52, s52, s54
    s_lshl_b32 s53, s44, 10
    s_add_u32 s53, s53, 49152
DMA2:
    s_mov_b32 m0, s53
    s_add_u32 s53, s53, 3072
    buffer_load_dwordx4 v56, s[28:31], s52 offen nt lds
    v_xor_b32 v56, 64, v56
    s_add_u32 s52, s52, 73728
    s_cmp_lt_u32 s53, 65536
    s_cbranch_scc1 DMA2
HC7:
    s_branch EXB
HOOKG:
    s_cmp_lg_u32 s49, 0
    s_cbranch_scc1 WOX
    s_cmp_ge_u32 s46, 20
    s_cbranch_scc1 HOOKG3
    v_and_b32 v72, 3, v1
    v_lshlrev_b32 v72, 3, v72
    v_bfe_u32 v73, v1, 2, 2
    v_lshl_add_u32 v72, v73, 7, v72
    v_lshrrev_b32 v73, 4, v1
    v_lshl_add_u32 v72, v73, 10, v72
    v_bfe_u32 v73, v1, 3, 2
    v_lshl_add_u32 v72, v73, 5, v72
    s_mul_i32 s52, s44, 12288
    v_add_u32 v72, s52, v72
    v_xor_b32 v73, 32, v72
    v_xor_b32 v74, 64, v72
    v_xor_b32 v75, 96, v72
    s_cmp_lg_u32 s44, 3
    s_cbranch_scc1 QCNA
    v_lshlrev_b32 v38, 2, v1
    v_add_u32 v39, 109568, v38
    v_lshlrev_b32 v38, 1, v38
    ds_read_b32 v32, v39 offset:0
    ds_read_b32 v34, v39 offset:256
    ds_read_b32 v36, v39 offset:512
    s_mul_i32 s52, s47, 12288
    s_mul_i32 s54, s48, 1536
    s_add_u32 s52, s52, s54
    s_add_u32 s52, s52, 1441792
    s_cmp_lg_u32 s50, 0
    s_cselect_b32 s53, s52, 1610612736
    s_cselect_b32 s54, 1610612736, s52
    s_waitcnt lgkmcnt(0)
    v_xor_b32 v33, s101, v32
    v_xor_b32 v35, s101, v34
    v_xor_b32 v37, s101, v36
    buffer_store_dwordx2 v[32:33], v38, s[16:19], s53 offen offset:0
    buffer_store_dwordx2 v[34:35], v38, s[16:19], s53 offen offset:512
    buffer_store_dwordx2 v[36:37], v38, s[16:19], s53 offen offset:1024
    s_cmp_eq_u32 s50, 0
    s_cbranch_scc1 SLOW4
PUBD4:
    s_branch QCMA
QCNA:
    s_waitcnt vmcnt(1)
QCMA:
    s_barrier
    buffer_load_dword v56, v65, s[16:19], s62 offen sc1
    buffer_load_dwordx4 v[44:47], v64, s[16:19], s62 offen offset:0 sc1
    buffer_load_dwordx4 v[48:51], v64, s[16:19], s62 offen offset:512 sc1
    buffer_load_dwordx4 v[52:55], v64, s[16:19], s62 offen offset:1024 sc1
    buffer_load_dword v57, v66, s[16:19], s49 offen sc1
    ds_read_b64_tr_b16 v[80:81], v72 offset:0
    ds_read_b64_tr_b16 v[82:83], v72 offset:512
    ds_read_b64_tr_b16 v[96:97], v72 offset:4096
    ds_read_b64_tr_b16 v[98:99], v72 offset:4608
    ds_read_b64_tr_b16 v[112:113], v72 offset:8192
    ds_read_b64_tr_b16 v[114:115], v72 offset:8704
    ds_read_b64_tr_b16 v[84:85], v73 offset:0
    ds_read_b64_tr_b16 v[86:87], v73 offset:512
    ds_read_b64_tr_b16 v[100:101], v73 offset:4096
    ds_read_b64_tr_b16 v[102:103], v73 offset:4608
    ds_read_b64_tr_b16 v[116:117], v73 offset:8192
    ds_read_b64_tr_b16 v[118:119], v73 offset:8704
    ds_read_b64_tr_b16 v[88:89], v74 offset:0
    ds_read_b64_tr_b16 v[90:91], v74 offset:512
    ds_read_b64_tr_b16 v[104:105], v74 offset:4096
    ds_read_b64_tr_b16 v[106:107], v74 offset:4608
    ds_read_b64_tr_b16 v[120:121], v74 offset:8192
    ds_read_b64_tr_b16 v[122:123], v74 offset:8704
    ds_read_b64_tr_b16 v[92:93], v75 offset:0
    ds_read_b64_tr_b16 v[94:95], v75 offset:512
    ds_read_b64_tr_b16 v[108:109], v75 offset:4096
    ds_read_b64_tr_b16 v[110:111], v75 offset:4608
    ds_read_b64_tr_b16 v[124:125], v75 offset:8192
    ds_read_b64_tr_b16 v[126:127], v75 offset:8704
    s_waitcnt lgkmcnt(0) vmcnt(0)
    s_branch WOC
HOOKG3:
    s_cmp_lg_u32 s44, 3
    s_cbranch_scc1 QCNB
    v_lshlrev_b32 v38, 2, v1
    v_add_u32 v39, 109568, v38
    v_lshlrev_b32 v38, 1, v38
    ds_read_b32 v32, v39 offset:0
    ds_read_b32 v34, v39 offset:256
    ds_read_b32 v36, v39 offset:512
    s_mul_i32 s52, s47, 12288
    s_mul_i32 s54, s48, 1536
    s_add_u32 s52, s52, s54
    s_add_u32 s52, s52, 1441792
    s_cmp_lg_u32 s50, 0
    s_cselect_b32 s53, s52, 1610612736
    s_cselect_b32 s54, 1610612736, s52
    s_waitcnt lgkmcnt(0)
    v_xor_b32 v33, s101, v32
    v_xor_b32 v35, s101, v34
    v_xor_b32 v37, s101, v36
    buffer_store_dwordx2 v[32:33], v38, s[16:19], s53 offen offset:0
    buffer_store_dwordx2 v[34:35], v38, s[16:19], s53 offen offset:512
    buffer_store_dwordx2 v[36:37], v38, s[16:19], s53 offen offset:1024
    s_cmp_eq_u32 s50, 0
    s_cbranch_scc1 SLOW5
PUBD5:
    s_branch QCMB
QCNB:
    s_waitcnt vmcnt(1)
QCMB:
    s_barrier
    s_cmp_lg_u32 s46, 31
    s_cbranch_scc1 EW1
    s_cmp_lg_u32 s44, 0
    s_cbranch_scc1 WOX
    v_and_b32 v32, 31, v1
    v_lshlrev_b32 v32, 2, v32
    v_add_u32 v32, 19968, v32
    s_lshl_b32 s52, s45, 7
    s_add_u32 s52, s52, 118784
    v_lshlrev_b32 v34, 13, v1
EWP:
    buffer_load_dword v33, v32, s[16:19], s62 offen sc1
    s_waitcnt vmcnt(0)
    v_cmp_u_f32 vcc, v33, v33
    s_cbranch_vccz EWOK
    s_add_u32 s51, s51, 1
    s_cmp_lt_u32 s51, 0x40000
    s_cbranch_scc1 EWP
EWOK:
    s_mov_b64 exec, 3
    buffer_store_dword v34, v34, s[16:19], s52 offen sc1
    s_mov_b64 exec, -1
EW1:
    s_cmp_ge_u32 s46, 30
    s_cbranch_scc1 WOX
    s_cmp_eq_u32 s44, 3
    s_cbranch_scc1 HD0
    v_lshrrev_b32 v33, 3, v1
    v_and_b32 v32, 7, v1
    v_and_b32 v34, 2, v33
    v_xor_b32 v32, v32, v34
    s_and_b32 s52, s44, 1
    s_lshl_b32 s52, s52, 2
    v_xor_b32 v32, s52, v32
    v_mul_u32_u24 v34, 1280, v33
    v_lshl_add_u32 v34, v32, 4, v34
    s_mul_i32 s52, s45, 245760
    s_lshl_b32 s54, s57, 7
    s_add_u32 s52, s52, s54
    s_mul_i32 s54, s44, 10240
    s_add_u32 s52, s52, s54
    s_lshl_b32 s53, s44, 10
DMA3:
    s_mov_b32 m0, s53
    s_add_u32 s53, s53, 3072
    buffer_load_dwordx4 v34, s[24:27], s52 offen nt lds
    v_xor_b32 v34, 64, v34
    s_add_u32 s52, s52, 30720
    s_cmp_lt_u32 s53, 24576
    s_cbranch_scc1 DMA3
HD0:
    v_mov_b64 v[116:117], -1
    v_mov_b64 v[118:119], -1
    v_mov_b32 v23, 1879048192
    s_mul_i32 s52, s57, 5120
    s_mul_i32 s54, s44, 1280
    s_add_u32 s52, s52, s54
    v_lshl_add_u32 v120, v1, 4, s52
    s_add_u32 s52, s52, 1024
    v_lshl_add_u32 v121, v1, 2, s52
    s_lshl_b32 s52, s57, 14
    s_lshl_b32 s54, s45, 11
    s_add_u32 s52, s52, s54
    s_lshl_b32 s54, s44, 9
    s_add_u32 s52, s52, s54
    v_lshl_add_u32 v122, v1, 3, s52
    v_cmp_gt_u32 vcc, 45312, v120
    s_nop 1
    v_cndmask_b32 v120, v23, v120, vcc
    v_cmp_gt_u32 vcc, 45312, v121
    s_nop 1
    v_cndmask_b32 v121, v23, v121, vcc
    v_cmp_gt_u32 vcc, 136192, v122
    s_nop 1
    v_cndmask_b32 v122, v23, v122, vcc
    s_branch F1E
AGWOP:
    s_add_u32 s51, s51, 1
    s_cmp_lt_u32 s51, 0x40000
    s_cbranch_scc1 WOP
    s_branch OKWOP
HOOKD:
    ds_read_b128 v[20:23], v2 offset:256
    ds_read_b128 v[24:27], v2 offset:320
    ds_read_b128 v[28:31], v2 offset:384
    ds_read_b128 v[32:35], v2 offset:448
    s_waitcnt lgkmcnt(0)
    v_mfma_f32_16x16x32_bf16 v[40:43], v[20:23], v[64:67], 0
    v_mfma_f32_16x16x32_bf16 v[40:43], v[24:27], v[68:71], v[40:43]
    v_mfma_f32_16x16x32_bf16 v[40:43], v[28:31], v[72:75], v[40:43]
    v_mfma_f32_16x16x32_bf16 v[40:43], v[32:35], v[76:79], v[40:43]
    s_add_u32 s52, s62, 8192
    s_cmp_lg_u32 s50, 0
    s_cselect_b32 s53, s52, 1610612736
    s_cselect_b32 s54, 1610612736, s52
    s_nop 3
    buffer_store_dword v41, v55, s[16:19], s53 offen offset:0
    s_cmp_eq_u32 s50, 0
    s_cbranch_scc1 SLOW6
PUBD6:
    v_and_b32 v16, 7, v1
    v_lshlrev_b32 v16, 7, v16
    s_add_u32 s52, s0, 118784
EWQ:
    buffer_load_dword v17, v16, s[16:19], s52 offen sc1
    s_waitcnt vmcnt(0)
    v_cmp_u_f32 vcc, v17, v17
    s_cbranch_vccz EWQK
    s_add_u32 s51, s51, 1
    s_sleep 1
    s_cmp_lt_u32 s51, 0x40000
    s_cbranch_scc1 EWQ
EWQK:
    s_sleep 1
    s_mov_b32 s51, 0
    s_cmp_lt_u32 s46, 20
    s_cbranch_scc1 F1W
    s_mov_b32 s100, 3
    s_cmp_lg_u32 s50, 0
    s_cselect_b32 s53, s63, 1610612736
    s_cselect_b32 s54, 1610612736, s63
    buffer_store_dwordx4 v[116:119], v120, s[16:19], s53 offen offset:0
    buffer_store_dword v116, v121, s[16:19], s53 offen offset:0
    s_cmp_eq_u32 s50, 0
    s_cbranch_scc1 SLOW7
PUBD7:
    s_mov_b32 s52, 393216
    buffer_store_dwordx2 v[116:117], v122, s[16:19], s52 offen sc1
    s_branch F1P
AGF1P:
    s_add_u32 s51, s51, 1
    s_sleep 1
    s_cmp_lt_u32 s51, 0x40000
    s_cbranch_scc1 F1P
    s_branch OKF1P
HOOKI:
    s_add_u32 s52, s62, 8192
    buffer_load_dwordx4 v[104:107], v58, s[16:19], s52 offen offset:0 sc1
    buffer_load_dwordx4 v[108:111], v58, s[16:19], s52 offen offset:3072 sc1
    buffer_load_dwordx2 v[112:113], v59, s[16:19], s52 offen sc1
    ds_read_b64_tr_b16 v[80:81], v57 offset:0
    ds_read_b64_tr_b16 v[82:83], v57 offset:512
    ds_read_b64_tr_b16 v[84:85], v57 offset:4096
    ds_read_b64_tr_b16 v[86:87], v57 offset:4608
    ds_read_b64_tr_b16 v[88:89], v57 offset:8192
    ds_read_b64_tr_b16 v[90:91], v57 offset:8704
    ds_read_b64_tr_b16 v[92:93], v57 offset:12288
    ds_read_b64_tr_b16 v[94:95], v57 offset:12800
    ds_read_b64_tr_b16 v[96:97], v57 offset:16384
    ds_read_b64_tr_b16 v[98:99], v57 offset:16896
    ds_read_b64_tr_b16 v[100:101], v57 offset:20480
    ds_read_b64_tr_b16 v[102:103], v57 offset:20992
    buffer_load_dword v74, v60, s[16:19], s62 offen sc1
    buffer_load_dwordx4 v[64:67], v58, s[16:19], s62 offen offset:0 sc1
    buffer_load_dwordx4 v[68:71], v58, s[16:19], s62 offen offset:3072 sc1
    buffer_load_dwordx2 v[72:73], v59, s[16:19], s62 offen sc1
    buffer_load_dword v76, v61, s[16:19], s49 offen sc1
    s_sleep 1
    s_waitcnt vmcnt(5)
GCC:
    v_pk_add_f32 v[114:115], v[104:105], v[106:107]
    v_pk_add_f32 v[116:117], v[108:109], v[110:111]
    v_add_f32 v126, v114, v115
    v_add_f32 v127, v116, v117
    v_pk_add_f32 v[126:127], v[126:127], v[112:113]
    v_cmp_u_f32 vcc, v126, v127
    s_cbranch_vccz W2P
    s_add_u32 s52, s62, 8192
    buffer_load_dwordx4 v[104:107], v58, s[16:19], s52 offen offset:0 sc1
    buffer_load_dwordx4 v[108:111], v58, s[16:19], s52 offen offset:3072 sc1
    buffer_load_dwordx2 v[112:113], v59, s[16:19], s52 offen sc1
    s_waitcnt vmcnt(0)
    s_add_u32 s51, s51, 1
    s_cmp_lt_u32 s51, 0x40000
    s_cbranch_scc1 GCC
    s_branch W2P
AGW2P:
    s_add_u32 s51, s51, 1
    s_cmp_lt_u32 s51, 0x40000
    s_cbranch_scc1 W2P
    s_branch OKW2P
AGY3P:
    s_add_u32 s51, s51, 1
    s_sleep 1
    s_cmp_lt_u32 s51, 0x40000
    s_cbranch_scc1 Y3P
    s_branch OKY3P
SLOW1:
    buffer_store_dword v30, v18, s[16:19], s35 offen offset:0 sc1
    s_branch PUBD1
SLOW2:
    buffer_store_dword v16, v14, s[16:19], s33 offen offset:0 sc1
    buffer_store_dword v20, v14, s[16:19], s33 offen offset:1024 sc1
    buffer_store_dword v24, v14, s[16:19], s33 offen offset:2048 sc1
    buffer_store_dwordx2 v[28:29], v15, s[16:19], s33 offen offset:0 sc1
    s_branch PUBD2
SLOW3:
    buffer_store_dword v24, v14, s[16:19], s33 offen offset:0 sc1
    s_branch PUBD3
SLOW4:
    buffer_store_dwordx2 v[32:33], v38, s[16:19], s54 offen offset:0 sc1
    buffer_store_dwordx2 v[34:35], v38, s[16:19], s54 offen offset:512 sc1
    buffer_store_dwordx2 v[36:37], v38, s[16:19], s54 offen offset:1024 sc1
    s_branch PUBD4
SLOW5:
    buffer_store_dwordx2 v[32:33], v38, s[16:19], s54 offen offset:0 sc1
    buffer_store_dwordx2 v[34:35], v38, s[16:19], s54 offen offset:512 sc1
    buffer_store_dwordx2 v[36:37], v38, s[16:19], s54 offen offset:1024 sc1
    s_branch PUBD5
SLOW6:
    buffer_store_dword v41, v55, s[16:19], s54 offen offset:0 sc1
    s_branch PUBD6
SLOW7:
    buffer_store_dwordx4 v[116:119], v120, s[16:19], s54 offen offset:0 sc1
    buffer_store_dword v116, v121, s[16:19], s54 offen offset:0 sc1
    s_branch PUBD7
SLOW8:
    buffer_store_dword v16, v54, s[16:19], s35 offen offset:0 sc1
    s_branch PUBD8
SLOW9:
    buffer_store_dword v40, v55, s[16:19], s33 offen offset:0 sc1
    buffer_store_dwordx2 v[36:37], v56, s[16:19], s33 offen offset:0 sc1
    s_branch PUBD9
CODEEND:
    s_endpgm
.section .rodata,"a"
.p2align 6
.amdhsa_kernel interleave_layers__sliding_block_cached__glu_gated_swiglu__decode_kernel
  .amdhsa_next_free_vgpr 512
  .amdhsa_next_free_sgpr 102
  .amdhsa_accum_offset 256
  .amdhsa_group_segment_fixed_size 0
  .amdhsa_kernarg_size 96
  .amdhsa_user_sgpr_count 2
  .amdhsa_user_sgpr_kernarg_segment_ptr 1
  .amdhsa_system_sgpr_workgroup_id_x 1
.end_amdhsa_kernel
```
